```python
import torch

def _softmax(x, axis=-1):
    return torch.softmax(x, dim=axis)

def _gelu(x):
    return torch.nn.functional.gelu(x, approximate='tanh')

def _silu(x):
    return torch.nn.functional.silu(x)

def _sigmoid(x):
    return torch.sigmoid(x)

def _layernorm(x, axis=-1, eps=1e-05):
    m = x.mean(dim=axis, keepdim=True)
    v = x.var(dim=axis, keepdim=True, unbiased=False)
    return (x - m) / torch.sqrt(v + eps)

def _scatter_add(tgt, idx, src, axis=0):
    return tgt.clone().index_add_(axis, idx, src)

def _segment_sum(src, seg, n):
    out = torch.zeros((n,) + src.shape[1:], dtype=src.dtype)
    return out.index_add_(0, seg, src)

def _pad(x, pw):
    flat = tuple((v for pair in reversed(pw) for v in pair))
    return torch.nn.functional.pad(x, flat)
kernel_name = 'gated_mix__memory_aug_recurrent_mem_tr__dense_activation_silu__prompt'

def setup_inputs():

    _w = lambda a: (lambda t: t.to(torch.bfloat16) if t.is_floating_point() else t)(torch.as_tensor(a))

    def _A_setup():
        B, S, Dm = (1, 2048, 1024)
        H, Dh = (32, 128)
        M, seg = (8, 32)
        seg = min(seg, S)
        S = S // seg * seg
        return {'x': _w((lambda *s: torch.randn(*s, dtype=torch.bfloat16) * 0.1)(B, S, Dm)), 'mem0': _w((lambda *s: torch.randn(*s, dtype=torch.bfloat16) * 0.8)(B, M, Dm)), 'Wq': _w((lambda *s: torch.randn(*s, dtype=torch.bfloat16) * 6.4)(Dm, H, Dh) * Dm ** (-0.5)), 'Wk': _w((lambda *s: torch.randn(*s, dtype=torch.bfloat16) * 6.4)(Dm, H, Dh) * Dm ** (-0.5)), 'Wv': _w((lambda *s: torch.randn(*s, dtype=torch.bfloat16) * 0.8)(Dm, H, Dh) * Dm ** (-0.5)), 'Wo': _w((lambda *s: torch.randn(*s, dtype=torch.bfloat16) * 0.8)(H, Dh, Dm) * (H * Dh) ** (-0.5)), 'seg_len': seg}
    _A_in = _A_setup()

    def _B_setup():
        B, S, D, F = (1, 2048, 1024, 3584)
        return {'x': _w((lambda *s: torch.randn(*s, dtype=torch.bfloat16) * 0.1)(B, S, D)), 'w1': _w((lambda *s: torch.randn(*s, dtype=torch.bfloat16) * 3.2)(D, F) * D ** (-0.5)), 'w2': _w((lambda *s: torch.randn(*s, dtype=torch.bfloat16) * 3.2)(F, D) * F ** (-0.5))}
    _B_in = _B_setup()
    return {'A_x': _A_in['x'], 'A_mem0': _A_in['mem0'], 'A_Wq': _A_in['Wq'], 'A_Wk': _A_in['Wk'], 'A_Wv': _A_in['Wv'], 'A_Wo': _A_in['Wo'], 'A_seg_len': _A_in['seg_len'], 'B_x': _B_in['x'], 'B_w1': _B_in['w1'], 'B_w2': _B_in['w2'], 'gate_w': _w((lambda *s: torch.randn(*s, dtype=torch.bfloat16) * 0.1)(1024) * 16.0)}

def reference(A_x, A_mem0, A_Wq, A_Wk, A_Wv, A_Wo, A_seg_len, B_x, B_w1, B_w2, gate_w):

    def _A_ref(x, mem0, Wq, Wk, Wv, Wo, seg_len):
        B, S, Dm = x.shape
        H, Dh = (Wq.shape[1], Wq.shape[2])
        M = mem0.shape[1]
        scale = Dh ** (-0.5)
        n_seg = S // seg_len
        L = M + seg_len
        idx = torch.arange(L)
        mask = (idx[:, None] < M) | (idx[:, None] >= idx[None, :])
        mem = mem0
        outs = []
        for s in range(n_seg):
            xs = x[:, s * seg_len:(s + 1) * seg_len, :].clone()
            h = torch.concatenate([mem, xs], axis=1)
            q = torch.einsum('btd,dhe->bhte', h, Wq)
            k = torch.einsum('btd,dhe->bhte', h, Wk)
            v = torch.einsum('btd,dhe->bhte', h, Wv)
            scores = torch.einsum('bhqe,bhke->bhqk', q, k) * scale
            scores = torch.where(mask[None, None], scores, -1000000000.0)
            p = _softmax(scores, axis=-1)
            o = torch.einsum('bhqk,bhke->bhqe', p, v)
            o = torch.einsum('bhte,hed->btd', o, Wo)
            mem = o[:, :M, :].clone()
            outs.append(o[:, M:, :])
        return torch.concatenate(outs, axis=1)

    def _B_ref(x, w1, w2):
        h = torch.einsum('bsd,df->bsf', x, w1)
        h = _silu(h)
        out = torch.einsum('bsf,fd->bsd', h, w2)
        return out
    x = A_x
    g = _sigmoid((x * gate_w).sum(-1, keepdims=True))
    a = _A_ref(x, A_mem0, A_Wq, A_Wk, A_Wv, A_Wo, A_seg_len)
    b = _B_ref(x, B_w1, B_w2)
    return g * a + (1 - g) * b
```

```asm
; @launch grid=(256,1,1) block=(512,1,1) lds=163840
.amdgcn_target "amdgcn-amd-amdhsa--gfx950"
.text
.globl gated_mix__memory_aug_recurrent_mem_tr__dense_activation_silu__prompt_kernel
.p2align 8
.type gated_mix__memory_aug_recurrent_mem_tr__dense_activation_silu__prompt_kernel,@function
gated_mix__memory_aug_recurrent_mem_tr__dense_activation_silu__prompt_kernel:
  s_cmp_ge_u32 s2, 256
  s_cbranch_scc1 L_end
  s_load_dwordx4 s[56:59], s[0:1], 96
  s_getreg_b32 s24, hwreg(HW_REG_XCC_ID, 0, 4)
  v_lshrrev_b32 v1, 6, v0
  s_nop 0
  v_readfirstlane_b32 s28, v1
  s_waitcnt lgkmcnt(0)
  s_mov_b32 s4, s58
  s_mov_b32 s5, s59
  s_mov_b32 s6, 0x10000000
  s_mov_b32 s7, 0x20000
  s_mov_b32 s20, s56
  s_mov_b32 s21, s57
  s_mov_b32 s22, 0x100
  s_mov_b32 s23, 0x20000
  v_and_b32 v1, 63, v0
  v_lshlrev_b32 v2, 4, v1
  v_mov_b32 v4, -1
  v_mov_b32 v8, 0
  v_mov_b32 v5, -1
  v_mov_b32 v9, 0
  v_mov_b32 v6, -1
  v_mov_b32 v10, 0
  v_mov_b32 v7, -1
  v_mov_b32 v11, 0
  s_lshl_b32 s42, s28, 8
  s_add_u32 s42, s42, s2
  s_lshl_b32 s42, s42, 10
  s_add_u32 s43, s4, 0x61fffff
  s_and_b32 s43, s43, 0xffe00000
  s_sub_u32 s43, s43, s4
  s_add_u32 s44, s42, 0x5d00000
  s_cmp_lt_u32 s28, 2
  s_cselect_b32 s45, s44, 0
  s_add_u32 s44, s42, 0x5d80000
  s_cmp_ge_u32 s28, 2
  s_cselect_b32 s45, s44, s45
  s_add_u32 s44, s42, s43
  s_sub_u32 s44, s44, 0x180000
  s_cmp_ge_u32 s28, 6
  s_cselect_b32 s45, s44, s45
  buffer_store_dwordx4 v[4:7], v2, s[4:7], s45 offen sc1
  s_cmp_lt_u32 s28, 6
  s_cbranch_scc1 L_clr_1
  s_add_u32 s45, s45, 0x80000
  buffer_store_dwordx4 v[4:7], v2, s[4:7], s45 offen sc1
L_clr_1:
  s_cmp_lg_u32 s28, 1
  s_cbranch_scc1 L_clr_2
  s_cmp_ge_u32 s2, 32
  s_cbranch_scc1 L_clr_2
  s_lshl_b32 s44, s2, 10
  s_add_u32 s44, s44, 0x5c10000
  buffer_store_dwordx4 v[8:11], v2, s[4:7], s44 offen sc1
L_clr_2:
  s_cmp_lg_u32 s28, 0
  s_cbranch_scc1 L_tk_3
  s_and_b32 s42, s24, 3
  s_lshl_b32 s42, s42, 6
  s_and_b32 s43, s24, 12
  s_add_u32 s42, s42, s43
  v_mov_b32 v2, s42
  v_mov_b32 v3, 0x80000000
  v_cmp_eq_u32 vcc, 0, v0
  v_mov_b32 v1, 1
  s_nop 0
  v_cndmask_b32 v2, v3, v2, vcc
  buffer_atomic_add v1, v2, s[20:23], 0 offen sc0
L_tk_3:
  s_waitcnt vmcnt(0)
  s_cmp_lg_u32 s28, 0
  s_cbranch_scc1 L_tk2_4
  v_readfirstlane_b32 s42, v1
  s_nop 1
  v_mov_b32 v1, s42
  v_mov_b32 v2, 17408
  ds_write_b32 v2, v1
  s_waitcnt lgkmcnt(0)
L_tk2_4:
  s_barrier
  s_cmp_lg_u32 s28, 0
  s_cbranch_scc1 L_ini_5
  v_mov_b32 v2, 32
  v_mov_b32 v3, 0x80000000
  v_cmp_eq_u32 vcc, 0, v0
  v_mov_b32 v1, 1
  s_nop 0
  v_cndmask_b32 v2, v3, v2, vcc
  buffer_atomic_add v1, v2, s[20:23], 0 offen
L_ini_5:
  v_mov_b32 v2, 17408
  ds_read_b32 v1, v2
  s_waitcnt lgkmcnt(0)
  v_readfirstlane_b32 s25, v1
  s_nop 3
  s_barrier
  s_mov_b32 s87, 0
  s_mov_b32 s59, 0
  s_mov_b32 s58, 0
  v_and_b32 v1, 63, v0
  s_cmp_ge_u32 s25, 32
  s_cbranch_scc1 L_extra
  s_cmp_ge_u32 s24, 8
  s_cbranch_scc1 L_extra
  s_cmp_lt_u32 s24, 4
  s_cbranch_scc1 L_rec
  s_load_dwordx4 s[60:63], s[0:1], 24
  s_load_dwordx2 s[68:69], s[0:1], 0
  s_lshl_b32 s42, s25, 3
  s_add_u32 s42, s42, s28
  v_and_b32 v12, 63, v0
  v_lshlrev_b32 v12, 4, v12
  s_waitcnt lgkmcnt(0)
  s_mov_b32 s8, s68
  s_mov_b32 s9, s69
  s_mov_b32 s10, 0x400000
  s_mov_b32 s11, 0x20000
  s_lshl_b32 s43, s42, 11
  buffer_load_dwordx4 a[60:63], v12, s[8:11], s43 offen offset:0
  buffer_load_dwordx4 a[60:63], v12, s[8:11], s43 offen offset:1024
  s_and_b32 s43, s24, 2
  s_cmp_eq_u32 s43, 0
  s_cselect_b32 s8, s60, s62
  s_cselect_b32 s9, s61, s63
  s_mov_b32 s10, 0x800000
  s_mov_b32 s11, 0x20000
  s_and_b32 s43, s24, 1
  s_lshl_b32 s43, s43, 12
  s_lshl_b32 s44, s42, 13
  s_add_u32 s43, s43, s44
  buffer_load_dwordx4 a[60:63], v12, s[8:11], s43 offen offset:0
  buffer_load_dwordx4 a[60:63], v12, s[8:11], s43 offen offset:1024
  buffer_load_dwordx4 a[60:63], v12, s[8:11], s43 offen offset:2048
  buffer_load_dwordx4 a[60:63], v12, s[8:11], s43 offen offset:3072
  s_add_u32 s43, s43, 2097152
  buffer_load_dwordx4 a[60:63], v12, s[8:11], s43 offen offset:0
  buffer_load_dwordx4 a[60:63], v12, s[8:11], s43 offen offset:1024
  buffer_load_dwordx4 a[60:63], v12, s[8:11], s43 offen offset:2048
  buffer_load_dwordx4 a[60:63], v12, s[8:11], s43 offen offset:3072
  s_add_u32 s43, s43, 2097152
  buffer_load_dwordx4 a[60:63], v12, s[8:11], s43 offen offset:0
  buffer_load_dwordx4 a[60:63], v12, s[8:11], s43 offen offset:1024
  buffer_load_dwordx4 a[60:63], v12, s[8:11], s43 offen offset:2048
  buffer_load_dwordx4 a[60:63], v12, s[8:11], s43 offen offset:3072
  s_add_u32 s43, s43, 2097152
  buffer_load_dwordx4 a[60:63], v12, s[8:11], s43 offen offset:0
  buffer_load_dwordx4 a[60:63], v12, s[8:11], s43 offen offset:1024
  buffer_load_dwordx4 a[60:63], v12, s[8:11], s43 offen offset:2048
  buffer_load_dwordx4 a[60:63], v12, s[8:11], s43 offen offset:3072
  s_add_u32 s43, s43, 2097152
  s_sub_u32 s24, s24, 4
L_exec:
  s_lshl_b32 s24, s24, 5
  s_add_u32 s25, s25, s24
  v_and_b32 v1, 63, v0
  s_load_dwordx2 s[80:81], s[0:1], 88
  s_waitcnt lgkmcnt(0)
  s_mov_b32 s16, s80
  s_mov_b32 s17, s81
  s_mov_b32 s18, 0x400000
  s_mov_b32 s19, 0x20000
  s_getpc_b64 s[70:71]
L_pc:
  s_add_u32 s70, s70, L_table-L_pc
  s_addc_u32 s71, s71, 0
  s_mov_b32 s68, s70
  s_mov_b32 s69, s71
  s_lshl_b32 s42, s25, 2
  s_load_dword s42, s[70:71], s42
  s_waitcnt lgkmcnt(0)
  s_add_u32 s70, s70, s42
  s_addc_u32 s71, s71, 0
  s_mov_b32 s82, 0
  s_load_dwordx2 s[50:51], s[0:1], 24
  s_load_dwordx2 s[52:53], s[0:1], 16
  s_load_dwordx2 s[54:55], s[0:1], 32
  s_load_dwordx2 s[56:57], s[0:1], 64
  s_waitcnt lgkmcnt(0)
  s_cmp_lg_u32 s58, 0
  s_cbranch_scc1 L_dyn
L_task:
  s_lshl_b32 s42, s82, 5
  s_load_dwordx8 s[72:79], s[70:71], s42
  s_add_u32 s42, s42, 32
  s_load_dwordx8 s[88:95], s[70:71], s42
  s_waitcnt lgkmcnt(0)
  s_cmp_eq_u32 s72, 0
  s_cbranch_scc1 L_dyn
L_run:
  s_cmp_lg_u32 s28, 0
  s_cbranch_scc1 L_go_6
  s_mov_b32 s42, s76
  s_or_b32 s42, s42, s77
  s_cmp_eq_u32 s42, 0
  s_cbranch_scc1 L_go_6
  v_mov_b32 v2, 0
  v_writelane_b32 v2, s76, 0
  v_writelane_b32 v2, s77, 1
  v_lshrrev_b32 v3, 24, v2
  v_lshlrev_b32 v3, 7, v3
  v_and_b32 v2, 0xffffff, v2
  s_mov_b32 s83, 0
  s_add_u32 s42, s59, 0x5c14000
L_poll_8:
  buffer_load_dword v20, v3, s[4:7], s42 offen sc1
  s_waitcnt vmcnt(0)
  v_cmp_lt_u32 vcc, v20, v2
  s_cbranch_vccz L_go_6
  s_sleep 4
  s_add_u32 s83, s83, 1
  s_cmp_lt_u32 s83, 1048576
  s_cbranch_scc1 L_poll_8
  s_branch L_abort
L_go_6:
  s_barrier
  s_mov_b32 s48, s73
  s_mov_b32 s49, s74
  s_cmp_eq_u32 s72, 1
  s_cbranch_scc1 L_t1
  s_cmp_eq_u32 s72, 2
  s_cbranch_scc1 L_t2
  s_cmp_eq_u32 s72, 3
  s_cbranch_scc1 L_t3
  s_cmp_eq_u32 s72, 4
  s_cbranch_scc1 L_t4
  s_cmp_eq_u32 s72, 5
  s_cbranch_scc1 L_t5
  s_cmp_eq_u32 s72, 7
  s_cbranch_scc1 L_t7
  s_cmp_eq_u32 s72, 8
  s_cbranch_scc1 L_t8
  s_cmp_eq_u32 s72, 9
  s_cbranch_scc1 L_t9
  s_cmp_eq_u32 s72, 10
  s_cbranch_scc1 L_t10
  s_cmp_eq_u32 s72, 11
  s_cbranch_scc1 L_t11
  s_cmp_eq_u32 s72, 12
  s_cbranch_scc1 L_t12
  s_cmp_eq_u32 s72, 14
  s_cbranch_scc1 L_t14
  s_cmp_eq_u32 s72, 16
  s_cbranch_scc1 L_t16
  s_cmp_eq_u32 s72, 17
  s_cbranch_scc1 L_t17
  s_branch L_abort
L_t1:
  s_mov_b32 s8, s4
  s_mov_b32 s9, s5
  s_mov_b32 s10, 0x10000000
  s_mov_b32 s11, 0x20000
  s_mov_b32 s33, 1024
  s_mov_b32 s45, 32768
  s_mov_b32 s36, 7
  s_mov_b32 s12, s50
  s_mov_b32 s13, s51
  s_mov_b32 s14, 0x800000
  s_mov_b32 s15, 0x20000
  s_lshl_b32 s32, s48, 11
  s_add_u32 s32, s32, 0x7000000
  s_lshl_b32 s34, s49, 1
  s_mov_b32 s39, 8192
  s_mov_b32 s35, 262144
  s_mov_b32 s38, 131072
  s_mul_i32 s37, s48, 8192
  s_lshl_b32 s42, s49, 5
  s_add_u32 s37, s37, s42
  s_add_u32 s37, s37, 0x0
  s_branch L_body_big_fn_kq
L_t2:
  s_mov_b32 s8, s4
  s_mov_b32 s9, s5
  s_mov_b32 s10, 0x10000000
  s_mov_b32 s11, 0x20000
  s_mov_b32 s33, 1024
  s_mov_b32 s45, 32768
  s_mov_b32 s36, 7
  s_mov_b32 s12, s54
  s_mov_b32 s13, s55
  s_mov_b32 s14, 0x800000
  s_mov_b32 s15, 0x20000
  s_lshl_b32 s32, s48, 11
  s_add_u32 s32, s32, 0x7000000
  s_lshl_b32 s34, s49, 1
  s_mov_b32 s39, 8192
  s_mov_b32 s35, 262144
  s_mov_b32 s38, 262144
  s_lshl_b32 s37, s48, 13
  s_lshl_b32 s42, s49, 6
  s_add_u32 s37, s37, s42
  s_add_u32 s37, s37, 0x1000000
  s_branch L_body_big_fn_v
L_t3:
  s_mov_b32 s8, s4
  s_mov_b32 s9, s5
  s_mov_b32 s10, 0x10000000
  s_mov_b32 s11, 0x20000
  s_mov_b32 s33, 1024
  s_mov_b32 s45, 32768
  s_mov_b32 s36, 7
  s_mov_b32 s12, s52
  s_mov_b32 s13, s53
  s_mov_b32 s14, 0x800000
  s_mov_b32 s15, 0x20000
  s_lshl_b32 s32, s48, 11
  s_add_u32 s32, s32, 0x7000000
  s_lshl_b32 s34, s49, 1
  s_mov_b32 s39, 8192
  s_mov_b32 s35, 262144
  s_mov_b32 s38, 131072
  s_mul_i32 s37, s48, 8192
  s_lshl_b32 s42, s49, 5
  s_add_u32 s37, s37, s42
  s_add_u32 s37, s37, 0x2000000
  s_branch L_body_big_fn_kq
L_t4:
  s_mov_b32 s8, s4
  s_mov_b32 s9, s5
  s_mov_b32 s10, 0x10000000
  s_mov_b32 s11, 0x20000
  s_mov_b32 s33, 1024
  s_mov_b32 s45, 32768
  s_mov_b32 s36, 7
  s_mov_b32 s12, s56
  s_mov_b32 s13, s57
  s_mov_b32 s14, 0x700000
  s_mov_b32 s15, 0x20000
  s_lshl_b32 s32, s48, 11
  s_add_u32 s32, s32, 0x7000000
  s_lshl_b32 s34, s49, 1
  s_mov_b32 s39, 7168
  s_mov_b32 s35, 229376
  s_mov_b32 s38, 114688
  s_mul_i32 s37, s48, 7168
  s_lshl_b32 s42, s49, 5
  s_add_u32 s37, s37, s42
  s_add_u32 s37, s37, 0x3000000
  s_branch L_body_big_fn_kq
L_t5:
  s_load_dwordx2 s[80:81], s[0:1], 72
  s_waitcnt lgkmcnt(0)
  s_mov_b32 s12, s80
  s_mov_b32 s13, s81
  s_mov_b32 s14, 0x700000
  s_mov_b32 s15, 0x20000
  s_mov_b32 s8, s4
  s_mov_b32 s9, s5
  s_mov_b32 s10, 0x10000000
  s_mov_b32 s11, 0x20000
  s_mov_b32 s45, 114688
  s_mul_i32 s32, s48, 7168
  s_add_u32 s32, s32, 0x3000000
  s_mov_b32 s33, 1024
  s_lshl_b32 s34, s49, 1
  s_mov_b32 s39, 2048
  s_mov_b32 s35, 65536
  s_mov_b32 s36, 27
  s_mov_b32 s38, 32768
  s_lshl_b32 s37, s48, 11
  s_lshl_b32 s42, s49, 5
  s_add_u32 s37, s37, s42
  s_add_u32 s37, s37, 0x5000000
  s_branch L_body_big_fm_kq
L_t7:
  s_mov_b32 s36, s75
  s_mul_i32 s42, s28, s36
  s_add_u32 s49, s49, s42
  v_lshlrev_b32 v18, 4, v1
  v_and_b32 v2, 15, v1
  v_lshrrev_b32 v3, 4, v1
  v_and_b32 v7, 7, v1
  v_lshlrev_b32 v4, 4, v7
  v_lshl_add_u32 v4, v3, 7, v4
  v_and_b32 v7, 1, v3
  v_lshlrev_b32 v5, 7, v7
  v_lshl_add_u32 v5, v2, 3, v5
  v_lshlrev_b32 v7, 2, v3
  v_add_u32 v8, 0, v7
  v_cmp_le_u32 s[60:61], v8, v2
  v_add_u32 v8, 1, v7
  v_cmp_le_u32 s[62:63], v8, v2
  v_add_u32 v8, 2, v7
  v_cmp_le_u32 s[64:65], v8, v2
  v_add_u32 v8, 3, v7
  v_cmp_le_u32 s[66:67], v8, v2
  v_cmp_gt_u32 s[84:85], 2, v3
  s_mov_b32 s46, 0x3db504f3
  s_mov_b32 s47, 0x3fb8aa3b
  v_mov_b32 v6, 0xff800000
  s_lshl_b32 s44, s48, 18
  s_lshl_b32 s42, s49, 12
  s_add_u32 s44, s44, s42
  s_add_u32 s43, s44, 0x0
  buffer_load_dwordx4 v[52:55], v18, s[4:7], s43 offen offset:0 sc1
  buffer_load_dwordx4 v[56:59], v18, s[4:7], s43 offen offset:1024 sc1
  buffer_load_dwordx4 v[60:63], v18, s[4:7], s43 offen offset:2048 sc1
  buffer_load_dwordx4 v[64:67], v18, s[4:7], s43 offen offset:3072 sc1
  s_add_u32 s43, s44, 0x2000000
  buffer_load_dwordx4 v[20:23], v18, s[4:7], s43 offen offset:0 sc1
  buffer_load_dwordx4 v[24:27], v18, s[4:7], s43 offen offset:1024 sc1
  buffer_load_dwordx4 v[28:31], v18, s[4:7], s43 offen offset:2048 sc1
  buffer_load_dwordx4 v[32:35], v18, s[4:7], s43 offen offset:3072 sc1
  s_add_u32 s43, s44, 0x20000
  buffer_load_dwordx4 v[68:71], v18, s[4:7], s43 offen offset:0 sc1
  buffer_load_dwordx4 v[72:75], v18, s[4:7], s43 offen offset:1024 sc1
  buffer_load_dwordx4 v[76:79], v18, s[4:7], s43 offen offset:2048 sc1
  buffer_load_dwordx4 v[80:83], v18, s[4:7], s43 offen offset:3072 sc1
  s_add_u32 s43, s44, 0x2020000
  buffer_load_dwordx4 v[36:39], v18, s[4:7], s43 offen offset:0 sc1
  buffer_load_dwordx4 v[40:43], v18, s[4:7], s43 offen offset:1024 sc1
  buffer_load_dwordx4 v[44:47], v18, s[4:7], s43 offen offset:2048 sc1
  buffer_load_dwordx4 v[48:51], v18, s[4:7], s43 offen offset:3072 sc1
  s_lshl_b32 s43, s48, 18
  s_lshl_b32 s42, s49, 13
  s_add_u32 s43, s43, s42
  s_add_u32 s43, s43, 0x1000000
  buffer_load_dwordx4 v[84:87], v18, s[4:7], s43 offen offset:0 sc1
  buffer_load_dwordx4 v[88:91], v18, s[4:7], s43 offen offset:1024 sc1
  buffer_load_dwordx4 v[92:95], v18, s[4:7], s43 offen offset:2048 sc1
  buffer_load_dwordx4 v[96:99], v18, s[4:7], s43 offen offset:3072 sc1
  s_add_u32 s43, s43, 4096
  buffer_load_dwordx4 v[100:103], v18, s[4:7], s43 offen offset:0 sc1
  buffer_load_dwordx4 v[104:107], v18, s[4:7], s43 offen offset:1024 sc1
  buffer_load_dwordx4 v[108:111], v18, s[4:7], s43 offen offset:2048 sc1
  buffer_load_dwordx4 v[112:115], v18, s[4:7], s43 offen offset:3072 sc1
  s_cmp_lg_u32 s28, 0
  s_cbranch_scc1 L_pwok_10
  s_lshl_b32 s42, s75, 5
  s_sub_u32 s42, s42, 1
  v_min_u32 v7, s42, v1
  v_add_u32 v8, 64, v1
  v_min_u32 v8, s42, v8
  v_lshlrev_b32 v7, 7, v7
  v_lshlrev_b32 v8, 7, v8
  s_lshl_b32 s42, s74, 9
  s_add_u32 s42, s42, 0x5c10000
  s_cmp_ge_u32 s73, 62
  s_cbranch_scc1 L_pwper_13
  v_mov_b32 v7, 0
  v_mov_b32 v8, 0
  s_mov_b32 s42, 0x5c17f00
L_pwper_13:
  s_add_u32 s42, s42, s59
  s_mov_b32 s83, 0
L_pw_9:
  buffer_load_dword v9, v7, s[4:7], s42 offen sc1
  buffer_load_dword v10, v8, s[4:7], s42 offen sc1
  s_waitcnt vmcnt(0)
  v_min_u32 v9, v9, v10
  v_cmp_ge_u32 vcc, s73, v9
  s_cbranch_vccz L_pwok_10
  s_add_u32 s83, s83, 1
  s_cmp_ge_u32 s83, 1048576
  s_cbranch_scc1 L_abort
  v_readfirstlane_b32 s43, v9
  s_nop 3
  s_add_u32 s43, s43, 1
  s_cmp_ge_u32 s73, 62
  s_cbranch_scc1 L_pwnear_12
  s_cmp_gt_u32 s73, s43
  s_cbranch_scc1 L_pwfar_11
L_pwnear_12:
  s_sleep 8
  s_branch L_pw_9
L_pwfar_11:
  s_sleep 60
  s_branch L_pw_9
L_pwok_10:
  s_barrier
  s_lshl_b32 s43, s48, 16
  s_lshl_b32 s42, s49, 11
  s_add_u32 s43, s43, s42
  s_add_u32 s43, s43, 0x5400000
  buffer_load_dwordx4 v[116:119], v4, s[4:7], s43 offen offset:0 sc1
  buffer_load_dwordx4 v[120:123], v4, s[4:7], s43 offen offset:512 sc1
  buffer_load_dwordx4 v[124:127], v4, s[4:7], s43 offen offset:1024 sc1
  buffer_load_dwordx4 v[128:131], v4, s[4:7], s43 offen offset:1536 sc1
  s_lshl_b32 s43, s48, 16
  s_lshl_b32 s42, s49, 11
  s_add_u32 s43, s43, s42
  s_add_u32 s43, s43, 0x5800000
  buffer_load_dwordx2 v[132:133], v5, s[4:7], s43 offen offset:0 sc1
  buffer_load_dwordx2 v[134:135], v5, s[4:7], s43 offen offset:256 sc1
  buffer_load_dwordx2 v[136:137], v5, s[4:7], s43 offen offset:512 sc1
  buffer_load_dwordx2 v[138:139], v5, s[4:7], s43 offen offset:768 sc1
  buffer_load_dwordx2 v[140:141], v5, s[4:7], s43 offen offset:1024 sc1
  buffer_load_dwordx2 v[142:143], v5, s[4:7], s43 offen offset:1280 sc1
  buffer_load_dwordx2 v[144:145], v5, s[4:7], s43 offen offset:1536 sc1
  buffer_load_dwordx2 v[146:147], v5, s[4:7], s43 offen offset:1792 sc1
  s_waitcnt vmcnt(0)
L_att_14:
  s_lshl_b32 s32, s48, 18
  s_lshl_b32 s42, s49, 12
  s_add_u32 s32, s32, s42
  s_add_u32 s32, s32, 0x4000000
  s_add_u32 s49, s49, 1
  s_sub_u32 s36, s36, 1
  s_waitcnt vmcnt(24)
  v_mfma_f32_16x16x32_bf16 v[148:151], v[52:55], v[20:23], 0
  v_mfma_f32_16x16x32_bf16 v[148:151], v[56:59], v[24:27], v[148:151]
  v_mfma_f32_16x16x32_bf16 v[148:151], v[60:63], v[28:31], v[148:151]
  v_mfma_f32_16x16x32_bf16 v[148:151], v[64:67], v[32:35], v[148:151]
  v_mfma_f32_16x16x32_bf16 v[152:155], v[52:55], v[36:39], 0
  v_mfma_f32_16x16x32_bf16 v[156:159], v[68:71], v[36:39], 0
  v_mfma_f32_16x16x32_bf16 v[152:155], v[56:59], v[40:43], v[152:155]
  v_mfma_f32_16x16x32_bf16 v[156:159], v[72:75], v[40:43], v[156:159]
  v_mfma_f32_16x16x32_bf16 v[152:155], v[60:63], v[44:47], v[152:155]
  v_mfma_f32_16x16x32_bf16 v[156:159], v[76:79], v[44:47], v[156:159]
  v_mfma_f32_16x16x32_bf16 v[152:155], v[64:67], v[48:51], v[152:155]
  v_mfma_f32_16x16x32_bf16 v[156:159], v[80:83], v[48:51], v[156:159]
  v_mfma_f32_16x16x32_bf16 v[160:163], v[116:119], v[20:23], 0
  v_mfma_f32_16x16x32_bf16 v[164:167], v[116:119], v[36:39], 0
  v_mfma_f32_16x16x32_bf16 v[160:163], v[120:123], v[24:27], v[160:163]
  v_mfma_f32_16x16x32_bf16 v[164:167], v[120:123], v[40:43], v[164:167]
  v_mfma_f32_16x16x32_bf16 v[160:163], v[124:127], v[28:31], v[160:163]
  v_mfma_f32_16x16x32_bf16 v[164:167], v[124:127], v[44:47], v[164:167]
  v_mfma_f32_16x16x32_bf16 v[160:163], v[128:131], v[32:35], v[160:163]
  v_mfma_f32_16x16x32_bf16 v[164:167], v[128:131], v[48:51], v[164:167]
  s_cmp_eq_u32 s36, 0
  s_cbranch_scc1 L_attnk_15
  s_nop 3
  s_lshl_b32 s44, s48, 18
  s_lshl_b32 s42, s49, 12
  s_add_u32 s44, s44, s42
  s_add_u32 s43, s44, 0x0
  buffer_load_dwordx4 v[52:55], v18, s[4:7], s43 offen offset:0 sc1
  buffer_load_dwordx4 v[56:59], v18, s[4:7], s43 offen offset:1024 sc1
  buffer_load_dwordx4 v[60:63], v18, s[4:7], s43 offen offset:2048 sc1
  buffer_load_dwordx4 v[64:67], v18, s[4:7], s43 offen offset:3072 sc1
  s_add_u32 s43, s44, 0x2000000
  buffer_load_dwordx4 v[20:23], v18, s[4:7], s43 offen offset:0 sc1
  buffer_load_dwordx4 v[24:27], v18, s[4:7], s43 offen offset:1024 sc1
  buffer_load_dwordx4 v[28:31], v18, s[4:7], s43 offen offset:2048 sc1
  buffer_load_dwordx4 v[32:35], v18, s[4:7], s43 offen offset:3072 sc1
  s_add_u32 s43, s44, 0x20000
  buffer_load_dwordx4 v[68:71], v18, s[4:7], s43 offen offset:0 sc1
  buffer_load_dwordx4 v[72:75], v18, s[4:7], s43 offen offset:1024 sc1
  buffer_load_dwordx4 v[76:79], v18, s[4:7], s43 offen offset:2048 sc1
  buffer_load_dwordx4 v[80:83], v18, s[4:7], s43 offen offset:3072 sc1
  s_add_u32 s43, s44, 0x2020000
  buffer_load_dwordx4 v[36:39], v18, s[4:7], s43 offen offset:0 sc1
  buffer_load_dwordx4 v[40:43], v18, s[4:7], s43 offen offset:1024 sc1
  buffer_load_dwordx4 v[44:47], v18, s[4:7], s43 offen offset:2048 sc1
  buffer_load_dwordx4 v[48:51], v18, s[4:7], s43 offen offset:3072 sc1
  s_lshl_b32 s43, s48, 16
  s_lshl_b32 s42, s49, 11
  s_add_u32 s43, s43, s42
  s_add_u32 s43, s43, 0x5400000
  buffer_load_dwordx4 v[116:119], v4, s[4:7], s43 offen offset:0 sc1
  buffer_load_dwordx4 v[120:123], v4, s[4:7], s43 offen offset:512 sc1
  buffer_load_dwordx4 v[124:127], v4, s[4:7], s43 offen offset:1024 sc1
  buffer_load_dwordx4 v[128:131], v4, s[4:7], s43 offen offset:1536 sc1
L_attnk_15:
  s_nop 7
  v_cvt_pk_bf16_f32 v180, v148, v149
  v_lshlrev_b32 v148, 16, v180
  v_and_b32 v149, 0xffff0000, v180
  v_cvt_pk_bf16_f32 v180, v150, v151
  v_lshlrev_b32 v150, 16, v180
  v_and_b32 v151, 0xffff0000, v180
  v_cvt_pk_bf16_f32 v180, v152, v153
  v_lshlrev_b32 v152, 16, v180
  v_and_b32 v153, 0xffff0000, v180
  v_cvt_pk_bf16_f32 v180, v154, v155
  v_lshlrev_b32 v154, 16, v180
  v_and_b32 v155, 0xffff0000, v180
  v_cvt_pk_bf16_f32 v180, v156, v157
  v_lshlrev_b32 v156, 16, v180
  v_and_b32 v157, 0xffff0000, v180
  v_cvt_pk_bf16_f32 v180, v158, v159
  v_lshlrev_b32 v158, 16, v180
  v_and_b32 v159, 0xffff0000, v180
  v_cvt_pk_bf16_f32 v180, v160, v161
  v_lshlrev_b32 v160, 16, v180
  v_and_b32 v161, 0xffff0000, v180
  v_cvt_pk_bf16_f32 v180, v162, v163
  v_lshlrev_b32 v162, 16, v180
  v_and_b32 v163, 0xffff0000, v180
  v_cvt_pk_bf16_f32 v180, v164, v165
  v_lshlrev_b32 v164, 16, v180
  v_and_b32 v165, 0xffff0000, v180
  v_cvt_pk_bf16_f32 v180, v166, v167
  v_lshlrev_b32 v166, 16, v180
  v_and_b32 v167, 0xffff0000, v180
  v_pk_mul_f32 v[148:149], v[148:149], s[46:47] op_sel_hi:[1,0]
  v_pk_mul_f32 v[150:151], v[150:151], s[46:47] op_sel_hi:[1,0]
  v_pk_mul_f32 v[152:153], v[152:153], s[46:47] op_sel_hi:[1,0]
  v_pk_mul_f32 v[154:155], v[154:155], s[46:47] op_sel_hi:[1,0]
  v_pk_mul_f32 v[156:157], v[156:157], s[46:47] op_sel_hi:[1,0]
  v_pk_mul_f32 v[158:159], v[158:159], s[46:47] op_sel_hi:[1,0]
  v_pk_mul_f32 v[160:161], v[160:161], s[46:47] op_sel_hi:[1,0]
  v_pk_mul_f32 v[162:163], v[162:163], s[46:47] op_sel_hi:[1,0]
  v_pk_mul_f32 v[164:165], v[164:165], s[46:47] op_sel_hi:[1,0]
  v_pk_mul_f32 v[166:167], v[166:167], s[46:47] op_sel_hi:[1,0]
  v_cvt_pk_bf16_f32 v180, v148, v149
  v_lshlrev_b32 v148, 16, v180
  v_and_b32 v149, 0xffff0000, v180
  v_cvt_pk_bf16_f32 v180, v150, v151
  v_lshlrev_b32 v150, 16, v180
  v_and_b32 v151, 0xffff0000, v180
  v_cvt_pk_bf16_f32 v180, v152, v153
  v_lshlrev_b32 v152, 16, v180
  v_and_b32 v153, 0xffff0000, v180
  v_cvt_pk_bf16_f32 v180, v154, v155
  v_lshlrev_b32 v154, 16, v180
  v_and_b32 v155, 0xffff0000, v180
  v_cvt_pk_bf16_f32 v180, v156, v157
  v_lshlrev_b32 v156, 16, v180
  v_and_b32 v157, 0xffff0000, v180
  v_cvt_pk_bf16_f32 v180, v158, v159
  v_lshlrev_b32 v158, 16, v180
  v_and_b32 v159, 0xffff0000, v180
  v_cvt_pk_bf16_f32 v180, v160, v161
  v_lshlrev_b32 v160, 16, v180
  v_and_b32 v161, 0xffff0000, v180
  v_cvt_pk_bf16_f32 v180, v162, v163
  v_lshlrev_b32 v162, 16, v180
  v_and_b32 v163, 0xffff0000, v180
  v_cvt_pk_bf16_f32 v180, v164, v165
  v_lshlrev_b32 v164, 16, v180
  v_and_b32 v165, 0xffff0000, v180
  v_cvt_pk_bf16_f32 v180, v166, v167
  v_lshlrev_b32 v166, 16, v180
  v_and_b32 v167, 0xffff0000, v180
  v_cndmask_b32 v148, v6, v148, s[60:61]
  v_cndmask_b32 v156, v6, v156, s[60:61]
  v_cndmask_b32 v160, v6, v160, s[84:85]
  v_cndmask_b32 v164, v6, v164, s[84:85]
  v_cndmask_b32 v149, v6, v149, s[62:63]
  v_cndmask_b32 v157, v6, v157, s[62:63]
  v_cndmask_b32 v161, v6, v161, s[84:85]
  v_cndmask_b32 v165, v6, v165, s[84:85]
  v_cndmask_b32 v150, v6, v150, s[64:65]
  v_cndmask_b32 v158, v6, v158, s[64:65]
  v_cndmask_b32 v162, v6, v162, s[84:85]
  v_cndmask_b32 v166, v6, v166, s[84:85]
  v_cndmask_b32 v151, v6, v151, s[66:67]
  v_cndmask_b32 v159, v6, v159, s[66:67]
  v_cndmask_b32 v163, v6, v163, s[84:85]
  v_cndmask_b32 v167, v6, v167, s[84:85]
  v_max3_f32 v180, v148, v149, v150
  v_max3_f32 v180, v180, v151, v160
  v_max3_f32 v180, v180, v161, v162
  v_max_f32 v180, v180, v163
  v_max3_f32 v182, v152, v153, v154
  v_max3_f32 v182, v182, v155, v156
  v_max3_f32 v182, v182, v157, v158
  v_max3_f32 v182, v182, v159, v164
  v_max3_f32 v182, v182, v165, v166
  v_max_f32 v182, v182, v167
  v_mov_b32 v181, v180
  v_mov_b32 v183, v182
  s_nop 1
  v_permlane16_swap_b32 v180, v181
  v_permlane16_swap_b32 v182, v183
  v_max_f32 v180, v180, v181
  v_max_f32 v182, v182, v183
  v_mov_b32 v181, v180
  v_mov_b32 v183, v182
  s_nop 1
  v_permlane32_swap_b32 v180, v181
  v_permlane32_swap_b32 v182, v183
  v_max_f32 v180, v180, v181
  v_max_f32 v182, v182, v183
  v_mul_f32 v180, s47, v180
  v_mul_f32 v182, s47, v182
  v_fma_f32 v148, v148, s47, -v180
  v_fma_f32 v149, v149, s47, -v180
  v_fma_f32 v150, v150, s47, -v180
  v_fma_f32 v151, v151, s47, -v180
  v_fma_f32 v160, v160, s47, -v180
  v_fma_f32 v161, v161, s47, -v180
  v_fma_f32 v162, v162, s47, -v180
  v_fma_f32 v163, v163, s47, -v180
  v_fma_f32 v152, v152, s47, -v182
  v_fma_f32 v153, v153, s47, -v182
  v_fma_f32 v154, v154, s47, -v182
  v_fma_f32 v155, v155, s47, -v182
  v_fma_f32 v156, v156, s47, -v182
  v_fma_f32 v157, v157, s47, -v182
  v_fma_f32 v158, v158, s47, -v182
  v_fma_f32 v159, v159, s47, -v182
  v_fma_f32 v164, v164, s47, -v182
  v_fma_f32 v165, v165, s47, -v182
  v_fma_f32 v166, v166, s47, -v182
  v_fma_f32 v167, v167, s47, -v182
  v_exp_f32 v148, v148
  v_exp_f32 v149, v149
  v_exp_f32 v150, v150
  v_exp_f32 v151, v151
  v_exp_f32 v160, v160
  v_exp_f32 v161, v161
  v_exp_f32 v162, v162
  v_exp_f32 v163, v163
  v_exp_f32 v152, v152
  v_exp_f32 v153, v153
  v_exp_f32 v154, v154
  v_exp_f32 v155, v155
  v_exp_f32 v156, v156
  v_exp_f32 v157, v157
  v_exp_f32 v158, v158
  v_exp_f32 v159, v159
  v_exp_f32 v164, v164
  v_exp_f32 v165, v165
  v_exp_f32 v166, v166
  v_exp_f32 v167, v167
  s_nop 0
  v_add_f32 v180, v148, v149
  v_add_f32 v180, v180, v150
  v_add_f32 v180, v180, v151
  v_add_f32 v180, v180, v160
  v_add_f32 v180, v180, v161
  v_add_f32 v180, v180, v162
  v_add_f32 v180, v180, v163
  v_add_f32 v182, v152, v153
  v_add_f32 v182, v182, v154
  v_add_f32 v182, v182, v155
  v_add_f32 v182, v182, v156
  v_add_f32 v182, v182, v157
  v_add_f32 v182, v182, v158
  v_add_f32 v182, v182, v159
  v_add_f32 v182, v182, v164
  v_add_f32 v182, v182, v165
  v_add_f32 v182, v182, v166
  v_add_f32 v182, v182, v167
  v_mov_b32 v181, v180
  v_mov_b32 v183, v182
  s_nop 1
  v_permlane16_swap_b32 v180, v181
  v_permlane16_swap_b32 v182, v183
  v_add_f32 v180, v180, v181
  v_add_f32 v182, v182, v183
  v_mov_b32 v181, v180
  v_mov_b32 v183, v182
  s_nop 1
  v_permlane32_swap_b32 v180, v181
  v_permlane32_swap_b32 v182, v183
  v_add_f32 v180, v180, v181
  v_add_f32 v182, v182, v183
  v_rcp_f32 v180, v180
  v_rcp_f32 v182, v182
  s_nop 0
  v_pk_mul_f32 v[148:149], v[148:149], v[180:181] op_sel_hi:[1,0]
  v_pk_mul_f32 v[150:151], v[150:151], v[180:181] op_sel_hi:[1,0]
  v_pk_mul_f32 v[160:161], v[160:161], v[180:181] op_sel_hi:[1,0]
  v_pk_mul_f32 v[162:163], v[162:163], v[180:181] op_sel_hi:[1,0]
  v_pk_mul_f32 v[152:153], v[152:153], v[182:183] op_sel_hi:[1,0]
  v_pk_mul_f32 v[154:155], v[154:155], v[182:183] op_sel_hi:[1,0]
  v_pk_mul_f32 v[156:157], v[156:157], v[182:183] op_sel_hi:[1,0]
  v_pk_mul_f32 v[158:159], v[158:159], v[182:183] op_sel_hi:[1,0]
  v_pk_mul_f32 v[164:165], v[164:165], v[182:183] op_sel_hi:[1,0]
  v_pk_mul_f32 v[166:167], v[166:167], v[182:183] op_sel_hi:[1,0]
  v_cvt_pk_bf16_f32 v168, v148, v149
  v_cvt_pk_bf16_f32 v169, v150, v151
  v_mov_b32 v170, 0
  v_mov_b32 v171, 0
  v_cvt_pk_bf16_f32 v172, v152, v153
  v_cvt_pk_bf16_f32 v173, v154, v155
  v_cvt_pk_bf16_f32 v174, v156, v157
  v_cvt_pk_bf16_f32 v175, v158, v159
  v_cvt_pk_bf16_f32 v176, v160, v161
  v_cvt_pk_bf16_f32 v177, v162, v163
  v_cvt_pk_bf16_f32 v178, v164, v165
  v_cvt_pk_bf16_f32 v179, v166, v167
  s_cmp_eq_u32 s36, 0
  s_cbranch_scc1 L_attl_17
  s_waitcnt vmcnt(28)
  s_branch L_attpv_18
L_attl_17:
  s_waitcnt vmcnt(8)
L_attpv_18:
  v_mfma_f32_16x16x16_bf16 a[0:3], v[132:133], v[176:177], 0
  v_mfma_f32_16x16x16_bf16 a[4:7], v[134:135], v[176:177], 0
  v_mfma_f32_16x16x16_bf16 a[8:11], v[136:137], v[176:177], 0
  v_mfma_f32_16x16x16_bf16 a[12:15], v[138:139], v[176:177], 0
  v_mfma_f32_16x16x16_bf16 a[16:19], v[140:141], v[176:177], 0
  v_mfma_f32_16x16x16_bf16 a[20:23], v[142:143], v[176:177], 0
  v_mfma_f32_16x16x16_bf16 a[24:27], v[144:145], v[176:177], 0
  v_mfma_f32_16x16x16_bf16 a[28:31], v[146:147], v[176:177], 0
  v_mfma_f32_16x16x32_bf16 a[0:3], v[84:87], v[168:171], a[0:3]
  v_mfma_f32_16x16x32_bf16 a[4:7], v[88:91], v[168:171], a[4:7]
  v_mfma_f32_16x16x32_bf16 a[8:11], v[92:95], v[168:171], a[8:11]
  v_mfma_f32_16x16x32_bf16 a[12:15], v[96:99], v[168:171], a[12:15]
  v_mfma_f32_16x16x32_bf16 a[16:19], v[100:103], v[168:171], a[16:19]
  v_mfma_f32_16x16x32_bf16 a[20:23], v[104:107], v[168:171], a[20:23]
  v_mfma_f32_16x16x32_bf16 a[24:27], v[108:111], v[168:171], a[24:27]
  v_mfma_f32_16x16x32_bf16 a[28:31], v[112:115], v[168:171], a[28:31]
  v_mfma_f32_16x16x16_bf16 a[32:35], v[132:133], v[178:179], 0
  v_mfma_f32_16x16x16_bf16 a[36:39], v[134:135], v[178:179], 0
  v_mfma_f32_16x16x16_bf16 a[40:43], v[136:137], v[178:179], 0
  v_mfma_f32_16x16x16_bf16 a[44:47], v[138:139], v[178:179], 0
  v_mfma_f32_16x16x16_bf16 a[48:51], v[140:141], v[178:179], 0
  v_mfma_f32_16x16x16_bf16 a[52:55], v[142:143], v[178:179], 0
  v_mfma_f32_16x16x16_bf16 a[56:59], v[144:145], v[178:179], 0
  v_mfma_f32_16x16x16_bf16 a[60:63], v[146:147], v[178:179], 0
  v_mfma_f32_16x16x32_bf16 a[32:35], v[84:87], v[172:175], a[32:35]
  v_mfma_f32_16x16x32_bf16 a[36:39], v[88:91], v[172:175], a[36:39]
  v_mfma_f32_16x16x32_bf16 a[40:43], v[92:95], v[172:175], a[40:43]
  v_mfma_f32_16x16x32_bf16 a[44:47], v[96:99], v[172:175], a[44:47]
  v_mfma_f32_16x16x32_bf16 a[48:51], v[100:103], v[172:175], a[48:51]
  v_mfma_f32_16x16x32_bf16 a[52:55], v[104:107], v[172:175], a[52:55]
  v_mfma_f32_16x16x32_bf16 a[56:59], v[108:111], v[172:175], a[56:59]
  v_mfma_f32_16x16x32_bf16 a[60:63], v[112:115], v[172:175], a[60:63]
  s_cmp_eq_u32 s36, 0
  s_cbranch_scc1 L_attnv_16
  s_nop 3
  s_lshl_b32 s43, s48, 16
  s_lshl_b32 s42, s49, 11
  s_add_u32 s43, s43, s42
  s_add_u32 s43, s43, 0x5800000
  buffer_load_dwordx2 v[132:133], v5, s[4:7], s43 offen offset:0 sc1
  buffer_load_dwordx2 v[134:135], v5, s[4:7], s43 offen offset:256 sc1
  buffer_load_dwordx2 v[136:137], v5, s[4:7], s43 offen offset:512 sc1
  buffer_load_dwordx2 v[138:139], v5, s[4:7], s43 offen offset:768 sc1
  buffer_load_dwordx2 v[140:141], v5, s[4:7], s43 offen offset:1024 sc1
  buffer_load_dwordx2 v[142:143], v5, s[4:7], s43 offen offset:1280 sc1
  buffer_load_dwordx2 v[144:145], v5, s[4:7], s43 offen offset:1536 sc1
  buffer_load_dwordx2 v[146:147], v5, s[4:7], s43 offen offset:1792 sc1
  s_lshl_b32 s43, s48, 18
  s_lshl_b32 s42, s49, 13
  s_add_u32 s43, s43, s42
  s_add_u32 s43, s43, 0x1000000
  buffer_load_dwordx4 v[84:87], v18, s[4:7], s43 offen offset:0 sc1
  buffer_load_dwordx4 v[88:91], v18, s[4:7], s43 offen offset:1024 sc1
  buffer_load_dwordx4 v[92:95], v18, s[4:7], s43 offen offset:2048 sc1
  buffer_load_dwordx4 v[96:99], v18, s[4:7], s43 offen offset:3072 sc1
  s_add_u32 s43, s43, 4096
  buffer_load_dwordx4 v[100:103], v18, s[4:7], s43 offen offset:0 sc1
  buffer_load_dwordx4 v[104:107], v18, s[4:7], s43 offen offset:1024 sc1
  buffer_load_dwordx4 v[108:111], v18, s[4:7], s43 offen offset:2048 sc1
  buffer_load_dwordx4 v[112:115], v18, s[4:7], s43 offen offset:3072 sc1
L_attnv_16:
  s_nop 1
  v_accvgpr_read_b32 v148, a0
  v_accvgpr_read_b32 v149, a1
  v_accvgpr_read_b32 v150, a2
  v_accvgpr_read_b32 v151, a3
  v_accvgpr_read_b32 v152, a4
  v_accvgpr_read_b32 v153, a5
  v_accvgpr_read_b32 v154, a6
  v_accvgpr_read_b32 v155, a7
  v_cvt_pk_bf16_f32 v156, v148, v149
  v_cvt_pk_bf16_f32 v157, v150, v151
  v_cvt_pk_bf16_f32 v158, v152, v153
  v_cvt_pk_bf16_f32 v159, v154, v155
  buffer_store_dwordx4 v[156:159], v18, s[4:7], s32 offen offset:0 sc1
  v_accvgpr_read_b32 v148, a8
  v_accvgpr_read_b32 v149, a9
  v_accvgpr_read_b32 v150, a10
  v_accvgpr_read_b32 v151, a11
  v_accvgpr_read_b32 v152, a12
  v_accvgpr_read_b32 v153, a13
  v_accvgpr_read_b32 v154, a14
  v_accvgpr_read_b32 v155, a15
  v_cvt_pk_bf16_f32 v160, v148, v149
  v_cvt_pk_bf16_f32 v161, v150, v151
  v_cvt_pk_bf16_f32 v162, v152, v153
  v_cvt_pk_bf16_f32 v163, v154, v155
  buffer_store_dwordx4 v[160:163], v18, s[4:7], s32 offen offset:1024 sc1
  v_accvgpr_read_b32 v148, a16
  v_accvgpr_read_b32 v149, a17
  v_accvgpr_read_b32 v150, a18
  v_accvgpr_read_b32 v151, a19
  v_accvgpr_read_b32 v152, a20
  v_accvgpr_read_b32 v153, a21
  v_accvgpr_read_b32 v154, a22
  v_accvgpr_read_b32 v155, a23
  v_cvt_pk_bf16_f32 v164, v148, v149
  v_cvt_pk_bf16_f32 v165, v150, v151
  v_cvt_pk_bf16_f32 v166, v152, v153
  v_cvt_pk_bf16_f32 v167, v154, v155
  buffer_store_dwordx4 v[164:167], v18, s[4:7], s32 offen offset:2048 sc1
  v_accvgpr_read_b32 v148, a24
  v_accvgpr_read_b32 v149, a25
  v_accvgpr_read_b32 v150, a26
  v_accvgpr_read_b32 v151, a27
  v_accvgpr_read_b32 v152, a28
  v_accvgpr_read_b32 v153, a29
  v_accvgpr_read_b32 v154, a30
  v_accvgpr_read_b32 v155, a31
  v_cvt_pk_bf16_f32 v156, v148, v149
  v_cvt_pk_bf16_f32 v157, v150, v151
  v_cvt_pk_bf16_f32 v158, v152, v153
  v_cvt_pk_bf16_f32 v159, v154, v155
  buffer_store_dwordx4 v[156:159], v18, s[4:7], s32 offen offset:3072 sc1
  s_add_u32 s32, s32, 131072
  v_accvgpr_read_b32 v148, a32
  v_accvgpr_read_b32 v149, a33
  v_accvgpr_read_b32 v150, a34
  v_accvgpr_read_b32 v151, a35
  v_accvgpr_read_b32 v152, a36
  v_accvgpr_read_b32 v153, a37
  v_accvgpr_read_b32 v154, a38
  v_accvgpr_read_b32 v155, a39
  v_cvt_pk_bf16_f32 v160, v148, v149
  v_cvt_pk_bf16_f32 v161, v150, v151
  v_cvt_pk_bf16_f32 v162, v152, v153
  v_cvt_pk_bf16_f32 v163, v154, v155
  buffer_store_dwordx4 v[160:163], v18, s[4:7], s32 offen offset:0 sc1
  v_accvgpr_read_b32 v148, a40
  v_accvgpr_read_b32 v149, a41
  v_accvgpr_read_b32 v150, a42
  v_accvgpr_read_b32 v151, a43
  v_accvgpr_read_b32 v152, a44
  v_accvgpr_read_b32 v153, a45
  v_accvgpr_read_b32 v154, a46
  v_accvgpr_read_b32 v155, a47
  v_cvt_pk_bf16_f32 v164, v148, v149
  v_cvt_pk_bf16_f32 v165, v150, v151
  v_cvt_pk_bf16_f32 v166, v152, v153
  v_cvt_pk_bf16_f32 v167, v154, v155
  buffer_store_dwordx4 v[164:167], v18, s[4:7], s32 offen offset:1024 sc1
  v_accvgpr_read_b32 v148, a48
  v_accvgpr_read_b32 v149, a49
  v_accvgpr_read_b32 v150, a50
  v_accvgpr_read_b32 v151, a51
  v_accvgpr_read_b32 v152, a52
  v_accvgpr_read_b32 v153, a53
  v_accvgpr_read_b32 v154, a54
  v_accvgpr_read_b32 v155, a55
  v_cvt_pk_bf16_f32 v156, v148, v149
  v_cvt_pk_bf16_f32 v157, v150, v151
  v_cvt_pk_bf16_f32 v158, v152, v153
  v_cvt_pk_bf16_f32 v159, v154, v155
  buffer_store_dwordx4 v[156:159], v18, s[4:7], s32 offen offset:2048 sc1
  v_accvgpr_read_b32 v148, a56
  v_accvgpr_read_b32 v149, a57
  v_accvgpr_read_b32 v150, a58
  v_accvgpr_read_b32 v151, a59
  v_accvgpr_read_b32 v152, a60
  v_accvgpr_read_b32 v153, a61
  v_accvgpr_read_b32 v154, a62
  v_accvgpr_read_b32 v155, a63
  v_cvt_pk_bf16_f32 v160, v148, v149
  v_cvt_pk_bf16_f32 v161, v150, v151
  v_cvt_pk_bf16_f32 v162, v152, v153
  v_cvt_pk_bf16_f32 v163, v154, v155
  buffer_store_dwordx4 v[160:163], v18, s[4:7], s32 offen offset:3072 sc1
  s_cmp_lg_u32 s36, 0
  s_cbranch_scc1 L_att_14
  s_branch L_done
L_t8:
  s_load_dwordx2 s[80:81], s[0:1], 80
  s_load_dwordx2 s[84:85], s[0:1], 0
  s_waitcnt lgkmcnt(0)
  s_mov_b32 s12, s80
  s_mov_b32 s13, s81
  s_mov_b32 s14, 0x800
  s_mov_b32 s15, 0x20000
  s_mov_b32 s8, s84
  s_mov_b32 s9, s85
  s_mov_b32 s10, 0x400000
  s_mov_b32 s11, 0x20000
  v_and_b32 v2, 15, v1
  v_lshrrev_b32 v3, 4, v1
  v_lshlrev_b32 v3, 4, v3
  v_lshl_add_u32 v4, v2, 11, v3
  v_lshlrev_b32 v18, 4, v1
  s_lshl_b32 s42, s48, 11
  s_lshl_b32 s43, s28, 8
  s_add_u32 s44, s42, s43
  buffer_load_dwordx4 v[20:23], v4, s[8:11], s44 offen offset:0
  buffer_load_dwordx4 v[24:27], v4, s[8:11], s44 offen offset:64
  buffer_load_dwordx4 v[28:31], v4, s[8:11], s44 offen offset:128
  buffer_load_dwordx4 v[32:35], v4, s[8:11], s44 offen offset:192
  buffer_load_dwordx4 v[36:39], v3, s[12:15], s43 offen offset:0
  buffer_load_dwordx4 v[40:43], v3, s[12:15], s43 offen offset:64
  buffer_load_dwordx4 v[44:47], v3, s[12:15], s43 offen offset:128
  buffer_load_dwordx4 v[48:51], v3, s[12:15], s43 offen offset:192
  s_lshl_b32 s43, s28, 12
  s_add_u32 s42, s42, s43
  s_add_u32 s42, s42, 0x7000000
  s_waitcnt vmcnt(7)
  buffer_store_dwordx4 v[20:23], v18, s[4:7], s42 offen offset:0 sc1
  s_waitcnt vmcnt(7)
  buffer_store_dwordx4 v[24:27], v18, s[4:7], s42 offen offset:1024 sc1
  s_waitcnt vmcnt(7)
  buffer_store_dwordx4 v[28:31], v18, s[4:7], s42 offen offset:2048 sc1
  s_waitcnt vmcnt(7)
  buffer_store_dwordx4 v[32:35], v18, s[4:7], s42 offen offset:3072 sc1
  s_waitcnt vmcnt(4)
  v_lshlrev_b32 v64, 16, v20
  v_and_b32 v65, 0xffff0000, v20
  v_lshlrev_b32 v96, 16, v36
  v_and_b32 v97, 0xffff0000, v36
  v_lshlrev_b32 v66, 16, v21
  v_and_b32 v67, 0xffff0000, v21
  v_lshlrev_b32 v98, 16, v37
  v_and_b32 v99, 0xffff0000, v37
  v_lshlrev_b32 v68, 16, v22
  v_and_b32 v69, 0xffff0000, v22
  v_lshlrev_b32 v100, 16, v38
  v_and_b32 v101, 0xffff0000, v38
  v_lshlrev_b32 v70, 16, v23
  v_and_b32 v71, 0xffff0000, v23
  v_lshlrev_b32 v102, 16, v39
  v_and_b32 v103, 0xffff0000, v39
  v_lshlrev_b32 v72, 16, v24
  v_and_b32 v73, 0xffff0000, v24
  v_lshlrev_b32 v104, 16, v40
  v_and_b32 v105, 0xffff0000, v40
  v_lshlrev_b32 v74, 16, v25
  v_and_b32 v75, 0xffff0000, v25
  v_lshlrev_b32 v106, 16, v41
  v_and_b32 v107, 0xffff0000, v41
  v_lshlrev_b32 v76, 16, v26
  v_and_b32 v77, 0xffff0000, v26
  v_lshlrev_b32 v108, 16, v42
  v_and_b32 v109, 0xffff0000, v42
  v_lshlrev_b32 v78, 16, v27
  v_and_b32 v79, 0xffff0000, v27
  v_lshlrev_b32 v110, 16, v43
  v_and_b32 v111, 0xffff0000, v43
  v_lshlrev_b32 v80, 16, v28
  v_and_b32 v81, 0xffff0000, v28
  v_lshlrev_b32 v112, 16, v44
  v_and_b32 v113, 0xffff0000, v44
  v_lshlrev_b32 v82, 16, v29
  v_and_b32 v83, 0xffff0000, v29
  v_lshlrev_b32 v114, 16, v45
  v_and_b32 v115, 0xffff0000, v45
  v_lshlrev_b32 v84, 16, v30
  v_and_b32 v85, 0xffff0000, v30
  v_lshlrev_b32 v116, 16, v46
  v_and_b32 v117, 0xffff0000, v46
  v_lshlrev_b32 v86, 16, v31
  v_and_b32 v87, 0xffff0000, v31
  v_lshlrev_b32 v118, 16, v47
  v_and_b32 v119, 0xffff0000, v47
  v_lshlrev_b32 v88, 16, v32
  v_and_b32 v89, 0xffff0000, v32
  v_lshlrev_b32 v120, 16, v48
  v_and_b32 v121, 0xffff0000, v48
  v_lshlrev_b32 v90, 16, v33
  v_and_b32 v91, 0xffff0000, v33
  v_lshlrev_b32 v122, 16, v49
  v_and_b32 v123, 0xffff0000, v49
  v_lshlrev_b32 v92, 16, v34
  v_and_b32 v93, 0xffff0000, v34
  v_lshlrev_b32 v124, 16, v50
  v_and_b32 v125, 0xffff0000, v50
  v_lshlrev_b32 v94, 16, v35
  v_and_b32 v95, 0xffff0000, v35
  v_lshlrev_b32 v126, 16, v51
  v_and_b32 v127, 0xffff0000, v51
  v_pk_mul_f32 v[64:65], v[64:65], v[96:97]
  v_pk_mul_f32 v[66:67], v[66:67], v[98:99]
  v_pk_mul_f32 v[68:69], v[68:69], v[100:101]
  v_pk_mul_f32 v[70:71], v[70:71], v[102:103]
  v_pk_mul_f32 v[72:73], v[72:73], v[104:105]
  v_pk_mul_f32 v[74:75], v[74:75], v[106:107]
  v_pk_mul_f32 v[76:77], v[76:77], v[108:109]
  v_pk_mul_f32 v[78:79], v[78:79], v[110:111]
  v_pk_mul_f32 v[80:81], v[80:81], v[112:113]
  v_pk_mul_f32 v[82:83], v[82:83], v[114:115]
  v_pk_mul_f32 v[84:85], v[84:85], v[116:117]
  v_pk_mul_f32 v[86:87], v[86:87], v[118:119]
  v_pk_mul_f32 v[88:89], v[88:89], v[120:121]
  v_pk_mul_f32 v[90:91], v[90:91], v[122:123]
  v_pk_mul_f32 v[92:93], v[92:93], v[124:125]
  v_pk_mul_f32 v[94:95], v[94:95], v[126:127]
  v_cvt_pk_bf16_f32 v36, v64, v65
  v_cvt_pk_bf16_f32 v37, v66, v67
  v_cvt_pk_bf16_f32 v38, v68, v69
  v_cvt_pk_bf16_f32 v39, v70, v71
  v_cvt_pk_bf16_f32 v40, v72, v73
  v_cvt_pk_bf16_f32 v41, v74, v75
  v_cvt_pk_bf16_f32 v42, v76, v77
  v_cvt_pk_bf16_f32 v43, v78, v79
  v_cvt_pk_bf16_f32 v44, v80, v81
  v_cvt_pk_bf16_f32 v45, v82, v83
  v_cvt_pk_bf16_f32 v46, v84, v85
  v_cvt_pk_bf16_f32 v47, v86, v87
  v_cvt_pk_bf16_f32 v48, v88, v89
  v_cvt_pk_bf16_f32 v49, v90, v91
  v_cvt_pk_bf16_f32 v50, v92, v93
  v_cvt_pk_bf16_f32 v51, v94, v95
  v_lshlrev_b32 v64, 16, v36
  v_and_b32 v65, 0xffff0000, v36
  v_lshlrev_b32 v66, 16, v37
  v_and_b32 v67, 0xffff0000, v37
  v_lshlrev_b32 v68, 16, v38
  v_and_b32 v69, 0xffff0000, v38
  v_lshlrev_b32 v70, 16, v39
  v_and_b32 v71, 0xffff0000, v39
  v_lshlrev_b32 v72, 16, v40
  v_and_b32 v73, 0xffff0000, v40
  v_lshlrev_b32 v74, 16, v41
  v_and_b32 v75, 0xffff0000, v41
  v_lshlrev_b32 v76, 16, v42
  v_and_b32 v77, 0xffff0000, v42
  v_lshlrev_b32 v78, 16, v43
  v_and_b32 v79, 0xffff0000, v43
  v_lshlrev_b32 v80, 16, v44
  v_and_b32 v81, 0xffff0000, v44
  v_lshlrev_b32 v82, 16, v45
  v_and_b32 v83, 0xffff0000, v45
  v_lshlrev_b32 v84, 16, v46
  v_and_b32 v85, 0xffff0000, v46
  v_lshlrev_b32 v86, 16, v47
  v_and_b32 v87, 0xffff0000, v47
  v_lshlrev_b32 v88, 16, v48
  v_and_b32 v89, 0xffff0000, v48
  v_lshlrev_b32 v90, 16, v49
  v_and_b32 v91, 0xffff0000, v49
  v_lshlrev_b32 v92, 16, v50
  v_and_b32 v93, 0xffff0000, v50
  v_lshlrev_b32 v94, 16, v51
  v_and_b32 v95, 0xffff0000, v51
  v_pk_add_f32 v[64:65], v[64:65], v[80:81]
  v_pk_add_f32 v[66:67], v[66:67], v[82:83]
  v_pk_add_f32 v[68:69], v[68:69], v[84:85]
  v_pk_add_f32 v[70:71], v[70:71], v[86:87]
  v_pk_add_f32 v[72:73], v[72:73], v[88:89]
  v_pk_add_f32 v[74:75], v[74:75], v[90:91]
  v_pk_add_f32 v[76:77], v[76:77], v[92:93]
  v_pk_add_f32 v[78:79], v[78:79], v[94:95]
  v_pk_add_f32 v[64:65], v[64:65], v[72:73]
  v_pk_add_f32 v[66:67], v[66:67], v[74:75]
  v_pk_add_f32 v[68:69], v[68:69], v[76:77]
  v_pk_add_f32 v[70:71], v[70:71], v[78:79]
  v_pk_add_f32 v[64:65], v[64:65], v[68:69]
  v_pk_add_f32 v[66:67], v[66:67], v[70:71]
  v_pk_add_f32 v[64:65], v[64:65], v[66:67]
  v_add_f32 v64, v64, v65
  v_mov_b32 v65, v64
  s_nop 1
  v_permlane16_swap_b32 v64, v65
  v_add_f32 v64, v64, v65
  v_mov_b32 v65, v64
  s_nop 1
  v_permlane32_swap_b32 v64, v65
  v_add_f32 v64, v64, v65
  s_lshl_b32 s43, s28, 6
  v_lshl_add_u32 v5, v2, 2, s43
  ds_write_b32 v5, v64
  s_waitcnt lgkmcnt(0)
  s_barrier
  s_cmp_lg_u32 s28, 0
  s_cbranch_scc1 L_gdone_19
  ds_read_b32 v64, v5 offset:0
  ds_read_b32 v65, v5 offset:64
  ds_read_b32 v66, v5 offset:128
  ds_read_b32 v67, v5 offset:192
  ds_read_b32 v68, v5 offset:256
  ds_read_b32 v69, v5 offset:320
  ds_read_b32 v70, v5 offset:384
  ds_read_b32 v71, v5 offset:448
  s_waitcnt lgkmcnt(0)
  v_pk_add_f32 v[64:65], v[64:65], v[68:69]
  v_pk_add_f32 v[66:67], v[66:67], v[70:71]
  v_pk_add_f32 v[64:65], v[64:65], v[66:67]
  v_add_f32 v64, v64, v65
  s_mov_b32 s46, 0xbfb8aa3b
  v_cvt_pk_bf16_f32 v64, v64, v64
  v_and_b32 v64, 0xffff0000, v64
  v_mul_f32 v64, s46, v64
  v_exp_f32 v64, v64
  s_nop 0
  v_add_f32 v64, 1.0, v64
  v_rcp_f32 v64, v64
  s_nop 0
  v_cvt_pk_bf16_f32 v64, v64, v64
  v_and_b32 v64, 0xffff0000, v64
  s_lshl_b32 s42, s48, 2
  s_add_u32 s42, s42, 0x5c00000
  buffer_store_dword v64, v5, s[4:7], s42 offen sc1
L_gdone_19:
  s_branch L_done
L_t9:
  s_mov_b32 s8, s4
  s_mov_b32 s9, s5
  s_mov_b32 s10, 0x10000000
  s_mov_b32 s11, 0x20000
  s_mov_b32 s33, 1024
  s_mov_b32 s45, 32768
  s_mov_b32 s36, 7
  s_mov_b32 s12, s50
  s_mov_b32 s13, s51
  s_mov_b32 s14, 0x800000
  s_mov_b32 s15, 0x20000
  s_lshl_b32 s32, s48, 11
  s_add_u32 s32, s32, 0x7000000
  s_lshl_b32 s34, s49, 1
  s_mov_b32 s39, 8192
  s_mov_b32 s35, 262144
  s_mov_b32 s38, 131072
  s_mul_i32 s37, s48, 8192
  s_lshl_b32 s42, s49, 5
  s_add_u32 s37, s37, s42
  s_add_u32 s37, s37, 0x0
  s_branch L_body_half_fn_kq
L_t10:
  s_mov_b32 s8, s4
  s_mov_b32 s9, s5
  s_mov_b32 s10, 0x10000000
  s_mov_b32 s11, 0x20000
  s_mov_b32 s33, 1024
  s_mov_b32 s45, 32768
  s_mov_b32 s36, 7
  s_mov_b32 s12, s54
  s_mov_b32 s13, s55
  s_mov_b32 s14, 0x800000
  s_mov_b32 s15, 0x20000
  s_lshl_b32 s32, s48, 11
  s_add_u32 s32, s32, 0x7000000
  s_lshl_b32 s34, s49, 1
  s_mov_b32 s39, 8192
  s_mov_b32 s35, 262144
  s_mov_b32 s38, 262144
  s_lshl_b32 s37, s48, 13
  s_lshl_b32 s42, s49, 6
  s_add_u32 s37, s37, s42
  s_add_u32 s37, s37, 0x1000000
  s_branch L_body_half_fn_v
L_t11:
  s_load_dwordx2 s[80:81], s[0:1], 40
  s_waitcnt lgkmcnt(0)
  s_mov_b32 s12, s80
  s_mov_b32 s13, s81
  s_mov_b32 s14, 0x800000
  s_mov_b32 s15, 0x20000
  s_mov_b32 s8, s4
  s_mov_b32 s9, s5
  s_mov_b32 s10, 0x10000000
  s_mov_b32 s11, 0x20000
  s_mov_b32 s45, 131072
  s_mul_i32 s32, s48, 8192
  s_add_u32 s32, s32, 0x4000000
  s_mov_b32 s33, 2048
  s_lshl_b32 s34, s49, 1
  s_mov_b32 s39, 2048
  s_mov_b32 s35, 131072
  s_mov_b32 s36, 15
  s_branch L_body_q128_fm_kq
L_t12:
  s_load_dwordx2 s[80:81], s[0:1], 40
  s_waitcnt lgkmcnt(0)
  s_mov_b32 s12, s80
  s_mov_b32 s13, s81
  s_mov_b32 s14, 0x800000
  s_mov_b32 s15, 0x20000
  s_mov_b32 s8, s4
  s_mov_b32 s9, s5
  s_mov_b32 s10, 0x10000000
  s_mov_b32 s11, 0x20000
  s_mov_b32 s45, 131072
  s_mul_i32 s32, s48, 8192
  s_add_u32 s32, s32, 0x4000000
  s_mov_b32 s33, 2048
  s_lshl_b32 s34, s49, 1
  s_mov_b32 s39, 2048
  s_mov_b32 s35, 131072
  s_mov_b32 s36, 7
  s_branch L_body_q64_fm_kq
L_t14:
  s_load_dwordx2 s[80:81], s[0:1], 40
  s_waitcnt lgkmcnt(0)
  s_mov_b32 s12, s80
  s_mov_b32 s13, s81
  s_mov_b32 s14, 0x800000
  s_mov_b32 s15, 0x20000
  s_mov_b32 s8, s4
  s_mov_b32 s9, s5
  s_mov_b32 s10, 0x10000000
  s_mov_b32 s11, 0x20000
  s_mov_b32 s45, 131072
  s_mul_i32 s32, s48, 8192
  s_add_u32 s32, s32, 0x4000000
  s_mov_b32 s33, 1024
  s_lshl_b32 s34, s49, 1
  s_mov_b32 s39, 2048
  s_mov_b32 s35, 65536
  s_mov_b32 s36, 31
  s_branch L_body_half_fm_kq
L_t16:
  s_load_dwordx2 s[84:85], s[0:1], 0
  s_waitcnt lgkmcnt(0)
  s_mov_b32 s8, s84
  s_mov_b32 s9, s85
  s_mov_b32 s10, 0x400000
  s_mov_b32 s11, 0x20000
  s_mov_b32 s33, 128
  s_mov_b32 s36, 3
  s_mov_b32 s12, s50
  s_mov_b32 s13, s51
  s_mov_b32 s14, 0x800000
  s_mov_b32 s15, 0x20000
  s_lshl_b32 s32, s48, 11
  s_lshl_b32 s34, s49, 1
  s_mov_b32 s39, 8192
  s_mov_b32 s35, 524288
  s_mov_b32 s38, 131072
  s_mul_i32 s37, s48, 8192
  s_lshl_b32 s42, s49, 5
  s_add_u32 s37, s37, s42
  s_add_u32 s37, s37, 0x0
  s_branch L_body_q128_rm_kq
L_t17:
  s_load_dwordx2 s[84:85], s[0:1], 0
  s_waitcnt lgkmcnt(0)
  s_mov_b32 s8, s84
  s_mov_b32 s9, s85
  s_mov_b32 s10, 0x400000
  s_mov_b32 s11, 0x20000
  s_mov_b32 s33, 128
  s_mov_b32 s36, 3
  s_mov_b32 s12, s54
  s_mov_b32 s13, s55
  s_mov_b32 s14, 0x800000
  s_mov_b32 s15, 0x20000
  s_lshl_b32 s32, s48, 11
  s_lshl_b32 s34, s49, 1
  s_mov_b32 s39, 8192
  s_mov_b32 s35, 524288
  s_mov_b32 s38, 262144
  s_lshl_b32 s37, s48, 13
  s_lshl_b32 s42, s49, 6
  s_add_u32 s37, s37, s42
  s_add_u32 s37, s37, 0x1000000
  s_branch L_body_q128_rm_v
L_body_big_fn_kq:
  s_lshr_b32 s42, s28, 2
  s_and_b32 s43, s28, 3
  s_mul_i32 s40, s28, 2048
  s_mul_i32 s41, s28, 2048
  s_add_u32 s41, s41, 65536
  v_lshlrev_b32 v18, 4, v1
  s_mul_i32 s44, s42, 8192
  v_lshrrev_b32 v22, 4, v1
  v_and_b32 v23, 15, v1
  v_add_u32 v12, s44, v18
  s_mul_i32 s44, s28, 2
  s_add_u32 s44, s44, 0
  s_mul_i32 s44, s44, s45
  v_add_u32 v4, s44, v18
  s_mul_i32 s44, s28, 2
  s_add_u32 s44, s44, 1
  s_mul_i32 s44, s44, s45
  s_sub_u32 s44, s44, 1024
  v_add_u32 v5, s44, v18
  v_lshrrev_b32 v23, 5, v1
  v_and_b32 v24, 31, v1
  s_mul_i32 s44, s28, 4
  s_add_u32 s44, s44, 0
  v_add_u32 v20, s44, v23
  v_and_b32 v21, 3, v20
  v_bfe_u32 v22, v20, 3, 1
  v_lshl_or_b32 v21, v22, 2, v21
  v_lshlrev_b32 v21, 1, v21
  v_xor_b32 v21, v21, v24
  v_mul_lo_u32 v20, v20, s39
  v_lshl_add_u32 v8, v21, 4, v20
  s_mul_i32 s44, s28, 4
  s_add_u32 s44, s44, 2
  v_add_u32 v20, s44, v23
  v_and_b32 v21, 3, v20
  v_bfe_u32 v22, v20, 3, 1
  v_lshl_or_b32 v21, v22, 2, v21
  v_lshlrev_b32 v21, 1, v21
  v_xor_b32 v21, v21, v24
  v_mul_lo_u32 v20, v20, s39
  v_lshl_add_u32 v9, v21, 4, v20
  v_subrev_u32 v9, 1024, v9
  v_bfe_u32 v20, v1, 2, 2
  v_lshrrev_b32 v21, 4, v1
  v_lshl_add_u32 v22, v21, 3, v20
  v_mul_u32_u24 v22, 512, v22
  v_and_b32 v23, 3, v1
  v_lshl_add_u32 v22, v23, 3, v22
  v_add_u32 v22, 65536, v22
  v_and_b32 v21, 1, v21
  v_lshl_or_b32 v20, v21, 2, v20
  s_mul_i32 s44, s43, 4
  s_add_u32 s44, s44, 0
  v_xor_b32 v21, s44, v20
  v_lshl_add_u32 v14, v21, 5, v22
  s_mul_i32 s44, s43, 4
  s_add_u32 s44, s44, 1
  v_xor_b32 v21, s44, v20
  v_lshl_add_u32 v15, v21, 5, v22
  s_mul_i32 s44, s43, 4
  s_add_u32 s44, s44, 2
  v_xor_b32 v21, s44, v20
  v_lshl_add_u32 v16, v21, 5, v22
  s_mul_i32 s44, s43, 4
  s_add_u32 s44, s44, 3
  v_xor_b32 v21, s44, v20
  v_lshl_add_u32 v17, v21, 5, v22
  s_mov_b32 s29, 0
  s_add_u32 m0, s40, 0
  s_nop 0
  buffer_load_dwordx4 v4, s[8:11], s32 offen offset:0 sc1 lds
  buffer_load_dwordx4 v5, s[8:11], s32 offen offset:1024 sc1 lds
  s_add_u32 s32, s32, s33
  s_add_u32 m0, s41, 0
  s_nop 0
  buffer_load_dwordx4 v8, s[12:15], s34 offen offset:0 lds
  buffer_load_dwordx4 v9, s[12:15], s34 offen offset:1024 lds
  s_add_u32 s34, s34, s35
  s_add_u32 m0, s40, 16384
  s_nop 0
  buffer_load_dwordx4 v4, s[8:11], s32 offen offset:0 sc1 lds
  buffer_load_dwordx4 v5, s[8:11], s32 offen offset:1024 sc1 lds
  s_add_u32 s32, s32, s33
  s_add_u32 m0, s41, 16384
  s_nop 0
  buffer_load_dwordx4 v8, s[12:15], s34 offen offset:0 lds
  buffer_load_dwordx4 v9, s[12:15], s34 offen offset:1024 lds
  s_add_u32 s34, s34, s35
  s_add_u32 m0, s40, 32768
  s_nop 0
  buffer_load_dwordx4 v4, s[8:11], s32 offen offset:0 sc1 lds
  buffer_load_dwordx4 v5, s[8:11], s32 offen offset:1024 sc1 lds
  s_add_u32 s32, s32, s33
  s_add_u32 m0, s41, 32768
  s_nop 0
  buffer_load_dwordx4 v8, s[12:15], s34 offen offset:0 lds
  buffer_load_dwordx4 v9, s[12:15], s34 offen offset:1024 lds
  s_add_u32 s34, s34, s35
  s_add_u32 m0, s40, 49152
  s_nop 0
  buffer_load_dwordx4 v4, s[8:11], s32 offen offset:0 sc1 lds
  buffer_load_dwordx4 v5, s[8:11], s32 offen offset:1024 sc1 lds
  s_add_u32 s32, s32, s33
  s_add_u32 m0, s41, 49152
  s_nop 0
  buffer_load_dwordx4 v8, s[12:15], s34 offen offset:0 lds
  buffer_load_dwordx4 v9, s[12:15], s34 offen offset:1024 lds
  s_add_u32 s34, s34, s35
  v_mov_b32 v64, 0
  v_mov_b32 v65, 0
  v_mov_b32 v66, 0
  v_mov_b32 v67, 0
  v_mov_b32 v68, 0
  v_mov_b32 v69, 0
  v_mov_b32 v70, 0
  v_mov_b32 v71, 0
  v_mov_b32 v72, 0
  v_mov_b32 v73, 0
  v_mov_b32 v74, 0
  v_mov_b32 v75, 0
  v_mov_b32 v76, 0
  v_mov_b32 v77, 0
  v_mov_b32 v78, 0
  v_mov_b32 v79, 0
  v_mov_b32 v80, 0
  v_mov_b32 v81, 0
  v_mov_b32 v82, 0
  v_mov_b32 v83, 0
  v_mov_b32 v84, 0
  v_mov_b32 v85, 0
  v_mov_b32 v86, 0
  v_mov_b32 v87, 0
  v_mov_b32 v88, 0
  v_mov_b32 v89, 0
  v_mov_b32 v90, 0
  v_mov_b32 v91, 0
  v_mov_b32 v92, 0
  v_mov_b32 v93, 0
  v_mov_b32 v94, 0
  v_mov_b32 v95, 0
  v_mov_b32 v96, 0
  v_mov_b32 v97, 0
  v_mov_b32 v98, 0
  v_mov_b32 v99, 0
  v_mov_b32 v100, 0
  v_mov_b32 v101, 0
  v_mov_b32 v102, 0
  v_mov_b32 v103, 0
  v_mov_b32 v104, 0
  v_mov_b32 v105, 0
  v_mov_b32 v106, 0
  v_mov_b32 v107, 0
  v_mov_b32 v108, 0
  v_mov_b32 v109, 0
  v_mov_b32 v110, 0
  v_mov_b32 v111, 0
  v_mov_b32 v112, 0
  v_mov_b32 v113, 0
  v_mov_b32 v114, 0
  v_mov_b32 v115, 0
  v_mov_b32 v116, 0
  v_mov_b32 v117, 0
  v_mov_b32 v118, 0
  v_mov_b32 v119, 0
  v_mov_b32 v120, 0
  v_mov_b32 v121, 0
  v_mov_b32 v122, 0
  v_mov_b32 v123, 0
  v_mov_b32 v124, 0
  v_mov_b32 v125, 0
  v_mov_b32 v126, 0
  v_mov_b32 v127, 0
  v_mov_b32 v128, 0
  v_mov_b32 v129, 0
  v_mov_b32 v130, 0
  v_mov_b32 v131, 0
  v_mov_b32 v132, 0
  v_mov_b32 v133, 0
  v_mov_b32 v134, 0
  v_mov_b32 v135, 0
  v_mov_b32 v136, 0
  v_mov_b32 v137, 0
  v_mov_b32 v138, 0
  v_mov_b32 v139, 0
  v_mov_b32 v140, 0
  v_mov_b32 v141, 0
  v_mov_b32 v142, 0
  v_mov_b32 v143, 0
  v_mov_b32 v144, 0
  v_mov_b32 v145, 0
  v_mov_b32 v146, 0
  v_mov_b32 v147, 0
  v_mov_b32 v148, 0
  v_mov_b32 v149, 0
  v_mov_b32 v150, 0
  v_mov_b32 v151, 0
  v_mov_b32 v152, 0
  v_mov_b32 v153, 0
  v_mov_b32 v154, 0
  v_mov_b32 v155, 0
  v_mov_b32 v156, 0
  v_mov_b32 v157, 0
  v_mov_b32 v158, 0
  v_mov_b32 v159, 0
  v_mov_b32 v160, 0
  v_mov_b32 v161, 0
  v_mov_b32 v162, 0
  v_mov_b32 v163, 0
  v_mov_b32 v164, 0
  v_mov_b32 v165, 0
  v_mov_b32 v166, 0
  v_mov_b32 v167, 0
  v_mov_b32 v168, 0
  v_mov_b32 v169, 0
  v_mov_b32 v170, 0
  v_mov_b32 v171, 0
  v_mov_b32 v172, 0
  v_mov_b32 v173, 0
  v_mov_b32 v174, 0
  v_mov_b32 v175, 0
  v_mov_b32 v176, 0
  v_mov_b32 v177, 0
  v_mov_b32 v178, 0
  v_mov_b32 v179, 0
  v_mov_b32 v180, 0
  v_mov_b32 v181, 0
  v_mov_b32 v182, 0
  v_mov_b32 v183, 0
  v_mov_b32 v184, 0
  v_mov_b32 v185, 0
  v_mov_b32 v186, 0
  v_mov_b32 v187, 0
  v_mov_b32 v188, 0
  v_mov_b32 v189, 0
  v_mov_b32 v190, 0
  v_mov_b32 v191, 0
  s_waitcnt vmcnt(12)
  s_barrier
  ds_read_b64_tr_b16 a[32:33], v14 offset:0
  ds_read_b64_tr_b16 a[34:35], v14 offset:2048
  ds_read_b64_tr_b16 a[36:37], v15 offset:0
  ds_read_b64_tr_b16 a[38:39], v15 offset:2048
  ds_read_b64_tr_b16 a[40:41], v16 offset:0
  ds_read_b64_tr_b16 a[42:43], v16 offset:2048
  ds_read_b64_tr_b16 a[44:45], v17 offset:0
  ds_read_b64_tr_b16 a[46:47], v17 offset:2048
  ds_read_b128 a[0:3], v12 offset:0
  ds_read_b128 a[4:7], v12 offset:1024
  ds_read_b128 a[8:11], v12 offset:2048
  ds_read_b128 a[12:15], v12 offset:3072
  ds_read_b128 a[16:19], v12 offset:4096
  ds_read_b128 a[20:23], v12 offset:5120
  ds_read_b128 a[24:27], v12 offset:6144
  ds_read_b128 a[28:31], v12 offset:7168
  s_waitcnt lgkmcnt(0)
L_loop_big_fn_kq:
  s_waitcnt lgkmcnt(4)
  v_mfma_f32_16x16x32_bf16 v[64:67], a[32:35], a[0:3], v[64:67]
  v_mfma_f32_16x16x32_bf16 v[68:71], a[36:39], a[0:3], v[68:71]
  v_mfma_f32_16x16x32_bf16 v[72:75], a[40:43], a[0:3], v[72:75]
  v_mfma_f32_16x16x32_bf16 v[76:79], a[44:47], a[0:3], v[76:79]
  s_waitcnt lgkmcnt(0)
  s_waitcnt vmcnt(8)
  s_barrier
  ds_read_b128 a[0:3], v12 offset:16384
  v_mfma_f32_16x16x32_bf16 v[80:83], a[32:35], a[4:7], v[80:83]
  s_add_u32 m0, s40, 0
  ds_read_b64_tr_b16 a[48:49], v14 offset:16384
  v_mfma_f32_16x16x32_bf16 v[84:87], a[36:39], a[4:7], v[84:87]
  buffer_load_dwordx4 v4, s[8:11], s32 offen offset:0 sc1 lds
  v_mfma_f32_16x16x32_bf16 v[88:91], a[40:43], a[4:7], v[88:91]
  buffer_load_dwordx4 v5, s[8:11], s32 offen offset:1024 sc1 lds
  s_add_u32 s32, s32, s33
  v_mfma_f32_16x16x32_bf16 v[92:95], a[44:47], a[4:7], v[92:95]
  ds_read_b128 a[4:7], v12 offset:17408
  v_mfma_f32_16x16x32_bf16 v[96:99], a[32:35], a[8:11], v[96:99]
  s_add_u32 m0, s41, 0
  ds_read_b64_tr_b16 a[50:51], v14 offset:18432
  v_mfma_f32_16x16x32_bf16 v[100:103], a[36:39], a[8:11], v[100:103]
  buffer_load_dwordx4 v8, s[12:15], s34 offen offset:0 lds
  v_mfma_f32_16x16x32_bf16 v[104:107], a[40:43], a[8:11], v[104:107]
  buffer_load_dwordx4 v9, s[12:15], s34 offen offset:1024 lds
  s_add_u32 s34, s34, s35
  v_mfma_f32_16x16x32_bf16 v[108:111], a[44:47], a[8:11], v[108:111]
  ds_read_b128 a[8:11], v12 offset:18432
  v_mfma_f32_16x16x32_bf16 v[112:115], a[32:35], a[12:15], v[112:115]
  ds_read_b64_tr_b16 a[52:53], v15 offset:16384
  v_mfma_f32_16x16x32_bf16 v[116:119], a[36:39], a[12:15], v[116:119]
  ds_read_b64_tr_b16 a[54:55], v15 offset:18432
  v_mfma_f32_16x16x32_bf16 v[120:123], a[40:43], a[12:15], v[120:123]
  ds_read_b64_tr_b16 a[56:57], v16 offset:16384
  v_mfma_f32_16x16x32_bf16 v[124:127], a[44:47], a[12:15], v[124:127]
  ds_read_b128 a[12:15], v12 offset:19456
  v_mfma_f32_16x16x32_bf16 v[128:131], a[32:35], a[16:19], v[128:131]
  ds_read_b64_tr_b16 a[58:59], v16 offset:18432
  v_mfma_f32_16x16x32_bf16 v[132:135], a[36:39], a[16:19], v[132:135]
  ds_read_b64_tr_b16 a[60:61], v17 offset:16384
  v_mfma_f32_16x16x32_bf16 v[136:139], a[40:43], a[16:19], v[136:139]
  ds_read_b64_tr_b16 a[62:63], v17 offset:18432
  v_mfma_f32_16x16x32_bf16 v[140:143], a[44:47], a[16:19], v[140:143]
  ds_read_b128 a[16:19], v12 offset:20480
  v_mfma_f32_16x16x32_bf16 v[144:147], a[32:35], a[20:23], v[144:147]
  v_mfma_f32_16x16x32_bf16 v[148:151], a[36:39], a[20:23], v[148:151]
  v_mfma_f32_16x16x32_bf16 v[152:155], a[40:43], a[20:23], v[152:155]
  v_mfma_f32_16x16x32_bf16 v[156:159], a[44:47], a[20:23], v[156:159]
  ds_read_b128 a[20:23], v12 offset:21504
  v_mfma_f32_16x16x32_bf16 v[160:163], a[32:35], a[24:27], v[160:163]
  v_mfma_f32_16x16x32_bf16 v[164:167], a[36:39], a[24:27], v[164:167]
  v_mfma_f32_16x16x32_bf16 v[168:171], a[40:43], a[24:27], v[168:171]
  v_mfma_f32_16x16x32_bf16 v[172:175], a[44:47], a[24:27], v[172:175]
  ds_read_b128 a[24:27], v12 offset:22528
  v_mfma_f32_16x16x32_bf16 v[176:179], a[32:35], a[28:31], v[176:179]
  v_mfma_f32_16x16x32_bf16 v[180:183], a[36:39], a[28:31], v[180:183]
  v_mfma_f32_16x16x32_bf16 v[184:187], a[40:43], a[28:31], v[184:187]
  v_mfma_f32_16x16x32_bf16 v[188:191], a[44:47], a[28:31], v[188:191]
  ds_read_b128 a[28:31], v12 offset:23552
  s_waitcnt lgkmcnt(4)
  v_mfma_f32_16x16x32_bf16 v[64:67], a[48:51], a[0:3], v[64:67]
  v_mfma_f32_16x16x32_bf16 v[68:71], a[52:55], a[0:3], v[68:71]
  v_mfma_f32_16x16x32_bf16 v[72:75], a[56:59], a[0:3], v[72:75]
  v_mfma_f32_16x16x32_bf16 v[76:79], a[60:63], a[0:3], v[76:79]
  s_waitcnt lgkmcnt(0)
  s_waitcnt vmcnt(8)
  s_barrier
  ds_read_b128 a[0:3], v12 offset:32768
  v_mfma_f32_16x16x32_bf16 v[80:83], a[48:51], a[4:7], v[80:83]
  s_add_u32 m0, s40, 16384
  ds_read_b64_tr_b16 a[32:33], v14 offset:32768
  v_mfma_f32_16x16x32_bf16 v[84:87], a[52:55], a[4:7], v[84:87]
  buffer_load_dwordx4 v4, s[8:11], s32 offen offset:0 sc1 lds
  v_mfma_f32_16x16x32_bf16 v[88:91], a[56:59], a[4:7], v[88:91]
  buffer_load_dwordx4 v5, s[8:11], s32 offen offset:1024 sc1 lds
  s_add_u32 s32, s32, s33
  v_mfma_f32_16x16x32_bf16 v[92:95], a[60:63], a[4:7], v[92:95]
  ds_read_b128 a[4:7], v12 offset:33792
  v_mfma_f32_16x16x32_bf16 v[96:99], a[48:51], a[8:11], v[96:99]
  s_add_u32 m0, s41, 16384
  ds_read_b64_tr_b16 a[34:35], v14 offset:34816
  v_mfma_f32_16x16x32_bf16 v[100:103], a[52:55], a[8:11], v[100:103]
  buffer_load_dwordx4 v8, s[12:15], s34 offen offset:0 lds
  v_mfma_f32_16x16x32_bf16 v[104:107], a[56:59], a[8:11], v[104:107]
  buffer_load_dwordx4 v9, s[12:15], s34 offen offset:1024 lds
  s_add_u32 s34, s34, s35
  v_mfma_f32_16x16x32_bf16 v[108:111], a[60:63], a[8:11], v[108:111]
  ds_read_b128 a[8:11], v12 offset:34816
  v_mfma_f32_16x16x32_bf16 v[112:115], a[48:51], a[12:15], v[112:115]
  ds_read_b64_tr_b16 a[36:37], v15 offset:32768
  v_mfma_f32_16x16x32_bf16 v[116:119], a[52:55], a[12:15], v[116:119]
  ds_read_b64_tr_b16 a[38:39], v15 offset:34816
  v_mfma_f32_16x16x32_bf16 v[120:123], a[56:59], a[12:15], v[120:123]
  ds_read_b64_tr_b16 a[40:41], v16 offset:32768
  v_mfma_f32_16x16x32_bf16 v[124:127], a[60:63], a[12:15], v[124:127]
  ds_read_b128 a[12:15], v12 offset:35840
  v_mfma_f32_16x16x32_bf16 v[128:131], a[48:51], a[16:19], v[128:131]
  ds_read_b64_tr_b16 a[42:43], v16 offset:34816
  v_mfma_f32_16x16x32_bf16 v[132:135], a[52:55], a[16:19], v[132:135]
  ds_read_b64_tr_b16 a[44:45], v17 offset:32768
  v_mfma_f32_16x16x32_bf16 v[136:139], a[56:59], a[16:19], v[136:139]
  ds_read_b64_tr_b16 a[46:47], v17 offset:34816
  v_mfma_f32_16x16x32_bf16 v[140:143], a[60:63], a[16:19], v[140:143]
  ds_read_b128 a[16:19], v12 offset:36864
  v_mfma_f32_16x16x32_bf16 v[144:147], a[48:51], a[20:23], v[144:147]
  v_mfma_f32_16x16x32_bf16 v[148:151], a[52:55], a[20:23], v[148:151]
  v_mfma_f32_16x16x32_bf16 v[152:155], a[56:59], a[20:23], v[152:155]
  v_mfma_f32_16x16x32_bf16 v[156:159], a[60:63], a[20:23], v[156:159]
  ds_read_b128 a[20:23], v12 offset:37888
  v_mfma_f32_16x16x32_bf16 v[160:163], a[48:51], a[24:27], v[160:163]
  v_mfma_f32_16x16x32_bf16 v[164:167], a[52:55], a[24:27], v[164:167]
  v_mfma_f32_16x16x32_bf16 v[168:171], a[56:59], a[24:27], v[168:171]
  v_mfma_f32_16x16x32_bf16 v[172:175], a[60:63], a[24:27], v[172:175]
  ds_read_b128 a[24:27], v12 offset:38912
  v_mfma_f32_16x16x32_bf16 v[176:179], a[48:51], a[28:31], v[176:179]
  v_mfma_f32_16x16x32_bf16 v[180:183], a[52:55], a[28:31], v[180:183]
  v_mfma_f32_16x16x32_bf16 v[184:187], a[56:59], a[28:31], v[184:187]
  v_mfma_f32_16x16x32_bf16 v[188:191], a[60:63], a[28:31], v[188:191]
  ds_read_b128 a[28:31], v12 offset:39936
  s_waitcnt lgkmcnt(4)
  v_mfma_f32_16x16x32_bf16 v[64:67], a[32:35], a[0:3], v[64:67]
  v_mfma_f32_16x16x32_bf16 v[68:71], a[36:39], a[0:3], v[68:71]
  v_mfma_f32_16x16x32_bf16 v[72:75], a[40:43], a[0:3], v[72:75]
  v_mfma_f32_16x16x32_bf16 v[76:79], a[44:47], a[0:3], v[76:79]
  s_waitcnt lgkmcnt(0)
  s_waitcnt vmcnt(8)
  s_barrier
  ds_read_b128 a[0:3], v12 offset:49152
  v_mfma_f32_16x16x32_bf16 v[80:83], a[32:35], a[4:7], v[80:83]
  s_add_u32 m0, s40, 32768
  ds_read_b64_tr_b16 a[48:49], v14 offset:49152
  v_mfma_f32_16x16x32_bf16 v[84:87], a[36:39], a[4:7], v[84:87]
  buffer_load_dwordx4 v4, s[8:11], s32 offen offset:0 sc1 lds
  v_mfma_f32_16x16x32_bf16 v[88:91], a[40:43], a[4:7], v[88:91]
  buffer_load_dwordx4 v5, s[8:11], s32 offen offset:1024 sc1 lds
  s_add_u32 s32, s32, s33
  v_mfma_f32_16x16x32_bf16 v[92:95], a[44:47], a[4:7], v[92:95]
  ds_read_b128 a[4:7], v12 offset:50176
  v_mfma_f32_16x16x32_bf16 v[96:99], a[32:35], a[8:11], v[96:99]
  s_add_u32 m0, s41, 32768
  ds_read_b64_tr_b16 a[50:51], v14 offset:51200
  v_mfma_f32_16x16x32_bf16 v[100:103], a[36:39], a[8:11], v[100:103]
  buffer_load_dwordx4 v8, s[12:15], s34 offen offset:0 lds
  v_mfma_f32_16x16x32_bf16 v[104:107], a[40:43], a[8:11], v[104:107]
  buffer_load_dwordx4 v9, s[12:15], s34 offen offset:1024 lds
  s_add_u32 s34, s34, s35
  v_mfma_f32_16x16x32_bf16 v[108:111], a[44:47], a[8:11], v[108:111]
  ds_read_b128 a[8:11], v12 offset:51200
  v_mfma_f32_16x16x32_bf16 v[112:115], a[32:35], a[12:15], v[112:115]
  ds_read_b64_tr_b16 a[52:53], v15 offset:49152
  v_mfma_f32_16x16x32_bf16 v[116:119], a[36:39], a[12:15], v[116:119]
  ds_read_b64_tr_b16 a[54:55], v15 offset:51200
  v_mfma_f32_16x16x32_bf16 v[120:123], a[40:43], a[12:15], v[120:123]
  ds_read_b64_tr_b16 a[56:57], v16 offset:49152
  v_mfma_f32_16x16x32_bf16 v[124:127], a[44:47], a[12:15], v[124:127]
  ds_read_b128 a[12:15], v12 offset:52224
  v_mfma_f32_16x16x32_bf16 v[128:131], a[32:35], a[16:19], v[128:131]
  ds_read_b64_tr_b16 a[58:59], v16 offset:51200
  v_mfma_f32_16x16x32_bf16 v[132:135], a[36:39], a[16:19], v[132:135]
  ds_read_b64_tr_b16 a[60:61], v17 offset:49152
  v_mfma_f32_16x16x32_bf16 v[136:139], a[40:43], a[16:19], v[136:139]
  ds_read_b64_tr_b16 a[62:63], v17 offset:51200
  v_mfma_f32_16x16x32_bf16 v[140:143], a[44:47], a[16:19], v[140:143]
  ds_read_b128 a[16:19], v12 offset:53248
  v_mfma_f32_16x16x32_bf16 v[144:147], a[32:35], a[20:23], v[144:147]
  v_mfma_f32_16x16x32_bf16 v[148:151], a[36:39], a[20:23], v[148:151]
  v_mfma_f32_16x16x32_bf16 v[152:155], a[40:43], a[20:23], v[152:155]
  v_mfma_f32_16x16x32_bf16 v[156:159], a[44:47], a[20:23], v[156:159]
  ds_read_b128 a[20:23], v12 offset:54272
  v_mfma_f32_16x16x32_bf16 v[160:163], a[32:35], a[24:27], v[160:163]
  v_mfma_f32_16x16x32_bf16 v[164:167], a[36:39], a[24:27], v[164:167]
  v_mfma_f32_16x16x32_bf16 v[168:171], a[40:43], a[24:27], v[168:171]
  v_mfma_f32_16x16x32_bf16 v[172:175], a[44:47], a[24:27], v[172:175]
  ds_read_b128 a[24:27], v12 offset:55296
  v_mfma_f32_16x16x32_bf16 v[176:179], a[32:35], a[28:31], v[176:179]
  v_mfma_f32_16x16x32_bf16 v[180:183], a[36:39], a[28:31], v[180:183]
  v_mfma_f32_16x16x32_bf16 v[184:187], a[40:43], a[28:31], v[184:187]
  v_mfma_f32_16x16x32_bf16 v[188:191], a[44:47], a[28:31], v[188:191]
  ds_read_b128 a[28:31], v12 offset:56320
  s_waitcnt lgkmcnt(4)
  v_mfma_f32_16x16x32_bf16 v[64:67], a[48:51], a[0:3], v[64:67]
  v_mfma_f32_16x16x32_bf16 v[68:71], a[52:55], a[0:3], v[68:71]
  v_mfma_f32_16x16x32_bf16 v[72:75], a[56:59], a[0:3], v[72:75]
  v_mfma_f32_16x16x32_bf16 v[76:79], a[60:63], a[0:3], v[76:79]
  s_waitcnt lgkmcnt(0)
  s_waitcnt vmcnt(8)
  s_barrier
  ds_read_b128 a[0:3], v12 offset:0
  v_mfma_f32_16x16x32_bf16 v[80:83], a[48:51], a[4:7], v[80:83]
  s_add_u32 m0, s40, 49152
  ds_read_b64_tr_b16 a[32:33], v14 offset:0
  v_mfma_f32_16x16x32_bf16 v[84:87], a[52:55], a[4:7], v[84:87]
  buffer_load_dwordx4 v4, s[8:11], s32 offen offset:0 sc1 lds
  v_mfma_f32_16x16x32_bf16 v[88:91], a[56:59], a[4:7], v[88:91]
  buffer_load_dwordx4 v5, s[8:11], s32 offen offset:1024 sc1 lds
  s_add_u32 s32, s32, s33
  v_mfma_f32_16x16x32_bf16 v[92:95], a[60:63], a[4:7], v[92:95]
  ds_read_b128 a[4:7], v12 offset:1024
  v_mfma_f32_16x16x32_bf16 v[96:99], a[48:51], a[8:11], v[96:99]
  s_add_u32 m0, s41, 49152
  ds_read_b64_tr_b16 a[34:35], v14 offset:2048
  v_mfma_f32_16x16x32_bf16 v[100:103], a[52:55], a[8:11], v[100:103]
  buffer_load_dwordx4 v8, s[12:15], s34 offen offset:0 lds
  v_mfma_f32_16x16x32_bf16 v[104:107], a[56:59], a[8:11], v[104:107]
  buffer_load_dwordx4 v9, s[12:15], s34 offen offset:1024 lds
  s_add_u32 s34, s34, s35
  v_mfma_f32_16x16x32_bf16 v[108:111], a[60:63], a[8:11], v[108:111]
  ds_read_b128 a[8:11], v12 offset:2048
  v_mfma_f32_16x16x32_bf16 v[112:115], a[48:51], a[12:15], v[112:115]
  ds_read_b64_tr_b16 a[36:37], v15 offset:0
  v_mfma_f32_16x16x32_bf16 v[116:119], a[52:55], a[12:15], v[116:119]
  ds_read_b64_tr_b16 a[38:39], v15 offset:2048
  v_mfma_f32_16x16x32_bf16 v[120:123], a[56:59], a[12:15], v[120:123]
  ds_read_b64_tr_b16 a[40:41], v16 offset:0
  v_mfma_f32_16x16x32_bf16 v[124:127], a[60:63], a[12:15], v[124:127]
  ds_read_b128 a[12:15], v12 offset:3072
  v_mfma_f32_16x16x32_bf16 v[128:131], a[48:51], a[16:19], v[128:131]
  ds_read_b64_tr_b16 a[42:43], v16 offset:2048
  v_mfma_f32_16x16x32_bf16 v[132:135], a[52:55], a[16:19], v[132:135]
  ds_read_b64_tr_b16 a[44:45], v17 offset:0
  v_mfma_f32_16x16x32_bf16 v[136:139], a[56:59], a[16:19], v[136:139]
  ds_read_b64_tr_b16 a[46:47], v17 offset:2048
  v_mfma_f32_16x16x32_bf16 v[140:143], a[60:63], a[16:19], v[140:143]
  ds_read_b128 a[16:19], v12 offset:4096
  v_mfma_f32_16x16x32_bf16 v[144:147], a[48:51], a[20:23], v[144:147]
  v_mfma_f32_16x16x32_bf16 v[148:151], a[52:55], a[20:23], v[148:151]
  v_mfma_f32_16x16x32_bf16 v[152:155], a[56:59], a[20:23], v[152:155]
  v_mfma_f32_16x16x32_bf16 v[156:159], a[60:63], a[20:23], v[156:159]
  ds_read_b128 a[20:23], v12 offset:5120
  v_mfma_f32_16x16x32_bf16 v[160:163], a[48:51], a[24:27], v[160:163]
  v_mfma_f32_16x16x32_bf16 v[164:167], a[52:55], a[24:27], v[164:167]
  v_mfma_f32_16x16x32_bf16 v[168:171], a[56:59], a[24:27], v[168:171]
  v_mfma_f32_16x16x32_bf16 v[172:175], a[60:63], a[24:27], v[172:175]
  ds_read_b128 a[24:27], v12 offset:6144
  v_mfma_f32_16x16x32_bf16 v[176:179], a[48:51], a[28:31], v[176:179]
  v_mfma_f32_16x16x32_bf16 v[180:183], a[52:55], a[28:31], v[180:183]
  v_mfma_f32_16x16x32_bf16 v[184:187], a[56:59], a[28:31], v[184:187]
  v_mfma_f32_16x16x32_bf16 v[188:191], a[60:63], a[28:31], v[188:191]
  ds_read_b128 a[28:31], v12 offset:7168
  s_sub_u32 s36, s36, 1
  s_cmp_lg_u32 s36, 0
  s_cbranch_scc1 L_loop_big_fn_kq
  s_cmp_lg_u32 s29, 0
  s_cbranch_scc1 L_episel_22
  s_cmp_eq_u32 s75, 0
  s_cbranch_scc1 L_tail_23
  s_cmp_lg_u32 s88, 1
  s_cbranch_scc1 L_swn_25
  s_mov_b32 s12, s50
  s_mov_b32 s13, s51
  s_mov_b32 s14, 0x800000
  s_mov_b32 s15, 0x20000
  s_lshl_b32 s32, s89, 11
  s_add_u32 s32, s32, 0x7000000
  s_lshl_b32 s34, s90, 1
  s_mov_b32 s39, 8192
  s_mov_b32 s35, 262144
  s_mov_b32 s31, 131072
  s_mul_i32 s30, s89, 8192
  s_lshl_b32 s42, s90, 5
  s_add_u32 s30, s30, s42
  s_add_u32 s30, s30, 0x0
  s_branch L_sw_24
L_swn_25:
  s_cmp_lg_u32 s88, 3
  s_cbranch_scc1 L_swn_26
  s_mov_b32 s12, s52
  s_mov_b32 s13, s53
  s_mov_b32 s14, 0x800000
  s_mov_b32 s15, 0x20000
  s_lshl_b32 s32, s89, 11
  s_add_u32 s32, s32, 0x7000000
  s_lshl_b32 s34, s90, 1
  s_mov_b32 s39, 8192
  s_mov_b32 s35, 262144
  s_mov_b32 s31, 131072
  s_mul_i32 s30, s89, 8192
  s_lshl_b32 s42, s90, 5
  s_add_u32 s30, s30, s42
  s_add_u32 s30, s30, 0x2000000
  s_branch L_sw_24
L_swn_26:
  s_cmp_lg_u32 s88, 2
  s_cbranch_scc1 L_swn_27
  s_mov_b32 s12, s54
  s_mov_b32 s13, s55
  s_mov_b32 s14, 0x800000
  s_mov_b32 s15, 0x20000
  s_lshl_b32 s32, s89, 11
  s_add_u32 s32, s32, 0x7000000
  s_lshl_b32 s34, s90, 1
  s_mov_b32 s39, 8192
  s_mov_b32 s35, 262144
  s_mov_b32 s31, 262144
  s_lshl_b32 s30, s89, 13
  s_lshl_b32 s42, s90, 6
  s_add_u32 s30, s30, s42
  s_add_u32 s30, s30, 0x1000000
  s_branch L_sw_24
L_swn_27:
  s_cmp_lg_u32 s88, 4
  s_cbranch_scc1 L_swn_28
  s_mov_b32 s12, s56
  s_mov_b32 s13, s57
  s_mov_b32 s14, 0x700000
  s_mov_b32 s15, 0x20000
  s_lshl_b32 s32, s89, 11
  s_add_u32 s32, s32, 0x7000000
  s_lshl_b32 s34, s90, 1
  s_mov_b32 s39, 7168
  s_mov_b32 s35, 229376
  s_mov_b32 s31, 114688
  s_mul_i32 s30, s89, 7168
  s_lshl_b32 s42, s90, 5
  s_add_u32 s30, s30, s42
  s_add_u32 s30, s30, 0x3000000
  s_branch L_sw_24
L_swn_28:
  s_branch L_abort
L_sw_24:
  v_lshrrev_b32 v23, 5, v1
  v_and_b32 v24, 31, v1
  s_mul_i32 s44, s28, 4
  s_add_u32 s44, s44, 0
  v_add_u32 v20, s44, v23
  v_and_b32 v21, 3, v20
  v_bfe_u32 v22, v20, 3, 1
  v_lshl_or_b32 v21, v22, 2, v21
  v_lshlrev_b32 v21, 1, v21
  v_xor_b32 v21, v21, v24
  v_mul_lo_u32 v20, v20, s39
  v_lshl_add_u32 v8, v21, 4, v20
  s_mul_i32 s44, s28, 4
  s_add_u32 s44, s44, 2
  v_add_u32 v20, s44, v23
  v_and_b32 v21, 3, v20
  v_bfe_u32 v22, v20, 3, 1
  v_lshl_or_b32 v21, v22, 2, v21
  v_lshlrev_b32 v21, 1, v21
  v_xor_b32 v21, v21, v24
  v_mul_lo_u32 v20, v20, s39
  v_lshl_add_u32 v9, v21, 4, v20
  v_subrev_u32 v9, 1024, v9
  s_mov_b32 s29, 1
  s_mov_b32 s36, 1
  s_branch L_loop_big_fn_kq
L_tail_23:
  s_waitcnt lgkmcnt(4)
  v_mfma_f32_16x16x32_bf16 v[64:67], a[32:35], a[0:3], v[64:67]
  v_mfma_f32_16x16x32_bf16 v[68:71], a[36:39], a[0:3], v[68:71]
  v_mfma_f32_16x16x32_bf16 v[72:75], a[40:43], a[0:3], v[72:75]
  v_mfma_f32_16x16x32_bf16 v[76:79], a[44:47], a[0:3], v[76:79]
  s_waitcnt lgkmcnt(0)
  s_waitcnt vmcnt(8)
  s_barrier
  ds_read_b128 a[0:3], v12 offset:16384
  v_mfma_f32_16x16x32_bf16 v[80:83], a[32:35], a[4:7], v[80:83]
  ds_read_b64_tr_b16 a[48:49], v14 offset:16384
  v_mfma_f32_16x16x32_bf16 v[84:87], a[36:39], a[4:7], v[84:87]
  ds_read_b64_tr_b16 a[50:51], v14 offset:18432
  v_mfma_f32_16x16x32_bf16 v[88:91], a[40:43], a[4:7], v[88:91]
  ds_read_b64_tr_b16 a[52:53], v15 offset:16384
  v_mfma_f32_16x16x32_bf16 v[92:95], a[44:47], a[4:7], v[92:95]
  ds_read_b128 a[4:7], v12 offset:17408
  v_mfma_f32_16x16x32_bf16 v[96:99], a[32:35], a[8:11], v[96:99]
  ds_read_b64_tr_b16 a[54:55], v15 offset:18432
  v_mfma_f32_16x16x32_bf16 v[100:103], a[36:39], a[8:11], v[100:103]
  ds_read_b64_tr_b16 a[56:57], v16 offset:16384
  v_mfma_f32_16x16x32_bf16 v[104:107], a[40:43], a[8:11], v[104:107]
  ds_read_b64_tr_b16 a[58:59], v16 offset:18432
  v_mfma_f32_16x16x32_bf16 v[108:111], a[44:47], a[8:11], v[108:111]
  ds_read_b128 a[8:11], v12 offset:18432
  v_mfma_f32_16x16x32_bf16 v[112:115], a[32:35], a[12:15], v[112:115]
  ds_read_b64_tr_b16 a[60:61], v17 offset:16384
  v_mfma_f32_16x16x32_bf16 v[116:119], a[36:39], a[12:15], v[116:119]
  ds_read_b64_tr_b16 a[62:63], v17 offset:18432
  v_mfma_f32_16x16x32_bf16 v[120:123], a[40:43], a[12:15], v[120:123]
  v_mfma_f32_16x16x32_bf16 v[124:127], a[44:47], a[12:15], v[124:127]
  ds_read_b128 a[12:15], v12 offset:19456
  v_mfma_f32_16x16x32_bf16 v[128:131], a[32:35], a[16:19], v[128:131]
  v_mfma_f32_16x16x32_bf16 v[132:135], a[36:39], a[16:19], v[132:135]
  v_mfma_f32_16x16x32_bf16 v[136:139], a[40:43], a[16:19], v[136:139]
  v_mfma_f32_16x16x32_bf16 v[140:143], a[44:47], a[16:19], v[140:143]
  ds_read_b128 a[16:19], v12 offset:20480
  v_mfma_f32_16x16x32_bf16 v[144:147], a[32:35], a[20:23], v[144:147]
  v_mfma_f32_16x16x32_bf16 v[148:151], a[36:39], a[20:23], v[148:151]
  v_mfma_f32_16x16x32_bf16 v[152:155], a[40:43], a[20:23], v[152:155]
  v_mfma_f32_16x16x32_bf16 v[156:159], a[44:47], a[20:23], v[156:159]
  ds_read_b128 a[20:23], v12 offset:21504
  v_mfma_f32_16x16x32_bf16 v[160:163], a[32:35], a[24:27], v[160:163]
  v_mfma_f32_16x16x32_bf16 v[164:167], a[36:39], a[24:27], v[164:167]
  v_mfma_f32_16x16x32_bf16 v[168:171], a[40:43], a[24:27], v[168:171]
  v_mfma_f32_16x16x32_bf16 v[172:175], a[44:47], a[24:27], v[172:175]
  ds_read_b128 a[24:27], v12 offset:22528
  v_mfma_f32_16x16x32_bf16 v[176:179], a[32:35], a[28:31], v[176:179]
  v_mfma_f32_16x16x32_bf16 v[180:183], a[36:39], a[28:31], v[180:183]
  v_mfma_f32_16x16x32_bf16 v[184:187], a[40:43], a[28:31], v[184:187]
  v_mfma_f32_16x16x32_bf16 v[188:191], a[44:47], a[28:31], v[188:191]
  ds_read_b128 a[28:31], v12 offset:23552
  s_waitcnt lgkmcnt(5)
  v_mfma_f32_16x16x32_bf16 v[64:67], a[48:51], a[0:3], v[64:67]
  v_mfma_f32_16x16x32_bf16 v[68:71], a[52:55], a[0:3], v[68:71]
  v_mfma_f32_16x16x32_bf16 v[72:75], a[56:59], a[0:3], v[72:75]
  v_mfma_f32_16x16x32_bf16 v[76:79], a[60:63], a[0:3], v[76:79]
  s_waitcnt lgkmcnt(0)
  s_waitcnt vmcnt(4)
  s_barrier
  ds_read_b128 a[0:3], v12 offset:32768
  v_mfma_f32_16x16x32_bf16 v[80:83], a[48:51], a[4:7], v[80:83]
  ds_read_b64_tr_b16 a[32:33], v14 offset:32768
  v_mfma_f32_16x16x32_bf16 v[84:87], a[52:55], a[4:7], v[84:87]
  ds_read_b64_tr_b16 a[34:35], v14 offset:34816
  v_mfma_f32_16x16x32_bf16 v[88:91], a[56:59], a[4:7], v[88:91]
  ds_read_b64_tr_b16 a[36:37], v15 offset:32768
  v_mfma_f32_16x16x32_bf16 v[92:95], a[60:63], a[4:7], v[92:95]
  ds_read_b128 a[4:7], v12 offset:33792
  v_mfma_f32_16x16x32_bf16 v[96:99], a[48:51], a[8:11], v[96:99]
  ds_read_b64_tr_b16 a[38:39], v15 offset:34816
  v_mfma_f32_16x16x32_bf16 v[100:103], a[52:55], a[8:11], v[100:103]
  ds_read_b64_tr_b16 a[40:41], v16 offset:32768
  v_mfma_f32_16x16x32_bf16 v[104:107], a[56:59], a[8:11], v[104:107]
  ds_read_b64_tr_b16 a[42:43], v16 offset:34816
  v_mfma_f32_16x16x32_bf16 v[108:111], a[60:63], a[8:11], v[108:111]
  ds_read_b128 a[8:11], v12 offset:34816
  v_mfma_f32_16x16x32_bf16 v[112:115], a[48:51], a[12:15], v[112:115]
  ds_read_b64_tr_b16 a[44:45], v17 offset:32768
  v_mfma_f32_16x16x32_bf16 v[116:119], a[52:55], a[12:15], v[116:119]
  ds_read_b64_tr_b16 a[46:47], v17 offset:34816
  v_mfma_f32_16x16x32_bf16 v[120:123], a[56:59], a[12:15], v[120:123]
  v_mfma_f32_16x16x32_bf16 v[124:127], a[60:63], a[12:15], v[124:127]
  ds_read_b128 a[12:15], v12 offset:35840
  v_mfma_f32_16x16x32_bf16 v[128:131], a[48:51], a[16:19], v[128:131]
  v_mfma_f32_16x16x32_bf16 v[132:135], a[52:55], a[16:19], v[132:135]
  v_mfma_f32_16x16x32_bf16 v[136:139], a[56:59], a[16:19], v[136:139]
  v_mfma_f32_16x16x32_bf16 v[140:143], a[60:63], a[16:19], v[140:143]
  ds_read_b128 a[16:19], v12 offset:36864
  v_mfma_f32_16x16x32_bf16 v[144:147], a[48:51], a[20:23], v[144:147]
  v_mfma_f32_16x16x32_bf16 v[148:151], a[52:55], a[20:23], v[148:151]
  v_mfma_f32_16x16x32_bf16 v[152:155], a[56:59], a[20:23], v[152:155]
  v_mfma_f32_16x16x32_bf16 v[156:159], a[60:63], a[20:23], v[156:159]
  ds_read_b128 a[20:23], v12 offset:37888
  v_mfma_f32_16x16x32_bf16 v[160:163], a[48:51], a[24:27], v[160:163]
  v_mfma_f32_16x16x32_bf16 v[164:167], a[52:55], a[24:27], v[164:167]
  v_mfma_f32_16x16x32_bf16 v[168:171], a[56:59], a[24:27], v[168:171]
  v_mfma_f32_16x16x32_bf16 v[172:175], a[60:63], a[24:27], v[172:175]
  ds_read_b128 a[24:27], v12 offset:38912
  v_mfma_f32_16x16x32_bf16 v[176:179], a[48:51], a[28:31], v[176:179]
  v_mfma_f32_16x16x32_bf16 v[180:183], a[52:55], a[28:31], v[180:183]
  v_mfma_f32_16x16x32_bf16 v[184:187], a[56:59], a[28:31], v[184:187]
  v_mfma_f32_16x16x32_bf16 v[188:191], a[60:63], a[28:31], v[188:191]
  ds_read_b128 a[28:31], v12 offset:39936
  s_waitcnt lgkmcnt(5)
  v_mfma_f32_16x16x32_bf16 v[64:67], a[32:35], a[0:3], v[64:67]
  v_mfma_f32_16x16x32_bf16 v[68:71], a[36:39], a[0:3], v[68:71]
  v_mfma_f32_16x16x32_bf16 v[72:75], a[40:43], a[0:3], v[72:75]
  v_mfma_f32_16x16x32_bf16 v[76:79], a[44:47], a[0:3], v[76:79]
  s_waitcnt lgkmcnt(0)
  s_waitcnt vmcnt(0)
  s_barrier
  ds_read_b128 a[0:3], v12 offset:49152
  v_mfma_f32_16x16x32_bf16 v[80:83], a[32:35], a[4:7], v[80:83]
  ds_read_b64_tr_b16 a[48:49], v14 offset:49152
  v_mfma_f32_16x16x32_bf16 v[84:87], a[36:39], a[4:7], v[84:87]
  ds_read_b64_tr_b16 a[50:51], v14 offset:51200
  v_mfma_f32_16x16x32_bf16 v[88:91], a[40:43], a[4:7], v[88:91]
  ds_read_b64_tr_b16 a[52:53], v15 offset:49152
  v_mfma_f32_16x16x32_bf16 v[92:95], a[44:47], a[4:7], v[92:95]
  ds_read_b128 a[4:7], v12 offset:50176
  v_mfma_f32_16x16x32_bf16 v[96:99], a[32:35], a[8:11], v[96:99]
  ds_read_b64_tr_b16 a[54:55], v15 offset:51200
  v_mfma_f32_16x16x32_bf16 v[100:103], a[36:39], a[8:11], v[100:103]
  ds_read_b64_tr_b16 a[56:57], v16 offset:49152
  v_mfma_f32_16x16x32_bf16 v[104:107], a[40:43], a[8:11], v[104:107]
  ds_read_b64_tr_b16 a[58:59], v16 offset:51200
  v_mfma_f32_16x16x32_bf16 v[108:111], a[44:47], a[8:11], v[108:111]
  ds_read_b128 a[8:11], v12 offset:51200
  v_mfma_f32_16x16x32_bf16 v[112:115], a[32:35], a[12:15], v[112:115]
  ds_read_b64_tr_b16 a[60:61], v17 offset:49152
  v_mfma_f32_16x16x32_bf16 v[116:119], a[36:39], a[12:15], v[116:119]
  ds_read_b64_tr_b16 a[62:63], v17 offset:51200
  v_mfma_f32_16x16x32_bf16 v[120:123], a[40:43], a[12:15], v[120:123]
  v_mfma_f32_16x16x32_bf16 v[124:127], a[44:47], a[12:15], v[124:127]
  ds_read_b128 a[12:15], v12 offset:52224
  v_mfma_f32_16x16x32_bf16 v[128:131], a[32:35], a[16:19], v[128:131]
  v_mfma_f32_16x16x32_bf16 v[132:135], a[36:39], a[16:19], v[132:135]
  v_mfma_f32_16x16x32_bf16 v[136:139], a[40:43], a[16:19], v[136:139]
  v_mfma_f32_16x16x32_bf16 v[140:143], a[44:47], a[16:19], v[140:143]
  ds_read_b128 a[16:19], v12 offset:53248
  v_mfma_f32_16x16x32_bf16 v[144:147], a[32:35], a[20:23], v[144:147]
  v_mfma_f32_16x16x32_bf16 v[148:151], a[36:39], a[20:23], v[148:151]
  v_mfma_f32_16x16x32_bf16 v[152:155], a[40:43], a[20:23], v[152:155]
  v_mfma_f32_16x16x32_bf16 v[156:159], a[44:47], a[20:23], v[156:159]
  ds_read_b128 a[20:23], v12 offset:54272
  v_mfma_f32_16x16x32_bf16 v[160:163], a[32:35], a[24:27], v[160:163]
  v_mfma_f32_16x16x32_bf16 v[164:167], a[36:39], a[24:27], v[164:167]
  v_mfma_f32_16x16x32_bf16 v[168:171], a[40:43], a[24:27], v[168:171]
  v_mfma_f32_16x16x32_bf16 v[172:175], a[44:47], a[24:27], v[172:175]
  ds_read_b128 a[24:27], v12 offset:55296
  v_mfma_f32_16x16x32_bf16 v[176:179], a[32:35], a[28:31], v[176:179]
  v_mfma_f32_16x16x32_bf16 v[180:183], a[36:39], a[28:31], v[180:183]
  v_mfma_f32_16x16x32_bf16 v[184:187], a[40:43], a[28:31], v[184:187]
  v_mfma_f32_16x16x32_bf16 v[188:191], a[44:47], a[28:31], v[188:191]
  ds_read_b128 a[28:31], v12 offset:56320
  s_waitcnt lgkmcnt(5)
  v_mfma_f32_16x16x32_bf16 v[64:67], a[48:51], a[0:3], v[64:67]
  v_mfma_f32_16x16x32_bf16 v[68:71], a[52:55], a[0:3], v[68:71]
  v_mfma_f32_16x16x32_bf16 v[72:75], a[56:59], a[0:3], v[72:75]
  v_mfma_f32_16x16x32_bf16 v[76:79], a[60:63], a[0:3], v[76:79]
  v_mfma_f32_16x16x32_bf16 v[80:83], a[48:51], a[4:7], v[80:83]
  v_mfma_f32_16x16x32_bf16 v[84:87], a[52:55], a[4:7], v[84:87]
  v_mfma_f32_16x16x32_bf16 v[88:91], a[56:59], a[4:7], v[88:91]
  v_mfma_f32_16x16x32_bf16 v[92:95], a[60:63], a[4:7], v[92:95]
  v_mfma_f32_16x16x32_bf16 v[96:99], a[48:51], a[8:11], v[96:99]
  v_mfma_f32_16x16x32_bf16 v[100:103], a[52:55], a[8:11], v[100:103]
  v_mfma_f32_16x16x32_bf16 v[104:107], a[56:59], a[8:11], v[104:107]
  v_mfma_f32_16x16x32_bf16 v[108:111], a[60:63], a[8:11], v[108:111]
  s_waitcnt lgkmcnt(4)
  v_mfma_f32_16x16x32_bf16 v[112:115], a[48:51], a[12:15], v[112:115]
  v_mfma_f32_16x16x32_bf16 v[116:119], a[52:55], a[12:15], v[116:119]
  v_mfma_f32_16x16x32_bf16 v[120:123], a[56:59], a[12:15], v[120:123]
  v_mfma_f32_16x16x32_bf16 v[124:127], a[60:63], a[12:15], v[124:127]
  s_waitcnt lgkmcnt(3)
  v_mfma_f32_16x16x32_bf16 v[128:131], a[48:51], a[16:19], v[128:131]
  v_mfma_f32_16x16x32_bf16 v[132:135], a[52:55], a[16:19], v[132:135]
  v_mfma_f32_16x16x32_bf16 v[136:139], a[56:59], a[16:19], v[136:139]
  v_mfma_f32_16x16x32_bf16 v[140:143], a[60:63], a[16:19], v[140:143]
  s_waitcnt lgkmcnt(2)
  v_mfma_f32_16x16x32_bf16 v[144:147], a[48:51], a[20:23], v[144:147]
  v_mfma_f32_16x16x32_bf16 v[148:151], a[52:55], a[20:23], v[148:151]
  v_mfma_f32_16x16x32_bf16 v[152:155], a[56:59], a[20:23], v[152:155]
  v_mfma_f32_16x16x32_bf16 v[156:159], a[60:63], a[20:23], v[156:159]
  s_waitcnt lgkmcnt(1)
  v_mfma_f32_16x16x32_bf16 v[160:163], a[48:51], a[24:27], v[160:163]
  v_mfma_f32_16x16x32_bf16 v[164:167], a[52:55], a[24:27], v[164:167]
  v_mfma_f32_16x16x32_bf16 v[168:171], a[56:59], a[24:27], v[168:171]
  v_mfma_f32_16x16x32_bf16 v[172:175], a[60:63], a[24:27], v[172:175]
  s_waitcnt lgkmcnt(0)
  v_mfma_f32_16x16x32_bf16 v[176:179], a[48:51], a[28:31], v[176:179]
  v_mfma_f32_16x16x32_bf16 v[180:183], a[52:55], a[28:31], v[180:183]
  v_mfma_f32_16x16x32_bf16 v[184:187], a[56:59], a[28:31], v[184:187]
  v_mfma_f32_16x16x32_bf16 v[188:191], a[60:63], a[28:31], v[188:191]
L_episel_22:
  s_nop 7
  s_cmp_eq_u32 s72, 4
  s_cbranch_scc1 L_epi_silu_21
L_epi_plain_20:
  s_lshr_b32 s42, s28, 2
  s_and_b32 s43, s28, 3
  s_mul_i32 s45, s43, 2048
  s_add_u32 s45, s45, s37
  s_mul_i32 s44, s42, 8
  s_mul_i32 s44, s44, s38
  s_add_u32 s44, s44, s45
  v_cvt_pk_bf16_f32 v44, v64, v65
  v_cvt_pk_bf16_f32 v45, v66, v67
  v_cvt_pk_bf16_f32 v46, v68, v69
  v_cvt_pk_bf16_f32 v47, v70, v71
  buffer_store_dwordx4 v[44:47], v18, s[4:7], s44 offen offset:0 sc1
  v_cvt_pk_bf16_f32 v48, v72, v73
  v_cvt_pk_bf16_f32 v49, v74, v75
  v_cvt_pk_bf16_f32 v50, v76, v77
  v_cvt_pk_bf16_f32 v51, v78, v79
  buffer_store_dwordx4 v[48:51], v18, s[4:7], s44 offen offset:1024 sc1
  s_add_u32 s44, s44, s38
  v_cvt_pk_bf16_f32 v52, v80, v81
  v_cvt_pk_bf16_f32 v53, v82, v83
  v_cvt_pk_bf16_f32 v54, v84, v85
  v_cvt_pk_bf16_f32 v55, v86, v87
  buffer_store_dwordx4 v[52:55], v18, s[4:7], s44 offen offset:0 sc1
  v_cvt_pk_bf16_f32 v56, v88, v89
  v_cvt_pk_bf16_f32 v57, v90, v91
  v_cvt_pk_bf16_f32 v58, v92, v93
  v_cvt_pk_bf16_f32 v59, v94, v95
  buffer_store_dwordx4 v[56:59], v18, s[4:7], s44 offen offset:1024 sc1
  s_add_u32 s44, s44, s38
  v_cvt_pk_bf16_f32 v44, v96, v97
  v_cvt_pk_bf16_f32 v45, v98, v99
  v_cvt_pk_bf16_f32 v46, v100, v101
  v_cvt_pk_bf16_f32 v47, v102, v103
  buffer_store_dwordx4 v[44:47], v18, s[4:7], s44 offen offset:0 sc1
  v_cvt_pk_bf16_f32 v48, v104, v105
  v_cvt_pk_bf16_f32 v49, v106, v107
  v_cvt_pk_bf16_f32 v50, v108, v109
  v_cvt_pk_bf16_f32 v51, v110, v111
  buffer_store_dwordx4 v[48:51], v18, s[4:7], s44 offen offset:1024 sc1
  s_add_u32 s44, s44, s38
  v_cvt_pk_bf16_f32 v52, v112, v113
  v_cvt_pk_bf16_f32 v53, v114, v115
  v_cvt_pk_bf16_f32 v54, v116, v117
  v_cvt_pk_bf16_f32 v55, v118, v119
  buffer_store_dwordx4 v[52:55], v18, s[4:7], s44 offen offset:0 sc1
  v_cvt_pk_bf16_f32 v56, v120, v121
  v_cvt_pk_bf16_f32 v57, v122, v123
  v_cvt_pk_bf16_f32 v58, v124, v125
  v_cvt_pk_bf16_f32 v59, v126, v127
  buffer_store_dwordx4 v[56:59], v18, s[4:7], s44 offen offset:1024 sc1
  s_add_u32 s44, s44, s38
  v_cvt_pk_bf16_f32 v44, v128, v129
  v_cvt_pk_bf16_f32 v45, v130, v131
  v_cvt_pk_bf16_f32 v46, v132, v133
  v_cvt_pk_bf16_f32 v47, v134, v135
  buffer_store_dwordx4 v[44:47], v18, s[4:7], s44 offen offset:0 sc1
  v_cvt_pk_bf16_f32 v48, v136, v137
  v_cvt_pk_bf16_f32 v49, v138, v139
  v_cvt_pk_bf16_f32 v50, v140, v141
  v_cvt_pk_bf16_f32 v51, v142, v143
  buffer_store_dwordx4 v[48:51], v18, s[4:7], s44 offen offset:1024 sc1
  s_add_u32 s44, s44, s38
  v_cvt_pk_bf16_f32 v52, v144, v145
  v_cvt_pk_bf16_f32 v53, v146, v147
  v_cvt_pk_bf16_f32 v54, v148, v149
  v_cvt_pk_bf16_f32 v55, v150, v151
  buffer_store_dwordx4 v[52:55], v18, s[4:7], s44 offen offset:0 sc1
  v_cvt_pk_bf16_f32 v56, v152, v153
  v_cvt_pk_bf16_f32 v57, v154, v155
  v_cvt_pk_bf16_f32 v58, v156, v157
  v_cvt_pk_bf16_f32 v59, v158, v159
  buffer_store_dwordx4 v[56:59], v18, s[4:7], s44 offen offset:1024 sc1
  s_add_u32 s44, s44, s38
  v_cvt_pk_bf16_f32 v44, v160, v161
  v_cvt_pk_bf16_f32 v45, v162, v163
  v_cvt_pk_bf16_f32 v46, v164, v165
  v_cvt_pk_bf16_f32 v47, v166, v167
  buffer_store_dwordx4 v[44:47], v18, s[4:7], s44 offen offset:0 sc1
  v_cvt_pk_bf16_f32 v48, v168, v169
  v_cvt_pk_bf16_f32 v49, v170, v171
  v_cvt_pk_bf16_f32 v50, v172, v173
  v_cvt_pk_bf16_f32 v51, v174, v175
  buffer_store_dwordx4 v[48:51], v18, s[4:7], s44 offen offset:1024 sc1
  s_add_u32 s44, s44, s38
  v_cvt_pk_bf16_f32 v52, v176, v177
  v_cvt_pk_bf16_f32 v53, v178, v179
  v_cvt_pk_bf16_f32 v54, v180, v181
  v_cvt_pk_bf16_f32 v55, v182, v183
  buffer_store_dwordx4 v[52:55], v18, s[4:7], s44 offen offset:0 sc1
  v_cvt_pk_bf16_f32 v56, v184, v185
  v_cvt_pk_bf16_f32 v57, v186, v187
  v_cvt_pk_bf16_f32 v58, v188, v189
  v_cvt_pk_bf16_f32 v59, v190, v191
  buffer_store_dwordx4 v[56:59], v18, s[4:7], s44 offen offset:1024 sc1
  s_branch L_chained
L_epi_silu_21:
  s_mov_b32 s46, 0xbfb8aa3b
  s_mov_b32 s47, 0xbfb8aa3b
  s_lshr_b32 s42, s28, 2
  s_and_b32 s43, s28, 3
  s_mul_i32 s45, s43, 2048
  s_add_u32 s45, s45, s37
  s_mul_i32 s44, s42, 8
  s_mul_i32 s44, s44, s38
  s_add_u32 s44, s44, s45
  v_pk_mul_f32 v[28:29], v[64:65], s[46:47]
  v_pk_mul_f32 v[30:31], v[66:67], s[46:47]
  v_pk_mul_f32 v[32:33], v[68:69], s[46:47]
  v_pk_mul_f32 v[34:35], v[70:71], s[46:47]
  v_pk_mul_f32 v[36:37], v[72:73], s[46:47]
  v_pk_mul_f32 v[38:39], v[74:75], s[46:47]
  v_pk_mul_f32 v[40:41], v[76:77], s[46:47]
  v_pk_mul_f32 v[42:43], v[78:79], s[46:47]
  v_exp_f32 v28, v28
  v_exp_f32 v29, v29
  v_exp_f32 v30, v30
  v_exp_f32 v31, v31
  v_exp_f32 v32, v32
  v_exp_f32 v33, v33
  v_exp_f32 v34, v34
  v_exp_f32 v35, v35
  v_exp_f32 v36, v36
  v_exp_f32 v37, v37
  v_exp_f32 v38, v38
  v_exp_f32 v39, v39
  v_exp_f32 v40, v40
  v_exp_f32 v41, v41
  v_exp_f32 v42, v42
  v_exp_f32 v43, v43
  v_pk_add_f32 v[28:29], v[28:29], 1.0 op_sel_hi:[1,0]
  v_pk_add_f32 v[30:31], v[30:31], 1.0 op_sel_hi:[1,0]
  v_pk_add_f32 v[32:33], v[32:33], 1.0 op_sel_hi:[1,0]
  v_pk_add_f32 v[34:35], v[34:35], 1.0 op_sel_hi:[1,0]
  v_pk_add_f32 v[36:37], v[36:37], 1.0 op_sel_hi:[1,0]
  v_pk_add_f32 v[38:39], v[38:39], 1.0 op_sel_hi:[1,0]
  v_pk_add_f32 v[40:41], v[40:41], 1.0 op_sel_hi:[1,0]
  v_pk_add_f32 v[42:43], v[42:43], 1.0 op_sel_hi:[1,0]
  v_rcp_f32 v28, v28
  v_rcp_f32 v29, v29
  v_rcp_f32 v30, v30
  v_rcp_f32 v31, v31
  v_rcp_f32 v32, v32
  v_rcp_f32 v33, v33
  v_rcp_f32 v34, v34
  v_rcp_f32 v35, v35
  v_rcp_f32 v36, v36
  v_rcp_f32 v37, v37
  v_rcp_f32 v38, v38
  v_rcp_f32 v39, v39
  v_rcp_f32 v40, v40
  v_rcp_f32 v41, v41
  v_rcp_f32 v42, v42
  v_rcp_f32 v43, v43
  v_pk_mul_f32 v[64:65], v[64:65], v[28:29]
  v_pk_mul_f32 v[66:67], v[66:67], v[30:31]
  v_pk_mul_f32 v[68:69], v[68:69], v[32:33]
  v_pk_mul_f32 v[70:71], v[70:71], v[34:35]
  v_pk_mul_f32 v[72:73], v[72:73], v[36:37]
  v_pk_mul_f32 v[74:75], v[74:75], v[38:39]
  v_pk_mul_f32 v[76:77], v[76:77], v[40:41]
  v_pk_mul_f32 v[78:79], v[78:79], v[42:43]
  v_cvt_pk_bf16_f32 v44, v64, v65
  v_cvt_pk_bf16_f32 v45, v66, v67
  v_cvt_pk_bf16_f32 v46, v68, v69
  v_cvt_pk_bf16_f32 v47, v70, v71
  buffer_store_dwordx4 v[44:47], v18, s[4:7], s44 offen offset:0 sc1
  v_cvt_pk_bf16_f32 v48, v72, v73
  v_cvt_pk_bf16_f32 v49, v74, v75
  v_cvt_pk_bf16_f32 v50, v76, v77
  v_cvt_pk_bf16_f32 v51, v78, v79
  buffer_store_dwordx4 v[48:51], v18, s[4:7], s44 offen offset:1024 sc1
  s_add_u32 s44, s44, s38
  v_pk_mul_f32 v[28:29], v[80:81], s[46:47]
  v_pk_mul_f32 v[30:31], v[82:83], s[46:47]
  v_pk_mul_f32 v[32:33], v[84:85], s[46:47]
  v_pk_mul_f32 v[34:35], v[86:87], s[46:47]
  v_pk_mul_f32 v[36:37], v[88:89], s[46:47]
  v_pk_mul_f32 v[38:39], v[90:91], s[46:47]
  v_pk_mul_f32 v[40:41], v[92:93], s[46:47]
  v_pk_mul_f32 v[42:43], v[94:95], s[46:47]
  v_exp_f32 v28, v28
  v_exp_f32 v29, v29
  v_exp_f32 v30, v30
  v_exp_f32 v31, v31
  v_exp_f32 v32, v32
  v_exp_f32 v33, v33
  v_exp_f32 v34, v34
  v_exp_f32 v35, v35
  v_exp_f32 v36, v36
  v_exp_f32 v37, v37
  v_exp_f32 v38, v38
  v_exp_f32 v39, v39
  v_exp_f32 v40, v40
  v_exp_f32 v41, v41
  v_exp_f32 v42, v42
  v_exp_f32 v43, v43
  v_pk_add_f32 v[28:29], v[28:29], 1.0 op_sel_hi:[1,0]
  v_pk_add_f32 v[30:31], v[30:31], 1.0 op_sel_hi:[1,0]
  v_pk_add_f32 v[32:33], v[32:33], 1.0 op_sel_hi:[1,0]
  v_pk_add_f32 v[34:35], v[34:35], 1.0 op_sel_hi:[1,0]
  v_pk_add_f32 v[36:37], v[36:37], 1.0 op_sel_hi:[1,0]
  v_pk_add_f32 v[38:39], v[38:39], 1.0 op_sel_hi:[1,0]
  v_pk_add_f32 v[40:41], v[40:41], 1.0 op_sel_hi:[1,0]
  v_pk_add_f32 v[42:43], v[42:43], 1.0 op_sel_hi:[1,0]
  v_rcp_f32 v28, v28
  v_rcp_f32 v29, v29
  v_rcp_f32 v30, v30
  v_rcp_f32 v31, v31
  v_rcp_f32 v32, v32
  v_rcp_f32 v33, v33
  v_rcp_f32 v34, v34
  v_rcp_f32 v35, v35
  v_rcp_f32 v36, v36
  v_rcp_f32 v37, v37
  v_rcp_f32 v38, v38
  v_rcp_f32 v39, v39
  v_rcp_f32 v40, v40
  v_rcp_f32 v41, v41
  v_rcp_f32 v42, v42
  v_rcp_f32 v43, v43
  v_pk_mul_f32 v[80:81], v[80:81], v[28:29]
  v_pk_mul_f32 v[82:83], v[82:83], v[30:31]
  v_pk_mul_f32 v[84:85], v[84:85], v[32:33]
  v_pk_mul_f32 v[86:87], v[86:87], v[34:35]
  v_pk_mul_f32 v[88:89], v[88:89], v[36:37]
  v_pk_mul_f32 v[90:91], v[90:91], v[38:39]
  v_pk_mul_f32 v[92:93], v[92:93], v[40:41]
  v_pk_mul_f32 v[94:95], v[94:95], v[42:43]
  v_cvt_pk_bf16_f32 v52, v80, v81
  v_cvt_pk_bf16_f32 v53, v82, v83
  v_cvt_pk_bf16_f32 v54, v84, v85
  v_cvt_pk_bf16_f32 v55, v86, v87
  buffer_store_dwordx4 v[52:55], v18, s[4:7], s44 offen offset:0 sc1
  v_cvt_pk_bf16_f32 v56, v88, v89
  v_cvt_pk_bf16_f32 v57, v90, v91
  v_cvt_pk_bf16_f32 v58, v92, v93
  v_cvt_pk_bf16_f32 v59, v94, v95
  buffer_store_dwordx4 v[56:59], v18, s[4:7], s44 offen offset:1024 sc1
  s_add_u32 s44, s44, s38
  v_pk_mul_f32 v[28:29], v[96:97], s[46:47]
  v_pk_mul_f32 v[30:31], v[98:99], s[46:47]
  v_pk_mul_f32 v[32:33], v[100:101], s[46:47]
  v_pk_mul_f32 v[34:35], v[102:103], s[46:47]
  v_pk_mul_f32 v[36:37], v[104:105], s[46:47]
  v_pk_mul_f32 v[38:39], v[106:107], s[46:47]
  v_pk_mul_f32 v[40:41], v[108:109], s[46:47]
  v_pk_mul_f32 v[42:43], v[110:111], s[46:47]
  v_exp_f32 v28, v28
  v_exp_f32 v29, v29
  v_exp_f32 v30, v30
  v_exp_f32 v31, v31
  v_exp_f32 v32, v32
  v_exp_f32 v33, v33
  v_exp_f32 v34, v34
  v_exp_f32 v35, v35
  v_exp_f32 v36, v36
  v_exp_f32 v37, v37
  v_exp_f32 v38, v38
  v_exp_f32 v39, v39
  v_exp_f32 v40, v40
  v_exp_f32 v41, v41
  v_exp_f32 v42, v42
  v_exp_f32 v43, v43
  v_pk_add_f32 v[28:29], v[28:29], 1.0 op_sel_hi:[1,0]
  v_pk_add_f32 v[30:31], v[30:31], 1.0 op_sel_hi:[1,0]
  v_pk_add_f32 v[32:33], v[32:33], 1.0 op_sel_hi:[1,0]
  v_pk_add_f32 v[34:35], v[34:35], 1.0 op_sel_hi:[1,0]
  v_pk_add_f32 v[36:37], v[36:37], 1.0 op_sel_hi:[1,0]
  v_pk_add_f32 v[38:39], v[38:39], 1.0 op_sel_hi:[1,0]
  v_pk_add_f32 v[40:41], v[40:41], 1.0 op_sel_hi:[1,0]
  v_pk_add_f32 v[42:43], v[42:43], 1.0 op_sel_hi:[1,0]
  v_rcp_f32 v28, v28
  v_rcp_f32 v29, v29
  v_rcp_f32 v30, v30
  v_rcp_f32 v31, v31
  v_rcp_f32 v32, v32
  v_rcp_f32 v33, v33
  v_rcp_f32 v34, v34
  v_rcp_f32 v35, v35
  v_rcp_f32 v36, v36
  v_rcp_f32 v37, v37
  v_rcp_f32 v38, v38
  v_rcp_f32 v39, v39
  v_rcp_f32 v40, v40
  v_rcp_f32 v41, v41
  v_rcp_f32 v42, v42
  v_rcp_f32 v43, v43
  v_pk_mul_f32 v[96:97], v[96:97], v[28:29]
  v_pk_mul_f32 v[98:99], v[98:99], v[30:31]
  v_pk_mul_f32 v[100:101], v[100:101], v[32:33]
  v_pk_mul_f32 v[102:103], v[102:103], v[34:35]
  v_pk_mul_f32 v[104:105], v[104:105], v[36:37]
  v_pk_mul_f32 v[106:107], v[106:107], v[38:39]
  v_pk_mul_f32 v[108:109], v[108:109], v[40:41]
  v_pk_mul_f32 v[110:111], v[110:111], v[42:43]
  v_cvt_pk_bf16_f32 v44, v96, v97
  v_cvt_pk_bf16_f32 v45, v98, v99
  v_cvt_pk_bf16_f32 v46, v100, v101
  v_cvt_pk_bf16_f32 v47, v102, v103
  buffer_store_dwordx4 v[44:47], v18, s[4:7], s44 offen offset:0 sc1
  v_cvt_pk_bf16_f32 v48, v104, v105
  v_cvt_pk_bf16_f32 v49, v106, v107
  v_cvt_pk_bf16_f32 v50, v108, v109
  v_cvt_pk_bf16_f32 v51, v110, v111
  buffer_store_dwordx4 v[48:51], v18, s[4:7], s44 offen offset:1024 sc1
  s_add_u32 s44, s44, s38
  v_pk_mul_f32 v[28:29], v[112:113], s[46:47]
  v_pk_mul_f32 v[30:31], v[114:115], s[46:47]
  v_pk_mul_f32 v[32:33], v[116:117], s[46:47]
  v_pk_mul_f32 v[34:35], v[118:119], s[46:47]
  v_pk_mul_f32 v[36:37], v[120:121], s[46:47]
  v_pk_mul_f32 v[38:39], v[122:123], s[46:47]
  v_pk_mul_f32 v[40:41], v[124:125], s[46:47]
  v_pk_mul_f32 v[42:43], v[126:127], s[46:47]
  v_exp_f32 v28, v28
  v_exp_f32 v29, v29
  v_exp_f32 v30, v30
  v_exp_f32 v31, v31
  v_exp_f32 v32, v32
  v_exp_f32 v33, v33
  v_exp_f32 v34, v34
  v_exp_f32 v35, v35
  v_exp_f32 v36, v36
  v_exp_f32 v37, v37
  v_exp_f32 v38, v38
  v_exp_f32 v39, v39
  v_exp_f32 v40, v40
  v_exp_f32 v41, v41
  v_exp_f32 v42, v42
  v_exp_f32 v43, v43
  v_pk_add_f32 v[28:29], v[28:29], 1.0 op_sel_hi:[1,0]
  v_pk_add_f32 v[30:31], v[30:31], 1.0 op_sel_hi:[1,0]
  v_pk_add_f32 v[32:33], v[32:33], 1.0 op_sel_hi:[1,0]
  v_pk_add_f32 v[34:35], v[34:35], 1.0 op_sel_hi:[1,0]
  v_pk_add_f32 v[36:37], v[36:37], 1.0 op_sel_hi:[1,0]
  v_pk_add_f32 v[38:39], v[38:39], 1.0 op_sel_hi:[1,0]
  v_pk_add_f32 v[40:41], v[40:41], 1.0 op_sel_hi:[1,0]
  v_pk_add_f32 v[42:43], v[42:43], 1.0 op_sel_hi:[1,0]
  v_rcp_f32 v28, v28
  v_rcp_f32 v29, v29
  v_rcp_f32 v30, v30
  v_rcp_f32 v31, v31
  v_rcp_f32 v32, v32
  v_rcp_f32 v33, v33
  v_rcp_f32 v34, v34
  v_rcp_f32 v35, v35
  v_rcp_f32 v36, v36
  v_rcp_f32 v37, v37
  v_rcp_f32 v38, v38
  v_rcp_f32 v39, v39
  v_rcp_f32 v40, v40
  v_rcp_f32 v41, v41
  v_rcp_f32 v42, v42
  v_rcp_f32 v43, v43
  v_pk_mul_f32 v[112:113], v[112:113], v[28:29]
  v_pk_mul_f32 v[114:115], v[114:115], v[30:31]
  v_pk_mul_f32 v[116:117], v[116:117], v[32:33]
  v_pk_mul_f32 v[118:119], v[118:119], v[34:35]
  v_pk_mul_f32 v[120:121], v[120:121], v[36:37]
  v_pk_mul_f32 v[122:123], v[122:123], v[38:39]
  v_pk_mul_f32 v[124:125], v[124:125], v[40:41]
  v_pk_mul_f32 v[126:127], v[126:127], v[42:43]
  v_cvt_pk_bf16_f32 v52, v112, v113
  v_cvt_pk_bf16_f32 v53, v114, v115
  v_cvt_pk_bf16_f32 v54, v116, v117
  v_cvt_pk_bf16_f32 v55, v118, v119
  buffer_store_dwordx4 v[52:55], v18, s[4:7], s44 offen offset:0 sc1
  v_cvt_pk_bf16_f32 v56, v120, v121
  v_cvt_pk_bf16_f32 v57, v122, v123
  v_cvt_pk_bf16_f32 v58, v124, v125
  v_cvt_pk_bf16_f32 v59, v126, v127
  buffer_store_dwordx4 v[56:59], v18, s[4:7], s44 offen offset:1024 sc1
  s_add_u32 s44, s44, s38
  v_pk_mul_f32 v[28:29], v[128:129], s[46:47]
  v_pk_mul_f32 v[30:31], v[130:131], s[46:47]
  v_pk_mul_f32 v[32:33], v[132:133], s[46:47]
  v_pk_mul_f32 v[34:35], v[134:135], s[46:47]
  v_pk_mul_f32 v[36:37], v[136:137], s[46:47]
  v_pk_mul_f32 v[38:39], v[138:139], s[46:47]
  v_pk_mul_f32 v[40:41], v[140:141], s[46:47]
  v_pk_mul_f32 v[42:43], v[142:143], s[46:47]
  v_exp_f32 v28, v28
  v_exp_f32 v29, v29
  v_exp_f32 v30, v30
  v_exp_f32 v31, v31
  v_exp_f32 v32, v32
  v_exp_f32 v33, v33
  v_exp_f32 v34, v34
  v_exp_f32 v35, v35
  v_exp_f32 v36, v36
  v_exp_f32 v37, v37
  v_exp_f32 v38, v38
  v_exp_f32 v39, v39
  v_exp_f32 v40, v40
  v_exp_f32 v41, v41
  v_exp_f32 v42, v42
  v_exp_f32 v43, v43
  v_pk_add_f32 v[28:29], v[28:29], 1.0 op_sel_hi:[1,0]
  v_pk_add_f32 v[30:31], v[30:31], 1.0 op_sel_hi:[1,0]
  v_pk_add_f32 v[32:33], v[32:33], 1.0 op_sel_hi:[1,0]
  v_pk_add_f32 v[34:35], v[34:35], 1.0 op_sel_hi:[1,0]
  v_pk_add_f32 v[36:37], v[36:37], 1.0 op_sel_hi:[1,0]
  v_pk_add_f32 v[38:39], v[38:39], 1.0 op_sel_hi:[1,0]
  v_pk_add_f32 v[40:41], v[40:41], 1.0 op_sel_hi:[1,0]
  v_pk_add_f32 v[42:43], v[42:43], 1.0 op_sel_hi:[1,0]
  v_rcp_f32 v28, v28
  v_rcp_f32 v29, v29
  v_rcp_f32 v30, v30
  v_rcp_f32 v31, v31
  v_rcp_f32 v32, v32
  v_rcp_f32 v33, v33
  v_rcp_f32 v34, v34
  v_rcp_f32 v35, v35
  v_rcp_f32 v36, v36
  v_rcp_f32 v37, v37
  v_rcp_f32 v38, v38
  v_rcp_f32 v39, v39
  v_rcp_f32 v40, v40
  v_rcp_f32 v41, v41
  v_rcp_f32 v42, v42
  v_rcp_f32 v43, v43
  v_pk_mul_f32 v[128:129], v[128:129], v[28:29]
  v_pk_mul_f32 v[130:131], v[130:131], v[30:31]
  v_pk_mul_f32 v[132:133], v[132:133], v[32:33]
  v_pk_mul_f32 v[134:135], v[134:135], v[34:35]
  v_pk_mul_f32 v[136:137], v[136:137], v[36:37]
  v_pk_mul_f32 v[138:139], v[138:139], v[38:39]
  v_pk_mul_f32 v[140:141], v[140:141], v[40:41]
  v_pk_mul_f32 v[142:143], v[142:143], v[42:43]
  v_cvt_pk_bf16_f32 v44, v128, v129
  v_cvt_pk_bf16_f32 v45, v130, v131
  v_cvt_pk_bf16_f32 v46, v132, v133
  v_cvt_pk_bf16_f32 v47, v134, v135
  buffer_store_dwordx4 v[44:47], v18, s[4:7], s44 offen offset:0 sc1
  v_cvt_pk_bf16_f32 v48, v136, v137
  v_cvt_pk_bf16_f32 v49, v138, v139
  v_cvt_pk_bf16_f32 v50, v140, v141
  v_cvt_pk_bf16_f32 v51, v142, v143
  buffer_store_dwordx4 v[48:51], v18, s[4:7], s44 offen offset:1024 sc1
  s_add_u32 s44, s44, s38
  v_pk_mul_f32 v[28:29], v[144:145], s[46:47]
  v_pk_mul_f32 v[30:31], v[146:147], s[46:47]
  v_pk_mul_f32 v[32:33], v[148:149], s[46:47]
  v_pk_mul_f32 v[34:35], v[150:151], s[46:47]
  v_pk_mul_f32 v[36:37], v[152:153], s[46:47]
  v_pk_mul_f32 v[38:39], v[154:155], s[46:47]
  v_pk_mul_f32 v[40:41], v[156:157], s[46:47]
  v_pk_mul_f32 v[42:43], v[158:159], s[46:47]
  v_exp_f32 v28, v28
  v_exp_f32 v29, v29
  v_exp_f32 v30, v30
  v_exp_f32 v31, v31
  v_exp_f32 v32, v32
  v_exp_f32 v33, v33
  v_exp_f32 v34, v34
  v_exp_f32 v35, v35
  v_exp_f32 v36, v36
  v_exp_f32 v37, v37
  v_exp_f32 v38, v38
  v_exp_f32 v39, v39
  v_exp_f32 v40, v40
  v_exp_f32 v41, v41
  v_exp_f32 v42, v42
  v_exp_f32 v43, v43
  v_pk_add_f32 v[28:29], v[28:29], 1.0 op_sel_hi:[1,0]
  v_pk_add_f32 v[30:31], v[30:31], 1.0 op_sel_hi:[1,0]
  v_pk_add_f32 v[32:33], v[32:33], 1.0 op_sel_hi:[1,0]
  v_pk_add_f32 v[34:35], v[34:35], 1.0 op_sel_hi:[1,0]
  v_pk_add_f32 v[36:37], v[36:37], 1.0 op_sel_hi:[1,0]
  v_pk_add_f32 v[38:39], v[38:39], 1.0 op_sel_hi:[1,0]
  v_pk_add_f32 v[40:41], v[40:41], 1.0 op_sel_hi:[1,0]
  v_pk_add_f32 v[42:43], v[42:43], 1.0 op_sel_hi:[1,0]
  v_rcp_f32 v28, v28
  v_rcp_f32 v29, v29
  v_rcp_f32 v30, v30
  v_rcp_f32 v31, v31
  v_rcp_f32 v32, v32
  v_rcp_f32 v33, v33
  v_rcp_f32 v34, v34
  v_rcp_f32 v35, v35
  v_rcp_f32 v36, v36
  v_rcp_f32 v37, v37
  v_rcp_f32 v38, v38
  v_rcp_f32 v39, v39
  v_rcp_f32 v40, v40
  v_rcp_f32 v41, v41
  v_rcp_f32 v42, v42
  v_rcp_f32 v43, v43
  v_pk_mul_f32 v[144:145], v[144:145], v[28:29]
  v_pk_mul_f32 v[146:147], v[146:147], v[30:31]
  v_pk_mul_f32 v[148:149], v[148:149], v[32:33]
  v_pk_mul_f32 v[150:151], v[150:151], v[34:35]
  v_pk_mul_f32 v[152:153], v[152:153], v[36:37]
  v_pk_mul_f32 v[154:155], v[154:155], v[38:39]
  v_pk_mul_f32 v[156:157], v[156:157], v[40:41]
  v_pk_mul_f32 v[158:159], v[158:159], v[42:43]
  v_cvt_pk_bf16_f32 v52, v144, v145
  v_cvt_pk_bf16_f32 v53, v146, v147
  v_cvt_pk_bf16_f32 v54, v148, v149
  v_cvt_pk_bf16_f32 v55, v150, v151
  buffer_store_dwordx4 v[52:55], v18, s[4:7], s44 offen offset:0 sc1
  v_cvt_pk_bf16_f32 v56, v152, v153
  v_cvt_pk_bf16_f32 v57, v154, v155
  v_cvt_pk_bf16_f32 v58, v156, v157
  v_cvt_pk_bf16_f32 v59, v158, v159
  buffer_store_dwordx4 v[56:59], v18, s[4:7], s44 offen offset:1024 sc1
  s_add_u32 s44, s44, s38
  v_pk_mul_f32 v[28:29], v[160:161], s[46:47]
  v_pk_mul_f32 v[30:31], v[162:163], s[46:47]
  v_pk_mul_f32 v[32:33], v[164:165], s[46:47]
  v_pk_mul_f32 v[34:35], v[166:167], s[46:47]
  v_pk_mul_f32 v[36:37], v[168:169], s[46:47]
  v_pk_mul_f32 v[38:39], v[170:171], s[46:47]
  v_pk_mul_f32 v[40:41], v[172:173], s[46:47]
  v_pk_mul_f32 v[42:43], v[174:175], s[46:47]
  v_exp_f32 v28, v28
  v_exp_f32 v29, v29
  v_exp_f32 v30, v30
  v_exp_f32 v31, v31
  v_exp_f32 v32, v32
  v_exp_f32 v33, v33
  v_exp_f32 v34, v34
  v_exp_f32 v35, v35
  v_exp_f32 v36, v36
  v_exp_f32 v37, v37
  v_exp_f32 v38, v38
  v_exp_f32 v39, v39
  v_exp_f32 v40, v40
  v_exp_f32 v41, v41
  v_exp_f32 v42, v42
  v_exp_f32 v43, v43
  v_pk_add_f32 v[28:29], v[28:29], 1.0 op_sel_hi:[1,0]
  v_pk_add_f32 v[30:31], v[30:31], 1.0 op_sel_hi:[1,0]
  v_pk_add_f32 v[32:33], v[32:33], 1.0 op_sel_hi:[1,0]
  v_pk_add_f32 v[34:35], v[34:35], 1.0 op_sel_hi:[1,0]
  v_pk_add_f32 v[36:37], v[36:37], 1.0 op_sel_hi:[1,0]
  v_pk_add_f32 v[38:39], v[38:39], 1.0 op_sel_hi:[1,0]
  v_pk_add_f32 v[40:41], v[40:41], 1.0 op_sel_hi:[1,0]
  v_pk_add_f32 v[42:43], v[42:43], 1.0 op_sel_hi:[1,0]
  v_rcp_f32 v28, v28
  v_rcp_f32 v29, v29
  v_rcp_f32 v30, v30
  v_rcp_f32 v31, v31
  v_rcp_f32 v32, v32
  v_rcp_f32 v33, v33
  v_rcp_f32 v34, v34
  v_rcp_f32 v35, v35
  v_rcp_f32 v36, v36
  v_rcp_f32 v37, v37
  v_rcp_f32 v38, v38
  v_rcp_f32 v39, v39
  v_rcp_f32 v40, v40
  v_rcp_f32 v41, v41
  v_rcp_f32 v42, v42
  v_rcp_f32 v43, v43
  v_pk_mul_f32 v[160:161], v[160:161], v[28:29]
  v_pk_mul_f32 v[162:163], v[162:163], v[30:31]
  v_pk_mul_f32 v[164:165], v[164:165], v[32:33]
  v_pk_mul_f32 v[166:167], v[166:167], v[34:35]
  v_pk_mul_f32 v[168:169], v[168:169], v[36:37]
  v_pk_mul_f32 v[170:171], v[170:171], v[38:39]
  v_pk_mul_f32 v[172:173], v[172:173], v[40:41]
  v_pk_mul_f32 v[174:175], v[174:175], v[42:43]
  v_cvt_pk_bf16_f32 v44, v160, v161
  v_cvt_pk_bf16_f32 v45, v162, v163
  v_cvt_pk_bf16_f32 v46, v164, v165
  v_cvt_pk_bf16_f32 v47, v166, v167
  buffer_store_dwordx4 v[44:47], v18, s[4:7], s44 offen offset:0 sc1
  v_cvt_pk_bf16_f32 v48, v168, v169
  v_cvt_pk_bf16_f32 v49, v170, v171
  v_cvt_pk_bf16_f32 v50, v172, v173
  v_cvt_pk_bf16_f32 v51, v174, v175
  buffer_store_dwordx4 v[48:51], v18, s[4:7], s44 offen offset:1024 sc1
  s_add_u32 s44, s44, s38
  v_pk_mul_f32 v[28:29], v[176:177], s[46:47]
  v_pk_mul_f32 v[30:31], v[178:179], s[46:47]
  v_pk_mul_f32 v[32:33], v[180:181], s[46:47]
  v_pk_mul_f32 v[34:35], v[182:183], s[46:47]
  v_pk_mul_f32 v[36:37], v[184:185], s[46:47]
  v_pk_mul_f32 v[38:39], v[186:187], s[46:47]
  v_pk_mul_f32 v[40:41], v[188:189], s[46:47]
  v_pk_mul_f32 v[42:43], v[190:191], s[46:47]
  v_exp_f32 v28, v28
  v_exp_f32 v29, v29
  v_exp_f32 v30, v30
  v_exp_f32 v31, v31
  v_exp_f32 v32, v32
  v_exp_f32 v33, v33
  v_exp_f32 v34, v34
  v_exp_f32 v35, v35
  v_exp_f32 v36, v36
  v_exp_f32 v37, v37
  v_exp_f32 v38, v38
  v_exp_f32 v39, v39
  v_exp_f32 v40, v40
  v_exp_f32 v41, v41
  v_exp_f32 v42, v42
  v_exp_f32 v43, v43
  v_pk_add_f32 v[28:29], v[28:29], 1.0 op_sel_hi:[1,0]
  v_pk_add_f32 v[30:31], v[30:31], 1.0 op_sel_hi:[1,0]
  v_pk_add_f32 v[32:33], v[32:33], 1.0 op_sel_hi:[1,0]
  v_pk_add_f32 v[34:35], v[34:35], 1.0 op_sel_hi:[1,0]
  v_pk_add_f32 v[36:37], v[36:37], 1.0 op_sel_hi:[1,0]
  v_pk_add_f32 v[38:39], v[38:39], 1.0 op_sel_hi:[1,0]
  v_pk_add_f32 v[40:41], v[40:41], 1.0 op_sel_hi:[1,0]
  v_pk_add_f32 v[42:43], v[42:43], 1.0 op_sel_hi:[1,0]
  v_rcp_f32 v28, v28
  v_rcp_f32 v29, v29
  v_rcp_f32 v30, v30
  v_rcp_f32 v31, v31
  v_rcp_f32 v32, v32
  v_rcp_f32 v33, v33
  v_rcp_f32 v34, v34
  v_rcp_f32 v35, v35
  v_rcp_f32 v36, v36
  v_rcp_f32 v37, v37
  v_rcp_f32 v38, v38
  v_rcp_f32 v39, v39
  v_rcp_f32 v40, v40
  v_rcp_f32 v41, v41
  v_rcp_f32 v42, v42
  v_rcp_f32 v43, v43
  v_pk_mul_f32 v[176:177], v[176:177], v[28:29]
  v_pk_mul_f32 v[178:179], v[178:179], v[30:31]
  v_pk_mul_f32 v[180:181], v[180:181], v[32:33]
  v_pk_mul_f32 v[182:183], v[182:183], v[34:35]
  v_pk_mul_f32 v[184:185], v[184:185], v[36:37]
  v_pk_mul_f32 v[186:187], v[186:187], v[38:39]
  v_pk_mul_f32 v[188:189], v[188:189], v[40:41]
  v_pk_mul_f32 v[190:191], v[190:191], v[42:43]
  v_cvt_pk_bf16_f32 v52, v176, v177
  v_cvt_pk_bf16_f32 v53, v178, v179
  v_cvt_pk_bf16_f32 v54, v180, v181
  v_cvt_pk_bf16_f32 v55, v182, v183
  buffer_store_dwordx4 v[52:55], v18, s[4:7], s44 offen offset:0 sc1
  v_cvt_pk_bf16_f32 v56, v184, v185
  v_cvt_pk_bf16_f32 v57, v186, v187
  v_cvt_pk_bf16_f32 v58, v188, v189
  v_cvt_pk_bf16_f32 v59, v190, v191
  buffer_store_dwordx4 v[56:59], v18, s[4:7], s44 offen offset:1024 sc1
  s_branch L_chained
L_head_big_fn_kq:
  s_waitcnt lgkmcnt(4)
  v_mfma_f32_16x16x32_bf16 v[64:67], a[32:35], a[0:3], 0
  v_mfma_f32_16x16x32_bf16 v[68:71], a[36:39], a[0:3], 0
  v_mfma_f32_16x16x32_bf16 v[72:75], a[40:43], a[0:3], 0
  v_mfma_f32_16x16x32_bf16 v[76:79], a[44:47], a[0:3], 0
  s_waitcnt lgkmcnt(0)
  s_waitcnt vmcnt(24)
  s_barrier
  ds_read_b128 a[0:3], v12 offset:16384
  v_mfma_f32_16x16x32_bf16 v[80:83], a[32:35], a[4:7], 0
  s_add_u32 m0, s40, 0
  ds_read_b64_tr_b16 a[48:49], v14 offset:16384
  v_mfma_f32_16x16x32_bf16 v[84:87], a[36:39], a[4:7], 0
  buffer_load_dwordx4 v4, s[8:11], s32 offen offset:0 sc1 lds
  v_mfma_f32_16x16x32_bf16 v[88:91], a[40:43], a[4:7], 0
  buffer_load_dwordx4 v5, s[8:11], s32 offen offset:1024 sc1 lds
  s_add_u32 s32, s32, s33
  v_mfma_f32_16x16x32_bf16 v[92:95], a[44:47], a[4:7], 0
  ds_read_b128 a[4:7], v12 offset:17408
  v_mfma_f32_16x16x32_bf16 v[96:99], a[32:35], a[8:11], 0
  s_add_u32 m0, s41, 0
  ds_read_b64_tr_b16 a[50:51], v14 offset:18432
  v_mfma_f32_16x16x32_bf16 v[100:103], a[36:39], a[8:11], 0
  buffer_load_dwordx4 v8, s[12:15], s34 offen offset:0 lds
  v_mfma_f32_16x16x32_bf16 v[104:107], a[40:43], a[8:11], 0
  buffer_load_dwordx4 v9, s[12:15], s34 offen offset:1024 lds
  s_add_u32 s34, s34, s35
  v_mfma_f32_16x16x32_bf16 v[108:111], a[44:47], a[8:11], 0
  ds_read_b128 a[8:11], v12 offset:18432
  v_mfma_f32_16x16x32_bf16 v[112:115], a[32:35], a[12:15], 0
  ds_read_b64_tr_b16 a[52:53], v15 offset:16384
  v_mfma_f32_16x16x32_bf16 v[116:119], a[36:39], a[12:15], 0
  ds_read_b64_tr_b16 a[54:55], v15 offset:18432
  v_mfma_f32_16x16x32_bf16 v[120:123], a[40:43], a[12:15], 0
  ds_read_b64_tr_b16 a[56:57], v16 offset:16384
  v_mfma_f32_16x16x32_bf16 v[124:127], a[44:47], a[12:15], 0
  ds_read_b128 a[12:15], v12 offset:19456
  v_mfma_f32_16x16x32_bf16 v[128:131], a[32:35], a[16:19], 0
  ds_read_b64_tr_b16 a[58:59], v16 offset:18432
  v_mfma_f32_16x16x32_bf16 v[132:135], a[36:39], a[16:19], 0
  ds_read_b64_tr_b16 a[60:61], v17 offset:16384
  v_mfma_f32_16x16x32_bf16 v[136:139], a[40:43], a[16:19], 0
  ds_read_b64_tr_b16 a[62:63], v17 offset:18432
  v_mfma_f32_16x16x32_bf16 v[140:143], a[44:47], a[16:19], 0
  ds_read_b128 a[16:19], v12 offset:20480
  v_mfma_f32_16x16x32_bf16 v[144:147], a[32:35], a[20:23], 0
  v_mfma_f32_16x16x32_bf16 v[148:151], a[36:39], a[20:23], 0
  v_mfma_f32_16x16x32_bf16 v[152:155], a[40:43], a[20:23], 0
  v_mfma_f32_16x16x32_bf16 v[156:159], a[44:47], a[20:23], 0
  ds_read_b128 a[20:23], v12 offset:21504
  v_mfma_f32_16x16x32_bf16 v[160:163], a[32:35], a[24:27], 0
  v_mfma_f32_16x16x32_bf16 v[164:167], a[36:39], a[24:27], 0
  v_mfma_f32_16x16x32_bf16 v[168:171], a[40:43], a[24:27], 0
  v_mfma_f32_16x16x32_bf16 v[172:175], a[44:47], a[24:27], 0
  ds_read_b128 a[24:27], v12 offset:22528
  v_mfma_f32_16x16x32_bf16 v[176:179], a[32:35], a[28:31], 0
  v_mfma_f32_16x16x32_bf16 v[180:183], a[36:39], a[28:31], 0
  v_mfma_f32_16x16x32_bf16 v[184:187], a[40:43], a[28:31], 0
  v_mfma_f32_16x16x32_bf16 v[188:191], a[44:47], a[28:31], 0
  ds_read_b128 a[28:31], v12 offset:23552
  s_waitcnt lgkmcnt(4)
  v_mfma_f32_16x16x32_bf16 v[64:67], a[48:51], a[0:3], v[64:67]
  v_mfma_f32_16x16x32_bf16 v[68:71], a[52:55], a[0:3], v[68:71]
  v_mfma_f32_16x16x32_bf16 v[72:75], a[56:59], a[0:3], v[72:75]
  v_mfma_f32_16x16x32_bf16 v[76:79], a[60:63], a[0:3], v[76:79]
  s_waitcnt lgkmcnt(0)
  s_waitcnt vmcnt(24)
  s_barrier
  ds_read_b128 a[0:3], v12 offset:32768
  v_mfma_f32_16x16x32_bf16 v[80:83], a[48:51], a[4:7], v[80:83]
  s_add_u32 m0, s40, 16384
  ds_read_b64_tr_b16 a[32:33], v14 offset:32768
  v_mfma_f32_16x16x32_bf16 v[84:87], a[52:55], a[4:7], v[84:87]
  buffer_load_dwordx4 v4, s[8:11], s32 offen offset:0 sc1 lds
  v_mfma_f32_16x16x32_bf16 v[88:91], a[56:59], a[4:7], v[88:91]
  buffer_load_dwordx4 v5, s[8:11], s32 offen offset:1024 sc1 lds
  s_add_u32 s32, s32, s33
  v_mfma_f32_16x16x32_bf16 v[92:95], a[60:63], a[4:7], v[92:95]
  ds_read_b128 a[4:7], v12 offset:33792
  v_mfma_f32_16x16x32_bf16 v[96:99], a[48:51], a[8:11], v[96:99]
  s_add_u32 m0, s41, 16384
  ds_read_b64_tr_b16 a[34:35], v14 offset:34816
  v_mfma_f32_16x16x32_bf16 v[100:103], a[52:55], a[8:11], v[100:103]
  buffer_load_dwordx4 v8, s[12:15], s34 offen offset:0 lds
  v_mfma_f32_16x16x32_bf16 v[104:107], a[56:59], a[8:11], v[104:107]
  buffer_load_dwordx4 v9, s[12:15], s34 offen offset:1024 lds
  s_add_u32 s34, s34, s35
  v_mfma_f32_16x16x32_bf16 v[108:111], a[60:63], a[8:11], v[108:111]
  ds_read_b128 a[8:11], v12 offset:34816
  v_mfma_f32_16x16x32_bf16 v[112:115], a[48:51], a[12:15], v[112:115]
  ds_read_b64_tr_b16 a[36:37], v15 offset:32768
  v_mfma_f32_16x16x32_bf16 v[116:119], a[52:55], a[12:15], v[116:119]
  ds_read_b64_tr_b16 a[38:39], v15 offset:34816
  v_mfma_f32_16x16x32_bf16 v[120:123], a[56:59], a[12:15], v[120:123]
  ds_read_b64_tr_b16 a[40:41], v16 offset:32768
  v_mfma_f32_16x16x32_bf16 v[124:127], a[60:63], a[12:15], v[124:127]
  ds_read_b128 a[12:15], v12 offset:35840
  v_mfma_f32_16x16x32_bf16 v[128:131], a[48:51], a[16:19], v[128:131]
  ds_read_b64_tr_b16 a[42:43], v16 offset:34816
  v_mfma_f32_16x16x32_bf16 v[132:135], a[52:55], a[16:19], v[132:135]
  ds_read_b64_tr_b16 a[44:45], v17 offset:32768
  v_mfma_f32_16x16x32_bf16 v[136:139], a[56:59], a[16:19], v[136:139]
  ds_read_b64_tr_b16 a[46:47], v17 offset:34816
  v_mfma_f32_16x16x32_bf16 v[140:143], a[60:63], a[16:19], v[140:143]
  ds_read_b128 a[16:19], v12 offset:36864
  v_mfma_f32_16x16x32_bf16 v[144:147], a[48:51], a[20:23], v[144:147]
  v_mfma_f32_16x16x32_bf16 v[148:151], a[52:55], a[20:23], v[148:151]
  v_mfma_f32_16x16x32_bf16 v[152:155], a[56:59], a[20:23], v[152:155]
  v_mfma_f32_16x16x32_bf16 v[156:159], a[60:63], a[20:23], v[156:159]
  ds_read_b128 a[20:23], v12 offset:37888
  v_mfma_f32_16x16x32_bf16 v[160:163], a[48:51], a[24:27], v[160:163]
  v_mfma_f32_16x16x32_bf16 v[164:167], a[52:55], a[24:27], v[164:167]
  v_mfma_f32_16x16x32_bf16 v[168:171], a[56:59], a[24:27], v[168:171]
  v_mfma_f32_16x16x32_bf16 v[172:175], a[60:63], a[24:27], v[172:175]
  ds_read_b128 a[24:27], v12 offset:38912
  v_mfma_f32_16x16x32_bf16 v[176:179], a[48:51], a[28:31], v[176:179]
  v_mfma_f32_16x16x32_bf16 v[180:183], a[52:55], a[28:31], v[180:183]
  v_mfma_f32_16x16x32_bf16 v[184:187], a[56:59], a[28:31], v[184:187]
  v_mfma_f32_16x16x32_bf16 v[188:191], a[60:63], a[28:31], v[188:191]
  ds_read_b128 a[28:31], v12 offset:39936
  s_waitcnt lgkmcnt(4)
  v_mfma_f32_16x16x32_bf16 v[64:67], a[32:35], a[0:3], v[64:67]
  v_mfma_f32_16x16x32_bf16 v[68:71], a[36:39], a[0:3], v[68:71]
  v_mfma_f32_16x16x32_bf16 v[72:75], a[40:43], a[0:3], v[72:75]
  v_mfma_f32_16x16x32_bf16 v[76:79], a[44:47], a[0:3], v[76:79]
  s_waitcnt lgkmcnt(0)
  s_waitcnt vmcnt(24)
  s_barrier
  ds_read_b128 a[0:3], v12 offset:49152
  v_mfma_f32_16x16x32_bf16 v[80:83], a[32:35], a[4:7], v[80:83]
  s_add_u32 m0, s40, 32768
  ds_read_b64_tr_b16 a[48:49], v14 offset:49152
  v_mfma_f32_16x16x32_bf16 v[84:87], a[36:39], a[4:7], v[84:87]
  buffer_load_dwordx4 v4, s[8:11], s32 offen offset:0 sc1 lds
  v_mfma_f32_16x16x32_bf16 v[88:91], a[40:43], a[4:7], v[88:91]
  buffer_load_dwordx4 v5, s[8:11], s32 offen offset:1024 sc1 lds
  s_add_u32 s32, s32, s33
  v_mfma_f32_16x16x32_bf16 v[92:95], a[44:47], a[4:7], v[92:95]
  ds_read_b128 a[4:7], v12 offset:50176
  v_mfma_f32_16x16x32_bf16 v[96:99], a[32:35], a[8:11], v[96:99]
  s_add_u32 m0, s41, 32768
  ds_read_b64_tr_b16 a[50:51], v14 offset:51200
  v_mfma_f32_16x16x32_bf16 v[100:103], a[36:39], a[8:11], v[100:103]
  buffer_load_dwordx4 v8, s[12:15], s34 offen offset:0 lds
  v_mfma_f32_16x16x32_bf16 v[104:107], a[40:43], a[8:11], v[104:107]
  buffer_load_dwordx4 v9, s[12:15], s34 offen offset:1024 lds
  s_add_u32 s34, s34, s35
  v_mfma_f32_16x16x32_bf16 v[108:111], a[44:47], a[8:11], v[108:111]
  ds_read_b128 a[8:11], v12 offset:51200
  v_mfma_f32_16x16x32_bf16 v[112:115], a[32:35], a[12:15], v[112:115]
  ds_read_b64_tr_b16 a[52:53], v15 offset:49152
  v_mfma_f32_16x16x32_bf16 v[116:119], a[36:39], a[12:15], v[116:119]
  ds_read_b64_tr_b16 a[54:55], v15 offset:51200
  v_mfma_f32_16x16x32_bf16 v[120:123], a[40:43], a[12:15], v[120:123]
  ds_read_b64_tr_b16 a[56:57], v16 offset:49152
  v_mfma_f32_16x16x32_bf16 v[124:127], a[44:47], a[12:15], v[124:127]
  ds_read_b128 a[12:15], v12 offset:52224
  v_mfma_f32_16x16x32_bf16 v[128:131], a[32:35], a[16:19], v[128:131]
  ds_read_b64_tr_b16 a[58:59], v16 offset:51200
  v_mfma_f32_16x16x32_bf16 v[132:135], a[36:39], a[16:19], v[132:135]
  ds_read_b64_tr_b16 a[60:61], v17 offset:49152
  v_mfma_f32_16x16x32_bf16 v[136:139], a[40:43], a[16:19], v[136:139]
  ds_read_b64_tr_b16 a[62:63], v17 offset:51200
  v_mfma_f32_16x16x32_bf16 v[140:143], a[44:47], a[16:19], v[140:143]
  ds_read_b128 a[16:19], v12 offset:53248
  v_mfma_f32_16x16x32_bf16 v[144:147], a[32:35], a[20:23], v[144:147]
  v_mfma_f32_16x16x32_bf16 v[148:151], a[36:39], a[20:23], v[148:151]
  v_mfma_f32_16x16x32_bf16 v[152:155], a[40:43], a[20:23], v[152:155]
  v_mfma_f32_16x16x32_bf16 v[156:159], a[44:47], a[20:23], v[156:159]
  ds_read_b128 a[20:23], v12 offset:54272
  v_mfma_f32_16x16x32_bf16 v[160:163], a[32:35], a[24:27], v[160:163]
  v_mfma_f32_16x16x32_bf16 v[164:167], a[36:39], a[24:27], v[164:167]
  v_mfma_f32_16x16x32_bf16 v[168:171], a[40:43], a[24:27], v[168:171]
  v_mfma_f32_16x16x32_bf16 v[172:175], a[44:47], a[24:27], v[172:175]
  ds_read_b128 a[24:27], v12 offset:55296
  v_mfma_f32_16x16x32_bf16 v[176:179], a[32:35], a[28:31], v[176:179]
  v_mfma_f32_16x16x32_bf16 v[180:183], a[36:39], a[28:31], v[180:183]
  v_mfma_f32_16x16x32_bf16 v[184:187], a[40:43], a[28:31], v[184:187]
  v_mfma_f32_16x16x32_bf16 v[188:191], a[44:47], a[28:31], v[188:191]
  ds_read_b128 a[28:31], v12 offset:56320
  s_waitcnt lgkmcnt(4)
  v_mfma_f32_16x16x32_bf16 v[64:67], a[48:51], a[0:3], v[64:67]
  v_mfma_f32_16x16x32_bf16 v[68:71], a[52:55], a[0:3], v[68:71]
  v_mfma_f32_16x16x32_bf16 v[72:75], a[56:59], a[0:3], v[72:75]
  v_mfma_f32_16x16x32_bf16 v[76:79], a[60:63], a[0:3], v[76:79]
  s_waitcnt lgkmcnt(0)
  s_waitcnt vmcnt(8)
  s_barrier
  s_cmp_eq_u32 s28, 0
  s_cbranch_scc1 L_sig_29
L_sigb_30:
  ds_read_b128 a[0:3], v12 offset:0
  v_mfma_f32_16x16x32_bf16 v[80:83], a[48:51], a[4:7], v[80:83]
  s_add_u32 m0, s40, 49152
  ds_read_b64_tr_b16 a[32:33], v14 offset:0
  v_mfma_f32_16x16x32_bf16 v[84:87], a[52:55], a[4:7], v[84:87]
  buffer_load_dwordx4 v4, s[8:11], s32 offen offset:0 sc1 lds
  v_mfma_f32_16x16x32_bf16 v[88:91], a[56:59], a[4:7], v[88:91]
  buffer_load_dwordx4 v5, s[8:11], s32 offen offset:1024 sc1 lds
  s_add_u32 s32, s32, s33
  v_mfma_f32_16x16x32_bf16 v[92:95], a[60:63], a[4:7], v[92:95]
  ds_read_b128 a[4:7], v12 offset:1024
  v_mfma_f32_16x16x32_bf16 v[96:99], a[48:51], a[8:11], v[96:99]
  s_add_u32 m0, s41, 49152
  ds_read_b64_tr_b16 a[34:35], v14 offset:2048
  v_mfma_f32_16x16x32_bf16 v[100:103], a[52:55], a[8:11], v[100:103]
  buffer_load_dwordx4 v8, s[12:15], s34 offen offset:0 lds
  v_mfma_f32_16x16x32_bf16 v[104:107], a[56:59], a[8:11], v[104:107]
  buffer_load_dwordx4 v9, s[12:15], s34 offen offset:1024 lds
  s_add_u32 s34, s34, s35
  v_mfma_f32_16x16x32_bf16 v[108:111], a[60:63], a[8:11], v[108:111]
  ds_read_b128 a[8:11], v12 offset:2048
  v_mfma_f32_16x16x32_bf16 v[112:115], a[48:51], a[12:15], v[112:115]
  ds_read_b64_tr_b16 a[36:37], v15 offset:0
  v_mfma_f32_16x16x32_bf16 v[116:119], a[52:55], a[12:15], v[116:119]
  ds_read_b64_tr_b16 a[38:39], v15 offset:2048
  v_mfma_f32_16x16x32_bf16 v[120:123], a[56:59], a[12:15], v[120:123]
  ds_read_b64_tr_b16 a[40:41], v16 offset:0
  v_mfma_f32_16x16x32_bf16 v[124:127], a[60:63], a[12:15], v[124:127]
  ds_read_b128 a[12:15], v12 offset:3072
  v_mfma_f32_16x16x32_bf16 v[128:131], a[48:51], a[16:19], v[128:131]
  ds_read_b64_tr_b16 a[42:43], v16 offset:2048
  v_mfma_f32_16x16x32_bf16 v[132:135], a[52:55], a[16:19], v[132:135]
  ds_read_b64_tr_b16 a[44:45], v17 offset:0
  v_mfma_f32_16x16x32_bf16 v[136:139], a[56:59], a[16:19], v[136:139]
  ds_read_b64_tr_b16 a[46:47], v17 offset:2048
  v_mfma_f32_16x16x32_bf16 v[140:143], a[60:63], a[16:19], v[140:143]
  ds_read_b128 a[16:19], v12 offset:4096
  v_mfma_f32_16x16x32_bf16 v[144:147], a[48:51], a[20:23], v[144:147]
  v_mfma_f32_16x16x32_bf16 v[148:151], a[52:55], a[20:23], v[148:151]
  v_mfma_f32_16x16x32_bf16 v[152:155], a[56:59], a[20:23], v[152:155]
  v_mfma_f32_16x16x32_bf16 v[156:159], a[60:63], a[20:23], v[156:159]
  ds_read_b128 a[20:23], v12 offset:5120
  v_mfma_f32_16x16x32_bf16 v[160:163], a[48:51], a[24:27], v[160:163]
  v_mfma_f32_16x16x32_bf16 v[164:167], a[52:55], a[24:27], v[164:167]
  v_mfma_f32_16x16x32_bf16 v[168:171], a[56:59], a[24:27], v[168:171]
  v_mfma_f32_16x16x32_bf16 v[172:175], a[60:63], a[24:27], v[172:175]
  ds_read_b128 a[24:27], v12 offset:6144
  v_mfma_f32_16x16x32_bf16 v[176:179], a[48:51], a[28:31], v[176:179]
  v_mfma_f32_16x16x32_bf16 v[180:183], a[52:55], a[28:31], v[180:183]
  v_mfma_f32_16x16x32_bf16 v[184:187], a[56:59], a[28:31], v[184:187]
  v_mfma_f32_16x16x32_bf16 v[188:191], a[60:63], a[28:31], v[188:191]
  ds_read_b128 a[28:31], v12 offset:7168
  s_sub_u32 s36, s36, 1
  s_branch L_loop_big_fn_kq
L_sig_29:
  s_lshr_b32 s42, s27, 8
  s_lshl_b32 s42, s42, 7
  s_add_u32 s42, s42, 0x5c14000
  s_add_u32 s42, s42, s59
  s_and_b32 s43, s27, 0xff
  v_mov_b32 v2, s42
  v_mov_b32 v3, s43
  v_mov_b32 v20, 0x80000000
  v_cmp_eq_u32 vcc, 0, v1
  s_nop 1
  v_cndmask_b32 v2, v20, v2, vcc
  buffer_atomic_add v3, v2, s[4:7], 0 offen
  s_branch L_sigb_30
L_body_big_fn_v:
  s_lshr_b32 s42, s28, 2
  s_and_b32 s43, s28, 3
  s_mul_i32 s40, s28, 2048
  s_mul_i32 s41, s28, 2048
  s_add_u32 s41, s41, 65536
  v_lshlrev_b32 v18, 4, v1
  s_mul_i32 s44, s42, 8192
  v_lshrrev_b32 v22, 4, v1
  v_and_b32 v23, 15, v1
  v_add_u32 v12, s44, v18
  s_mul_i32 s44, s28, 2
  s_add_u32 s44, s44, 0
  s_mul_i32 s44, s44, s45
  v_add_u32 v4, s44, v18
  s_mul_i32 s44, s28, 2
  s_add_u32 s44, s44, 1
  s_mul_i32 s44, s44, s45
  s_sub_u32 s44, s44, 1024
  v_add_u32 v5, s44, v18
  v_lshrrev_b32 v23, 5, v1
  v_and_b32 v24, 31, v1
  s_mul_i32 s44, s28, 4
  s_add_u32 s44, s44, 0
  v_add_u32 v20, s44, v23
  v_and_b32 v21, 3, v20
  v_bfe_u32 v22, v20, 3, 1
  v_lshl_or_b32 v21, v22, 2, v21
  v_lshlrev_b32 v21, 1, v21
  v_xor_b32 v21, v21, v24
  v_mul_lo_u32 v20, v20, s39
  v_lshl_add_u32 v8, v21, 4, v20
  s_mul_i32 s44, s28, 4
  s_add_u32 s44, s44, 2
  v_add_u32 v20, s44, v23
  v_and_b32 v21, 3, v20
  v_bfe_u32 v22, v20, 3, 1
  v_lshl_or_b32 v21, v22, 2, v21
  v_lshlrev_b32 v21, 1, v21
  v_xor_b32 v21, v21, v24
  v_mul_lo_u32 v20, v20, s39
  v_lshl_add_u32 v9, v21, 4, v20
  v_subrev_u32 v9, 1024, v9
  v_bfe_u32 v20, v1, 2, 2
  v_lshrrev_b32 v21, 4, v1
  v_lshl_add_u32 v22, v21, 3, v20
  v_mul_u32_u24 v22, 512, v22
  v_and_b32 v23, 3, v1
  v_lshl_add_u32 v22, v23, 3, v22
  v_add_u32 v22, 65536, v22
  v_and_b32 v21, 1, v21
  v_lshl_or_b32 v20, v21, 2, v20
  s_mul_i32 s44, s43, 4
  s_add_u32 s44, s44, 0
  v_xor_b32 v21, s44, v20
  v_lshl_add_u32 v14, v21, 5, v22
  s_mul_i32 s44, s43, 4
  s_add_u32 s44, s44, 1
  v_xor_b32 v21, s44, v20
  v_lshl_add_u32 v15, v21, 5, v22
  s_mul_i32 s44, s43, 4
  s_add_u32 s44, s44, 2
  v_xor_b32 v21, s44, v20
  v_lshl_add_u32 v16, v21, 5, v22
  s_mul_i32 s44, s43, 4
  s_add_u32 s44, s44, 3
  v_xor_b32 v21, s44, v20
  v_lshl_add_u32 v17, v21, 5, v22
  s_mov_b32 s29, 0
  s_add_u32 m0, s40, 0
  s_nop 0
  buffer_load_dwordx4 v4, s[8:11], s32 offen offset:0 sc1 lds
  buffer_load_dwordx4 v5, s[8:11], s32 offen offset:1024 sc1 lds
  s_add_u32 s32, s32, s33
  s_add_u32 m0, s41, 0
  s_nop 0
  buffer_load_dwordx4 v8, s[12:15], s34 offen offset:0 lds
  buffer_load_dwordx4 v9, s[12:15], s34 offen offset:1024 lds
  s_add_u32 s34, s34, s35
  s_add_u32 m0, s40, 16384
  s_nop 0
  buffer_load_dwordx4 v4, s[8:11], s32 offen offset:0 sc1 lds
  buffer_load_dwordx4 v5, s[8:11], s32 offen offset:1024 sc1 lds
  s_add_u32 s32, s32, s33
  s_add_u32 m0, s41, 16384
  s_nop 0
  buffer_load_dwordx4 v8, s[12:15], s34 offen offset:0 lds
  buffer_load_dwordx4 v9, s[12:15], s34 offen offset:1024 lds
  s_add_u32 s34, s34, s35
  s_add_u32 m0, s40, 32768
  s_nop 0
  buffer_load_dwordx4 v4, s[8:11], s32 offen offset:0 sc1 lds
  buffer_load_dwordx4 v5, s[8:11], s32 offen offset:1024 sc1 lds
  s_add_u32 s32, s32, s33
  s_add_u32 m0, s41, 32768
  s_nop 0
  buffer_load_dwordx4 v8, s[12:15], s34 offen offset:0 lds
  buffer_load_dwordx4 v9, s[12:15], s34 offen offset:1024 lds
  s_add_u32 s34, s34, s35
  s_add_u32 m0, s40, 49152
  s_nop 0
  buffer_load_dwordx4 v4, s[8:11], s32 offen offset:0 sc1 lds
  buffer_load_dwordx4 v5, s[8:11], s32 offen offset:1024 sc1 lds
  s_add_u32 s32, s32, s33
  s_add_u32 m0, s41, 49152
  s_nop 0
  buffer_load_dwordx4 v8, s[12:15], s34 offen offset:0 lds
  buffer_load_dwordx4 v9, s[12:15], s34 offen offset:1024 lds
  s_add_u32 s34, s34, s35
  v_mov_b32 v64, 0
  v_mov_b32 v65, 0
  v_mov_b32 v66, 0
  v_mov_b32 v67, 0
  v_mov_b32 v68, 0
  v_mov_b32 v69, 0
  v_mov_b32 v70, 0
  v_mov_b32 v71, 0
  v_mov_b32 v72, 0
  v_mov_b32 v73, 0
  v_mov_b32 v74, 0
  v_mov_b32 v75, 0
  v_mov_b32 v76, 0
  v_mov_b32 v77, 0
  v_mov_b32 v78, 0
  v_mov_b32 v79, 0
  v_mov_b32 v80, 0
  v_mov_b32 v81, 0
  v_mov_b32 v82, 0
  v_mov_b32 v83, 0
  v_mov_b32 v84, 0
  v_mov_b32 v85, 0
  v_mov_b32 v86, 0
  v_mov_b32 v87, 0
  v_mov_b32 v88, 0
  v_mov_b32 v89, 0
  v_mov_b32 v90, 0
  v_mov_b32 v91, 0
  v_mov_b32 v92, 0
  v_mov_b32 v93, 0
  v_mov_b32 v94, 0
  v_mov_b32 v95, 0
  v_mov_b32 v96, 0
  v_mov_b32 v97, 0
  v_mov_b32 v98, 0
  v_mov_b32 v99, 0
  v_mov_b32 v100, 0
  v_mov_b32 v101, 0
  v_mov_b32 v102, 0
  v_mov_b32 v103, 0
  v_mov_b32 v104, 0
  v_mov_b32 v105, 0
  v_mov_b32 v106, 0
  v_mov_b32 v107, 0
  v_mov_b32 v108, 0
  v_mov_b32 v109, 0
  v_mov_b32 v110, 0
  v_mov_b32 v111, 0
  v_mov_b32 v112, 0
  v_mov_b32 v113, 0
  v_mov_b32 v114, 0
  v_mov_b32 v115, 0
  v_mov_b32 v116, 0
  v_mov_b32 v117, 0
  v_mov_b32 v118, 0
  v_mov_b32 v119, 0
  v_mov_b32 v120, 0
  v_mov_b32 v121, 0
  v_mov_b32 v122, 0
  v_mov_b32 v123, 0
  v_mov_b32 v124, 0
  v_mov_b32 v125, 0
  v_mov_b32 v126, 0
  v_mov_b32 v127, 0
  v_mov_b32 v128, 0
  v_mov_b32 v129, 0
  v_mov_b32 v130, 0
  v_mov_b32 v131, 0
  v_mov_b32 v132, 0
  v_mov_b32 v133, 0
  v_mov_b32 v134, 0
  v_mov_b32 v135, 0
  v_mov_b32 v136, 0
  v_mov_b32 v137, 0
  v_mov_b32 v138, 0
  v_mov_b32 v139, 0
  v_mov_b32 v140, 0
  v_mov_b32 v141, 0
  v_mov_b32 v142, 0
  v_mov_b32 v143, 0
  v_mov_b32 v144, 0
  v_mov_b32 v145, 0
  v_mov_b32 v146, 0
  v_mov_b32 v147, 0
  v_mov_b32 v148, 0
  v_mov_b32 v149, 0
  v_mov_b32 v150, 0
  v_mov_b32 v151, 0
  v_mov_b32 v152, 0
  v_mov_b32 v153, 0
  v_mov_b32 v154, 0
  v_mov_b32 v155, 0
  v_mov_b32 v156, 0
  v_mov_b32 v157, 0
  v_mov_b32 v158, 0
  v_mov_b32 v159, 0
  v_mov_b32 v160, 0
  v_mov_b32 v161, 0
  v_mov_b32 v162, 0
  v_mov_b32 v163, 0
  v_mov_b32 v164, 0
  v_mov_b32 v165, 0
  v_mov_b32 v166, 0
  v_mov_b32 v167, 0
  v_mov_b32 v168, 0
  v_mov_b32 v169, 0
  v_mov_b32 v170, 0
  v_mov_b32 v171, 0
  v_mov_b32 v172, 0
  v_mov_b32 v173, 0
  v_mov_b32 v174, 0
  v_mov_b32 v175, 0
  v_mov_b32 v176, 0
  v_mov_b32 v177, 0
  v_mov_b32 v178, 0
  v_mov_b32 v179, 0
  v_mov_b32 v180, 0
  v_mov_b32 v181, 0
  v_mov_b32 v182, 0
  v_mov_b32 v183, 0
  v_mov_b32 v184, 0
  v_mov_b32 v185, 0
  v_mov_b32 v186, 0
  v_mov_b32 v187, 0
  v_mov_b32 v188, 0
  v_mov_b32 v189, 0
  v_mov_b32 v190, 0
  v_mov_b32 v191, 0
  s_waitcnt vmcnt(12)
  s_barrier
  ds_read_b64_tr_b16 a[32:33], v14 offset:0
  ds_read_b64_tr_b16 a[34:35], v14 offset:2048
  ds_read_b64_tr_b16 a[36:37], v15 offset:0
  ds_read_b64_tr_b16 a[38:39], v15 offset:2048
  ds_read_b64_tr_b16 a[40:41], v16 offset:0
  ds_read_b64_tr_b16 a[42:43], v16 offset:2048
  ds_read_b64_tr_b16 a[44:45], v17 offset:0
  ds_read_b64_tr_b16 a[46:47], v17 offset:2048
  ds_read_b128 a[0:3], v12 offset:0
  ds_read_b128 a[4:7], v12 offset:1024
  ds_read_b128 a[8:11], v12 offset:2048
  ds_read_b128 a[12:15], v12 offset:3072
  ds_read_b128 a[16:19], v12 offset:4096
  ds_read_b128 a[20:23], v12 offset:5120
  ds_read_b128 a[24:27], v12 offset:6144
  ds_read_b128 a[28:31], v12 offset:7168
  s_waitcnt lgkmcnt(0)
L_loop_big_fn_v:
  s_waitcnt lgkmcnt(4)
  v_mfma_f32_16x16x32_bf16 v[64:67], a[0:3], a[32:35], v[64:67]
  v_mfma_f32_16x16x32_bf16 v[68:71], a[0:3], a[36:39], v[68:71]
  v_mfma_f32_16x16x32_bf16 v[72:75], a[0:3], a[40:43], v[72:75]
  v_mfma_f32_16x16x32_bf16 v[76:79], a[0:3], a[44:47], v[76:79]
  s_waitcnt lgkmcnt(0)
  s_waitcnt vmcnt(8)
  s_barrier
  ds_read_b128 a[0:3], v12 offset:16384
  v_mfma_f32_16x16x32_bf16 v[80:83], a[4:7], a[32:35], v[80:83]
  s_add_u32 m0, s40, 0
  ds_read_b64_tr_b16 a[48:49], v14 offset:16384
  v_mfma_f32_16x16x32_bf16 v[84:87], a[4:7], a[36:39], v[84:87]
  buffer_load_dwordx4 v4, s[8:11], s32 offen offset:0 sc1 lds
  v_mfma_f32_16x16x32_bf16 v[88:91], a[4:7], a[40:43], v[88:91]
  buffer_load_dwordx4 v5, s[8:11], s32 offen offset:1024 sc1 lds
  s_add_u32 s32, s32, s33
  v_mfma_f32_16x16x32_bf16 v[92:95], a[4:7], a[44:47], v[92:95]
  ds_read_b128 a[4:7], v12 offset:17408
  v_mfma_f32_16x16x32_bf16 v[96:99], a[8:11], a[32:35], v[96:99]
  s_add_u32 m0, s41, 0
  ds_read_b64_tr_b16 a[50:51], v14 offset:18432
  v_mfma_f32_16x16x32_bf16 v[100:103], a[8:11], a[36:39], v[100:103]
  buffer_load_dwordx4 v8, s[12:15], s34 offen offset:0 lds
  v_mfma_f32_16x16x32_bf16 v[104:107], a[8:11], a[40:43], v[104:107]
  buffer_load_dwordx4 v9, s[12:15], s34 offen offset:1024 lds
  s_add_u32 s34, s34, s35
  v_mfma_f32_16x16x32_bf16 v[108:111], a[8:11], a[44:47], v[108:111]
  ds_read_b128 a[8:11], v12 offset:18432
  v_mfma_f32_16x16x32_bf16 v[112:115], a[12:15], a[32:35], v[112:115]
  ds_read_b64_tr_b16 a[52:53], v15 offset:16384
  v_mfma_f32_16x16x32_bf16 v[116:119], a[12:15], a[36:39], v[116:119]
  ds_read_b64_tr_b16 a[54:55], v15 offset:18432
  v_mfma_f32_16x16x32_bf16 v[120:123], a[12:15], a[40:43], v[120:123]
  ds_read_b64_tr_b16 a[56:57], v16 offset:16384
  v_mfma_f32_16x16x32_bf16 v[124:127], a[12:15], a[44:47], v[124:127]
  ds_read_b128 a[12:15], v12 offset:19456
  v_mfma_f32_16x16x32_bf16 v[128:131], a[16:19], a[32:35], v[128:131]
  ds_read_b64_tr_b16 a[58:59], v16 offset:18432
  v_mfma_f32_16x16x32_bf16 v[132:135], a[16:19], a[36:39], v[132:135]
  ds_read_b64_tr_b16 a[60:61], v17 offset:16384
  v_mfma_f32_16x16x32_bf16 v[136:139], a[16:19], a[40:43], v[136:139]
  ds_read_b64_tr_b16 a[62:63], v17 offset:18432
  v_mfma_f32_16x16x32_bf16 v[140:143], a[16:19], a[44:47], v[140:143]
  ds_read_b128 a[16:19], v12 offset:20480
  v_mfma_f32_16x16x32_bf16 v[144:147], a[20:23], a[32:35], v[144:147]
  v_mfma_f32_16x16x32_bf16 v[148:151], a[20:23], a[36:39], v[148:151]
  v_mfma_f32_16x16x32_bf16 v[152:155], a[20:23], a[40:43], v[152:155]
  v_mfma_f32_16x16x32_bf16 v[156:159], a[20:23], a[44:47], v[156:159]
  ds_read_b128 a[20:23], v12 offset:21504
  v_mfma_f32_16x16x32_bf16 v[160:163], a[24:27], a[32:35], v[160:163]
  v_mfma_f32_16x16x32_bf16 v[164:167], a[24:27], a[36:39], v[164:167]
  v_mfma_f32_16x16x32_bf16 v[168:171], a[24:27], a[40:43], v[168:171]
  v_mfma_f32_16x16x32_bf16 v[172:175], a[24:27], a[44:47], v[172:175]
  ds_read_b128 a[24:27], v12 offset:22528
  v_mfma_f32_16x16x32_bf16 v[176:179], a[28:31], a[32:35], v[176:179]
  v_mfma_f32_16x16x32_bf16 v[180:183], a[28:31], a[36:39], v[180:183]
  v_mfma_f32_16x16x32_bf16 v[184:187], a[28:31], a[40:43], v[184:187]
  v_mfma_f32_16x16x32_bf16 v[188:191], a[28:31], a[44:47], v[188:191]
  ds_read_b128 a[28:31], v12 offset:23552
  s_waitcnt lgkmcnt(4)
  v_mfma_f32_16x16x32_bf16 v[64:67], a[0:3], a[48:51], v[64:67]
  v_mfma_f32_16x16x32_bf16 v[68:71], a[0:3], a[52:55], v[68:71]
  v_mfma_f32_16x16x32_bf16 v[72:75], a[0:3], a[56:59], v[72:75]
  v_mfma_f32_16x16x32_bf16 v[76:79], a[0:3], a[60:63], v[76:79]
  s_waitcnt lgkmcnt(0)
  s_waitcnt vmcnt(8)
  s_barrier
  ds_read_b128 a[0:3], v12 offset:32768
  v_mfma_f32_16x16x32_bf16 v[80:83], a[4:7], a[48:51], v[80:83]
  s_add_u32 m0, s40, 16384
  ds_read_b64_tr_b16 a[32:33], v14 offset:32768
  v_mfma_f32_16x16x32_bf16 v[84:87], a[4:7], a[52:55], v[84:87]
  buffer_load_dwordx4 v4, s[8:11], s32 offen offset:0 sc1 lds
  v_mfma_f32_16x16x32_bf16 v[88:91], a[4:7], a[56:59], v[88:91]
  buffer_load_dwordx4 v5, s[8:11], s32 offen offset:1024 sc1 lds
  s_add_u32 s32, s32, s33
  v_mfma_f32_16x16x32_bf16 v[92:95], a[4:7], a[60:63], v[92:95]
  ds_read_b128 a[4:7], v12 offset:33792
  v_mfma_f32_16x16x32_bf16 v[96:99], a[8:11], a[48:51], v[96:99]
  s_add_u32 m0, s41, 16384
  ds_read_b64_tr_b16 a[34:35], v14 offset:34816
  v_mfma_f32_16x16x32_bf16 v[100:103], a[8:11], a[52:55], v[100:103]
  buffer_load_dwordx4 v8, s[12:15], s34 offen offset:0 lds
  v_mfma_f32_16x16x32_bf16 v[104:107], a[8:11], a[56:59], v[104:107]
  buffer_load_dwordx4 v9, s[12:15], s34 offen offset:1024 lds
  s_add_u32 s34, s34, s35
  v_mfma_f32_16x16x32_bf16 v[108:111], a[8:11], a[60:63], v[108:111]
  ds_read_b128 a[8:11], v12 offset:34816
  v_mfma_f32_16x16x32_bf16 v[112:115], a[12:15], a[48:51], v[112:115]
  ds_read_b64_tr_b16 a[36:37], v15 offset:32768
  v_mfma_f32_16x16x32_bf16 v[116:119], a[12:15], a[52:55], v[116:119]
  ds_read_b64_tr_b16 a[38:39], v15 offset:34816
  v_mfma_f32_16x16x32_bf16 v[120:123], a[12:15], a[56:59], v[120:123]
  ds_read_b64_tr_b16 a[40:41], v16 offset:32768
  v_mfma_f32_16x16x32_bf16 v[124:127], a[12:15], a[60:63], v[124:127]
  ds_read_b128 a[12:15], v12 offset:35840
  v_mfma_f32_16x16x32_bf16 v[128:131], a[16:19], a[48:51], v[128:131]
  ds_read_b64_tr_b16 a[42:43], v16 offset:34816
  v_mfma_f32_16x16x32_bf16 v[132:135], a[16:19], a[52:55], v[132:135]
  ds_read_b64_tr_b16 a[44:45], v17 offset:32768
  v_mfma_f32_16x16x32_bf16 v[136:139], a[16:19], a[56:59], v[136:139]
  ds_read_b64_tr_b16 a[46:47], v17 offset:34816
  v_mfma_f32_16x16x32_bf16 v[140:143], a[16:19], a[60:63], v[140:143]
  ds_read_b128 a[16:19], v12 offset:36864
  v_mfma_f32_16x16x32_bf16 v[144:147], a[20:23], a[48:51], v[144:147]
  v_mfma_f32_16x16x32_bf16 v[148:151], a[20:23], a[52:55], v[148:151]
  v_mfma_f32_16x16x32_bf16 v[152:155], a[20:23], a[56:59], v[152:155]
  v_mfma_f32_16x16x32_bf16 v[156:159], a[20:23], a[60:63], v[156:159]
  ds_read_b128 a[20:23], v12 offset:37888
  v_mfma_f32_16x16x32_bf16 v[160:163], a[24:27], a[48:51], v[160:163]
  v_mfma_f32_16x16x32_bf16 v[164:167], a[24:27], a[52:55], v[164:167]
  v_mfma_f32_16x16x32_bf16 v[168:171], a[24:27], a[56:59], v[168:171]
  v_mfma_f32_16x16x32_bf16 v[172:175], a[24:27], a[60:63], v[172:175]
  ds_read_b128 a[24:27], v12 offset:38912
  v_mfma_f32_16x16x32_bf16 v[176:179], a[28:31], a[48:51], v[176:179]
  v_mfma_f32_16x16x32_bf16 v[180:183], a[28:31], a[52:55], v[180:183]
  v_mfma_f32_16x16x32_bf16 v[184:187], a[28:31], a[56:59], v[184:187]
  v_mfma_f32_16x16x32_bf16 v[188:191], a[28:31], a[60:63], v[188:191]
  ds_read_b128 a[28:31], v12 offset:39936
  s_waitcnt lgkmcnt(4)
  v_mfma_f32_16x16x32_bf16 v[64:67], a[0:3], a[32:35], v[64:67]
  v_mfma_f32_16x16x32_bf16 v[68:71], a[0:3], a[36:39], v[68:71]
  v_mfma_f32_16x16x32_bf16 v[72:75], a[0:3], a[40:43], v[72:75]
  v_mfma_f32_16x16x32_bf16 v[76:79], a[0:3], a[44:47], v[76:79]
  s_waitcnt lgkmcnt(0)
  s_waitcnt vmcnt(8)
  s_barrier
  ds_read_b128 a[0:3], v12 offset:49152
  v_mfma_f32_16x16x32_bf16 v[80:83], a[4:7], a[32:35], v[80:83]
  s_add_u32 m0, s40, 32768
  ds_read_b64_tr_b16 a[48:49], v14 offset:49152
  v_mfma_f32_16x16x32_bf16 v[84:87], a[4:7], a[36:39], v[84:87]
  buffer_load_dwordx4 v4, s[8:11], s32 offen offset:0 sc1 lds
  v_mfma_f32_16x16x32_bf16 v[88:91], a[4:7], a[40:43], v[88:91]
  buffer_load_dwordx4 v5, s[8:11], s32 offen offset:1024 sc1 lds
  s_add_u32 s32, s32, s33
  v_mfma_f32_16x16x32_bf16 v[92:95], a[4:7], a[44:47], v[92:95]
  ds_read_b128 a[4:7], v12 offset:50176
  v_mfma_f32_16x16x32_bf16 v[96:99], a[8:11], a[32:35], v[96:99]
  s_add_u32 m0, s41, 32768
  ds_read_b64_tr_b16 a[50:51], v14 offset:51200
  v_mfma_f32_16x16x32_bf16 v[100:103], a[8:11], a[36:39], v[100:103]
  buffer_load_dwordx4 v8, s[12:15], s34 offen offset:0 lds
  v_mfma_f32_16x16x32_bf16 v[104:107], a[8:11], a[40:43], v[104:107]
  buffer_load_dwordx4 v9, s[12:15], s34 offen offset:1024 lds
  s_add_u32 s34, s34, s35
  v_mfma_f32_16x16x32_bf16 v[108:111], a[8:11], a[44:47], v[108:111]
  ds_read_b128 a[8:11], v12 offset:51200
  v_mfma_f32_16x16x32_bf16 v[112:115], a[12:15], a[32:35], v[112:115]
  ds_read_b64_tr_b16 a[52:53], v15 offset:49152
  v_mfma_f32_16x16x32_bf16 v[116:119], a[12:15], a[36:39], v[116:119]
  ds_read_b64_tr_b16 a[54:55], v15 offset:51200
  v_mfma_f32_16x16x32_bf16 v[120:123], a[12:15], a[40:43], v[120:123]
  ds_read_b64_tr_b16 a[56:57], v16 offset:49152
  v_mfma_f32_16x16x32_bf16 v[124:127], a[12:15], a[44:47], v[124:127]
  ds_read_b128 a[12:15], v12 offset:52224
  v_mfma_f32_16x16x32_bf16 v[128:131], a[16:19], a[32:35], v[128:131]
  ds_read_b64_tr_b16 a[58:59], v16 offset:51200
  v_mfma_f32_16x16x32_bf16 v[132:135], a[16:19], a[36:39], v[132:135]
  ds_read_b64_tr_b16 a[60:61], v17 offset:49152
  v_mfma_f32_16x16x32_bf16 v[136:139], a[16:19], a[40:43], v[136:139]
  ds_read_b64_tr_b16 a[62:63], v17 offset:51200
  v_mfma_f32_16x16x32_bf16 v[140:143], a[16:19], a[44:47], v[140:143]
  ds_read_b128 a[16:19], v12 offset:53248
  v_mfma_f32_16x16x32_bf16 v[144:147], a[20:23], a[32:35], v[144:147]
  v_mfma_f32_16x16x32_bf16 v[148:151], a[20:23], a[36:39], v[148:151]
  v_mfma_f32_16x16x32_bf16 v[152:155], a[20:23], a[40:43], v[152:155]
  v_mfma_f32_16x16x32_bf16 v[156:159], a[20:23], a[44:47], v[156:159]
  ds_read_b128 a[20:23], v12 offset:54272
  v_mfma_f32_16x16x32_bf16 v[160:163], a[24:27], a[32:35], v[160:163]
  v_mfma_f32_16x16x32_bf16 v[164:167], a[24:27], a[36:39], v[164:167]
  v_mfma_f32_16x16x32_bf16 v[168:171], a[24:27], a[40:43], v[168:171]
  v_mfma_f32_16x16x32_bf16 v[172:175], a[24:27], a[44:47], v[172:175]
  ds_read_b128 a[24:27], v12 offset:55296
  v_mfma_f32_16x16x32_bf16 v[176:179], a[28:31], a[32:35], v[176:179]
  v_mfma_f32_16x16x32_bf16 v[180:183], a[28:31], a[36:39], v[180:183]
  v_mfma_f32_16x16x32_bf16 v[184:187], a[28:31], a[40:43], v[184:187]
  v_mfma_f32_16x16x32_bf16 v[188:191], a[28:31], a[44:47], v[188:191]
  ds_read_b128 a[28:31], v12 offset:56320
  s_waitcnt lgkmcnt(4)
  v_mfma_f32_16x16x32_bf16 v[64:67], a[0:3], a[48:51], v[64:67]
  v_mfma_f32_16x16x32_bf16 v[68:71], a[0:3], a[52:55], v[68:71]
  v_mfma_f32_16x16x32_bf16 v[72:75], a[0:3], a[56:59], v[72:75]
  v_mfma_f32_16x16x32_bf16 v[76:79], a[0:3], a[60:63], v[76:79]
  s_waitcnt lgkmcnt(0)
  s_waitcnt vmcnt(8)
  s_barrier
  ds_read_b128 a[0:3], v12 offset:0
  v_mfma_f32_16x16x32_bf16 v[80:83], a[4:7], a[48:51], v[80:83]
  s_add_u32 m0, s40, 49152
  ds_read_b64_tr_b16 a[32:33], v14 offset:0
  v_mfma_f32_16x16x32_bf16 v[84:87], a[4:7], a[52:55], v[84:87]
  buffer_load_dwordx4 v4, s[8:11], s32 offen offset:0 sc1 lds
  v_mfma_f32_16x16x32_bf16 v[88:91], a[4:7], a[56:59], v[88:91]
  buffer_load_dwordx4 v5, s[8:11], s32 offen offset:1024 sc1 lds
  s_add_u32 s32, s32, s33
  v_mfma_f32_16x16x32_bf16 v[92:95], a[4:7], a[60:63], v[92:95]
  ds_read_b128 a[4:7], v12 offset:1024
  v_mfma_f32_16x16x32_bf16 v[96:99], a[8:11], a[48:51], v[96:99]
  s_add_u32 m0, s41, 49152
  ds_read_b64_tr_b16 a[34:35], v14 offset:2048
  v_mfma_f32_16x16x32_bf16 v[100:103], a[8:11], a[52:55], v[100:103]
  buffer_load_dwordx4 v8, s[12:15], s34 offen offset:0 lds
  v_mfma_f32_16x16x32_bf16 v[104:107], a[8:11], a[56:59], v[104:107]
  buffer_load_dwordx4 v9, s[12:15], s34 offen offset:1024 lds
  s_add_u32 s34, s34, s35
  v_mfma_f32_16x16x32_bf16 v[108:111], a[8:11], a[60:63], v[108:111]
  ds_read_b128 a[8:11], v12 offset:2048
  v_mfma_f32_16x16x32_bf16 v[112:115], a[12:15], a[48:51], v[112:115]
  ds_read_b64_tr_b16 a[36:37], v15 offset:0
  v_mfma_f32_16x16x32_bf16 v[116:119], a[12:15], a[52:55], v[116:119]
  ds_read_b64_tr_b16 a[38:39], v15 offset:2048
  v_mfma_f32_16x16x32_bf16 v[120:123], a[12:15], a[56:59], v[120:123]
  ds_read_b64_tr_b16 a[40:41], v16 offset:0
  v_mfma_f32_16x16x32_bf16 v[124:127], a[12:15], a[60:63], v[124:127]
  ds_read_b128 a[12:15], v12 offset:3072
  v_mfma_f32_16x16x32_bf16 v[128:131], a[16:19], a[48:51], v[128:131]
  ds_read_b64_tr_b16 a[42:43], v16 offset:2048
  v_mfma_f32_16x16x32_bf16 v[132:135], a[16:19], a[52:55], v[132:135]
  ds_read_b64_tr_b16 a[44:45], v17 offset:0
  v_mfma_f32_16x16x32_bf16 v[136:139], a[16:19], a[56:59], v[136:139]
  ds_read_b64_tr_b16 a[46:47], v17 offset:2048
  v_mfma_f32_16x16x32_bf16 v[140:143], a[16:19], a[60:63], v[140:143]
  ds_read_b128 a[16:19], v12 offset:4096
  v_mfma_f32_16x16x32_bf16 v[144:147], a[20:23], a[48:51], v[144:147]
  v_mfma_f32_16x16x32_bf16 v[148:151], a[20:23], a[52:55], v[148:151]
  v_mfma_f32_16x16x32_bf16 v[152:155], a[20:23], a[56:59], v[152:155]
  v_mfma_f32_16x16x32_bf16 v[156:159], a[20:23], a[60:63], v[156:159]
  ds_read_b128 a[20:23], v12 offset:5120
  v_mfma_f32_16x16x32_bf16 v[160:163], a[24:27], a[48:51], v[160:163]
  v_mfma_f32_16x16x32_bf16 v[164:167], a[24:27], a[52:55], v[164:167]
  v_mfma_f32_16x16x32_bf16 v[168:171], a[24:27], a[56:59], v[168:171]
  v_mfma_f32_16x16x32_bf16 v[172:175], a[24:27], a[60:63], v[172:175]
  ds_read_b128 a[24:27], v12 offset:6144
  v_mfma_f32_16x16x32_bf16 v[176:179], a[28:31], a[48:51], v[176:179]
  v_mfma_f32_16x16x32_bf16 v[180:183], a[28:31], a[52:55], v[180:183]
  v_mfma_f32_16x16x32_bf16 v[184:187], a[28:31], a[56:59], v[184:187]
  v_mfma_f32_16x16x32_bf16 v[188:191], a[28:31], a[60:63], v[188:191]
  ds_read_b128 a[28:31], v12 offset:7168
  s_sub_u32 s36, s36, 1
  s_cmp_lg_u32 s36, 0
  s_cbranch_scc1 L_loop_big_fn_v
  s_cmp_lg_u32 s29, 0
  s_cbranch_scc1 L_episel_32
  s_cmp_eq_u32 s75, 0
  s_cbranch_scc1 L_tail_33
  s_cmp_lg_u32 s88, 1
  s_cbranch_scc1 L_swn_35
  s_mov_b32 s12, s50
  s_mov_b32 s13, s51
  s_mov_b32 s14, 0x800000
  s_mov_b32 s15, 0x20000
  s_lshl_b32 s32, s89, 11
  s_add_u32 s32, s32, 0x7000000
  s_lshl_b32 s34, s90, 1
  s_mov_b32 s39, 8192
  s_mov_b32 s35, 262144
  s_mov_b32 s31, 131072
  s_mul_i32 s30, s89, 8192
  s_lshl_b32 s42, s90, 5
  s_add_u32 s30, s30, s42
  s_add_u32 s30, s30, 0x0
  s_branch L_sw_34
L_swn_35:
  s_cmp_lg_u32 s88, 3
  s_cbranch_scc1 L_swn_36
  s_mov_b32 s12, s52
  s_mov_b32 s13, s53
  s_mov_b32 s14, 0x800000
  s_mov_b32 s15, 0x20000
  s_lshl_b32 s32, s89, 11
  s_add_u32 s32, s32, 0x7000000
  s_lshl_b32 s34, s90, 1
  s_mov_b32 s39, 8192
  s_mov_b32 s35, 262144
  s_mov_b32 s31, 131072
  s_mul_i32 s30, s89, 8192
  s_lshl_b32 s42, s90, 5
  s_add_u32 s30, s30, s42
  s_add_u32 s30, s30, 0x2000000
  s_branch L_sw_34
L_swn_36:
  s_cmp_lg_u32 s88, 2
  s_cbranch_scc1 L_swn_37
  s_mov_b32 s12, s54
  s_mov_b32 s13, s55
  s_mov_b32 s14, 0x800000
  s_mov_b32 s15, 0x20000
  s_lshl_b32 s32, s89, 11
  s_add_u32 s32, s32, 0x7000000
  s_lshl_b32 s34, s90, 1
  s_mov_b32 s39, 8192
  s_mov_b32 s35, 262144
  s_mov_b32 s31, 262144
  s_lshl_b32 s30, s89, 13
  s_lshl_b32 s42, s90, 6
  s_add_u32 s30, s30, s42
  s_add_u32 s30, s30, 0x1000000
  s_branch L_sw_34
L_swn_37:
  s_cmp_lg_u32 s88, 4
  s_cbranch_scc1 L_swn_38
  s_mov_b32 s12, s56
  s_mov_b32 s13, s57
  s_mov_b32 s14, 0x700000
  s_mov_b32 s15, 0x20000
  s_lshl_b32 s32, s89, 11
  s_add_u32 s32, s32, 0x7000000
  s_lshl_b32 s34, s90, 1
  s_mov_b32 s39, 7168
  s_mov_b32 s35, 229376
  s_mov_b32 s31, 114688
  s_mul_i32 s30, s89, 7168
  s_lshl_b32 s42, s90, 5
  s_add_u32 s30, s30, s42
  s_add_u32 s30, s30, 0x3000000
  s_branch L_sw_34
L_swn_38:
  s_branch L_abort
L_sw_34:
  v_lshrrev_b32 v23, 5, v1
  v_and_b32 v24, 31, v1
  s_mul_i32 s44, s28, 4
  s_add_u32 s44, s44, 0
  v_add_u32 v20, s44, v23
  v_and_b32 v21, 3, v20
  v_bfe_u32 v22, v20, 3, 1
  v_lshl_or_b32 v21, v22, 2, v21
  v_lshlrev_b32 v21, 1, v21
  v_xor_b32 v21, v21, v24
  v_mul_lo_u32 v20, v20, s39
  v_lshl_add_u32 v8, v21, 4, v20
  s_mul_i32 s44, s28, 4
  s_add_u32 s44, s44, 2
  v_add_u32 v20, s44, v23
  v_and_b32 v21, 3, v20
  v_bfe_u32 v22, v20, 3, 1
  v_lshl_or_b32 v21, v22, 2, v21
  v_lshlrev_b32 v21, 1, v21
  v_xor_b32 v21, v21, v24
  v_mul_lo_u32 v20, v20, s39
  v_lshl_add_u32 v9, v21, 4, v20
  v_subrev_u32 v9, 1024, v9
  s_mov_b32 s29, 1
  s_mov_b32 s36, 1
  s_branch L_loop_big_fn_v
L_tail_33:
  s_waitcnt lgkmcnt(4)
  v_mfma_f32_16x16x32_bf16 v[64:67], a[0:3], a[32:35], v[64:67]
  v_mfma_f32_16x16x32_bf16 v[68:71], a[0:3], a[36:39], v[68:71]
  v_mfma_f32_16x16x32_bf16 v[72:75], a[0:3], a[40:43], v[72:75]
  v_mfma_f32_16x16x32_bf16 v[76:79], a[0:3], a[44:47], v[76:79]
  s_waitcnt lgkmcnt(0)
  s_waitcnt vmcnt(8)
  s_barrier
  ds_read_b128 a[0:3], v12 offset:16384
  v_mfma_f32_16x16x32_bf16 v[80:83], a[4:7], a[32:35], v[80:83]
  ds_read_b64_tr_b16 a[48:49], v14 offset:16384
  v_mfma_f32_16x16x32_bf16 v[84:87], a[4:7], a[36:39], v[84:87]
  ds_read_b64_tr_b16 a[50:51], v14 offset:18432
  v_mfma_f32_16x16x32_bf16 v[88:91], a[4:7], a[40:43], v[88:91]
  ds_read_b64_tr_b16 a[52:53], v15 offset:16384
  v_mfma_f32_16x16x32_bf16 v[92:95], a[4:7], a[44:47], v[92:95]
  ds_read_b128 a[4:7], v12 offset:17408
  v_mfma_f32_16x16x32_bf16 v[96:99], a[8:11], a[32:35], v[96:99]
  ds_read_b64_tr_b16 a[54:55], v15 offset:18432
  v_mfma_f32_16x16x32_bf16 v[100:103], a[8:11], a[36:39], v[100:103]
  ds_read_b64_tr_b16 a[56:57], v16 offset:16384
  v_mfma_f32_16x16x32_bf16 v[104:107], a[8:11], a[40:43], v[104:107]
  ds_read_b64_tr_b16 a[58:59], v16 offset:18432
  v_mfma_f32_16x16x32_bf16 v[108:111], a[8:11], a[44:47], v[108:111]
  ds_read_b128 a[8:11], v12 offset:18432
  v_mfma_f32_16x16x32_bf16 v[112:115], a[12:15], a[32:35], v[112:115]
  ds_read_b64_tr_b16 a[60:61], v17 offset:16384
  v_mfma_f32_16x16x32_bf16 v[116:119], a[12:15], a[36:39], v[116:119]
  ds_read_b64_tr_b16 a[62:63], v17 offset:18432
  v_mfma_f32_16x16x32_bf16 v[120:123], a[12:15], a[40:43], v[120:123]
  v_mfma_f32_16x16x32_bf16 v[124:127], a[12:15], a[44:47], v[124:127]
  ds_read_b128 a[12:15], v12 offset:19456
  v_mfma_f32_16x16x32_bf16 v[128:131], a[16:19], a[32:35], v[128:131]
  v_mfma_f32_16x16x32_bf16 v[132:135], a[16:19], a[36:39], v[132:135]
  v_mfma_f32_16x16x32_bf16 v[136:139], a[16:19], a[40:43], v[136:139]
  v_mfma_f32_16x16x32_bf16 v[140:143], a[16:19], a[44:47], v[140:143]
  ds_read_b128 a[16:19], v12 offset:20480
  v_mfma_f32_16x16x32_bf16 v[144:147], a[20:23], a[32:35], v[144:147]
  v_mfma_f32_16x16x32_bf16 v[148:151], a[20:23], a[36:39], v[148:151]
  v_mfma_f32_16x16x32_bf16 v[152:155], a[20:23], a[40:43], v[152:155]
  v_mfma_f32_16x16x32_bf16 v[156:159], a[20:23], a[44:47], v[156:159]
  ds_read_b128 a[20:23], v12 offset:21504
  v_mfma_f32_16x16x32_bf16 v[160:163], a[24:27], a[32:35], v[160:163]
  v_mfma_f32_16x16x32_bf16 v[164:167], a[24:27], a[36:39], v[164:167]
  v_mfma_f32_16x16x32_bf16 v[168:171], a[24:27], a[40:43], v[168:171]
  v_mfma_f32_16x16x32_bf16 v[172:175], a[24:27], a[44:47], v[172:175]
  ds_read_b128 a[24:27], v12 offset:22528
  v_mfma_f32_16x16x32_bf16 v[176:179], a[28:31], a[32:35], v[176:179]
  v_mfma_f32_16x16x32_bf16 v[180:183], a[28:31], a[36:39], v[180:183]
  v_mfma_f32_16x16x32_bf16 v[184:187], a[28:31], a[40:43], v[184:187]
  v_mfma_f32_16x16x32_bf16 v[188:191], a[28:31], a[44:47], v[188:191]
  ds_read_b128 a[28:31], v12 offset:23552
  s_waitcnt lgkmcnt(5)
  v_mfma_f32_16x16x32_bf16 v[64:67], a[0:3], a[48:51], v[64:67]
  v_mfma_f32_16x16x32_bf16 v[68:71], a[0:3], a[52:55], v[68:71]
  v_mfma_f32_16x16x32_bf16 v[72:75], a[0:3], a[56:59], v[72:75]
  v_mfma_f32_16x16x32_bf16 v[76:79], a[0:3], a[60:63], v[76:79]
  s_waitcnt lgkmcnt(0)
  s_waitcnt vmcnt(4)
  s_barrier
  ds_read_b128 a[0:3], v12 offset:32768
  v_mfma_f32_16x16x32_bf16 v[80:83], a[4:7], a[48:51], v[80:83]
  ds_read_b64_tr_b16 a[32:33], v14 offset:32768
  v_mfma_f32_16x16x32_bf16 v[84:87], a[4:7], a[52:55], v[84:87]
  ds_read_b64_tr_b16 a[34:35], v14 offset:34816
  v_mfma_f32_16x16x32_bf16 v[88:91], a[4:7], a[56:59], v[88:91]
  ds_read_b64_tr_b16 a[36:37], v15 offset:32768
  v_mfma_f32_16x16x32_bf16 v[92:95], a[4:7], a[60:63], v[92:95]
  ds_read_b128 a[4:7], v12 offset:33792
  v_mfma_f32_16x16x32_bf16 v[96:99], a[8:11], a[48:51], v[96:99]
  ds_read_b64_tr_b16 a[38:39], v15 offset:34816
  v_mfma_f32_16x16x32_bf16 v[100:103], a[8:11], a[52:55], v[100:103]
  ds_read_b64_tr_b16 a[40:41], v16 offset:32768
  v_mfma_f32_16x16x32_bf16 v[104:107], a[8:11], a[56:59], v[104:107]
  ds_read_b64_tr_b16 a[42:43], v16 offset:34816
  v_mfma_f32_16x16x32_bf16 v[108:111], a[8:11], a[60:63], v[108:111]
  ds_read_b128 a[8:11], v12 offset:34816
  v_mfma_f32_16x16x32_bf16 v[112:115], a[12:15], a[48:51], v[112:115]
  ds_read_b64_tr_b16 a[44:45], v17 offset:32768
  v_mfma_f32_16x16x32_bf16 v[116:119], a[12:15], a[52:55], v[116:119]
  ds_read_b64_tr_b16 a[46:47], v17 offset:34816
  v_mfma_f32_16x16x32_bf16 v[120:123], a[12:15], a[56:59], v[120:123]
  v_mfma_f32_16x16x32_bf16 v[124:127], a[12:15], a[60:63], v[124:127]
  ds_read_b128 a[12:15], v12 offset:35840
  v_mfma_f32_16x16x32_bf16 v[128:131], a[16:19], a[48:51], v[128:131]
  v_mfma_f32_16x16x32_bf16 v[132:135], a[16:19], a[52:55], v[132:135]
  v_mfma_f32_16x16x32_bf16 v[136:139], a[16:19], a[56:59], v[136:139]
  v_mfma_f32_16x16x32_bf16 v[140:143], a[16:19], a[60:63], v[140:143]
  ds_read_b128 a[16:19], v12 offset:36864
  v_mfma_f32_16x16x32_bf16 v[144:147], a[20:23], a[48:51], v[144:147]
  v_mfma_f32_16x16x32_bf16 v[148:151], a[20:23], a[52:55], v[148:151]
  v_mfma_f32_16x16x32_bf16 v[152:155], a[20:23], a[56:59], v[152:155]
  v_mfma_f32_16x16x32_bf16 v[156:159], a[20:23], a[60:63], v[156:159]
  ds_read_b128 a[20:23], v12 offset:37888
  v_mfma_f32_16x16x32_bf16 v[160:163], a[24:27], a[48:51], v[160:163]
  v_mfma_f32_16x16x32_bf16 v[164:167], a[24:27], a[52:55], v[164:167]
  v_mfma_f32_16x16x32_bf16 v[168:171], a[24:27], a[56:59], v[168:171]
  v_mfma_f32_16x16x32_bf16 v[172:175], a[24:27], a[60:63], v[172:175]
  ds_read_b128 a[24:27], v12 offset:38912
  v_mfma_f32_16x16x32_bf16 v[176:179], a[28:31], a[48:51], v[176:179]
  v_mfma_f32_16x16x32_bf16 v[180:183], a[28:31], a[52:55], v[180:183]
  v_mfma_f32_16x16x32_bf16 v[184:187], a[28:31], a[56:59], v[184:187]
  v_mfma_f32_16x16x32_bf16 v[188:191], a[28:31], a[60:63], v[188:191]
  ds_read_b128 a[28:31], v12 offset:39936
  s_waitcnt lgkmcnt(5)
  v_mfma_f32_16x16x32_bf16 v[64:67], a[0:3], a[32:35], v[64:67]
  v_mfma_f32_16x16x32_bf16 v[68:71], a[0:3], a[36:39], v[68:71]
  v_mfma_f32_16x16x32_bf16 v[72:75], a[0:3], a[40:43], v[72:75]
  v_mfma_f32_16x16x32_bf16 v[76:79], a[0:3], a[44:47], v[76:79]
  s_waitcnt lgkmcnt(0)
  s_waitcnt vmcnt(0)
  s_barrier
  ds_read_b128 a[0:3], v12 offset:49152
  v_mfma_f32_16x16x32_bf16 v[80:83], a[4:7], a[32:35], v[80:83]
  ds_read_b64_tr_b16 a[48:49], v14 offset:49152
  v_mfma_f32_16x16x32_bf16 v[84:87], a[4:7], a[36:39], v[84:87]
  ds_read_b64_tr_b16 a[50:51], v14 offset:51200
  v_mfma_f32_16x16x32_bf16 v[88:91], a[4:7], a[40:43], v[88:91]
  ds_read_b64_tr_b16 a[52:53], v15 offset:49152
  v_mfma_f32_16x16x32_bf16 v[92:95], a[4:7], a[44:47], v[92:95]
  ds_read_b128 a[4:7], v12 offset:50176
  v_mfma_f32_16x16x32_bf16 v[96:99], a[8:11], a[32:35], v[96:99]
  ds_read_b64_tr_b16 a[54:55], v15 offset:51200
  v_mfma_f32_16x16x32_bf16 v[100:103], a[8:11], a[36:39], v[100:103]
  ds_read_b64_tr_b16 a[56:57], v16 offset:49152
  v_mfma_f32_16x16x32_bf16 v[104:107], a[8:11], a[40:43], v[104:107]
  ds_read_b64_tr_b16 a[58:59], v16 offset:51200
  v_mfma_f32_16x16x32_bf16 v[108:111], a[8:11], a[44:47], v[108:111]
  ds_read_b128 a[8:11], v12 offset:51200
  v_mfma_f32_16x16x32_bf16 v[112:115], a[12:15], a[32:35], v[112:115]
  ds_read_b64_tr_b16 a[60:61], v17 offset:49152
  v_mfma_f32_16x16x32_bf16 v[116:119], a[12:15], a[36:39], v[116:119]
  ds_read_b64_tr_b16 a[62:63], v17 offset:51200
  v_mfma_f32_16x16x32_bf16 v[120:123], a[12:15], a[40:43], v[120:123]
  v_mfma_f32_16x16x32_bf16 v[124:127], a[12:15], a[44:47], v[124:127]
  ds_read_b128 a[12:15], v12 offset:52224
  v_mfma_f32_16x16x32_bf16 v[128:131], a[16:19], a[32:35], v[128:131]
  v_mfma_f32_16x16x32_bf16 v[132:135], a[16:19], a[36:39], v[132:135]
  v_mfma_f32_16x16x32_bf16 v[136:139], a[16:19], a[40:43], v[136:139]
  v_mfma_f32_16x16x32_bf16 v[140:143], a[16:19], a[44:47], v[140:143]
  ds_read_b128 a[16:19], v12 offset:53248
  v_mfma_f32_16x16x32_bf16 v[144:147], a[20:23], a[32:35], v[144:147]
  v_mfma_f32_16x16x32_bf16 v[148:151], a[20:23], a[36:39], v[148:151]
  v_mfma_f32_16x16x32_bf16 v[152:155], a[20:23], a[40:43], v[152:155]
  v_mfma_f32_16x16x32_bf16 v[156:159], a[20:23], a[44:47], v[156:159]
  ds_read_b128 a[20:23], v12 offset:54272
  v_mfma_f32_16x16x32_bf16 v[160:163], a[24:27], a[32:35], v[160:163]
  v_mfma_f32_16x16x32_bf16 v[164:167], a[24:27], a[36:39], v[164:167]
  v_mfma_f32_16x16x32_bf16 v[168:171], a[24:27], a[40:43], v[168:171]
  v_mfma_f32_16x16x32_bf16 v[172:175], a[24:27], a[44:47], v[172:175]
  ds_read_b128 a[24:27], v12 offset:55296
  v_mfma_f32_16x16x32_bf16 v[176:179], a[28:31], a[32:35], v[176:179]
  v_mfma_f32_16x16x32_bf16 v[180:183], a[28:31], a[36:39], v[180:183]
  v_mfma_f32_16x16x32_bf16 v[184:187], a[28:31], a[40:43], v[184:187]
  v_mfma_f32_16x16x32_bf16 v[188:191], a[28:31], a[44:47], v[188:191]
  ds_read_b128 a[28:31], v12 offset:56320
  s_waitcnt lgkmcnt(5)
  v_mfma_f32_16x16x32_bf16 v[64:67], a[0:3], a[48:51], v[64:67]
  v_mfma_f32_16x16x32_bf16 v[68:71], a[0:3], a[52:55], v[68:71]
  v_mfma_f32_16x16x32_bf16 v[72:75], a[0:3], a[56:59], v[72:75]
  v_mfma_f32_16x16x32_bf16 v[76:79], a[0:3], a[60:63], v[76:79]
  v_mfma_f32_16x16x32_bf16 v[80:83], a[4:7], a[48:51], v[80:83]
  v_mfma_f32_16x16x32_bf16 v[84:87], a[4:7], a[52:55], v[84:87]
  v_mfma_f32_16x16x32_bf16 v[88:91], a[4:7], a[56:59], v[88:91]
  v_mfma_f32_16x16x32_bf16 v[92:95], a[4:7], a[60:63], v[92:95]
  v_mfma_f32_16x16x32_bf16 v[96:99], a[8:11], a[48:51], v[96:99]
  v_mfma_f32_16x16x32_bf16 v[100:103], a[8:11], a[52:55], v[100:103]
  v_mfma_f32_16x16x32_bf16 v[104:107], a[8:11], a[56:59], v[104:107]
  v_mfma_f32_16x16x32_bf16 v[108:111], a[8:11], a[60:63], v[108:111]
  s_waitcnt lgkmcnt(4)
  v_mfma_f32_16x16x32_bf16 v[112:115], a[12:15], a[48:51], v[112:115]
  v_mfma_f32_16x16x32_bf16 v[116:119], a[12:15], a[52:55], v[116:119]
  v_mfma_f32_16x16x32_bf16 v[120:123], a[12:15], a[56:59], v[120:123]
  v_mfma_f32_16x16x32_bf16 v[124:127], a[12:15], a[60:63], v[124:127]
  s_waitcnt lgkmcnt(3)
  v_mfma_f32_16x16x32_bf16 v[128:131], a[16:19], a[48:51], v[128:131]
  v_mfma_f32_16x16x32_bf16 v[132:135], a[16:19], a[52:55], v[132:135]
  v_mfma_f32_16x16x32_bf16 v[136:139], a[16:19], a[56:59], v[136:139]
  v_mfma_f32_16x16x32_bf16 v[140:143], a[16:19], a[60:63], v[140:143]
  s_waitcnt lgkmcnt(2)
  v_mfma_f32_16x16x32_bf16 v[144:147], a[20:23], a[48:51], v[144:147]
  v_mfma_f32_16x16x32_bf16 v[148:151], a[20:23], a[52:55], v[148:151]
  v_mfma_f32_16x16x32_bf16 v[152:155], a[20:23], a[56:59], v[152:155]
  v_mfma_f32_16x16x32_bf16 v[156:159], a[20:23], a[60:63], v[156:159]
  s_waitcnt lgkmcnt(1)
  v_mfma_f32_16x16x32_bf16 v[160:163], a[24:27], a[48:51], v[160:163]
  v_mfma_f32_16x16x32_bf16 v[164:167], a[24:27], a[52:55], v[164:167]
  v_mfma_f32_16x16x32_bf16 v[168:171], a[24:27], a[56:59], v[168:171]
  v_mfma_f32_16x16x32_bf16 v[172:175], a[24:27], a[60:63], v[172:175]
  s_waitcnt lgkmcnt(0)
  v_mfma_f32_16x16x32_bf16 v[176:179], a[28:31], a[48:51], v[176:179]
  v_mfma_f32_16x16x32_bf16 v[180:183], a[28:31], a[52:55], v[180:183]
  v_mfma_f32_16x16x32_bf16 v[184:187], a[28:31], a[56:59], v[184:187]
  v_mfma_f32_16x16x32_bf16 v[188:191], a[28:31], a[60:63], v[188:191]
L_episel_32:
  s_nop 7
L_epi_plain_31:
  s_lshr_b32 s42, s28, 2
  s_and_b32 s43, s28, 3
  s_mul_i32 s45, s43, 4096
  s_add_u32 s45, s45, s37
  s_mul_i32 s44, s42, 4
  s_mul_i32 s44, s44, s38
  s_add_u32 s44, s44, s45
  v_cvt_pk_bf16_f32 v44, v64, v65
  v_cvt_pk_bf16_f32 v45, v66, v67
  v_cvt_pk_bf16_f32 v46, v80, v81
  v_cvt_pk_bf16_f32 v47, v82, v83
  buffer_store_dwordx4 v[44:47], v18, s[4:7], s44 offen offset:0 sc1
  v_cvt_pk_bf16_f32 v48, v68, v69
  v_cvt_pk_bf16_f32 v49, v70, v71
  v_cvt_pk_bf16_f32 v50, v84, v85
  v_cvt_pk_bf16_f32 v51, v86, v87
  buffer_store_dwordx4 v[48:51], v18, s[4:7], s44 offen offset:1024 sc1
  v_cvt_pk_bf16_f32 v52, v72, v73
  v_cvt_pk_bf16_f32 v53, v74, v75
  v_cvt_pk_bf16_f32 v54, v88, v89
  v_cvt_pk_bf16_f32 v55, v90, v91
  buffer_store_dwordx4 v[52:55], v18, s[4:7], s44 offen offset:2048 sc1
  v_cvt_pk_bf16_f32 v56, v76, v77
  v_cvt_pk_bf16_f32 v57, v78, v79
  v_cvt_pk_bf16_f32 v58, v92, v93
  v_cvt_pk_bf16_f32 v59, v94, v95
  buffer_store_dwordx4 v[56:59], v18, s[4:7], s44 offen offset:3072 sc1
  s_add_u32 s44, s44, s38
  v_cvt_pk_bf16_f32 v44, v96, v97
  v_cvt_pk_bf16_f32 v45, v98, v99
  v_cvt_pk_bf16_f32 v46, v112, v113
  v_cvt_pk_bf16_f32 v47, v114, v115
  buffer_store_dwordx4 v[44:47], v18, s[4:7], s44 offen offset:0 sc1
  v_cvt_pk_bf16_f32 v48, v100, v101
  v_cvt_pk_bf16_f32 v49, v102, v103
  v_cvt_pk_bf16_f32 v50, v116, v117
  v_cvt_pk_bf16_f32 v51, v118, v119
  buffer_store_dwordx4 v[48:51], v18, s[4:7], s44 offen offset:1024 sc1
  v_cvt_pk_bf16_f32 v52, v104, v105
  v_cvt_pk_bf16_f32 v53, v106, v107
  v_cvt_pk_bf16_f32 v54, v120, v121
  v_cvt_pk_bf16_f32 v55, v122, v123
  buffer_store_dwordx4 v[52:55], v18, s[4:7], s44 offen offset:2048 sc1
  v_cvt_pk_bf16_f32 v56, v108, v109
  v_cvt_pk_bf16_f32 v57, v110, v111
  v_cvt_pk_bf16_f32 v58, v124, v125
  v_cvt_pk_bf16_f32 v59, v126, v127
  buffer_store_dwordx4 v[56:59], v18, s[4:7], s44 offen offset:3072 sc1
  s_add_u32 s44, s44, s38
  v_cvt_pk_bf16_f32 v44, v128, v129
  v_cvt_pk_bf16_f32 v45, v130, v131
  v_cvt_pk_bf16_f32 v46, v144, v145
  v_cvt_pk_bf16_f32 v47, v146, v147
  buffer_store_dwordx4 v[44:47], v18, s[4:7], s44 offen offset:0 sc1
  v_cvt_pk_bf16_f32 v48, v132, v133
  v_cvt_pk_bf16_f32 v49, v134, v135
  v_cvt_pk_bf16_f32 v50, v148, v149
  v_cvt_pk_bf16_f32 v51, v150, v151
  buffer_store_dwordx4 v[48:51], v18, s[4:7], s44 offen offset:1024 sc1
  v_cvt_pk_bf16_f32 v52, v136, v137
  v_cvt_pk_bf16_f32 v53, v138, v139
  v_cvt_pk_bf16_f32 v54, v152, v153
  v_cvt_pk_bf16_f32 v55, v154, v155
  buffer_store_dwordx4 v[52:55], v18, s[4:7], s44 offen offset:2048 sc1
  v_cvt_pk_bf16_f32 v56, v140, v141
  v_cvt_pk_bf16_f32 v57, v142, v143
  v_cvt_pk_bf16_f32 v58, v156, v157
  v_cvt_pk_bf16_f32 v59, v158, v159
  buffer_store_dwordx4 v[56:59], v18, s[4:7], s44 offen offset:3072 sc1
  s_add_u32 s44, s44, s38
  v_cvt_pk_bf16_f32 v44, v160, v161
  v_cvt_pk_bf16_f32 v45, v162, v163
  v_cvt_pk_bf16_f32 v46, v176, v177
  v_cvt_pk_bf16_f32 v47, v178, v179
  buffer_store_dwordx4 v[44:47], v18, s[4:7], s44 offen offset:0 sc1
  v_cvt_pk_bf16_f32 v48, v164, v165
  v_cvt_pk_bf16_f32 v49, v166, v167
  v_cvt_pk_bf16_f32 v50, v180, v181
  v_cvt_pk_bf16_f32 v51, v182, v183
  buffer_store_dwordx4 v[48:51], v18, s[4:7], s44 offen offset:1024 sc1
  v_cvt_pk_bf16_f32 v52, v168, v169
  v_cvt_pk_bf16_f32 v53, v170, v171
  v_cvt_pk_bf16_f32 v54, v184, v185
  v_cvt_pk_bf16_f32 v55, v186, v187
  buffer_store_dwordx4 v[52:55], v18, s[4:7], s44 offen offset:2048 sc1
  v_cvt_pk_bf16_f32 v56, v172, v173
  v_cvt_pk_bf16_f32 v57, v174, v175
  v_cvt_pk_bf16_f32 v58, v188, v189
  v_cvt_pk_bf16_f32 v59, v190, v191
  buffer_store_dwordx4 v[56:59], v18, s[4:7], s44 offen offset:3072 sc1
  s_branch L_chained
L_head_big_fn_v:
  s_waitcnt lgkmcnt(4)
  v_mfma_f32_16x16x32_bf16 v[64:67], a[0:3], a[32:35], 0
  v_mfma_f32_16x16x32_bf16 v[68:71], a[0:3], a[36:39], 0
  v_mfma_f32_16x16x32_bf16 v[72:75], a[0:3], a[40:43], 0
  v_mfma_f32_16x16x32_bf16 v[76:79], a[0:3], a[44:47], 0
  s_waitcnt lgkmcnt(0)
  s_waitcnt vmcnt(24)
  s_barrier
  ds_read_b128 a[0:3], v12 offset:16384
  v_mfma_f32_16x16x32_bf16 v[80:83], a[4:7], a[32:35], 0
  s_add_u32 m0, s40, 0
  ds_read_b64_tr_b16 a[48:49], v14 offset:16384
  v_mfma_f32_16x16x32_bf16 v[84:87], a[4:7], a[36:39], 0
  buffer_load_dwordx4 v4, s[8:11], s32 offen offset:0 sc1 lds
  v_mfma_f32_16x16x32_bf16 v[88:91], a[4:7], a[40:43], 0
  buffer_load_dwordx4 v5, s[8:11], s32 offen offset:1024 sc1 lds
  s_add_u32 s32, s32, s33
  v_mfma_f32_16x16x32_bf16 v[92:95], a[4:7], a[44:47], 0
  ds_read_b128 a[4:7], v12 offset:17408
  v_mfma_f32_16x16x32_bf16 v[96:99], a[8:11], a[32:35], 0
  s_add_u32 m0, s41, 0
  ds_read_b64_tr_b16 a[50:51], v14 offset:18432
  v_mfma_f32_16x16x32_bf16 v[100:103], a[8:11], a[36:39], 0
  buffer_load_dwordx4 v8, s[12:15], s34 offen offset:0 lds
  v_mfma_f32_16x16x32_bf16 v[104:107], a[8:11], a[40:43], 0
  buffer_load_dwordx4 v9, s[12:15], s34 offen offset:1024 lds
  s_add_u32 s34, s34, s35
  v_mfma_f32_16x16x32_bf16 v[108:111], a[8:11], a[44:47], 0
  ds_read_b128 a[8:11], v12 offset:18432
  v_mfma_f32_16x16x32_bf16 v[112:115], a[12:15], a[32:35], 0
  ds_read_b64_tr_b16 a[52:53], v15 offset:16384
  v_mfma_f32_16x16x32_bf16 v[116:119], a[12:15], a[36:39], 0
  ds_read_b64_tr_b16 a[54:55], v15 offset:18432
  v_mfma_f32_16x16x32_bf16 v[120:123], a[12:15], a[40:43], 0
  ds_read_b64_tr_b16 a[56:57], v16 offset:16384
  v_mfma_f32_16x16x32_bf16 v[124:127], a[12:15], a[44:47], 0
  ds_read_b128 a[12:15], v12 offset:19456
  v_mfma_f32_16x16x32_bf16 v[128:131], a[16:19], a[32:35], 0
  ds_read_b64_tr_b16 a[58:59], v16 offset:18432
  v_mfma_f32_16x16x32_bf16 v[132:135], a[16:19], a[36:39], 0
  ds_read_b64_tr_b16 a[60:61], v17 offset:16384
  v_mfma_f32_16x16x32_bf16 v[136:139], a[16:19], a[40:43], 0
  ds_read_b64_tr_b16 a[62:63], v17 offset:18432
  v_mfma_f32_16x16x32_bf16 v[140:143], a[16:19], a[44:47], 0
  ds_read_b128 a[16:19], v12 offset:20480
  v_mfma_f32_16x16x32_bf16 v[144:147], a[20:23], a[32:35], 0
  v_mfma_f32_16x16x32_bf16 v[148:151], a[20:23], a[36:39], 0
  v_mfma_f32_16x16x32_bf16 v[152:155], a[20:23], a[40:43], 0
  v_mfma_f32_16x16x32_bf16 v[156:159], a[20:23], a[44:47], 0
  ds_read_b128 a[20:23], v12 offset:21504
  v_mfma_f32_16x16x32_bf16 v[160:163], a[24:27], a[32:35], 0
  v_mfma_f32_16x16x32_bf16 v[164:167], a[24:27], a[36:39], 0
  v_mfma_f32_16x16x32_bf16 v[168:171], a[24:27], a[40:43], 0
  v_mfma_f32_16x16x32_bf16 v[172:175], a[24:27], a[44:47], 0
  ds_read_b128 a[24:27], v12 offset:22528
  v_mfma_f32_16x16x32_bf16 v[176:179], a[28:31], a[32:35], 0
  v_mfma_f32_16x16x32_bf16 v[180:183], a[28:31], a[36:39], 0
  v_mfma_f32_16x16x32_bf16 v[184:187], a[28:31], a[40:43], 0
  v_mfma_f32_16x16x32_bf16 v[188:191], a[28:31], a[44:47], 0
  ds_read_b128 a[28:31], v12 offset:23552
  s_waitcnt lgkmcnt(4)
  v_mfma_f32_16x16x32_bf16 v[64:67], a[0:3], a[48:51], v[64:67]
  v_mfma_f32_16x16x32_bf16 v[68:71], a[0:3], a[52:55], v[68:71]
  v_mfma_f32_16x16x32_bf16 v[72:75], a[0:3], a[56:59], v[72:75]
  v_mfma_f32_16x16x32_bf16 v[76:79], a[0:3], a[60:63], v[76:79]
  s_waitcnt lgkmcnt(0)
  s_waitcnt vmcnt(24)
  s_barrier
  ds_read_b128 a[0:3], v12 offset:32768
  v_mfma_f32_16x16x32_bf16 v[80:83], a[4:7], a[48:51], v[80:83]
  s_add_u32 m0, s40, 16384
  ds_read_b64_tr_b16 a[32:33], v14 offset:32768
  v_mfma_f32_16x16x32_bf16 v[84:87], a[4:7], a[52:55], v[84:87]
  buffer_load_dwordx4 v4, s[8:11], s32 offen offset:0 sc1 lds
  v_mfma_f32_16x16x32_bf16 v[88:91], a[4:7], a[56:59], v[88:91]
  buffer_load_dwordx4 v5, s[8:11], s32 offen offset:1024 sc1 lds
  s_add_u32 s32, s32, s33
  v_mfma_f32_16x16x32_bf16 v[92:95], a[4:7], a[60:63], v[92:95]
  ds_read_b128 a[4:7], v12 offset:33792
  v_mfma_f32_16x16x32_bf16 v[96:99], a[8:11], a[48:51], v[96:99]
  s_add_u32 m0, s41, 16384
  ds_read_b64_tr_b16 a[34:35], v14 offset:34816
  v_mfma_f32_16x16x32_bf16 v[100:103], a[8:11], a[52:55], v[100:103]
  buffer_load_dwordx4 v8, s[12:15], s34 offen offset:0 lds
  v_mfma_f32_16x16x32_bf16 v[104:107], a[8:11], a[56:59], v[104:107]
  buffer_load_dwordx4 v9, s[12:15], s34 offen offset:1024 lds
  s_add_u32 s34, s34, s35
  v_mfma_f32_16x16x32_bf16 v[108:111], a[8:11], a[60:63], v[108:111]
  ds_read_b128 a[8:11], v12 offset:34816
  v_mfma_f32_16x16x32_bf16 v[112:115], a[12:15], a[48:51], v[112:115]
  ds_read_b64_tr_b16 a[36:37], v15 offset:32768
  v_mfma_f32_16x16x32_bf16 v[116:119], a[12:15], a[52:55], v[116:119]
  ds_read_b64_tr_b16 a[38:39], v15 offset:34816
  v_mfma_f32_16x16x32_bf16 v[120:123], a[12:15], a[56:59], v[120:123]
  ds_read_b64_tr_b16 a[40:41], v16 offset:32768
  v_mfma_f32_16x16x32_bf16 v[124:127], a[12:15], a[60:63], v[124:127]
  ds_read_b128 a[12:15], v12 offset:35840
  v_mfma_f32_16x16x32_bf16 v[128:131], a[16:19], a[48:51], v[128:131]
  ds_read_b64_tr_b16 a[42:43], v16 offset:34816
  v_mfma_f32_16x16x32_bf16 v[132:135], a[16:19], a[52:55], v[132:135]
  ds_read_b64_tr_b16 a[44:45], v17 offset:32768
  v_mfma_f32_16x16x32_bf16 v[136:139], a[16:19], a[56:59], v[136:139]
  ds_read_b64_tr_b16 a[46:47], v17 offset:34816
  v_mfma_f32_16x16x32_bf16 v[140:143], a[16:19], a[60:63], v[140:143]
  ds_read_b128 a[16:19], v12 offset:36864
  v_mfma_f32_16x16x32_bf16 v[144:147], a[20:23], a[48:51], v[144:147]
  v_mfma_f32_16x16x32_bf16 v[148:151], a[20:23], a[52:55], v[148:151]
  v_mfma_f32_16x16x32_bf16 v[152:155], a[20:23], a[56:59], v[152:155]
  v_mfma_f32_16x16x32_bf16 v[156:159], a[20:23], a[60:63], v[156:159]
  ds_read_b128 a[20:23], v12 offset:37888
  v_mfma_f32_16x16x32_bf16 v[160:163], a[24:27], a[48:51], v[160:163]
  v_mfma_f32_16x16x32_bf16 v[164:167], a[24:27], a[52:55], v[164:167]
  v_mfma_f32_16x16x32_bf16 v[168:171], a[24:27], a[56:59], v[168:171]
  v_mfma_f32_16x16x32_bf16 v[172:175], a[24:27], a[60:63], v[172:175]
  ds_read_b128 a[24:27], v12 offset:38912
  v_mfma_f32_16x16x32_bf16 v[176:179], a[28:31], a[48:51], v[176:179]
  v_mfma_f32_16x16x32_bf16 v[180:183], a[28:31], a[52:55], v[180:183]
  v_mfma_f32_16x16x32_bf16 v[184:187], a[28:31], a[56:59], v[184:187]
  v_mfma_f32_16x16x32_bf16 v[188:191], a[28:31], a[60:63], v[188:191]
  ds_read_b128 a[28:31], v12 offset:39936
  s_waitcnt lgkmcnt(4)
  v_mfma_f32_16x16x32_bf16 v[64:67], a[0:3], a[32:35], v[64:67]
  v_mfma_f32_16x16x32_bf16 v[68:71], a[0:3], a[36:39], v[68:71]
  v_mfma_f32_16x16x32_bf16 v[72:75], a[0:3], a[40:43], v[72:75]
  v_mfma_f32_16x16x32_bf16 v[76:79], a[0:3], a[44:47], v[76:79]
  s_waitcnt lgkmcnt(0)
  s_waitcnt vmcnt(24)
  s_barrier
  ds_read_b128 a[0:3], v12 offset:49152
  v_mfma_f32_16x16x32_bf16 v[80:83], a[4:7], a[32:35], v[80:83]
  s_add_u32 m0, s40, 32768
  ds_read_b64_tr_b16 a[48:49], v14 offset:49152
  v_mfma_f32_16x16x32_bf16 v[84:87], a[4:7], a[36:39], v[84:87]
  buffer_load_dwordx4 v4, s[8:11], s32 offen offset:0 sc1 lds
  v_mfma_f32_16x16x32_bf16 v[88:91], a[4:7], a[40:43], v[88:91]
  buffer_load_dwordx4 v5, s[8:11], s32 offen offset:1024 sc1 lds
  s_add_u32 s32, s32, s33
  v_mfma_f32_16x16x32_bf16 v[92:95], a[4:7], a[44:47], v[92:95]
  ds_read_b128 a[4:7], v12 offset:50176
  v_mfma_f32_16x16x32_bf16 v[96:99], a[8:11], a[32:35], v[96:99]
  s_add_u32 m0, s41, 32768
  ds_read_b64_tr_b16 a[50:51], v14 offset:51200
  v_mfma_f32_16x16x32_bf16 v[100:103], a[8:11], a[36:39], v[100:103]
  buffer_load_dwordx4 v8, s[12:15], s34 offen offset:0 lds
  v_mfma_f32_16x16x32_bf16 v[104:107], a[8:11], a[40:43], v[104:107]
  buffer_load_dwordx4 v9, s[12:15], s34 offen offset:1024 lds
  s_add_u32 s34, s34, s35
  v_mfma_f32_16x16x32_bf16 v[108:111], a[8:11], a[44:47], v[108:111]
  ds_read_b128 a[8:11], v12 offset:51200
  v_mfma_f32_16x16x32_bf16 v[112:115], a[12:15], a[32:35], v[112:115]
  ds_read_b64_tr_b16 a[52:53], v15 offset:49152
  v_mfma_f32_16x16x32_bf16 v[116:119], a[12:15], a[36:39], v[116:119]
  ds_read_b64_tr_b16 a[54:55], v15 offset:51200
  v_mfma_f32_16x16x32_bf16 v[120:123], a[12:15], a[40:43], v[120:123]
  ds_read_b64_tr_b16 a[56:57], v16 offset:49152
  v_mfma_f32_16x16x32_bf16 v[124:127], a[12:15], a[44:47], v[124:127]
  ds_read_b128 a[12:15], v12 offset:52224
  v_mfma_f32_16x16x32_bf16 v[128:131], a[16:19], a[32:35], v[128:131]
  ds_read_b64_tr_b16 a[58:59], v16 offset:51200
  v_mfma_f32_16x16x32_bf16 v[132:135], a[16:19], a[36:39], v[132:135]
  ds_read_b64_tr_b16 a[60:61], v17 offset:49152
  v_mfma_f32_16x16x32_bf16 v[136:139], a[16:19], a[40:43], v[136:139]
  ds_read_b64_tr_b16 a[62:63], v17 offset:51200
  v_mfma_f32_16x16x32_bf16 v[140:143], a[16:19], a[44:47], v[140:143]
  ds_read_b128 a[16:19], v12 offset:53248
  v_mfma_f32_16x16x32_bf16 v[144:147], a[20:23], a[32:35], v[144:147]
  v_mfma_f32_16x16x32_bf16 v[148:151], a[20:23], a[36:39], v[148:151]
  v_mfma_f32_16x16x32_bf16 v[152:155], a[20:23], a[40:43], v[152:155]
  v_mfma_f32_16x16x32_bf16 v[156:159], a[20:23], a[44:47], v[156:159]
  ds_read_b128 a[20:23], v12 offset:54272
  v_mfma_f32_16x16x32_bf16 v[160:163], a[24:27], a[32:35], v[160:163]
  v_mfma_f32_16x16x32_bf16 v[164:167], a[24:27], a[36:39], v[164:167]
  v_mfma_f32_16x16x32_bf16 v[168:171], a[24:27], a[40:43], v[168:171]
  v_mfma_f32_16x16x32_bf16 v[172:175], a[24:27], a[44:47], v[172:175]
  ds_read_b128 a[24:27], v12 offset:55296
  v_mfma_f32_16x16x32_bf16 v[176:179], a[28:31], a[32:35], v[176:179]
  v_mfma_f32_16x16x32_bf16 v[180:183], a[28:31], a[36:39], v[180:183]
  v_mfma_f32_16x16x32_bf16 v[184:187], a[28:31], a[40:43], v[184:187]
  v_mfma_f32_16x16x32_bf16 v[188:191], a[28:31], a[44:47], v[188:191]
  ds_read_b128 a[28:31], v12 offset:56320
  s_waitcnt lgkmcnt(4)
  v_mfma_f32_16x16x32_bf16 v[64:67], a[0:3], a[48:51], v[64:67]
  v_mfma_f32_16x16x32_bf16 v[68:71], a[0:3], a[52:55], v[68:71]
  v_mfma_f32_16x16x32_bf16 v[72:75], a[0:3], a[56:59], v[72:75]
  v_mfma_f32_16x16x32_bf16 v[76:79], a[0:3], a[60:63], v[76:79]
  s_waitcnt lgkmcnt(0)
  s_waitcnt vmcnt(8)
  s_barrier
  s_cmp_eq_u32 s28, 0
  s_cbranch_scc1 L_sig_39
L_sigb_40:
  ds_read_b128 a[0:3], v12 offset:0
  v_mfma_f32_16x16x32_bf16 v[80:83], a[4:7], a[48:51], v[80:83]
  s_add_u32 m0, s40, 49152
  ds_read_b64_tr_b16 a[32:33], v14 offset:0
  v_mfma_f32_16x16x32_bf16 v[84:87], a[4:7], a[52:55], v[84:87]
  buffer_load_dwordx4 v4, s[8:11], s32 offen offset:0 sc1 lds
  v_mfma_f32_16x16x32_bf16 v[88:91], a[4:7], a[56:59], v[88:91]
  buffer_load_dwordx4 v5, s[8:11], s32 offen offset:1024 sc1 lds
  s_add_u32 s32, s32, s33
  v_mfma_f32_16x16x32_bf16 v[92:95], a[4:7], a[60:63], v[92:95]
  ds_read_b128 a[4:7], v12 offset:1024
  v_mfma_f32_16x16x32_bf16 v[96:99], a[8:11], a[48:51], v[96:99]
  s_add_u32 m0, s41, 49152
  ds_read_b64_tr_b16 a[34:35], v14 offset:2048
  v_mfma_f32_16x16x32_bf16 v[100:103], a[8:11], a[52:55], v[100:103]
  buffer_load_dwordx4 v8, s[12:15], s34 offen offset:0 lds
  v_mfma_f32_16x16x32_bf16 v[104:107], a[8:11], a[56:59], v[104:107]
  buffer_load_dwordx4 v9, s[12:15], s34 offen offset:1024 lds
  s_add_u32 s34, s34, s35
  v_mfma_f32_16x16x32_bf16 v[108:111], a[8:11], a[60:63], v[108:111]
  ds_read_b128 a[8:11], v12 offset:2048
  v_mfma_f32_16x16x32_bf16 v[112:115], a[12:15], a[48:51], v[112:115]
  ds_read_b64_tr_b16 a[36:37], v15 offset:0
  v_mfma_f32_16x16x32_bf16 v[116:119], a[12:15], a[52:55], v[116:119]
  ds_read_b64_tr_b16 a[38:39], v15 offset:2048
  v_mfma_f32_16x16x32_bf16 v[120:123], a[12:15], a[56:59], v[120:123]
  ds_read_b64_tr_b16 a[40:41], v16 offset:0
  v_mfma_f32_16x16x32_bf16 v[124:127], a[12:15], a[60:63], v[124:127]
  ds_read_b128 a[12:15], v12 offset:3072
  v_mfma_f32_16x16x32_bf16 v[128:131], a[16:19], a[48:51], v[128:131]
  ds_read_b64_tr_b16 a[42:43], v16 offset:2048
  v_mfma_f32_16x16x32_bf16 v[132:135], a[16:19], a[52:55], v[132:135]
  ds_read_b64_tr_b16 a[44:45], v17 offset:0
  v_mfma_f32_16x16x32_bf16 v[136:139], a[16:19], a[56:59], v[136:139]
  ds_read_b64_tr_b16 a[46:47], v17 offset:2048
  v_mfma_f32_16x16x32_bf16 v[140:143], a[16:19], a[60:63], v[140:143]
  ds_read_b128 a[16:19], v12 offset:4096
  v_mfma_f32_16x16x32_bf16 v[144:147], a[20:23], a[48:51], v[144:147]
  v_mfma_f32_16x16x32_bf16 v[148:151], a[20:23], a[52:55], v[148:151]
  v_mfma_f32_16x16x32_bf16 v[152:155], a[20:23], a[56:59], v[152:155]
  v_mfma_f32_16x16x32_bf16 v[156:159], a[20:23], a[60:63], v[156:159]
  ds_read_b128 a[20:23], v12 offset:5120
  v_mfma_f32_16x16x32_bf16 v[160:163], a[24:27], a[48:51], v[160:163]
  v_mfma_f32_16x16x32_bf16 v[164:167], a[24:27], a[52:55], v[164:167]
  v_mfma_f32_16x16x32_bf16 v[168:171], a[24:27], a[56:59], v[168:171]
  v_mfma_f32_16x16x32_bf16 v[172:175], a[24:27], a[60:63], v[172:175]
  ds_read_b128 a[24:27], v12 offset:6144
  v_mfma_f32_16x16x32_bf16 v[176:179], a[28:31], a[48:51], v[176:179]
  v_mfma_f32_16x16x32_bf16 v[180:183], a[28:31], a[52:55], v[180:183]
  v_mfma_f32_16x16x32_bf16 v[184:187], a[28:31], a[56:59], v[184:187]
  v_mfma_f32_16x16x32_bf16 v[188:191], a[28:31], a[60:63], v[188:191]
  ds_read_b128 a[28:31], v12 offset:7168
  s_sub_u32 s36, s36, 1
  s_branch L_loop_big_fn_v
L_sig_39:
  s_lshr_b32 s42, s27, 8
  s_lshl_b32 s42, s42, 7
  s_add_u32 s42, s42, 0x5c14000
  s_add_u32 s42, s42, s59
  s_and_b32 s43, s27, 0xff
  v_mov_b32 v2, s42
  v_mov_b32 v3, s43
  v_mov_b32 v20, 0x80000000
  v_cmp_eq_u32 vcc, 0, v1
  s_nop 1
  v_cndmask_b32 v2, v20, v2, vcc
  buffer_atomic_add v3, v2, s[4:7], 0 offen
  s_branch L_sigb_40
L_body_big_fm_kq:
  s_lshr_b32 s42, s28, 2
  s_and_b32 s43, s28, 3
  s_mul_i32 s40, s28, 2048
  s_mul_i32 s41, s28, 2048
  s_add_u32 s41, s41, 65536
  v_lshlrev_b32 v18, 4, v1
  s_mul_i32 s44, s42, 8192
  v_lshrrev_b32 v22, 4, v1
  v_and_b32 v23, 15, v1
  v_add_u32 v12, s44, v18
  s_mul_i32 s44, s28, 2
  s_add_u32 s44, s44, 0
  s_mul_i32 s44, s44, s45
  v_add_u32 v4, s44, v18
  s_mul_i32 s44, s28, 2
  s_add_u32 s44, s44, 1
  s_mul_i32 s44, s44, s45
  s_sub_u32 s44, s44, 1024
  v_add_u32 v5, s44, v18
  v_lshrrev_b32 v23, 5, v1
  v_and_b32 v24, 31, v1
  s_mul_i32 s44, s28, 4
  s_add_u32 s44, s44, 0
  v_add_u32 v20, s44, v23
  v_and_b32 v21, 7, v20
  v_lshlrev_b32 v21, 1, v21
  v_xor_b32 v21, v21, v24
  v_mul_lo_u32 v20, v20, s39
  v_lshl_add_u32 v8, v21, 4, v20
  s_mul_i32 s44, s28, 4
  s_add_u32 s44, s44, 2
  v_add_u32 v20, s44, v23
  v_and_b32 v21, 7, v20
  v_lshlrev_b32 v21, 1, v21
  v_xor_b32 v21, v21, v24
  v_mul_lo_u32 v20, v20, s39
  v_lshl_add_u32 v9, v21, 4, v20
  v_subrev_u32 v9, 1024, v9
  v_bfe_u32 v20, v1, 2, 2
  v_lshrrev_b32 v21, 4, v1
  v_lshl_add_u32 v22, v21, 2, v20
  v_mul_u32_u24 v22, 512, v22
  v_and_b32 v23, 3, v1
  v_lshl_add_u32 v22, v23, 3, v22
  v_add_u32 v22, 65536, v22
  v_and_b32 v21, 1, v21
  v_lshl_or_b32 v20, v21, 2, v20
  s_mul_i32 s44, s43, 4
  s_add_u32 s44, s44, 0
  v_xor_b32 v21, s44, v20
  v_lshl_add_u32 v14, v21, 5, v22
  s_mul_i32 s44, s43, 4
  s_add_u32 s44, s44, 1
  v_xor_b32 v21, s44, v20
  v_lshl_add_u32 v15, v21, 5, v22
  s_mul_i32 s44, s43, 4
  s_add_u32 s44, s44, 2
  v_xor_b32 v21, s44, v20
  v_lshl_add_u32 v16, v21, 5, v22
  s_mul_i32 s44, s43, 4
  s_add_u32 s44, s44, 3
  v_xor_b32 v21, s44, v20
  v_lshl_add_u32 v17, v21, 5, v22
  s_add_u32 m0, s40, 0
  s_nop 0
  buffer_load_dwordx4 v4, s[8:11], s32 offen offset:0 sc1 lds
  buffer_load_dwordx4 v5, s[8:11], s32 offen offset:1024 sc1 lds
  s_add_u32 s32, s32, s33
  s_add_u32 m0, s41, 0
  s_nop 0
  buffer_load_dwordx4 v8, s[12:15], s34 offen offset:0 lds
  buffer_load_dwordx4 v9, s[12:15], s34 offen offset:1024 lds
  s_add_u32 s34, s34, s35
  s_add_u32 m0, s40, 16384
  s_nop 0
  buffer_load_dwordx4 v4, s[8:11], s32 offen offset:0 sc1 lds
  buffer_load_dwordx4 v5, s[8:11], s32 offen offset:1024 sc1 lds
  s_add_u32 s32, s32, s33
  s_add_u32 m0, s41, 16384
  s_nop 0
  buffer_load_dwordx4 v8, s[12:15], s34 offen offset:0 lds
  buffer_load_dwordx4 v9, s[12:15], s34 offen offset:1024 lds
  s_add_u32 s34, s34, s35
  s_add_u32 m0, s40, 32768
  s_nop 0
  buffer_load_dwordx4 v4, s[8:11], s32 offen offset:0 sc1 lds
  buffer_load_dwordx4 v5, s[8:11], s32 offen offset:1024 sc1 lds
  s_add_u32 s32, s32, s33
  s_add_u32 m0, s41, 32768
  s_nop 0
  buffer_load_dwordx4 v8, s[12:15], s34 offen offset:0 lds
  buffer_load_dwordx4 v9, s[12:15], s34 offen offset:1024 lds
  s_add_u32 s34, s34, s35
  s_add_u32 m0, s40, 49152
  s_nop 0
  buffer_load_dwordx4 v4, s[8:11], s32 offen offset:0 sc1 lds
  buffer_load_dwordx4 v5, s[8:11], s32 offen offset:1024 sc1 lds
  s_add_u32 s32, s32, s33
  s_add_u32 m0, s41, 49152
  s_nop 0
  buffer_load_dwordx4 v8, s[12:15], s34 offen offset:0 lds
  buffer_load_dwordx4 v9, s[12:15], s34 offen offset:1024 lds
  s_add_u32 s34, s34, s35
  v_mov_b32 v64, 0
  v_mov_b32 v65, 0
  v_mov_b32 v66, 0
  v_mov_b32 v67, 0
  v_mov_b32 v68, 0
  v_mov_b32 v69, 0
  v_mov_b32 v70, 0
  v_mov_b32 v71, 0
  v_mov_b32 v72, 0
  v_mov_b32 v73, 0
  v_mov_b32 v74, 0
  v_mov_b32 v75, 0
  v_mov_b32 v76, 0
  v_mov_b32 v77, 0
  v_mov_b32 v78, 0
  v_mov_b32 v79, 0
  v_mov_b32 v80, 0
  v_mov_b32 v81, 0
  v_mov_b32 v82, 0
  v_mov_b32 v83, 0
  v_mov_b32 v84, 0
  v_mov_b32 v85, 0
  v_mov_b32 v86, 0
  v_mov_b32 v87, 0
  v_mov_b32 v88, 0
  v_mov_b32 v89, 0
  v_mov_b32 v90, 0
  v_mov_b32 v91, 0
  v_mov_b32 v92, 0
  v_mov_b32 v93, 0
  v_mov_b32 v94, 0
  v_mov_b32 v95, 0
  v_mov_b32 v96, 0
  v_mov_b32 v97, 0
  v_mov_b32 v98, 0
  v_mov_b32 v99, 0
  v_mov_b32 v100, 0
  v_mov_b32 v101, 0
  v_mov_b32 v102, 0
  v_mov_b32 v103, 0
  v_mov_b32 v104, 0
  v_mov_b32 v105, 0
  v_mov_b32 v106, 0
  v_mov_b32 v107, 0
  v_mov_b32 v108, 0
  v_mov_b32 v109, 0
  v_mov_b32 v110, 0
  v_mov_b32 v111, 0
  v_mov_b32 v112, 0
  v_mov_b32 v113, 0
  v_mov_b32 v114, 0
  v_mov_b32 v115, 0
  v_mov_b32 v116, 0
  v_mov_b32 v117, 0
  v_mov_b32 v118, 0
  v_mov_b32 v119, 0
  v_mov_b32 v120, 0
  v_mov_b32 v121, 0
  v_mov_b32 v122, 0
  v_mov_b32 v123, 0
  v_mov_b32 v124, 0
  v_mov_b32 v125, 0
  v_mov_b32 v126, 0
  v_mov_b32 v127, 0
  v_mov_b32 v128, 0
  v_mov_b32 v129, 0
  v_mov_b32 v130, 0
  v_mov_b32 v131, 0
  v_mov_b32 v132, 0
  v_mov_b32 v133, 0
  v_mov_b32 v134, 0
  v_mov_b32 v135, 0
  v_mov_b32 v136, 0
  v_mov_b32 v137, 0
  v_mov_b32 v138, 0
  v_mov_b32 v139, 0
  v_mov_b32 v140, 0
  v_mov_b32 v141, 0
  v_mov_b32 v142, 0
  v_mov_b32 v143, 0
  v_mov_b32 v144, 0
  v_mov_b32 v145, 0
  v_mov_b32 v146, 0
  v_mov_b32 v147, 0
  v_mov_b32 v148, 0
  v_mov_b32 v149, 0
  v_mov_b32 v150, 0
  v_mov_b32 v151, 0
  v_mov_b32 v152, 0
  v_mov_b32 v153, 0
  v_mov_b32 v154, 0
  v_mov_b32 v155, 0
  v_mov_b32 v156, 0
  v_mov_b32 v157, 0
  v_mov_b32 v158, 0
  v_mov_b32 v159, 0
  v_mov_b32 v160, 0
  v_mov_b32 v161, 0
  v_mov_b32 v162, 0
  v_mov_b32 v163, 0
  v_mov_b32 v164, 0
  v_mov_b32 v165, 0
  v_mov_b32 v166, 0
  v_mov_b32 v167, 0
  v_mov_b32 v168, 0
  v_mov_b32 v169, 0
  v_mov_b32 v170, 0
  v_mov_b32 v171, 0
  v_mov_b32 v172, 0
  v_mov_b32 v173, 0
  v_mov_b32 v174, 0
  v_mov_b32 v175, 0
  v_mov_b32 v176, 0
  v_mov_b32 v177, 0
  v_mov_b32 v178, 0
  v_mov_b32 v179, 0
  v_mov_b32 v180, 0
  v_mov_b32 v181, 0
  v_mov_b32 v182, 0
  v_mov_b32 v183, 0
  v_mov_b32 v184, 0
  v_mov_b32 v185, 0
  v_mov_b32 v186, 0
  v_mov_b32 v187, 0
  v_mov_b32 v188, 0
  v_mov_b32 v189, 0
  v_mov_b32 v190, 0
  v_mov_b32 v191, 0
  s_waitcnt vmcnt(12)
  s_barrier
  ds_read_b64_tr_b16 a[32:33], v14 offset:0
  ds_read_b64_tr_b16 a[34:35], v14 offset:8192
  ds_read_b64_tr_b16 a[36:37], v15 offset:0
  ds_read_b64_tr_b16 a[38:39], v15 offset:8192
  ds_read_b64_tr_b16 a[40:41], v16 offset:0
  ds_read_b64_tr_b16 a[42:43], v16 offset:8192
  ds_read_b64_tr_b16 a[44:45], v17 offset:0
  ds_read_b64_tr_b16 a[46:47], v17 offset:8192
  ds_read_b128 a[0:3], v12 offset:0
  ds_read_b128 a[4:7], v12 offset:1024
  ds_read_b128 a[8:11], v12 offset:2048
  ds_read_b128 a[12:15], v12 offset:3072
  ds_read_b128 a[16:19], v12 offset:4096
  ds_read_b128 a[20:23], v12 offset:5120
  ds_read_b128 a[24:27], v12 offset:6144
  ds_read_b128 a[28:31], v12 offset:7168
  s_waitcnt lgkmcnt(0)
L_loop_big_fm_kq:
  s_waitcnt lgkmcnt(4)
  v_mfma_f32_16x16x32_bf16 v[64:67], a[32:35], a[0:3], v[64:67]
  v_mfma_f32_16x16x32_bf16 v[68:71], a[36:39], a[0:3], v[68:71]
  v_mfma_f32_16x16x32_bf16 v[72:75], a[40:43], a[0:3], v[72:75]
  v_mfma_f32_16x16x32_bf16 v[76:79], a[44:47], a[0:3], v[76:79]
  s_waitcnt lgkmcnt(0)
  s_waitcnt vmcnt(8)
  s_barrier
  ds_read_b128 a[0:3], v12 offset:16384
  v_mfma_f32_16x16x32_bf16 v[80:83], a[32:35], a[4:7], v[80:83]
  s_add_u32 m0, s40, 0
  ds_read_b64_tr_b16 a[48:49], v14 offset:16384
  v_mfma_f32_16x16x32_bf16 v[84:87], a[36:39], a[4:7], v[84:87]
  buffer_load_dwordx4 v4, s[8:11], s32 offen offset:0 sc1 lds
  v_mfma_f32_16x16x32_bf16 v[88:91], a[40:43], a[4:7], v[88:91]
  buffer_load_dwordx4 v5, s[8:11], s32 offen offset:1024 sc1 lds
  s_add_u32 s32, s32, s33
  v_mfma_f32_16x16x32_bf16 v[92:95], a[44:47], a[4:7], v[92:95]
  ds_read_b128 a[4:7], v12 offset:17408
  v_mfma_f32_16x16x32_bf16 v[96:99], a[32:35], a[8:11], v[96:99]
  s_add_u32 m0, s41, 0
  ds_read_b64_tr_b16 a[50:51], v14 offset:24576
  v_mfma_f32_16x16x32_bf16 v[100:103], a[36:39], a[8:11], v[100:103]
  buffer_load_dwordx4 v8, s[12:15], s34 offen offset:0 lds
  v_mfma_f32_16x16x32_bf16 v[104:107], a[40:43], a[8:11], v[104:107]
  buffer_load_dwordx4 v9, s[12:15], s34 offen offset:1024 lds
  s_add_u32 s34, s34, s35
  v_mfma_f32_16x16x32_bf16 v[108:111], a[44:47], a[8:11], v[108:111]
  ds_read_b128 a[8:11], v12 offset:18432
  v_mfma_f32_16x16x32_bf16 v[112:115], a[32:35], a[12:15], v[112:115]
  ds_read_b64_tr_b16 a[52:53], v15 offset:16384
  v_mfma_f32_16x16x32_bf16 v[116:119], a[36:39], a[12:15], v[116:119]
  ds_read_b64_tr_b16 a[54:55], v15 offset:24576
  v_mfma_f32_16x16x32_bf16 v[120:123], a[40:43], a[12:15], v[120:123]
  ds_read_b64_tr_b16 a[56:57], v16 offset:16384
  v_mfma_f32_16x16x32_bf16 v[124:127], a[44:47], a[12:15], v[124:127]
  ds_read_b128 a[12:15], v12 offset:19456
  v_mfma_f32_16x16x32_bf16 v[128:131], a[32:35], a[16:19], v[128:131]
  ds_read_b64_tr_b16 a[58:59], v16 offset:24576
  v_mfma_f32_16x16x32_bf16 v[132:135], a[36:39], a[16:19], v[132:135]
  ds_read_b64_tr_b16 a[60:61], v17 offset:16384
  v_mfma_f32_16x16x32_bf16 v[136:139], a[40:43], a[16:19], v[136:139]
  ds_read_b64_tr_b16 a[62:63], v17 offset:24576
  v_mfma_f32_16x16x32_bf16 v[140:143], a[44:47], a[16:19], v[140:143]
  ds_read_b128 a[16:19], v12 offset:20480
  v_mfma_f32_16x16x32_bf16 v[144:147], a[32:35], a[20:23], v[144:147]
  v_mfma_f32_16x16x32_bf16 v[148:151], a[36:39], a[20:23], v[148:151]
  v_mfma_f32_16x16x32_bf16 v[152:155], a[40:43], a[20:23], v[152:155]
  v_mfma_f32_16x16x32_bf16 v[156:159], a[44:47], a[20:23], v[156:159]
  ds_read_b128 a[20:23], v12 offset:21504
  v_mfma_f32_16x16x32_bf16 v[160:163], a[32:35], a[24:27], v[160:163]
  v_mfma_f32_16x16x32_bf16 v[164:167], a[36:39], a[24:27], v[164:167]
  v_mfma_f32_16x16x32_bf16 v[168:171], a[40:43], a[24:27], v[168:171]
  v_mfma_f32_16x16x32_bf16 v[172:175], a[44:47], a[24:27], v[172:175]
  ds_read_b128 a[24:27], v12 offset:22528
  v_mfma_f32_16x16x32_bf16 v[176:179], a[32:35], a[28:31], v[176:179]
  v_mfma_f32_16x16x32_bf16 v[180:183], a[36:39], a[28:31], v[180:183]
  v_mfma_f32_16x16x32_bf16 v[184:187], a[40:43], a[28:31], v[184:187]
  v_mfma_f32_16x16x32_bf16 v[188:191], a[44:47], a[28:31], v[188:191]
  ds_read_b128 a[28:31], v12 offset:23552
  s_waitcnt lgkmcnt(4)
  v_mfma_f32_16x16x32_bf16 v[64:67], a[48:51], a[0:3], v[64:67]
  v_mfma_f32_16x16x32_bf16 v[68:71], a[52:55], a[0:3], v[68:71]
  v_mfma_f32_16x16x32_bf16 v[72:75], a[56:59], a[0:3], v[72:75]
  v_mfma_f32_16x16x32_bf16 v[76:79], a[60:63], a[0:3], v[76:79]
  s_waitcnt lgkmcnt(0)
  s_waitcnt vmcnt(8)
  s_barrier
  ds_read_b128 a[0:3], v12 offset:32768
  v_mfma_f32_16x16x32_bf16 v[80:83], a[48:51], a[4:7], v[80:83]
  s_add_u32 m0, s40, 16384
  ds_read_b64_tr_b16 a[32:33], v14 offset:32768
  v_mfma_f32_16x16x32_bf16 v[84:87], a[52:55], a[4:7], v[84:87]
  buffer_load_dwordx4 v4, s[8:11], s32 offen offset:0 sc1 lds
  v_mfma_f32_16x16x32_bf16 v[88:91], a[56:59], a[4:7], v[88:91]
  buffer_load_dwordx4 v5, s[8:11], s32 offen offset:1024 sc1 lds
  s_add_u32 s32, s32, s33
  v_mfma_f32_16x16x32_bf16 v[92:95], a[60:63], a[4:7], v[92:95]
  ds_read_b128 a[4:7], v12 offset:33792
  v_mfma_f32_16x16x32_bf16 v[96:99], a[48:51], a[8:11], v[96:99]
  s_add_u32 m0, s41, 16384
  ds_read_b64_tr_b16 a[34:35], v14 offset:40960
  v_mfma_f32_16x16x32_bf16 v[100:103], a[52:55], a[8:11], v[100:103]
  buffer_load_dwordx4 v8, s[12:15], s34 offen offset:0 lds
  v_mfma_f32_16x16x32_bf16 v[104:107], a[56:59], a[8:11], v[104:107]
  buffer_load_dwordx4 v9, s[12:15], s34 offen offset:1024 lds
  s_add_u32 s34, s34, s35
  v_mfma_f32_16x16x32_bf16 v[108:111], a[60:63], a[8:11], v[108:111]
  ds_read_b128 a[8:11], v12 offset:34816
  v_mfma_f32_16x16x32_bf16 v[112:115], a[48:51], a[12:15], v[112:115]
  ds_read_b64_tr_b16 a[36:37], v15 offset:32768
  v_mfma_f32_16x16x32_bf16 v[116:119], a[52:55], a[12:15], v[116:119]
  ds_read_b64_tr_b16 a[38:39], v15 offset:40960
  v_mfma_f32_16x16x32_bf16 v[120:123], a[56:59], a[12:15], v[120:123]
  ds_read_b64_tr_b16 a[40:41], v16 offset:32768
  v_mfma_f32_16x16x32_bf16 v[124:127], a[60:63], a[12:15], v[124:127]
  ds_read_b128 a[12:15], v12 offset:35840
  v_mfma_f32_16x16x32_bf16 v[128:131], a[48:51], a[16:19], v[128:131]
  ds_read_b64_tr_b16 a[42:43], v16 offset:40960
  v_mfma_f32_16x16x32_bf16 v[132:135], a[52:55], a[16:19], v[132:135]
  ds_read_b64_tr_b16 a[44:45], v17 offset:32768
  v_mfma_f32_16x16x32_bf16 v[136:139], a[56:59], a[16:19], v[136:139]
  ds_read_b64_tr_b16 a[46:47], v17 offset:40960
  v_mfma_f32_16x16x32_bf16 v[140:143], a[60:63], a[16:19], v[140:143]
  ds_read_b128 a[16:19], v12 offset:36864
  v_mfma_f32_16x16x32_bf16 v[144:147], a[48:51], a[20:23], v[144:147]
  v_mfma_f32_16x16x32_bf16 v[148:151], a[52:55], a[20:23], v[148:151]
  v_mfma_f32_16x16x32_bf16 v[152:155], a[56:59], a[20:23], v[152:155]
  v_mfma_f32_16x16x32_bf16 v[156:159], a[60:63], a[20:23], v[156:159]
  ds_read_b128 a[20:23], v12 offset:37888
  v_mfma_f32_16x16x32_bf16 v[160:163], a[48:51], a[24:27], v[160:163]
  v_mfma_f32_16x16x32_bf16 v[164:167], a[52:55], a[24:27], v[164:167]
  v_mfma_f32_16x16x32_bf16 v[168:171], a[56:59], a[24:27], v[168:171]
  v_mfma_f32_16x16x32_bf16 v[172:175], a[60:63], a[24:27], v[172:175]
  ds_read_b128 a[24:27], v12 offset:38912
  v_mfma_f32_16x16x32_bf16 v[176:179], a[48:51], a[28:31], v[176:179]
  v_mfma_f32_16x16x32_bf16 v[180:183], a[52:55], a[28:31], v[180:183]
  v_mfma_f32_16x16x32_bf16 v[184:187], a[56:59], a[28:31], v[184:187]
  v_mfma_f32_16x16x32_bf16 v[188:191], a[60:63], a[28:31], v[188:191]
  ds_read_b128 a[28:31], v12 offset:39936
  s_waitcnt lgkmcnt(4)
  v_mfma_f32_16x16x32_bf16 v[64:67], a[32:35], a[0:3], v[64:67]
  v_mfma_f32_16x16x32_bf16 v[68:71], a[36:39], a[0:3], v[68:71]
  v_mfma_f32_16x16x32_bf16 v[72:75], a[40:43], a[0:3], v[72:75]
  v_mfma_f32_16x16x32_bf16 v[76:79], a[44:47], a[0:3], v[76:79]
  s_waitcnt lgkmcnt(0)
  s_waitcnt vmcnt(8)
  s_barrier
  ds_read_b128 a[0:3], v12 offset:49152
  v_mfma_f32_16x16x32_bf16 v[80:83], a[32:35], a[4:7], v[80:83]
  s_add_u32 m0, s40, 32768
  ds_read_b64_tr_b16 a[48:49], v14 offset:49152
  v_mfma_f32_16x16x32_bf16 v[84:87], a[36:39], a[4:7], v[84:87]
  buffer_load_dwordx4 v4, s[8:11], s32 offen offset:0 sc1 lds
  v_mfma_f32_16x16x32_bf16 v[88:91], a[40:43], a[4:7], v[88:91]
  buffer_load_dwordx4 v5, s[8:11], s32 offen offset:1024 sc1 lds
  s_add_u32 s32, s32, s33
  v_mfma_f32_16x16x32_bf16 v[92:95], a[44:47], a[4:7], v[92:95]
  ds_read_b128 a[4:7], v12 offset:50176
  v_mfma_f32_16x16x32_bf16 v[96:99], a[32:35], a[8:11], v[96:99]
  s_add_u32 m0, s41, 32768
  ds_read_b64_tr_b16 a[50:51], v14 offset:57344
  v_mfma_f32_16x16x32_bf16 v[100:103], a[36:39], a[8:11], v[100:103]
  buffer_load_dwordx4 v8, s[12:15], s34 offen offset:0 lds
  v_mfma_f32_16x16x32_bf16 v[104:107], a[40:43], a[8:11], v[104:107]
  buffer_load_dwordx4 v9, s[12:15], s34 offen offset:1024 lds
  s_add_u32 s34, s34, s35
  v_mfma_f32_16x16x32_bf16 v[108:111], a[44:47], a[8:11], v[108:111]
  ds_read_b128 a[8:11], v12 offset:51200
  v_mfma_f32_16x16x32_bf16 v[112:115], a[32:35], a[12:15], v[112:115]
  ds_read_b64_tr_b16 a[52:53], v15 offset:49152
  v_mfma_f32_16x16x32_bf16 v[116:119], a[36:39], a[12:15], v[116:119]
  ds_read_b64_tr_b16 a[54:55], v15 offset:57344
  v_mfma_f32_16x16x32_bf16 v[120:123], a[40:43], a[12:15], v[120:123]
  ds_read_b64_tr_b16 a[56:57], v16 offset:49152
  v_mfma_f32_16x16x32_bf16 v[124:127], a[44:47], a[12:15], v[124:127]
  ds_read_b128 a[12:15], v12 offset:52224
  v_mfma_f32_16x16x32_bf16 v[128:131], a[32:35], a[16:19], v[128:131]
  ds_read_b64_tr_b16 a[58:59], v16 offset:57344
  v_mfma_f32_16x16x32_bf16 v[132:135], a[36:39], a[16:19], v[132:135]
  ds_read_b64_tr_b16 a[60:61], v17 offset:49152
  v_mfma_f32_16x16x32_bf16 v[136:139], a[40:43], a[16:19], v[136:139]
  ds_read_b64_tr_b16 a[62:63], v17 offset:57344
  v_mfma_f32_16x16x32_bf16 v[140:143], a[44:47], a[16:19], v[140:143]
  ds_read_b128 a[16:19], v12 offset:53248
  v_mfma_f32_16x16x32_bf16 v[144:147], a[32:35], a[20:23], v[144:147]
  v_mfma_f32_16x16x32_bf16 v[148:151], a[36:39], a[20:23], v[148:151]
  v_mfma_f32_16x16x32_bf16 v[152:155], a[40:43], a[20:23], v[152:155]
  v_mfma_f32_16x16x32_bf16 v[156:159], a[44:47], a[20:23], v[156:159]
  ds_read_b128 a[20:23], v12 offset:54272
  v_mfma_f32_16x16x32_bf16 v[160:163], a[32:35], a[24:27], v[160:163]
  v_mfma_f32_16x16x32_bf16 v[164:167], a[36:39], a[24:27], v[164:167]
  v_mfma_f32_16x16x32_bf16 v[168:171], a[40:43], a[24:27], v[168:171]
  v_mfma_f32_16x16x32_bf16 v[172:175], a[44:47], a[24:27], v[172:175]
  ds_read_b128 a[24:27], v12 offset:55296
  v_mfma_f32_16x16x32_bf16 v[176:179], a[32:35], a[28:31], v[176:179]
  v_mfma_f32_16x16x32_bf16 v[180:183], a[36:39], a[28:31], v[180:183]
  v_mfma_f32_16x16x32_bf16 v[184:187], a[40:43], a[28:31], v[184:187]
  v_mfma_f32_16x16x32_bf16 v[188:191], a[44:47], a[28:31], v[188:191]
  ds_read_b128 a[28:31], v12 offset:56320
  s_waitcnt lgkmcnt(4)
  v_mfma_f32_16x16x32_bf16 v[64:67], a[48:51], a[0:3], v[64:67]
  v_mfma_f32_16x16x32_bf16 v[68:71], a[52:55], a[0:3], v[68:71]
  v_mfma_f32_16x16x32_bf16 v[72:75], a[56:59], a[0:3], v[72:75]
  v_mfma_f32_16x16x32_bf16 v[76:79], a[60:63], a[0:3], v[76:79]
  s_waitcnt lgkmcnt(0)
  s_waitcnt vmcnt(8)
  s_barrier
  ds_read_b128 a[0:3], v12 offset:0
  v_mfma_f32_16x16x32_bf16 v[80:83], a[48:51], a[4:7], v[80:83]
  s_add_u32 m0, s40, 49152
  ds_read_b64_tr_b16 a[32:33], v14 offset:0
  v_mfma_f32_16x16x32_bf16 v[84:87], a[52:55], a[4:7], v[84:87]
  buffer_load_dwordx4 v4, s[8:11], s32 offen offset:0 sc1 lds
  v_mfma_f32_16x16x32_bf16 v[88:91], a[56:59], a[4:7], v[88:91]
  buffer_load_dwordx4 v5, s[8:11], s32 offen offset:1024 sc1 lds
  s_add_u32 s32, s32, s33
  v_mfma_f32_16x16x32_bf16 v[92:95], a[60:63], a[4:7], v[92:95]
  ds_read_b128 a[4:7], v12 offset:1024
  v_mfma_f32_16x16x32_bf16 v[96:99], a[48:51], a[8:11], v[96:99]
  s_add_u32 m0, s41, 49152
  ds_read_b64_tr_b16 a[34:35], v14 offset:8192
  v_mfma_f32_16x16x32_bf16 v[100:103], a[52:55], a[8:11], v[100:103]
  buffer_load_dwordx4 v8, s[12:15], s34 offen offset:0 lds
  v_mfma_f32_16x16x32_bf16 v[104:107], a[56:59], a[8:11], v[104:107]
  buffer_load_dwordx4 v9, s[12:15], s34 offen offset:1024 lds
  s_add_u32 s34, s34, s35
  v_mfma_f32_16x16x32_bf16 v[108:111], a[60:63], a[8:11], v[108:111]
  ds_read_b128 a[8:11], v12 offset:2048
  v_mfma_f32_16x16x32_bf16 v[112:115], a[48:51], a[12:15], v[112:115]
  ds_read_b64_tr_b16 a[36:37], v15 offset:0
  v_mfma_f32_16x16x32_bf16 v[116:119], a[52:55], a[12:15], v[116:119]
  ds_read_b64_tr_b16 a[38:39], v15 offset:8192
  v_mfma_f32_16x16x32_bf16 v[120:123], a[56:59], a[12:15], v[120:123]
  ds_read_b64_tr_b16 a[40:41], v16 offset:0
  v_mfma_f32_16x16x32_bf16 v[124:127], a[60:63], a[12:15], v[124:127]
  ds_read_b128 a[12:15], v12 offset:3072
  v_mfma_f32_16x16x32_bf16 v[128:131], a[48:51], a[16:19], v[128:131]
  ds_read_b64_tr_b16 a[42:43], v16 offset:8192
  v_mfma_f32_16x16x32_bf16 v[132:135], a[52:55], a[16:19], v[132:135]
  ds_read_b64_tr_b16 a[44:45], v17 offset:0
  v_mfma_f32_16x16x32_bf16 v[136:139], a[56:59], a[16:19], v[136:139]
  ds_read_b64_tr_b16 a[46:47], v17 offset:8192
  v_mfma_f32_16x16x32_bf16 v[140:143], a[60:63], a[16:19], v[140:143]
  ds_read_b128 a[16:19], v12 offset:4096
  v_mfma_f32_16x16x32_bf16 v[144:147], a[48:51], a[20:23], v[144:147]
  v_mfma_f32_16x16x32_bf16 v[148:151], a[52:55], a[20:23], v[148:151]
  v_mfma_f32_16x16x32_bf16 v[152:155], a[56:59], a[20:23], v[152:155]
  v_mfma_f32_16x16x32_bf16 v[156:159], a[60:63], a[20:23], v[156:159]
  ds_read_b128 a[20:23], v12 offset:5120
  v_mfma_f32_16x16x32_bf16 v[160:163], a[48:51], a[24:27], v[160:163]
  v_mfma_f32_16x16x32_bf16 v[164:167], a[52:55], a[24:27], v[164:167]
  v_mfma_f32_16x16x32_bf16 v[168:171], a[56:59], a[24:27], v[168:171]
  v_mfma_f32_16x16x32_bf16 v[172:175], a[60:63], a[24:27], v[172:175]
  ds_read_b128 a[24:27], v12 offset:6144
  v_mfma_f32_16x16x32_bf16 v[176:179], a[48:51], a[28:31], v[176:179]
  v_mfma_f32_16x16x32_bf16 v[180:183], a[52:55], a[28:31], v[180:183]
  v_mfma_f32_16x16x32_bf16 v[184:187], a[56:59], a[28:31], v[184:187]
  v_mfma_f32_16x16x32_bf16 v[188:191], a[60:63], a[28:31], v[188:191]
  ds_read_b128 a[28:31], v12 offset:7168
  s_sub_u32 s36, s36, 1
  s_cmp_lg_u32 s36, 0
  s_cbranch_scc1 L_loop_big_fm_kq
  s_waitcnt lgkmcnt(4)
  v_mfma_f32_16x16x32_bf16 v[64:67], a[32:35], a[0:3], v[64:67]
  v_mfma_f32_16x16x32_bf16 v[68:71], a[36:39], a[0:3], v[68:71]
  v_mfma_f32_16x16x32_bf16 v[72:75], a[40:43], a[0:3], v[72:75]
  v_mfma_f32_16x16x32_bf16 v[76:79], a[44:47], a[0:3], v[76:79]
  s_waitcnt lgkmcnt(0)
  s_waitcnt vmcnt(8)
  s_barrier
  ds_read_b128 a[0:3], v12 offset:16384
  v_mfma_f32_16x16x32_bf16 v[80:83], a[32:35], a[4:7], v[80:83]
  ds_read_b64_tr_b16 a[48:49], v14 offset:16384
  v_mfma_f32_16x16x32_bf16 v[84:87], a[36:39], a[4:7], v[84:87]
  ds_read_b64_tr_b16 a[50:51], v14 offset:24576
  v_mfma_f32_16x16x32_bf16 v[88:91], a[40:43], a[4:7], v[88:91]
  ds_read_b64_tr_b16 a[52:53], v15 offset:16384
  v_mfma_f32_16x16x32_bf16 v[92:95], a[44:47], a[4:7], v[92:95]
  ds_read_b128 a[4:7], v12 offset:17408
  v_mfma_f32_16x16x32_bf16 v[96:99], a[32:35], a[8:11], v[96:99]
  ds_read_b64_tr_b16 a[54:55], v15 offset:24576
  v_mfma_f32_16x16x32_bf16 v[100:103], a[36:39], a[8:11], v[100:103]
  ds_read_b64_tr_b16 a[56:57], v16 offset:16384
  v_mfma_f32_16x16x32_bf16 v[104:107], a[40:43], a[8:11], v[104:107]
  ds_read_b64_tr_b16 a[58:59], v16 offset:24576
  v_mfma_f32_16x16x32_bf16 v[108:111], a[44:47], a[8:11], v[108:111]
  ds_read_b128 a[8:11], v12 offset:18432
  v_mfma_f32_16x16x32_bf16 v[112:115], a[32:35], a[12:15], v[112:115]
  ds_read_b64_tr_b16 a[60:61], v17 offset:16384
  v_mfma_f32_16x16x32_bf16 v[116:119], a[36:39], a[12:15], v[116:119]
  ds_read_b64_tr_b16 a[62:63], v17 offset:24576
  v_mfma_f32_16x16x32_bf16 v[120:123], a[40:43], a[12:15], v[120:123]
  v_mfma_f32_16x16x32_bf16 v[124:127], a[44:47], a[12:15], v[124:127]
  ds_read_b128 a[12:15], v12 offset:19456
  v_mfma_f32_16x16x32_bf16 v[128:131], a[32:35], a[16:19], v[128:131]
  v_mfma_f32_16x16x32_bf16 v[132:135], a[36:39], a[16:19], v[132:135]
  v_mfma_f32_16x16x32_bf16 v[136:139], a[40:43], a[16:19], v[136:139]
  v_mfma_f32_16x16x32_bf16 v[140:143], a[44:47], a[16:19], v[140:143]
  ds_read_b128 a[16:19], v12 offset:20480
  v_mfma_f32_16x16x32_bf16 v[144:147], a[32:35], a[20:23], v[144:147]
  v_mfma_f32_16x16x32_bf16 v[148:151], a[36:39], a[20:23], v[148:151]
  v_mfma_f32_16x16x32_bf16 v[152:155], a[40:43], a[20:23], v[152:155]
  v_mfma_f32_16x16x32_bf16 v[156:159], a[44:47], a[20:23], v[156:159]
  ds_read_b128 a[20:23], v12 offset:21504
  v_mfma_f32_16x16x32_bf16 v[160:163], a[32:35], a[24:27], v[160:163]
  v_mfma_f32_16x16x32_bf16 v[164:167], a[36:39], a[24:27], v[164:167]
  v_mfma_f32_16x16x32_bf16 v[168:171], a[40:43], a[24:27], v[168:171]
  v_mfma_f32_16x16x32_bf16 v[172:175], a[44:47], a[24:27], v[172:175]
  ds_read_b128 a[24:27], v12 offset:22528
  v_mfma_f32_16x16x32_bf16 v[176:179], a[32:35], a[28:31], v[176:179]
  v_mfma_f32_16x16x32_bf16 v[180:183], a[36:39], a[28:31], v[180:183]
  v_mfma_f32_16x16x32_bf16 v[184:187], a[40:43], a[28:31], v[184:187]
  v_mfma_f32_16x16x32_bf16 v[188:191], a[44:47], a[28:31], v[188:191]
  ds_read_b128 a[28:31], v12 offset:23552
  s_waitcnt lgkmcnt(5)
  v_mfma_f32_16x16x32_bf16 v[64:67], a[48:51], a[0:3], v[64:67]
  v_mfma_f32_16x16x32_bf16 v[68:71], a[52:55], a[0:3], v[68:71]
  v_mfma_f32_16x16x32_bf16 v[72:75], a[56:59], a[0:3], v[72:75]
  v_mfma_f32_16x16x32_bf16 v[76:79], a[60:63], a[0:3], v[76:79]
  s_waitcnt lgkmcnt(0)
  s_waitcnt vmcnt(4)
  s_barrier
  ds_read_b128 a[0:3], v12 offset:32768
  v_mfma_f32_16x16x32_bf16 v[80:83], a[48:51], a[4:7], v[80:83]
  ds_read_b64_tr_b16 a[32:33], v14 offset:32768
  v_mfma_f32_16x16x32_bf16 v[84:87], a[52:55], a[4:7], v[84:87]
  ds_read_b64_tr_b16 a[34:35], v14 offset:40960
  v_mfma_f32_16x16x32_bf16 v[88:91], a[56:59], a[4:7], v[88:91]
  ds_read_b64_tr_b16 a[36:37], v15 offset:32768
  v_mfma_f32_16x16x32_bf16 v[92:95], a[60:63], a[4:7], v[92:95]
  ds_read_b128 a[4:7], v12 offset:33792
  v_mfma_f32_16x16x32_bf16 v[96:99], a[48:51], a[8:11], v[96:99]
  ds_read_b64_tr_b16 a[38:39], v15 offset:40960
  v_mfma_f32_16x16x32_bf16 v[100:103], a[52:55], a[8:11], v[100:103]
  ds_read_b64_tr_b16 a[40:41], v16 offset:32768
  v_mfma_f32_16x16x32_bf16 v[104:107], a[56:59], a[8:11], v[104:107]
  ds_read_b64_tr_b16 a[42:43], v16 offset:40960
  v_mfma_f32_16x16x32_bf16 v[108:111], a[60:63], a[8:11], v[108:111]
  ds_read_b128 a[8:11], v12 offset:34816
  v_mfma_f32_16x16x32_bf16 v[112:115], a[48:51], a[12:15], v[112:115]
  ds_read_b64_tr_b16 a[44:45], v17 offset:32768
  v_mfma_f32_16x16x32_bf16 v[116:119], a[52:55], a[12:15], v[116:119]
  ds_read_b64_tr_b16 a[46:47], v17 offset:40960
  v_mfma_f32_16x16x32_bf16 v[120:123], a[56:59], a[12:15], v[120:123]
  v_mfma_f32_16x16x32_bf16 v[124:127], a[60:63], a[12:15], v[124:127]
  ds_read_b128 a[12:15], v12 offset:35840
  v_mfma_f32_16x16x32_bf16 v[128:131], a[48:51], a[16:19], v[128:131]
  v_mfma_f32_16x16x32_bf16 v[132:135], a[52:55], a[16:19], v[132:135]
  v_mfma_f32_16x16x32_bf16 v[136:139], a[56:59], a[16:19], v[136:139]
  v_mfma_f32_16x16x32_bf16 v[140:143], a[60:63], a[16:19], v[140:143]
  ds_read_b128 a[16:19], v12 offset:36864
  v_mfma_f32_16x16x32_bf16 v[144:147], a[48:51], a[20:23], v[144:147]
  v_mfma_f32_16x16x32_bf16 v[148:151], a[52:55], a[20:23], v[148:151]
  v_mfma_f32_16x16x32_bf16 v[152:155], a[56:59], a[20:23], v[152:155]
  v_mfma_f32_16x16x32_bf16 v[156:159], a[60:63], a[20:23], v[156:159]
  ds_read_b128 a[20:23], v12 offset:37888
  v_mfma_f32_16x16x32_bf16 v[160:163], a[48:51], a[24:27], v[160:163]
  v_mfma_f32_16x16x32_bf16 v[164:167], a[52:55], a[24:27], v[164:167]
  v_mfma_f32_16x16x32_bf16 v[168:171], a[56:59], a[24:27], v[168:171]
  v_mfma_f32_16x16x32_bf16 v[172:175], a[60:63], a[24:27], v[172:175]
  ds_read_b128 a[24:27], v12 offset:38912
  v_mfma_f32_16x16x32_bf16 v[176:179], a[48:51], a[28:31], v[176:179]
  v_mfma_f32_16x16x32_bf16 v[180:183], a[52:55], a[28:31], v[180:183]
  v_mfma_f32_16x16x32_bf16 v[184:187], a[56:59], a[28:31], v[184:187]
  v_mfma_f32_16x16x32_bf16 v[188:191], a[60:63], a[28:31], v[188:191]
  ds_read_b128 a[28:31], v12 offset:39936
  s_waitcnt lgkmcnt(5)
  v_mfma_f32_16x16x32_bf16 v[64:67], a[32:35], a[0:3], v[64:67]
  v_mfma_f32_16x16x32_bf16 v[68:71], a[36:39], a[0:3], v[68:71]
  v_mfma_f32_16x16x32_bf16 v[72:75], a[40:43], a[0:3], v[72:75]
  v_mfma_f32_16x16x32_bf16 v[76:79], a[44:47], a[0:3], v[76:79]
  s_waitcnt lgkmcnt(0)
  s_waitcnt vmcnt(0)
  s_barrier
  ds_read_b128 a[0:3], v12 offset:49152
  v_mfma_f32_16x16x32_bf16 v[80:83], a[32:35], a[4:7], v[80:83]
  ds_read_b64_tr_b16 a[48:49], v14 offset:49152
  v_mfma_f32_16x16x32_bf16 v[84:87], a[36:39], a[4:7], v[84:87]
  ds_read_b64_tr_b16 a[50:51], v14 offset:57344
  v_mfma_f32_16x16x32_bf16 v[88:91], a[40:43], a[4:7], v[88:91]
  ds_read_b64_tr_b16 a[52:53], v15 offset:49152
  v_mfma_f32_16x16x32_bf16 v[92:95], a[44:47], a[4:7], v[92:95]
  ds_read_b128 a[4:7], v12 offset:50176
  v_mfma_f32_16x16x32_bf16 v[96:99], a[32:35], a[8:11], v[96:99]
  ds_read_b64_tr_b16 a[54:55], v15 offset:57344
  v_mfma_f32_16x16x32_bf16 v[100:103], a[36:39], a[8:11], v[100:103]
  ds_read_b64_tr_b16 a[56:57], v16 offset:49152
  v_mfma_f32_16x16x32_bf16 v[104:107], a[40:43], a[8:11], v[104:107]
  ds_read_b64_tr_b16 a[58:59], v16 offset:57344
  v_mfma_f32_16x16x32_bf16 v[108:111], a[44:47], a[8:11], v[108:111]
  ds_read_b128 a[8:11], v12 offset:51200
  v_mfma_f32_16x16x32_bf16 v[112:115], a[32:35], a[12:15], v[112:115]
  ds_read_b64_tr_b16 a[60:61], v17 offset:49152
  v_mfma_f32_16x16x32_bf16 v[116:119], a[36:39], a[12:15], v[116:119]
  ds_read_b64_tr_b16 a[62:63], v17 offset:57344
  v_mfma_f32_16x16x32_bf16 v[120:123], a[40:43], a[12:15], v[120:123]
  v_mfma_f32_16x16x32_bf16 v[124:127], a[44:47], a[12:15], v[124:127]
  ds_read_b128 a[12:15], v12 offset:52224
  v_mfma_f32_16x16x32_bf16 v[128:131], a[32:35], a[16:19], v[128:131]
  v_mfma_f32_16x16x32_bf16 v[132:135], a[36:39], a[16:19], v[132:135]
  v_mfma_f32_16x16x32_bf16 v[136:139], a[40:43], a[16:19], v[136:139]
  v_mfma_f32_16x16x32_bf16 v[140:143], a[44:47], a[16:19], v[140:143]
  ds_read_b128 a[16:19], v12 offset:53248
  v_mfma_f32_16x16x32_bf16 v[144:147], a[32:35], a[20:23], v[144:147]
  v_mfma_f32_16x16x32_bf16 v[148:151], a[36:39], a[20:23], v[148:151]
  v_mfma_f32_16x16x32_bf16 v[152:155], a[40:43], a[20:23], v[152:155]
  v_mfma_f32_16x16x32_bf16 v[156:159], a[44:47], a[20:23], v[156:159]
  ds_read_b128 a[20:23], v12 offset:54272
  v_mfma_f32_16x16x32_bf16 v[160:163], a[32:35], a[24:27], v[160:163]
  v_mfma_f32_16x16x32_bf16 v[164:167], a[36:39], a[24:27], v[164:167]
  v_mfma_f32_16x16x32_bf16 v[168:171], a[40:43], a[24:27], v[168:171]
  v_mfma_f32_16x16x32_bf16 v[172:175], a[44:47], a[24:27], v[172:175]
  ds_read_b128 a[24:27], v12 offset:55296
  v_mfma_f32_16x16x32_bf16 v[176:179], a[32:35], a[28:31], v[176:179]
  v_mfma_f32_16x16x32_bf16 v[180:183], a[36:39], a[28:31], v[180:183]
  v_mfma_f32_16x16x32_bf16 v[184:187], a[40:43], a[28:31], v[184:187]
  v_mfma_f32_16x16x32_bf16 v[188:191], a[44:47], a[28:31], v[188:191]
  ds_read_b128 a[28:31], v12 offset:56320
  s_waitcnt lgkmcnt(5)
  v_mfma_f32_16x16x32_bf16 v[64:67], a[48:51], a[0:3], v[64:67]
  v_mfma_f32_16x16x32_bf16 v[68:71], a[52:55], a[0:3], v[68:71]
  v_mfma_f32_16x16x32_bf16 v[72:75], a[56:59], a[0:3], v[72:75]
  v_mfma_f32_16x16x32_bf16 v[76:79], a[60:63], a[0:3], v[76:79]
  v_mfma_f32_16x16x32_bf16 v[80:83], a[48:51], a[4:7], v[80:83]
  v_mfma_f32_16x16x32_bf16 v[84:87], a[52:55], a[4:7], v[84:87]
  v_mfma_f32_16x16x32_bf16 v[88:91], a[56:59], a[4:7], v[88:91]
  v_mfma_f32_16x16x32_bf16 v[92:95], a[60:63], a[4:7], v[92:95]
  v_mfma_f32_16x16x32_bf16 v[96:99], a[48:51], a[8:11], v[96:99]
  v_mfma_f32_16x16x32_bf16 v[100:103], a[52:55], a[8:11], v[100:103]
  v_mfma_f32_16x16x32_bf16 v[104:107], a[56:59], a[8:11], v[104:107]
  v_mfma_f32_16x16x32_bf16 v[108:111], a[60:63], a[8:11], v[108:111]
  s_waitcnt lgkmcnt(4)
  v_mfma_f32_16x16x32_bf16 v[112:115], a[48:51], a[12:15], v[112:115]
  v_mfma_f32_16x16x32_bf16 v[116:119], a[52:55], a[12:15], v[116:119]
  v_mfma_f32_16x16x32_bf16 v[120:123], a[56:59], a[12:15], v[120:123]
  v_mfma_f32_16x16x32_bf16 v[124:127], a[60:63], a[12:15], v[124:127]
  s_waitcnt lgkmcnt(3)
  v_mfma_f32_16x16x32_bf16 v[128:131], a[48:51], a[16:19], v[128:131]
  v_mfma_f32_16x16x32_bf16 v[132:135], a[52:55], a[16:19], v[132:135]
  v_mfma_f32_16x16x32_bf16 v[136:139], a[56:59], a[16:19], v[136:139]
  v_mfma_f32_16x16x32_bf16 v[140:143], a[60:63], a[16:19], v[140:143]
  s_waitcnt lgkmcnt(2)
  v_mfma_f32_16x16x32_bf16 v[144:147], a[48:51], a[20:23], v[144:147]
  v_mfma_f32_16x16x32_bf16 v[148:151], a[52:55], a[20:23], v[148:151]
  v_mfma_f32_16x16x32_bf16 v[152:155], a[56:59], a[20:23], v[152:155]
  v_mfma_f32_16x16x32_bf16 v[156:159], a[60:63], a[20:23], v[156:159]
  s_waitcnt lgkmcnt(1)
  v_mfma_f32_16x16x32_bf16 v[160:163], a[48:51], a[24:27], v[160:163]
  v_mfma_f32_16x16x32_bf16 v[164:167], a[52:55], a[24:27], v[164:167]
  v_mfma_f32_16x16x32_bf16 v[168:171], a[56:59], a[24:27], v[168:171]
  v_mfma_f32_16x16x32_bf16 v[172:175], a[60:63], a[24:27], v[172:175]
  s_waitcnt lgkmcnt(0)
  v_mfma_f32_16x16x32_bf16 v[176:179], a[48:51], a[28:31], v[176:179]
  v_mfma_f32_16x16x32_bf16 v[180:183], a[52:55], a[28:31], v[180:183]
  v_mfma_f32_16x16x32_bf16 v[184:187], a[56:59], a[28:31], v[184:187]
  v_mfma_f32_16x16x32_bf16 v[188:191], a[60:63], a[28:31], v[188:191]
L_episel_42:
  s_nop 7
L_epi_plain_41:
  s_lshr_b32 s42, s28, 2
  s_and_b32 s43, s28, 3
  s_mul_i32 s45, s43, 2048
  s_add_u32 s45, s45, s37
  s_mul_i32 s44, s42, 8
  s_mul_i32 s44, s44, s38
  s_add_u32 s44, s44, s45
  v_cvt_pk_bf16_f32 v44, v64, v65
  v_cvt_pk_bf16_f32 v45, v66, v67
  v_cvt_pk_bf16_f32 v46, v68, v69
  v_cvt_pk_bf16_f32 v47, v70, v71
  buffer_store_dwordx4 v[44:47], v18, s[4:7], s44 offen offset:0 sc1
  v_cvt_pk_bf16_f32 v48, v72, v73
  v_cvt_pk_bf16_f32 v49, v74, v75
  v_cvt_pk_bf16_f32 v50, v76, v77
  v_cvt_pk_bf16_f32 v51, v78, v79
  buffer_store_dwordx4 v[48:51], v18, s[4:7], s44 offen offset:1024 sc1
  s_add_u32 s44, s44, s38
  v_cvt_pk_bf16_f32 v52, v80, v81
  v_cvt_pk_bf16_f32 v53, v82, v83
  v_cvt_pk_bf16_f32 v54, v84, v85
  v_cvt_pk_bf16_f32 v55, v86, v87
  buffer_store_dwordx4 v[52:55], v18, s[4:7], s44 offen offset:0 sc1
  v_cvt_pk_bf16_f32 v56, v88, v89
  v_cvt_pk_bf16_f32 v57, v90, v91
  v_cvt_pk_bf16_f32 v58, v92, v93
  v_cvt_pk_bf16_f32 v59, v94, v95
  buffer_store_dwordx4 v[56:59], v18, s[4:7], s44 offen offset:1024 sc1
  s_add_u32 s44, s44, s38
  v_cvt_pk_bf16_f32 v44, v96, v97
  v_cvt_pk_bf16_f32 v45, v98, v99
  v_cvt_pk_bf16_f32 v46, v100, v101
  v_cvt_pk_bf16_f32 v47, v102, v103
  buffer_store_dwordx4 v[44:47], v18, s[4:7], s44 offen offset:0 sc1
  v_cvt_pk_bf16_f32 v48, v104, v105
  v_cvt_pk_bf16_f32 v49, v106, v107
  v_cvt_pk_bf16_f32 v50, v108, v109
  v_cvt_pk_bf16_f32 v51, v110, v111
  buffer_store_dwordx4 v[48:51], v18, s[4:7], s44 offen offset:1024 sc1
  s_add_u32 s44, s44, s38
  v_cvt_pk_bf16_f32 v52, v112, v113
  v_cvt_pk_bf16_f32 v53, v114, v115
  v_cvt_pk_bf16_f32 v54, v116, v117
  v_cvt_pk_bf16_f32 v55, v118, v119
  buffer_store_dwordx4 v[52:55], v18, s[4:7], s44 offen offset:0 sc1
  v_cvt_pk_bf16_f32 v56, v120, v121
  v_cvt_pk_bf16_f32 v57, v122, v123
  v_cvt_pk_bf16_f32 v58, v124, v125
  v_cvt_pk_bf16_f32 v59, v126, v127
  buffer_store_dwordx4 v[56:59], v18, s[4:7], s44 offen offset:1024 sc1
  s_add_u32 s44, s44, s38
  v_cvt_pk_bf16_f32 v44, v128, v129
  v_cvt_pk_bf16_f32 v45, v130, v131
  v_cvt_pk_bf16_f32 v46, v132, v133
  v_cvt_pk_bf16_f32 v47, v134, v135
  buffer_store_dwordx4 v[44:47], v18, s[4:7], s44 offen offset:0 sc1
  v_cvt_pk_bf16_f32 v48, v136, v137
  v_cvt_pk_bf16_f32 v49, v138, v139
  v_cvt_pk_bf16_f32 v50, v140, v141
  v_cvt_pk_bf16_f32 v51, v142, v143
  buffer_store_dwordx4 v[48:51], v18, s[4:7], s44 offen offset:1024 sc1
  s_add_u32 s44, s44, s38
  v_cvt_pk_bf16_f32 v52, v144, v145
  v_cvt_pk_bf16_f32 v53, v146, v147
  v_cvt_pk_bf16_f32 v54, v148, v149
  v_cvt_pk_bf16_f32 v55, v150, v151
  buffer_store_dwordx4 v[52:55], v18, s[4:7], s44 offen offset:0 sc1
  v_cvt_pk_bf16_f32 v56, v152, v153
  v_cvt_pk_bf16_f32 v57, v154, v155
  v_cvt_pk_bf16_f32 v58, v156, v157
  v_cvt_pk_bf16_f32 v59, v158, v159
  buffer_store_dwordx4 v[56:59], v18, s[4:7], s44 offen offset:1024 sc1
  s_add_u32 s44, s44, s38
  v_cvt_pk_bf16_f32 v44, v160, v161
  v_cvt_pk_bf16_f32 v45, v162, v163
  v_cvt_pk_bf16_f32 v46, v164, v165
  v_cvt_pk_bf16_f32 v47, v166, v167
  buffer_store_dwordx4 v[44:47], v18, s[4:7], s44 offen offset:0 sc1
  v_cvt_pk_bf16_f32 v48, v168, v169
  v_cvt_pk_bf16_f32 v49, v170, v171
  v_cvt_pk_bf16_f32 v50, v172, v173
  v_cvt_pk_bf16_f32 v51, v174, v175
  buffer_store_dwordx4 v[48:51], v18, s[4:7], s44 offen offset:1024 sc1
  s_add_u32 s44, s44, s38
  v_cvt_pk_bf16_f32 v52, v176, v177
  v_cvt_pk_bf16_f32 v53, v178, v179
  v_cvt_pk_bf16_f32 v54, v180, v181
  v_cvt_pk_bf16_f32 v55, v182, v183
  buffer_store_dwordx4 v[52:55], v18, s[4:7], s44 offen offset:0 sc1
  v_cvt_pk_bf16_f32 v56, v184, v185
  v_cvt_pk_bf16_f32 v57, v186, v187
  v_cvt_pk_bf16_f32 v58, v188, v189
  v_cvt_pk_bf16_f32 v59, v190, v191
  buffer_store_dwordx4 v[56:59], v18, s[4:7], s44 offen offset:1024 sc1
  s_branch L_done
L_body_half_fn_kq:
  s_lshr_b32 s42, s28, 1
  s_and_b32 s43, s28, 1
  s_mul_i32 s40, s28, 2048
  s_mul_i32 s41, s28, 1024
  s_add_u32 s41, s41, 65536
  v_lshlrev_b32 v18, 4, v1
  s_mul_i32 s44, s42, 4096
  v_lshrrev_b32 v22, 4, v1
  v_and_b32 v23, 15, v1
  v_add_u32 v12, s44, v18
  s_mul_i32 s44, s28, 2
  s_add_u32 s44, s44, 0
  s_mul_i32 s44, s44, s45
  v_add_u32 v4, s44, v18
  s_mul_i32 s44, s28, 2
  s_add_u32 s44, s44, 1
  s_mul_i32 s44, s44, s45
  s_sub_u32 s44, s44, 1024
  v_add_u32 v5, s44, v18
  v_lshrrev_b32 v23, 4, v1
  v_and_b32 v24, 15, v1
  s_mul_i32 s44, s28, 4
  s_add_u32 s44, s44, 0
  v_add_u32 v20, s44, v23
  v_and_b32 v21, 3, v20
  v_bfe_u32 v22, v20, 3, 1
  v_lshl_or_b32 v21, v22, 2, v21
  v_lshlrev_b32 v21, 1, v21
  v_xor_b32 v21, v21, v24
  v_mul_lo_u32 v20, v20, s39
  v_lshl_add_u32 v8, v21, 4, v20
  v_bfe_u32 v20, v1, 2, 2
  v_lshrrev_b32 v21, 4, v1
  v_lshl_add_u32 v22, v21, 3, v20
  v_mul_u32_u24 v22, 256, v22
  v_and_b32 v23, 3, v1
  v_lshl_add_u32 v22, v23, 3, v22
  v_add_u32 v22, 65536, v22
  v_and_b32 v21, 1, v21
  v_lshl_or_b32 v20, v21, 2, v20
  s_mul_i32 s44, s43, 4
  s_add_u32 s44, s44, 0
  v_xor_b32 v21, s44, v20
  v_lshl_add_u32 v14, v21, 5, v22
  s_mul_i32 s44, s43, 4
  s_add_u32 s44, s44, 1
  v_xor_b32 v21, s44, v20
  v_lshl_add_u32 v15, v21, 5, v22
  s_mul_i32 s44, s43, 4
  s_add_u32 s44, s44, 2
  v_xor_b32 v21, s44, v20
  v_lshl_add_u32 v16, v21, 5, v22
  s_mul_i32 s44, s43, 4
  s_add_u32 s44, s44, 3
  v_xor_b32 v21, s44, v20
  v_lshl_add_u32 v17, v21, 5, v22
  s_add_u32 m0, s40, 0
  s_nop 0
  buffer_load_dwordx4 v4, s[8:11], s32 offen offset:0 sc1 lds
  buffer_load_dwordx4 v5, s[8:11], s32 offen offset:1024 sc1 lds
  s_add_u32 s32, s32, s33
  s_add_u32 m0, s41, 0
  s_nop 0
  buffer_load_dwordx4 v8, s[12:15], s34 offen offset:0 lds
  s_add_u32 s34, s34, s35
  s_add_u32 m0, s40, 16384
  s_nop 0
  buffer_load_dwordx4 v4, s[8:11], s32 offen offset:0 sc1 lds
  buffer_load_dwordx4 v5, s[8:11], s32 offen offset:1024 sc1 lds
  s_add_u32 s32, s32, s33
  s_add_u32 m0, s41, 8192
  s_nop 0
  buffer_load_dwordx4 v8, s[12:15], s34 offen offset:0 lds
  s_add_u32 s34, s34, s35
  s_add_u32 m0, s40, 32768
  s_nop 0
  buffer_load_dwordx4 v4, s[8:11], s32 offen offset:0 sc1 lds
  buffer_load_dwordx4 v5, s[8:11], s32 offen offset:1024 sc1 lds
  s_add_u32 s32, s32, s33
  s_add_u32 m0, s41, 16384
  s_nop 0
  buffer_load_dwordx4 v8, s[12:15], s34 offen offset:0 lds
  s_add_u32 s34, s34, s35
  s_add_u32 m0, s40, 49152
  s_nop 0
  buffer_load_dwordx4 v4, s[8:11], s32 offen offset:0 sc1 lds
  buffer_load_dwordx4 v5, s[8:11], s32 offen offset:1024 sc1 lds
  s_add_u32 s32, s32, s33
  s_add_u32 m0, s41, 24576
  s_nop 0
  buffer_load_dwordx4 v8, s[12:15], s34 offen offset:0 lds
  s_add_u32 s34, s34, s35
  v_mov_b32 v64, 0
  v_mov_b32 v65, 0
  v_mov_b32 v66, 0
  v_mov_b32 v67, 0
  v_mov_b32 v68, 0
  v_mov_b32 v69, 0
  v_mov_b32 v70, 0
  v_mov_b32 v71, 0
  v_mov_b32 v72, 0
  v_mov_b32 v73, 0
  v_mov_b32 v74, 0
  v_mov_b32 v75, 0
  v_mov_b32 v76, 0
  v_mov_b32 v77, 0
  v_mov_b32 v78, 0
  v_mov_b32 v79, 0
  v_mov_b32 v80, 0
  v_mov_b32 v81, 0
  v_mov_b32 v82, 0
  v_mov_b32 v83, 0
  v_mov_b32 v84, 0
  v_mov_b32 v85, 0
  v_mov_b32 v86, 0
  v_mov_b32 v87, 0
  v_mov_b32 v88, 0
  v_mov_b32 v89, 0
  v_mov_b32 v90, 0
  v_mov_b32 v91, 0
  v_mov_b32 v92, 0
  v_mov_b32 v93, 0
  v_mov_b32 v94, 0
  v_mov_b32 v95, 0
  v_mov_b32 v96, 0
  v_mov_b32 v97, 0
  v_mov_b32 v98, 0
  v_mov_b32 v99, 0
  v_mov_b32 v100, 0
  v_mov_b32 v101, 0
  v_mov_b32 v102, 0
  v_mov_b32 v103, 0
  v_mov_b32 v104, 0
  v_mov_b32 v105, 0
  v_mov_b32 v106, 0
  v_mov_b32 v107, 0
  v_mov_b32 v108, 0
  v_mov_b32 v109, 0
  v_mov_b32 v110, 0
  v_mov_b32 v111, 0
  v_mov_b32 v112, 0
  v_mov_b32 v113, 0
  v_mov_b32 v114, 0
  v_mov_b32 v115, 0
  v_mov_b32 v116, 0
  v_mov_b32 v117, 0
  v_mov_b32 v118, 0
  v_mov_b32 v119, 0
  v_mov_b32 v120, 0
  v_mov_b32 v121, 0
  v_mov_b32 v122, 0
  v_mov_b32 v123, 0
  v_mov_b32 v124, 0
  v_mov_b32 v125, 0
  v_mov_b32 v126, 0
  v_mov_b32 v127, 0
  s_waitcnt vmcnt(9)
  s_barrier
  ds_read_b64_tr_b16 a[32:33], v14 offset:0
  ds_read_b64_tr_b16 a[34:35], v14 offset:1024
  ds_read_b64_tr_b16 a[36:37], v15 offset:0
  ds_read_b64_tr_b16 a[38:39], v15 offset:1024
  ds_read_b64_tr_b16 a[40:41], v16 offset:0
  ds_read_b64_tr_b16 a[42:43], v16 offset:1024
  ds_read_b64_tr_b16 a[44:45], v17 offset:0
  ds_read_b64_tr_b16 a[46:47], v17 offset:1024
  ds_read_b128 a[0:3], v12 offset:0
  ds_read_b128 a[4:7], v12 offset:1024
  ds_read_b128 a[8:11], v12 offset:2048
  ds_read_b128 a[12:15], v12 offset:3072
  s_waitcnt lgkmcnt(0)
L_loop_half_fn_kq:
  s_waitcnt lgkmcnt(3)
  v_mfma_f32_16x16x32_bf16 v[64:67], a[32:35], a[0:3], v[64:67]
  v_mfma_f32_16x16x32_bf16 v[68:71], a[36:39], a[0:3], v[68:71]
  v_mfma_f32_16x16x32_bf16 v[72:75], a[40:43], a[0:3], v[72:75]
  v_mfma_f32_16x16x32_bf16 v[76:79], a[44:47], a[0:3], v[76:79]
  s_waitcnt lgkmcnt(0)
  s_waitcnt vmcnt(6)
  s_barrier
  ds_read_b64_tr_b16 a[48:49], v14 offset:8192
  ds_read_b64_tr_b16 a[50:51], v14 offset:9216
  v_mfma_f32_16x16x32_bf16 v[80:83], a[32:35], a[4:7], v[80:83]
  ds_read_b64_tr_b16 a[52:53], v15 offset:8192
  ds_read_b64_tr_b16 a[54:55], v15 offset:9216
  v_mfma_f32_16x16x32_bf16 v[84:87], a[36:39], a[4:7], v[84:87]
  ds_read_b64_tr_b16 a[56:57], v16 offset:8192
  ds_read_b64_tr_b16 a[58:59], v16 offset:9216
  v_mfma_f32_16x16x32_bf16 v[88:91], a[40:43], a[4:7], v[88:91]
  ds_read_b64_tr_b16 a[60:61], v17 offset:8192
  ds_read_b64_tr_b16 a[62:63], v17 offset:9216
  v_mfma_f32_16x16x32_bf16 v[92:95], a[44:47], a[4:7], v[92:95]
  ds_read_b128 a[16:19], v12 offset:16384
  v_mfma_f32_16x16x32_bf16 v[96:99], a[32:35], a[8:11], v[96:99]
  ds_read_b128 a[20:23], v12 offset:17408
  v_mfma_f32_16x16x32_bf16 v[100:103], a[36:39], a[8:11], v[100:103]
  ds_read_b128 a[24:27], v12 offset:18432
  v_mfma_f32_16x16x32_bf16 v[104:107], a[40:43], a[8:11], v[104:107]
  ds_read_b128 a[28:31], v12 offset:19456
  v_mfma_f32_16x16x32_bf16 v[108:111], a[44:47], a[8:11], v[108:111]
  s_add_u32 m0, s40, 0
  v_mfma_f32_16x16x32_bf16 v[112:115], a[32:35], a[12:15], v[112:115]
  buffer_load_dwordx4 v4, s[8:11], s32 offen offset:0 sc1 lds
  v_mfma_f32_16x16x32_bf16 v[116:119], a[36:39], a[12:15], v[116:119]
  buffer_load_dwordx4 v5, s[8:11], s32 offen offset:1024 sc1 lds
  s_add_u32 s32, s32, s33
  v_mfma_f32_16x16x32_bf16 v[120:123], a[40:43], a[12:15], v[120:123]
  s_add_u32 m0, s41, 0
  s_nop 0
  buffer_load_dwordx4 v8, s[12:15], s34 offen offset:0 lds
  s_add_u32 s34, s34, s35
  v_mfma_f32_16x16x32_bf16 v[124:127], a[44:47], a[12:15], v[124:127]
  s_waitcnt lgkmcnt(3)
  v_mfma_f32_16x16x32_bf16 v[64:67], a[48:51], a[16:19], v[64:67]
  v_mfma_f32_16x16x32_bf16 v[68:71], a[52:55], a[16:19], v[68:71]
  v_mfma_f32_16x16x32_bf16 v[72:75], a[56:59], a[16:19], v[72:75]
  v_mfma_f32_16x16x32_bf16 v[76:79], a[60:63], a[16:19], v[76:79]
  s_waitcnt lgkmcnt(0)
  s_waitcnt vmcnt(6)
  s_barrier
  ds_read_b64_tr_b16 a[32:33], v14 offset:16384
  ds_read_b64_tr_b16 a[34:35], v14 offset:17408
  v_mfma_f32_16x16x32_bf16 v[80:83], a[48:51], a[20:23], v[80:83]
  ds_read_b64_tr_b16 a[36:37], v15 offset:16384
  ds_read_b64_tr_b16 a[38:39], v15 offset:17408
  v_mfma_f32_16x16x32_bf16 v[84:87], a[52:55], a[20:23], v[84:87]
  ds_read_b64_tr_b16 a[40:41], v16 offset:16384
  ds_read_b64_tr_b16 a[42:43], v16 offset:17408
  v_mfma_f32_16x16x32_bf16 v[88:91], a[56:59], a[20:23], v[88:91]
  ds_read_b64_tr_b16 a[44:45], v17 offset:16384
  ds_read_b64_tr_b16 a[46:47], v17 offset:17408
  v_mfma_f32_16x16x32_bf16 v[92:95], a[60:63], a[20:23], v[92:95]
  ds_read_b128 a[0:3], v12 offset:32768
  v_mfma_f32_16x16x32_bf16 v[96:99], a[48:51], a[24:27], v[96:99]
  ds_read_b128 a[4:7], v12 offset:33792
  v_mfma_f32_16x16x32_bf16 v[100:103], a[52:55], a[24:27], v[100:103]
  ds_read_b128 a[8:11], v12 offset:34816
  v_mfma_f32_16x16x32_bf16 v[104:107], a[56:59], a[24:27], v[104:107]
  ds_read_b128 a[12:15], v12 offset:35840
  v_mfma_f32_16x16x32_bf16 v[108:111], a[60:63], a[24:27], v[108:111]
  s_add_u32 m0, s40, 16384
  v_mfma_f32_16x16x32_bf16 v[112:115], a[48:51], a[28:31], v[112:115]
  buffer_load_dwordx4 v4, s[8:11], s32 offen offset:0 sc1 lds
  v_mfma_f32_16x16x32_bf16 v[116:119], a[52:55], a[28:31], v[116:119]
  buffer_load_dwordx4 v5, s[8:11], s32 offen offset:1024 sc1 lds
  s_add_u32 s32, s32, s33
  v_mfma_f32_16x16x32_bf16 v[120:123], a[56:59], a[28:31], v[120:123]
  s_add_u32 m0, s41, 8192
  s_nop 0
  buffer_load_dwordx4 v8, s[12:15], s34 offen offset:0 lds
  s_add_u32 s34, s34, s35
  v_mfma_f32_16x16x32_bf16 v[124:127], a[60:63], a[28:31], v[124:127]
  s_waitcnt lgkmcnt(3)
  v_mfma_f32_16x16x32_bf16 v[64:67], a[32:35], a[0:3], v[64:67]
  v_mfma_f32_16x16x32_bf16 v[68:71], a[36:39], a[0:3], v[68:71]
  v_mfma_f32_16x16x32_bf16 v[72:75], a[40:43], a[0:3], v[72:75]
  v_mfma_f32_16x16x32_bf16 v[76:79], a[44:47], a[0:3], v[76:79]
  s_waitcnt lgkmcnt(0)
  s_waitcnt vmcnt(6)
  s_barrier
  ds_read_b64_tr_b16 a[48:49], v14 offset:24576
  ds_read_b64_tr_b16 a[50:51], v14 offset:25600
  v_mfma_f32_16x16x32_bf16 v[80:83], a[32:35], a[4:7], v[80:83]
  ds_read_b64_tr_b16 a[52:53], v15 offset:24576
  ds_read_b64_tr_b16 a[54:55], v15 offset:25600
  v_mfma_f32_16x16x32_bf16 v[84:87], a[36:39], a[4:7], v[84:87]
  ds_read_b64_tr_b16 a[56:57], v16 offset:24576
  ds_read_b64_tr_b16 a[58:59], v16 offset:25600
  v_mfma_f32_16x16x32_bf16 v[88:91], a[40:43], a[4:7], v[88:91]
  ds_read_b64_tr_b16 a[60:61], v17 offset:24576
  ds_read_b64_tr_b16 a[62:63], v17 offset:25600
  v_mfma_f32_16x16x32_bf16 v[92:95], a[44:47], a[4:7], v[92:95]
  ds_read_b128 a[16:19], v12 offset:49152
  v_mfma_f32_16x16x32_bf16 v[96:99], a[32:35], a[8:11], v[96:99]
  ds_read_b128 a[20:23], v12 offset:50176
  v_mfma_f32_16x16x32_bf16 v[100:103], a[36:39], a[8:11], v[100:103]
  ds_read_b128 a[24:27], v12 offset:51200
  v_mfma_f32_16x16x32_bf16 v[104:107], a[40:43], a[8:11], v[104:107]
  ds_read_b128 a[28:31], v12 offset:52224
  v_mfma_f32_16x16x32_bf16 v[108:111], a[44:47], a[8:11], v[108:111]
  s_add_u32 m0, s40, 32768
  v_mfma_f32_16x16x32_bf16 v[112:115], a[32:35], a[12:15], v[112:115]
  buffer_load_dwordx4 v4, s[8:11], s32 offen offset:0 sc1 lds
  v_mfma_f32_16x16x32_bf16 v[116:119], a[36:39], a[12:15], v[116:119]
  buffer_load_dwordx4 v5, s[8:11], s32 offen offset:1024 sc1 lds
  s_add_u32 s32, s32, s33
  v_mfma_f32_16x16x32_bf16 v[120:123], a[40:43], a[12:15], v[120:123]
  s_add_u32 m0, s41, 16384
  s_nop 0
  buffer_load_dwordx4 v8, s[12:15], s34 offen offset:0 lds
  s_add_u32 s34, s34, s35
  v_mfma_f32_16x16x32_bf16 v[124:127], a[44:47], a[12:15], v[124:127]
  s_waitcnt lgkmcnt(3)
  v_mfma_f32_16x16x32_bf16 v[64:67], a[48:51], a[16:19], v[64:67]
  v_mfma_f32_16x16x32_bf16 v[68:71], a[52:55], a[16:19], v[68:71]
  v_mfma_f32_16x16x32_bf16 v[72:75], a[56:59], a[16:19], v[72:75]
  v_mfma_f32_16x16x32_bf16 v[76:79], a[60:63], a[16:19], v[76:79]
  s_waitcnt lgkmcnt(0)
  s_waitcnt vmcnt(6)
  s_barrier
  ds_read_b64_tr_b16 a[32:33], v14 offset:0
  ds_read_b64_tr_b16 a[34:35], v14 offset:1024
  v_mfma_f32_16x16x32_bf16 v[80:83], a[48:51], a[20:23], v[80:83]
  ds_read_b64_tr_b16 a[36:37], v15 offset:0
  ds_read_b64_tr_b16 a[38:39], v15 offset:1024
  v_mfma_f32_16x16x32_bf16 v[84:87], a[52:55], a[20:23], v[84:87]
  ds_read_b64_tr_b16 a[40:41], v16 offset:0
  ds_read_b64_tr_b16 a[42:43], v16 offset:1024
  v_mfma_f32_16x16x32_bf16 v[88:91], a[56:59], a[20:23], v[88:91]
  ds_read_b64_tr_b16 a[44:45], v17 offset:0
  ds_read_b64_tr_b16 a[46:47], v17 offset:1024
  v_mfma_f32_16x16x32_bf16 v[92:95], a[60:63], a[20:23], v[92:95]
  ds_read_b128 a[0:3], v12 offset:0
  v_mfma_f32_16x16x32_bf16 v[96:99], a[48:51], a[24:27], v[96:99]
  ds_read_b128 a[4:7], v12 offset:1024
  v_mfma_f32_16x16x32_bf16 v[100:103], a[52:55], a[24:27], v[100:103]
  ds_read_b128 a[8:11], v12 offset:2048
  v_mfma_f32_16x16x32_bf16 v[104:107], a[56:59], a[24:27], v[104:107]
  ds_read_b128 a[12:15], v12 offset:3072
  v_mfma_f32_16x16x32_bf16 v[108:111], a[60:63], a[24:27], v[108:111]
  s_add_u32 m0, s40, 49152
  v_mfma_f32_16x16x32_bf16 v[112:115], a[48:51], a[28:31], v[112:115]
  buffer_load_dwordx4 v4, s[8:11], s32 offen offset:0 sc1 lds
  v_mfma_f32_16x16x32_bf16 v[116:119], a[52:55], a[28:31], v[116:119]
  buffer_load_dwordx4 v5, s[8:11], s32 offen offset:1024 sc1 lds
  s_add_u32 s32, s32, s33
  v_mfma_f32_16x16x32_bf16 v[120:123], a[56:59], a[28:31], v[120:123]
  s_add_u32 m0, s41, 24576
  s_nop 0
  buffer_load_dwordx4 v8, s[12:15], s34 offen offset:0 lds
  s_add_u32 s34, s34, s35
  v_mfma_f32_16x16x32_bf16 v[124:127], a[60:63], a[28:31], v[124:127]
  s_sub_u32 s36, s36, 1
  s_cmp_lg_u32 s36, 0
  s_cbranch_scc1 L_loop_half_fn_kq
  s_waitcnt lgkmcnt(3)
  v_mfma_f32_16x16x32_bf16 v[64:67], a[32:35], a[0:3], v[64:67]
  v_mfma_f32_16x16x32_bf16 v[68:71], a[36:39], a[0:3], v[68:71]
  v_mfma_f32_16x16x32_bf16 v[72:75], a[40:43], a[0:3], v[72:75]
  v_mfma_f32_16x16x32_bf16 v[76:79], a[44:47], a[0:3], v[76:79]
  s_waitcnt lgkmcnt(0)
  s_waitcnt vmcnt(6)
  s_barrier
  ds_read_b64_tr_b16 a[48:49], v14 offset:8192
  ds_read_b64_tr_b16 a[50:51], v14 offset:9216
  v_mfma_f32_16x16x32_bf16 v[80:83], a[32:35], a[4:7], v[80:83]
  ds_read_b64_tr_b16 a[52:53], v15 offset:8192
  ds_read_b64_tr_b16 a[54:55], v15 offset:9216
  v_mfma_f32_16x16x32_bf16 v[84:87], a[36:39], a[4:7], v[84:87]
  ds_read_b64_tr_b16 a[56:57], v16 offset:8192
  ds_read_b64_tr_b16 a[58:59], v16 offset:9216
  v_mfma_f32_16x16x32_bf16 v[88:91], a[40:43], a[4:7], v[88:91]
  ds_read_b64_tr_b16 a[60:61], v17 offset:8192
  ds_read_b64_tr_b16 a[62:63], v17 offset:9216
  v_mfma_f32_16x16x32_bf16 v[92:95], a[44:47], a[4:7], v[92:95]
  ds_read_b128 a[16:19], v12 offset:16384
  v_mfma_f32_16x16x32_bf16 v[96:99], a[32:35], a[8:11], v[96:99]
  ds_read_b128 a[20:23], v12 offset:17408
  v_mfma_f32_16x16x32_bf16 v[100:103], a[36:39], a[8:11], v[100:103]
  ds_read_b128 a[24:27], v12 offset:18432
  v_mfma_f32_16x16x32_bf16 v[104:107], a[40:43], a[8:11], v[104:107]
  ds_read_b128 a[28:31], v12 offset:19456
  v_mfma_f32_16x16x32_bf16 v[108:111], a[44:47], a[8:11], v[108:111]
  v_mfma_f32_16x16x32_bf16 v[112:115], a[32:35], a[12:15], v[112:115]
  v_mfma_f32_16x16x32_bf16 v[116:119], a[36:39], a[12:15], v[116:119]
  v_mfma_f32_16x16x32_bf16 v[120:123], a[40:43], a[12:15], v[120:123]
  v_mfma_f32_16x16x32_bf16 v[124:127], a[44:47], a[12:15], v[124:127]
  s_waitcnt lgkmcnt(3)
  v_mfma_f32_16x16x32_bf16 v[64:67], a[48:51], a[16:19], v[64:67]
  v_mfma_f32_16x16x32_bf16 v[68:71], a[52:55], a[16:19], v[68:71]
  v_mfma_f32_16x16x32_bf16 v[72:75], a[56:59], a[16:19], v[72:75]
  v_mfma_f32_16x16x32_bf16 v[76:79], a[60:63], a[16:19], v[76:79]
  s_waitcnt lgkmcnt(0)
  s_waitcnt vmcnt(3)
  s_barrier
  ds_read_b64_tr_b16 a[32:33], v14 offset:16384
  ds_read_b64_tr_b16 a[34:35], v14 offset:17408
  v_mfma_f32_16x16x32_bf16 v[80:83], a[48:51], a[20:23], v[80:83]
  ds_read_b64_tr_b16 a[36:37], v15 offset:16384
  ds_read_b64_tr_b16 a[38:39], v15 offset:17408
  v_mfma_f32_16x16x32_bf16 v[84:87], a[52:55], a[20:23], v[84:87]
  ds_read_b64_tr_b16 a[40:41], v16 offset:16384
  ds_read_b64_tr_b16 a[42:43], v16 offset:17408
  v_mfma_f32_16x16x32_bf16 v[88:91], a[56:59], a[20:23], v[88:91]
  ds_read_b64_tr_b16 a[44:45], v17 offset:16384
  ds_read_b64_tr_b16 a[46:47], v17 offset:17408
  v_mfma_f32_16x16x32_bf16 v[92:95], a[60:63], a[20:23], v[92:95]
  ds_read_b128 a[0:3], v12 offset:32768
  v_mfma_f32_16x16x32_bf16 v[96:99], a[48:51], a[24:27], v[96:99]
  ds_read_b128 a[4:7], v12 offset:33792
  v_mfma_f32_16x16x32_bf16 v[100:103], a[52:55], a[24:27], v[100:103]
  ds_read_b128 a[8:11], v12 offset:34816
  v_mfma_f32_16x16x32_bf16 v[104:107], a[56:59], a[24:27], v[104:107]
  ds_read_b128 a[12:15], v12 offset:35840
  v_mfma_f32_16x16x32_bf16 v[108:111], a[60:63], a[24:27], v[108:111]
  v_mfma_f32_16x16x32_bf16 v[112:115], a[48:51], a[28:31], v[112:115]
  v_mfma_f32_16x16x32_bf16 v[116:119], a[52:55], a[28:31], v[116:119]
  v_mfma_f32_16x16x32_bf16 v[120:123], a[56:59], a[28:31], v[120:123]
  v_mfma_f32_16x16x32_bf16 v[124:127], a[60:63], a[28:31], v[124:127]
  s_waitcnt lgkmcnt(3)
  v_mfma_f32_16x16x32_bf16 v[64:67], a[32:35], a[0:3], v[64:67]
  v_mfma_f32_16x16x32_bf16 v[68:71], a[36:39], a[0:3], v[68:71]
  v_mfma_f32_16x16x32_bf16 v[72:75], a[40:43], a[0:3], v[72:75]
  v_mfma_f32_16x16x32_bf16 v[76:79], a[44:47], a[0:3], v[76:79]
  s_waitcnt lgkmcnt(0)
  s_waitcnt vmcnt(0)
  s_barrier
  ds_read_b64_tr_b16 a[48:49], v14 offset:24576
  ds_read_b64_tr_b16 a[50:51], v14 offset:25600
  v_mfma_f32_16x16x32_bf16 v[80:83], a[32:35], a[4:7], v[80:83]
  ds_read_b64_tr_b16 a[52:53], v15 offset:24576
  ds_read_b64_tr_b16 a[54:55], v15 offset:25600
  v_mfma_f32_16x16x32_bf16 v[84:87], a[36:39], a[4:7], v[84:87]
  ds_read_b64_tr_b16 a[56:57], v16 offset:24576
  ds_read_b64_tr_b16 a[58:59], v16 offset:25600
  v_mfma_f32_16x16x32_bf16 v[88:91], a[40:43], a[4:7], v[88:91]
  ds_read_b64_tr_b16 a[60:61], v17 offset:24576
  ds_read_b64_tr_b16 a[62:63], v17 offset:25600
  v_mfma_f32_16x16x32_bf16 v[92:95], a[44:47], a[4:7], v[92:95]
  ds_read_b128 a[16:19], v12 offset:49152
  v_mfma_f32_16x16x32_bf16 v[96:99], a[32:35], a[8:11], v[96:99]
  ds_read_b128 a[20:23], v12 offset:50176
  v_mfma_f32_16x16x32_bf16 v[100:103], a[36:39], a[8:11], v[100:103]
  ds_read_b128 a[24:27], v12 offset:51200
  v_mfma_f32_16x16x32_bf16 v[104:107], a[40:43], a[8:11], v[104:107]
  ds_read_b128 a[28:31], v12 offset:52224
  v_mfma_f32_16x16x32_bf16 v[108:111], a[44:47], a[8:11], v[108:111]
  v_mfma_f32_16x16x32_bf16 v[112:115], a[32:35], a[12:15], v[112:115]
  v_mfma_f32_16x16x32_bf16 v[116:119], a[36:39], a[12:15], v[116:119]
  v_mfma_f32_16x16x32_bf16 v[120:123], a[40:43], a[12:15], v[120:123]
  v_mfma_f32_16x16x32_bf16 v[124:127], a[44:47], a[12:15], v[124:127]
  s_waitcnt lgkmcnt(3)
  v_mfma_f32_16x16x32_bf16 v[64:67], a[48:51], a[16:19], v[64:67]
  v_mfma_f32_16x16x32_bf16 v[68:71], a[52:55], a[16:19], v[68:71]
  v_mfma_f32_16x16x32_bf16 v[72:75], a[56:59], a[16:19], v[72:75]
  v_mfma_f32_16x16x32_bf16 v[76:79], a[60:63], a[16:19], v[76:79]
  s_waitcnt lgkmcnt(2)
  v_mfma_f32_16x16x32_bf16 v[80:83], a[48:51], a[20:23], v[80:83]
  v_mfma_f32_16x16x32_bf16 v[84:87], a[52:55], a[20:23], v[84:87]
  v_mfma_f32_16x16x32_bf16 v[88:91], a[56:59], a[20:23], v[88:91]
  v_mfma_f32_16x16x32_bf16 v[92:95], a[60:63], a[20:23], v[92:95]
  s_waitcnt lgkmcnt(1)
  v_mfma_f32_16x16x32_bf16 v[96:99], a[48:51], a[24:27], v[96:99]
  v_mfma_f32_16x16x32_bf16 v[100:103], a[52:55], a[24:27], v[100:103]
  v_mfma_f32_16x16x32_bf16 v[104:107], a[56:59], a[24:27], v[104:107]
  v_mfma_f32_16x16x32_bf16 v[108:111], a[60:63], a[24:27], v[108:111]
  s_waitcnt lgkmcnt(0)
  v_mfma_f32_16x16x32_bf16 v[112:115], a[48:51], a[28:31], v[112:115]
  v_mfma_f32_16x16x32_bf16 v[116:119], a[52:55], a[28:31], v[116:119]
  v_mfma_f32_16x16x32_bf16 v[120:123], a[56:59], a[28:31], v[120:123]
  v_mfma_f32_16x16x32_bf16 v[124:127], a[60:63], a[28:31], v[124:127]
L_episel_44:
  s_nop 7
L_epi_plain_43:
  s_lshr_b32 s42, s28, 1
  s_and_b32 s43, s28, 1
  s_mul_i32 s45, s43, 2048
  s_add_u32 s45, s45, s37
  s_mul_i32 s44, s42, 4
  s_mul_i32 s44, s44, s38
  s_add_u32 s44, s44, s45
  v_cvt_pk_bf16_f32 v44, v64, v65
  v_cvt_pk_bf16_f32 v45, v66, v67
  v_cvt_pk_bf16_f32 v46, v68, v69
  v_cvt_pk_bf16_f32 v47, v70, v71
  buffer_store_dwordx4 v[44:47], v18, s[4:7], s44 offen offset:0 sc1
  v_cvt_pk_bf16_f32 v48, v72, v73
  v_cvt_pk_bf16_f32 v49, v74, v75
  v_cvt_pk_bf16_f32 v50, v76, v77
  v_cvt_pk_bf16_f32 v51, v78, v79
  buffer_store_dwordx4 v[48:51], v18, s[4:7], s44 offen offset:1024 sc1
  s_add_u32 s44, s44, s38
  v_cvt_pk_bf16_f32 v52, v80, v81
  v_cvt_pk_bf16_f32 v53, v82, v83
  v_cvt_pk_bf16_f32 v54, v84, v85
  v_cvt_pk_bf16_f32 v55, v86, v87
  buffer_store_dwordx4 v[52:55], v18, s[4:7], s44 offen offset:0 sc1
  v_cvt_pk_bf16_f32 v56, v88, v89
  v_cvt_pk_bf16_f32 v57, v90, v91
  v_cvt_pk_bf16_f32 v58, v92, v93
  v_cvt_pk_bf16_f32 v59, v94, v95
  buffer_store_dwordx4 v[56:59], v18, s[4:7], s44 offen offset:1024 sc1
  s_add_u32 s44, s44, s38
  v_cvt_pk_bf16_f32 v44, v96, v97
  v_cvt_pk_bf16_f32 v45, v98, v99
  v_cvt_pk_bf16_f32 v46, v100, v101
  v_cvt_pk_bf16_f32 v47, v102, v103
  buffer_store_dwordx4 v[44:47], v18, s[4:7], s44 offen offset:0 sc1
  v_cvt_pk_bf16_f32 v48, v104, v105
  v_cvt_pk_bf16_f32 v49, v106, v107
  v_cvt_pk_bf16_f32 v50, v108, v109
  v_cvt_pk_bf16_f32 v51, v110, v111
  buffer_store_dwordx4 v[48:51], v18, s[4:7], s44 offen offset:1024 sc1
  s_add_u32 s44, s44, s38
  v_cvt_pk_bf16_f32 v52, v112, v113
  v_cvt_pk_bf16_f32 v53, v114, v115
  v_cvt_pk_bf16_f32 v54, v116, v117
  v_cvt_pk_bf16_f32 v55, v118, v119
  buffer_store_dwordx4 v[52:55], v18, s[4:7], s44 offen offset:0 sc1
  v_cvt_pk_bf16_f32 v56, v120, v121
  v_cvt_pk_bf16_f32 v57, v122, v123
  v_cvt_pk_bf16_f32 v58, v124, v125
  v_cvt_pk_bf16_f32 v59, v126, v127
  buffer_store_dwordx4 v[56:59], v18, s[4:7], s44 offen offset:1024 sc1
  s_branch L_done
L_body_half_fn_v:
  s_lshr_b32 s42, s28, 1
  s_and_b32 s43, s28, 1
  s_mul_i32 s40, s28, 2048
  s_mul_i32 s41, s28, 1024
  s_add_u32 s41, s41, 65536
  v_lshlrev_b32 v18, 4, v1
  s_mul_i32 s44, s42, 4096
  v_lshrrev_b32 v22, 4, v1
  v_and_b32 v23, 15, v1
  v_add_u32 v12, s44, v18
  s_mul_i32 s44, s28, 2
  s_add_u32 s44, s44, 0
  s_mul_i32 s44, s44, s45
  v_add_u32 v4, s44, v18
  s_mul_i32 s44, s28, 2
  s_add_u32 s44, s44, 1
  s_mul_i32 s44, s44, s45
  s_sub_u32 s44, s44, 1024
  v_add_u32 v5, s44, v18
  v_lshrrev_b32 v23, 4, v1
  v_and_b32 v24, 15, v1
  s_mul_i32 s44, s28, 4
  s_add_u32 s44, s44, 0
  v_add_u32 v20, s44, v23
  v_and_b32 v21, 3, v20
  v_bfe_u32 v22, v20, 3, 1
  v_lshl_or_b32 v21, v22, 2, v21
  v_lshlrev_b32 v21, 1, v21
  v_xor_b32 v21, v21, v24
  v_mul_lo_u32 v20, v20, s39
  v_lshl_add_u32 v8, v21, 4, v20
  v_bfe_u32 v20, v1, 2, 2
  v_lshrrev_b32 v21, 4, v1
  v_lshl_add_u32 v22, v21, 3, v20
  v_mul_u32_u24 v22, 256, v22
  v_and_b32 v23, 3, v1
  v_lshl_add_u32 v22, v23, 3, v22
  v_add_u32 v22, 65536, v22
  v_and_b32 v21, 1, v21
  v_lshl_or_b32 v20, v21, 2, v20
  s_mul_i32 s44, s43, 4
  s_add_u32 s44, s44, 0
  v_xor_b32 v21, s44, v20
  v_lshl_add_u32 v14, v21, 5, v22
  s_mul_i32 s44, s43, 4
  s_add_u32 s44, s44, 1
  v_xor_b32 v21, s44, v20
  v_lshl_add_u32 v15, v21, 5, v22
  s_mul_i32 s44, s43, 4
  s_add_u32 s44, s44, 2
  v_xor_b32 v21, s44, v20
  v_lshl_add_u32 v16, v21, 5, v22
  s_mul_i32 s44, s43, 4
  s_add_u32 s44, s44, 3
  v_xor_b32 v21, s44, v20
  v_lshl_add_u32 v17, v21, 5, v22
  s_add_u32 m0, s40, 0
  s_nop 0
  buffer_load_dwordx4 v4, s[8:11], s32 offen offset:0 sc1 lds
  buffer_load_dwordx4 v5, s[8:11], s32 offen offset:1024 sc1 lds
  s_add_u32 s32, s32, s33
  s_add_u32 m0, s41, 0
  s_nop 0
  buffer_load_dwordx4 v8, s[12:15], s34 offen offset:0 lds
  s_add_u32 s34, s34, s35
  s_add_u32 m0, s40, 16384
  s_nop 0
  buffer_load_dwordx4 v4, s[8:11], s32 offen offset:0 sc1 lds
  buffer_load_dwordx4 v5, s[8:11], s32 offen offset:1024 sc1 lds
  s_add_u32 s32, s32, s33
  s_add_u32 m0, s41, 8192
  s_nop 0
  buffer_load_dwordx4 v8, s[12:15], s34 offen offset:0 lds
  s_add_u32 s34, s34, s35
  s_add_u32 m0, s40, 32768
  s_nop 0
  buffer_load_dwordx4 v4, s[8:11], s32 offen offset:0 sc1 lds
  buffer_load_dwordx4 v5, s[8:11], s32 offen offset:1024 sc1 lds
  s_add_u32 s32, s32, s33
  s_add_u32 m0, s41, 16384
  s_nop 0
  buffer_load_dwordx4 v8, s[12:15], s34 offen offset:0 lds
  s_add_u32 s34, s34, s35
  s_add_u32 m0, s40, 49152
  s_nop 0
  buffer_load_dwordx4 v4, s[8:11], s32 offen offset:0 sc1 lds
  buffer_load_dwordx4 v5, s[8:11], s32 offen offset:1024 sc1 lds
  s_add_u32 s32, s32, s33
  s_add_u32 m0, s41, 24576
  s_nop 0
  buffer_load_dwordx4 v8, s[12:15], s34 offen offset:0 lds
  s_add_u32 s34, s34, s35
  v_mov_b32 v64, 0
  v_mov_b32 v65, 0
  v_mov_b32 v66, 0
  v_mov_b32 v67, 0
  v_mov_b32 v68, 0
  v_mov_b32 v69, 0
  v_mov_b32 v70, 0
  v_mov_b32 v71, 0
  v_mov_b32 v72, 0
  v_mov_b32 v73, 0
  v_mov_b32 v74, 0
  v_mov_b32 v75, 0
  v_mov_b32 v76, 0
  v_mov_b32 v77, 0
  v_mov_b32 v78, 0
  v_mov_b32 v79, 0
  v_mov_b32 v80, 0
  v_mov_b32 v81, 0
  v_mov_b32 v82, 0
  v_mov_b32 v83, 0
  v_mov_b32 v84, 0
  v_mov_b32 v85, 0
  v_mov_b32 v86, 0
  v_mov_b32 v87, 0
  v_mov_b32 v88, 0
  v_mov_b32 v89, 0
  v_mov_b32 v90, 0
  v_mov_b32 v91, 0
  v_mov_b32 v92, 0
  v_mov_b32 v93, 0
  v_mov_b32 v94, 0
  v_mov_b32 v95, 0
  v_mov_b32 v96, 0
  v_mov_b32 v97, 0
  v_mov_b32 v98, 0
  v_mov_b32 v99, 0
  v_mov_b32 v100, 0
  v_mov_b32 v101, 0
  v_mov_b32 v102, 0
  v_mov_b32 v103, 0
  v_mov_b32 v104, 0
  v_mov_b32 v105, 0
  v_mov_b32 v106, 0
  v_mov_b32 v107, 0
  v_mov_b32 v108, 0
  v_mov_b32 v109, 0
  v_mov_b32 v110, 0
  v_mov_b32 v111, 0
  v_mov_b32 v112, 0
  v_mov_b32 v113, 0
  v_mov_b32 v114, 0
  v_mov_b32 v115, 0
  v_mov_b32 v116, 0
  v_mov_b32 v117, 0
  v_mov_b32 v118, 0
  v_mov_b32 v119, 0
  v_mov_b32 v120, 0
  v_mov_b32 v121, 0
  v_mov_b32 v122, 0
  v_mov_b32 v123, 0
  v_mov_b32 v124, 0
  v_mov_b32 v125, 0
  v_mov_b32 v126, 0
  v_mov_b32 v127, 0
  s_waitcnt vmcnt(9)
  s_barrier
  ds_read_b64_tr_b16 a[32:33], v14 offset:0
  ds_read_b64_tr_b16 a[34:35], v14 offset:1024
  ds_read_b64_tr_b16 a[36:37], v15 offset:0
  ds_read_b64_tr_b16 a[38:39], v15 offset:1024
  ds_read_b64_tr_b16 a[40:41], v16 offset:0
  ds_read_b64_tr_b16 a[42:43], v16 offset:1024
  ds_read_b64_tr_b16 a[44:45], v17 offset:0
  ds_read_b64_tr_b16 a[46:47], v17 offset:1024
  ds_read_b128 a[0:3], v12 offset:0
  ds_read_b128 a[4:7], v12 offset:1024
  ds_read_b128 a[8:11], v12 offset:2048
  ds_read_b128 a[12:15], v12 offset:3072
  s_waitcnt lgkmcnt(0)
L_loop_half_fn_v:
  s_waitcnt lgkmcnt(3)
  v_mfma_f32_16x16x32_bf16 v[64:67], a[0:3], a[32:35], v[64:67]
  v_mfma_f32_16x16x32_bf16 v[68:71], a[0:3], a[36:39], v[68:71]
  v_mfma_f32_16x16x32_bf16 v[72:75], a[0:3], a[40:43], v[72:75]
  v_mfma_f32_16x16x32_bf16 v[76:79], a[0:3], a[44:47], v[76:79]
  s_waitcnt lgkmcnt(0)
  s_waitcnt vmcnt(6)
  s_barrier
  ds_read_b64_tr_b16 a[48:49], v14 offset:8192
  ds_read_b64_tr_b16 a[50:51], v14 offset:9216
  v_mfma_f32_16x16x32_bf16 v[80:83], a[4:7], a[32:35], v[80:83]
  ds_read_b64_tr_b16 a[52:53], v15 offset:8192
  ds_read_b64_tr_b16 a[54:55], v15 offset:9216
  v_mfma_f32_16x16x32_bf16 v[84:87], a[4:7], a[36:39], v[84:87]
  ds_read_b64_tr_b16 a[56:57], v16 offset:8192
  ds_read_b64_tr_b16 a[58:59], v16 offset:9216
  v_mfma_f32_16x16x32_bf16 v[88:91], a[4:7], a[40:43], v[88:91]
  ds_read_b64_tr_b16 a[60:61], v17 offset:8192
  ds_read_b64_tr_b16 a[62:63], v17 offset:9216
  v_mfma_f32_16x16x32_bf16 v[92:95], a[4:7], a[44:47], v[92:95]
  ds_read_b128 a[16:19], v12 offset:16384
  v_mfma_f32_16x16x32_bf16 v[96:99], a[8:11], a[32:35], v[96:99]
  ds_read_b128 a[20:23], v12 offset:17408
  v_mfma_f32_16x16x32_bf16 v[100:103], a[8:11], a[36:39], v[100:103]
  ds_read_b128 a[24:27], v12 offset:18432
  v_mfma_f32_16x16x32_bf16 v[104:107], a[8:11], a[40:43], v[104:107]
  ds_read_b128 a[28:31], v12 offset:19456
  v_mfma_f32_16x16x32_bf16 v[108:111], a[8:11], a[44:47], v[108:111]
  s_add_u32 m0, s40, 0
  v_mfma_f32_16x16x32_bf16 v[112:115], a[12:15], a[32:35], v[112:115]
  buffer_load_dwordx4 v4, s[8:11], s32 offen offset:0 sc1 lds
  v_mfma_f32_16x16x32_bf16 v[116:119], a[12:15], a[36:39], v[116:119]
  buffer_load_dwordx4 v5, s[8:11], s32 offen offset:1024 sc1 lds
  s_add_u32 s32, s32, s33
  v_mfma_f32_16x16x32_bf16 v[120:123], a[12:15], a[40:43], v[120:123]
  s_add_u32 m0, s41, 0
  s_nop 0
  buffer_load_dwordx4 v8, s[12:15], s34 offen offset:0 lds
  s_add_u32 s34, s34, s35
  v_mfma_f32_16x16x32_bf16 v[124:127], a[12:15], a[44:47], v[124:127]
  s_waitcnt lgkmcnt(3)
  v_mfma_f32_16x16x32_bf16 v[64:67], a[16:19], a[48:51], v[64:67]
  v_mfma_f32_16x16x32_bf16 v[68:71], a[16:19], a[52:55], v[68:71]
  v_mfma_f32_16x16x32_bf16 v[72:75], a[16:19], a[56:59], v[72:75]
  v_mfma_f32_16x16x32_bf16 v[76:79], a[16:19], a[60:63], v[76:79]
  s_waitcnt lgkmcnt(0)
  s_waitcnt vmcnt(6)
  s_barrier
  ds_read_b64_tr_b16 a[32:33], v14 offset:16384
  ds_read_b64_tr_b16 a[34:35], v14 offset:17408
  v_mfma_f32_16x16x32_bf16 v[80:83], a[20:23], a[48:51], v[80:83]
  ds_read_b64_tr_b16 a[36:37], v15 offset:16384
  ds_read_b64_tr_b16 a[38:39], v15 offset:17408
  v_mfma_f32_16x16x32_bf16 v[84:87], a[20:23], a[52:55], v[84:87]
  ds_read_b64_tr_b16 a[40:41], v16 offset:16384
  ds_read_b64_tr_b16 a[42:43], v16 offset:17408
  v_mfma_f32_16x16x32_bf16 v[88:91], a[20:23], a[56:59], v[88:91]
  ds_read_b64_tr_b16 a[44:45], v17 offset:16384
  ds_read_b64_tr_b16 a[46:47], v17 offset:17408
  v_mfma_f32_16x16x32_bf16 v[92:95], a[20:23], a[60:63], v[92:95]
  ds_read_b128 a[0:3], v12 offset:32768
  v_mfma_f32_16x16x32_bf16 v[96:99], a[24:27], a[48:51], v[96:99]
  ds_read_b128 a[4:7], v12 offset:33792
  v_mfma_f32_16x16x32_bf16 v[100:103], a[24:27], a[52:55], v[100:103]
  ds_read_b128 a[8:11], v12 offset:34816
  v_mfma_f32_16x16x32_bf16 v[104:107], a[24:27], a[56:59], v[104:107]
  ds_read_b128 a[12:15], v12 offset:35840
  v_mfma_f32_16x16x32_bf16 v[108:111], a[24:27], a[60:63], v[108:111]
  s_add_u32 m0, s40, 16384
  v_mfma_f32_16x16x32_bf16 v[112:115], a[28:31], a[48:51], v[112:115]
  buffer_load_dwordx4 v4, s[8:11], s32 offen offset:0 sc1 lds
  v_mfma_f32_16x16x32_bf16 v[116:119], a[28:31], a[52:55], v[116:119]
  buffer_load_dwordx4 v5, s[8:11], s32 offen offset:1024 sc1 lds
  s_add_u32 s32, s32, s33
  v_mfma_f32_16x16x32_bf16 v[120:123], a[28:31], a[56:59], v[120:123]
  s_add_u32 m0, s41, 8192
  s_nop 0
  buffer_load_dwordx4 v8, s[12:15], s34 offen offset:0 lds
  s_add_u32 s34, s34, s35
  v_mfma_f32_16x16x32_bf16 v[124:127], a[28:31], a[60:63], v[124:127]
  s_waitcnt lgkmcnt(3)
  v_mfma_f32_16x16x32_bf16 v[64:67], a[0:3], a[32:35], v[64:67]
  v_mfma_f32_16x16x32_bf16 v[68:71], a[0:3], a[36:39], v[68:71]
  v_mfma_f32_16x16x32_bf16 v[72:75], a[0:3], a[40:43], v[72:75]
  v_mfma_f32_16x16x32_bf16 v[76:79], a[0:3], a[44:47], v[76:79]
  s_waitcnt lgkmcnt(0)
  s_waitcnt vmcnt(6)
  s_barrier
  ds_read_b64_tr_b16 a[48:49], v14 offset:24576
  ds_read_b64_tr_b16 a[50:51], v14 offset:25600
  v_mfma_f32_16x16x32_bf16 v[80:83], a[4:7], a[32:35], v[80:83]
  ds_read_b64_tr_b16 a[52:53], v15 offset:24576
  ds_read_b64_tr_b16 a[54:55], v15 offset:25600
  v_mfma_f32_16x16x32_bf16 v[84:87], a[4:7], a[36:39], v[84:87]
  ds_read_b64_tr_b16 a[56:57], v16 offset:24576
  ds_read_b64_tr_b16 a[58:59], v16 offset:25600
  v_mfma_f32_16x16x32_bf16 v[88:91], a[4:7], a[40:43], v[88:91]
  ds_read_b64_tr_b16 a[60:61], v17 offset:24576
  ds_read_b64_tr_b16 a[62:63], v17 offset:25600
  v_mfma_f32_16x16x32_bf16 v[92:95], a[4:7], a[44:47], v[92:95]
  ds_read_b128 a[16:19], v12 offset:49152
  v_mfma_f32_16x16x32_bf16 v[96:99], a[8:11], a[32:35], v[96:99]
  ds_read_b128 a[20:23], v12 offset:50176
  v_mfma_f32_16x16x32_bf16 v[100:103], a[8:11], a[36:39], v[100:103]
  ds_read_b128 a[24:27], v12 offset:51200
  v_mfma_f32_16x16x32_bf16 v[104:107], a[8:11], a[40:43], v[104:107]
  ds_read_b128 a[28:31], v12 offset:52224
  v_mfma_f32_16x16x32_bf16 v[108:111], a[8:11], a[44:47], v[108:111]
  s_add_u32 m0, s40, 32768
  v_mfma_f32_16x16x32_bf16 v[112:115], a[12:15], a[32:35], v[112:115]
  buffer_load_dwordx4 v4, s[8:11], s32 offen offset:0 sc1 lds
  v_mfma_f32_16x16x32_bf16 v[116:119], a[12:15], a[36:39], v[116:119]
  buffer_load_dwordx4 v5, s[8:11], s32 offen offset:1024 sc1 lds
  s_add_u32 s32, s32, s33
  v_mfma_f32_16x16x32_bf16 v[120:123], a[12:15], a[40:43], v[120:123]
  s_add_u32 m0, s41, 16384
  s_nop 0
  buffer_load_dwordx4 v8, s[12:15], s34 offen offset:0 lds
  s_add_u32 s34, s34, s35
  v_mfma_f32_16x16x32_bf16 v[124:127], a[12:15], a[44:47], v[124:127]
  s_waitcnt lgkmcnt(3)
  v_mfma_f32_16x16x32_bf16 v[64:67], a[16:19], a[48:51], v[64:67]
  v_mfma_f32_16x16x32_bf16 v[68:71], a[16:19], a[52:55], v[68:71]
  v_mfma_f32_16x16x32_bf16 v[72:75], a[16:19], a[56:59], v[72:75]
  v_mfma_f32_16x16x32_bf16 v[76:79], a[16:19], a[60:63], v[76:79]
  s_waitcnt lgkmcnt(0)
  s_waitcnt vmcnt(6)
  s_barrier
  ds_read_b64_tr_b16 a[32:33], v14 offset:0
  ds_read_b64_tr_b16 a[34:35], v14 offset:1024
  v_mfma_f32_16x16x32_bf16 v[80:83], a[20:23], a[48:51], v[80:83]
  ds_read_b64_tr_b16 a[36:37], v15 offset:0
  ds_read_b64_tr_b16 a[38:39], v15 offset:1024
  v_mfma_f32_16x16x32_bf16 v[84:87], a[20:23], a[52:55], v[84:87]
  ds_read_b64_tr_b16 a[40:41], v16 offset:0
  ds_read_b64_tr_b16 a[42:43], v16 offset:1024
  v_mfma_f32_16x16x32_bf16 v[88:91], a[20:23], a[56:59], v[88:91]
  ds_read_b64_tr_b16 a[44:45], v17 offset:0
  ds_read_b64_tr_b16 a[46:47], v17 offset:1024
  v_mfma_f32_16x16x32_bf16 v[92:95], a[20:23], a[60:63], v[92:95]
  ds_read_b128 a[0:3], v12 offset:0
  v_mfma_f32_16x16x32_bf16 v[96:99], a[24:27], a[48:51], v[96:99]
  ds_read_b128 a[4:7], v12 offset:1024
  v_mfma_f32_16x16x32_bf16 v[100:103], a[24:27], a[52:55], v[100:103]
  ds_read_b128 a[8:11], v12 offset:2048
  v_mfma_f32_16x16x32_bf16 v[104:107], a[24:27], a[56:59], v[104:107]
  ds_read_b128 a[12:15], v12 offset:3072
  v_mfma_f32_16x16x32_bf16 v[108:111], a[24:27], a[60:63], v[108:111]
  s_add_u32 m0, s40, 49152
  v_mfma_f32_16x16x32_bf16 v[112:115], a[28:31], a[48:51], v[112:115]
  buffer_load_dwordx4 v4, s[8:11], s32 offen offset:0 sc1 lds
  v_mfma_f32_16x16x32_bf16 v[116:119], a[28:31], a[52:55], v[116:119]
  buffer_load_dwordx4 v5, s[8:11], s32 offen offset:1024 sc1 lds
  s_add_u32 s32, s32, s33
  v_mfma_f32_16x16x32_bf16 v[120:123], a[28:31], a[56:59], v[120:123]
  s_add_u32 m0, s41, 24576
  s_nop 0
  buffer_load_dwordx4 v8, s[12:15], s34 offen offset:0 lds
  s_add_u32 s34, s34, s35
  v_mfma_f32_16x16x32_bf16 v[124:127], a[28:31], a[60:63], v[124:127]
  s_sub_u32 s36, s36, 1
  s_cmp_lg_u32 s36, 0
  s_cbranch_scc1 L_loop_half_fn_v
  s_waitcnt lgkmcnt(3)
  v_mfma_f32_16x16x32_bf16 v[64:67], a[0:3], a[32:35], v[64:67]
  v_mfma_f32_16x16x32_bf16 v[68:71], a[0:3], a[36:39], v[68:71]
  v_mfma_f32_16x16x32_bf16 v[72:75], a[0:3], a[40:43], v[72:75]
  v_mfma_f32_16x16x32_bf16 v[76:79], a[0:3], a[44:47], v[76:79]
  s_waitcnt lgkmcnt(0)
  s_waitcnt vmcnt(6)
  s_barrier
  ds_read_b64_tr_b16 a[48:49], v14 offset:8192
  ds_read_b64_tr_b16 a[50:51], v14 offset:9216
  v_mfma_f32_16x16x32_bf16 v[80:83], a[4:7], a[32:35], v[80:83]
  ds_read_b64_tr_b16 a[52:53], v15 offset:8192
  ds_read_b64_tr_b16 a[54:55], v15 offset:9216
  v_mfma_f32_16x16x32_bf16 v[84:87], a[4:7], a[36:39], v[84:87]
  ds_read_b64_tr_b16 a[56:57], v16 offset:8192
  ds_read_b64_tr_b16 a[58:59], v16 offset:9216
  v_mfma_f32_16x16x32_bf16 v[88:91], a[4:7], a[40:43], v[88:91]
  ds_read_b64_tr_b16 a[60:61], v17 offset:8192
  ds_read_b64_tr_b16 a[62:63], v17 offset:9216
  v_mfma_f32_16x16x32_bf16 v[92:95], a[4:7], a[44:47], v[92:95]
  ds_read_b128 a[16:19], v12 offset:16384
  v_mfma_f32_16x16x32_bf16 v[96:99], a[8:11], a[32:35], v[96:99]
  ds_read_b128 a[20:23], v12 offset:17408
  v_mfma_f32_16x16x32_bf16 v[100:103], a[8:11], a[36:39], v[100:103]
  ds_read_b128 a[24:27], v12 offset:18432
  v_mfma_f32_16x16x32_bf16 v[104:107], a[8:11], a[40:43], v[104:107]
  ds_read_b128 a[28:31], v12 offset:19456
  v_mfma_f32_16x16x32_bf16 v[108:111], a[8:11], a[44:47], v[108:111]
  v_mfma_f32_16x16x32_bf16 v[112:115], a[12:15], a[32:35], v[112:115]
  v_mfma_f32_16x16x32_bf16 v[116:119], a[12:15], a[36:39], v[116:119]
  v_mfma_f32_16x16x32_bf16 v[120:123], a[12:15], a[40:43], v[120:123]
  v_mfma_f32_16x16x32_bf16 v[124:127], a[12:15], a[44:47], v[124:127]
  s_waitcnt lgkmcnt(3)
  v_mfma_f32_16x16x32_bf16 v[64:67], a[16:19], a[48:51], v[64:67]
  v_mfma_f32_16x16x32_bf16 v[68:71], a[16:19], a[52:55], v[68:71]
  v_mfma_f32_16x16x32_bf16 v[72:75], a[16:19], a[56:59], v[72:75]
  v_mfma_f32_16x16x32_bf16 v[76:79], a[16:19], a[60:63], v[76:79]
  s_waitcnt lgkmcnt(0)
  s_waitcnt vmcnt(3)
  s_barrier
  ds_read_b64_tr_b16 a[32:33], v14 offset:16384
  ds_read_b64_tr_b16 a[34:35], v14 offset:17408
  v_mfma_f32_16x16x32_bf16 v[80:83], a[20:23], a[48:51], v[80:83]
  ds_read_b64_tr_b16 a[36:37], v15 offset:16384
  ds_read_b64_tr_b16 a[38:39], v15 offset:17408
  v_mfma_f32_16x16x32_bf16 v[84:87], a[20:23], a[52:55], v[84:87]
  ds_read_b64_tr_b16 a[40:41], v16 offset:16384
  ds_read_b64_tr_b16 a[42:43], v16 offset:17408
  v_mfma_f32_16x16x32_bf16 v[88:91], a[20:23], a[56:59], v[88:91]
  ds_read_b64_tr_b16 a[44:45], v17 offset:16384
  ds_read_b64_tr_b16 a[46:47], v17 offset:17408
  v_mfma_f32_16x16x32_bf16 v[92:95], a[20:23], a[60:63], v[92:95]
  ds_read_b128 a[0:3], v12 offset:32768
  v_mfma_f32_16x16x32_bf16 v[96:99], a[24:27], a[48:51], v[96:99]
  ds_read_b128 a[4:7], v12 offset:33792
  v_mfma_f32_16x16x32_bf16 v[100:103], a[24:27], a[52:55], v[100:103]
  ds_read_b128 a[8:11], v12 offset:34816
  v_mfma_f32_16x16x32_bf16 v[104:107], a[24:27], a[56:59], v[104:107]
  ds_read_b128 a[12:15], v12 offset:35840
  v_mfma_f32_16x16x32_bf16 v[108:111], a[24:27], a[60:63], v[108:111]
  v_mfma_f32_16x16x32_bf16 v[112:115], a[28:31], a[48:51], v[112:115]
  v_mfma_f32_16x16x32_bf16 v[116:119], a[28:31], a[52:55], v[116:119]
  v_mfma_f32_16x16x32_bf16 v[120:123], a[28:31], a[56:59], v[120:123]
  v_mfma_f32_16x16x32_bf16 v[124:127], a[28:31], a[60:63], v[124:127]
  s_waitcnt lgkmcnt(3)
  v_mfma_f32_16x16x32_bf16 v[64:67], a[0:3], a[32:35], v[64:67]
  v_mfma_f32_16x16x32_bf16 v[68:71], a[0:3], a[36:39], v[68:71]
  v_mfma_f32_16x16x32_bf16 v[72:75], a[0:3], a[40:43], v[72:75]
  v_mfma_f32_16x16x32_bf16 v[76:79], a[0:3], a[44:47], v[76:79]
  s_waitcnt lgkmcnt(0)
  s_waitcnt vmcnt(0)
  s_barrier
  ds_read_b64_tr_b16 a[48:49], v14 offset:24576
  ds_read_b64_tr_b16 a[50:51], v14 offset:25600
  v_mfma_f32_16x16x32_bf16 v[80:83], a[4:7], a[32:35], v[80:83]
  ds_read_b64_tr_b16 a[52:53], v15 offset:24576
  ds_read_b64_tr_b16 a[54:55], v15 offset:25600
  v_mfma_f32_16x16x32_bf16 v[84:87], a[4:7], a[36:39], v[84:87]
  ds_read_b64_tr_b16 a[56:57], v16 offset:24576
  ds_read_b64_tr_b16 a[58:59], v16 offset:25600
  v_mfma_f32_16x16x32_bf16 v[88:91], a[4:7], a[40:43], v[88:91]
  ds_read_b64_tr_b16 a[60:61], v17 offset:24576
  ds_read_b64_tr_b16 a[62:63], v17 offset:25600
  v_mfma_f32_16x16x32_bf16 v[92:95], a[4:7], a[44:47], v[92:95]
  ds_read_b128 a[16:19], v12 offset:49152
  v_mfma_f32_16x16x32_bf16 v[96:99], a[8:11], a[32:35], v[96:99]
  ds_read_b128 a[20:23], v12 offset:50176
  v_mfma_f32_16x16x32_bf16 v[100:103], a[8:11], a[36:39], v[100:103]
  ds_read_b128 a[24:27], v12 offset:51200
  v_mfma_f32_16x16x32_bf16 v[104:107], a[8:11], a[40:43], v[104:107]
  ds_read_b128 a[28:31], v12 offset:52224
  v_mfma_f32_16x16x32_bf16 v[108:111], a[8:11], a[44:47], v[108:111]
  v_mfma_f32_16x16x32_bf16 v[112:115], a[12:15], a[32:35], v[112:115]
  v_mfma_f32_16x16x32_bf16 v[116:119], a[12:15], a[36:39], v[116:119]
  v_mfma_f32_16x16x32_bf16 v[120:123], a[12:15], a[40:43], v[120:123]
  v_mfma_f32_16x16x32_bf16 v[124:127], a[12:15], a[44:47], v[124:127]
  s_waitcnt lgkmcnt(3)
  v_mfma_f32_16x16x32_bf16 v[64:67], a[16:19], a[48:51], v[64:67]
  v_mfma_f32_16x16x32_bf16 v[68:71], a[16:19], a[52:55], v[68:71]
  v_mfma_f32_16x16x32_bf16 v[72:75], a[16:19], a[56:59], v[72:75]
  v_mfma_f32_16x16x32_bf16 v[76:79], a[16:19], a[60:63], v[76:79]
  s_waitcnt lgkmcnt(2)
  v_mfma_f32_16x16x32_bf16 v[80:83], a[20:23], a[48:51], v[80:83]
  v_mfma_f32_16x16x32_bf16 v[84:87], a[20:23], a[52:55], v[84:87]
  v_mfma_f32_16x16x32_bf16 v[88:91], a[20:23], a[56:59], v[88:91]
  v_mfma_f32_16x16x32_bf16 v[92:95], a[20:23], a[60:63], v[92:95]
  s_waitcnt lgkmcnt(1)
  v_mfma_f32_16x16x32_bf16 v[96:99], a[24:27], a[48:51], v[96:99]
  v_mfma_f32_16x16x32_bf16 v[100:103], a[24:27], a[52:55], v[100:103]
  v_mfma_f32_16x16x32_bf16 v[104:107], a[24:27], a[56:59], v[104:107]
  v_mfma_f32_16x16x32_bf16 v[108:111], a[24:27], a[60:63], v[108:111]
  s_waitcnt lgkmcnt(0)
  v_mfma_f32_16x16x32_bf16 v[112:115], a[28:31], a[48:51], v[112:115]
  v_mfma_f32_16x16x32_bf16 v[116:119], a[28:31], a[52:55], v[116:119]
  v_mfma_f32_16x16x32_bf16 v[120:123], a[28:31], a[56:59], v[120:123]
  v_mfma_f32_16x16x32_bf16 v[124:127], a[28:31], a[60:63], v[124:127]
L_episel_46:
  s_nop 7
L_epi_plain_45:
  s_lshr_b32 s42, s28, 1
  s_and_b32 s43, s28, 1
  s_mul_i32 s45, s43, 4096
  s_add_u32 s45, s45, s37
  s_mul_i32 s44, s42, 2
  s_mul_i32 s44, s44, s38
  s_add_u32 s44, s44, s45
  v_cvt_pk_bf16_f32 v44, v64, v65
  v_cvt_pk_bf16_f32 v45, v66, v67
  v_cvt_pk_bf16_f32 v46, v80, v81
  v_cvt_pk_bf16_f32 v47, v82, v83
  buffer_store_dwordx4 v[44:47], v18, s[4:7], s44 offen offset:0 sc1
  v_cvt_pk_bf16_f32 v48, v68, v69
  v_cvt_pk_bf16_f32 v49, v70, v71
  v_cvt_pk_bf16_f32 v50, v84, v85
  v_cvt_pk_bf16_f32 v51, v86, v87
  buffer_store_dwordx4 v[48:51], v18, s[4:7], s44 offen offset:1024 sc1
  v_cvt_pk_bf16_f32 v52, v72, v73
  v_cvt_pk_bf16_f32 v53, v74, v75
  v_cvt_pk_bf16_f32 v54, v88, v89
  v_cvt_pk_bf16_f32 v55, v90, v91
  buffer_store_dwordx4 v[52:55], v18, s[4:7], s44 offen offset:2048 sc1
  v_cvt_pk_bf16_f32 v56, v76, v77
  v_cvt_pk_bf16_f32 v57, v78, v79
  v_cvt_pk_bf16_f32 v58, v92, v93
  v_cvt_pk_bf16_f32 v59, v94, v95
  buffer_store_dwordx4 v[56:59], v18, s[4:7], s44 offen offset:3072 sc1
  s_add_u32 s44, s44, s38
  v_cvt_pk_bf16_f32 v44, v96, v97
  v_cvt_pk_bf16_f32 v45, v98, v99
  v_cvt_pk_bf16_f32 v46, v112, v113
  v_cvt_pk_bf16_f32 v47, v114, v115
  buffer_store_dwordx4 v[44:47], v18, s[4:7], s44 offen offset:0 sc1
  v_cvt_pk_bf16_f32 v48, v100, v101
  v_cvt_pk_bf16_f32 v49, v102, v103
  v_cvt_pk_bf16_f32 v50, v116, v117
  v_cvt_pk_bf16_f32 v51, v118, v119
  buffer_store_dwordx4 v[48:51], v18, s[4:7], s44 offen offset:1024 sc1
  v_cvt_pk_bf16_f32 v52, v104, v105
  v_cvt_pk_bf16_f32 v53, v106, v107
  v_cvt_pk_bf16_f32 v54, v120, v121
  v_cvt_pk_bf16_f32 v55, v122, v123
  buffer_store_dwordx4 v[52:55], v18, s[4:7], s44 offen offset:2048 sc1
  v_cvt_pk_bf16_f32 v56, v108, v109
  v_cvt_pk_bf16_f32 v57, v110, v111
  v_cvt_pk_bf16_f32 v58, v124, v125
  v_cvt_pk_bf16_f32 v59, v126, v127
  buffer_store_dwordx4 v[56:59], v18, s[4:7], s44 offen offset:3072 sc1
  s_branch L_done
L_body_q128_fm_kq:
  s_lshr_b32 s42, s28, 2
  s_and_b32 s43, s28, 3
  s_mul_i32 s40, s28, 2048
  s_mul_i32 s41, s28, 2048
  s_add_u32 s41, s41, 65536
  v_lshlrev_b32 v18, 4, v1
  s_mul_i32 s44, s42, 8192
  v_lshrrev_b32 v22, 4, v1
  v_and_b32 v23, 15, v1
  v_add_u32 v12, s44, v18
  s_mul_i32 s44, s28, 2
  s_add_u32 s44, s44, 0
  s_and_b32 s46, s44, 1
  s_lshl_b32 s46, s46, 10
  s_lshr_b32 s44, s44, 1
  s_mul_i32 s44, s44, s45
  s_add_u32 s44, s44, s46
  v_add_u32 v4, s44, v18
  s_mul_i32 s44, s28, 2
  s_add_u32 s44, s44, 1
  s_and_b32 s46, s44, 1
  s_lshl_b32 s46, s46, 10
  s_lshr_b32 s44, s44, 1
  s_mul_i32 s44, s44, s45
  s_add_u32 s44, s44, s46
  s_sub_u32 s44, s44, 1024
  v_add_u32 v5, s44, v18
  v_lshrrev_b32 v23, 4, v1
  v_and_b32 v24, 15, v1
  s_mul_i32 s44, s28, 8
  s_add_u32 s44, s44, 0
  v_add_u32 v20, s44, v23
  v_and_b32 v21, 7, v20
  v_lshlrev_b32 v21, 1, v21
  v_xor_b32 v21, v21, v24
  v_mul_lo_u32 v20, v20, s39
  v_lshl_add_u32 v8, v21, 4, v20
  s_mul_i32 s44, s28, 8
  s_add_u32 s44, s44, 4
  v_add_u32 v20, s44, v23
  v_and_b32 v21, 7, v20
  v_lshlrev_b32 v21, 1, v21
  v_xor_b32 v21, v21, v24
  v_mul_lo_u32 v20, v20, s39
  v_lshl_add_u32 v9, v21, 4, v20
  v_subrev_u32 v9, 1024, v9
  v_bfe_u32 v20, v1, 2, 2
  v_lshrrev_b32 v21, 4, v1
  v_lshl_add_u32 v22, v21, 2, v20
  v_mul_u32_u24 v22, 256, v22
  v_and_b32 v23, 3, v1
  v_lshl_add_u32 v22, v23, 3, v22
  v_add_u32 v22, 65536, v22
  v_and_b32 v21, 1, v21
  v_lshl_or_b32 v20, v21, 2, v20
  s_mul_i32 s44, s43, 2
  s_add_u32 s44, s44, 0
  v_xor_b32 v21, s44, v20
  v_lshl_add_u32 v14, v21, 5, v22
  s_mul_i32 s44, s43, 2
  s_add_u32 s44, s44, 1
  v_xor_b32 v21, s44, v20
  v_lshl_add_u32 v15, v21, 5, v22
  s_add_u32 m0, s40, 0
  s_nop 0
  buffer_load_dwordx4 v4, s[8:11], s32 offen offset:0 sc1 lds
  buffer_load_dwordx4 v5, s[8:11], s32 offen offset:1024 sc1 lds
  s_add_u32 s32, s32, s33
  s_add_u32 m0, s41, 0
  s_nop 0
  buffer_load_dwordx4 v8, s[12:15], s34 offen offset:0 lds
  buffer_load_dwordx4 v9, s[12:15], s34 offen offset:1024 lds
  s_add_u32 s34, s34, s35
  s_add_u32 m0, s40, 16384
  s_nop 0
  buffer_load_dwordx4 v4, s[8:11], s32 offen offset:0 sc1 lds
  buffer_load_dwordx4 v5, s[8:11], s32 offen offset:1024 sc1 lds
  s_add_u32 s32, s32, s33
  s_add_u32 m0, s41, 16384
  s_nop 0
  buffer_load_dwordx4 v8, s[12:15], s34 offen offset:0 lds
  buffer_load_dwordx4 v9, s[12:15], s34 offen offset:1024 lds
  s_add_u32 s34, s34, s35
  s_add_u32 m0, s40, 32768
  s_nop 0
  buffer_load_dwordx4 v4, s[8:11], s32 offen offset:0 sc1 lds
  buffer_load_dwordx4 v5, s[8:11], s32 offen offset:1024 sc1 lds
  s_add_u32 s32, s32, s33
  s_add_u32 m0, s41, 32768
  s_nop 0
  buffer_load_dwordx4 v8, s[12:15], s34 offen offset:0 lds
  buffer_load_dwordx4 v9, s[12:15], s34 offen offset:1024 lds
  s_add_u32 s34, s34, s35
  s_add_u32 m0, s40, 49152
  s_nop 0
  buffer_load_dwordx4 v4, s[8:11], s32 offen offset:0 sc1 lds
  buffer_load_dwordx4 v5, s[8:11], s32 offen offset:1024 sc1 lds
  s_add_u32 s32, s32, s33
  s_add_u32 m0, s41, 49152
  s_nop 0
  buffer_load_dwordx4 v8, s[12:15], s34 offen offset:0 lds
  buffer_load_dwordx4 v9, s[12:15], s34 offen offset:1024 lds
  s_add_u32 s34, s34, s35
  v_mov_b32 v64, 0
  v_mov_b32 v65, 0
  v_mov_b32 v66, 0
  v_mov_b32 v67, 0
  v_mov_b32 v68, 0
  v_mov_b32 v69, 0
  v_mov_b32 v70, 0
  v_mov_b32 v71, 0
  v_mov_b32 v72, 0
  v_mov_b32 v73, 0
  v_mov_b32 v74, 0
  v_mov_b32 v75, 0
  v_mov_b32 v76, 0
  v_mov_b32 v77, 0
  v_mov_b32 v78, 0
  v_mov_b32 v79, 0
  v_mov_b32 v80, 0
  v_mov_b32 v81, 0
  v_mov_b32 v82, 0
  v_mov_b32 v83, 0
  v_mov_b32 v84, 0
  v_mov_b32 v85, 0
  v_mov_b32 v86, 0
  v_mov_b32 v87, 0
  v_mov_b32 v88, 0
  v_mov_b32 v89, 0
  v_mov_b32 v90, 0
  v_mov_b32 v91, 0
  v_mov_b32 v92, 0
  v_mov_b32 v93, 0
  v_mov_b32 v94, 0
  v_mov_b32 v95, 0
  s_waitcnt vmcnt(12)
  s_barrier
  ds_read_b64_tr_b16 a[32:33], v14 offset:0
  ds_read_b64_tr_b16 a[34:35], v14 offset:4096
  ds_read_b64_tr_b16 a[36:37], v15 offset:0
  ds_read_b64_tr_b16 a[38:39], v15 offset:4096
  ds_read_b128 a[0:3], v12 offset:0
  ds_read_b128 a[4:7], v12 offset:2048
  ds_read_b128 a[8:11], v12 offset:4096
  ds_read_b128 a[12:15], v12 offset:6144
  s_waitcnt lgkmcnt(0)
L_loop_q128_fm_kq:
  s_waitcnt lgkmcnt(3)
  v_mfma_f32_16x16x32_bf16 v[64:67], a[32:35], a[0:3], v[64:67]
  ds_read_b64_tr_b16 a[40:41], v14 offset:8192
  ds_read_b64_tr_b16 a[42:43], v14 offset:12288
  v_mfma_f32_16x16x32_bf16 v[68:71], a[36:39], a[0:3], v[68:71]
  ds_read_b64_tr_b16 a[44:45], v15 offset:8192
  ds_read_b64_tr_b16 a[46:47], v15 offset:12288
  s_waitcnt lgkmcnt(6)
  v_mfma_f32_16x16x32_bf16 v[72:75], a[32:35], a[4:7], v[72:75]
  ds_read_b128 a[16:19], v12 offset:1024
  ds_read_b128 a[20:23], v12 offset:3072
  v_mfma_f32_16x16x32_bf16 v[76:79], a[36:39], a[4:7], v[76:79]
  ds_read_b128 a[24:27], v12 offset:5120
  s_waitcnt lgkmcnt(8)
  v_mfma_f32_16x16x32_bf16 v[80:83], a[32:35], a[8:11], v[80:83]
  ds_read_b128 a[28:31], v12 offset:7168
  v_mfma_f32_16x16x32_bf16 v[84:87], a[36:39], a[8:11], v[84:87]
  s_waitcnt lgkmcnt(8)
  v_mfma_f32_16x16x32_bf16 v[88:91], a[32:35], a[12:15], v[88:91]
  v_mfma_f32_16x16x32_bf16 v[92:95], a[36:39], a[12:15], v[92:95]
  s_waitcnt lgkmcnt(3)
  v_mfma_f32_16x16x32_bf16 v[64:67], a[40:43], a[16:19], v[64:67]
  v_mfma_f32_16x16x32_bf16 v[68:71], a[44:47], a[16:19], v[68:71]
  s_waitcnt lgkmcnt(0)
  s_waitcnt vmcnt(8)
  s_barrier
  ds_read_b64_tr_b16 a[32:33], v14 offset:16384
  ds_read_b64_tr_b16 a[34:35], v14 offset:20480
  v_mfma_f32_16x16x32_bf16 v[72:75], a[40:43], a[20:23], v[72:75]
  ds_read_b64_tr_b16 a[36:37], v15 offset:16384
  ds_read_b64_tr_b16 a[38:39], v15 offset:20480
  v_mfma_f32_16x16x32_bf16 v[76:79], a[44:47], a[20:23], v[76:79]
  ds_read_b128 a[0:3], v12 offset:16384
  ds_read_b128 a[4:7], v12 offset:18432
  v_mfma_f32_16x16x32_bf16 v[80:83], a[40:43], a[24:27], v[80:83]
  ds_read_b128 a[8:11], v12 offset:20480
  ds_read_b128 a[12:15], v12 offset:22528
  v_mfma_f32_16x16x32_bf16 v[84:87], a[44:47], a[24:27], v[84:87]
  s_add_u32 m0, s40, 0
  v_mfma_f32_16x16x32_bf16 v[88:91], a[40:43], a[28:31], v[88:91]
  buffer_load_dwordx4 v4, s[8:11], s32 offen offset:0 sc1 lds
  v_mfma_f32_16x16x32_bf16 v[92:95], a[44:47], a[28:31], v[92:95]
  buffer_load_dwordx4 v5, s[8:11], s32 offen offset:1024 sc1 lds
  s_add_u32 s32, s32, s33
  s_add_u32 m0, s41, 0
  s_nop 0
  buffer_load_dwordx4 v8, s[12:15], s34 offen offset:0 lds
  buffer_load_dwordx4 v9, s[12:15], s34 offen offset:1024 lds
  s_add_u32 s34, s34, s35
  s_waitcnt lgkmcnt(3)
  v_mfma_f32_16x16x32_bf16 v[64:67], a[32:35], a[0:3], v[64:67]
  ds_read_b64_tr_b16 a[40:41], v14 offset:24576
  ds_read_b64_tr_b16 a[42:43], v14 offset:28672
  v_mfma_f32_16x16x32_bf16 v[68:71], a[36:39], a[0:3], v[68:71]
  ds_read_b64_tr_b16 a[44:45], v15 offset:24576
  ds_read_b64_tr_b16 a[46:47], v15 offset:28672
  s_waitcnt lgkmcnt(6)
  v_mfma_f32_16x16x32_bf16 v[72:75], a[32:35], a[4:7], v[72:75]
  ds_read_b128 a[16:19], v12 offset:17408
  ds_read_b128 a[20:23], v12 offset:19456
  v_mfma_f32_16x16x32_bf16 v[76:79], a[36:39], a[4:7], v[76:79]
  ds_read_b128 a[24:27], v12 offset:21504
  s_waitcnt lgkmcnt(8)
  v_mfma_f32_16x16x32_bf16 v[80:83], a[32:35], a[8:11], v[80:83]
  ds_read_b128 a[28:31], v12 offset:23552
  v_mfma_f32_16x16x32_bf16 v[84:87], a[36:39], a[8:11], v[84:87]
  s_waitcnt lgkmcnt(8)
  v_mfma_f32_16x16x32_bf16 v[88:91], a[32:35], a[12:15], v[88:91]
  v_mfma_f32_16x16x32_bf16 v[92:95], a[36:39], a[12:15], v[92:95]
  s_waitcnt lgkmcnt(3)
  v_mfma_f32_16x16x32_bf16 v[64:67], a[40:43], a[16:19], v[64:67]
  v_mfma_f32_16x16x32_bf16 v[68:71], a[44:47], a[16:19], v[68:71]
  s_waitcnt lgkmcnt(0)
  s_waitcnt vmcnt(8)
  s_barrier
  ds_read_b64_tr_b16 a[32:33], v14 offset:32768
  ds_read_b64_tr_b16 a[34:35], v14 offset:36864
  v_mfma_f32_16x16x32_bf16 v[72:75], a[40:43], a[20:23], v[72:75]
  ds_read_b64_tr_b16 a[36:37], v15 offset:32768
  ds_read_b64_tr_b16 a[38:39], v15 offset:36864
  v_mfma_f32_16x16x32_bf16 v[76:79], a[44:47], a[20:23], v[76:79]
  ds_read_b128 a[0:3], v12 offset:32768
  ds_read_b128 a[4:7], v12 offset:34816
  v_mfma_f32_16x16x32_bf16 v[80:83], a[40:43], a[24:27], v[80:83]
  ds_read_b128 a[8:11], v12 offset:36864
  ds_read_b128 a[12:15], v12 offset:38912
  v_mfma_f32_16x16x32_bf16 v[84:87], a[44:47], a[24:27], v[84:87]
  s_add_u32 m0, s40, 16384
  v_mfma_f32_16x16x32_bf16 v[88:91], a[40:43], a[28:31], v[88:91]
  buffer_load_dwordx4 v4, s[8:11], s32 offen offset:0 sc1 lds
  v_mfma_f32_16x16x32_bf16 v[92:95], a[44:47], a[28:31], v[92:95]
  buffer_load_dwordx4 v5, s[8:11], s32 offen offset:1024 sc1 lds
  s_add_u32 s32, s32, s33
  s_add_u32 m0, s41, 16384
  s_nop 0
  buffer_load_dwordx4 v8, s[12:15], s34 offen offset:0 lds
  buffer_load_dwordx4 v9, s[12:15], s34 offen offset:1024 lds
  s_add_u32 s34, s34, s35
  s_waitcnt lgkmcnt(3)
  v_mfma_f32_16x16x32_bf16 v[64:67], a[32:35], a[0:3], v[64:67]
  ds_read_b64_tr_b16 a[40:41], v14 offset:40960
  ds_read_b64_tr_b16 a[42:43], v14 offset:45056
  v_mfma_f32_16x16x32_bf16 v[68:71], a[36:39], a[0:3], v[68:71]
  ds_read_b64_tr_b16 a[44:45], v15 offset:40960
  ds_read_b64_tr_b16 a[46:47], v15 offset:45056
  s_waitcnt lgkmcnt(6)
  v_mfma_f32_16x16x32_bf16 v[72:75], a[32:35], a[4:7], v[72:75]
  ds_read_b128 a[16:19], v12 offset:33792
  ds_read_b128 a[20:23], v12 offset:35840
  v_mfma_f32_16x16x32_bf16 v[76:79], a[36:39], a[4:7], v[76:79]
  ds_read_b128 a[24:27], v12 offset:37888
  s_waitcnt lgkmcnt(8)
  v_mfma_f32_16x16x32_bf16 v[80:83], a[32:35], a[8:11], v[80:83]
  ds_read_b128 a[28:31], v12 offset:39936
  v_mfma_f32_16x16x32_bf16 v[84:87], a[36:39], a[8:11], v[84:87]
  s_waitcnt lgkmcnt(8)
  v_mfma_f32_16x16x32_bf16 v[88:91], a[32:35], a[12:15], v[88:91]
  v_mfma_f32_16x16x32_bf16 v[92:95], a[36:39], a[12:15], v[92:95]
  s_waitcnt lgkmcnt(3)
  v_mfma_f32_16x16x32_bf16 v[64:67], a[40:43], a[16:19], v[64:67]
  v_mfma_f32_16x16x32_bf16 v[68:71], a[44:47], a[16:19], v[68:71]
  s_waitcnt lgkmcnt(0)
  s_waitcnt vmcnt(8)
  s_barrier
  ds_read_b64_tr_b16 a[32:33], v14 offset:49152
  ds_read_b64_tr_b16 a[34:35], v14 offset:53248
  v_mfma_f32_16x16x32_bf16 v[72:75], a[40:43], a[20:23], v[72:75]
  ds_read_b64_tr_b16 a[36:37], v15 offset:49152
  ds_read_b64_tr_b16 a[38:39], v15 offset:53248
  v_mfma_f32_16x16x32_bf16 v[76:79], a[44:47], a[20:23], v[76:79]
  ds_read_b128 a[0:3], v12 offset:49152
  ds_read_b128 a[4:7], v12 offset:51200
  v_mfma_f32_16x16x32_bf16 v[80:83], a[40:43], a[24:27], v[80:83]
  ds_read_b128 a[8:11], v12 offset:53248
  ds_read_b128 a[12:15], v12 offset:55296
  v_mfma_f32_16x16x32_bf16 v[84:87], a[44:47], a[24:27], v[84:87]
  s_add_u32 m0, s40, 32768
  v_mfma_f32_16x16x32_bf16 v[88:91], a[40:43], a[28:31], v[88:91]
  buffer_load_dwordx4 v4, s[8:11], s32 offen offset:0 sc1 lds
  v_mfma_f32_16x16x32_bf16 v[92:95], a[44:47], a[28:31], v[92:95]
  buffer_load_dwordx4 v5, s[8:11], s32 offen offset:1024 sc1 lds
  s_add_u32 s32, s32, s33
  s_add_u32 m0, s41, 32768
  s_nop 0
  buffer_load_dwordx4 v8, s[12:15], s34 offen offset:0 lds
  buffer_load_dwordx4 v9, s[12:15], s34 offen offset:1024 lds
  s_add_u32 s34, s34, s35
  s_waitcnt lgkmcnt(3)
  v_mfma_f32_16x16x32_bf16 v[64:67], a[32:35], a[0:3], v[64:67]
  ds_read_b64_tr_b16 a[40:41], v14 offset:57344
  ds_read_b64_tr_b16 a[42:43], v14 offset:61440
  v_mfma_f32_16x16x32_bf16 v[68:71], a[36:39], a[0:3], v[68:71]
  ds_read_b64_tr_b16 a[44:45], v15 offset:57344
  ds_read_b64_tr_b16 a[46:47], v15 offset:61440
  s_waitcnt lgkmcnt(6)
  v_mfma_f32_16x16x32_bf16 v[72:75], a[32:35], a[4:7], v[72:75]
  ds_read_b128 a[16:19], v12 offset:50176
  ds_read_b128 a[20:23], v12 offset:52224
  v_mfma_f32_16x16x32_bf16 v[76:79], a[36:39], a[4:7], v[76:79]
  ds_read_b128 a[24:27], v12 offset:54272
  s_waitcnt lgkmcnt(8)
  v_mfma_f32_16x16x32_bf16 v[80:83], a[32:35], a[8:11], v[80:83]
  ds_read_b128 a[28:31], v12 offset:56320
  v_mfma_f32_16x16x32_bf16 v[84:87], a[36:39], a[8:11], v[84:87]
  s_waitcnt lgkmcnt(8)
  v_mfma_f32_16x16x32_bf16 v[88:91], a[32:35], a[12:15], v[88:91]
  v_mfma_f32_16x16x32_bf16 v[92:95], a[36:39], a[12:15], v[92:95]
  s_waitcnt lgkmcnt(3)
  v_mfma_f32_16x16x32_bf16 v[64:67], a[40:43], a[16:19], v[64:67]
  v_mfma_f32_16x16x32_bf16 v[68:71], a[44:47], a[16:19], v[68:71]
  s_waitcnt lgkmcnt(0)
  s_waitcnt vmcnt(8)
  s_barrier
  ds_read_b64_tr_b16 a[32:33], v14 offset:0
  ds_read_b64_tr_b16 a[34:35], v14 offset:4096
  v_mfma_f32_16x16x32_bf16 v[72:75], a[40:43], a[20:23], v[72:75]
  ds_read_b64_tr_b16 a[36:37], v15 offset:0
  ds_read_b64_tr_b16 a[38:39], v15 offset:4096
  v_mfma_f32_16x16x32_bf16 v[76:79], a[44:47], a[20:23], v[76:79]
  ds_read_b128 a[0:3], v12 offset:0
  ds_read_b128 a[4:7], v12 offset:2048
  v_mfma_f32_16x16x32_bf16 v[80:83], a[40:43], a[24:27], v[80:83]
  ds_read_b128 a[8:11], v12 offset:4096
  ds_read_b128 a[12:15], v12 offset:6144
  v_mfma_f32_16x16x32_bf16 v[84:87], a[44:47], a[24:27], v[84:87]
  s_add_u32 m0, s40, 49152
  v_mfma_f32_16x16x32_bf16 v[88:91], a[40:43], a[28:31], v[88:91]
  buffer_load_dwordx4 v4, s[8:11], s32 offen offset:0 sc1 lds
  v_mfma_f32_16x16x32_bf16 v[92:95], a[44:47], a[28:31], v[92:95]
  buffer_load_dwordx4 v5, s[8:11], s32 offen offset:1024 sc1 lds
  s_add_u32 s32, s32, s33
  s_add_u32 m0, s41, 49152
  s_nop 0
  buffer_load_dwordx4 v8, s[12:15], s34 offen offset:0 lds
  buffer_load_dwordx4 v9, s[12:15], s34 offen offset:1024 lds
  s_add_u32 s34, s34, s35
  s_sub_u32 s36, s36, 1
  s_cmp_lg_u32 s36, 0
  s_cbranch_scc1 L_loop_q128_fm_kq
  s_waitcnt lgkmcnt(3)
  v_mfma_f32_16x16x32_bf16 v[64:67], a[32:35], a[0:3], v[64:67]
  ds_read_b64_tr_b16 a[40:41], v14 offset:8192
  ds_read_b64_tr_b16 a[42:43], v14 offset:12288
  v_mfma_f32_16x16x32_bf16 v[68:71], a[36:39], a[0:3], v[68:71]
  ds_read_b64_tr_b16 a[44:45], v15 offset:8192
  ds_read_b64_tr_b16 a[46:47], v15 offset:12288
  s_waitcnt lgkmcnt(6)
  v_mfma_f32_16x16x32_bf16 v[72:75], a[32:35], a[4:7], v[72:75]
  ds_read_b128 a[16:19], v12 offset:1024
  ds_read_b128 a[20:23], v12 offset:3072
  v_mfma_f32_16x16x32_bf16 v[76:79], a[36:39], a[4:7], v[76:79]
  ds_read_b128 a[24:27], v12 offset:5120
  s_waitcnt lgkmcnt(8)
  v_mfma_f32_16x16x32_bf16 v[80:83], a[32:35], a[8:11], v[80:83]
  ds_read_b128 a[28:31], v12 offset:7168
  v_mfma_f32_16x16x32_bf16 v[84:87], a[36:39], a[8:11], v[84:87]
  s_waitcnt lgkmcnt(8)
  v_mfma_f32_16x16x32_bf16 v[88:91], a[32:35], a[12:15], v[88:91]
  v_mfma_f32_16x16x32_bf16 v[92:95], a[36:39], a[12:15], v[92:95]
  s_waitcnt lgkmcnt(3)
  v_mfma_f32_16x16x32_bf16 v[64:67], a[40:43], a[16:19], v[64:67]
  v_mfma_f32_16x16x32_bf16 v[68:71], a[44:47], a[16:19], v[68:71]
  s_waitcnt lgkmcnt(0)
  s_waitcnt vmcnt(8)
  s_barrier
  ds_read_b64_tr_b16 a[32:33], v14 offset:16384
  ds_read_b64_tr_b16 a[34:35], v14 offset:20480
  v_mfma_f32_16x16x32_bf16 v[72:75], a[40:43], a[20:23], v[72:75]
  ds_read_b64_tr_b16 a[36:37], v15 offset:16384
  ds_read_b64_tr_b16 a[38:39], v15 offset:20480
  v_mfma_f32_16x16x32_bf16 v[76:79], a[44:47], a[20:23], v[76:79]
  ds_read_b128 a[0:3], v12 offset:16384
  ds_read_b128 a[4:7], v12 offset:18432
  v_mfma_f32_16x16x32_bf16 v[80:83], a[40:43], a[24:27], v[80:83]
  ds_read_b128 a[8:11], v12 offset:20480
  ds_read_b128 a[12:15], v12 offset:22528
  v_mfma_f32_16x16x32_bf16 v[84:87], a[44:47], a[24:27], v[84:87]
  v_mfma_f32_16x16x32_bf16 v[88:91], a[40:43], a[28:31], v[88:91]
  v_mfma_f32_16x16x32_bf16 v[92:95], a[44:47], a[28:31], v[92:95]
  s_waitcnt lgkmcnt(3)
  v_mfma_f32_16x16x32_bf16 v[64:67], a[32:35], a[0:3], v[64:67]
  ds_read_b64_tr_b16 a[40:41], v14 offset:24576
  ds_read_b64_tr_b16 a[42:43], v14 offset:28672
  v_mfma_f32_16x16x32_bf16 v[68:71], a[36:39], a[0:3], v[68:71]
  ds_read_b64_tr_b16 a[44:45], v15 offset:24576
  ds_read_b64_tr_b16 a[46:47], v15 offset:28672
  s_waitcnt lgkmcnt(6)
  v_mfma_f32_16x16x32_bf16 v[72:75], a[32:35], a[4:7], v[72:75]
  ds_read_b128 a[16:19], v12 offset:17408
  ds_read_b128 a[20:23], v12 offset:19456
  v_mfma_f32_16x16x32_bf16 v[76:79], a[36:39], a[4:7], v[76:79]
  ds_read_b128 a[24:27], v12 offset:21504
  s_waitcnt lgkmcnt(8)
  v_mfma_f32_16x16x32_bf16 v[80:83], a[32:35], a[8:11], v[80:83]
  ds_read_b128 a[28:31], v12 offset:23552
  v_mfma_f32_16x16x32_bf16 v[84:87], a[36:39], a[8:11], v[84:87]
  s_waitcnt lgkmcnt(8)
  v_mfma_f32_16x16x32_bf16 v[88:91], a[32:35], a[12:15], v[88:91]
  v_mfma_f32_16x16x32_bf16 v[92:95], a[36:39], a[12:15], v[92:95]
  s_waitcnt lgkmcnt(3)
  v_mfma_f32_16x16x32_bf16 v[64:67], a[40:43], a[16:19], v[64:67]
  v_mfma_f32_16x16x32_bf16 v[68:71], a[44:47], a[16:19], v[68:71]
  s_waitcnt lgkmcnt(0)
  s_waitcnt vmcnt(4)
  s_barrier
  ds_read_b64_tr_b16 a[32:33], v14 offset:32768
  ds_read_b64_tr_b16 a[34:35], v14 offset:36864
  v_mfma_f32_16x16x32_bf16 v[72:75], a[40:43], a[20:23], v[72:75]
  ds_read_b64_tr_b16 a[36:37], v15 offset:32768
  ds_read_b64_tr_b16 a[38:39], v15 offset:36864
  v_mfma_f32_16x16x32_bf16 v[76:79], a[44:47], a[20:23], v[76:79]
  ds_read_b128 a[0:3], v12 offset:32768
  ds_read_b128 a[4:7], v12 offset:34816
  v_mfma_f32_16x16x32_bf16 v[80:83], a[40:43], a[24:27], v[80:83]
  ds_read_b128 a[8:11], v12 offset:36864
  ds_read_b128 a[12:15], v12 offset:38912
  v_mfma_f32_16x16x32_bf16 v[84:87], a[44:47], a[24:27], v[84:87]
  v_mfma_f32_16x16x32_bf16 v[88:91], a[40:43], a[28:31], v[88:91]
  v_mfma_f32_16x16x32_bf16 v[92:95], a[44:47], a[28:31], v[92:95]
  s_waitcnt lgkmcnt(3)
  v_mfma_f32_16x16x32_bf16 v[64:67], a[32:35], a[0:3], v[64:67]
  ds_read_b64_tr_b16 a[40:41], v14 offset:40960
  ds_read_b64_tr_b16 a[42:43], v14 offset:45056
  v_mfma_f32_16x16x32_bf16 v[68:71], a[36:39], a[0:3], v[68:71]
  ds_read_b64_tr_b16 a[44:45], v15 offset:40960
  ds_read_b64_tr_b16 a[46:47], v15 offset:45056
  s_waitcnt lgkmcnt(6)
  v_mfma_f32_16x16x32_bf16 v[72:75], a[32:35], a[4:7], v[72:75]
  ds_read_b128 a[16:19], v12 offset:33792
  ds_read_b128 a[20:23], v12 offset:35840
  v_mfma_f32_16x16x32_bf16 v[76:79], a[36:39], a[4:7], v[76:79]
  ds_read_b128 a[24:27], v12 offset:37888
  s_waitcnt lgkmcnt(8)
  v_mfma_f32_16x16x32_bf16 v[80:83], a[32:35], a[8:11], v[80:83]
  ds_read_b128 a[28:31], v12 offset:39936
  v_mfma_f32_16x16x32_bf16 v[84:87], a[36:39], a[8:11], v[84:87]
  s_waitcnt lgkmcnt(8)
  v_mfma_f32_16x16x32_bf16 v[88:91], a[32:35], a[12:15], v[88:91]
  v_mfma_f32_16x16x32_bf16 v[92:95], a[36:39], a[12:15], v[92:95]
  s_waitcnt lgkmcnt(3)
  v_mfma_f32_16x16x32_bf16 v[64:67], a[40:43], a[16:19], v[64:67]
  v_mfma_f32_16x16x32_bf16 v[68:71], a[44:47], a[16:19], v[68:71]
  s_waitcnt lgkmcnt(0)
  s_waitcnt vmcnt(0)
  s_barrier
  ds_read_b64_tr_b16 a[32:33], v14 offset:49152
  ds_read_b64_tr_b16 a[34:35], v14 offset:53248
  v_mfma_f32_16x16x32_bf16 v[72:75], a[40:43], a[20:23], v[72:75]
  ds_read_b64_tr_b16 a[36:37], v15 offset:49152
  ds_read_b64_tr_b16 a[38:39], v15 offset:53248
  v_mfma_f32_16x16x32_bf16 v[76:79], a[44:47], a[20:23], v[76:79]
  ds_read_b128 a[0:3], v12 offset:49152
  ds_read_b128 a[4:7], v12 offset:51200
  v_mfma_f32_16x16x32_bf16 v[80:83], a[40:43], a[24:27], v[80:83]
  ds_read_b128 a[8:11], v12 offset:53248
  ds_read_b128 a[12:15], v12 offset:55296
  v_mfma_f32_16x16x32_bf16 v[84:87], a[44:47], a[24:27], v[84:87]
  v_mfma_f32_16x16x32_bf16 v[88:91], a[40:43], a[28:31], v[88:91]
  v_mfma_f32_16x16x32_bf16 v[92:95], a[44:47], a[28:31], v[92:95]
  s_waitcnt lgkmcnt(3)
  v_mfma_f32_16x16x32_bf16 v[64:67], a[32:35], a[0:3], v[64:67]
  ds_read_b64_tr_b16 a[40:41], v14 offset:57344
  ds_read_b64_tr_b16 a[42:43], v14 offset:61440
  v_mfma_f32_16x16x32_bf16 v[68:71], a[36:39], a[0:3], v[68:71]
  ds_read_b64_tr_b16 a[44:45], v15 offset:57344
  ds_read_b64_tr_b16 a[46:47], v15 offset:61440
  s_waitcnt lgkmcnt(6)
  v_mfma_f32_16x16x32_bf16 v[72:75], a[32:35], a[4:7], v[72:75]
  ds_read_b128 a[16:19], v12 offset:50176
  ds_read_b128 a[20:23], v12 offset:52224
  v_mfma_f32_16x16x32_bf16 v[76:79], a[36:39], a[4:7], v[76:79]
  ds_read_b128 a[24:27], v12 offset:54272
  s_waitcnt lgkmcnt(8)
  v_mfma_f32_16x16x32_bf16 v[80:83], a[32:35], a[8:11], v[80:83]
  ds_read_b128 a[28:31], v12 offset:56320
  v_mfma_f32_16x16x32_bf16 v[84:87], a[36:39], a[8:11], v[84:87]
  s_waitcnt lgkmcnt(8)
  v_mfma_f32_16x16x32_bf16 v[88:91], a[32:35], a[12:15], v[88:91]
  v_mfma_f32_16x16x32_bf16 v[92:95], a[36:39], a[12:15], v[92:95]
  s_waitcnt lgkmcnt(3)
  v_mfma_f32_16x16x32_bf16 v[64:67], a[40:43], a[16:19], v[64:67]
  v_mfma_f32_16x16x32_bf16 v[68:71], a[44:47], a[16:19], v[68:71]
  s_waitcnt lgkmcnt(2)
  v_mfma_f32_16x16x32_bf16 v[72:75], a[40:43], a[20:23], v[72:75]
  v_mfma_f32_16x16x32_bf16 v[76:79], a[44:47], a[20:23], v[76:79]
  s_waitcnt lgkmcnt(1)
  v_mfma_f32_16x16x32_bf16 v[80:83], a[40:43], a[24:27], v[80:83]
  v_mfma_f32_16x16x32_bf16 v[84:87], a[44:47], a[24:27], v[84:87]
  s_waitcnt lgkmcnt(0)
  v_mfma_f32_16x16x32_bf16 v[88:91], a[40:43], a[28:31], v[88:91]
  v_mfma_f32_16x16x32_bf16 v[92:95], a[44:47], a[28:31], v[92:95]
L_episel_48:
  s_nop 7
L_epi_final_47:
  s_cmp_lg_u32 s28, 0
  s_cbranch_scc1 L_latew_49
  s_mov_b32 s42, s78
  s_cmp_eq_u32 s42, 0
  s_cbranch_scc1 L_latew_49
  v_mov_b32 v2, 0
  v_writelane_b32 v2, s78, 0
  v_lshrrev_b32 v3, 24, v2
  v_lshlrev_b32 v3, 7, v3
  v_and_b32 v2, 0xffffff, v2
  s_mov_b32 s83, 0
  s_add_u32 s42, s59, 0x5c14000
L_poll_50:
  buffer_load_dword v20, v3, s[4:7], s42 offen sc1
  s_waitcnt vmcnt(0)
  v_cmp_lt_u32 vcc, v20, v2
  s_cbranch_vccz L_latew_49
  s_sleep 4
  s_add_u32 s83, s83, 1
  s_cmp_lt_u32 s83, 1048576
  s_cbranch_scc1 L_poll_50
  s_branch L_abort
L_latew_49:
  s_barrier
  s_lshr_b32 s42, s28, 2
  s_and_b32 s43, s28, 3
  s_mul_i32 s44, s42, 64
  s_add_u32 s48, s48, s44
  s_mul_i32 s44, s43, 32
  s_add_u32 s49, s49, s44
  s_lshl_b32 s44, s48, 11
  s_lshl_b32 s45, s49, 5
  s_add_u32 s37, s44, s45
  s_add_u32 s37, s37, 0x5000000
  s_lshl_b32 s44, s48, 2
  s_add_u32 s44, s44, 0x5c00000
  v_and_b32 v2, 15, v1
  v_lshlrev_b32 v3, 2, v2
  buffer_load_dword v4, v3, s[4:7], s44 offen offset:0 sc1
  buffer_load_dword v5, v3, s[4:7], s44 offen offset:64 sc1
  buffer_load_dword v6, v3, s[4:7], s44 offen offset:128 sc1
  buffer_load_dword v7, v3, s[4:7], s44 offen offset:192 sc1
  buffer_load_dwordx4 v[20:23], v18, s[4:7], s37 offen offset:0 sc1
  s_add_u32 s37, s37, 32768
  buffer_load_dwordx4 v[24:27], v18, s[4:7], s37 offen offset:0 sc1
  s_add_u32 s37, s37, 32768
  buffer_load_dwordx4 v[28:31], v18, s[4:7], s37 offen offset:0 sc1
  s_add_u32 s37, s37, 32768
  v_lshlrev_b32 v12, 11, v2
  v_bfe_u32 v3, v1, 4, 1
  v_lshl_add_u32 v12, v3, 5, v12
  v_lshrrev_b32 v3, 5, v1
  v_lshl_add_u32 v12, v3, 4, v12
  s_lshl_b32 s44, s48, 11
  s_lshl_b32 s45, s49, 1
  s_add_u32 s44, s44, s45
  s_waitcnt vmcnt(2)
  v_sub_f32 v14, 1.0, v4
  v_mov_b32 v16, v4
  v_lshlrev_b32 v52, 16, v20
  v_and_b32 v53, 0xffff0000, v20
  v_pk_mul_f32 v[64:65], v[64:65], v[16:17] op_sel_hi:[1,0]
  v_pk_fma_f32 v[64:65], v[52:53], v[14:15], v[64:65] op_sel_hi:[1,0,1]
  v_cvt_pk_bf16_f32 v56, v64, v65
  v_lshlrev_b32 v54, 16, v21
  v_and_b32 v55, 0xffff0000, v21
  v_pk_mul_f32 v[66:67], v[66:67], v[16:17] op_sel_hi:[1,0]
  v_pk_fma_f32 v[66:67], v[54:55], v[14:15], v[66:67] op_sel_hi:[1,0,1]
  v_cvt_pk_bf16_f32 v57, v66, v67
  v_lshlrev_b32 v52, 16, v22
  v_and_b32 v53, 0xffff0000, v22
  v_pk_mul_f32 v[68:69], v[68:69], v[16:17] op_sel_hi:[1,0]
  v_pk_fma_f32 v[68:69], v[52:53], v[14:15], v[68:69] op_sel_hi:[1,0,1]
  v_cvt_pk_bf16_f32 v58, v68, v69
  v_lshlrev_b32 v54, 16, v23
  v_and_b32 v55, 0xffff0000, v23
  v_pk_mul_f32 v[70:71], v[70:71], v[16:17] op_sel_hi:[1,0]
  v_pk_fma_f32 v[70:71], v[54:55], v[14:15], v[70:71] op_sel_hi:[1,0,1]
  v_cvt_pk_bf16_f32 v59, v70, v71
  s_nop 1
  v_permlane16_swap_b32 v56, v58
  v_permlane16_swap_b32 v57, v59
  buffer_store_dwordx4 v[56:59], v12, s[16:19], s44 offen offset:0
  s_nop 0
  buffer_load_dwordx4 v[32:35], v18, s[4:7], s37 offen offset:0 sc1
  s_add_u32 s37, s37, 32768
  s_add_u32 s44, s44, 32768
  s_waitcnt vmcnt(3)
  v_sub_f32 v14, 1.0, v5
  v_mov_b32 v16, v5
  v_lshlrev_b32 v52, 16, v24
  v_and_b32 v53, 0xffff0000, v24
  v_pk_mul_f32 v[72:73], v[72:73], v[16:17] op_sel_hi:[1,0]
  v_pk_fma_f32 v[72:73], v[52:53], v[14:15], v[72:73] op_sel_hi:[1,0,1]
  v_cvt_pk_bf16_f32 v56, v72, v73
  v_lshlrev_b32 v54, 16, v25
  v_and_b32 v55, 0xffff0000, v25
  v_pk_mul_f32 v[74:75], v[74:75], v[16:17] op_sel_hi:[1,0]
  v_pk_fma_f32 v[74:75], v[54:55], v[14:15], v[74:75] op_sel_hi:[1,0,1]
  v_cvt_pk_bf16_f32 v57, v74, v75
  v_lshlrev_b32 v52, 16, v26
  v_and_b32 v53, 0xffff0000, v26
  v_pk_mul_f32 v[76:77], v[76:77], v[16:17] op_sel_hi:[1,0]
  v_pk_fma_f32 v[76:77], v[52:53], v[14:15], v[76:77] op_sel_hi:[1,0,1]
  v_cvt_pk_bf16_f32 v58, v76, v77
  v_lshlrev_b32 v54, 16, v27
  v_and_b32 v55, 0xffff0000, v27
  v_pk_mul_f32 v[78:79], v[78:79], v[16:17] op_sel_hi:[1,0]
  v_pk_fma_f32 v[78:79], v[54:55], v[14:15], v[78:79] op_sel_hi:[1,0,1]
  v_cvt_pk_bf16_f32 v59, v78, v79
  s_nop 1
  v_permlane16_swap_b32 v56, v58
  v_permlane16_swap_b32 v57, v59
  buffer_store_dwordx4 v[56:59], v12, s[16:19], s44 offen offset:0
  s_nop 0
  s_add_u32 s44, s44, 32768
  s_waitcnt vmcnt(3)
  v_sub_f32 v14, 1.0, v6
  v_mov_b32 v16, v6
  v_lshlrev_b32 v52, 16, v28
  v_and_b32 v53, 0xffff0000, v28
  v_pk_mul_f32 v[80:81], v[80:81], v[16:17] op_sel_hi:[1,0]
  v_pk_fma_f32 v[80:81], v[52:53], v[14:15], v[80:81] op_sel_hi:[1,0,1]
  v_cvt_pk_bf16_f32 v56, v80, v81
  v_lshlrev_b32 v54, 16, v29
  v_and_b32 v55, 0xffff0000, v29
  v_pk_mul_f32 v[82:83], v[82:83], v[16:17] op_sel_hi:[1,0]
  v_pk_fma_f32 v[82:83], v[54:55], v[14:15], v[82:83] op_sel_hi:[1,0,1]
  v_cvt_pk_bf16_f32 v57, v82, v83
  v_lshlrev_b32 v52, 16, v30
  v_and_b32 v53, 0xffff0000, v30
  v_pk_mul_f32 v[84:85], v[84:85], v[16:17] op_sel_hi:[1,0]
  v_pk_fma_f32 v[84:85], v[52:53], v[14:15], v[84:85] op_sel_hi:[1,0,1]
  v_cvt_pk_bf16_f32 v58, v84, v85
  v_lshlrev_b32 v54, 16, v31
  v_and_b32 v55, 0xffff0000, v31
  v_pk_mul_f32 v[86:87], v[86:87], v[16:17] op_sel_hi:[1,0]
  v_pk_fma_f32 v[86:87], v[54:55], v[14:15], v[86:87] op_sel_hi:[1,0,1]
  v_cvt_pk_bf16_f32 v59, v86, v87
  s_nop 1
  v_permlane16_swap_b32 v56, v58
  v_permlane16_swap_b32 v57, v59
  buffer_store_dwordx4 v[56:59], v12, s[16:19], s44 offen offset:0
  s_nop 0
  s_add_u32 s44, s44, 32768
  s_waitcnt vmcnt(2)
  v_sub_f32 v14, 1.0, v7
  v_mov_b32 v16, v7
  v_lshlrev_b32 v52, 16, v32
  v_and_b32 v53, 0xffff0000, v32
  v_pk_mul_f32 v[88:89], v[88:89], v[16:17] op_sel_hi:[1,0]
  v_pk_fma_f32 v[88:89], v[52:53], v[14:15], v[88:89] op_sel_hi:[1,0,1]
  v_cvt_pk_bf16_f32 v56, v88, v89
  v_lshlrev_b32 v54, 16, v33
  v_and_b32 v55, 0xffff0000, v33
  v_pk_mul_f32 v[90:91], v[90:91], v[16:17] op_sel_hi:[1,0]
  v_pk_fma_f32 v[90:91], v[54:55], v[14:15], v[90:91] op_sel_hi:[1,0,1]
  v_cvt_pk_bf16_f32 v57, v90, v91
  v_lshlrev_b32 v52, 16, v34
  v_and_b32 v53, 0xffff0000, v34
  v_pk_mul_f32 v[92:93], v[92:93], v[16:17] op_sel_hi:[1,0]
  v_pk_fma_f32 v[92:93], v[52:53], v[14:15], v[92:93] op_sel_hi:[1,0,1]
  v_cvt_pk_bf16_f32 v58, v92, v93
  v_lshlrev_b32 v54, 16, v35
  v_and_b32 v55, 0xffff0000, v35
  v_pk_mul_f32 v[94:95], v[94:95], v[16:17] op_sel_hi:[1,0]
  v_pk_fma_f32 v[94:95], v[54:55], v[14:15], v[94:95] op_sel_hi:[1,0,1]
  v_cvt_pk_bf16_f32 v59, v94, v95
  s_nop 1
  v_permlane16_swap_b32 v56, v58
  v_permlane16_swap_b32 v57, v59
  buffer_store_dwordx4 v[56:59], v12, s[16:19], s44 offen offset:0
  s_nop 0
  s_add_u32 s44, s44, 32768
  s_branch L_done
L_body_q64_fm_kq:
  s_lshr_b32 s42, s28, 1
  s_and_b32 s43, s28, 1
  s_mul_i32 s40, s28, 1024
  s_mul_i32 s41, s28, 1024
  s_add_u32 s41, s41, 65536
  v_lshlrev_b32 v18, 4, v1
  s_mul_i32 s44, s42, 2048
  v_lshrrev_b32 v22, 4, v1
  v_and_b32 v23, 15, v1
  v_add_u32 v12, s44, v18
  s_mul_i32 s44, s28, 1
  s_add_u32 s44, s44, 0
  s_and_b32 s46, s44, 1
  s_lshl_b32 s46, s46, 10
  s_lshr_b32 s44, s44, 1
  s_mul_i32 s44, s44, s45
  s_add_u32 s44, s44, s46
  v_add_u32 v4, s44, v18
  v_lshrrev_b32 v23, 3, v1
  v_and_b32 v24, 7, v1
  s_mul_i32 s44, s28, 8
  s_add_u32 s44, s44, 0
  v_add_u32 v20, s44, v23
  v_and_b32 v21, 7, v20
  v_lshrrev_b32 v21, 1, v21
  v_lshlrev_b32 v21, 1, v21
  v_xor_b32 v21, v21, v24
  v_mul_lo_u32 v20, v20, s39
  v_lshl_add_u32 v8, v21, 4, v20
  v_bfe_u32 v20, v1, 2, 2
  v_lshrrev_b32 v21, 4, v1
  v_lshl_add_u32 v22, v21, 2, v20
  v_mul_u32_u24 v22, 128, v22
  v_and_b32 v23, 3, v1
  v_lshl_add_u32 v22, v23, 3, v22
  v_add_u32 v22, 65536, v22
  v_and_b32 v21, 1, v21
  v_lshl_or_b32 v20, v21, 2, v20
  v_lshrrev_b32 v20, 1, v20
  s_mul_i32 s44, s43, 2
  s_add_u32 s44, s44, 0
  v_xor_b32 v21, s44, v20
  v_lshl_add_u32 v14, v21, 5, v22
  s_mul_i32 s44, s43, 2
  s_add_u32 s44, s44, 1
  v_xor_b32 v21, s44, v20
  v_lshl_add_u32 v15, v21, 5, v22
  s_add_u32 m0, s40, 0
  s_nop 0
  buffer_load_dwordx4 v4, s[8:11], s32 offen offset:0 sc1 lds
  s_add_u32 s32, s32, s33
  s_add_u32 m0, s41, 0
  s_nop 0
  buffer_load_dwordx4 v8, s[12:15], s34 offen offset:0 lds
  s_add_u32 s34, s34, s35
  s_add_u32 m0, s40, 8192
  s_nop 0
  buffer_load_dwordx4 v4, s[8:11], s32 offen offset:0 sc1 lds
  s_add_u32 s32, s32, s33
  s_add_u32 m0, s41, 8192
  s_nop 0
  buffer_load_dwordx4 v8, s[12:15], s34 offen offset:0 lds
  s_add_u32 s34, s34, s35
  s_add_u32 m0, s40, 16384
  s_nop 0
  buffer_load_dwordx4 v4, s[8:11], s32 offen offset:0 sc1 lds
  s_add_u32 s32, s32, s33
  s_add_u32 m0, s41, 16384
  s_nop 0
  buffer_load_dwordx4 v8, s[12:15], s34 offen offset:0 lds
  s_add_u32 s34, s34, s35
  s_add_u32 m0, s40, 24576
  s_nop 0
  buffer_load_dwordx4 v4, s[8:11], s32 offen offset:0 sc1 lds
  s_add_u32 s32, s32, s33
  s_add_u32 m0, s41, 24576
  s_nop 0
  buffer_load_dwordx4 v8, s[12:15], s34 offen offset:0 lds
  s_add_u32 s34, s34, s35
  s_add_u32 m0, s40, 32768
  s_nop 0
  buffer_load_dwordx4 v4, s[8:11], s32 offen offset:0 sc1 lds
  s_add_u32 s32, s32, s33
  s_add_u32 m0, s41, 32768
  s_nop 0
  buffer_load_dwordx4 v8, s[12:15], s34 offen offset:0 lds
  s_add_u32 s34, s34, s35
  s_add_u32 m0, s40, 40960
  s_nop 0
  buffer_load_dwordx4 v4, s[8:11], s32 offen offset:0 sc1 lds
  s_add_u32 s32, s32, s33
  s_add_u32 m0, s41, 40960
  s_nop 0
  buffer_load_dwordx4 v8, s[12:15], s34 offen offset:0 lds
  s_add_u32 s34, s34, s35
  s_add_u32 m0, s40, 49152
  s_nop 0
  buffer_load_dwordx4 v4, s[8:11], s32 offen offset:0 sc1 lds
  s_add_u32 s32, s32, s33
  s_add_u32 m0, s41, 49152
  s_nop 0
  buffer_load_dwordx4 v8, s[12:15], s34 offen offset:0 lds
  s_add_u32 s34, s34, s35
  s_add_u32 m0, s40, 57344
  s_nop 0
  buffer_load_dwordx4 v4, s[8:11], s32 offen offset:0 sc1 lds
  s_add_u32 s32, s32, s33
  s_add_u32 m0, s41, 57344
  s_nop 0
  buffer_load_dwordx4 v8, s[12:15], s34 offen offset:0 lds
  s_add_u32 s34, s34, s35
  v_mov_b32 v64, 0
  v_mov_b32 v65, 0
  v_mov_b32 v66, 0
  v_mov_b32 v67, 0
  v_mov_b32 v68, 0
  v_mov_b32 v69, 0
  v_mov_b32 v70, 0
  v_mov_b32 v71, 0
  s_waitcnt vmcnt(14)
  s_barrier
  ds_read_b64_tr_b16 a[8:9], v14 offset:0
  ds_read_b64_tr_b16 a[10:11], v14 offset:2048
  ds_read_b64_tr_b16 a[12:13], v15 offset:0
  ds_read_b64_tr_b16 a[14:15], v15 offset:2048
  ds_read_b128 a[0:3], v12 offset:0
  s_waitcnt lgkmcnt(0)
L_loop_q64_fm_kq:
  s_waitcnt lgkmcnt(0)
  v_mfma_f32_16x16x32_bf16 v[64:67], a[8:11], a[0:3], v[64:67]
  ds_read_b64_tr_b16 a[16:17], v14 offset:4096
  ds_read_b64_tr_b16 a[18:19], v14 offset:6144
  ds_read_b64_tr_b16 a[20:21], v15 offset:4096
  ds_read_b64_tr_b16 a[22:23], v15 offset:6144
  ds_read_b128 a[4:7], v12 offset:1024
  v_mfma_f32_16x16x32_bf16 v[68:71], a[12:15], a[0:3], v[68:71]
  s_waitcnt lgkmcnt(0)
  v_mfma_f32_16x16x32_bf16 v[64:67], a[16:19], a[4:7], v[64:67]
  s_waitcnt lgkmcnt(0)
  s_waitcnt vmcnt(12)
  s_barrier
  ds_read_b64_tr_b16 a[8:9], v14 offset:8192
  ds_read_b64_tr_b16 a[10:11], v14 offset:10240
  ds_read_b64_tr_b16 a[12:13], v15 offset:8192
  ds_read_b64_tr_b16 a[14:15], v15 offset:10240
  ds_read_b128 a[0:3], v12 offset:8192
  v_mfma_f32_16x16x32_bf16 v[68:71], a[20:23], a[4:7], v[68:71]
  s_add_u32 m0, s40, 0
  s_nop 0
  buffer_load_dwordx4 v4, s[8:11], s32 offen offset:0 sc1 lds
  s_add_u32 s32, s32, s33
  s_add_u32 m0, s41, 0
  s_nop 0
  buffer_load_dwordx4 v8, s[12:15], s34 offen offset:0 lds
  s_add_u32 s34, s34, s35
  s_waitcnt lgkmcnt(0)
  v_mfma_f32_16x16x32_bf16 v[64:67], a[8:11], a[0:3], v[64:67]
  ds_read_b64_tr_b16 a[16:17], v14 offset:12288
  ds_read_b64_tr_b16 a[18:19], v14 offset:14336
  ds_read_b64_tr_b16 a[20:21], v15 offset:12288
  ds_read_b64_tr_b16 a[22:23], v15 offset:14336
  ds_read_b128 a[4:7], v12 offset:9216
  v_mfma_f32_16x16x32_bf16 v[68:71], a[12:15], a[0:3], v[68:71]
  s_waitcnt lgkmcnt(0)
  v_mfma_f32_16x16x32_bf16 v[64:67], a[16:19], a[4:7], v[64:67]
  s_waitcnt lgkmcnt(0)
  s_waitcnt vmcnt(12)
  s_barrier
  ds_read_b64_tr_b16 a[8:9], v14 offset:16384
  ds_read_b64_tr_b16 a[10:11], v14 offset:18432
  ds_read_b64_tr_b16 a[12:13], v15 offset:16384
  ds_read_b64_tr_b16 a[14:15], v15 offset:18432
  ds_read_b128 a[0:3], v12 offset:16384
  v_mfma_f32_16x16x32_bf16 v[68:71], a[20:23], a[4:7], v[68:71]
  s_add_u32 m0, s40, 8192
  s_nop 0
  buffer_load_dwordx4 v4, s[8:11], s32 offen offset:0 sc1 lds
  s_add_u32 s32, s32, s33
  s_add_u32 m0, s41, 8192
  s_nop 0
  buffer_load_dwordx4 v8, s[12:15], s34 offen offset:0 lds
  s_add_u32 s34, s34, s35
  s_waitcnt lgkmcnt(0)
  v_mfma_f32_16x16x32_bf16 v[64:67], a[8:11], a[0:3], v[64:67]
  ds_read_b64_tr_b16 a[16:17], v14 offset:20480
  ds_read_b64_tr_b16 a[18:19], v14 offset:22528
  ds_read_b64_tr_b16 a[20:21], v15 offset:20480
  ds_read_b64_tr_b16 a[22:23], v15 offset:22528
  ds_read_b128 a[4:7], v12 offset:17408
  v_mfma_f32_16x16x32_bf16 v[68:71], a[12:15], a[0:3], v[68:71]
  s_waitcnt lgkmcnt(0)
  v_mfma_f32_16x16x32_bf16 v[64:67], a[16:19], a[4:7], v[64:67]
  s_waitcnt lgkmcnt(0)
  s_waitcnt vmcnt(12)
  s_barrier
  ds_read_b64_tr_b16 a[8:9], v14 offset:24576
  ds_read_b64_tr_b16 a[10:11], v14 offset:26624
  ds_read_b64_tr_b16 a[12:13], v15 offset:24576
  ds_read_b64_tr_b16 a[14:15], v15 offset:26624
  ds_read_b128 a[0:3], v12 offset:24576
  v_mfma_f32_16x16x32_bf16 v[68:71], a[20:23], a[4:7], v[68:71]
  s_add_u32 m0, s40, 16384
  s_nop 0
  buffer_load_dwordx4 v4, s[8:11], s32 offen offset:0 sc1 lds
  s_add_u32 s32, s32, s33
  s_add_u32 m0, s41, 16384
  s_nop 0
  buffer_load_dwordx4 v8, s[12:15], s34 offen offset:0 lds
  s_add_u32 s34, s34, s35
  s_waitcnt lgkmcnt(0)
  v_mfma_f32_16x16x32_bf16 v[64:67], a[8:11], a[0:3], v[64:67]
  ds_read_b64_tr_b16 a[16:17], v14 offset:28672
  ds_read_b64_tr_b16 a[18:19], v14 offset:30720
  ds_read_b64_tr_b16 a[20:21], v15 offset:28672
  ds_read_b64_tr_b16 a[22:23], v15 offset:30720
  ds_read_b128 a[4:7], v12 offset:25600
  v_mfma_f32_16x16x32_bf16 v[68:71], a[12:15], a[0:3], v[68:71]
  s_waitcnt lgkmcnt(0)
  v_mfma_f32_16x16x32_bf16 v[64:67], a[16:19], a[4:7], v[64:67]
  s_waitcnt lgkmcnt(0)
  s_waitcnt vmcnt(12)
  s_barrier
  ds_read_b64_tr_b16 a[8:9], v14 offset:32768
  ds_read_b64_tr_b16 a[10:11], v14 offset:34816
  ds_read_b64_tr_b16 a[12:13], v15 offset:32768
  ds_read_b64_tr_b16 a[14:15], v15 offset:34816
  ds_read_b128 a[0:3], v12 offset:32768
  v_mfma_f32_16x16x32_bf16 v[68:71], a[20:23], a[4:7], v[68:71]
  s_add_u32 m0, s40, 24576
  s_nop 0
  buffer_load_dwordx4 v4, s[8:11], s32 offen offset:0 sc1 lds
  s_add_u32 s32, s32, s33
  s_add_u32 m0, s41, 24576
  s_nop 0
  buffer_load_dwordx4 v8, s[12:15], s34 offen offset:0 lds
  s_add_u32 s34, s34, s35
  s_waitcnt lgkmcnt(0)
  v_mfma_f32_16x16x32_bf16 v[64:67], a[8:11], a[0:3], v[64:67]
  ds_read_b64_tr_b16 a[16:17], v14 offset:36864
  ds_read_b64_tr_b16 a[18:19], v14 offset:38912
  ds_read_b64_tr_b16 a[20:21], v15 offset:36864
  ds_read_b64_tr_b16 a[22:23], v15 offset:38912
  ds_read_b128 a[4:7], v12 offset:33792
  v_mfma_f32_16x16x32_bf16 v[68:71], a[12:15], a[0:3], v[68:71]
  s_waitcnt lgkmcnt(0)
  v_mfma_f32_16x16x32_bf16 v[64:67], a[16:19], a[4:7], v[64:67]
  s_waitcnt lgkmcnt(0)
  s_waitcnt vmcnt(12)
  s_barrier
  ds_read_b64_tr_b16 a[8:9], v14 offset:40960
  ds_read_b64_tr_b16 a[10:11], v14 offset:43008
  ds_read_b64_tr_b16 a[12:13], v15 offset:40960
  ds_read_b64_tr_b16 a[14:15], v15 offset:43008
  ds_read_b128 a[0:3], v12 offset:40960
  v_mfma_f32_16x16x32_bf16 v[68:71], a[20:23], a[4:7], v[68:71]
  s_add_u32 m0, s40, 32768
  s_nop 0
  buffer_load_dwordx4 v4, s[8:11], s32 offen offset:0 sc1 lds
  s_add_u32 s32, s32, s33
  s_add_u32 m0, s41, 32768
  s_nop 0
  buffer_load_dwordx4 v8, s[12:15], s34 offen offset:0 lds
  s_add_u32 s34, s34, s35
  s_waitcnt lgkmcnt(0)
  v_mfma_f32_16x16x32_bf16 v[64:67], a[8:11], a[0:3], v[64:67]
  ds_read_b64_tr_b16 a[16:17], v14 offset:45056
  ds_read_b64_tr_b16 a[18:19], v14 offset:47104
  ds_read_b64_tr_b16 a[20:21], v15 offset:45056
  ds_read_b64_tr_b16 a[22:23], v15 offset:47104
  ds_read_b128 a[4:7], v12 offset:41984
  v_mfma_f32_16x16x32_bf16 v[68:71], a[12:15], a[0:3], v[68:71]
  s_waitcnt lgkmcnt(0)
  v_mfma_f32_16x16x32_bf16 v[64:67], a[16:19], a[4:7], v[64:67]
  s_waitcnt lgkmcnt(0)
  s_waitcnt vmcnt(12)
  s_barrier
  ds_read_b64_tr_b16 a[8:9], v14 offset:49152
  ds_read_b64_tr_b16 a[10:11], v14 offset:51200
  ds_read_b64_tr_b16 a[12:13], v15 offset:49152
  ds_read_b64_tr_b16 a[14:15], v15 offset:51200
  ds_read_b128 a[0:3], v12 offset:49152
  v_mfma_f32_16x16x32_bf16 v[68:71], a[20:23], a[4:7], v[68:71]
  s_add_u32 m0, s40, 40960
  s_nop 0
  buffer_load_dwordx4 v4, s[8:11], s32 offen offset:0 sc1 lds
  s_add_u32 s32, s32, s33
  s_add_u32 m0, s41, 40960
  s_nop 0
  buffer_load_dwordx4 v8, s[12:15], s34 offen offset:0 lds
  s_add_u32 s34, s34, s35
  s_waitcnt lgkmcnt(0)
  v_mfma_f32_16x16x32_bf16 v[64:67], a[8:11], a[0:3], v[64:67]
  ds_read_b64_tr_b16 a[16:17], v14 offset:53248
  ds_read_b64_tr_b16 a[18:19], v14 offset:55296
  ds_read_b64_tr_b16 a[20:21], v15 offset:53248
  ds_read_b64_tr_b16 a[22:23], v15 offset:55296
  ds_read_b128 a[4:7], v12 offset:50176
  v_mfma_f32_16x16x32_bf16 v[68:71], a[12:15], a[0:3], v[68:71]
  s_waitcnt lgkmcnt(0)
  v_mfma_f32_16x16x32_bf16 v[64:67], a[16:19], a[4:7], v[64:67]
  s_waitcnt lgkmcnt(0)
  s_waitcnt vmcnt(12)
  s_barrier
  ds_read_b64_tr_b16 a[8:9], v14 offset:57344
  ds_read_b64_tr_b16 a[10:11], v14 offset:59392
  ds_read_b64_tr_b16 a[12:13], v15 offset:57344
  ds_read_b64_tr_b16 a[14:15], v15 offset:59392
  ds_read_b128 a[0:3], v12 offset:57344
  v_mfma_f32_16x16x32_bf16 v[68:71], a[20:23], a[4:7], v[68:71]
  s_add_u32 m0, s40, 49152
  s_nop 0
  buffer_load_dwordx4 v4, s[8:11], s32 offen offset:0 sc1 lds
  s_add_u32 s32, s32, s33
  s_add_u32 m0, s41, 49152
  s_nop 0
  buffer_load_dwordx4 v8, s[12:15], s34 offen offset:0 lds
  s_add_u32 s34, s34, s35
  s_waitcnt lgkmcnt(0)
  v_mfma_f32_16x16x32_bf16 v[64:67], a[8:11], a[0:3], v[64:67]
  ds_read_b64_tr_b16 a[16:17], v14 offset:61440
  ds_read_b64_tr_b16 a[18:19], v14 offset:63488
  ds_read_b64_tr_b16 a[20:21], v15 offset:61440
  ds_read_b64_tr_b16 a[22:23], v15 offset:63488
  ds_read_b128 a[4:7], v12 offset:58368
  v_mfma_f32_16x16x32_bf16 v[68:71], a[12:15], a[0:3], v[68:71]
  s_waitcnt lgkmcnt(0)
  v_mfma_f32_16x16x32_bf16 v[64:67], a[16:19], a[4:7], v[64:67]
  s_waitcnt lgkmcnt(0)
  s_waitcnt vmcnt(12)
  s_barrier
  ds_read_b64_tr_b16 a[8:9], v14 offset:0
  ds_read_b64_tr_b16 a[10:11], v14 offset:2048
  ds_read_b64_tr_b16 a[12:13], v15 offset:0
  ds_read_b64_tr_b16 a[14:15], v15 offset:2048
  ds_read_b128 a[0:3], v12 offset:0
  v_mfma_f32_16x16x32_bf16 v[68:71], a[20:23], a[4:7], v[68:71]
  s_add_u32 m0, s40, 57344
  s_nop 0
  buffer_load_dwordx4 v4, s[8:11], s32 offen offset:0 sc1 lds
  s_add_u32 s32, s32, s33
  s_add_u32 m0, s41, 57344
  s_nop 0
  buffer_load_dwordx4 v8, s[12:15], s34 offen offset:0 lds
  s_add_u32 s34, s34, s35
  s_sub_u32 s36, s36, 1
  s_cmp_lg_u32 s36, 0
  s_cbranch_scc1 L_loop_q64_fm_kq
  s_waitcnt lgkmcnt(0)
  v_mfma_f32_16x16x32_bf16 v[64:67], a[8:11], a[0:3], v[64:67]
  ds_read_b64_tr_b16 a[16:17], v14 offset:4096
  ds_read_b64_tr_b16 a[18:19], v14 offset:6144
  ds_read_b64_tr_b16 a[20:21], v15 offset:4096
  ds_read_b64_tr_b16 a[22:23], v15 offset:6144
  ds_read_b128 a[4:7], v12 offset:1024
  v_mfma_f32_16x16x32_bf16 v[68:71], a[12:15], a[0:3], v[68:71]
  s_waitcnt lgkmcnt(0)
  v_mfma_f32_16x16x32_bf16 v[64:67], a[16:19], a[4:7], v[64:67]
  s_waitcnt lgkmcnt(0)
  s_waitcnt vmcnt(12)
  s_barrier
  ds_read_b64_tr_b16 a[8:9], v14 offset:8192
  ds_read_b64_tr_b16 a[10:11], v14 offset:10240
  ds_read_b64_tr_b16 a[12:13], v15 offset:8192
  ds_read_b64_tr_b16 a[14:15], v15 offset:10240
  ds_read_b128 a[0:3], v12 offset:8192
  v_mfma_f32_16x16x32_bf16 v[68:71], a[20:23], a[4:7], v[68:71]
  s_waitcnt lgkmcnt(0)
  v_mfma_f32_16x16x32_bf16 v[64:67], a[8:11], a[0:3], v[64:67]
  ds_read_b64_tr_b16 a[16:17], v14 offset:12288
  ds_read_b64_tr_b16 a[18:19], v14 offset:14336
  ds_read_b64_tr_b16 a[20:21], v15 offset:12288
  ds_read_b64_tr_b16 a[22:23], v15 offset:14336
  ds_read_b128 a[4:7], v12 offset:9216
  v_mfma_f32_16x16x32_bf16 v[68:71], a[12:15], a[0:3], v[68:71]
  s_waitcnt lgkmcnt(0)
  v_mfma_f32_16x16x32_bf16 v[64:67], a[16:19], a[4:7], v[64:67]
  s_waitcnt lgkmcnt(0)
  s_waitcnt vmcnt(10)
  s_barrier
  ds_read_b64_tr_b16 a[8:9], v14 offset:16384
  ds_read_b64_tr_b16 a[10:11], v14 offset:18432
  ds_read_b64_tr_b16 a[12:13], v15 offset:16384
  ds_read_b64_tr_b16 a[14:15], v15 offset:18432
  ds_read_b128 a[0:3], v12 offset:16384
  v_mfma_f32_16x16x32_bf16 v[68:71], a[20:23], a[4:7], v[68:71]
  s_waitcnt lgkmcnt(0)
  v_mfma_f32_16x16x32_bf16 v[64:67], a[8:11], a[0:3], v[64:67]
  ds_read_b64_tr_b16 a[16:17], v14 offset:20480
  ds_read_b64_tr_b16 a[18:19], v14 offset:22528
  ds_read_b64_tr_b16 a[20:21], v15 offset:20480
  ds_read_b64_tr_b16 a[22:23], v15 offset:22528
  ds_read_b128 a[4:7], v12 offset:17408
  v_mfma_f32_16x16x32_bf16 v[68:71], a[12:15], a[0:3], v[68:71]
  s_waitcnt lgkmcnt(0)
  v_mfma_f32_16x16x32_bf16 v[64:67], a[16:19], a[4:7], v[64:67]
  s_waitcnt lgkmcnt(0)
  s_waitcnt vmcnt(8)
  s_barrier
  ds_read_b64_tr_b16 a[8:9], v14 offset:24576
  ds_read_b64_tr_b16 a[10:11], v14 offset:26624
  ds_read_b64_tr_b16 a[12:13], v15 offset:24576
  ds_read_b64_tr_b16 a[14:15], v15 offset:26624
  ds_read_b128 a[0:3], v12 offset:24576
  v_mfma_f32_16x16x32_bf16 v[68:71], a[20:23], a[4:7], v[68:71]
  s_waitcnt lgkmcnt(0)
  v_mfma_f32_16x16x32_bf16 v[64:67], a[8:11], a[0:3], v[64:67]
  ds_read_b64_tr_b16 a[16:17], v14 offset:28672
  ds_read_b64_tr_b16 a[18:19], v14 offset:30720
  ds_read_b64_tr_b16 a[20:21], v15 offset:28672
  ds_read_b64_tr_b16 a[22:23], v15 offset:30720
  ds_read_b128 a[4:7], v12 offset:25600
  v_mfma_f32_16x16x32_bf16 v[68:71], a[12:15], a[0:3], v[68:71]
  s_waitcnt lgkmcnt(0)
  v_mfma_f32_16x16x32_bf16 v[64:67], a[16:19], a[4:7], v[64:67]
  s_waitcnt lgkmcnt(0)
  s_waitcnt vmcnt(6)
  s_barrier
  ds_read_b64_tr_b16 a[8:9], v14 offset:32768
  ds_read_b64_tr_b16 a[10:11], v14 offset:34816
  ds_read_b64_tr_b16 a[12:13], v15 offset:32768
  ds_read_b64_tr_b16 a[14:15], v15 offset:34816
  ds_read_b128 a[0:3], v12 offset:32768
  v_mfma_f32_16x16x32_bf16 v[68:71], a[20:23], a[4:7], v[68:71]
  s_waitcnt lgkmcnt(0)
  v_mfma_f32_16x16x32_bf16 v[64:67], a[8:11], a[0:3], v[64:67]
  ds_read_b64_tr_b16 a[16:17], v14 offset:36864
  ds_read_b64_tr_b16 a[18:19], v14 offset:38912
  ds_read_b64_tr_b16 a[20:21], v15 offset:36864
  ds_read_b64_tr_b16 a[22:23], v15 offset:38912
  ds_read_b128 a[4:7], v12 offset:33792
  v_mfma_f32_16x16x32_bf16 v[68:71], a[12:15], a[0:3], v[68:71]
  s_waitcnt lgkmcnt(0)
  v_mfma_f32_16x16x32_bf16 v[64:67], a[16:19], a[4:7], v[64:67]
  s_waitcnt lgkmcnt(0)
  s_waitcnt vmcnt(4)
  s_barrier
  ds_read_b64_tr_b16 a[8:9], v14 offset:40960
  ds_read_b64_tr_b16 a[10:11], v14 offset:43008
  ds_read_b64_tr_b16 a[12:13], v15 offset:40960
  ds_read_b64_tr_b16 a[14:15], v15 offset:43008
  ds_read_b128 a[0:3], v12 offset:40960
  v_mfma_f32_16x16x32_bf16 v[68:71], a[20:23], a[4:7], v[68:71]
  s_waitcnt lgkmcnt(0)
  v_mfma_f32_16x16x32_bf16 v[64:67], a[8:11], a[0:3], v[64:67]
  ds_read_b64_tr_b16 a[16:17], v14 offset:45056
  ds_read_b64_tr_b16 a[18:19], v14 offset:47104
  ds_read_b64_tr_b16 a[20:21], v15 offset:45056
  ds_read_b64_tr_b16 a[22:23], v15 offset:47104
  ds_read_b128 a[4:7], v12 offset:41984
  v_mfma_f32_16x16x32_bf16 v[68:71], a[12:15], a[0:3], v[68:71]
  s_waitcnt lgkmcnt(0)
  v_mfma_f32_16x16x32_bf16 v[64:67], a[16:19], a[4:7], v[64:67]
  s_waitcnt lgkmcnt(0)
  s_waitcnt vmcnt(2)
  s_barrier
  ds_read_b64_tr_b16 a[8:9], v14 offset:49152
  ds_read_b64_tr_b16 a[10:11], v14 offset:51200
  ds_read_b64_tr_b16 a[12:13], v15 offset:49152
  ds_read_b64_tr_b16 a[14:15], v15 offset:51200
  ds_read_b128 a[0:3], v12 offset:49152
  v_mfma_f32_16x16x32_bf16 v[68:71], a[20:23], a[4:7], v[68:71]
  s_waitcnt lgkmcnt(0)
  v_mfma_f32_16x16x32_bf16 v[64:67], a[8:11], a[0:3], v[64:67]
  ds_read_b64_tr_b16 a[16:17], v14 offset:53248
  ds_read_b64_tr_b16 a[18:19], v14 offset:55296
  ds_read_b64_tr_b16 a[20:21], v15 offset:53248
  ds_read_b64_tr_b16 a[22:23], v15 offset:55296
  ds_read_b128 a[4:7], v12 offset:50176
  v_mfma_f32_16x16x32_bf16 v[68:71], a[12:15], a[0:3], v[68:71]
  s_waitcnt lgkmcnt(0)
  v_mfma_f32_16x16x32_bf16 v[64:67], a[16:19], a[4:7], v[64:67]
  s_waitcnt lgkmcnt(0)
  s_waitcnt vmcnt(0)
  s_barrier
  ds_read_b64_tr_b16 a[8:9], v14 offset:57344
  ds_read_b64_tr_b16 a[10:11], v14 offset:59392
  ds_read_b64_tr_b16 a[12:13], v15 offset:57344
  ds_read_b64_tr_b16 a[14:15], v15 offset:59392
  ds_read_b128 a[0:3], v12 offset:57344
  v_mfma_f32_16x16x32_bf16 v[68:71], a[20:23], a[4:7], v[68:71]
  s_waitcnt lgkmcnt(0)
  v_mfma_f32_16x16x32_bf16 v[64:67], a[8:11], a[0:3], v[64:67]
  ds_read_b64_tr_b16 a[16:17], v14 offset:61440
  ds_read_b64_tr_b16 a[18:19], v14 offset:63488
  ds_read_b64_tr_b16 a[20:21], v15 offset:61440
  ds_read_b64_tr_b16 a[22:23], v15 offset:63488
  ds_read_b128 a[4:7], v12 offset:58368
  v_mfma_f32_16x16x32_bf16 v[68:71], a[12:15], a[0:3], v[68:71]
  s_waitcnt lgkmcnt(0)
  v_mfma_f32_16x16x32_bf16 v[64:67], a[16:19], a[4:7], v[64:67]
  v_mfma_f32_16x16x32_bf16 v[68:71], a[20:23], a[4:7], v[68:71]
L_episel_52:
  s_nop 7
L_epi_final_51:
  s_cmp_lg_u32 s28, 0
  s_cbranch_scc1 L_latew_53
  s_mov_b32 s42, s78
  s_cmp_eq_u32 s42, 0
  s_cbranch_scc1 L_latew_53
  v_mov_b32 v2, 0
  v_writelane_b32 v2, s78, 0
  v_lshrrev_b32 v3, 24, v2
  v_lshlrev_b32 v3, 7, v3
  v_and_b32 v2, 0xffffff, v2
  s_mov_b32 s83, 0
  s_add_u32 s42, s59, 0x5c14000
L_poll_54:
  buffer_load_dword v20, v3, s[4:7], s42 offen sc1
  s_waitcnt vmcnt(0)
  v_cmp_lt_u32 vcc, v20, v2
  s_cbranch_vccz L_latew_53
  s_sleep 4
  s_add_u32 s83, s83, 1
  s_cmp_lt_u32 s83, 1048576
  s_cbranch_scc1 L_poll_54
  s_branch L_abort
L_latew_53:
  s_barrier
  s_lshr_b32 s42, s28, 1
  s_and_b32 s43, s28, 1
  s_mul_i32 s44, s42, 16
  s_add_u32 s48, s48, s44
  s_mul_i32 s44, s43, 32
  s_add_u32 s49, s49, s44
  s_lshl_b32 s44, s48, 11
  s_lshl_b32 s45, s49, 5
  s_add_u32 s37, s44, s45
  s_add_u32 s37, s37, 0x5000000
  s_lshl_b32 s44, s48, 2
  s_add_u32 s44, s44, 0x5c00000
  v_and_b32 v2, 15, v1
  v_lshlrev_b32 v3, 2, v2
  buffer_load_dword v4, v3, s[4:7], s44 offen offset:0 sc1
  buffer_load_dwordx4 v[20:23], v18, s[4:7], s37 offen offset:0 sc1
  s_add_u32 s37, s37, 32768
  v_lshlrev_b32 v12, 11, v2
  v_bfe_u32 v3, v1, 4, 1
  v_lshl_add_u32 v12, v3, 5, v12
  v_lshrrev_b32 v3, 5, v1
  v_lshl_add_u32 v12, v3, 4, v12
  s_lshl_b32 s44, s48, 11
  s_lshl_b32 s45, s49, 1
  s_add_u32 s44, s44, s45
  s_waitcnt vmcnt(0)
  v_sub_f32 v14, 1.0, v4
  v_mov_b32 v16, v4
  v_lshlrev_b32 v52, 16, v20
  v_and_b32 v53, 0xffff0000, v20
  v_pk_mul_f32 v[64:65], v[64:65], v[16:17] op_sel_hi:[1,0]
  v_pk_fma_f32 v[64:65], v[52:53], v[14:15], v[64:65] op_sel_hi:[1,0,1]
  v_cvt_pk_bf16_f32 v56, v64, v65
  v_lshlrev_b32 v54, 16, v21
  v_and_b32 v55, 0xffff0000, v21
  v_pk_mul_f32 v[66:67], v[66:67], v[16:17] op_sel_hi:[1,0]
  v_pk_fma_f32 v[66:67], v[54:55], v[14:15], v[66:67] op_sel_hi:[1,0,1]
  v_cvt_pk_bf16_f32 v57, v66, v67
  v_lshlrev_b32 v52, 16, v22
  v_and_b32 v53, 0xffff0000, v22
  v_pk_mul_f32 v[68:69], v[68:69], v[16:17] op_sel_hi:[1,0]
  v_pk_fma_f32 v[68:69], v[52:53], v[14:15], v[68:69] op_sel_hi:[1,0,1]
  v_cvt_pk_bf16_f32 v58, v68, v69
  v_lshlrev_b32 v54, 16, v23
  v_and_b32 v55, 0xffff0000, v23
  v_pk_mul_f32 v[70:71], v[70:71], v[16:17] op_sel_hi:[1,0]
  v_pk_fma_f32 v[70:71], v[54:55], v[14:15], v[70:71] op_sel_hi:[1,0,1]
  v_cvt_pk_bf16_f32 v59, v70, v71
  s_nop 1
  v_permlane16_swap_b32 v56, v58
  v_permlane16_swap_b32 v57, v59
  buffer_store_dwordx4 v[56:59], v12, s[16:19], s44 offen offset:0
  s_nop 0
  s_add_u32 s44, s44, 32768
  s_branch L_done
L_body_half_fm_kq:
  s_lshr_b32 s42, s28, 1
  s_and_b32 s43, s28, 1
  s_mul_i32 s40, s28, 2048
  s_mul_i32 s41, s28, 1024
  s_add_u32 s41, s41, 65536
  v_lshlrev_b32 v18, 4, v1
  s_mul_i32 s44, s42, 4096
  v_lshrrev_b32 v22, 4, v1
  v_and_b32 v23, 15, v1
  v_add_u32 v12, s44, v18
  s_mul_i32 s44, s28, 2
  s_add_u32 s44, s44, 0
  s_mul_i32 s44, s44, s45
  v_add_u32 v4, s44, v18
  s_mul_i32 s44, s28, 2
  s_add_u32 s44, s44, 1
  s_mul_i32 s44, s44, s45
  s_sub_u32 s44, s44, 1024
  v_add_u32 v5, s44, v18
  v_lshrrev_b32 v23, 4, v1
  v_and_b32 v24, 15, v1
  s_mul_i32 s44, s28, 4
  s_add_u32 s44, s44, 0
  v_add_u32 v20, s44, v23
  v_and_b32 v21, 7, v20
  v_lshlrev_b32 v21, 1, v21
  v_xor_b32 v21, v21, v24
  v_mul_lo_u32 v20, v20, s39
  v_lshl_add_u32 v8, v21, 4, v20
  v_bfe_u32 v20, v1, 2, 2
  v_lshrrev_b32 v21, 4, v1
  v_lshl_add_u32 v22, v21, 2, v20
  v_mul_u32_u24 v22, 256, v22
  v_and_b32 v23, 3, v1
  v_lshl_add_u32 v22, v23, 3, v22
  v_add_u32 v22, 65536, v22
  v_and_b32 v21, 1, v21
  v_lshl_or_b32 v20, v21, 2, v20
  s_mul_i32 s44, s43, 4
  s_add_u32 s44, s44, 0
  v_xor_b32 v21, s44, v20
  v_lshl_add_u32 v14, v21, 5, v22
  s_mul_i32 s44, s43, 4
  s_add_u32 s44, s44, 1
  v_xor_b32 v21, s44, v20
  v_lshl_add_u32 v15, v21, 5, v22
  s_mul_i32 s44, s43, 4
  s_add_u32 s44, s44, 2
  v_xor_b32 v21, s44, v20
  v_lshl_add_u32 v16, v21, 5, v22
  s_mul_i32 s44, s43, 4
  s_add_u32 s44, s44, 3
  v_xor_b32 v21, s44, v20
  v_lshl_add_u32 v17, v21, 5, v22
  s_add_u32 m0, s40, 0
  s_nop 0
  buffer_load_dwordx4 v4, s[8:11], s32 offen offset:0 sc1 lds
  buffer_load_dwordx4 v5, s[8:11], s32 offen offset:1024 sc1 lds
  s_add_u32 s32, s32, s33
  s_add_u32 m0, s41, 0
  s_nop 0
  buffer_load_dwordx4 v8, s[12:15], s34 offen offset:0 lds
  s_add_u32 s34, s34, s35
  s_add_u32 m0, s40, 16384
  s_nop 0
  buffer_load_dwordx4 v4, s[8:11], s32 offen offset:0 sc1 lds
  buffer_load_dwordx4 v5, s[8:11], s32 offen offset:1024 sc1 lds
  s_add_u32 s32, s32, s33
  s_add_u32 m0, s41, 8192
  s_nop 0
  buffer_load_dwordx4 v8, s[12:15], s34 offen offset:0 lds
  s_add_u32 s34, s34, s35
  s_add_u32 m0, s40, 32768
  s_nop 0
  buffer_load_dwordx4 v4, s[8:11], s32 offen offset:0 sc1 lds
  buffer_load_dwordx4 v5, s[8:11], s32 offen offset:1024 sc1 lds
  s_add_u32 s32, s32, s33
  s_add_u32 m0, s41, 16384
  s_nop 0
  buffer_load_dwordx4 v8, s[12:15], s34 offen offset:0 lds
  s_add_u32 s34, s34, s35
  s_add_u32 m0, s40, 49152
  s_nop 0
  buffer_load_dwordx4 v4, s[8:11], s32 offen offset:0 sc1 lds
  buffer_load_dwordx4 v5, s[8:11], s32 offen offset:1024 sc1 lds
  s_add_u32 s32, s32, s33
  s_add_u32 m0, s41, 24576
  s_nop 0
  buffer_load_dwordx4 v8, s[12:15], s34 offen offset:0 lds
  s_add_u32 s34, s34, s35
  v_mov_b32 v64, 0
  v_mov_b32 v65, 0
  v_mov_b32 v66, 0
  v_mov_b32 v67, 0
  v_mov_b32 v68, 0
  v_mov_b32 v69, 0
  v_mov_b32 v70, 0
  v_mov_b32 v71, 0
  v_mov_b32 v72, 0
  v_mov_b32 v73, 0
  v_mov_b32 v74, 0
  v_mov_b32 v75, 0
  v_mov_b32 v76, 0
  v_mov_b32 v77, 0
  v_mov_b32 v78, 0
  v_mov_b32 v79, 0
  v_mov_b32 v80, 0
  v_mov_b32 v81, 0
  v_mov_b32 v82, 0
  v_mov_b32 v83, 0
  v_mov_b32 v84, 0
  v_mov_b32 v85, 0
  v_mov_b32 v86, 0
  v_mov_b32 v87, 0
  v_mov_b32 v88, 0
  v_mov_b32 v89, 0
  v_mov_b32 v90, 0
  v_mov_b32 v91, 0
  v_mov_b32 v92, 0
  v_mov_b32 v93, 0
  v_mov_b32 v94, 0
  v_mov_b32 v95, 0
  v_mov_b32 v96, 0
  v_mov_b32 v97, 0
  v_mov_b32 v98, 0
  v_mov_b32 v99, 0
  v_mov_b32 v100, 0
  v_mov_b32 v101, 0
  v_mov_b32 v102, 0
  v_mov_b32 v103, 0
  v_mov_b32 v104, 0
  v_mov_b32 v105, 0
  v_mov_b32 v106, 0
  v_mov_b32 v107, 0
  v_mov_b32 v108, 0
  v_mov_b32 v109, 0
  v_mov_b32 v110, 0
  v_mov_b32 v111, 0
  v_mov_b32 v112, 0
  v_mov_b32 v113, 0
  v_mov_b32 v114, 0
  v_mov_b32 v115, 0
  v_mov_b32 v116, 0
  v_mov_b32 v117, 0
  v_mov_b32 v118, 0
  v_mov_b32 v119, 0
  v_mov_b32 v120, 0
  v_mov_b32 v121, 0
  v_mov_b32 v122, 0
  v_mov_b32 v123, 0
  v_mov_b32 v124, 0
  v_mov_b32 v125, 0
  v_mov_b32 v126, 0
  v_mov_b32 v127, 0
  s_waitcnt vmcnt(9)
  s_barrier
  ds_read_b64_tr_b16 a[32:33], v14 offset:0
  ds_read_b64_tr_b16 a[34:35], v14 offset:4096
  ds_read_b64_tr_b16 a[36:37], v15 offset:0
  ds_read_b64_tr_b16 a[38:39], v15 offset:4096
  ds_read_b64_tr_b16 a[40:41], v16 offset:0
  ds_read_b64_tr_b16 a[42:43], v16 offset:4096
  ds_read_b64_tr_b16 a[44:45], v17 offset:0
  ds_read_b64_tr_b16 a[46:47], v17 offset:4096
  ds_read_b128 a[0:3], v12 offset:0
  ds_read_b128 a[4:7], v12 offset:1024
  ds_read_b128 a[8:11], v12 offset:2048
  ds_read_b128 a[12:15], v12 offset:3072
  s_waitcnt lgkmcnt(0)
L_loop_half_fm_kq:
  s_waitcnt lgkmcnt(3)
  v_mfma_f32_16x16x32_bf16 v[64:67], a[32:35], a[0:3], v[64:67]
  v_mfma_f32_16x16x32_bf16 v[68:71], a[36:39], a[0:3], v[68:71]
  v_mfma_f32_16x16x32_bf16 v[72:75], a[40:43], a[0:3], v[72:75]
  v_mfma_f32_16x16x32_bf16 v[76:79], a[44:47], a[0:3], v[76:79]
  s_waitcnt lgkmcnt(0)
  s_waitcnt vmcnt(6)
  s_barrier
  ds_read_b64_tr_b16 a[48:49], v14 offset:8192
  ds_read_b64_tr_b16 a[50:51], v14 offset:12288
  v_mfma_f32_16x16x32_bf16 v[80:83], a[32:35], a[4:7], v[80:83]
  ds_read_b64_tr_b16 a[52:53], v15 offset:8192
  ds_read_b64_tr_b16 a[54:55], v15 offset:12288
  v_mfma_f32_16x16x32_bf16 v[84:87], a[36:39], a[4:7], v[84:87]
  ds_read_b64_tr_b16 a[56:57], v16 offset:8192
  ds_read_b64_tr_b16 a[58:59], v16 offset:12288
  v_mfma_f32_16x16x32_bf16 v[88:91], a[40:43], a[4:7], v[88:91]
  ds_read_b64_tr_b16 a[60:61], v17 offset:8192
  ds_read_b64_tr_b16 a[62:63], v17 offset:12288
  v_mfma_f32_16x16x32_bf16 v[92:95], a[44:47], a[4:7], v[92:95]
  ds_read_b128 a[16:19], v12 offset:16384
  v_mfma_f32_16x16x32_bf16 v[96:99], a[32:35], a[8:11], v[96:99]
  ds_read_b128 a[20:23], v12 offset:17408
  v_mfma_f32_16x16x32_bf16 v[100:103], a[36:39], a[8:11], v[100:103]
  ds_read_b128 a[24:27], v12 offset:18432
  v_mfma_f32_16x16x32_bf16 v[104:107], a[40:43], a[8:11], v[104:107]
  ds_read_b128 a[28:31], v12 offset:19456
  v_mfma_f32_16x16x32_bf16 v[108:111], a[44:47], a[8:11], v[108:111]
  s_add_u32 m0, s40, 0
  v_mfma_f32_16x16x32_bf16 v[112:115], a[32:35], a[12:15], v[112:115]
  buffer_load_dwordx4 v4, s[8:11], s32 offen offset:0 sc1 lds
  v_mfma_f32_16x16x32_bf16 v[116:119], a[36:39], a[12:15], v[116:119]
  buffer_load_dwordx4 v5, s[8:11], s32 offen offset:1024 sc1 lds
  s_add_u32 s32, s32, s33
  v_mfma_f32_16x16x32_bf16 v[120:123], a[40:43], a[12:15], v[120:123]
  s_add_u32 m0, s41, 0
  s_nop 0
  buffer_load_dwordx4 v8, s[12:15], s34 offen offset:0 lds
  s_add_u32 s34, s34, s35
  v_mfma_f32_16x16x32_bf16 v[124:127], a[44:47], a[12:15], v[124:127]
  s_waitcnt lgkmcnt(3)
  v_mfma_f32_16x16x32_bf16 v[64:67], a[48:51], a[16:19], v[64:67]
  v_mfma_f32_16x16x32_bf16 v[68:71], a[52:55], a[16:19], v[68:71]
  v_mfma_f32_16x16x32_bf16 v[72:75], a[56:59], a[16:19], v[72:75]
  v_mfma_f32_16x16x32_bf16 v[76:79], a[60:63], a[16:19], v[76:79]
  s_waitcnt lgkmcnt(0)
  s_waitcnt vmcnt(6)
  s_barrier
  ds_read_b64_tr_b16 a[32:33], v14 offset:16384
  ds_read_b64_tr_b16 a[34:35], v14 offset:20480
  v_mfma_f32_16x16x32_bf16 v[80:83], a[48:51], a[20:23], v[80:83]
  ds_read_b64_tr_b16 a[36:37], v15 offset:16384
  ds_read_b64_tr_b16 a[38:39], v15 offset:20480
  v_mfma_f32_16x16x32_bf16 v[84:87], a[52:55], a[20:23], v[84:87]
  ds_read_b64_tr_b16 a[40:41], v16 offset:16384
  ds_read_b64_tr_b16 a[42:43], v16 offset:20480
  v_mfma_f32_16x16x32_bf16 v[88:91], a[56:59], a[20:23], v[88:91]
  ds_read_b64_tr_b16 a[44:45], v17 offset:16384
  ds_read_b64_tr_b16 a[46:47], v17 offset:20480
  v_mfma_f32_16x16x32_bf16 v[92:95], a[60:63], a[20:23], v[92:95]
  ds_read_b128 a[0:3], v12 offset:32768
  v_mfma_f32_16x16x32_bf16 v[96:99], a[48:51], a[24:27], v[96:99]
  ds_read_b128 a[4:7], v12 offset:33792
  v_mfma_f32_16x16x32_bf16 v[100:103], a[52:55], a[24:27], v[100:103]
  ds_read_b128 a[8:11], v12 offset:34816
  v_mfma_f32_16x16x32_bf16 v[104:107], a[56:59], a[24:27], v[104:107]
  ds_read_b128 a[12:15], v12 offset:35840
  v_mfma_f32_16x16x32_bf16 v[108:111], a[60:63], a[24:27], v[108:111]
  s_add_u32 m0, s40, 16384
  v_mfma_f32_16x16x32_bf16 v[112:115], a[48:51], a[28:31], v[112:115]
  buffer_load_dwordx4 v4, s[8:11], s32 offen offset:0 sc1 lds
  v_mfma_f32_16x16x32_bf16 v[116:119], a[52:55], a[28:31], v[116:119]
  buffer_load_dwordx4 v5, s[8:11], s32 offen offset:1024 sc1 lds
  s_add_u32 s32, s32, s33
  v_mfma_f32_16x16x32_bf16 v[120:123], a[56:59], a[28:31], v[120:123]
  s_add_u32 m0, s41, 8192
  s_nop 0
  buffer_load_dwordx4 v8, s[12:15], s34 offen offset:0 lds
  s_add_u32 s34, s34, s35
  v_mfma_f32_16x16x32_bf16 v[124:127], a[60:63], a[28:31], v[124:127]
  s_waitcnt lgkmcnt(3)
  v_mfma_f32_16x16x32_bf16 v[64:67], a[32:35], a[0:3], v[64:67]
  v_mfma_f32_16x16x32_bf16 v[68:71], a[36:39], a[0:3], v[68:71]
  v_mfma_f32_16x16x32_bf16 v[72:75], a[40:43], a[0:3], v[72:75]
  v_mfma_f32_16x16x32_bf16 v[76:79], a[44:47], a[0:3], v[76:79]
  s_waitcnt lgkmcnt(0)
  s_waitcnt vmcnt(6)
  s_barrier
  ds_read_b64_tr_b16 a[48:49], v14 offset:24576
  ds_read_b64_tr_b16 a[50:51], v14 offset:28672
  v_mfma_f32_16x16x32_bf16 v[80:83], a[32:35], a[4:7], v[80:83]
  ds_read_b64_tr_b16 a[52:53], v15 offset:24576
  ds_read_b64_tr_b16 a[54:55], v15 offset:28672
  v_mfma_f32_16x16x32_bf16 v[84:87], a[36:39], a[4:7], v[84:87]
  ds_read_b64_tr_b16 a[56:57], v16 offset:24576
  ds_read_b64_tr_b16 a[58:59], v16 offset:28672
  v_mfma_f32_16x16x32_bf16 v[88:91], a[40:43], a[4:7], v[88:91]
  ds_read_b64_tr_b16 a[60:61], v17 offset:24576
  ds_read_b64_tr_b16 a[62:63], v17 offset:28672
  v_mfma_f32_16x16x32_bf16 v[92:95], a[44:47], a[4:7], v[92:95]
  ds_read_b128 a[16:19], v12 offset:49152
  v_mfma_f32_16x16x32_bf16 v[96:99], a[32:35], a[8:11], v[96:99]
  ds_read_b128 a[20:23], v12 offset:50176
  v_mfma_f32_16x16x32_bf16 v[100:103], a[36:39], a[8:11], v[100:103]
  ds_read_b128 a[24:27], v12 offset:51200
  v_mfma_f32_16x16x32_bf16 v[104:107], a[40:43], a[8:11], v[104:107]
  ds_read_b128 a[28:31], v12 offset:52224
  v_mfma_f32_16x16x32_bf16 v[108:111], a[44:47], a[8:11], v[108:111]
  s_add_u32 m0, s40, 32768
  v_mfma_f32_16x16x32_bf16 v[112:115], a[32:35], a[12:15], v[112:115]
  buffer_load_dwordx4 v4, s[8:11], s32 offen offset:0 sc1 lds
  v_mfma_f32_16x16x32_bf16 v[116:119], a[36:39], a[12:15], v[116:119]
  buffer_load_dwordx4 v5, s[8:11], s32 offen offset:1024 sc1 lds
  s_add_u32 s32, s32, s33
  v_mfma_f32_16x16x32_bf16 v[120:123], a[40:43], a[12:15], v[120:123]
  s_add_u32 m0, s41, 16384
  s_nop 0
  buffer_load_dwordx4 v8, s[12:15], s34 offen offset:0 lds
  s_add_u32 s34, s34, s35
  v_mfma_f32_16x16x32_bf16 v[124:127], a[44:47], a[12:15], v[124:127]
  s_waitcnt lgkmcnt(3)
  v_mfma_f32_16x16x32_bf16 v[64:67], a[48:51], a[16:19], v[64:67]
  v_mfma_f32_16x16x32_bf16 v[68:71], a[52:55], a[16:19], v[68:71]
  v_mfma_f32_16x16x32_bf16 v[72:75], a[56:59], a[16:19], v[72:75]
  v_mfma_f32_16x16x32_bf16 v[76:79], a[60:63], a[16:19], v[76:79]
  s_waitcnt lgkmcnt(0)
  s_waitcnt vmcnt(6)
  s_barrier
  ds_read_b64_tr_b16 a[32:33], v14 offset:0
  ds_read_b64_tr_b16 a[34:35], v14 offset:4096
  v_mfma_f32_16x16x32_bf16 v[80:83], a[48:51], a[20:23], v[80:83]
  ds_read_b64_tr_b16 a[36:37], v15 offset:0
  ds_read_b64_tr_b16 a[38:39], v15 offset:4096
  v_mfma_f32_16x16x32_bf16 v[84:87], a[52:55], a[20:23], v[84:87]
  ds_read_b64_tr_b16 a[40:41], v16 offset:0
  ds_read_b64_tr_b16 a[42:43], v16 offset:4096
  v_mfma_f32_16x16x32_bf16 v[88:91], a[56:59], a[20:23], v[88:91]
  ds_read_b64_tr_b16 a[44:45], v17 offset:0
  ds_read_b64_tr_b16 a[46:47], v17 offset:4096
  v_mfma_f32_16x16x32_bf16 v[92:95], a[60:63], a[20:23], v[92:95]
  ds_read_b128 a[0:3], v12 offset:0
  v_mfma_f32_16x16x32_bf16 v[96:99], a[48:51], a[24:27], v[96:99]
  ds_read_b128 a[4:7], v12 offset:1024
  v_mfma_f32_16x16x32_bf16 v[100:103], a[52:55], a[24:27], v[100:103]
  ds_read_b128 a[8:11], v12 offset:2048
  v_mfma_f32_16x16x32_bf16 v[104:107], a[56:59], a[24:27], v[104:107]
  ds_read_b128 a[12:15], v12 offset:3072
  v_mfma_f32_16x16x32_bf16 v[108:111], a[60:63], a[24:27], v[108:111]
  s_add_u32 m0, s40, 49152
  v_mfma_f32_16x16x32_bf16 v[112:115], a[48:51], a[28:31], v[112:115]
  buffer_load_dwordx4 v4, s[8:11], s32 offen offset:0 sc1 lds
  v_mfma_f32_16x16x32_bf16 v[116:119], a[52:55], a[28:31], v[116:119]
  buffer_load_dwordx4 v5, s[8:11], s32 offen offset:1024 sc1 lds
  s_add_u32 s32, s32, s33
  v_mfma_f32_16x16x32_bf16 v[120:123], a[56:59], a[28:31], v[120:123]
  s_add_u32 m0, s41, 24576
  s_nop 0
  buffer_load_dwordx4 v8, s[12:15], s34 offen offset:0 lds
  s_add_u32 s34, s34, s35
  v_mfma_f32_16x16x32_bf16 v[124:127], a[60:63], a[28:31], v[124:127]
  s_sub_u32 s36, s36, 1
  s_cmp_lg_u32 s36, 0
  s_cbranch_scc1 L_loop_half_fm_kq
  s_waitcnt lgkmcnt(3)
  v_mfma_f32_16x16x32_bf16 v[64:67], a[32:35], a[0:3], v[64:67]
  v_mfma_f32_16x16x32_bf16 v[68:71], a[36:39], a[0:3], v[68:71]
  v_mfma_f32_16x16x32_bf16 v[72:75], a[40:43], a[0:3], v[72:75]
  v_mfma_f32_16x16x32_bf16 v[76:79], a[44:47], a[0:3], v[76:79]
  s_waitcnt lgkmcnt(0)
  s_waitcnt vmcnt(6)
  s_barrier
  ds_read_b64_tr_b16 a[48:49], v14 offset:8192
  ds_read_b64_tr_b16 a[50:51], v14 offset:12288
  v_mfma_f32_16x16x32_bf16 v[80:83], a[32:35], a[4:7], v[80:83]
  ds_read_b64_tr_b16 a[52:53], v15 offset:8192
  ds_read_b64_tr_b16 a[54:55], v15 offset:12288
  v_mfma_f32_16x16x32_bf16 v[84:87], a[36:39], a[4:7], v[84:87]
  ds_read_b64_tr_b16 a[56:57], v16 offset:8192
  ds_read_b64_tr_b16 a[58:59], v16 offset:12288
  v_mfma_f32_16x16x32_bf16 v[88:91], a[40:43], a[4:7], v[88:91]
  ds_read_b64_tr_b16 a[60:61], v17 offset:8192
  ds_read_b64_tr_b16 a[62:63], v17 offset:12288
  v_mfma_f32_16x16x32_bf16 v[92:95], a[44:47], a[4:7], v[92:95]
  ds_read_b128 a[16:19], v12 offset:16384
  v_mfma_f32_16x16x32_bf16 v[96:99], a[32:35], a[8:11], v[96:99]
  ds_read_b128 a[20:23], v12 offset:17408
  v_mfma_f32_16x16x32_bf16 v[100:103], a[36:39], a[8:11], v[100:103]
  ds_read_b128 a[24:27], v12 offset:18432
  v_mfma_f32_16x16x32_bf16 v[104:107], a[40:43], a[8:11], v[104:107]
  ds_read_b128 a[28:31], v12 offset:19456
  v_mfma_f32_16x16x32_bf16 v[108:111], a[44:47], a[8:11], v[108:111]
  v_mfma_f32_16x16x32_bf16 v[112:115], a[32:35], a[12:15], v[112:115]
  v_mfma_f32_16x16x32_bf16 v[116:119], a[36:39], a[12:15], v[116:119]
  v_mfma_f32_16x16x32_bf16 v[120:123], a[40:43], a[12:15], v[120:123]
  v_mfma_f32_16x16x32_bf16 v[124:127], a[44:47], a[12:15], v[124:127]
  s_waitcnt lgkmcnt(3)
  v_mfma_f32_16x16x32_bf16 v[64:67], a[48:51], a[16:19], v[64:67]
  v_mfma_f32_16x16x32_bf16 v[68:71], a[52:55], a[16:19], v[68:71]
  v_mfma_f32_16x16x32_bf16 v[72:75], a[56:59], a[16:19], v[72:75]
  v_mfma_f32_16x16x32_bf16 v[76:79], a[60:63], a[16:19], v[76:79]
  s_waitcnt lgkmcnt(0)
  s_waitcnt vmcnt(3)
  s_barrier
  ds_read_b64_tr_b16 a[32:33], v14 offset:16384
  ds_read_b64_tr_b16 a[34:35], v14 offset:20480
  v_mfma_f32_16x16x32_bf16 v[80:83], a[48:51], a[20:23], v[80:83]
  ds_read_b64_tr_b16 a[36:37], v15 offset:16384
  ds_read_b64_tr_b16 a[38:39], v15 offset:20480
  v_mfma_f32_16x16x32_bf16 v[84:87], a[52:55], a[20:23], v[84:87]
  ds_read_b64_tr_b16 a[40:41], v16 offset:16384
  ds_read_b64_tr_b16 a[42:43], v16 offset:20480
  v_mfma_f32_16x16x32_bf16 v[88:91], a[56:59], a[20:23], v[88:91]
  ds_read_b64_tr_b16 a[44:45], v17 offset:16384
  ds_read_b64_tr_b16 a[46:47], v17 offset:20480
  v_mfma_f32_16x16x32_bf16 v[92:95], a[60:63], a[20:23], v[92:95]
  ds_read_b128 a[0:3], v12 offset:32768
  v_mfma_f32_16x16x32_bf16 v[96:99], a[48:51], a[24:27], v[96:99]
  ds_read_b128 a[4:7], v12 offset:33792
  v_mfma_f32_16x16x32_bf16 v[100:103], a[52:55], a[24:27], v[100:103]
  ds_read_b128 a[8:11], v12 offset:34816
  v_mfma_f32_16x16x32_bf16 v[104:107], a[56:59], a[24:27], v[104:107]
  ds_read_b128 a[12:15], v12 offset:35840
  v_mfma_f32_16x16x32_bf16 v[108:111], a[60:63], a[24:27], v[108:111]
  v_mfma_f32_16x16x32_bf16 v[112:115], a[48:51], a[28:31], v[112:115]
  v_mfma_f32_16x16x32_bf16 v[116:119], a[52:55], a[28:31], v[116:119]
  v_mfma_f32_16x16x32_bf16 v[120:123], a[56:59], a[28:31], v[120:123]
  v_mfma_f32_16x16x32_bf16 v[124:127], a[60:63], a[28:31], v[124:127]
  s_waitcnt lgkmcnt(3)
  v_mfma_f32_16x16x32_bf16 v[64:67], a[32:35], a[0:3], v[64:67]
  v_mfma_f32_16x16x32_bf16 v[68:71], a[36:39], a[0:3], v[68:71]
  v_mfma_f32_16x16x32_bf16 v[72:75], a[40:43], a[0:3], v[72:75]
  v_mfma_f32_16x16x32_bf16 v[76:79], a[44:47], a[0:3], v[76:79]
  s_waitcnt lgkmcnt(0)
  s_waitcnt vmcnt(0)
  s_barrier
  ds_read_b64_tr_b16 a[48:49], v14 offset:24576
  ds_read_b64_tr_b16 a[50:51], v14 offset:28672
  v_mfma_f32_16x16x32_bf16 v[80:83], a[32:35], a[4:7], v[80:83]
  ds_read_b64_tr_b16 a[52:53], v15 offset:24576
  ds_read_b64_tr_b16 a[54:55], v15 offset:28672
  v_mfma_f32_16x16x32_bf16 v[84:87], a[36:39], a[4:7], v[84:87]
  ds_read_b64_tr_b16 a[56:57], v16 offset:24576
  ds_read_b64_tr_b16 a[58:59], v16 offset:28672
  v_mfma_f32_16x16x32_bf16 v[88:91], a[40:43], a[4:7], v[88:91]
  ds_read_b64_tr_b16 a[60:61], v17 offset:24576
  ds_read_b64_tr_b16 a[62:63], v17 offset:28672
  v_mfma_f32_16x16x32_bf16 v[92:95], a[44:47], a[4:7], v[92:95]
  ds_read_b128 a[16:19], v12 offset:49152
  v_mfma_f32_16x16x32_bf16 v[96:99], a[32:35], a[8:11], v[96:99]
  ds_read_b128 a[20:23], v12 offset:50176
  v_mfma_f32_16x16x32_bf16 v[100:103], a[36:39], a[8:11], v[100:103]
  ds_read_b128 a[24:27], v12 offset:51200
  v_mfma_f32_16x16x32_bf16 v[104:107], a[40:43], a[8:11], v[104:107]
  ds_read_b128 a[28:31], v12 offset:52224
  v_mfma_f32_16x16x32_bf16 v[108:111], a[44:47], a[8:11], v[108:111]
  v_mfma_f32_16x16x32_bf16 v[112:115], a[32:35], a[12:15], v[112:115]
  v_mfma_f32_16x16x32_bf16 v[116:119], a[36:39], a[12:15], v[116:119]
  v_mfma_f32_16x16x32_bf16 v[120:123], a[40:43], a[12:15], v[120:123]
  v_mfma_f32_16x16x32_bf16 v[124:127], a[44:47], a[12:15], v[124:127]
  s_waitcnt lgkmcnt(3)
  v_mfma_f32_16x16x32_bf16 v[64:67], a[48:51], a[16:19], v[64:67]
  v_mfma_f32_16x16x32_bf16 v[68:71], a[52:55], a[16:19], v[68:71]
  v_mfma_f32_16x16x32_bf16 v[72:75], a[56:59], a[16:19], v[72:75]
  v_mfma_f32_16x16x32_bf16 v[76:79], a[60:63], a[16:19], v[76:79]
  s_waitcnt lgkmcnt(2)
  v_mfma_f32_16x16x32_bf16 v[80:83], a[48:51], a[20:23], v[80:83]
  v_mfma_f32_16x16x32_bf16 v[84:87], a[52:55], a[20:23], v[84:87]
  v_mfma_f32_16x16x32_bf16 v[88:91], a[56:59], a[20:23], v[88:91]
  v_mfma_f32_16x16x32_bf16 v[92:95], a[60:63], a[20:23], v[92:95]
  s_waitcnt lgkmcnt(1)
  v_mfma_f32_16x16x32_bf16 v[96:99], a[48:51], a[24:27], v[96:99]
  v_mfma_f32_16x16x32_bf16 v[100:103], a[52:55], a[24:27], v[100:103]
  v_mfma_f32_16x16x32_bf16 v[104:107], a[56:59], a[24:27], v[104:107]
  v_mfma_f32_16x16x32_bf16 v[108:111], a[60:63], a[24:27], v[108:111]
  s_waitcnt lgkmcnt(0)
  v_mfma_f32_16x16x32_bf16 v[112:115], a[48:51], a[28:31], v[112:115]
  v_mfma_f32_16x16x32_bf16 v[116:119], a[52:55], a[28:31], v[116:119]
  v_mfma_f32_16x16x32_bf16 v[120:123], a[56:59], a[28:31], v[120:123]
  v_mfma_f32_16x16x32_bf16 v[124:127], a[60:63], a[28:31], v[124:127]
L_episel_56:
  s_nop 7
L_epi_final_55:
  s_cmp_lg_u32 s28, 0
  s_cbranch_scc1 L_latew_57
  s_mov_b32 s42, s78
  s_cmp_eq_u32 s42, 0
  s_cbranch_scc1 L_latew_57
  v_mov_b32 v2, 0
  v_writelane_b32 v2, s78, 0
  v_lshrrev_b32 v3, 24, v2
  v_lshlrev_b32 v3, 7, v3
  v_and_b32 v2, 0xffffff, v2
  s_mov_b32 s83, 0
  s_add_u32 s42, s59, 0x5c14000
L_poll_58:
  buffer_load_dword v20, v3, s[4:7], s42 offen sc1
  s_waitcnt vmcnt(0)
  v_cmp_lt_u32 vcc, v20, v2
  s_cbranch_vccz L_latew_57
  s_sleep 4
  s_add_u32 s83, s83, 1
  s_cmp_lt_u32 s83, 1048576
  s_cbranch_scc1 L_poll_58
  s_branch L_abort
L_latew_57:
  s_barrier
  s_lshr_b32 s42, s28, 1
  s_and_b32 s43, s28, 1
  s_mul_i32 s44, s42, 64
  s_add_u32 s48, s48, s44
  s_mul_i32 s44, s43, 64
  s_add_u32 s49, s49, s44
  s_lshl_b32 s44, s48, 11
  s_lshl_b32 s45, s49, 5
  s_add_u32 s37, s44, s45
  s_add_u32 s37, s37, 0x5000000
  s_lshl_b32 s44, s48, 2
  s_add_u32 s44, s44, 0x5c00000
  v_and_b32 v2, 15, v1
  v_lshlrev_b32 v3, 2, v2
  buffer_load_dword v4, v3, s[4:7], s44 offen offset:0 sc1
  buffer_load_dword v5, v3, s[4:7], s44 offen offset:64 sc1
  buffer_load_dword v6, v3, s[4:7], s44 offen offset:128 sc1
  buffer_load_dword v7, v3, s[4:7], s44 offen offset:192 sc1
  buffer_load_dwordx4 v[20:23], v18, s[4:7], s37 offen offset:0 sc1
  buffer_load_dwordx4 v[24:27], v18, s[4:7], s37 offen offset:1024 sc1
  s_add_u32 s37, s37, 32768
  buffer_load_dwordx4 v[28:31], v18, s[4:7], s37 offen offset:0 sc1
  buffer_load_dwordx4 v[32:35], v18, s[4:7], s37 offen offset:1024 sc1
  s_add_u32 s37, s37, 32768
  buffer_load_dwordx4 v[36:39], v18, s[4:7], s37 offen offset:0 sc1
  buffer_load_dwordx4 v[40:43], v18, s[4:7], s37 offen offset:1024 sc1
  s_add_u32 s37, s37, 32768
  v_lshlrev_b32 v12, 11, v2
  v_bfe_u32 v3, v1, 4, 1
  v_lshl_add_u32 v12, v3, 5, v12
  v_lshrrev_b32 v3, 5, v1
  v_lshl_add_u32 v12, v3, 4, v12
  s_lshl_b32 s44, s48, 11
  s_lshl_b32 s45, s49, 1
  s_add_u32 s44, s44, s45
  s_waitcnt vmcnt(4)
  v_sub_f32 v14, 1.0, v4
  v_mov_b32 v16, v4
  v_lshlrev_b32 v52, 16, v20
  v_and_b32 v53, 0xffff0000, v20
  v_pk_mul_f32 v[64:65], v[64:65], v[16:17] op_sel_hi:[1,0]
  v_pk_fma_f32 v[64:65], v[52:53], v[14:15], v[64:65] op_sel_hi:[1,0,1]
  v_cvt_pk_bf16_f32 v56, v64, v65
  v_lshlrev_b32 v54, 16, v21
  v_and_b32 v55, 0xffff0000, v21
  v_pk_mul_f32 v[66:67], v[66:67], v[16:17] op_sel_hi:[1,0]
  v_pk_fma_f32 v[66:67], v[54:55], v[14:15], v[66:67] op_sel_hi:[1,0,1]
  v_cvt_pk_bf16_f32 v57, v66, v67
  v_lshlrev_b32 v52, 16, v22
  v_and_b32 v53, 0xffff0000, v22
  v_pk_mul_f32 v[68:69], v[68:69], v[16:17] op_sel_hi:[1,0]
  v_pk_fma_f32 v[68:69], v[52:53], v[14:15], v[68:69] op_sel_hi:[1,0,1]
  v_cvt_pk_bf16_f32 v58, v68, v69
  v_lshlrev_b32 v54, 16, v23
  v_and_b32 v55, 0xffff0000, v23
  v_pk_mul_f32 v[70:71], v[70:71], v[16:17] op_sel_hi:[1,0]
  v_pk_fma_f32 v[70:71], v[54:55], v[14:15], v[70:71] op_sel_hi:[1,0,1]
  v_cvt_pk_bf16_f32 v59, v70, v71
  s_nop 1
  v_permlane16_swap_b32 v56, v58
  v_permlane16_swap_b32 v57, v59
  buffer_store_dwordx4 v[56:59], v12, s[16:19], s44 offen offset:0
  s_nop 0
  v_lshlrev_b32 v52, 16, v24
  v_and_b32 v53, 0xffff0000, v24
  v_pk_mul_f32 v[72:73], v[72:73], v[16:17] op_sel_hi:[1,0]
  v_pk_fma_f32 v[72:73], v[52:53], v[14:15], v[72:73] op_sel_hi:[1,0,1]
  v_cvt_pk_bf16_f32 v56, v72, v73
  v_lshlrev_b32 v54, 16, v25
  v_and_b32 v55, 0xffff0000, v25
  v_pk_mul_f32 v[74:75], v[74:75], v[16:17] op_sel_hi:[1,0]
  v_pk_fma_f32 v[74:75], v[54:55], v[14:15], v[74:75] op_sel_hi:[1,0,1]
  v_cvt_pk_bf16_f32 v57, v74, v75
  v_lshlrev_b32 v52, 16, v26
  v_and_b32 v53, 0xffff0000, v26
  v_pk_mul_f32 v[76:77], v[76:77], v[16:17] op_sel_hi:[1,0]
  v_pk_fma_f32 v[76:77], v[52:53], v[14:15], v[76:77] op_sel_hi:[1,0,1]
  v_cvt_pk_bf16_f32 v58, v76, v77
  v_lshlrev_b32 v54, 16, v27
  v_and_b32 v55, 0xffff0000, v27
  v_pk_mul_f32 v[78:79], v[78:79], v[16:17] op_sel_hi:[1,0]
  v_pk_fma_f32 v[78:79], v[54:55], v[14:15], v[78:79] op_sel_hi:[1,0,1]
  v_cvt_pk_bf16_f32 v59, v78, v79
  s_nop 1
  v_permlane16_swap_b32 v56, v58
  v_permlane16_swap_b32 v57, v59
  buffer_store_dwordx4 v[56:59], v12, s[16:19], s44 offen offset:64
  s_nop 0
  buffer_load_dwordx4 v[44:47], v18, s[4:7], s37 offen offset:0 sc1
  buffer_load_dwordx4 v[48:51], v18, s[4:7], s37 offen offset:1024 sc1
  s_add_u32 s37, s37, 32768
  s_add_u32 s44, s44, 32768
  s_waitcnt vmcnt(6)
  v_sub_f32 v14, 1.0, v5
  v_mov_b32 v16, v5
  v_lshlrev_b32 v52, 16, v28
  v_and_b32 v53, 0xffff0000, v28
  v_pk_mul_f32 v[80:81], v[80:81], v[16:17] op_sel_hi:[1,0]
  v_pk_fma_f32 v[80:81], v[52:53], v[14:15], v[80:81] op_sel_hi:[1,0,1]
  v_cvt_pk_bf16_f32 v56, v80, v81
  v_lshlrev_b32 v54, 16, v29
  v_and_b32 v55, 0xffff0000, v29
  v_pk_mul_f32 v[82:83], v[82:83], v[16:17] op_sel_hi:[1,0]
  v_pk_fma_f32 v[82:83], v[54:55], v[14:15], v[82:83] op_sel_hi:[1,0,1]
  v_cvt_pk_bf16_f32 v57, v82, v83
  v_lshlrev_b32 v52, 16, v30
  v_and_b32 v53, 0xffff0000, v30
  v_pk_mul_f32 v[84:85], v[84:85], v[16:17] op_sel_hi:[1,0]
  v_pk_fma_f32 v[84:85], v[52:53], v[14:15], v[84:85] op_sel_hi:[1,0,1]
  v_cvt_pk_bf16_f32 v58, v84, v85
  v_lshlrev_b32 v54, 16, v31
  v_and_b32 v55, 0xffff0000, v31
  v_pk_mul_f32 v[86:87], v[86:87], v[16:17] op_sel_hi:[1,0]
  v_pk_fma_f32 v[86:87], v[54:55], v[14:15], v[86:87] op_sel_hi:[1,0,1]
  v_cvt_pk_bf16_f32 v59, v86, v87
  s_nop 1
  v_permlane16_swap_b32 v56, v58
  v_permlane16_swap_b32 v57, v59
  buffer_store_dwordx4 v[56:59], v12, s[16:19], s44 offen offset:0
  s_nop 0
  v_lshlrev_b32 v52, 16, v32
  v_and_b32 v53, 0xffff0000, v32
  v_pk_mul_f32 v[88:89], v[88:89], v[16:17] op_sel_hi:[1,0]
  v_pk_fma_f32 v[88:89], v[52:53], v[14:15], v[88:89] op_sel_hi:[1,0,1]
  v_cvt_pk_bf16_f32 v56, v88, v89
  v_lshlrev_b32 v54, 16, v33
  v_and_b32 v55, 0xffff0000, v33
  v_pk_mul_f32 v[90:91], v[90:91], v[16:17] op_sel_hi:[1,0]
  v_pk_fma_f32 v[90:91], v[54:55], v[14:15], v[90:91] op_sel_hi:[1,0,1]
  v_cvt_pk_bf16_f32 v57, v90, v91
  v_lshlrev_b32 v52, 16, v34
  v_and_b32 v53, 0xffff0000, v34
  v_pk_mul_f32 v[92:93], v[92:93], v[16:17] op_sel_hi:[1,0]
  v_pk_fma_f32 v[92:93], v[52:53], v[14:15], v[92:93] op_sel_hi:[1,0,1]
  v_cvt_pk_bf16_f32 v58, v92, v93
  v_lshlrev_b32 v54, 16, v35
  v_and_b32 v55, 0xffff0000, v35
  v_pk_mul_f32 v[94:95], v[94:95], v[16:17] op_sel_hi:[1,0]
  v_pk_fma_f32 v[94:95], v[54:55], v[14:15], v[94:95] op_sel_hi:[1,0,1]
  v_cvt_pk_bf16_f32 v59, v94, v95
  s_nop 1
  v_permlane16_swap_b32 v56, v58
  v_permlane16_swap_b32 v57, v59
  buffer_store_dwordx4 v[56:59], v12, s[16:19], s44 offen offset:64
  s_nop 0
  s_add_u32 s44, s44, 32768
  s_waitcnt vmcnt(6)
  v_sub_f32 v14, 1.0, v6
  v_mov_b32 v16, v6
  v_lshlrev_b32 v52, 16, v36
  v_and_b32 v53, 0xffff0000, v36
  v_pk_mul_f32 v[96:97], v[96:97], v[16:17] op_sel_hi:[1,0]
  v_pk_fma_f32 v[96:97], v[52:53], v[14:15], v[96:97] op_sel_hi:[1,0,1]
  v_cvt_pk_bf16_f32 v56, v96, v97
  v_lshlrev_b32 v54, 16, v37
  v_and_b32 v55, 0xffff0000, v37
  v_pk_mul_f32 v[98:99], v[98:99], v[16:17] op_sel_hi:[1,0]
  v_pk_fma_f32 v[98:99], v[54:55], v[14:15], v[98:99] op_sel_hi:[1,0,1]
  v_cvt_pk_bf16_f32 v57, v98, v99
  v_lshlrev_b32 v52, 16, v38
  v_and_b32 v53, 0xffff0000, v38
  v_pk_mul_f32 v[100:101], v[100:101], v[16:17] op_sel_hi:[1,0]
  v_pk_fma_f32 v[100:101], v[52:53], v[14:15], v[100:101] op_sel_hi:[1,0,1]
  v_cvt_pk_bf16_f32 v58, v100, v101
  v_lshlrev_b32 v54, 16, v39
  v_and_b32 v55, 0xffff0000, v39
  v_pk_mul_f32 v[102:103], v[102:103], v[16:17] op_sel_hi:[1,0]
  v_pk_fma_f32 v[102:103], v[54:55], v[14:15], v[102:103] op_sel_hi:[1,0,1]
  v_cvt_pk_bf16_f32 v59, v102, v103
  s_nop 1
  v_permlane16_swap_b32 v56, v58
  v_permlane16_swap_b32 v57, v59
  buffer_store_dwordx4 v[56:59], v12, s[16:19], s44 offen offset:0
  s_nop 0
  v_lshlrev_b32 v52, 16, v40
  v_and_b32 v53, 0xffff0000, v40
  v_pk_mul_f32 v[104:105], v[104:105], v[16:17] op_sel_hi:[1,0]
  v_pk_fma_f32 v[104:105], v[52:53], v[14:15], v[104:105] op_sel_hi:[1,0,1]
  v_cvt_pk_bf16_f32 v56, v104, v105
  v_lshlrev_b32 v54, 16, v41
  v_and_b32 v55, 0xffff0000, v41
  v_pk_mul_f32 v[106:107], v[106:107], v[16:17] op_sel_hi:[1,0]
  v_pk_fma_f32 v[106:107], v[54:55], v[14:15], v[106:107] op_sel_hi:[1,0,1]
  v_cvt_pk_bf16_f32 v57, v106, v107
  v_lshlrev_b32 v52, 16, v42
  v_and_b32 v53, 0xffff0000, v42
  v_pk_mul_f32 v[108:109], v[108:109], v[16:17] op_sel_hi:[1,0]
  v_pk_fma_f32 v[108:109], v[52:53], v[14:15], v[108:109] op_sel_hi:[1,0,1]
  v_cvt_pk_bf16_f32 v58, v108, v109
  v_lshlrev_b32 v54, 16, v43
  v_and_b32 v55, 0xffff0000, v43
  v_pk_mul_f32 v[110:111], v[110:111], v[16:17] op_sel_hi:[1,0]
  v_pk_fma_f32 v[110:111], v[54:55], v[14:15], v[110:111] op_sel_hi:[1,0,1]
  v_cvt_pk_bf16_f32 v59, v110, v111
  s_nop 1
  v_permlane16_swap_b32 v56, v58
  v_permlane16_swap_b32 v57, v59
  buffer_store_dwordx4 v[56:59], v12, s[16:19], s44 offen offset:64
  s_nop 0
  s_add_u32 s44, s44, 32768
  s_waitcnt vmcnt(4)
  v_sub_f32 v14, 1.0, v7
  v_mov_b32 v16, v7
  v_lshlrev_b32 v52, 16, v44
  v_and_b32 v53, 0xffff0000, v44
  v_pk_mul_f32 v[112:113], v[112:113], v[16:17] op_sel_hi:[1,0]
  v_pk_fma_f32 v[112:113], v[52:53], v[14:15], v[112:113] op_sel_hi:[1,0,1]
  v_cvt_pk_bf16_f32 v56, v112, v113
  v_lshlrev_b32 v54, 16, v45
  v_and_b32 v55, 0xffff0000, v45
  v_pk_mul_f32 v[114:115], v[114:115], v[16:17] op_sel_hi:[1,0]
  v_pk_fma_f32 v[114:115], v[54:55], v[14:15], v[114:115] op_sel_hi:[1,0,1]
  v_cvt_pk_bf16_f32 v57, v114, v115
  v_lshlrev_b32 v52, 16, v46
  v_and_b32 v53, 0xffff0000, v46
  v_pk_mul_f32 v[116:117], v[116:117], v[16:17] op_sel_hi:[1,0]
  v_pk_fma_f32 v[116:117], v[52:53], v[14:15], v[116:117] op_sel_hi:[1,0,1]
  v_cvt_pk_bf16_f32 v58, v116, v117
  v_lshlrev_b32 v54, 16, v47
  v_and_b32 v55, 0xffff0000, v47
  v_pk_mul_f32 v[118:119], v[118:119], v[16:17] op_sel_hi:[1,0]
  v_pk_fma_f32 v[118:119], v[54:55], v[14:15], v[118:119] op_sel_hi:[1,0,1]
  v_cvt_pk_bf16_f32 v59, v118, v119
  s_nop 1
  v_permlane16_swap_b32 v56, v58
  v_permlane16_swap_b32 v57, v59
  buffer_store_dwordx4 v[56:59], v12, s[16:19], s44 offen offset:0
  s_nop 0
  v_lshlrev_b32 v52, 16, v48
  v_and_b32 v53, 0xffff0000, v48
  v_pk_mul_f32 v[120:121], v[120:121], v[16:17] op_sel_hi:[1,0]
  v_pk_fma_f32 v[120:121], v[52:53], v[14:15], v[120:121] op_sel_hi:[1,0,1]
  v_cvt_pk_bf16_f32 v56, v120, v121
  v_lshlrev_b32 v54, 16, v49
  v_and_b32 v55, 0xffff0000, v49
  v_pk_mul_f32 v[122:123], v[122:123], v[16:17] op_sel_hi:[1,0]
  v_pk_fma_f32 v[122:123], v[54:55], v[14:15], v[122:123] op_sel_hi:[1,0,1]
  v_cvt_pk_bf16_f32 v57, v122, v123
  v_lshlrev_b32 v52, 16, v50
  v_and_b32 v53, 0xffff0000, v50
  v_pk_mul_f32 v[124:125], v[124:125], v[16:17] op_sel_hi:[1,0]
  v_pk_fma_f32 v[124:125], v[52:53], v[14:15], v[124:125] op_sel_hi:[1,0,1]
  v_cvt_pk_bf16_f32 v58, v124, v125
  v_lshlrev_b32 v54, 16, v51
  v_and_b32 v55, 0xffff0000, v51
  v_pk_mul_f32 v[126:127], v[126:127], v[16:17] op_sel_hi:[1,0]
  v_pk_fma_f32 v[126:127], v[54:55], v[14:15], v[126:127] op_sel_hi:[1,0,1]
  v_cvt_pk_bf16_f32 v59, v126, v127
  s_nop 1
  v_permlane16_swap_b32 v56, v58
  v_permlane16_swap_b32 v57, v59
  buffer_store_dwordx4 v[56:59], v12, s[16:19], s44 offen offset:64
  s_nop 0
  s_add_u32 s44, s44, 32768
  s_branch L_done
L_body_q128_rm_kq:
  s_lshr_b32 s42, s28, 2
  s_and_b32 s43, s28, 3
  s_mul_i32 s40, s28, 2048
  s_mul_i32 s41, s28, 2048
  s_add_u32 s41, s41, 65536
  v_lshlrev_b32 v18, 4, v1
  s_mul_i32 s44, s42, 8192
  v_lshrrev_b32 v22, 4, v1
  v_and_b32 v23, 15, v1
  v_bfe_u32 v21, v1, 1, 3
  v_add_u32 v20, 0, v22
  v_xor_b32 v20, v20, v21
  v_lshlrev_b32 v20, 4, v20
  v_lshl_add_u32 v20, v23, 7, v20
  v_add_u32 v12, s44, v20
  v_add_u32 v20, 4, v22
  v_xor_b32 v20, v20, v21
  v_lshlrev_b32 v20, 4, v20
  v_lshl_add_u32 v20, v23, 7, v20
  v_add_u32 v13, s44, v20
  v_and_b32 v23, 7, v1
  v_lshrrev_b32 v21, 3, v1
  s_mul_i32 s44, s28, 2
  s_add_u32 s44, s44, 0
  s_and_b32 s45, s44, 1
  s_lshl_b32 s45, s45, 2
  v_or_b32 v20, s45, v22
  v_xor_b32 v20, v20, v23
  v_lshlrev_b32 v20, 4, v20
  v_lshl_add_u32 v20, v21, 11, v20
  s_lshl_b32 s44, s44, 14
  v_add_u32 v4, s44, v20
  s_mul_i32 s44, s28, 2
  s_add_u32 s44, s44, 1
  s_and_b32 s45, s44, 1
  s_lshl_b32 s45, s45, 2
  v_or_b32 v20, s45, v22
  v_xor_b32 v20, v20, v23
  v_lshlrev_b32 v20, 4, v20
  v_lshl_add_u32 v20, v21, 11, v20
  s_lshl_b32 s44, s44, 14
  s_sub_u32 s44, s44, 1024
  v_add_u32 v5, s44, v20
  v_lshrrev_b32 v23, 4, v1
  v_and_b32 v24, 15, v1
  s_mul_i32 s44, s28, 8
  s_add_u32 s44, s44, 0
  v_add_u32 v20, s44, v23
  v_and_b32 v21, 3, v20
  v_bfe_u32 v22, v20, 3, 1
  v_lshl_or_b32 v21, v22, 2, v21
  v_lshlrev_b32 v21, 1, v21
  v_xor_b32 v21, v21, v24
  v_mul_lo_u32 v20, v20, s39
  v_lshl_add_u32 v8, v21, 4, v20
  s_mul_i32 s44, s28, 8
  s_add_u32 s44, s44, 4
  v_add_u32 v20, s44, v23
  v_and_b32 v21, 3, v20
  v_bfe_u32 v22, v20, 3, 1
  v_lshl_or_b32 v21, v22, 2, v21
  v_lshlrev_b32 v21, 1, v21
  v_xor_b32 v21, v21, v24
  v_mul_lo_u32 v20, v20, s39
  v_lshl_add_u32 v9, v21, 4, v20
  v_subrev_u32 v9, 1024, v9
  v_bfe_u32 v20, v1, 2, 2
  v_lshrrev_b32 v21, 4, v1
  v_lshl_add_u32 v22, v21, 3, v20
  v_mul_u32_u24 v22, 256, v22
  v_and_b32 v23, 3, v1
  v_lshl_add_u32 v22, v23, 3, v22
  v_add_u32 v22, 65536, v22
  v_and_b32 v21, 1, v21
  v_lshl_or_b32 v20, v21, 2, v20
  s_mul_i32 s44, s43, 2
  s_add_u32 s44, s44, 0
  v_xor_b32 v21, s44, v20
  v_lshl_add_u32 v14, v21, 5, v22
  s_mul_i32 s44, s43, 2
  s_add_u32 s44, s44, 1
  v_xor_b32 v21, s44, v20
  v_lshl_add_u32 v15, v21, 5, v22
  s_add_u32 m0, s40, 0
  s_nop 0
  buffer_load_dwordx4 v4, s[8:11], s32 offen offset:0 lds
  buffer_load_dwordx4 v5, s[8:11], s32 offen offset:1024 lds
  s_add_u32 s32, s32, s33
  s_add_u32 m0, s41, 0
  s_nop 0
  buffer_load_dwordx4 v8, s[12:15], s34 offen offset:0 lds
  buffer_load_dwordx4 v9, s[12:15], s34 offen offset:1024 lds
  s_add_u32 s34, s34, s35
  s_add_u32 m0, s40, 16384
  s_nop 0
  buffer_load_dwordx4 v4, s[8:11], s32 offen offset:0 lds
  buffer_load_dwordx4 v5, s[8:11], s32 offen offset:1024 lds
  s_add_u32 s32, s32, s33
  s_add_u32 m0, s41, 16384
  s_nop 0
  buffer_load_dwordx4 v8, s[12:15], s34 offen offset:0 lds
  buffer_load_dwordx4 v9, s[12:15], s34 offen offset:1024 lds
  s_add_u32 s34, s34, s35
  s_add_u32 m0, s40, 32768
  s_nop 0
  buffer_load_dwordx4 v4, s[8:11], s32 offen offset:0 lds
  buffer_load_dwordx4 v5, s[8:11], s32 offen offset:1024 lds
  s_add_u32 s32, s32, s33
  s_add_u32 m0, s41, 32768
  s_nop 0
  buffer_load_dwordx4 v8, s[12:15], s34 offen offset:0 lds
  buffer_load_dwordx4 v9, s[12:15], s34 offen offset:1024 lds
  s_add_u32 s34, s34, s35
  s_add_u32 m0, s40, 49152
  s_nop 0
  buffer_load_dwordx4 v4, s[8:11], s32 offen offset:0 lds
  buffer_load_dwordx4 v5, s[8:11], s32 offen offset:1024 lds
  s_add_u32 s32, s32, s33
  s_add_u32 m0, s41, 49152
  s_nop 0
  buffer_load_dwordx4 v8, s[12:15], s34 offen offset:0 lds
  buffer_load_dwordx4 v9, s[12:15], s34 offen offset:1024 lds
  s_add_u32 s34, s34, s35
  v_mov_b32 v64, 0
  v_mov_b32 v65, 0
  v_mov_b32 v66, 0
  v_mov_b32 v67, 0
  v_mov_b32 v68, 0
  v_mov_b32 v69, 0
  v_mov_b32 v70, 0
  v_mov_b32 v71, 0
  v_mov_b32 v72, 0
  v_mov_b32 v73, 0
  v_mov_b32 v74, 0
  v_mov_b32 v75, 0
  v_mov_b32 v76, 0
  v_mov_b32 v77, 0
  v_mov_b32 v78, 0
  v_mov_b32 v79, 0
  v_mov_b32 v80, 0
  v_mov_b32 v81, 0
  v_mov_b32 v82, 0
  v_mov_b32 v83, 0
  v_mov_b32 v84, 0
  v_mov_b32 v85, 0
  v_mov_b32 v86, 0
  v_mov_b32 v87, 0
  v_mov_b32 v88, 0
  v_mov_b32 v89, 0
  v_mov_b32 v90, 0
  v_mov_b32 v91, 0
  v_mov_b32 v92, 0
  v_mov_b32 v93, 0
  v_mov_b32 v94, 0
  v_mov_b32 v95, 0
  s_waitcnt vmcnt(12)
  s_barrier
  ds_read_b64_tr_b16 a[32:33], v14 offset:0
  ds_read_b64_tr_b16 a[34:35], v14 offset:1024
  ds_read_b64_tr_b16 a[36:37], v15 offset:0
  ds_read_b64_tr_b16 a[38:39], v15 offset:1024
  ds_read_b128 a[0:3], v12 offset:0
  ds_read_b128 a[4:7], v12 offset:2048
  ds_read_b128 a[8:11], v12 offset:4096
  ds_read_b128 a[12:15], v12 offset:6144
  s_waitcnt lgkmcnt(0)
L_loop_q128_rm_kq:
  s_waitcnt lgkmcnt(3)
  v_mfma_f32_16x16x32_bf16 v[64:67], a[32:35], a[0:3], v[64:67]
  ds_read_b64_tr_b16 a[40:41], v14 offset:8192
  ds_read_b64_tr_b16 a[42:43], v14 offset:9216
  v_mfma_f32_16x16x32_bf16 v[68:71], a[36:39], a[0:3], v[68:71]
  ds_read_b64_tr_b16 a[44:45], v15 offset:8192
  ds_read_b64_tr_b16 a[46:47], v15 offset:9216
  s_waitcnt lgkmcnt(6)
  v_mfma_f32_16x16x32_bf16 v[72:75], a[32:35], a[4:7], v[72:75]
  ds_read_b128 a[16:19], v13 offset:0
  ds_read_b128 a[20:23], v13 offset:2048
  v_mfma_f32_16x16x32_bf16 v[76:79], a[36:39], a[4:7], v[76:79]
  ds_read_b128 a[24:27], v13 offset:4096
  s_waitcnt lgkmcnt(8)
  v_mfma_f32_16x16x32_bf16 v[80:83], a[32:35], a[8:11], v[80:83]
  ds_read_b128 a[28:31], v13 offset:6144
  v_mfma_f32_16x16x32_bf16 v[84:87], a[36:39], a[8:11], v[84:87]
  s_waitcnt lgkmcnt(8)
  v_mfma_f32_16x16x32_bf16 v[88:91], a[32:35], a[12:15], v[88:91]
  v_mfma_f32_16x16x32_bf16 v[92:95], a[36:39], a[12:15], v[92:95]
  s_waitcnt lgkmcnt(3)
  v_mfma_f32_16x16x32_bf16 v[64:67], a[40:43], a[16:19], v[64:67]
  v_mfma_f32_16x16x32_bf16 v[68:71], a[44:47], a[16:19], v[68:71]
  s_waitcnt lgkmcnt(0)
  s_waitcnt vmcnt(8)
  s_barrier
  ds_read_b64_tr_b16 a[32:33], v14 offset:16384
  ds_read_b64_tr_b16 a[34:35], v14 offset:17408
  v_mfma_f32_16x16x32_bf16 v[72:75], a[40:43], a[20:23], v[72:75]
  ds_read_b64_tr_b16 a[36:37], v15 offset:16384
  ds_read_b64_tr_b16 a[38:39], v15 offset:17408
  v_mfma_f32_16x16x32_bf16 v[76:79], a[44:47], a[20:23], v[76:79]
  ds_read_b128 a[0:3], v12 offset:16384
  ds_read_b128 a[4:7], v12 offset:18432
  v_mfma_f32_16x16x32_bf16 v[80:83], a[40:43], a[24:27], v[80:83]
  ds_read_b128 a[8:11], v12 offset:20480
  ds_read_b128 a[12:15], v12 offset:22528
  v_mfma_f32_16x16x32_bf16 v[84:87], a[44:47], a[24:27], v[84:87]
  s_add_u32 m0, s40, 0
  v_mfma_f32_16x16x32_bf16 v[88:91], a[40:43], a[28:31], v[88:91]
  buffer_load_dwordx4 v4, s[8:11], s32 offen offset:0 lds
  v_mfma_f32_16x16x32_bf16 v[92:95], a[44:47], a[28:31], v[92:95]
  buffer_load_dwordx4 v5, s[8:11], s32 offen offset:1024 lds
  s_add_u32 s32, s32, s33
  s_add_u32 m0, s41, 0
  s_nop 0
  buffer_load_dwordx4 v8, s[12:15], s34 offen offset:0 lds
  buffer_load_dwordx4 v9, s[12:15], s34 offen offset:1024 lds
  s_add_u32 s34, s34, s35
  s_waitcnt lgkmcnt(3)
  v_mfma_f32_16x16x32_bf16 v[64:67], a[32:35], a[0:3], v[64:67]
  ds_read_b64_tr_b16 a[40:41], v14 offset:24576
  ds_read_b64_tr_b16 a[42:43], v14 offset:25600
  v_mfma_f32_16x16x32_bf16 v[68:71], a[36:39], a[0:3], v[68:71]
  ds_read_b64_tr_b16 a[44:45], v15 offset:24576
  ds_read_b64_tr_b16 a[46:47], v15 offset:25600
  s_waitcnt lgkmcnt(6)
  v_mfma_f32_16x16x32_bf16 v[72:75], a[32:35], a[4:7], v[72:75]
  ds_read_b128 a[16:19], v13 offset:16384
  ds_read_b128 a[20:23], v13 offset:18432
  v_mfma_f32_16x16x32_bf16 v[76:79], a[36:39], a[4:7], v[76:79]
  ds_read_b128 a[24:27], v13 offset:20480
  s_waitcnt lgkmcnt(8)
  v_mfma_f32_16x16x32_bf16 v[80:83], a[32:35], a[8:11], v[80:83]
  ds_read_b128 a[28:31], v13 offset:22528
  v_mfma_f32_16x16x32_bf16 v[84:87], a[36:39], a[8:11], v[84:87]
  s_waitcnt lgkmcnt(8)
  v_mfma_f32_16x16x32_bf16 v[88:91], a[32:35], a[12:15], v[88:91]
  v_mfma_f32_16x16x32_bf16 v[92:95], a[36:39], a[12:15], v[92:95]
  s_waitcnt lgkmcnt(3)
  v_mfma_f32_16x16x32_bf16 v[64:67], a[40:43], a[16:19], v[64:67]
  v_mfma_f32_16x16x32_bf16 v[68:71], a[44:47], a[16:19], v[68:71]
  s_waitcnt lgkmcnt(0)
  s_waitcnt vmcnt(8)
  s_barrier
  ds_read_b64_tr_b16 a[32:33], v14 offset:32768
  ds_read_b64_tr_b16 a[34:35], v14 offset:33792
  v_mfma_f32_16x16x32_bf16 v[72:75], a[40:43], a[20:23], v[72:75]
  ds_read_b64_tr_b16 a[36:37], v15 offset:32768
  ds_read_b64_tr_b16 a[38:39], v15 offset:33792
  v_mfma_f32_16x16x32_bf16 v[76:79], a[44:47], a[20:23], v[76:79]
  ds_read_b128 a[0:3], v12 offset:32768
  ds_read_b128 a[4:7], v12 offset:34816
  v_mfma_f32_16x16x32_bf16 v[80:83], a[40:43], a[24:27], v[80:83]
  ds_read_b128 a[8:11], v12 offset:36864
  ds_read_b128 a[12:15], v12 offset:38912
  v_mfma_f32_16x16x32_bf16 v[84:87], a[44:47], a[24:27], v[84:87]
  s_add_u32 m0, s40, 16384
  v_mfma_f32_16x16x32_bf16 v[88:91], a[40:43], a[28:31], v[88:91]
  buffer_load_dwordx4 v4, s[8:11], s32 offen offset:0 lds
  v_mfma_f32_16x16x32_bf16 v[92:95], a[44:47], a[28:31], v[92:95]
  buffer_load_dwordx4 v5, s[8:11], s32 offen offset:1024 lds
  s_add_u32 s32, s32, s33
  s_add_u32 m0, s41, 16384
  s_nop 0
  buffer_load_dwordx4 v8, s[12:15], s34 offen offset:0 lds
  buffer_load_dwordx4 v9, s[12:15], s34 offen offset:1024 lds
  s_add_u32 s34, s34, s35
  s_waitcnt lgkmcnt(3)
  v_mfma_f32_16x16x32_bf16 v[64:67], a[32:35], a[0:3], v[64:67]
  ds_read_b64_tr_b16 a[40:41], v14 offset:40960
  ds_read_b64_tr_b16 a[42:43], v14 offset:41984
  v_mfma_f32_16x16x32_bf16 v[68:71], a[36:39], a[0:3], v[68:71]
  ds_read_b64_tr_b16 a[44:45], v15 offset:40960
  ds_read_b64_tr_b16 a[46:47], v15 offset:41984
  s_waitcnt lgkmcnt(6)
  v_mfma_f32_16x16x32_bf16 v[72:75], a[32:35], a[4:7], v[72:75]
  ds_read_b128 a[16:19], v13 offset:32768
  ds_read_b128 a[20:23], v13 offset:34816
  v_mfma_f32_16x16x32_bf16 v[76:79], a[36:39], a[4:7], v[76:79]
  ds_read_b128 a[24:27], v13 offset:36864
  s_waitcnt lgkmcnt(8)
  v_mfma_f32_16x16x32_bf16 v[80:83], a[32:35], a[8:11], v[80:83]
  ds_read_b128 a[28:31], v13 offset:38912
  v_mfma_f32_16x16x32_bf16 v[84:87], a[36:39], a[8:11], v[84:87]
  s_waitcnt lgkmcnt(8)
  v_mfma_f32_16x16x32_bf16 v[88:91], a[32:35], a[12:15], v[88:91]
  v_mfma_f32_16x16x32_bf16 v[92:95], a[36:39], a[12:15], v[92:95]
  s_waitcnt lgkmcnt(3)
  v_mfma_f32_16x16x32_bf16 v[64:67], a[40:43], a[16:19], v[64:67]
  v_mfma_f32_16x16x32_bf16 v[68:71], a[44:47], a[16:19], v[68:71]
  s_waitcnt lgkmcnt(0)
  s_waitcnt vmcnt(8)
  s_barrier
  ds_read_b64_tr_b16 a[32:33], v14 offset:49152
  ds_read_b64_tr_b16 a[34:35], v14 offset:50176
  v_mfma_f32_16x16x32_bf16 v[72:75], a[40:43], a[20:23], v[72:75]
  ds_read_b64_tr_b16 a[36:37], v15 offset:49152
  ds_read_b64_tr_b16 a[38:39], v15 offset:50176
  v_mfma_f32_16x16x32_bf16 v[76:79], a[44:47], a[20:23], v[76:79]
  ds_read_b128 a[0:3], v12 offset:49152
  ds_read_b128 a[4:7], v12 offset:51200
  v_mfma_f32_16x16x32_bf16 v[80:83], a[40:43], a[24:27], v[80:83]
  ds_read_b128 a[8:11], v12 offset:53248
  ds_read_b128 a[12:15], v12 offset:55296
  v_mfma_f32_16x16x32_bf16 v[84:87], a[44:47], a[24:27], v[84:87]
  s_add_u32 m0, s40, 32768
  v_mfma_f32_16x16x32_bf16 v[88:91], a[40:43], a[28:31], v[88:91]
  buffer_load_dwordx4 v4, s[8:11], s32 offen offset:0 lds
  v_mfma_f32_16x16x32_bf16 v[92:95], a[44:47], a[28:31], v[92:95]
  buffer_load_dwordx4 v5, s[8:11], s32 offen offset:1024 lds
  s_add_u32 s32, s32, s33
  s_add_u32 m0, s41, 32768
  s_nop 0
  buffer_load_dwordx4 v8, s[12:15], s34 offen offset:0 lds
  buffer_load_dwordx4 v9, s[12:15], s34 offen offset:1024 lds
  s_add_u32 s34, s34, s35
  s_waitcnt lgkmcnt(3)
  v_mfma_f32_16x16x32_bf16 v[64:67], a[32:35], a[0:3], v[64:67]
  ds_read_b64_tr_b16 a[40:41], v14 offset:57344
  ds_read_b64_tr_b16 a[42:43], v14 offset:58368
  v_mfma_f32_16x16x32_bf16 v[68:71], a[36:39], a[0:3], v[68:71]
  ds_read_b64_tr_b16 a[44:45], v15 offset:57344
  ds_read_b64_tr_b16 a[46:47], v15 offset:58368
  s_waitcnt lgkmcnt(6)
  v_mfma_f32_16x16x32_bf16 v[72:75], a[32:35], a[4:7], v[72:75]
  ds_read_b128 a[16:19], v13 offset:49152
  ds_read_b128 a[20:23], v13 offset:51200
  v_mfma_f32_16x16x32_bf16 v[76:79], a[36:39], a[4:7], v[76:79]
  ds_read_b128 a[24:27], v13 offset:53248
  s_waitcnt lgkmcnt(8)
  v_mfma_f32_16x16x32_bf16 v[80:83], a[32:35], a[8:11], v[80:83]
  ds_read_b128 a[28:31], v13 offset:55296
  v_mfma_f32_16x16x32_bf16 v[84:87], a[36:39], a[8:11], v[84:87]
  s_waitcnt lgkmcnt(8)
  v_mfma_f32_16x16x32_bf16 v[88:91], a[32:35], a[12:15], v[88:91]
  v_mfma_f32_16x16x32_bf16 v[92:95], a[36:39], a[12:15], v[92:95]
  s_waitcnt lgkmcnt(3)
  v_mfma_f32_16x16x32_bf16 v[64:67], a[40:43], a[16:19], v[64:67]
  v_mfma_f32_16x16x32_bf16 v[68:71], a[44:47], a[16:19], v[68:71]
  s_waitcnt lgkmcnt(0)
  s_waitcnt vmcnt(8)
  s_barrier
  ds_read_b64_tr_b16 a[32:33], v14 offset:0
  ds_read_b64_tr_b16 a[34:35], v14 offset:1024
  v_mfma_f32_16x16x32_bf16 v[72:75], a[40:43], a[20:23], v[72:75]
  ds_read_b64_tr_b16 a[36:37], v15 offset:0
  ds_read_b64_tr_b16 a[38:39], v15 offset:1024
  v_mfma_f32_16x16x32_bf16 v[76:79], a[44:47], a[20:23], v[76:79]
  ds_read_b128 a[0:3], v12 offset:0
  ds_read_b128 a[4:7], v12 offset:2048
  v_mfma_f32_16x16x32_bf16 v[80:83], a[40:43], a[24:27], v[80:83]
  ds_read_b128 a[8:11], v12 offset:4096
  ds_read_b128 a[12:15], v12 offset:6144
  v_mfma_f32_16x16x32_bf16 v[84:87], a[44:47], a[24:27], v[84:87]
  s_add_u32 m0, s40, 49152
  v_mfma_f32_16x16x32_bf16 v[88:91], a[40:43], a[28:31], v[88:91]
  buffer_load_dwordx4 v4, s[8:11], s32 offen offset:0 lds
  v_mfma_f32_16x16x32_bf16 v[92:95], a[44:47], a[28:31], v[92:95]
  buffer_load_dwordx4 v5, s[8:11], s32 offen offset:1024 lds
  s_add_u32 s32, s32, s33
  s_add_u32 m0, s41, 49152
  s_nop 0
  buffer_load_dwordx4 v8, s[12:15], s34 offen offset:0 lds
  buffer_load_dwordx4 v9, s[12:15], s34 offen offset:1024 lds
  s_add_u32 s34, s34, s35
  s_sub_u32 s36, s36, 1
  s_cmp_lg_u32 s36, 0
  s_cbranch_scc1 L_loop_q128_rm_kq
  s_waitcnt lgkmcnt(3)
  v_mfma_f32_16x16x32_bf16 v[64:67], a[32:35], a[0:3], v[64:67]
  ds_read_b64_tr_b16 a[40:41], v14 offset:8192
  ds_read_b64_tr_b16 a[42:43], v14 offset:9216
  v_mfma_f32_16x16x32_bf16 v[68:71], a[36:39], a[0:3], v[68:71]
  ds_read_b64_tr_b16 a[44:45], v15 offset:8192
  ds_read_b64_tr_b16 a[46:47], v15 offset:9216
  s_waitcnt lgkmcnt(6)
  v_mfma_f32_16x16x32_bf16 v[72:75], a[32:35], a[4:7], v[72:75]
  ds_read_b128 a[16:19], v13 offset:0
  ds_read_b128 a[20:23], v13 offset:2048
  v_mfma_f32_16x16x32_bf16 v[76:79], a[36:39], a[4:7], v[76:79]
  ds_read_b128 a[24:27], v13 offset:4096
  s_waitcnt lgkmcnt(8)
  v_mfma_f32_16x16x32_bf16 v[80:83], a[32:35], a[8:11], v[80:83]
  ds_read_b128 a[28:31], v13 offset:6144
  v_mfma_f32_16x16x32_bf16 v[84:87], a[36:39], a[8:11], v[84:87]
  s_waitcnt lgkmcnt(8)
  v_mfma_f32_16x16x32_bf16 v[88:91], a[32:35], a[12:15], v[88:91]
  v_mfma_f32_16x16x32_bf16 v[92:95], a[36:39], a[12:15], v[92:95]
  s_waitcnt lgkmcnt(3)
  v_mfma_f32_16x16x32_bf16 v[64:67], a[40:43], a[16:19], v[64:67]
  v_mfma_f32_16x16x32_bf16 v[68:71], a[44:47], a[16:19], v[68:71]
  s_waitcnt lgkmcnt(0)
  s_waitcnt vmcnt(8)
  s_barrier
  ds_read_b64_tr_b16 a[32:33], v14 offset:16384
  ds_read_b64_tr_b16 a[34:35], v14 offset:17408
  v_mfma_f32_16x16x32_bf16 v[72:75], a[40:43], a[20:23], v[72:75]
  ds_read_b64_tr_b16 a[36:37], v15 offset:16384
  ds_read_b64_tr_b16 a[38:39], v15 offset:17408
  v_mfma_f32_16x16x32_bf16 v[76:79], a[44:47], a[20:23], v[76:79]
  ds_read_b128 a[0:3], v12 offset:16384
  ds_read_b128 a[4:7], v12 offset:18432
  v_mfma_f32_16x16x32_bf16 v[80:83], a[40:43], a[24:27], v[80:83]
  ds_read_b128 a[8:11], v12 offset:20480
  ds_read_b128 a[12:15], v12 offset:22528
  v_mfma_f32_16x16x32_bf16 v[84:87], a[44:47], a[24:27], v[84:87]
  v_mfma_f32_16x16x32_bf16 v[88:91], a[40:43], a[28:31], v[88:91]
  v_mfma_f32_16x16x32_bf16 v[92:95], a[44:47], a[28:31], v[92:95]
  s_waitcnt lgkmcnt(3)
  v_mfma_f32_16x16x32_bf16 v[64:67], a[32:35], a[0:3], v[64:67]
  ds_read_b64_tr_b16 a[40:41], v14 offset:24576
  ds_read_b64_tr_b16 a[42:43], v14 offset:25600
  v_mfma_f32_16x16x32_bf16 v[68:71], a[36:39], a[0:3], v[68:71]
  ds_read_b64_tr_b16 a[44:45], v15 offset:24576
  ds_read_b64_tr_b16 a[46:47], v15 offset:25600
  s_waitcnt lgkmcnt(6)
  v_mfma_f32_16x16x32_bf16 v[72:75], a[32:35], a[4:7], v[72:75]
  ds_read_b128 a[16:19], v13 offset:16384
  ds_read_b128 a[20:23], v13 offset:18432
  v_mfma_f32_16x16x32_bf16 v[76:79], a[36:39], a[4:7], v[76:79]
  ds_read_b128 a[24:27], v13 offset:20480
  s_waitcnt lgkmcnt(8)
  v_mfma_f32_16x16x32_bf16 v[80:83], a[32:35], a[8:11], v[80:83]
  ds_read_b128 a[28:31], v13 offset:22528
  v_mfma_f32_16x16x32_bf16 v[84:87], a[36:39], a[8:11], v[84:87]
  s_waitcnt lgkmcnt(8)
  v_mfma_f32_16x16x32_bf16 v[88:91], a[32:35], a[12:15], v[88:91]
  v_mfma_f32_16x16x32_bf16 v[92:95], a[36:39], a[12:15], v[92:95]
  s_waitcnt lgkmcnt(3)
  v_mfma_f32_16x16x32_bf16 v[64:67], a[40:43], a[16:19], v[64:67]
  v_mfma_f32_16x16x32_bf16 v[68:71], a[44:47], a[16:19], v[68:71]
  s_waitcnt lgkmcnt(0)
  s_waitcnt vmcnt(4)
  s_barrier
  ds_read_b64_tr_b16 a[32:33], v14 offset:32768
  ds_read_b64_tr_b16 a[34:35], v14 offset:33792
  v_mfma_f32_16x16x32_bf16 v[72:75], a[40:43], a[20:23], v[72:75]
  ds_read_b64_tr_b16 a[36:37], v15 offset:32768
  ds_read_b64_tr_b16 a[38:39], v15 offset:33792
  v_mfma_f32_16x16x32_bf16 v[76:79], a[44:47], a[20:23], v[76:79]
  ds_read_b128 a[0:3], v12 offset:32768
  ds_read_b128 a[4:7], v12 offset:34816
  v_mfma_f32_16x16x32_bf16 v[80:83], a[40:43], a[24:27], v[80:83]
  ds_read_b128 a[8:11], v12 offset:36864
  ds_read_b128 a[12:15], v12 offset:38912
  v_mfma_f32_16x16x32_bf16 v[84:87], a[44:47], a[24:27], v[84:87]
  v_mfma_f32_16x16x32_bf16 v[88:91], a[40:43], a[28:31], v[88:91]
  v_mfma_f32_16x16x32_bf16 v[92:95], a[44:47], a[28:31], v[92:95]
  s_waitcnt lgkmcnt(3)
  v_mfma_f32_16x16x32_bf16 v[64:67], a[32:35], a[0:3], v[64:67]
  ds_read_b64_tr_b16 a[40:41], v14 offset:40960
  ds_read_b64_tr_b16 a[42:43], v14 offset:41984
  v_mfma_f32_16x16x32_bf16 v[68:71], a[36:39], a[0:3], v[68:71]
  ds_read_b64_tr_b16 a[44:45], v15 offset:40960
  ds_read_b64_tr_b16 a[46:47], v15 offset:41984
  s_waitcnt lgkmcnt(6)
  v_mfma_f32_16x16x32_bf16 v[72:75], a[32:35], a[4:7], v[72:75]
  ds_read_b128 a[16:19], v13 offset:32768
  ds_read_b128 a[20:23], v13 offset:34816
  v_mfma_f32_16x16x32_bf16 v[76:79], a[36:39], a[4:7], v[76:79]
  ds_read_b128 a[24:27], v13 offset:36864
  s_waitcnt lgkmcnt(8)
  v_mfma_f32_16x16x32_bf16 v[80:83], a[32:35], a[8:11], v[80:83]
  ds_read_b128 a[28:31], v13 offset:38912
  v_mfma_f32_16x16x32_bf16 v[84:87], a[36:39], a[8:11], v[84:87]
  s_waitcnt lgkmcnt(8)
  v_mfma_f32_16x16x32_bf16 v[88:91], a[32:35], a[12:15], v[88:91]
  v_mfma_f32_16x16x32_bf16 v[92:95], a[36:39], a[12:15], v[92:95]
  s_waitcnt lgkmcnt(3)
  v_mfma_f32_16x16x32_bf16 v[64:67], a[40:43], a[16:19], v[64:67]
  v_mfma_f32_16x16x32_bf16 v[68:71], a[44:47], a[16:19], v[68:71]
  s_waitcnt lgkmcnt(0)
  s_waitcnt vmcnt(0)
  s_barrier
  ds_read_b64_tr_b16 a[32:33], v14 offset:49152
  ds_read_b64_tr_b16 a[34:35], v14 offset:50176
  v_mfma_f32_16x16x32_bf16 v[72:75], a[40:43], a[20:23], v[72:75]
  ds_read_b64_tr_b16 a[36:37], v15 offset:49152
  ds_read_b64_tr_b16 a[38:39], v15 offset:50176
  v_mfma_f32_16x16x32_bf16 v[76:79], a[44:47], a[20:23], v[76:79]
  ds_read_b128 a[0:3], v12 offset:49152
  ds_read_b128 a[4:7], v12 offset:51200
  v_mfma_f32_16x16x32_bf16 v[80:83], a[40:43], a[24:27], v[80:83]
  ds_read_b128 a[8:11], v12 offset:53248
  ds_read_b128 a[12:15], v12 offset:55296
  v_mfma_f32_16x16x32_bf16 v[84:87], a[44:47], a[24:27], v[84:87]
  v_mfma_f32_16x16x32_bf16 v[88:91], a[40:43], a[28:31], v[88:91]
  v_mfma_f32_16x16x32_bf16 v[92:95], a[44:47], a[28:31], v[92:95]
  s_waitcnt lgkmcnt(3)
  v_mfma_f32_16x16x32_bf16 v[64:67], a[32:35], a[0:3], v[64:67]
  ds_read_b64_tr_b16 a[40:41], v14 offset:57344
  ds_read_b64_tr_b16 a[42:43], v14 offset:58368
  v_mfma_f32_16x16x32_bf16 v[68:71], a[36:39], a[0:3], v[68:71]
  ds_read_b64_tr_b16 a[44:45], v15 offset:57344
  ds_read_b64_tr_b16 a[46:47], v15 offset:58368
  s_waitcnt lgkmcnt(6)
  v_mfma_f32_16x16x32_bf16 v[72:75], a[32:35], a[4:7], v[72:75]
  ds_read_b128 a[16:19], v13 offset:49152
  ds_read_b128 a[20:23], v13 offset:51200
  v_mfma_f32_16x16x32_bf16 v[76:79], a[36:39], a[4:7], v[76:79]
  ds_read_b128 a[24:27], v13 offset:53248
  s_waitcnt lgkmcnt(8)
  v_mfma_f32_16x16x32_bf16 v[80:83], a[32:35], a[8:11], v[80:83]
  ds_read_b128 a[28:31], v13 offset:55296
  v_mfma_f32_16x16x32_bf16 v[84:87], a[36:39], a[8:11], v[84:87]
  s_waitcnt lgkmcnt(8)
  v_mfma_f32_16x16x32_bf16 v[88:91], a[32:35], a[12:15], v[88:91]
  v_mfma_f32_16x16x32_bf16 v[92:95], a[36:39], a[12:15], v[92:95]
  s_waitcnt lgkmcnt(3)
  v_mfma_f32_16x16x32_bf16 v[64:67], a[40:43], a[16:19], v[64:67]
  v_mfma_f32_16x16x32_bf16 v[68:71], a[44:47], a[16:19], v[68:71]
  s_waitcnt lgkmcnt(2)
  v_mfma_f32_16x16x32_bf16 v[72:75], a[40:43], a[20:23], v[72:75]
  v_mfma_f32_16x16x32_bf16 v[76:79], a[44:47], a[20:23], v[76:79]
  s_waitcnt lgkmcnt(1)
  v_mfma_f32_16x16x32_bf16 v[80:83], a[40:43], a[24:27], v[80:83]
  v_mfma_f32_16x16x32_bf16 v[84:87], a[44:47], a[24:27], v[84:87]
  s_waitcnt lgkmcnt(0)
  v_mfma_f32_16x16x32_bf16 v[88:91], a[40:43], a[28:31], v[88:91]
  v_mfma_f32_16x16x32_bf16 v[92:95], a[44:47], a[28:31], v[92:95]
L_episel_60:
  s_nop 7
L_epi_plain_59:
  s_lshr_b32 s42, s28, 2
  s_and_b32 s43, s28, 3
  s_mul_i32 s45, s43, 1024
  s_add_u32 s45, s45, s37
  s_mul_i32 s44, s42, 4
  s_mul_i32 s44, s44, s38
  s_add_u32 s44, s44, s45
  v_cvt_pk_bf16_f32 v44, v64, v65
  v_cvt_pk_bf16_f32 v45, v66, v67
  v_cvt_pk_bf16_f32 v46, v68, v69
  v_cvt_pk_bf16_f32 v47, v70, v71
  buffer_store_dwordx4 v[44:47], v18, s[4:7], s44 offen offset:0 sc1
  s_add_u32 s44, s44, s38
  v_cvt_pk_bf16_f32 v48, v72, v73
  v_cvt_pk_bf16_f32 v49, v74, v75
  v_cvt_pk_bf16_f32 v50, v76, v77
  v_cvt_pk_bf16_f32 v51, v78, v79
  buffer_store_dwordx4 v[48:51], v18, s[4:7], s44 offen offset:0 sc1
  s_add_u32 s44, s44, s38
  v_cvt_pk_bf16_f32 v52, v80, v81
  v_cvt_pk_bf16_f32 v53, v82, v83
  v_cvt_pk_bf16_f32 v54, v84, v85
  v_cvt_pk_bf16_f32 v55, v86, v87
  buffer_store_dwordx4 v[52:55], v18, s[4:7], s44 offen offset:0 sc1
  s_add_u32 s44, s44, s38
  v_cvt_pk_bf16_f32 v56, v88, v89
  v_cvt_pk_bf16_f32 v57, v90, v91
  v_cvt_pk_bf16_f32 v58, v92, v93
  v_cvt_pk_bf16_f32 v59, v94, v95
  buffer_store_dwordx4 v[56:59], v18, s[4:7], s44 offen offset:0 sc1
  s_branch L_done
L_body_q128_rm_v:
  s_lshr_b32 s42, s28, 2
  s_and_b32 s43, s28, 3
  s_mul_i32 s40, s28, 2048
  s_mul_i32 s41, s28, 2048
  s_add_u32 s41, s41, 65536
  v_lshlrev_b32 v18, 4, v1
  s_mul_i32 s44, s42, 8192
  v_lshrrev_b32 v22, 4, v1
  v_and_b32 v23, 15, v1
  v_bfe_u32 v21, v1, 1, 3
  v_add_u32 v20, 0, v22
  v_xor_b32 v20, v20, v21
  v_lshlrev_b32 v20, 4, v20
  v_lshl_add_u32 v20, v23, 7, v20
  v_add_u32 v12, s44, v20
  v_add_u32 v20, 4, v22
  v_xor_b32 v20, v20, v21
  v_lshlrev_b32 v20, 4, v20
  v_lshl_add_u32 v20, v23, 7, v20
  v_add_u32 v13, s44, v20
  v_and_b32 v23, 7, v1
  v_lshrrev_b32 v21, 3, v1
  s_mul_i32 s44, s28, 2
  s_add_u32 s44, s44, 0
  s_and_b32 s45, s44, 1
  s_lshl_b32 s45, s45, 2
  v_or_b32 v20, s45, v22
  v_xor_b32 v20, v20, v23
  v_lshlrev_b32 v20, 4, v20
  v_lshl_add_u32 v20, v21, 11, v20
  s_lshl_b32 s44, s44, 14
  v_add_u32 v4, s44, v20
  s_mul_i32 s44, s28, 2
  s_add_u32 s44, s44, 1
  s_and_b32 s45, s44, 1
  s_lshl_b32 s45, s45, 2
  v_or_b32 v20, s45, v22
  v_xor_b32 v20, v20, v23
  v_lshlrev_b32 v20, 4, v20
  v_lshl_add_u32 v20, v21, 11, v20
  s_lshl_b32 s44, s44, 14
  s_sub_u32 s44, s44, 1024
  v_add_u32 v5, s44, v20
  v_lshrrev_b32 v23, 4, v1
  v_and_b32 v24, 15, v1
  s_mul_i32 s44, s28, 8
  s_add_u32 s44, s44, 0
  v_add_u32 v20, s44, v23
  v_and_b32 v21, 3, v20
  v_bfe_u32 v22, v20, 3, 1
  v_lshl_or_b32 v21, v22, 2, v21
  v_lshlrev_b32 v21, 1, v21
  v_xor_b32 v21, v21, v24
  v_mul_lo_u32 v20, v20, s39
  v_lshl_add_u32 v8, v21, 4, v20
  s_mul_i32 s44, s28, 8
  s_add_u32 s44, s44, 4
  v_add_u32 v20, s44, v23
  v_and_b32 v21, 3, v20
  v_bfe_u32 v22, v20, 3, 1
  v_lshl_or_b32 v21, v22, 2, v21
  v_lshlrev_b32 v21, 1, v21
  v_xor_b32 v21, v21, v24
  v_mul_lo_u32 v20, v20, s39
  v_lshl_add_u32 v9, v21, 4, v20
  v_subrev_u32 v9, 1024, v9
  v_bfe_u32 v20, v1, 2, 2
  v_lshrrev_b32 v21, 4, v1
  v_lshl_add_u32 v22, v21, 3, v20
  v_mul_u32_u24 v22, 256, v22
  v_and_b32 v23, 3, v1
  v_lshl_add_u32 v22, v23, 3, v22
  v_add_u32 v22, 65536, v22
  v_and_b32 v21, 1, v21
  v_lshl_or_b32 v20, v21, 2, v20
  s_mul_i32 s44, s43, 2
  s_add_u32 s44, s44, 0
  v_xor_b32 v21, s44, v20
  v_lshl_add_u32 v14, v21, 5, v22
  s_mul_i32 s44, s43, 2
  s_add_u32 s44, s44, 1
  v_xor_b32 v21, s44, v20
  v_lshl_add_u32 v15, v21, 5, v22
  s_add_u32 m0, s40, 0
  s_nop 0
  buffer_load_dwordx4 v4, s[8:11], s32 offen offset:0 lds
  buffer_load_dwordx4 v5, s[8:11], s32 offen offset:1024 lds
  s_add_u32 s32, s32, s33
  s_add_u32 m0, s41, 0
  s_nop 0
  buffer_load_dwordx4 v8, s[12:15], s34 offen offset:0 lds
  buffer_load_dwordx4 v9, s[12:15], s34 offen offset:1024 lds
  s_add_u32 s34, s34, s35
  s_add_u32 m0, s40, 16384
  s_nop 0
  buffer_load_dwordx4 v4, s[8:11], s32 offen offset:0 lds
  buffer_load_dwordx4 v5, s[8:11], s32 offen offset:1024 lds
  s_add_u32 s32, s32, s33
  s_add_u32 m0, s41, 16384
  s_nop 0
  buffer_load_dwordx4 v8, s[12:15], s34 offen offset:0 lds
  buffer_load_dwordx4 v9, s[12:15], s34 offen offset:1024 lds
  s_add_u32 s34, s34, s35
  s_add_u32 m0, s40, 32768
  s_nop 0
  buffer_load_dwordx4 v4, s[8:11], s32 offen offset:0 lds
  buffer_load_dwordx4 v5, s[8:11], s32 offen offset:1024 lds
  s_add_u32 s32, s32, s33
  s_add_u32 m0, s41, 32768
  s_nop 0
  buffer_load_dwordx4 v8, s[12:15], s34 offen offset:0 lds
  buffer_load_dwordx4 v9, s[12:15], s34 offen offset:1024 lds
  s_add_u32 s34, s34, s35
  s_add_u32 m0, s40, 49152
  s_nop 0
  buffer_load_dwordx4 v4, s[8:11], s32 offen offset:0 lds
  buffer_load_dwordx4 v5, s[8:11], s32 offen offset:1024 lds
  s_add_u32 s32, s32, s33
  s_add_u32 m0, s41, 49152
  s_nop 0
  buffer_load_dwordx4 v8, s[12:15], s34 offen offset:0 lds
  buffer_load_dwordx4 v9, s[12:15], s34 offen offset:1024 lds
  s_add_u32 s34, s34, s35
  v_mov_b32 v64, 0
  v_mov_b32 v65, 0
  v_mov_b32 v66, 0
  v_mov_b32 v67, 0
  v_mov_b32 v68, 0
  v_mov_b32 v69, 0
  v_mov_b32 v70, 0
  v_mov_b32 v71, 0
  v_mov_b32 v72, 0
  v_mov_b32 v73, 0
  v_mov_b32 v74, 0
  v_mov_b32 v75, 0
  v_mov_b32 v76, 0
  v_mov_b32 v77, 0
  v_mov_b32 v78, 0
  v_mov_b32 v79, 0
  v_mov_b32 v80, 0
  v_mov_b32 v81, 0
  v_mov_b32 v82, 0
  v_mov_b32 v83, 0
  v_mov_b32 v84, 0
  v_mov_b32 v85, 0
  v_mov_b32 v86, 0
  v_mov_b32 v87, 0
  v_mov_b32 v88, 0
  v_mov_b32 v89, 0
  v_mov_b32 v90, 0
  v_mov_b32 v91, 0
  v_mov_b32 v92, 0
  v_mov_b32 v93, 0
  v_mov_b32 v94, 0
  v_mov_b32 v95, 0
  s_waitcnt vmcnt(12)
  s_barrier
  ds_read_b64_tr_b16 a[32:33], v14 offset:0
  ds_read_b64_tr_b16 a[34:35], v14 offset:1024
  ds_read_b64_tr_b16 a[36:37], v15 offset:0
  ds_read_b64_tr_b16 a[38:39], v15 offset:1024
  ds_read_b128 a[0:3], v12 offset:0
  ds_read_b128 a[4:7], v12 offset:2048
  ds_read_b128 a[8:11], v12 offset:4096
  ds_read_b128 a[12:15], v12 offset:6144
  s_waitcnt lgkmcnt(0)
L_loop_q128_rm_v:
  s_waitcnt lgkmcnt(3)
  v_mfma_f32_16x16x32_bf16 v[64:67], a[0:3], a[32:35], v[64:67]
  ds_read_b64_tr_b16 a[40:41], v14 offset:8192
  ds_read_b64_tr_b16 a[42:43], v14 offset:9216
  v_mfma_f32_16x16x32_bf16 v[68:71], a[0:3], a[36:39], v[68:71]
  ds_read_b64_tr_b16 a[44:45], v15 offset:8192
  ds_read_b64_tr_b16 a[46:47], v15 offset:9216
  s_waitcnt lgkmcnt(6)
  v_mfma_f32_16x16x32_bf16 v[72:75], a[4:7], a[32:35], v[72:75]
  ds_read_b128 a[16:19], v13 offset:0
  ds_read_b128 a[20:23], v13 offset:2048
  v_mfma_f32_16x16x32_bf16 v[76:79], a[4:7], a[36:39], v[76:79]
  ds_read_b128 a[24:27], v13 offset:4096
  s_waitcnt lgkmcnt(8)
  v_mfma_f32_16x16x32_bf16 v[80:83], a[8:11], a[32:35], v[80:83]
  ds_read_b128 a[28:31], v13 offset:6144
  v_mfma_f32_16x16x32_bf16 v[84:87], a[8:11], a[36:39], v[84:87]
  s_waitcnt lgkmcnt(8)
  v_mfma_f32_16x16x32_bf16 v[88:91], a[12:15], a[32:35], v[88:91]
  v_mfma_f32_16x16x32_bf16 v[92:95], a[12:15], a[36:39], v[92:95]
  s_waitcnt lgkmcnt(3)
  v_mfma_f32_16x16x32_bf16 v[64:67], a[16:19], a[40:43], v[64:67]
  v_mfma_f32_16x16x32_bf16 v[68:71], a[16:19], a[44:47], v[68:71]
  s_waitcnt lgkmcnt(0)
  s_waitcnt vmcnt(8)
  s_barrier
  ds_read_b64_tr_b16 a[32:33], v14 offset:16384
  ds_read_b64_tr_b16 a[34:35], v14 offset:17408
  v_mfma_f32_16x16x32_bf16 v[72:75], a[20:23], a[40:43], v[72:75]
  ds_read_b64_tr_b16 a[36:37], v15 offset:16384
  ds_read_b64_tr_b16 a[38:39], v15 offset:17408
  v_mfma_f32_16x16x32_bf16 v[76:79], a[20:23], a[44:47], v[76:79]
  ds_read_b128 a[0:3], v12 offset:16384
  ds_read_b128 a[4:7], v12 offset:18432
  v_mfma_f32_16x16x32_bf16 v[80:83], a[24:27], a[40:43], v[80:83]
  ds_read_b128 a[8:11], v12 offset:20480
  ds_read_b128 a[12:15], v12 offset:22528
  v_mfma_f32_16x16x32_bf16 v[84:87], a[24:27], a[44:47], v[84:87]
  s_add_u32 m0, s40, 0
  v_mfma_f32_16x16x32_bf16 v[88:91], a[28:31], a[40:43], v[88:91]
  buffer_load_dwordx4 v4, s[8:11], s32 offen offset:0 lds
  v_mfma_f32_16x16x32_bf16 v[92:95], a[28:31], a[44:47], v[92:95]
  buffer_load_dwordx4 v5, s[8:11], s32 offen offset:1024 lds
  s_add_u32 s32, s32, s33
  s_add_u32 m0, s41, 0
  s_nop 0
  buffer_load_dwordx4 v8, s[12:15], s34 offen offset:0 lds
  buffer_load_dwordx4 v9, s[12:15], s34 offen offset:1024 lds
  s_add_u32 s34, s34, s35
  s_waitcnt lgkmcnt(3)
  v_mfma_f32_16x16x32_bf16 v[64:67], a[0:3], a[32:35], v[64:67]
  ds_read_b64_tr_b16 a[40:41], v14 offset:24576
  ds_read_b64_tr_b16 a[42:43], v14 offset:25600
  v_mfma_f32_16x16x32_bf16 v[68:71], a[0:3], a[36:39], v[68:71]
  ds_read_b64_tr_b16 a[44:45], v15 offset:24576
  ds_read_b64_tr_b16 a[46:47], v15 offset:25600
  s_waitcnt lgkmcnt(6)
  v_mfma_f32_16x16x32_bf16 v[72:75], a[4:7], a[32:35], v[72:75]
  ds_read_b128 a[16:19], v13 offset:16384
  ds_read_b128 a[20:23], v13 offset:18432
  v_mfma_f32_16x16x32_bf16 v[76:79], a[4:7], a[36:39], v[76:79]
  ds_read_b128 a[24:27], v13 offset:20480
  s_waitcnt lgkmcnt(8)
  v_mfma_f32_16x16x32_bf16 v[80:83], a[8:11], a[32:35], v[80:83]
  ds_read_b128 a[28:31], v13 offset:22528
  v_mfma_f32_16x16x32_bf16 v[84:87], a[8:11], a[36:39], v[84:87]
  s_waitcnt lgkmcnt(8)
  v_mfma_f32_16x16x32_bf16 v[88:91], a[12:15], a[32:35], v[88:91]
  v_mfma_f32_16x16x32_bf16 v[92:95], a[12:15], a[36:39], v[92:95]
  s_waitcnt lgkmcnt(3)
  v_mfma_f32_16x16x32_bf16 v[64:67], a[16:19], a[40:43], v[64:67]
  v_mfma_f32_16x16x32_bf16 v[68:71], a[16:19], a[44:47], v[68:71]
  s_waitcnt lgkmcnt(0)
  s_waitcnt vmcnt(8)
  s_barrier
  ds_read_b64_tr_b16 a[32:33], v14 offset:32768
  ds_read_b64_tr_b16 a[34:35], v14 offset:33792
  v_mfma_f32_16x16x32_bf16 v[72:75], a[20:23], a[40:43], v[72:75]
  ds_read_b64_tr_b16 a[36:37], v15 offset:32768
  ds_read_b64_tr_b16 a[38:39], v15 offset:33792
  v_mfma_f32_16x16x32_bf16 v[76:79], a[20:23], a[44:47], v[76:79]
  ds_read_b128 a[0:3], v12 offset:32768
  ds_read_b128 a[4:7], v12 offset:34816
  v_mfma_f32_16x16x32_bf16 v[80:83], a[24:27], a[40:43], v[80:83]
  ds_read_b128 a[8:11], v12 offset:36864
  ds_read_b128 a[12:15], v12 offset:38912
  v_mfma_f32_16x16x32_bf16 v[84:87], a[24:27], a[44:47], v[84:87]
  s_add_u32 m0, s40, 16384
  v_mfma_f32_16x16x32_bf16 v[88:91], a[28:31], a[40:43], v[88:91]
  buffer_load_dwordx4 v4, s[8:11], s32 offen offset:0 lds
  v_mfma_f32_16x16x32_bf16 v[92:95], a[28:31], a[44:47], v[92:95]
  buffer_load_dwordx4 v5, s[8:11], s32 offen offset:1024 lds
  s_add_u32 s32, s32, s33
  s_add_u32 m0, s41, 16384
  s_nop 0
  buffer_load_dwordx4 v8, s[12:15], s34 offen offset:0 lds
  buffer_load_dwordx4 v9, s[12:15], s34 offen offset:1024 lds
  s_add_u32 s34, s34, s35
  s_waitcnt lgkmcnt(3)
  v_mfma_f32_16x16x32_bf16 v[64:67], a[0:3], a[32:35], v[64:67]
  ds_read_b64_tr_b16 a[40:41], v14 offset:40960
  ds_read_b64_tr_b16 a[42:43], v14 offset:41984
  v_mfma_f32_16x16x32_bf16 v[68:71], a[0:3], a[36:39], v[68:71]
  ds_read_b64_tr_b16 a[44:45], v15 offset:40960
  ds_read_b64_tr_b16 a[46:47], v15 offset:41984
  s_waitcnt lgkmcnt(6)
  v_mfma_f32_16x16x32_bf16 v[72:75], a[4:7], a[32:35], v[72:75]
  ds_read_b128 a[16:19], v13 offset:32768
  ds_read_b128 a[20:23], v13 offset:34816
  v_mfma_f32_16x16x32_bf16 v[76:79], a[4:7], a[36:39], v[76:79]
  ds_read_b128 a[24:27], v13 offset:36864
  s_waitcnt lgkmcnt(8)
  v_mfma_f32_16x16x32_bf16 v[80:83], a[8:11], a[32:35], v[80:83]
  ds_read_b128 a[28:31], v13 offset:38912
  v_mfma_f32_16x16x32_bf16 v[84:87], a[8:11], a[36:39], v[84:87]
  s_waitcnt lgkmcnt(8)
  v_mfma_f32_16x16x32_bf16 v[88:91], a[12:15], a[32:35], v[88:91]
  v_mfma_f32_16x16x32_bf16 v[92:95], a[12:15], a[36:39], v[92:95]
  s_waitcnt lgkmcnt(3)
  v_mfma_f32_16x16x32_bf16 v[64:67], a[16:19], a[40:43], v[64:67]
  v_mfma_f32_16x16x32_bf16 v[68:71], a[16:19], a[44:47], v[68:71]
  s_waitcnt lgkmcnt(0)
  s_waitcnt vmcnt(8)
  s_barrier
  ds_read_b64_tr_b16 a[32:33], v14 offset:49152
  ds_read_b64_tr_b16 a[34:35], v14 offset:50176
  v_mfma_f32_16x16x32_bf16 v[72:75], a[20:23], a[40:43], v[72:75]
  ds_read_b64_tr_b16 a[36:37], v15 offset:49152
  ds_read_b64_tr_b16 a[38:39], v15 offset:50176
  v_mfma_f32_16x16x32_bf16 v[76:79], a[20:23], a[44:47], v[76:79]
  ds_read_b128 a[0:3], v12 offset:49152
  ds_read_b128 a[4:7], v12 offset:51200
  v_mfma_f32_16x16x32_bf16 v[80:83], a[24:27], a[40:43], v[80:83]
  ds_read_b128 a[8:11], v12 offset:53248
  ds_read_b128 a[12:15], v12 offset:55296
  v_mfma_f32_16x16x32_bf16 v[84:87], a[24:27], a[44:47], v[84:87]
  s_add_u32 m0, s40, 32768
  v_mfma_f32_16x16x32_bf16 v[88:91], a[28:31], a[40:43], v[88:91]
  buffer_load_dwordx4 v4, s[8:11], s32 offen offset:0 lds
  v_mfma_f32_16x16x32_bf16 v[92:95], a[28:31], a[44:47], v[92:95]
  buffer_load_dwordx4 v5, s[8:11], s32 offen offset:1024 lds
  s_add_u32 s32, s32, s33
  s_add_u32 m0, s41, 32768
  s_nop 0
  buffer_load_dwordx4 v8, s[12:15], s34 offen offset:0 lds
  buffer_load_dwordx4 v9, s[12:15], s34 offen offset:1024 lds
  s_add_u32 s34, s34, s35
  s_waitcnt lgkmcnt(3)
  v_mfma_f32_16x16x32_bf16 v[64:67], a[0:3], a[32:35], v[64:67]
  ds_read_b64_tr_b16 a[40:41], v14 offset:57344
  ds_read_b64_tr_b16 a[42:43], v14 offset:58368
  v_mfma_f32_16x16x32_bf16 v[68:71], a[0:3], a[36:39], v[68:71]
  ds_read_b64_tr_b16 a[44:45], v15 offset:57344
  ds_read_b64_tr_b16 a[46:47], v15 offset:58368
  s_waitcnt lgkmcnt(6)
  v_mfma_f32_16x16x32_bf16 v[72:75], a[4:7], a[32:35], v[72:75]
  ds_read_b128 a[16:19], v13 offset:49152
  ds_read_b128 a[20:23], v13 offset:51200
  v_mfma_f32_16x16x32_bf16 v[76:79], a[4:7], a[36:39], v[76:79]
  ds_read_b128 a[24:27], v13 offset:53248
  s_waitcnt lgkmcnt(8)
  v_mfma_f32_16x16x32_bf16 v[80:83], a[8:11], a[32:35], v[80:83]
  ds_read_b128 a[28:31], v13 offset:55296
  v_mfma_f32_16x16x32_bf16 v[84:87], a[8:11], a[36:39], v[84:87]
  s_waitcnt lgkmcnt(8)
  v_mfma_f32_16x16x32_bf16 v[88:91], a[12:15], a[32:35], v[88:91]
  v_mfma_f32_16x16x32_bf16 v[92:95], a[12:15], a[36:39], v[92:95]
  s_waitcnt lgkmcnt(3)
  v_mfma_f32_16x16x32_bf16 v[64:67], a[16:19], a[40:43], v[64:67]
  v_mfma_f32_16x16x32_bf16 v[68:71], a[16:19], a[44:47], v[68:71]
  s_waitcnt lgkmcnt(0)
  s_waitcnt vmcnt(8)
  s_barrier
  ds_read_b64_tr_b16 a[32:33], v14 offset:0
  ds_read_b64_tr_b16 a[34:35], v14 offset:1024
  v_mfma_f32_16x16x32_bf16 v[72:75], a[20:23], a[40:43], v[72:75]
  ds_read_b64_tr_b16 a[36:37], v15 offset:0
  ds_read_b64_tr_b16 a[38:39], v15 offset:1024
  v_mfma_f32_16x16x32_bf16 v[76:79], a[20:23], a[44:47], v[76:79]
  ds_read_b128 a[0:3], v12 offset:0
  ds_read_b128 a[4:7], v12 offset:2048
  v_mfma_f32_16x16x32_bf16 v[80:83], a[24:27], a[40:43], v[80:83]
  ds_read_b128 a[8:11], v12 offset:4096
  ds_read_b128 a[12:15], v12 offset:6144
  v_mfma_f32_16x16x32_bf16 v[84:87], a[24:27], a[44:47], v[84:87]
  s_add_u32 m0, s40, 49152
  v_mfma_f32_16x16x32_bf16 v[88:91], a[28:31], a[40:43], v[88:91]
  buffer_load_dwordx4 v4, s[8:11], s32 offen offset:0 lds
  v_mfma_f32_16x16x32_bf16 v[92:95], a[28:31], a[44:47], v[92:95]
  buffer_load_dwordx4 v5, s[8:11], s32 offen offset:1024 lds
  s_add_u32 s32, s32, s33
  s_add_u32 m0, s41, 49152
  s_nop 0
  buffer_load_dwordx4 v8, s[12:15], s34 offen offset:0 lds
  buffer_load_dwordx4 v9, s[12:15], s34 offen offset:1024 lds
  s_add_u32 s34, s34, s35
  s_sub_u32 s36, s36, 1
  s_cmp_lg_u32 s36, 0
  s_cbranch_scc1 L_loop_q128_rm_v
  s_waitcnt lgkmcnt(3)
  v_mfma_f32_16x16x32_bf16 v[64:67], a[0:3], a[32:35], v[64:67]
  ds_read_b64_tr_b16 a[40:41], v14 offset:8192
  ds_read_b64_tr_b16 a[42:43], v14 offset:9216
  v_mfma_f32_16x16x32_bf16 v[68:71], a[0:3], a[36:39], v[68:71]
  ds_read_b64_tr_b16 a[44:45], v15 offset:8192
  ds_read_b64_tr_b16 a[46:47], v15 offset:9216
  s_waitcnt lgkmcnt(6)
  v_mfma_f32_16x16x32_bf16 v[72:75], a[4:7], a[32:35], v[72:75]
  ds_read_b128 a[16:19], v13 offset:0
  ds_read_b128 a[20:23], v13 offset:2048
  v_mfma_f32_16x16x32_bf16 v[76:79], a[4:7], a[36:39], v[76:79]
  ds_read_b128 a[24:27], v13 offset:4096
  s_waitcnt lgkmcnt(8)
  v_mfma_f32_16x16x32_bf16 v[80:83], a[8:11], a[32:35], v[80:83]
  ds_read_b128 a[28:31], v13 offset:6144
  v_mfma_f32_16x16x32_bf16 v[84:87], a[8:11], a[36:39], v[84:87]
  s_waitcnt lgkmcnt(8)
  v_mfma_f32_16x16x32_bf16 v[88:91], a[12:15], a[32:35], v[88:91]
  v_mfma_f32_16x16x32_bf16 v[92:95], a[12:15], a[36:39], v[92:95]
  s_waitcnt lgkmcnt(3)
  v_mfma_f32_16x16x32_bf16 v[64:67], a[16:19], a[40:43], v[64:67]
  v_mfma_f32_16x16x32_bf16 v[68:71], a[16:19], a[44:47], v[68:71]
  s_waitcnt lgkmcnt(0)
  s_waitcnt vmcnt(8)
  s_barrier
  ds_read_b64_tr_b16 a[32:33], v14 offset:16384
  ds_read_b64_tr_b16 a[34:35], v14 offset:17408
  v_mfma_f32_16x16x32_bf16 v[72:75], a[20:23], a[40:43], v[72:75]
  ds_read_b64_tr_b16 a[36:37], v15 offset:16384
  ds_read_b64_tr_b16 a[38:39], v15 offset:17408
  v_mfma_f32_16x16x32_bf16 v[76:79], a[20:23], a[44:47], v[76:79]
  ds_read_b128 a[0:3], v12 offset:16384
  ds_read_b128 a[4:7], v12 offset:18432
  v_mfma_f32_16x16x32_bf16 v[80:83], a[24:27], a[40:43], v[80:83]
  ds_read_b128 a[8:11], v12 offset:20480
  ds_read_b128 a[12:15], v12 offset:22528
  v_mfma_f32_16x16x32_bf16 v[84:87], a[24:27], a[44:47], v[84:87]
  v_mfma_f32_16x16x32_bf16 v[88:91], a[28:31], a[40:43], v[88:91]
  v_mfma_f32_16x16x32_bf16 v[92:95], a[28:31], a[44:47], v[92:95]
  s_waitcnt lgkmcnt(3)
  v_mfma_f32_16x16x32_bf16 v[64:67], a[0:3], a[32:35], v[64:67]
  ds_read_b64_tr_b16 a[40:41], v14 offset:24576
  ds_read_b64_tr_b16 a[42:43], v14 offset:25600
  v_mfma_f32_16x16x32_bf16 v[68:71], a[0:3], a[36:39], v[68:71]
  ds_read_b64_tr_b16 a[44:45], v15 offset:24576
  ds_read_b64_tr_b16 a[46:47], v15 offset:25600
  s_waitcnt lgkmcnt(6)
  v_mfma_f32_16x16x32_bf16 v[72:75], a[4:7], a[32:35], v[72:75]
  ds_read_b128 a[16:19], v13 offset:16384
  ds_read_b128 a[20:23], v13 offset:18432
  v_mfma_f32_16x16x32_bf16 v[76:79], a[4:7], a[36:39], v[76:79]
  ds_read_b128 a[24:27], v13 offset:20480
  s_waitcnt lgkmcnt(8)
  v_mfma_f32_16x16x32_bf16 v[80:83], a[8:11], a[32:35], v[80:83]
  ds_read_b128 a[28:31], v13 offset:22528
  v_mfma_f32_16x16x32_bf16 v[84:87], a[8:11], a[36:39], v[84:87]
  s_waitcnt lgkmcnt(8)
  v_mfma_f32_16x16x32_bf16 v[88:91], a[12:15], a[32:35], v[88:91]
  v_mfma_f32_16x16x32_bf16 v[92:95], a[12:15], a[36:39], v[92:95]
  s_waitcnt lgkmcnt(3)
  v_mfma_f32_16x16x32_bf16 v[64:67], a[16:19], a[40:43], v[64:67]
  v_mfma_f32_16x16x32_bf16 v[68:71], a[16:19], a[44:47], v[68:71]
  s_waitcnt lgkmcnt(0)
  s_waitcnt vmcnt(4)
  s_barrier
  ds_read_b64_tr_b16 a[32:33], v14 offset:32768
  ds_read_b64_tr_b16 a[34:35], v14 offset:33792
  v_mfma_f32_16x16x32_bf16 v[72:75], a[20:23], a[40:43], v[72:75]
  ds_read_b64_tr_b16 a[36:37], v15 offset:32768
  ds_read_b64_tr_b16 a[38:39], v15 offset:33792
  v_mfma_f32_16x16x32_bf16 v[76:79], a[20:23], a[44:47], v[76:79]
  ds_read_b128 a[0:3], v12 offset:32768
  ds_read_b128 a[4:7], v12 offset:34816
  v_mfma_f32_16x16x32_bf16 v[80:83], a[24:27], a[40:43], v[80:83]
  ds_read_b128 a[8:11], v12 offset:36864
  ds_read_b128 a[12:15], v12 offset:38912
  v_mfma_f32_16x16x32_bf16 v[84:87], a[24:27], a[44:47], v[84:87]
  v_mfma_f32_16x16x32_bf16 v[88:91], a[28:31], a[40:43], v[88:91]
  v_mfma_f32_16x16x32_bf16 v[92:95], a[28:31], a[44:47], v[92:95]
  s_waitcnt lgkmcnt(3)
  v_mfma_f32_16x16x32_bf16 v[64:67], a[0:3], a[32:35], v[64:67]
  ds_read_b64_tr_b16 a[40:41], v14 offset:40960
  ds_read_b64_tr_b16 a[42:43], v14 offset:41984
  v_mfma_f32_16x16x32_bf16 v[68:71], a[0:3], a[36:39], v[68:71]
  ds_read_b64_tr_b16 a[44:45], v15 offset:40960
  ds_read_b64_tr_b16 a[46:47], v15 offset:41984
  s_waitcnt lgkmcnt(6)
  v_mfma_f32_16x16x32_bf16 v[72:75], a[4:7], a[32:35], v[72:75]
  ds_read_b128 a[16:19], v13 offset:32768
  ds_read_b128 a[20:23], v13 offset:34816
  v_mfma_f32_16x16x32_bf16 v[76:79], a[4:7], a[36:39], v[76:79]
  ds_read_b128 a[24:27], v13 offset:36864
  s_waitcnt lgkmcnt(8)
  v_mfma_f32_16x16x32_bf16 v[80:83], a[8:11], a[32:35], v[80:83]
  ds_read_b128 a[28:31], v13 offset:38912
  v_mfma_f32_16x16x32_bf16 v[84:87], a[8:11], a[36:39], v[84:87]
  s_waitcnt lgkmcnt(8)
  v_mfma_f32_16x16x32_bf16 v[88:91], a[12:15], a[32:35], v[88:91]
  v_mfma_f32_16x16x32_bf16 v[92:95], a[12:15], a[36:39], v[92:95]
  s_waitcnt lgkmcnt(3)
  v_mfma_f32_16x16x32_bf16 v[64:67], a[16:19], a[40:43], v[64:67]
  v_mfma_f32_16x16x32_bf16 v[68:71], a[16:19], a[44:47], v[68:71]
  s_waitcnt lgkmcnt(0)
  s_waitcnt vmcnt(0)
  s_barrier
  ds_read_b64_tr_b16 a[32:33], v14 offset:49152
  ds_read_b64_tr_b16 a[34:35], v14 offset:50176
  v_mfma_f32_16x16x32_bf16 v[72:75], a[20:23], a[40:43], v[72:75]
  ds_read_b64_tr_b16 a[36:37], v15 offset:49152
  ds_read_b64_tr_b16 a[38:39], v15 offset:50176
  v_mfma_f32_16x16x32_bf16 v[76:79], a[20:23], a[44:47], v[76:79]
  ds_read_b128 a[0:3], v12 offset:49152
  ds_read_b128 a[4:7], v12 offset:51200
  v_mfma_f32_16x16x32_bf16 v[80:83], a[24:27], a[40:43], v[80:83]
  ds_read_b128 a[8:11], v12 offset:53248
  ds_read_b128 a[12:15], v12 offset:55296
  v_mfma_f32_16x16x32_bf16 v[84:87], a[24:27], a[44:47], v[84:87]
  v_mfma_f32_16x16x32_bf16 v[88:91], a[28:31], a[40:43], v[88:91]
  v_mfma_f32_16x16x32_bf16 v[92:95], a[28:31], a[44:47], v[92:95]
  s_waitcnt lgkmcnt(3)
  v_mfma_f32_16x16x32_bf16 v[64:67], a[0:3], a[32:35], v[64:67]
  ds_read_b64_tr_b16 a[40:41], v14 offset:57344
  ds_read_b64_tr_b16 a[42:43], v14 offset:58368
  v_mfma_f32_16x16x32_bf16 v[68:71], a[0:3], a[36:39], v[68:71]
  ds_read_b64_tr_b16 a[44:45], v15 offset:57344
  ds_read_b64_tr_b16 a[46:47], v15 offset:58368
  s_waitcnt lgkmcnt(6)
  v_mfma_f32_16x16x32_bf16 v[72:75], a[4:7], a[32:35], v[72:75]
  ds_read_b128 a[16:19], v13 offset:49152
  ds_read_b128 a[20:23], v13 offset:51200
  v_mfma_f32_16x16x32_bf16 v[76:79], a[4:7], a[36:39], v[76:79]
  ds_read_b128 a[24:27], v13 offset:53248
  s_waitcnt lgkmcnt(8)
  v_mfma_f32_16x16x32_bf16 v[80:83], a[8:11], a[32:35], v[80:83]
  ds_read_b128 a[28:31], v13 offset:55296
  v_mfma_f32_16x16x32_bf16 v[84:87], a[8:11], a[36:39], v[84:87]
  s_waitcnt lgkmcnt(8)
  v_mfma_f32_16x16x32_bf16 v[88:91], a[12:15], a[32:35], v[88:91]
  v_mfma_f32_16x16x32_bf16 v[92:95], a[12:15], a[36:39], v[92:95]
  s_waitcnt lgkmcnt(3)
  v_mfma_f32_16x16x32_bf16 v[64:67], a[16:19], a[40:43], v[64:67]
  v_mfma_f32_16x16x32_bf16 v[68:71], a[16:19], a[44:47], v[68:71]
  s_waitcnt lgkmcnt(2)
  v_mfma_f32_16x16x32_bf16 v[72:75], a[20:23], a[40:43], v[72:75]
  v_mfma_f32_16x16x32_bf16 v[76:79], a[20:23], a[44:47], v[76:79]
  s_waitcnt lgkmcnt(1)
  v_mfma_f32_16x16x32_bf16 v[80:83], a[24:27], a[40:43], v[80:83]
  v_mfma_f32_16x16x32_bf16 v[84:87], a[24:27], a[44:47], v[84:87]
  s_waitcnt lgkmcnt(0)
  v_mfma_f32_16x16x32_bf16 v[88:91], a[28:31], a[40:43], v[88:91]
  v_mfma_f32_16x16x32_bf16 v[92:95], a[28:31], a[44:47], v[92:95]
L_episel_62:
  s_nop 7
L_epi_plain_61:
  s_lshr_b32 s42, s28, 2
  s_and_b32 s43, s28, 3
  s_mul_i32 s45, s43, 2048
  s_add_u32 s45, s45, s37
  s_mul_i32 s44, s42, 2
  s_mul_i32 s44, s44, s38
  s_add_u32 s44, s44, s45
  v_cvt_pk_bf16_f32 v44, v64, v65
  v_cvt_pk_bf16_f32 v45, v66, v67
  v_cvt_pk_bf16_f32 v46, v72, v73
  v_cvt_pk_bf16_f32 v47, v74, v75
  buffer_store_dwordx4 v[44:47], v18, s[4:7], s44 offen offset:0 sc1
  v_cvt_pk_bf16_f32 v48, v68, v69
  v_cvt_pk_bf16_f32 v49, v70, v71
  v_cvt_pk_bf16_f32 v50, v76, v77
  v_cvt_pk_bf16_f32 v51, v78, v79
  buffer_store_dwordx4 v[48:51], v18, s[4:7], s44 offen offset:1024 sc1
  s_add_u32 s44, s44, s38
  v_cvt_pk_bf16_f32 v52, v80, v81
  v_cvt_pk_bf16_f32 v53, v82, v83
  v_cvt_pk_bf16_f32 v54, v88, v89
  v_cvt_pk_bf16_f32 v55, v90, v91
  buffer_store_dwordx4 v[52:55], v18, s[4:7], s44 offen offset:0 sc1
  v_cvt_pk_bf16_f32 v56, v84, v85
  v_cvt_pk_bf16_f32 v57, v86, v87
  v_cvt_pk_bf16_f32 v58, v92, v93
  v_cvt_pk_bf16_f32 v59, v94, v95
  buffer_store_dwordx4 v[56:59], v18, s[4:7], s44 offen offset:1024 sc1
  s_branch L_done
L_chained:
  s_cmp_eq_u32 s29, 0
  s_cbranch_scc1 L_done
  s_mov_b32 s27, s79
  s_mov_b32 s72, s88
  s_mov_b32 s73, s89
  s_mov_b32 s74, s90
  s_mov_b32 s75, s91
  s_mov_b32 s76, s92
  s_mov_b32 s77, s93
  s_mov_b32 s78, s94
  s_mov_b32 s79, s95
  s_add_u32 s82, s82, 1
  s_lshl_b32 s42, s82, 5
  s_add_u32 s42, s42, 32
  s_load_dwordx8 s[88:95], s[70:71], s42
  s_mov_b32 s37, s30
  s_mov_b32 s38, s31
  s_mov_b32 s36, 7
  s_mov_b32 s29, 0
  s_waitcnt lgkmcnt(0)
  s_cmp_eq_u32 s72, 2
  s_cbranch_scc1 L_head_big_fn_v
  s_branch L_head_big_fn_kq
L_done:
  s_or_b32 s42, s87, s28
  s_cmp_lg_u32 s42, 0
  s_cbranch_scc1 L_done_65
  v_mov_b32 v2, 40
  buffer_load_dword v8, v2, s[20:23], 0 offen sc1
L_done_65:
  s_waitcnt vmcnt(0)
  s_barrier
  s_cmp_lg_u32 s87, 0
  s_cbranch_scc1 L_known_63
  s_cmp_lg_u32 s28, 0
  s_cbranch_scc1 L_mode_64
  v_readfirstlane_b32 s87, v8
  s_nop 3
  s_cmp_lg_u32 s87, 0
  s_cbranch_scc1 L_got_66
  v_lshlrev_b32 v4, 2, v1
  s_mov_b32 s42, 0
L_rm_67:
  buffer_load_dword v5, v4, s[20:23], 0 offen sc1
  s_waitcnt vmcnt(0)
  v_readlane_b32 s87, v5, 10
  v_readlane_b32 s43, v5, 8
  v_cmp_eq_u32 vcc, 32, v5
  s_nop 2
  s_cmp_lg_u32 s87, 0
  s_cbranch_scc1 L_rmdone_69
  s_cmp_lt_u32 s43, 256
  s_cbranch_scc1 L_rmnc_70
  s_and_b32 vcc_lo, vcc_lo, 0x30003
  s_and_b32 vcc_hi, vcc_hi, 0x30003
  s_and_b32 vcc_lo, vcc_lo, vcc_hi
  s_cmp_eq_u32 vcc_lo, 0x30003
  s_cselect_b32 s43, 1, 2
  s_branch L_rmcas_68
L_rmnc_70:
  s_sleep 2
  s_add_u32 s42, s42, 1
  s_cmp_lt_u32 s42, 2048
  s_cbranch_scc1 L_rm_67
  s_mov_b32 s43, 2
L_rmcas_68:
  v_mov_b32 v6, s43
  v_mov_b32 v7, 0
  v_mov_b32 v4, 40
  v_mov_b32 v5, 0x80000000
  v_cmp_eq_u32 vcc, 0, v1
  s_nop 1
  v_cndmask_b32 v4, v5, v4, vcc
  buffer_atomic_cmpswap v[6:7], v4, s[20:23], 0 offen sc0
  s_waitcnt vmcnt(0)
  v_readfirstlane_b32 s87, v6
  s_nop 3
  s_cmp_eq_u32 s87, 0
  s_cselect_b32 s87, s43, s87
L_rmdone_69:
L_got_66:
  s_cmp_lg_u32 s87, 1
  s_cbranch_scc1 L_early_71
  s_lshr_b32 s42, s79, 8
  s_lshl_b32 s42, s42, 7
  s_add_u32 s42, s42, 0x5c14000
  s_add_u32 s42, s42, s59
  s_and_b32 s43, s79, 0xff
  v_mov_b32 v2, s42
  v_mov_b32 v3, s43
  v_mov_b32 v20, 0x80000000
  v_cmp_eq_u32 vcc, 0, v1
  s_nop 1
  v_cndmask_b32 v2, v20, v2, vcc
  buffer_atomic_add v3, v2, s[4:7], 0 offen
  s_mov_b32 s79, 0
L_early_71:
  v_mov_b32 v4, s87
  v_mov_b32 v2, 17408
  ds_write_b32 v2, v4
  s_waitcnt lgkmcnt(0)
L_mode_64:
  s_barrier
  v_mov_b32 v2, 17408
  ds_read_b32 v4, v2
  s_waitcnt lgkmcnt(0)
  v_readfirstlane_b32 s87, v4
  s_nop 3
  s_cmp_eq_u32 s87, 2
  s_cbranch_scc1 L_slow
L_known_63:
  s_cmp_lg_u32 s28, 0
  s_cbranch_scc1 L_nosig_72
  s_cmp_eq_u32 s79, 0
  s_cbranch_scc1 L_nosig_72
  s_lshr_b32 s42, s79, 8
  s_lshl_b32 s42, s42, 7
  s_add_u32 s42, s42, 0x5c14000
  s_add_u32 s42, s42, s59
  s_and_b32 s43, s79, 0xff
  v_mov_b32 v2, s42
  v_mov_b32 v3, s43
  v_mov_b32 v20, 0x80000000
  v_cmp_eq_u32 vcc, 0, v1
  s_nop 1
  v_cndmask_b32 v2, v20, v2, vcc
  buffer_atomic_add v3, v2, s[4:7], 0 offen
L_nosig_72:
  s_add_u32 s82, s82, 1
  s_cmp_eq_u32 s58, 0
  s_cbranch_scc1 L_task
L_dyn:
  s_cmp_lg_u32 s58, 0
  s_cbranch_scc1 L_dq_73
  s_add_u32 s58, s73, 1
L_dq_73:
  s_lshr_b32 s43, s25, 5
  s_and_b32 s43, s43, 3
  s_cmp_eq_u32 s58, 2
  s_cselect_b32 s42, 5, 0
  s_add_u32 s43, s43, s42
  s_cmp_lg_u32 s59, 0
  s_cselect_b32 s43, 4, s43
  s_cmp_lg_u32 s28, 0
  s_cbranch_scc1 L_dyn_74
  s_lshl_b32 s42, s43, 2
  s_add_u32 s42, s42, 80
  v_mov_b32 v2, s42
  v_mov_b32 v3, 1
  v_mov_b32 v4, 0x80000000
  v_cmp_eq_u32 vcc, 0, v1
  s_nop 1
  v_cndmask_b32 v2, v4, v2, vcc
  buffer_atomic_add v3, v2, s[20:23], 0 offen sc0
  s_waitcnt vmcnt(0)
  v_readfirstlane_b32 s42, v3
  s_nop 1
  v_mov_b32 v3, s42
  v_mov_b32 v2, 17408
  ds_write_b32 v2, v3
  s_waitcnt lgkmcnt(0)
L_dyn_74:
  s_barrier
  v_mov_b32 v2, 17408
  ds_read_b32 v3, v2
  s_lshl_b32 s43, s43, 3
  s_add_u32 s43, s43, 1024
  s_load_dwordx2 s[46:47], s[68:69], s43
  s_waitcnt lgkmcnt(0)
  v_readfirstlane_b32 s42, v3
  s_nop 3
  s_cmp_lt_u32 s42, s47
  s_cbranch_scc1 L_have_75
  s_cmp_lg_u32 s58, 2
  s_cbranch_scc1 L_end
  s_mov_b32 s58, 1
  s_barrier
  s_branch L_dq_73
L_have_75:
  s_lshl_b32 s42, s42, 5
  s_add_u32 s42, s42, s46
  s_load_dwordx8 s[72:79], s[68:69], s42
  s_waitcnt lgkmcnt(0)
  s_branch L_run
L_exec_t:
  s_branch L_exec
L_abort:
  v_mov_b32 v1, 1
  v_mov_b32 v2, 124
  buffer_atomic_add v1, v2, s[20:23], 0 offen
L_end:
  s_endpgm
L_rec:
  s_load_dwordx4 s[44:47], s[0:1], 8
  s_load_dwordx4 s[48:51], s[0:1], 24
  s_load_dwordx2 s[54:55], s[0:1], 40
  s_waitcnt lgkmcnt(0)
  s_mov_b32 s52, s44
  s_mov_b32 s53, s45
  s_lshl_b32 s26, s24, 3
  s_lshr_b32 s39, s25, 2
  s_add_u32 s26, s26, s39
  s_and_b32 s27, s25, 3
  s_mov_b32 s29, 0
  s_mov_b32 s31, 0
  s_add_u32 s39, s4, 0x61fffff
  s_and_b32 s39, s39, 0xffe00000
  s_sub_u32 s36, s39, s4
  v_and_b32 v1, 63, v0
  v_and_b32 v2, 15, v1
  v_lshrrev_b32 v3, 4, v1
  s_cmp_lt_u32 s28, 4
  s_cbranch_scc1 L_ws1_80
  s_cmp_eq_u32 s28, 7
  s_cbranch_scc1 L_w7_79
  s_mov_b32 s8, s54
  s_mov_b32 s9, s55
  s_mov_b32 s10, 0x800000
  s_mov_b32 s11, 0x20000
  s_lshl_b32 s39, s24, 21
  s_sub_u32 s41, s28, 4
  s_mul_i32 s40, s41, 16384
  s_add_u32 s40, s40, 92160
  s_lshl_b32 s41, s41, 19
  s_add_u32 s39, s39, s41
  s_lshl_b32 s41, s25, 6
  s_add_u32 s39, s39, s41
  v_lshrrev_b32 v4, 2, v1
  v_mul_u32_u24 v4, 2048, v4
  v_and_b32 v6, 3, v1
  v_lshl_add_u32 v4, v6, 4, v4
  v_add_u32 v4, s39, v4
  v_lshrrev_b32 v6, 1, v3
  v_and_b32 v7, 1, v3
  v_lshlrev_b32 v6, 3, v6
  v_lshl_add_u32 v6, v7, 4, v6
  v_lshrrev_b32 v7, 2, v2
  v_add_u32 v6, v6, v7
  v_and_b32 v7, 3, v2
  v_lshlrev_b32 v7, 3, v7
  v_lshl_add_u32 v5, v6, 6, v7
  v_add_u32 v5, s40, v5
  s_add_u32 m0, s40, 0
  s_mov_b32 s39, 0x0
  buffer_load_dwordx4 v4, s[8:11], s39 offen lds
  s_add_u32 m0, s40, 1024
  s_mov_b32 s39, 0x8000
  buffer_load_dwordx4 v4, s[8:11], s39 offen lds
  s_add_u32 m0, s40, 2048
  s_mov_b32 s39, 0x10000
  buffer_load_dwordx4 v4, s[8:11], s39 offen lds
  s_add_u32 m0, s40, 3072
  s_mov_b32 s39, 0x18000
  buffer_load_dwordx4 v4, s[8:11], s39 offen lds
  s_add_u32 m0, s40, 4096
  s_mov_b32 s39, 0x20000
  buffer_load_dwordx4 v4, s[8:11], s39 offen lds
  s_add_u32 m0, s40, 5120
  s_mov_b32 s39, 0x28000
  buffer_load_dwordx4 v4, s[8:11], s39 offen lds
  s_add_u32 m0, s40, 6144
  s_mov_b32 s39, 0x30000
  buffer_load_dwordx4 v4, s[8:11], s39 offen lds
  s_add_u32 m0, s40, 7168
  s_mov_b32 s39, 0x38000
  buffer_load_dwordx4 v4, s[8:11], s39 offen lds
  s_add_u32 m0, s40, 8192
  s_mov_b32 s39, 0x40000
  buffer_load_dwordx4 v4, s[8:11], s39 offen lds
  s_add_u32 m0, s40, 9216
  s_mov_b32 s39, 0x48000
  buffer_load_dwordx4 v4, s[8:11], s39 offen lds
  s_add_u32 m0, s40, 10240
  s_mov_b32 s39, 0x50000
  buffer_load_dwordx4 v4, s[8:11], s39 offen lds
  s_add_u32 m0, s40, 11264
  s_mov_b32 s39, 0x58000
  buffer_load_dwordx4 v4, s[8:11], s39 offen lds
  s_add_u32 m0, s40, 12288
  s_mov_b32 s39, 0x60000
  buffer_load_dwordx4 v4, s[8:11], s39 offen lds
  s_add_u32 m0, s40, 13312
  s_mov_b32 s39, 0x68000
  buffer_load_dwordx4 v4, s[8:11], s39 offen lds
  s_add_u32 m0, s40, 14336
  s_mov_b32 s39, 0x70000
  buffer_load_dwordx4 v4, s[8:11], s39 offen lds
  s_add_u32 m0, s40, 15360
  s_mov_b32 s39, 0x78000
  buffer_load_dwordx4 v4, s[8:11], s39 offen lds
  s_waitcnt vmcnt(12)
  ds_read_b64_tr_b16 v[12:13], v5 offset:0
  ds_read_b64_tr_b16 v[14:15], v5 offset:256
  ds_read_b64_tr_b16 v[16:17], v5 offset:2048
  ds_read_b64_tr_b16 v[18:19], v5 offset:2304
  ds_read_b64_tr_b16 v[20:21], v5 offset:32
  ds_read_b64_tr_b16 v[22:23], v5 offset:288
  ds_read_b64_tr_b16 v[24:25], v5 offset:2080
  ds_read_b64_tr_b16 v[26:27], v5 offset:2336
  s_waitcnt lgkmcnt(0)
  v_accvgpr_write_b32 a0, v12
  v_accvgpr_write_b32 a2, v13
  v_accvgpr_write_b32 a1, v14
  v_accvgpr_write_b32 a3, v15
  v_accvgpr_write_b32 a4, v16
  v_accvgpr_write_b32 a6, v17
  v_accvgpr_write_b32 a5, v18
  v_accvgpr_write_b32 a7, v19
  v_accvgpr_write_b32 a8, v20
  v_accvgpr_write_b32 a10, v21
  v_accvgpr_write_b32 a9, v22
  v_accvgpr_write_b32 a11, v23
  v_accvgpr_write_b32 a12, v24
  v_accvgpr_write_b32 a14, v25
  v_accvgpr_write_b32 a13, v26
  v_accvgpr_write_b32 a15, v27
  s_waitcnt vmcnt(8)
  ds_read_b64_tr_b16 v[12:13], v5 offset:4096
  ds_read_b64_tr_b16 v[14:15], v5 offset:4352
  ds_read_b64_tr_b16 v[16:17], v5 offset:6144
  ds_read_b64_tr_b16 v[18:19], v5 offset:6400
  ds_read_b64_tr_b16 v[20:21], v5 offset:4128
  ds_read_b64_tr_b16 v[22:23], v5 offset:4384
  ds_read_b64_tr_b16 v[24:25], v5 offset:6176
  ds_read_b64_tr_b16 v[26:27], v5 offset:6432
  s_waitcnt lgkmcnt(0)
  v_accvgpr_write_b32 a16, v12
  v_accvgpr_write_b32 a18, v13
  v_accvgpr_write_b32 a17, v14
  v_accvgpr_write_b32 a19, v15
  v_accvgpr_write_b32 a20, v16
  v_accvgpr_write_b32 a22, v17
  v_accvgpr_write_b32 a21, v18
  v_accvgpr_write_b32 a23, v19
  v_accvgpr_write_b32 a24, v20
  v_accvgpr_write_b32 a26, v21
  v_accvgpr_write_b32 a25, v22
  v_accvgpr_write_b32 a27, v23
  v_accvgpr_write_b32 a28, v24
  v_accvgpr_write_b32 a30, v25
  v_accvgpr_write_b32 a29, v26
  v_accvgpr_write_b32 a31, v27
  s_waitcnt vmcnt(4)
  ds_read_b64_tr_b16 v[12:13], v5 offset:8192
  ds_read_b64_tr_b16 v[14:15], v5 offset:8448
  ds_read_b64_tr_b16 v[16:17], v5 offset:10240
  ds_read_b64_tr_b16 v[18:19], v5 offset:10496
  ds_read_b64_tr_b16 v[20:21], v5 offset:8224
  ds_read_b64_tr_b16 v[22:23], v5 offset:8480
  ds_read_b64_tr_b16 v[24:25], v5 offset:10272
  ds_read_b64_tr_b16 v[26:27], v5 offset:10528
  s_waitcnt lgkmcnt(0)
  v_accvgpr_write_b32 a32, v12
  v_accvgpr_write_b32 a34, v13
  v_accvgpr_write_b32 a33, v14
  v_accvgpr_write_b32 a35, v15
  v_accvgpr_write_b32 a36, v16
  v_accvgpr_write_b32 a38, v17
  v_accvgpr_write_b32 a37, v18
  v_accvgpr_write_b32 a39, v19
  v_accvgpr_write_b32 a40, v20
  v_accvgpr_write_b32 a42, v21
  v_accvgpr_write_b32 a41, v22
  v_accvgpr_write_b32 a43, v23
  v_accvgpr_write_b32 a44, v24
  v_accvgpr_write_b32 a46, v25
  v_accvgpr_write_b32 a45, v26
  v_accvgpr_write_b32 a47, v27
  s_waitcnt vmcnt(0)
  ds_read_b64_tr_b16 v[12:13], v5 offset:12288
  ds_read_b64_tr_b16 v[14:15], v5 offset:12544
  ds_read_b64_tr_b16 v[16:17], v5 offset:14336
  ds_read_b64_tr_b16 v[18:19], v5 offset:14592
  ds_read_b64_tr_b16 v[20:21], v5 offset:12320
  ds_read_b64_tr_b16 v[22:23], v5 offset:12576
  ds_read_b64_tr_b16 v[24:25], v5 offset:14368
  ds_read_b64_tr_b16 v[26:27], v5 offset:14624
  s_waitcnt lgkmcnt(0)
  v_accvgpr_write_b32 a48, v12
  v_accvgpr_write_b32 a50, v13
  v_accvgpr_write_b32 a49, v14
  v_accvgpr_write_b32 a51, v15
  v_accvgpr_write_b32 a52, v16
  v_accvgpr_write_b32 a54, v17
  v_accvgpr_write_b32 a53, v18
  v_accvgpr_write_b32 a55, v19
  v_accvgpr_write_b32 a56, v20
  v_accvgpr_write_b32 a58, v21
  v_accvgpr_write_b32 a57, v22
  v_accvgpr_write_b32 a59, v23
  v_accvgpr_write_b32 a60, v24
  v_accvgpr_write_b32 a62, v25
  v_accvgpr_write_b32 a61, v26
  v_accvgpr_write_b32 a63, v27
  s_setprio 0
  v_and_b32 v4, 8, v1
  v_cmp_eq_u32 vcc, 0, v4
  v_mov_b32 v4, 0xeeee
  v_mov_b32 v6, 0x4444
  v_cndmask_b32 v4, v4, v6, vcc
  s_sub_u32 s40, s28, 4
  s_lshl_b32 s39, s40, 12
  v_lshl_add_u32 v5, v1, 4, s39
  v_and_b32 v6, 1, v3
  v_mul_u32_u24 v7, 576, v6
  v_lshrrev_b32 v6, 5, v1
  v_lshl_add_u32 v6, v6, 4, v2
  v_lshl_add_u32 v7, v6, 2, v7
  s_mul_i32 s39, s40, 1152
  s_add_u32 s39, s39, 12800
  v_add_u32 v7, s39, v7
  s_cmp_eq_u32 s28, 4
  s_cbranch_scc1 L_w4_76
  s_cmp_eq_u32 s28, 5
  s_cbranch_scc1 L_w5_77
  s_branch L_w6_78
L_ws1_80:
  s_mov_b32 s8, s46
  s_mov_b32 s9, s47
  s_mov_b32 s10, 0x800000
  s_mov_b32 s11, 0x20000
  s_mov_b32 s12, s48
  s_mov_b32 s13, s49
  s_mov_b32 s14, 0x800000
  s_mov_b32 s15, 0x20000
  s_mov_b32 s16, s50
  s_mov_b32 s17, s51
  s_mov_b32 s18, 0x800000
  s_mov_b32 s19, 0x20000
  s_lshl_b32 s39, s26, 8
  s_lshl_b32 s41, s27, 6
  s_add_u32 s39, s39, s41
  s_lshl_b32 s41, s28, 19
  s_add_u32 s39, s39, s41
  s_mul_i32 s40, s28, 16384
  s_add_u32 s40, s40, 26624
  v_lshrrev_b32 v4, 2, v1
  v_mul_u32_u24 v4, 8192, v4
  v_and_b32 v6, 3, v1
  v_lshl_add_u32 v4, v6, 4, v4
  v_add_u32 v4, s39, v4
  v_lshrrev_b32 v6, 1, v3
  v_and_b32 v7, 1, v3
  v_lshlrev_b32 v6, 4, v6
  v_lshl_add_u32 v6, v7, 2, v6
  v_lshrrev_b32 v7, 2, v2
  v_add_u32 v6, v6, v7
  v_and_b32 v7, 3, v2
  v_lshlrev_b32 v7, 3, v7
  v_lshl_add_u32 v5, v6, 6, v7
  v_add_u32 v5, s40, v5
  s_add_u32 m0, s40, 0
  s_mov_b32 s39, 0x0
  buffer_load_dwordx4 v4, s[8:11], s39 offen lds
  s_add_u32 m0, s40, 1024
  s_mov_b32 s39, 0x20000
  buffer_load_dwordx4 v4, s[8:11], s39 offen lds
  s_add_u32 m0, s40, 2048
  s_mov_b32 s39, 0x40000
  buffer_load_dwordx4 v4, s[8:11], s39 offen lds
  s_add_u32 m0, s40, 3072
  s_mov_b32 s39, 0x60000
  buffer_load_dwordx4 v4, s[8:11], s39 offen lds
  s_add_u32 m0, s40, 4096
  s_mov_b32 s39, 0x200000
  buffer_load_dwordx4 v4, s[8:11], s39 offen lds
  s_add_u32 m0, s40, 5120
  s_mov_b32 s39, 0x220000
  buffer_load_dwordx4 v4, s[8:11], s39 offen lds
  s_add_u32 m0, s40, 6144
  s_mov_b32 s39, 0x240000
  buffer_load_dwordx4 v4, s[8:11], s39 offen lds
  s_add_u32 m0, s40, 7168
  s_mov_b32 s39, 0x260000
  buffer_load_dwordx4 v4, s[8:11], s39 offen lds
  s_add_u32 m0, s40, 8192
  s_mov_b32 s39, 0x400000
  buffer_load_dwordx4 v4, s[8:11], s39 offen lds
  s_add_u32 m0, s40, 9216
  s_mov_b32 s39, 0x420000
  buffer_load_dwordx4 v4, s[8:11], s39 offen lds
  s_add_u32 m0, s40, 10240
  s_mov_b32 s39, 0x440000
  buffer_load_dwordx4 v4, s[8:11], s39 offen lds
  s_add_u32 m0, s40, 11264
  s_mov_b32 s39, 0x460000
  buffer_load_dwordx4 v4, s[8:11], s39 offen lds
  s_add_u32 m0, s40, 12288
  s_mov_b32 s39, 0x600000
  buffer_load_dwordx4 v4, s[8:11], s39 offen lds
  s_add_u32 m0, s40, 13312
  s_mov_b32 s39, 0x620000
  buffer_load_dwordx4 v4, s[8:11], s39 offen lds
  s_add_u32 m0, s40, 14336
  s_mov_b32 s39, 0x640000
  buffer_load_dwordx4 v4, s[8:11], s39 offen lds
  s_add_u32 m0, s40, 15360
  s_mov_b32 s39, 0x660000
  buffer_load_dwordx4 v4, s[8:11], s39 offen lds
  s_waitcnt vmcnt(12)
  ds_read_b64_tr_b16 v[12:13], v5 offset:0
  ds_read_b64_tr_b16 v[14:15], v5 offset:512
  ds_read_b64_tr_b16 v[16:17], v5 offset:2048
  ds_read_b64_tr_b16 v[18:19], v5 offset:2560
  ds_read_b64_tr_b16 v[20:21], v5 offset:32
  ds_read_b64_tr_b16 v[22:23], v5 offset:544
  ds_read_b64_tr_b16 v[24:25], v5 offset:2080
  ds_read_b64_tr_b16 v[26:27], v5 offset:2592
  s_waitcnt lgkmcnt(0)
  s_add_u32 m0, s40, 0
  s_mov_b32 s39, 0x0
  buffer_load_dwordx4 v4, s[12:15], s39 offen lds
  s_add_u32 m0, s40, 1024
  s_mov_b32 s39, 0x20000
  buffer_load_dwordx4 v4, s[12:15], s39 offen lds
  s_add_u32 m0, s40, 2048
  s_mov_b32 s39, 0x40000
  buffer_load_dwordx4 v4, s[12:15], s39 offen lds
  s_add_u32 m0, s40, 3072
  s_mov_b32 s39, 0x60000
  buffer_load_dwordx4 v4, s[12:15], s39 offen lds
  v_accvgpr_write_b32 a0, v12
  v_accvgpr_write_b32 a2, v13
  v_accvgpr_write_b32 a1, v14
  v_accvgpr_write_b32 a3, v15
  v_accvgpr_write_b32 a4, v16
  v_accvgpr_write_b32 a6, v17
  v_accvgpr_write_b32 a5, v18
  v_accvgpr_write_b32 a7, v19
  v_accvgpr_write_b32 a8, v20
  v_accvgpr_write_b32 a10, v21
  v_accvgpr_write_b32 a9, v22
  v_accvgpr_write_b32 a11, v23
  v_accvgpr_write_b32 a12, v24
  v_accvgpr_write_b32 a14, v25
  v_accvgpr_write_b32 a13, v26
  v_accvgpr_write_b32 a15, v27
  s_waitcnt vmcnt(12)
  ds_read_b64_tr_b16 v[12:13], v5 offset:4096
  ds_read_b64_tr_b16 v[14:15], v5 offset:4608
  ds_read_b64_tr_b16 v[16:17], v5 offset:6144
  ds_read_b64_tr_b16 v[18:19], v5 offset:6656
  ds_read_b64_tr_b16 v[20:21], v5 offset:4128
  ds_read_b64_tr_b16 v[22:23], v5 offset:4640
  ds_read_b64_tr_b16 v[24:25], v5 offset:6176
  ds_read_b64_tr_b16 v[26:27], v5 offset:6688
  s_waitcnt lgkmcnt(0)
  s_add_u32 m0, s40, 4096
  s_mov_b32 s39, 0x0
  buffer_load_dwordx4 v4, s[16:19], s39 offen lds
  s_add_u32 m0, s40, 5120
  s_mov_b32 s39, 0x20000
  buffer_load_dwordx4 v4, s[16:19], s39 offen lds
  s_add_u32 m0, s40, 6144
  s_mov_b32 s39, 0x40000
  buffer_load_dwordx4 v4, s[16:19], s39 offen lds
  s_add_u32 m0, s40, 7168
  s_mov_b32 s39, 0x60000
  buffer_load_dwordx4 v4, s[16:19], s39 offen lds
  v_accvgpr_write_b32 a48, v12
  v_accvgpr_write_b32 a50, v13
  v_accvgpr_write_b32 a49, v14
  v_accvgpr_write_b32 a51, v15
  v_accvgpr_write_b32 a52, v16
  v_accvgpr_write_b32 a54, v17
  v_accvgpr_write_b32 a53, v18
  v_accvgpr_write_b32 a55, v19
  v_accvgpr_write_b32 a56, v20
  v_accvgpr_write_b32 a58, v21
  v_accvgpr_write_b32 a57, v22
  v_accvgpr_write_b32 a59, v23
  v_accvgpr_write_b32 a60, v24
  v_accvgpr_write_b32 a62, v25
  v_accvgpr_write_b32 a61, v26
  v_accvgpr_write_b32 a63, v27
  s_waitcnt vmcnt(12)
  ds_read_b64_tr_b16 v[12:13], v5 offset:8192
  ds_read_b64_tr_b16 v[14:15], v5 offset:8704
  ds_read_b64_tr_b16 v[16:17], v5 offset:10240
  ds_read_b64_tr_b16 v[18:19], v5 offset:10752
  ds_read_b64_tr_b16 v[20:21], v5 offset:8224
  ds_read_b64_tr_b16 v[22:23], v5 offset:8736
  ds_read_b64_tr_b16 v[24:25], v5 offset:10272
  ds_read_b64_tr_b16 v[26:27], v5 offset:10784
  s_waitcnt lgkmcnt(0)
  s_add_u32 m0, s40, 8192
  s_mov_b32 s39, 0x200000
  buffer_load_dwordx4 v4, s[12:15], s39 offen lds
  s_add_u32 m0, s40, 9216
  s_mov_b32 s39, 0x220000
  buffer_load_dwordx4 v4, s[12:15], s39 offen lds
  s_add_u32 m0, s40, 10240
  s_mov_b32 s39, 0x240000
  buffer_load_dwordx4 v4, s[12:15], s39 offen lds
  s_add_u32 m0, s40, 11264
  s_mov_b32 s39, 0x260000
  buffer_load_dwordx4 v4, s[12:15], s39 offen lds
  v_mov_b32 v96, v12
  v_mov_b32 v98, v13
  v_mov_b32 v97, v14
  v_mov_b32 v99, v15
  v_mov_b32 v100, v16
  v_mov_b32 v102, v17
  v_mov_b32 v101, v18
  v_mov_b32 v103, v19
  v_mov_b32 v104, v20
  v_mov_b32 v106, v21
  v_mov_b32 v105, v22
  v_mov_b32 v107, v23
  v_mov_b32 v108, v24
  v_mov_b32 v110, v25
  v_mov_b32 v109, v26
  v_mov_b32 v111, v27
  s_waitcnt vmcnt(12)
  ds_read_b64_tr_b16 v[12:13], v5 offset:12288
  ds_read_b64_tr_b16 v[14:15], v5 offset:12800
  ds_read_b64_tr_b16 v[16:17], v5 offset:14336
  ds_read_b64_tr_b16 v[18:19], v5 offset:14848
  ds_read_b64_tr_b16 v[20:21], v5 offset:12320
  ds_read_b64_tr_b16 v[22:23], v5 offset:12832
  ds_read_b64_tr_b16 v[24:25], v5 offset:14368
  ds_read_b64_tr_b16 v[26:27], v5 offset:14880
  s_waitcnt lgkmcnt(0)
  s_add_u32 m0, s40, 12288
  s_mov_b32 s39, 0x200000
  buffer_load_dwordx4 v4, s[16:19], s39 offen lds
  s_add_u32 m0, s40, 13312
  s_mov_b32 s39, 0x220000
  buffer_load_dwordx4 v4, s[16:19], s39 offen lds
  s_add_u32 m0, s40, 14336
  s_mov_b32 s39, 0x240000
  buffer_load_dwordx4 v4, s[16:19], s39 offen lds
  s_add_u32 m0, s40, 15360
  s_mov_b32 s39, 0x260000
  buffer_load_dwordx4 v4, s[16:19], s39 offen lds
  v_mov_b32 v144, v12
  v_mov_b32 v146, v13
  v_mov_b32 v145, v14
  v_mov_b32 v147, v15
  v_mov_b32 v148, v16
  v_mov_b32 v150, v17
  v_mov_b32 v149, v18
  v_mov_b32 v151, v19
  v_mov_b32 v152, v20
  v_mov_b32 v154, v21
  v_mov_b32 v153, v22
  v_mov_b32 v155, v23
  v_mov_b32 v156, v24
  v_mov_b32 v158, v25
  v_mov_b32 v157, v26
  v_mov_b32 v159, v27
  s_waitcnt vmcnt(12)
  ds_read_b64_tr_b16 v[12:13], v5 offset:0
  ds_read_b64_tr_b16 v[14:15], v5 offset:512
  ds_read_b64_tr_b16 v[16:17], v5 offset:2048
  ds_read_b64_tr_b16 v[18:19], v5 offset:2560
  ds_read_b64_tr_b16 v[20:21], v5 offset:32
  ds_read_b64_tr_b16 v[22:23], v5 offset:544
  ds_read_b64_tr_b16 v[24:25], v5 offset:2080
  ds_read_b64_tr_b16 v[26:27], v5 offset:2592
  s_waitcnt lgkmcnt(0)
  s_add_u32 m0, s40, 0
  s_mov_b32 s39, 0x400000
  buffer_load_dwordx4 v4, s[12:15], s39 offen lds
  s_add_u32 m0, s40, 1024
  s_mov_b32 s39, 0x420000
  buffer_load_dwordx4 v4, s[12:15], s39 offen lds
  s_add_u32 m0, s40, 2048
  s_mov_b32 s39, 0x440000
  buffer_load_dwordx4 v4, s[12:15], s39 offen lds
  s_add_u32 m0, s40, 3072
  s_mov_b32 s39, 0x460000
  buffer_load_dwordx4 v4, s[12:15], s39 offen lds
  v_accvgpr_write_b32 a16, v12
  v_accvgpr_write_b32 a18, v13
  v_accvgpr_write_b32 a17, v14
  v_accvgpr_write_b32 a19, v15
  v_accvgpr_write_b32 a20, v16
  v_accvgpr_write_b32 a22, v17
  v_accvgpr_write_b32 a21, v18
  v_accvgpr_write_b32 a23, v19
  v_accvgpr_write_b32 a24, v20
  v_accvgpr_write_b32 a26, v21
  v_accvgpr_write_b32 a25, v22
  v_accvgpr_write_b32 a27, v23
  v_accvgpr_write_b32 a28, v24
  v_accvgpr_write_b32 a30, v25
  v_accvgpr_write_b32 a29, v26
  v_accvgpr_write_b32 a31, v27
  s_waitcnt vmcnt(12)
  ds_read_b64_tr_b16 v[12:13], v5 offset:4096
  ds_read_b64_tr_b16 v[14:15], v5 offset:4608
  ds_read_b64_tr_b16 v[16:17], v5 offset:6144
  ds_read_b64_tr_b16 v[18:19], v5 offset:6656
  ds_read_b64_tr_b16 v[20:21], v5 offset:4128
  ds_read_b64_tr_b16 v[22:23], v5 offset:4640
  ds_read_b64_tr_b16 v[24:25], v5 offset:6176
  ds_read_b64_tr_b16 v[26:27], v5 offset:6688
  s_waitcnt lgkmcnt(0)
  s_add_u32 m0, s40, 4096
  s_mov_b32 s39, 0x400000
  buffer_load_dwordx4 v4, s[16:19], s39 offen lds
  s_add_u32 m0, s40, 5120
  s_mov_b32 s39, 0x420000
  buffer_load_dwordx4 v4, s[16:19], s39 offen lds
  s_add_u32 m0, s40, 6144
  s_mov_b32 s39, 0x440000
  buffer_load_dwordx4 v4, s[16:19], s39 offen lds
  s_add_u32 m0, s40, 7168
  s_mov_b32 s39, 0x460000
  buffer_load_dwordx4 v4, s[16:19], s39 offen lds
  v_accvgpr_write_b32 a32, v12
  v_accvgpr_write_b32 a34, v13
  v_accvgpr_write_b32 a33, v14
  v_accvgpr_write_b32 a35, v15
  v_accvgpr_write_b32 a36, v16
  v_accvgpr_write_b32 a38, v17
  v_accvgpr_write_b32 a37, v18
  v_accvgpr_write_b32 a39, v19
  v_accvgpr_write_b32 a40, v20
  v_accvgpr_write_b32 a42, v21
  v_accvgpr_write_b32 a41, v22
  v_accvgpr_write_b32 a43, v23
  v_accvgpr_write_b32 a44, v24
  v_accvgpr_write_b32 a46, v25
  v_accvgpr_write_b32 a45, v26
  v_accvgpr_write_b32 a47, v27
  s_waitcnt vmcnt(12)
  ds_read_b64_tr_b16 v[12:13], v5 offset:8192
  ds_read_b64_tr_b16 v[14:15], v5 offset:8704
  ds_read_b64_tr_b16 v[16:17], v5 offset:10240
  ds_read_b64_tr_b16 v[18:19], v5 offset:10752
  ds_read_b64_tr_b16 v[20:21], v5 offset:8224
  ds_read_b64_tr_b16 v[22:23], v5 offset:8736
  ds_read_b64_tr_b16 v[24:25], v5 offset:10272
  ds_read_b64_tr_b16 v[26:27], v5 offset:10784
  s_waitcnt lgkmcnt(0)
  s_add_u32 m0, s40, 8192
  s_mov_b32 s39, 0x600000
  buffer_load_dwordx4 v4, s[12:15], s39 offen lds
  s_add_u32 m0, s40, 9216
  s_mov_b32 s39, 0x620000
  buffer_load_dwordx4 v4, s[12:15], s39 offen lds
  s_add_u32 m0, s40, 10240
  s_mov_b32 s39, 0x640000
  buffer_load_dwordx4 v4, s[12:15], s39 offen lds
  s_add_u32 m0, s40, 11264
  s_mov_b32 s39, 0x660000
  buffer_load_dwordx4 v4, s[12:15], s39 offen lds
  v_mov_b32 v64, v12
  v_mov_b32 v66, v13
  v_mov_b32 v65, v14
  v_mov_b32 v67, v15
  v_mov_b32 v68, v16
  v_mov_b32 v70, v17
  v_mov_b32 v69, v18
  v_mov_b32 v71, v19
  v_mov_b32 v72, v20
  v_mov_b32 v74, v21
  v_mov_b32 v73, v22
  v_mov_b32 v75, v23
  v_mov_b32 v76, v24
  v_mov_b32 v78, v25
  v_mov_b32 v77, v26
  v_mov_b32 v79, v27
  s_waitcnt vmcnt(12)
  ds_read_b64_tr_b16 v[12:13], v5 offset:12288
  ds_read_b64_tr_b16 v[14:15], v5 offset:12800
  ds_read_b64_tr_b16 v[16:17], v5 offset:14336
  ds_read_b64_tr_b16 v[18:19], v5 offset:14848
  ds_read_b64_tr_b16 v[20:21], v5 offset:12320
  ds_read_b64_tr_b16 v[22:23], v5 offset:12832
  ds_read_b64_tr_b16 v[24:25], v5 offset:14368
  ds_read_b64_tr_b16 v[26:27], v5 offset:14880
  s_waitcnt lgkmcnt(0)
  s_add_u32 m0, s40, 12288
  s_mov_b32 s39, 0x600000
  buffer_load_dwordx4 v4, s[16:19], s39 offen lds
  s_add_u32 m0, s40, 13312
  s_mov_b32 s39, 0x620000
  buffer_load_dwordx4 v4, s[16:19], s39 offen lds
  s_add_u32 m0, s40, 14336
  s_mov_b32 s39, 0x640000
  buffer_load_dwordx4 v4, s[16:19], s39 offen lds
  s_add_u32 m0, s40, 15360
  s_mov_b32 s39, 0x660000
  buffer_load_dwordx4 v4, s[16:19], s39 offen lds
  v_mov_b32 v80, v12
  v_mov_b32 v82, v13
  v_mov_b32 v81, v14
  v_mov_b32 v83, v15
  v_mov_b32 v84, v16
  v_mov_b32 v86, v17
  v_mov_b32 v85, v18
  v_mov_b32 v87, v19
  v_mov_b32 v88, v20
  v_mov_b32 v90, v21
  v_mov_b32 v89, v22
  v_mov_b32 v91, v23
  v_mov_b32 v92, v24
  v_mov_b32 v94, v25
  v_mov_b32 v93, v26
  v_mov_b32 v95, v27
  s_waitcnt vmcnt(12)
  ds_read_b64_tr_b16 v[12:13], v5 offset:0
  ds_read_b64_tr_b16 v[14:15], v5 offset:512
  ds_read_b64_tr_b16 v[16:17], v5 offset:2048
  ds_read_b64_tr_b16 v[18:19], v5 offset:2560
  ds_read_b64_tr_b16 v[20:21], v5 offset:32
  ds_read_b64_tr_b16 v[22:23], v5 offset:544
  ds_read_b64_tr_b16 v[24:25], v5 offset:2080
  ds_read_b64_tr_b16 v[26:27], v5 offset:2592
  s_waitcnt lgkmcnt(0)
  v_mov_b32 v112, v12
  v_mov_b32 v114, v13
  v_mov_b32 v113, v14
  v_mov_b32 v115, v15
  v_mov_b32 v116, v16
  v_mov_b32 v118, v17
  v_mov_b32 v117, v18
  v_mov_b32 v119, v19
  v_mov_b32 v120, v20
  v_mov_b32 v122, v21
  v_mov_b32 v121, v22
  v_mov_b32 v123, v23
  v_mov_b32 v124, v24
  v_mov_b32 v126, v25
  v_mov_b32 v125, v26
  v_mov_b32 v127, v27
  s_waitcnt vmcnt(8)
  ds_read_b64_tr_b16 v[12:13], v5 offset:4096
  ds_read_b64_tr_b16 v[14:15], v5 offset:4608
  ds_read_b64_tr_b16 v[16:17], v5 offset:6144
  ds_read_b64_tr_b16 v[18:19], v5 offset:6656
  ds_read_b64_tr_b16 v[20:21], v5 offset:4128
  ds_read_b64_tr_b16 v[22:23], v5 offset:4640
  ds_read_b64_tr_b16 v[24:25], v5 offset:6176
  ds_read_b64_tr_b16 v[26:27], v5 offset:6688
  s_waitcnt lgkmcnt(0)
  v_mov_b32 v128, v12
  v_mov_b32 v130, v13
  v_mov_b32 v129, v14
  v_mov_b32 v131, v15
  v_mov_b32 v132, v16
  v_mov_b32 v134, v17
  v_mov_b32 v133, v18
  v_mov_b32 v135, v19
  v_mov_b32 v136, v20
  v_mov_b32 v138, v21
  v_mov_b32 v137, v22
  v_mov_b32 v139, v23
  v_mov_b32 v140, v24
  v_mov_b32 v142, v25
  v_mov_b32 v141, v26
  v_mov_b32 v143, v27
  s_waitcnt vmcnt(4)
  ds_read_b64_tr_b16 v[12:13], v5 offset:8192
  ds_read_b64_tr_b16 v[14:15], v5 offset:8704
  ds_read_b64_tr_b16 v[16:17], v5 offset:10240
  ds_read_b64_tr_b16 v[18:19], v5 offset:10752
  ds_read_b64_tr_b16 v[20:21], v5 offset:8224
  ds_read_b64_tr_b16 v[22:23], v5 offset:8736
  ds_read_b64_tr_b16 v[24:25], v5 offset:10272
  ds_read_b64_tr_b16 v[26:27], v5 offset:10784
  s_waitcnt lgkmcnt(0)
  v_mov_b32 v160, v12
  v_mov_b32 v162, v13
  v_mov_b32 v161, v14
  v_mov_b32 v163, v15
  v_mov_b32 v164, v16
  v_mov_b32 v166, v17
  v_mov_b32 v165, v18
  v_mov_b32 v167, v19
  v_mov_b32 v168, v20
  v_mov_b32 v170, v21
  v_mov_b32 v169, v22
  v_mov_b32 v171, v23
  v_mov_b32 v172, v24
  v_mov_b32 v174, v25
  v_mov_b32 v173, v26
  v_mov_b32 v175, v27
  s_waitcnt vmcnt(0)
  ds_read_b64_tr_b16 v[12:13], v5 offset:12288
  ds_read_b64_tr_b16 v[14:15], v5 offset:12800
  ds_read_b64_tr_b16 v[16:17], v5 offset:14336
  ds_read_b64_tr_b16 v[18:19], v5 offset:14848
  ds_read_b64_tr_b16 v[20:21], v5 offset:12320
  ds_read_b64_tr_b16 v[22:23], v5 offset:12832
  ds_read_b64_tr_b16 v[24:25], v5 offset:14368
  ds_read_b64_tr_b16 v[26:27], v5 offset:14880
  s_waitcnt lgkmcnt(0)
  v_mov_b32 v176, v12
  v_mov_b32 v178, v13
  v_mov_b32 v177, v14
  v_mov_b32 v179, v15
  v_mov_b32 v180, v16
  v_mov_b32 v182, v17
  v_mov_b32 v181, v18
  v_mov_b32 v183, v19
  v_mov_b32 v184, v20
  v_mov_b32 v186, v21
  v_mov_b32 v185, v22
  v_mov_b32 v187, v23
  v_mov_b32 v188, v24
  v_mov_b32 v190, v25
  v_mov_b32 v189, v26
  v_mov_b32 v191, v27
  v_and_b32 v4, 8, v1
  v_cmp_eq_u32 vcc, 0, v4
  v_mov_b32 v4, 0xeeee
  v_mov_b32 v6, 0x4444
  v_cndmask_b32 v4, v4, v6, vcc
  s_mov_b32 s8, s52
  s_mov_b32 s9, s53
  s_mov_b32 s10, 0x4000
  s_mov_b32 s11, 0x20000
  v_and_b32 v6, 7, v1
  v_lshlrev_b32 v6, 11, v6
  v_lshrrev_b32 v9, 3, v1
  v_lshl_add_u32 v6, v9, 4, v6
  s_lshl_b32 s39, s28, 7
  v_add_u32 v6, s39, v6
  buffer_load_dwordx4 v[12:15], v6, s[8:11], 0 offen offset:0
  buffer_load_dwordx4 v[16:19], v6, s[8:11], 0 offen offset:512
  buffer_load_dwordx4 v[20:23], v6, s[8:11], 0 offen offset:1024
  buffer_load_dwordx4 v[24:27], v6, s[8:11], 0 offen offset:1536
  s_lshl_b32 s39, s28, 10
  v_lshl_add_u32 v5, v1, 4, s39
  v_and_b32 v6, 1, v3
  v_mul_u32_u24 v7, 1088, v6
  v_lshrrev_b32 v6, 5, v1
  v_lshl_add_u32 v6, v6, 4, v2
  v_lshl_add_u32 v7, v6, 2, v7
  s_mul_i32 s39, s28, 2176
  v_add_u32 v7, s39, v7
  s_lshl_b32 s39, s28, 10
  s_add_u32 s39, s39, 8704
  v_lshl_add_u32 v2, v1, 4, s39
  v_mov_b32 v28, 0
  v_mov_b32 v29, 0
  v_mov_b32 v30, 0
  v_mov_b32 v31, 0
  v_mov_b32 v32, 0
  v_mov_b32 v33, 0
  v_mov_b32 v34, 0
  v_mov_b32 v35, 0
  v_mov_b32 v36, 0
  v_mov_b32 v37, 0
  v_mov_b32 v38, 0
  v_mov_b32 v39, 0
  v_mov_b32 v40, 0
  v_mov_b32 v41, 0
  v_mov_b32 v42, 0
  v_mov_b32 v43, 0
  v_mov_b32 v44, 0
  v_mov_b32 v45, 0
  v_mov_b32 v46, 0
  v_mov_b32 v47, 0
  v_mov_b32 v48, 0
  v_mov_b32 v49, 0
  v_mov_b32 v50, 0
  v_mov_b32 v51, 0
  s_barrier
  s_barrier
  v_mov_b32 v6, 17420
  ds_read_b32 v6, v6
  s_waitcnt lgkmcnt(0)
  v_readfirstlane_b32 s40, v6
  s_nop 3
  s_cmp_eq_u32 s40, 2
  s_cbranch_scc1 L_slow
  s_waitcnt vmcnt(0)
  v_smfmac_f32_16x16x64_bf16 v[28:31], v[12:15], a[0:7], v4
  v_smfmac_f32_16x16x64_bf16 v[32:35], v[12:15], a[8:15], v4
  s_barrier
  v_smfmac_f32_16x16x64_bf16 v[28:31], v[16:19], a[48:55], v4
  v_smfmac_f32_16x16x64_bf16 v[32:35], v[16:19], a[56:63], v4
  v_smfmac_f32_16x16x64_bf16 v[28:31], v[20:23], v[96:103], v4
  v_smfmac_f32_16x16x64_bf16 v[32:35], v[20:23], v[104:111], v4
  v_smfmac_f32_16x16x64_bf16 v[28:31], v[24:27], v[144:151], v4
  v_smfmac_f32_16x16x64_bf16 v[32:35], v[24:27], v[152:159], v4
  v_smfmac_f32_16x16x64_bf16 v[36:39], v[12:15], a[16:23], v4
  v_smfmac_f32_16x16x64_bf16 v[40:43], v[12:15], a[24:31], v4
  v_smfmac_f32_16x16x64_bf16 v[36:39], v[16:19], v[64:71], v4
  v_smfmac_f32_16x16x64_bf16 v[40:43], v[16:19], v[72:79], v4
  v_permlane32_swap_b32 v28, v32
  v_permlane32_swap_b32 v29, v33
  v_smfmac_f32_16x16x64_bf16 v[36:39], v[20:23], v[112:119], v4
  v_permlane32_swap_b32 v30, v34
  v_permlane32_swap_b32 v31, v35
  v_smfmac_f32_16x16x64_bf16 v[40:43], v[20:23], v[120:127], v4
  v_pk_add_f32 v[28:29], v[28:29], v[32:33]
  v_pk_add_f32 v[30:31], v[30:31], v[34:35]
  v_smfmac_f32_16x16x64_bf16 v[36:39], v[24:27], v[160:167], v4
  ds_write2_b32 v7, v28, v29 offset0:0 offset1:68
  ds_write2_b32 v7, v30, v31 offset0:136 offset1:204
  v_smfmac_f32_16x16x64_bf16 v[40:43], v[24:27], v[168:175], v4
  v_smfmac_f32_16x16x64_bf16 v[44:47], v[12:15], a[32:39], v4
  v_smfmac_f32_16x16x64_bf16 v[48:51], v[12:15], a[40:47], v4
  v_smfmac_f32_16x16x64_bf16 v[44:47], v[16:19], v[80:87], v4
  v_permlane32_swap_b32 v36, v40
  v_permlane32_swap_b32 v37, v41
  v_permlane32_swap_b32 v38, v42
  v_permlane32_swap_b32 v39, v43
  v_pk_add_f32 v[36:37], v[36:37], v[40:41]
  v_pk_add_f32 v[38:39], v[38:39], v[42:43]
  ds_write2_b32 v7, v36, v37 offset0:32 offset1:100
  ds_write2_b32 v7, v38, v39 offset0:168 offset1:236
  s_waitcnt lgkmcnt(0)
  s_barrier
  v_smfmac_f32_16x16x64_bf16 v[48:51], v[16:19], v[88:95], v4
  v_smfmac_f32_16x16x64_bf16 v[44:47], v[20:23], v[128:135], v4
  v_smfmac_f32_16x16x64_bf16 v[48:51], v[20:23], v[136:143], v4
  v_smfmac_f32_16x16x64_bf16 v[44:47], v[24:27], v[176:183], v4
  v_smfmac_f32_16x16x64_bf16 v[48:51], v[24:27], v[184:191], v4
  s_branch L_s1rest_82
L_s1loop_81:
  s_barrier
  v_mov_b32 v28, 0
  v_mov_b32 v29, 0
  v_mov_b32 v30, 0
  v_mov_b32 v31, 0
  v_mov_b32 v32, 0
  v_mov_b32 v33, 0
  v_mov_b32 v34, 0
  v_mov_b32 v35, 0
  v_mov_b32 v36, 0
  v_mov_b32 v37, 0
  v_mov_b32 v38, 0
  v_mov_b32 v39, 0
  v_mov_b32 v40, 0
  v_mov_b32 v41, 0
  v_mov_b32 v42, 0
  v_mov_b32 v43, 0
  v_mov_b32 v44, 0
  v_mov_b32 v45, 0
  v_mov_b32 v46, 0
  v_mov_b32 v47, 0
  v_mov_b32 v48, 0
  v_mov_b32 v49, 0
  v_mov_b32 v50, 0
  v_mov_b32 v51, 0
  buffer_load_dwordx4 v[12:15], v5, s[4:7], s64 offen sc1
  buffer_load_dwordx4 v[16:19], v5, s[4:7], s65 offen sc1
  buffer_load_dwordx4 v[20:23], v5, s[4:7], s66 offen sc1
  buffer_load_dwordx4 v[24:27], v5, s[4:7], s67 offen sc1
L_b2wait_83:
  s_waitcnt vmcnt(0)
  v_max3_u32 v3, v15, v19, v23
  v_max_u32 v3, v3, v27
  v_cmp_eq_u32 vcc, -1, v3
  s_cbranch_vccnz L_b2retry_84
  v_smfmac_f32_16x16x64_bf16 v[28:31], v[12:15], a[0:7], v4
  v_smfmac_f32_16x16x64_bf16 v[32:35], v[12:15], a[8:15], v4
  s_barrier
  v_smfmac_f32_16x16x64_bf16 v[28:31], v[16:19], a[48:55], v4
  v_smfmac_f32_16x16x64_bf16 v[32:35], v[16:19], a[56:63], v4
  v_smfmac_f32_16x16x64_bf16 v[28:31], v[20:23], v[96:103], v4
  v_smfmac_f32_16x16x64_bf16 v[32:35], v[20:23], v[104:111], v4
  v_smfmac_f32_16x16x64_bf16 v[28:31], v[24:27], v[144:151], v4
  v_smfmac_f32_16x16x64_bf16 v[32:35], v[24:27], v[152:159], v4
  v_smfmac_f32_16x16x64_bf16 v[36:39], v[12:15], a[16:23], v4
  v_smfmac_f32_16x16x64_bf16 v[40:43], v[12:15], a[24:31], v4
  v_smfmac_f32_16x16x64_bf16 v[36:39], v[16:19], v[64:71], v4
  v_smfmac_f32_16x16x64_bf16 v[40:43], v[16:19], v[72:79], v4
  v_permlane32_swap_b32 v28, v32
  v_permlane32_swap_b32 v29, v33
  v_smfmac_f32_16x16x64_bf16 v[36:39], v[20:23], v[112:119], v4
  v_permlane32_swap_b32 v30, v34
  v_permlane32_swap_b32 v31, v35
  v_smfmac_f32_16x16x64_bf16 v[40:43], v[20:23], v[120:127], v4
  v_pk_add_f32 v[28:29], v[28:29], v[32:33]
  v_pk_add_f32 v[30:31], v[30:31], v[34:35]
  v_smfmac_f32_16x16x64_bf16 v[36:39], v[24:27], v[160:167], v4
  ds_write2_b32 v7, v28, v29 offset0:0 offset1:68
  ds_write2_b32 v7, v30, v31 offset0:136 offset1:204
  v_smfmac_f32_16x16x64_bf16 v[40:43], v[24:27], v[168:175], v4
  v_smfmac_f32_16x16x64_bf16 v[44:47], v[12:15], a[32:39], v4
  v_smfmac_f32_16x16x64_bf16 v[48:51], v[12:15], a[40:47], v4
  v_smfmac_f32_16x16x64_bf16 v[44:47], v[16:19], v[80:87], v4
  v_permlane32_swap_b32 v36, v40
  v_permlane32_swap_b32 v37, v41
  v_permlane32_swap_b32 v38, v42
  v_permlane32_swap_b32 v39, v43
  v_pk_add_f32 v[36:37], v[36:37], v[40:41]
  v_pk_add_f32 v[38:39], v[38:39], v[42:43]
  ds_write2_b32 v7, v36, v37 offset0:32 offset1:100
  ds_write2_b32 v7, v38, v39 offset0:168 offset1:236
  s_waitcnt lgkmcnt(0)
  s_barrier
  v_smfmac_f32_16x16x64_bf16 v[48:51], v[16:19], v[88:95], v4
  v_smfmac_f32_16x16x64_bf16 v[44:47], v[20:23], v[128:135], v4
  v_smfmac_f32_16x16x64_bf16 v[48:51], v[20:23], v[136:143], v4
  v_smfmac_f32_16x16x64_bf16 v[44:47], v[24:27], v[176:183], v4
  v_smfmac_f32_16x16x64_bf16 v[48:51], v[24:27], v[184:191], v4
L_s1rest_82:
  s_nop 7
  v_permlane32_swap_b32 v44, v48
  v_permlane32_swap_b32 v45, v49
  v_permlane32_swap_b32 v46, v50
  v_permlane32_swap_b32 v47, v51
  v_pk_add_f32 v[44:45], v[44:45], v[48:49]
  v_pk_add_f32 v[46:47], v[46:47], v[50:51]
  ds_write_b128 v2, v[44:47]
  s_waitcnt lgkmcnt(0)
  s_barrier
  s_cmp_eq_u32 s29, 63
  s_cbranch_scc1 L_rec_done
  s_add_u32 s29, s29, 1
  s_add_u32 s39, s29, 0
  s_and_b32 s39, s39, 3
  s_mul_i32 s39, s39, 0x4000
  s_mul_i32 s64, s24, 0x10000
  s_add_u32 s64, s64, s39
  s_add_u32 s64, s64, 0x5d40000
  s_add_u32 s65, s64, 4096
  s_add_u32 s66, s64, 8192
  s_add_u32 s67, s64, 12288
  s_barrier
  s_barrier
  s_branch L_s1loop_81
L_b2retry_84:
  buffer_load_dwordx4 v[12:15], v5, s[4:7], s64 offen sc1
  buffer_load_dwordx4 v[16:19], v5, s[4:7], s65 offen sc1
  buffer_load_dwordx4 v[20:23], v5, s[4:7], s66 offen sc1
  buffer_load_dwordx4 v[24:27], v5, s[4:7], s67 offen sc1
  s_add_u32 s31, s31, 1
  s_cmp_lt_u32 s31, 1048576
  s_cbranch_scc1 L_b2wait_83
  s_branch L_abort
L_w4_76:
  v_and_b32 v6, 7, v2
  v_mul_u32_u24 v36, 272, v6
  v_lshrrev_b32 v6, 3, v2
  v_lshl_add_u32 v36, v6, 7, v36
  v_lshl_add_u32 v36, v3, 4, v36
  s_lshl_b32 s39, s25, 11
  v_lshl_add_u32 v37, v1, 4, s39
  s_xor_b32 s40, s25, 1
  s_lshl_b32 s40, s40, 11
  v_lshl_add_u32 v39, v1, 4, s40
  s_xor_b32 s40, s25, 2
  s_lshl_b32 s40, s40, 11
  v_lshl_add_u32 v40, v1, 4, s40
  s_xor_b32 s40, s25, 3
  s_lshl_b32 s40, s40, 11
  v_lshl_add_u32 v41, v1, 4, s40
  v_and_b32 v6, 1, v3
  v_lshlrev_b32 v6, 3, v6
  v_add_u32 v6, v6, v2
  s_add_u32 s40, s39, 1024
  v_lshl_add_u32 v38, v6, 4, s40
  v_and_b32 v6, 0x28, v1
  v_cmp_eq_u32 vcc, 0x20, v6
  v_mov_b32 v6, 0x80000000
  s_nop 0
  v_cndmask_b32 v38, v6, v38, vcc
  v_lshlrev_b32 v6, 4, v2
  v_lshl_add_u32 v6, v3, 2, v6
  v_add_u32 v42, 1024, v6
  v_add_u32 v43, 8704, v6
  v_lshlrev_b32 v6, 7, v3
  v_lshl_add_u32 v6, v2, 4, v6
  s_lshl_b32 s39, s25, 9
  v_add_u32 v44, s39, v6
  v_cmp_gt_u32 vcc, 8, v2
  v_mov_b32 v6, 0x80000000
  s_nop 0
  v_cndmask_b32 v44, v6, v44, vcc
  v_lshlrev_b32 v45, 4, v1
  v_mov_b32 v132, 0x3f803f80
  v_mov_b32 v133, 0x3f803f80
  v_mov_b32 v134, 0x3f803f80
  v_mov_b32 v135, 0x3f803f80
  v_mov_b32 v129, 0
  v_mov_b32 v131, 0
  v_mov_b32 v141, 0
  s_mov_b32 s46, 0x3e0293ee
  v_mov_b32 v46, 0x439cd7d4
  s_xor_b32 s48, s25, 0
  s_lshl_b32 s48, s48, 11
  s_xor_b32 s49, s25, 1
  s_lshl_b32 s49, s49, 11
  s_xor_b32 s50, s25, 2
  s_lshl_b32 s50, s50, 11
  s_xor_b32 s51, s25, 3
  s_lshl_b32 s51, s51, 11
  s_barrier
  s_barrier
  v_mov_b32 v6, 17420
  ds_read_b32 v6, v6
  s_waitcnt lgkmcnt(0)
  v_readfirstlane_b32 s40, v6
  s_nop 3
  s_cmp_eq_u32 s40, 2
  s_cbranch_scc1 L_slow
L_w4loop_85:
  s_and_b32 s39, s29, 1
  s_lshl_b32 s39, s39, 12
  v_add_u32 v6, s39, v45
  ds_read_b128 v[48:51], v6 offset:18432
  ds_read_b128 v[52:55], v6 offset:19456
  ds_read_b128 v[56:59], v6 offset:20480
  ds_read_b128 v[60:63], v6 offset:21504
  s_add_u32 s39, s29, 0
  s_and_b32 s39, s39, 3
  s_mul_i32 s39, s39, 0x10000
  s_mul_i32 s34, s24, 0x40000
  s_add_u32 s34, s34, s39
  s_add_u32 s34, s34, 0x5e00000
  s_add_u32 s39, s29, 0
  s_and_b32 s39, s39, 3
  s_mul_i32 s39, s39, 0x4000
  s_mul_i32 s32, s24, 0x10000
  s_add_u32 s32, s32, s39
  s_add_u32 s32, s32, 0x5d00000
  s_add_u32 s64, s48, s34
  s_add_u32 s65, s49, s34
  s_add_u32 s66, s50, s34
  s_add_u32 s67, s51, s34
  s_waitcnt lgkmcnt(0)
  s_barrier
  s_cmp_eq_u32 s29, 63
  s_cbranch_scc1 L_rec_done_y2_y
  s_barrier
  ds_read_b128 v[64:67], v36 offset:0
  ds_read_b128 v[68:71], v36 offset:64
  ds_read_b128 v[72:75], v36 offset:2176
  ds_read_b128 v[76:79], v36 offset:2240
  ds_read_b128 v[80:83], v36 offset:4352
  ds_read_b128 v[84:87], v36 offset:4416
  ds_read_b128 v[88:91], v36 offset:6528
  ds_read_b128 v[92:95], v36 offset:6592
  s_waitcnt lgkmcnt(4)
  v_pk_add_f32 v[64:65], v[64:65], v[72:73]
  v_pk_add_f32 v[66:67], v[66:67], v[74:75]
  v_pk_add_f32 v[68:69], v[68:69], v[76:77]
  v_pk_add_f32 v[70:71], v[70:71], v[78:79]
  s_waitcnt lgkmcnt(2)
  v_pk_add_f32 v[64:65], v[64:65], v[80:81]
  v_pk_add_f32 v[66:67], v[66:67], v[82:83]
  v_pk_add_f32 v[68:69], v[68:69], v[84:85]
  v_pk_add_f32 v[70:71], v[70:71], v[86:87]
  s_waitcnt lgkmcnt(0)
  v_pk_add_f32 v[64:65], v[64:65], v[88:89]
  v_pk_add_f32 v[66:67], v[66:67], v[90:91]
  v_pk_add_f32 v[68:69], v[68:69], v[92:93]
  v_pk_add_f32 v[70:71], v[70:71], v[94:95]
  v_cvt_pk_bf16_f32 v96, v64, v65
  v_cvt_pk_bf16_f32 v97, v66, v67
  v_cvt_pk_bf16_f32 v98, v68, v69
  v_cvt_pk_bf16_f32 v99, v70, v71
  s_nop 1
  v_mfma_f32_16x16x32_bf16 v[104:107], v[52:55], v[96:99], 0
  v_mfma_f32_16x16x32_bf16 v[100:103], v[48:51], v[96:99], 0
  v_mfma_f32_16x16x32_bf16 v[108:111], v[96:99], v[96:99], 0
  s_nop 6
  v_mov_b32_dpp v100, v104 row_shr:8 row_mask:0xf bank_mask:0xc
  v_mov_b32_dpp v101, v105 row_shr:8 row_mask:0xf bank_mask:0xc
  v_mov_b32_dpp v102, v106 row_shr:8 row_mask:0xf bank_mask:0xc
  v_mov_b32_dpp v103, v107 row_shr:8 row_mask:0xf bank_mask:0xc
  buffer_store_dwordx4 v[100:103], v37, s[4:7], s34 offen
  buffer_store_dwordx4 v[108:111], v38, s[4:7], s34 offen
  s_barrier
  buffer_load_dwordx4 v[112:115], v39, s[4:7], s34 offen sc1
  buffer_load_dwordx4 v[116:119], v40, s[4:7], s34 offen sc1
  buffer_load_dwordx4 v[120:123], v41, s[4:7], s34 offen sc1
  buffer_load_dword v124, v42, s[4:7], s64 offen sc1
  buffer_load_dword v125, v42, s[4:7], s65 offen sc1
  buffer_load_dword v126, v42, s[4:7], s66 offen sc1
  buffer_load_dword v127, v42, s[4:7], s67 offen sc1
  ds_read2st64_b32 v[64:65], v43 offset0:0 offset1:1
  ds_read2st64_b32 v[66:67], v43 offset0:2 offset1:3
  ds_read2st64_b32 v[68:69], v43 offset0:4 offset1:5
  ds_read2st64_b32 v[70:71], v43 offset0:6 offset1:7
  ds_read2st64_b32 v[72:73], v43 offset0:8 offset1:9
  ds_read2st64_b32 v[74:75], v43 offset0:10 offset1:11
  ds_read2st64_b32 v[76:77], v43 offset0:12 offset1:13
  ds_read2st64_b32 v[78:79], v43 offset0:14 offset1:15
  s_waitcnt lgkmcnt(0)
  v_pk_add_f32 v[64:65], v[64:65], v[68:69]
  v_pk_add_f32 v[66:67], v[66:67], v[70:71]
  v_pk_add_f32 v[72:73], v[72:73], v[76:77]
  v_pk_add_f32 v[74:75], v[74:75], v[78:79]
  v_pk_add_f32 v[64:65], v[64:65], v[72:73]
  v_pk_add_f32 v[66:67], v[66:67], v[74:75]
  v_cvt_pk_bf16_f32 v128, v64, v65
  v_cvt_pk_bf16_f32 v130, v66, v67
  buffer_load_dwordx4 v[160:163], v39, s[4:7], s34 offen sc1
  buffer_load_dwordx4 v[164:167], v40, s[4:7], s34 offen sc1
  buffer_load_dwordx4 v[168:171], v41, s[4:7], s34 offen sc1
  buffer_load_dword v172, v42, s[4:7], s64 offen sc1
  buffer_load_dword v173, v42, s[4:7], s65 offen sc1
  buffer_load_dword v174, v42, s[4:7], s66 offen sc1
  buffer_load_dword v175, v42, s[4:7], s67 offen sc1
L_cwa_86:
  s_waitcnt vmcnt(7)
  v_max3_u32 v9, v115, v119, v123
  v_max3_u32 v9, v9, v124, v125
  v_max3_u32 v9, v9, v126, v127
  v_cmp_eq_u32 vcc, -1, v9
  s_cbranch_vccnz L_cra_87
  v_pk_add_f32 v[116:117], v[116:117], v[120:121]
  v_pk_add_f32 v[118:119], v[118:119], v[122:123]
  v_pk_add_f32 v[100:101], v[100:101], v[112:113]
  v_pk_add_f32 v[102:103], v[102:103], v[114:115]
  v_pk_add_f32 v[124:125], v[124:125], v[126:127]
  v_pk_add_f32 v[100:101], v[100:101], v[116:117]
  v_pk_add_f32 v[102:103], v[102:103], v[118:119]
  v_add_f32 v159, v124, v125
L_cdone_88:
  v_max3_f32 v156, abs(v100), abs(v101), abs(v102)
  v_max3_f32 v156, v156, abs(v103), abs(v159)
  v_cmp_nlt_f32 vcc, v156, v46
  s_cbranch_vccnz L_smax_89
  v_mul_f32 v159, s46, v159
  v_mul_f32 v100, s46, v100
  v_mul_f32 v101, s46, v101
  v_mul_f32 v102, s46, v102
  v_mul_f32 v103, s46, v103
L_smaxb_90:
  v_exp_f32 v159, v159
  v_exp_f32 v100, v100
  v_exp_f32 v101, v101
  v_exp_f32 v102, v102
  v_exp_f32 v103, v103
  v_mov_b32_dpp v157, v159 row_shl:8 row_mask:0xf bank_mask:0xf
  v_cvt_pk_bf16_f32 v136, v100, v101
  v_cvt_pk_bf16_f32 v137, v102, v103
  v_cvt_pk_bf16_f32 v140, v159, v157
  v_mov_b32_dpp v138, v136 row_shl:8 row_mask:0xf bank_mask:0xf
  v_mov_b32_dpp v139, v137 row_shl:8 row_mask:0xf bank_mask:0xf
  v_mfma_f32_16x16x16_bf16 v[152:155], v[132:133], v[140:141], 0
  v_mfma_f32_16x16x16_bf16 v[144:147], v[128:129], v[140:141], 0
  v_mfma_f32_16x16x16_bf16 v[148:151], v[130:131], v[140:141], 0
  v_mfma_f32_16x16x32_bf16 v[152:155], v[132:135], v[136:139], v[152:155]
  v_mfma_f32_16x16x32_bf16 v[144:147], v[56:59], v[136:139], v[144:147]
  v_mfma_f32_16x16x32_bf16 v[148:151], v[60:63], v[136:139], v[148:151]
  s_nop 5
  v_rcp_f32 v156, v152
  s_nop 0
  v_pk_mul_f32 v[144:145], v[144:145], v[156:157] op_sel_hi:[1,0]
  v_pk_mul_f32 v[146:147], v[146:147], v[156:157] op_sel_hi:[1,0]
  v_pk_mul_f32 v[148:149], v[148:149], v[156:157] op_sel_hi:[1,0]
  v_pk_mul_f32 v[150:151], v[150:151], v[156:157] op_sel_hi:[1,0]
  v_cvt_pk_bf16_f32 v96, v144, v145
  v_cvt_pk_bf16_f32 v97, v146, v147
  v_cvt_pk_bf16_f32 v98, v148, v149
  v_cvt_pk_bf16_f32 v99, v150, v151
  buffer_store_dwordx4 v[96:99], v44, s[4:7], s32 offen
  s_barrier
  v_mov_b32 v28, 0
  v_mov_b32 v29, 0
  v_mov_b32 v30, 0
  v_mov_b32 v31, 0
  v_mov_b32 v32, 0
  v_mov_b32 v33, 0
  v_mov_b32 v34, 0
  v_mov_b32 v35, 0
  buffer_load_dwordx4 v[12:15], v5, s[4:7], s32 offen offset:0 sc1
  buffer_load_dwordx4 v[16:19], v5, s[4:7], s32 offen offset:1024 sc1
  buffer_load_dwordx4 v[20:23], v5, s[4:7], s32 offen offset:2048 sc1
  buffer_load_dwordx4 v[24:27], v5, s[4:7], s32 offen offset:3072 sc1
L_await_91:
  s_waitcnt vmcnt(0)
  v_max3_u32 v9, v15, v19, v23
  v_max_u32 v9, v9, v27
  v_cmp_eq_u32 vcc, -1, v9
  s_cbranch_vccnz L_aretry_92
  v_smfmac_f32_16x16x64_bf16 v[28:31], v[12:15], a[0:7], v4
  v_smfmac_f32_16x16x64_bf16 v[32:35], v[12:15], a[8:15], v4
  v_smfmac_f32_16x16x64_bf16 v[28:31], v[16:19], a[16:23], v4
  v_smfmac_f32_16x16x64_bf16 v[32:35], v[16:19], a[24:31], v4
  v_smfmac_f32_16x16x64_bf16 v[28:31], v[20:23], a[32:39], v4
  v_smfmac_f32_16x16x64_bf16 v[32:35], v[20:23], a[40:47], v4
  v_smfmac_f32_16x16x64_bf16 v[28:31], v[24:27], a[48:55], v4
  v_smfmac_f32_16x16x64_bf16 v[32:35], v[24:27], a[56:63], v4
  s_nop 7
  v_permlane32_swap_b32 v28, v32
  v_permlane32_swap_b32 v29, v33
  v_permlane32_swap_b32 v30, v34
  v_permlane32_swap_b32 v31, v35
  v_pk_add_f32 v[28:29], v[28:29], v[32:33]
  v_pk_add_f32 v[30:31], v[30:31], v[34:35]
  ds_write2_b32 v7, v28, v29 offset0:0 offset1:36
  ds_write2_b32 v7, v30, v31 offset0:72 offset1:108
  s_waitcnt lgkmcnt(0)
  s_barrier
  s_add_u32 s29, s29, 1
  s_barrier
  s_branch L_w4loop_85
L_cra_87:
  buffer_load_dwordx4 v[112:115], v39, s[4:7], s34 offen sc1
  buffer_load_dwordx4 v[116:119], v40, s[4:7], s34 offen sc1
  buffer_load_dwordx4 v[120:123], v41, s[4:7], s34 offen sc1
  buffer_load_dword v124, v42, s[4:7], s64 offen sc1
  buffer_load_dword v125, v42, s[4:7], s65 offen sc1
  buffer_load_dword v126, v42, s[4:7], s66 offen sc1
  buffer_load_dword v127, v42, s[4:7], s67 offen sc1
  s_waitcnt vmcnt(7)
  v_max3_u32 v9, v163, v167, v171
  v_max3_u32 v9, v9, v172, v173
  v_max3_u32 v9, v9, v174, v175
  v_cmp_eq_u32 vcc, -1, v9
  s_cbranch_vccz L_cub_93
  buffer_load_dwordx4 v[160:163], v39, s[4:7], s34 offen sc1
  buffer_load_dwordx4 v[164:167], v40, s[4:7], s34 offen sc1
  buffer_load_dwordx4 v[168:171], v41, s[4:7], s34 offen sc1
  buffer_load_dword v172, v42, s[4:7], s64 offen sc1
  buffer_load_dword v173, v42, s[4:7], s65 offen sc1
  buffer_load_dword v174, v42, s[4:7], s66 offen sc1
  buffer_load_dword v175, v42, s[4:7], s67 offen sc1
  s_add_u32 s31, s31, 1
  s_cmp_lt_u32 s31, 1048576
  s_cbranch_scc1 L_cwa_86
  s_branch L_abort
L_cub_93:
  v_pk_add_f32 v[164:165], v[164:165], v[168:169]
  v_pk_add_f32 v[166:167], v[166:167], v[170:171]
  v_pk_add_f32 v[100:101], v[100:101], v[160:161]
  v_pk_add_f32 v[102:103], v[102:103], v[162:163]
  v_pk_add_f32 v[172:173], v[172:173], v[174:175]
  v_pk_add_f32 v[100:101], v[100:101], v[164:165]
  v_pk_add_f32 v[102:103], v[102:103], v[166:167]
  v_add_f32 v159, v172, v173
  s_branch L_cdone_88
L_smax_89:
  v_max3_f32 v156, v100, v101, v102
  v_max3_f32 v156, v156, v103, v159
  s_nop 1
  v_max_f32_dpp v157, v156, v156 row_ror:8 row_mask:0xf bank_mask:0xf
  v_max_f32_dpp v156, v156, v156 row_ror:8 row_mask:0xf bank_mask:0xf
  s_nop 1
  v_permlane16_swap_b32 v156, v157
  v_max_f32 v158, v156, v157
  v_max_f32 v157, v156, v157
  s_nop 1
  v_permlane32_swap_b32 v158, v157
  v_max_f32 v156, v158, v157
  v_mul_f32 v156, s46, v156
  v_fma_f32 v159, v159, s46, -v156
  v_fma_f32 v100, v100, s46, -v156
  v_fma_f32 v101, v101, s46, -v156
  v_fma_f32 v102, v102, s46, -v156
  v_fma_f32 v103, v103, s46, -v156
  s_branch L_smaxb_90
L_aretry_92:
  buffer_load_dwordx4 v[12:15], v5, s[4:7], s32 offen offset:0 sc1
  buffer_load_dwordx4 v[16:19], v5, s[4:7], s32 offen offset:1024 sc1
  buffer_load_dwordx4 v[20:23], v5, s[4:7], s32 offen offset:2048 sc1
  buffer_load_dwordx4 v[24:27], v5, s[4:7], s32 offen offset:3072 sc1
  s_add_u32 s31, s31, 1
  s_cmp_lt_u32 s31, 1048576
  s_cbranch_scc1 L_await_91
  s_branch L_abort
L_w5_77:
  s_lshl_b32 s40, s26, 12
  s_lshl_b32 s39, s27, 10
  s_add_u32 s40, s40, s39
  v_lshl_add_u32 v36, v1, 4, s40
  v_add_u32 v37, 131072, v36
  s_lshl_b32 s40, s40, 1
  s_add_u32 s40, s40, 0x1000000
  v_lshl_add_u32 v38, v1, 4, s40
  v_add_u32 v39, 1024, v38
  v_mov_b32 v45, 0
  v_mov_b32 v46, 0
  s_movk_i32 s42, 128
  v_and_b32 v6, 7, v1
  v_mul_u32_u24 v40, 272, v6
  v_add_u32 v40, 128, v40
  v_bfe_u32 v6, v1, 3, 2
  v_lshl_add_u32 v40, v6, 4, v40
  s_lshl_b32 s40, s26, 11
  s_lshl_b32 s39, s27, 9
  s_add_u32 s40, s40, s39
  s_add_u32 s39, s40, 0x5400000
  v_lshl_add_u32 v42, v1, 4, s39
  v_cmp_gt_u32 vcc, 32, v1
  v_mov_b32 v6, 0x80000000
  s_nop 0
  v_cndmask_b32 v42, v6, v42, vcc
  v_lshlrev_b32 v41, 4, v1
  v_add_u32 v41, 8704, v41
  s_add_u32 s39, s40, 0x5800000
  v_lshl_add_u32 v43, v1, 3, s39
  s_lshl_b32 s39, s24, 5
  s_add_u32 s39, s39, s25
  s_lshl_b32 s39, s39, 7
  s_add_u32 s39, s39, 0x5c10000
  v_mov_b32 v44, s39
  v_cmp_eq_u32 vcc, 0, v1
  v_mov_b32 v6, 0x80000000
  s_nop 0
  v_cndmask_b32 v44, v6, v44, vcc
  s_lshl_b32 s39, s24, 5
  s_add_u32 s39, s39, s25
  s_cmp_eq_u32 s39, 1
  s_mov_b32 s39, 0x80000000
  s_cselect_b32 s39, 0x5c17f00, s39
  v_mov_b32 v47, s39
  v_cmp_eq_u32 vcc, 0, v1
  v_mov_b32 v6, 0x80000000
  s_nop 0
  v_cndmask_b32 v47, v6, v47, vcc
  v_lshlrev_b32 v8, 2, v1
  v_mov_b32 v9, 0
  s_mov_b32 s40, 0x5c14400
L_w5p_95:
  buffer_load_dword v10, v8, s[20:23], 0 offen sc1
  buffer_load_dword v11, v9, s[4:7], s40 offen sc1
  s_waitcnt vmcnt(0)
  v_readlane_b32 s37, v10, 10
  v_readfirstlane_b32 s41, v11
  s_nop 3
  s_cmp_eq_u32 s37, 0
  s_cbranch_scc1 L_w5r_96
  s_cmp_eq_u32 s37, 2
  s_cbranch_scc1 L_nokv_94
  s_cmp_ge_u32 s41, 128
  s_cbranch_scc1 L_w5g_97
  s_sleep 2
  s_add_u32 s31, s31, 1
  s_cmp_lt_u32 s31, 1048576
  s_cbranch_scc1 L_w5p_95
  s_branch L_abort
L_w5r_96:
  v_lshlrev_b32 v8, 2, v1
  s_mov_b32 s40, 0
L_rm_98:
  buffer_load_dword v9, v8, s[20:23], 0 offen sc1
  s_waitcnt vmcnt(0)
  v_readlane_b32 s37, v9, 10
  v_readlane_b32 s41, v9, 8
  v_cmp_eq_u32 vcc, 32, v9
  s_nop 2
  s_cmp_lg_u32 s37, 0
  s_cbranch_scc1 L_rmdone_100
  s_cmp_lt_u32 s41, 256
  s_cbranch_scc1 L_rmnc_101
  s_and_b32 vcc_lo, vcc_lo, 0x30003
  s_and_b32 vcc_hi, vcc_hi, 0x30003
  s_and_b32 vcc_lo, vcc_lo, vcc_hi
  s_cmp_eq_u32 vcc_lo, 0x30003
  s_cselect_b32 s41, 1, 2
  s_branch L_rmcas_99
L_rmnc_101:
  s_sleep 2
  s_add_u32 s40, s40, 1
  s_cmp_lt_u32 s40, 2048
  s_cbranch_scc1 L_rm_98
  s_mov_b32 s41, 2
L_rmcas_99:
  v_mov_b32 v10, s41
  v_mov_b32 v11, 0
  v_mov_b32 v8, 40
  v_mov_b32 v9, 0x80000000
  v_cmp_eq_u32 vcc, 0, v1
  s_nop 1
  v_cndmask_b32 v8, v9, v8, vcc
  buffer_atomic_cmpswap v[10:11], v8, s[20:23], 0 offen sc0
  s_waitcnt vmcnt(0)
  v_readfirstlane_b32 s37, v10
  s_nop 3
  s_cmp_eq_u32 s37, 0
  s_cselect_b32 s37, s41, s37
L_rmdone_100:
  v_lshlrev_b32 v8, 2, v1
  v_mov_b32 v9, 0
  s_mov_b32 s40, 0x5c14400
  s_branch L_w5p_95
L_w5g_97:
  s_add_u32 s39, s29, 0
  s_min_u32 s37, s39, 63
  s_lshl_b32 s37, s37, 18
  s_and_b32 s39, s39, 1
  s_lshl_b32 s39, s39, 12
  s_add_u32 m0, s39, 18432
  s_nop 0
  buffer_load_dwordx4 v36, s[4:7], s37 offen sc1 lds
  s_add_u32 m0, s39, 19456
  s_nop 0
  buffer_load_dwordx4 v37, s[4:7], s37 offen sc1 lds
  s_add_u32 m0, s39, 20480
  s_nop 0
  buffer_load_dwordx4 v38, s[4:7], s37 offen sc1 lds
  s_add_u32 m0, s39, 21504
  s_nop 0
  buffer_load_dwordx4 v39, s[4:7], s37 offen sc1 lds
  s_add_u32 s39, s29, 1
  s_min_u32 s37, s39, 63
  s_lshl_b32 s37, s37, 18
  s_and_b32 s39, s39, 1
  s_lshl_b32 s39, s39, 12
  s_add_u32 m0, s39, 18432
  s_nop 0
  buffer_load_dwordx4 v36, s[4:7], s37 offen sc1 lds
  s_add_u32 m0, s39, 19456
  s_nop 0
  buffer_load_dwordx4 v37, s[4:7], s37 offen sc1 lds
  s_add_u32 m0, s39, 20480
  s_nop 0
  buffer_load_dwordx4 v38, s[4:7], s37 offen sc1 lds
  s_add_u32 m0, s39, 21504
  s_nop 0
  buffer_load_dwordx4 v39, s[4:7], s37 offen sc1 lds
L_nokv_94:
  s_waitcnt vmcnt(0)
  s_barrier
  s_barrier
  v_mov_b32 v6, 17420
  ds_read_b32 v6, v6
  s_waitcnt lgkmcnt(0)
  v_readfirstlane_b32 s40, v6
  s_nop 3
  s_cmp_eq_u32 s40, 2
  s_cbranch_scc1 L_slow
  s_barrier
  s_branch L_w5first_104
L_w5loop_102:
  s_barrier
  s_sub_u32 s39, s29, 1
  v_mov_b32 v6, s39
  buffer_store_dword v6, v47, s[4:7], 0 offen sc1
  buffer_store_dwordx4 v[96:99], v42, s[4:7], s38 offen sc1
  buffer_store_dwordx2 v[100:101], v43, s[4:7], s38 offen sc1
  s_add_u32 s40, s29, 1
  s_and_b32 s39, s40, 0x47
  s_cmp_lg_u32 s39, 0
  s_cbranch_scc1 L_kvok_105
  v_cmp_le_u32 vcc, s42, v45
  s_cbranch_vccnz L_kvok_105
  s_lshl_b32 s40, s40, 4
  s_add_u32 s40, s40, 0x5c14400
  v_mov_b32 v8, 0
  s_mov_b32 s41, 0x80
L_poll_107:
  buffer_load_dword v6, v8, s[4:7], s40 offen sc1
  s_waitcnt vmcnt(0)
  v_cmp_le_u32 vcc, s41, v6
  s_cbranch_vccnz L_pollok_108
  s_sleep 4
  s_add_u32 s31, s31, 1
  s_cmp_lt_u32 s31, 1048576
  s_cbranch_scc1 L_poll_107
  s_branch L_abort
L_pollok_108:
L_kvok_105:
  s_add_u32 s40, s29, 2
  s_and_b32 s39, s40, 0x47
  s_cmp_lg_u32 s39, 0
  s_cbranch_scc1 L_kvnf_106
  s_lshl_b32 s40, s40, 4
  s_add_u32 s40, s40, 0x5c14400
  buffer_load_dword v45, v46, s[4:7], s40 offen sc1
L_kvnf_106:
  s_add_u32 s39, s29, 1
  s_min_u32 s37, s39, 63
  s_lshl_b32 s37, s37, 18
  s_and_b32 s39, s39, 1
  s_lshl_b32 s39, s39, 12
  s_add_u32 m0, s39, 18432
  s_nop 0
  buffer_load_dwordx4 v36, s[4:7], s37 offen sc1 lds
  s_add_u32 m0, s39, 19456
  s_nop 0
  buffer_load_dwordx4 v37, s[4:7], s37 offen sc1 lds
  s_add_u32 m0, s39, 20480
  s_nop 0
  buffer_load_dwordx4 v38, s[4:7], s37 offen sc1 lds
  s_add_u32 m0, s39, 21504
  s_nop 0
  buffer_load_dwordx4 v39, s[4:7], s37 offen sc1 lds
L_w5first_104:
  s_add_u32 s39, s29, 0
  s_and_b32 s39, s39, 3
  s_mul_i32 s39, s39, 0x4000
  s_mul_i32 s32, s24, 0x10000
  s_add_u32 s32, s32, s39
  s_add_u32 s32, s32, 0x5d00000
  s_barrier
  s_barrier
  ds_read_b128 v[48:51], v40 offset:0
  ds_read_b128 v[52:55], v40 offset:64
  ds_read_b128 v[56:59], v40 offset:2176
  ds_read_b128 v[60:63], v40 offset:2240
  ds_read_b128 v[64:67], v40 offset:4352
  ds_read_b128 v[68:71], v40 offset:4416
  ds_read_b128 v[72:75], v40 offset:6528
  ds_read_b128 v[76:79], v40 offset:6592
  ds_read_b128 v[80:83], v41 offset:0
  ds_read_b128 v[84:87], v41 offset:1024
  ds_read_b128 v[88:91], v41 offset:2048
  ds_read_b128 v[92:95], v41 offset:3072
  s_lshl_b32 s38, s29, 16
  s_waitcnt lgkmcnt(0)
  v_pk_add_f32 v[48:49], v[48:49], v[56:57]
  v_pk_add_f32 v[50:51], v[50:51], v[58:59]
  v_pk_add_f32 v[52:53], v[52:53], v[60:61]
  v_pk_add_f32 v[54:55], v[54:55], v[62:63]
  v_pk_add_f32 v[48:49], v[48:49], v[64:65]
  v_pk_add_f32 v[50:51], v[50:51], v[66:67]
  v_pk_add_f32 v[52:53], v[52:53], v[68:69]
  v_pk_add_f32 v[54:55], v[54:55], v[70:71]
  v_pk_add_f32 v[48:49], v[48:49], v[72:73]
  v_pk_add_f32 v[50:51], v[50:51], v[74:75]
  v_pk_add_f32 v[52:53], v[52:53], v[76:77]
  v_pk_add_f32 v[54:55], v[54:55], v[78:79]
  v_cvt_pk_bf16_f32 v96, v48, v49
  v_cvt_pk_bf16_f32 v97, v50, v51
  v_cvt_pk_bf16_f32 v98, v52, v53
  v_cvt_pk_bf16_f32 v99, v54, v55
  v_pk_add_f32 v[80:81], v[80:81], v[84:85]
  v_pk_add_f32 v[82:83], v[82:83], v[86:87]
  v_pk_add_f32 v[80:81], v[80:81], v[88:89]
  v_pk_add_f32 v[82:83], v[82:83], v[90:91]
  v_pk_add_f32 v[80:81], v[80:81], v[92:93]
  v_pk_add_f32 v[82:83], v[82:83], v[94:95]
  v_cvt_pk_bf16_f32 v100, v80, v81
  v_cvt_pk_bf16_f32 v101, v82, v83
  s_cmp_eq_u32 s29, 63
  s_cbranch_scc1 L_w5last_103
  s_barrier
  v_mov_b32 v28, 0
  v_mov_b32 v29, 0
  v_mov_b32 v30, 0
  v_mov_b32 v31, 0
  v_mov_b32 v32, 0
  v_mov_b32 v33, 0
  v_mov_b32 v34, 0
  v_mov_b32 v35, 0
  buffer_load_dwordx4 v[12:15], v5, s[4:7], s32 offen offset:0 sc1
  buffer_load_dwordx4 v[16:19], v5, s[4:7], s32 offen offset:1024 sc1
  buffer_load_dwordx4 v[20:23], v5, s[4:7], s32 offen offset:2048 sc1
  buffer_load_dwordx4 v[24:27], v5, s[4:7], s32 offen offset:3072 sc1
L_await_109:
  s_waitcnt vmcnt(0)
  v_max3_u32 v9, v15, v19, v23
  v_max_u32 v9, v9, v27
  v_cmp_eq_u32 vcc, -1, v9
  s_cbranch_vccnz L_aretry_110
  v_smfmac_f32_16x16x64_bf16 v[28:31], v[12:15], a[0:7], v4
  v_smfmac_f32_16x16x64_bf16 v[32:35], v[12:15], a[8:15], v4
  v_smfmac_f32_16x16x64_bf16 v[28:31], v[16:19], a[16:23], v4
  v_smfmac_f32_16x16x64_bf16 v[32:35], v[16:19], a[24:31], v4
  v_smfmac_f32_16x16x64_bf16 v[28:31], v[20:23], a[32:39], v4
  v_smfmac_f32_16x16x64_bf16 v[32:35], v[20:23], a[40:47], v4
  v_smfmac_f32_16x16x64_bf16 v[28:31], v[24:27], a[48:55], v4
  v_smfmac_f32_16x16x64_bf16 v[32:35], v[24:27], a[56:63], v4
  s_nop 7
  v_permlane32_swap_b32 v28, v32
  v_permlane32_swap_b32 v29, v33
  v_permlane32_swap_b32 v30, v34
  v_permlane32_swap_b32 v31, v35
  v_pk_add_f32 v[28:29], v[28:29], v[32:33]
  v_pk_add_f32 v[30:31], v[30:31], v[34:35]
  ds_write2_b32 v7, v28, v29 offset0:0 offset1:36
  ds_write2_b32 v7, v30, v31 offset0:72 offset1:108
  s_waitcnt lgkmcnt(0)
  s_barrier
  s_add_u32 s29, s29, 1
  s_barrier
  s_branch L_w5loop_102
L_w5last_103:
  buffer_store_dwordx4 v[96:99], v42, s[4:7], s38 offen sc1
  buffer_store_dwordx2 v[100:101], v43, s[4:7], s38 offen sc1
  s_waitcnt vmcnt(0)
  v_mov_b32 v6, 64
  buffer_store_dword v6, v44, s[4:7], 0 offen sc1
  s_branch L_rec_done
L_aretry_110:
  buffer_load_dwordx4 v[12:15], v5, s[4:7], s32 offen offset:0 sc1
  buffer_load_dwordx4 v[16:19], v5, s[4:7], s32 offen offset:1024 sc1
  buffer_load_dwordx4 v[20:23], v5, s[4:7], s32 offen offset:2048 sc1
  buffer_load_dwordx4 v[24:27], v5, s[4:7], s32 offen offset:3072 sc1
  s_add_u32 s31, s31, 1
  s_cmp_lt_u32 s31, 1048576
  s_cbranch_scc1 L_await_109
  s_branch L_abort
L_w6_78:
  v_and_b32 v6, 7, v1
  v_mul_u32_u24 v36, 144, v6
  v_lshrrev_b32 v8, 3, v1
  v_lshl_add_u32 v36, v8, 4, v36
  s_lshr_b32 s40, s25, 3
  s_lshl_b32 s40, s40, 14
  s_and_b32 s39, s25, 7
  s_lshl_b32 s39, s39, 10
  s_add_u32 s40, s40, s39
  s_xor_b32 s39, s24, 0
  s_lshl_b32 s39, s39, 16
  s_add_u32 s39, s39, s40
  v_lshl_add_u32 v37, v1, 4, s39
  s_xor_b32 s39, s24, 1
  s_lshl_b32 s39, s39, 16
  s_add_u32 s39, s39, s40
  v_lshl_add_u32 v38, v1, 4, s39
  s_xor_b32 s39, s24, 2
  s_lshl_b32 s39, s39, 16
  s_add_u32 s39, s39, s40
  v_lshl_add_u32 v39, v1, 4, s39
  s_xor_b32 s39, s24, 3
  s_lshl_b32 s39, s39, 16
  s_add_u32 s39, s39, s40
  v_lshl_add_u32 v40, v1, 4, s39
  v_lshlrev_b32 v41, 4, v6
  v_lshrrev_b32 v9, 1, v8
  v_lshl_add_u32 v41, v9, 7, v41
  v_and_b32 v9, 1, v8
  v_lshl_add_u32 v41, v9, 3, v41
  s_lshl_b32 s39, s25, 9
  v_add_u32 v41, s39, v41
  s_barrier
  s_barrier
  v_mov_b32 v6, 17420
  ds_read_b32 v6, v6
  s_waitcnt lgkmcnt(0)
  v_readfirstlane_b32 s40, v6
  s_nop 3
  s_cmp_eq_u32 s40, 2
  s_cbranch_scc1 L_slow
  v_mov_b32 v6, 17416
  ds_read_b32 v6, v6
  s_waitcnt lgkmcnt(0)
  v_readfirstlane_b32 s39, v6
  s_nop 3
  s_add_u32 s36, s36, s39
L_w6loop_111:
  s_add_u32 s39, s29, 0
  s_and_b32 s39, s39, 3
  s_mul_i32 s39, s39, 0x4000
  s_mul_i32 s32, s24, 0x10000
  s_add_u32 s32, s32, s39
  s_add_u32 s32, s32, 0x5d00000
  s_add_u32 s39, s29, 1
  s_and_b32 s39, s39, 3
  s_mul_i32 s39, s39, 0x4000
  s_mul_i32 s33, s24, 0x10000
  s_add_u32 s33, s33, s39
  s_add_u32 s33, s33, 0x5d40000
  s_add_u32 s39, s29, 0
  s_and_b32 s39, s39, 3
  s_lshl_b32 s39, s39, 18
  s_add_u32 s35, s36, s39
  s_barrier
  s_barrier
  s_barrier
  s_cmp_eq_u32 s29, 63
  s_cbranch_scc1 L_rec_done
  s_barrier
  v_mov_b32 v28, 0
  v_mov_b32 v29, 0
  v_mov_b32 v30, 0
  v_mov_b32 v31, 0
  v_mov_b32 v32, 0
  v_mov_b32 v33, 0
  v_mov_b32 v34, 0
  v_mov_b32 v35, 0
  buffer_load_dwordx4 v[12:15], v5, s[4:7], s32 offen offset:0 sc1
  buffer_load_dwordx4 v[16:19], v5, s[4:7], s32 offen offset:1024 sc1
  buffer_load_dwordx4 v[20:23], v5, s[4:7], s32 offen offset:2048 sc1
  buffer_load_dwordx4 v[24:27], v5, s[4:7], s32 offen offset:3072 sc1
L_await_112:
  s_waitcnt vmcnt(0)
  v_max3_u32 v9, v15, v19, v23
  v_max_u32 v9, v9, v27
  v_cmp_eq_u32 vcc, -1, v9
  s_cbranch_vccnz L_aretry_113
  v_smfmac_f32_16x16x64_bf16 v[28:31], v[12:15], a[0:7], v4
  v_smfmac_f32_16x16x64_bf16 v[32:35], v[12:15], a[8:15], v4
  v_smfmac_f32_16x16x64_bf16 v[28:31], v[16:19], a[16:23], v4
  v_smfmac_f32_16x16x64_bf16 v[32:35], v[16:19], a[24:31], v4
  v_smfmac_f32_16x16x64_bf16 v[28:31], v[20:23], a[32:39], v4
  v_smfmac_f32_16x16x64_bf16 v[32:35], v[20:23], a[40:47], v4
  v_smfmac_f32_16x16x64_bf16 v[28:31], v[24:27], a[48:55], v4
  v_smfmac_f32_16x16x64_bf16 v[32:35], v[24:27], a[56:63], v4
  s_nop 7
  v_permlane32_swap_b32 v28, v32
  v_permlane32_swap_b32 v29, v33
  v_permlane32_swap_b32 v30, v34
  v_permlane32_swap_b32 v31, v35
  v_pk_add_f32 v[28:29], v[28:29], v[32:33]
  v_pk_add_f32 v[30:31], v[30:31], v[34:35]
  ds_write2_b32 v7, v28, v29 offset0:0 offset1:36
  ds_write2_b32 v7, v30, v31 offset0:72 offset1:108
  s_waitcnt lgkmcnt(0)
  s_barrier
  ds_read_b128 v[48:51], v36 offset:12800
  ds_read_b128 v[52:55], v36 offset:13952
  ds_read_b128 v[56:59], v36 offset:15104
  ds_read_b128 v[60:63], v36 offset:16256
  s_waitcnt lgkmcnt(2)
  v_pk_add_f32 v[48:49], v[48:49], v[52:53]
  v_pk_add_f32 v[50:51], v[50:51], v[54:55]
  s_waitcnt lgkmcnt(0)
  v_pk_add_f32 v[56:57], v[56:57], v[60:61]
  v_pk_add_f32 v[58:59], v[58:59], v[62:63]
  v_pk_add_f32 v[48:49], v[48:49], v[56:57]
  v_pk_add_f32 v[50:51], v[50:51], v[58:59]
  buffer_store_dwordx4 v[48:51], v37, s[4:7], s35 offen sc1
  s_waitcnt vmcnt(0)
  buffer_load_dwordx4 v[64:67], v38, s[4:7], s35 offen sc1
  buffer_load_dwordx4 v[68:71], v39, s[4:7], s35 offen sc1
  buffer_load_dwordx4 v[72:75], v40, s[4:7], s35 offen sc1
L_b1wait_114:
  s_waitcnt vmcnt(0)
  v_max3_u32 v9, v67, v71, v75
  v_cmp_eq_u32 vcc, -1, v9
  s_cbranch_vccnz L_b1retry_115
  v_pk_add_f32 v[68:69], v[68:69], v[72:73]
  v_pk_add_f32 v[70:71], v[70:71], v[74:75]
  v_pk_add_f32 v[48:49], v[48:49], v[64:65]
  v_pk_add_f32 v[50:51], v[50:51], v[66:67]
  v_pk_add_f32 v[48:49], v[48:49], v[68:69]
  v_pk_add_f32 v[50:51], v[50:51], v[70:71]
  v_cvt_pk_bf16_f32 v76, v48, v49
  v_cvt_pk_bf16_f32 v77, v50, v51
  buffer_store_dwordx2 v[76:77], v41, s[4:7], s33 offen
  s_add_u32 s29, s29, 1
  s_barrier
  s_branch L_w6loop_111
L_aretry_113:
  buffer_load_dwordx4 v[12:15], v5, s[4:7], s32 offen offset:0 sc1
  buffer_load_dwordx4 v[16:19], v5, s[4:7], s32 offen offset:1024 sc1
  buffer_load_dwordx4 v[20:23], v5, s[4:7], s32 offen offset:2048 sc1
  buffer_load_dwordx4 v[24:27], v5, s[4:7], s32 offen offset:3072 sc1
  s_add_u32 s31, s31, 1
  s_cmp_lt_u32 s31, 1048576
  s_cbranch_scc1 L_await_112
  s_branch L_abort
L_b1retry_115:
  buffer_load_dwordx4 v[64:67], v38, s[4:7], s35 offen sc1
  buffer_load_dwordx4 v[68:71], v39, s[4:7], s35 offen sc1
  buffer_load_dwordx4 v[72:75], v40, s[4:7], s35 offen sc1
  s_add_u32 s31, s31, 1
  s_cmp_lt_u32 s31, 1048576
  s_cbranch_scc1 L_b1wait_114
  s_branch L_abort
L_w7_79:
  v_mov_b32 v36, -1
  v_mov_b32 v37, -1
  v_mov_b32 v38, -1
  v_mov_b32 v39, -1
  s_lshl_b32 s39, s25, 9
  v_lshl_add_u32 v40, v1, 4, s39
  v_cmp_gt_u32 vcc, 32, v1
  v_mov_b32 v6, 0x80000000
  s_nop 0
  v_cndmask_b32 v40, v6, v40, vcc
  s_lshl_b32 s39, s25, 11
  v_lshl_add_u32 v41, v1, 4, s39
  v_add_u32 v42, 1024, v41
  s_lshr_b32 s40, s25, 3
  s_lshl_b32 s40, s40, 14
  s_and_b32 s39, s25, 7
  s_lshl_b32 s39, s39, 10
  s_add_u32 s40, s40, s39
  s_xor_b32 s39, s24, 0
  s_lshl_b32 s39, s39, 16
  s_add_u32 s39, s39, s40
  v_lshl_add_u32 v43, v1, 4, s39
  s_mov_b32 s68, -1
  s_mov_b32 s69, -1
  s_mov_b32 s8, s54
  s_mov_b32 s9, s55
  s_mov_b32 s10, 0x800000
  s_mov_b32 s11, 0x20000
  s_lshl_b32 s39, s24, 21
  s_sub_u32 s41, s28, 4
  s_mul_i32 s40, s41, 16384
  s_add_u32 s40, s40, 92160
  s_lshl_b32 s41, s41, 19
  s_add_u32 s39, s39, s41
  s_lshl_b32 s41, s25, 6
  s_add_u32 s39, s39, s41
  v_lshrrev_b32 v4, 2, v1
  v_mul_u32_u24 v4, 2048, v4
  v_and_b32 v6, 3, v1
  v_lshl_add_u32 v4, v6, 4, v4
  v_add_u32 v4, s39, v4
  v_lshrrev_b32 v6, 1, v3
  v_and_b32 v7, 1, v3
  v_lshlrev_b32 v6, 3, v6
  v_lshl_add_u32 v6, v7, 4, v6
  v_lshrrev_b32 v7, 2, v2
  v_add_u32 v6, v6, v7
  v_and_b32 v7, 3, v2
  v_lshlrev_b32 v7, 3, v7
  v_lshl_add_u32 v5, v6, 6, v7
  v_add_u32 v5, s40, v5
  s_add_u32 m0, s40, 0
  s_mov_b32 s39, 0x0
  buffer_load_dwordx4 v4, s[8:11], s39 offen lds
  s_add_u32 m0, s40, 1024
  s_mov_b32 s39, 0x8000
  buffer_load_dwordx4 v4, s[8:11], s39 offen lds
  s_add_u32 m0, s40, 2048
  s_mov_b32 s39, 0x10000
  buffer_load_dwordx4 v4, s[8:11], s39 offen lds
  s_add_u32 m0, s40, 3072
  s_mov_b32 s39, 0x18000
  buffer_load_dwordx4 v4, s[8:11], s39 offen lds
  s_add_u32 m0, s40, 4096
  s_mov_b32 s39, 0x20000
  buffer_load_dwordx4 v4, s[8:11], s39 offen lds
  s_add_u32 m0, s40, 5120
  s_mov_b32 s39, 0x28000
  buffer_load_dwordx4 v4, s[8:11], s39 offen lds
  s_add_u32 m0, s40, 6144
  s_mov_b32 s39, 0x30000
  buffer_load_dwordx4 v4, s[8:11], s39 offen lds
  s_add_u32 m0, s40, 7168
  s_mov_b32 s39, 0x38000
  buffer_load_dwordx4 v4, s[8:11], s39 offen lds
  s_add_u32 m0, s40, 8192
  s_mov_b32 s39, 0x40000
  buffer_load_dwordx4 v4, s[8:11], s39 offen lds
  s_add_u32 m0, s40, 9216
  s_mov_b32 s39, 0x48000
  buffer_load_dwordx4 v4, s[8:11], s39 offen lds
  s_add_u32 m0, s40, 10240
  s_mov_b32 s39, 0x50000
  buffer_load_dwordx4 v4, s[8:11], s39 offen lds
  s_add_u32 m0, s40, 11264
  s_mov_b32 s39, 0x58000
  buffer_load_dwordx4 v4, s[8:11], s39 offen lds
  s_add_u32 m0, s40, 12288
  s_mov_b32 s39, 0x60000
  buffer_load_dwordx4 v4, s[8:11], s39 offen lds
  s_add_u32 m0, s40, 13312
  s_mov_b32 s39, 0x68000
  buffer_load_dwordx4 v4, s[8:11], s39 offen lds
  s_add_u32 m0, s40, 14336
  s_mov_b32 s39, 0x70000
  buffer_load_dwordx4 v4, s[8:11], s39 offen lds
  s_add_u32 m0, s40, 15360
  s_mov_b32 s39, 0x78000
  buffer_load_dwordx4 v4, s[8:11], s39 offen lds
  s_lshl_b32 s39, s24, 5
  s_add_u32 s39, s39, s25
  s_and_b32 s41, s39, 63
  s_lshl_b32 s41, s41, 7
  s_lshr_b32 s39, s39, 6
  s_lshl_b32 s39, s39, 14
  s_add_u32 s39, s39, s41
  s_add_u32 s39, s39, s36
  s_add_u32 s39, s39, 1048576
  s_add_u32 s70, s4, s39
  s_addc_u32 s71, s5, 0
  s_memtime s[42:43]
  s_waitcnt lgkmcnt(0)
  s_load_dword s39, s[70:71], 0
  s_waitcnt lgkmcnt(0)
  s_memtime s[44:45]
  s_waitcnt lgkmcnt(0)
  s_sub_u32 s44, s44, s42
  s_min_u32 s68, s68, s44
  s_lshl_b32 s39, s24, 5
  s_add_u32 s39, s39, s25
  s_and_b32 s41, s39, 63
  s_lshl_b32 s41, s41, 7
  s_lshr_b32 s39, s39, 6
  s_lshl_b32 s39, s39, 14
  s_add_u32 s39, s39, s41
  s_add_u32 s39, s39, s36
  s_add_u32 s39, s39, 1056768
  s_add_u32 s70, s4, s39
  s_addc_u32 s71, s5, 0
  s_memtime s[42:43]
  s_waitcnt lgkmcnt(0)
  s_load_dword s39, s[70:71], 0
  s_waitcnt lgkmcnt(0)
  s_memtime s[44:45]
  s_waitcnt lgkmcnt(0)
  s_sub_u32 s44, s44, s42
  s_min_u32 s69, s69, s44
  s_waitcnt vmcnt(12)
  ds_read_b64_tr_b16 v[12:13], v5 offset:0
  ds_read_b64_tr_b16 v[14:15], v5 offset:256
  ds_read_b64_tr_b16 v[16:17], v5 offset:2048
  ds_read_b64_tr_b16 v[18:19], v5 offset:2304
  ds_read_b64_tr_b16 v[20:21], v5 offset:32
  ds_read_b64_tr_b16 v[22:23], v5 offset:288
  ds_read_b64_tr_b16 v[24:25], v5 offset:2080
  ds_read_b64_tr_b16 v[26:27], v5 offset:2336
  s_waitcnt lgkmcnt(0)
  v_accvgpr_write_b32 a0, v12
  v_accvgpr_write_b32 a2, v13
  v_accvgpr_write_b32 a1, v14
  v_accvgpr_write_b32 a3, v15
  v_accvgpr_write_b32 a4, v16
  v_accvgpr_write_b32 a6, v17
  v_accvgpr_write_b32 a5, v18
  v_accvgpr_write_b32 a7, v19
  v_accvgpr_write_b32 a8, v20
  v_accvgpr_write_b32 a10, v21
  v_accvgpr_write_b32 a9, v22
  v_accvgpr_write_b32 a11, v23
  v_accvgpr_write_b32 a12, v24
  v_accvgpr_write_b32 a14, v25
  v_accvgpr_write_b32 a13, v26
  v_accvgpr_write_b32 a15, v27
  s_lshl_b32 s39, s24, 5
  s_add_u32 s39, s39, s25
  s_and_b32 s41, s39, 63
  s_lshl_b32 s41, s41, 7
  s_lshr_b32 s39, s39, 6
  s_lshl_b32 s39, s39, 14
  s_add_u32 s39, s39, s41
  s_add_u32 s39, s39, s36
  s_add_u32 s39, s39, 1081344
  s_add_u32 s70, s4, s39
  s_addc_u32 s71, s5, 0
  s_memtime s[42:43]
  s_waitcnt lgkmcnt(0)
  s_load_dword s39, s[70:71], 0
  s_waitcnt lgkmcnt(0)
  s_memtime s[44:45]
  s_waitcnt lgkmcnt(0)
  s_sub_u32 s44, s44, s42
  s_min_u32 s68, s68, s44
  s_lshl_b32 s39, s24, 5
  s_add_u32 s39, s39, s25
  s_and_b32 s41, s39, 63
  s_lshl_b32 s41, s41, 7
  s_lshr_b32 s39, s39, 6
  s_lshl_b32 s39, s39, 14
  s_add_u32 s39, s39, s41
  s_add_u32 s39, s39, s36
  s_add_u32 s39, s39, 1089536
  s_add_u32 s70, s4, s39
  s_addc_u32 s71, s5, 0
  s_memtime s[42:43]
  s_waitcnt lgkmcnt(0)
  s_load_dword s39, s[70:71], 0
  s_waitcnt lgkmcnt(0)
  s_memtime s[44:45]
  s_waitcnt lgkmcnt(0)
  s_sub_u32 s44, s44, s42
  s_min_u32 s69, s69, s44
  s_waitcnt vmcnt(8)
  ds_read_b64_tr_b16 v[12:13], v5 offset:4096
  ds_read_b64_tr_b16 v[14:15], v5 offset:4352
  ds_read_b64_tr_b16 v[16:17], v5 offset:6144
  ds_read_b64_tr_b16 v[18:19], v5 offset:6400
  ds_read_b64_tr_b16 v[20:21], v5 offset:4128
  ds_read_b64_tr_b16 v[22:23], v5 offset:4384
  ds_read_b64_tr_b16 v[24:25], v5 offset:6176
  ds_read_b64_tr_b16 v[26:27], v5 offset:6432
  s_waitcnt lgkmcnt(0)
  v_accvgpr_write_b32 a16, v12
  v_accvgpr_write_b32 a18, v13
  v_accvgpr_write_b32 a17, v14
  v_accvgpr_write_b32 a19, v15
  v_accvgpr_write_b32 a20, v16
  v_accvgpr_write_b32 a22, v17
  v_accvgpr_write_b32 a21, v18
  v_accvgpr_write_b32 a23, v19
  v_accvgpr_write_b32 a24, v20
  v_accvgpr_write_b32 a26, v21
  v_accvgpr_write_b32 a25, v22
  v_accvgpr_write_b32 a27, v23
  v_accvgpr_write_b32 a28, v24
  v_accvgpr_write_b32 a30, v25
  v_accvgpr_write_b32 a29, v26
  v_accvgpr_write_b32 a31, v27
  s_lshl_b32 s39, s24, 5
  s_add_u32 s39, s39, s25
  s_and_b32 s41, s39, 63
  s_lshl_b32 s41, s41, 7
  s_lshr_b32 s39, s39, 6
  s_lshl_b32 s39, s39, 14
  s_add_u32 s39, s39, s41
  s_add_u32 s39, s39, s36
  s_add_u32 s39, s39, 1114112
  s_add_u32 s70, s4, s39
  s_addc_u32 s71, s5, 0
  s_memtime s[42:43]
  s_waitcnt lgkmcnt(0)
  s_load_dword s39, s[70:71], 0
  s_waitcnt lgkmcnt(0)
  s_memtime s[44:45]
  s_waitcnt lgkmcnt(0)
  s_sub_u32 s44, s44, s42
  s_min_u32 s68, s68, s44
  s_lshl_b32 s39, s24, 5
  s_add_u32 s39, s39, s25
  s_and_b32 s41, s39, 63
  s_lshl_b32 s41, s41, 7
  s_lshr_b32 s39, s39, 6
  s_lshl_b32 s39, s39, 14
  s_add_u32 s39, s39, s41
  s_add_u32 s39, s39, s36
  s_add_u32 s39, s39, 1122304
  s_add_u32 s70, s4, s39
  s_addc_u32 s71, s5, 0
  s_memtime s[42:43]
  s_waitcnt lgkmcnt(0)
  s_load_dword s39, s[70:71], 0
  s_waitcnt lgkmcnt(0)
  s_memtime s[44:45]
  s_waitcnt lgkmcnt(0)
  s_sub_u32 s44, s44, s42
  s_min_u32 s69, s69, s44
  s_waitcnt vmcnt(4)
  ds_read_b64_tr_b16 v[12:13], v5 offset:8192
  ds_read_b64_tr_b16 v[14:15], v5 offset:8448
  ds_read_b64_tr_b16 v[16:17], v5 offset:10240
  ds_read_b64_tr_b16 v[18:19], v5 offset:10496
  ds_read_b64_tr_b16 v[20:21], v5 offset:8224
  ds_read_b64_tr_b16 v[22:23], v5 offset:8480
  ds_read_b64_tr_b16 v[24:25], v5 offset:10272
  ds_read_b64_tr_b16 v[26:27], v5 offset:10528
  s_waitcnt lgkmcnt(0)
  v_accvgpr_write_b32 a32, v12
  v_accvgpr_write_b32 a34, v13
  v_accvgpr_write_b32 a33, v14
  v_accvgpr_write_b32 a35, v15
  v_accvgpr_write_b32 a36, v16
  v_accvgpr_write_b32 a38, v17
  v_accvgpr_write_b32 a37, v18
  v_accvgpr_write_b32 a39, v19
  v_accvgpr_write_b32 a40, v20
  v_accvgpr_write_b32 a42, v21
  v_accvgpr_write_b32 a41, v22
  v_accvgpr_write_b32 a43, v23
  v_accvgpr_write_b32 a44, v24
  v_accvgpr_write_b32 a46, v25
  v_accvgpr_write_b32 a45, v26
  v_accvgpr_write_b32 a47, v27
  s_cmp_lt_u32 s69, s68
  s_cselect_b32 s39, 1, 0
  s_or_b32 s39, s39, 0x10000
  v_mov_b32 v9, s39
  v_mov_b32 v8, 36
  v_cmp_eq_u32 vcc, 0, v1
  v_mov_b32 v6, 0x80000000
  s_nop 0
  v_cndmask_b32 v8, v6, v8, vcc
  buffer_atomic_add v9, v8, s[20:23], 0 offen
  s_waitcnt vmcnt(1)
  ds_read_b64_tr_b16 v[12:13], v5 offset:12288
  ds_read_b64_tr_b16 v[14:15], v5 offset:12544
  ds_read_b64_tr_b16 v[16:17], v5 offset:14336
  ds_read_b64_tr_b16 v[18:19], v5 offset:14592
  ds_read_b64_tr_b16 v[20:21], v5 offset:12320
  ds_read_b64_tr_b16 v[22:23], v5 offset:12576
  ds_read_b64_tr_b16 v[24:25], v5 offset:14368
  ds_read_b64_tr_b16 v[26:27], v5 offset:14624
  s_waitcnt lgkmcnt(0)
  v_accvgpr_write_b32 a48, v12
  v_accvgpr_write_b32 a50, v13
  v_accvgpr_write_b32 a49, v14
  v_accvgpr_write_b32 a51, v15
  v_accvgpr_write_b32 a52, v16
  v_accvgpr_write_b32 a54, v17
  v_accvgpr_write_b32 a53, v18
  v_accvgpr_write_b32 a55, v19
  v_accvgpr_write_b32 a56, v20
  v_accvgpr_write_b32 a58, v21
  v_accvgpr_write_b32 a57, v22
  v_accvgpr_write_b32 a59, v23
  v_accvgpr_write_b32 a60, v24
  v_accvgpr_write_b32 a62, v25
  v_accvgpr_write_b32 a61, v26
  v_accvgpr_write_b32 a63, v27
  s_setprio 0
  v_and_b32 v4, 8, v1
  v_cmp_eq_u32 vcc, 0, v4
  v_mov_b32 v4, 0xeeee
  v_mov_b32 v6, 0x4444
  v_cndmask_b32 v4, v4, v6, vcc
  s_sub_u32 s40, s28, 4
  s_lshl_b32 s39, s40, 12
  v_lshl_add_u32 v5, v1, 4, s39
  v_and_b32 v6, 1, v3
  v_mul_u32_u24 v7, 576, v6
  v_lshrrev_b32 v6, 5, v1
  v_lshl_add_u32 v6, v6, 4, v2
  v_lshl_add_u32 v7, v6, 2, v7
  s_mul_i32 s39, s40, 1152
  s_add_u32 s39, s39, 12800
  v_add_u32 v7, s39, v7
  s_barrier
  v_lshlrev_b32 v8, 2, v1
L_w7p_117:
  buffer_load_dword v10, v8, s[20:23], 0 offen sc1
  s_waitcnt vmcnt(0)
  v_readlane_b32 s37, v10, 10
  v_readlane_b32 s40, v10, 9
  s_nop 3
  s_cmp_eq_u32 s37, 0
  s_cbranch_scc1 L_w7r_118
  s_cmp_eq_u32 s37, 2
  s_cbranch_scc1 L_novote_116
  s_cmp_ge_u32 s40, 0x800000
  s_cbranch_scc1 L_novote_116
  s_sleep 1
  s_add_u32 s31, s31, 1
  s_cmp_lt_u32 s31, 1048576
  s_cbranch_scc1 L_w7p_117
  s_branch L_abort
L_w7r_118:
  v_lshlrev_b32 v8, 2, v1
  s_mov_b32 s40, 0
L_rm_119:
  buffer_load_dword v9, v8, s[20:23], 0 offen sc1
  s_waitcnt vmcnt(0)
  v_readlane_b32 s37, v9, 10
  v_readlane_b32 s41, v9, 8
  v_cmp_eq_u32 vcc, 32, v9
  s_nop 2
  s_cmp_lg_u32 s37, 0
  s_cbranch_scc1 L_rmdone_121
  s_cmp_lt_u32 s41, 256
  s_cbranch_scc1 L_rmnc_122
  s_and_b32 vcc_lo, vcc_lo, 0x30003
  s_and_b32 vcc_hi, vcc_hi, 0x30003
  s_and_b32 vcc_lo, vcc_lo, vcc_hi
  s_cmp_eq_u32 vcc_lo, 0x30003
  s_cselect_b32 s41, 1, 2
  s_branch L_rmcas_120
L_rmnc_122:
  s_sleep 2
  s_add_u32 s40, s40, 1
  s_cmp_lt_u32 s40, 2048
  s_cbranch_scc1 L_rm_119
  s_mov_b32 s41, 2
L_rmcas_120:
  v_mov_b32 v10, s41
  v_mov_b32 v11, 0
  v_mov_b32 v8, 40
  v_mov_b32 v9, 0x80000000
  v_cmp_eq_u32 vcc, 0, v1
  s_nop 1
  v_cndmask_b32 v8, v9, v8, vcc
  buffer_atomic_cmpswap v[10:11], v8, s[20:23], 0 offen sc0
  s_waitcnt vmcnt(0)
  v_readfirstlane_b32 s37, v10
  s_nop 3
  s_cmp_eq_u32 s37, 0
  s_cselect_b32 s37, s41, s37
L_rmdone_121:
  v_lshlrev_b32 v8, 2, v1
  s_branch L_w7p_117
L_novote_116:
  v_mov_b32 v6, s37
  v_mov_b32 v8, 17420
  ds_write_b32 v8, v6
  s_and_b32 s40, s40, 0xffff
  s_cmp_gt_u32 s40, 64
  s_cselect_b32 s39, 8192, 0
  v_mov_b32 v6, s39
  v_mov_b32 v8, 17416
  ds_write_b32 v8, v6
  s_waitcnt lgkmcnt(0)
  s_barrier
  v_mov_b32 v6, 17420
  ds_read_b32 v6, v6
  s_waitcnt lgkmcnt(0)
  v_readfirstlane_b32 s40, v6
  s_nop 3
  s_cmp_eq_u32 s40, 2
  s_cbranch_scc1 L_slow
  s_add_u32 s36, s36, s39
  v_lshlrev_b32 v44, 4, v1
  s_lshl_b32 s64, s24, 15
  s_lshl_b32 s39, s25, 10
  s_add_u32 s64, s64, s39
  s_add_u32 s64, s64, 0x6400000
L_w7loop_123:
  s_add_u32 s39, s29, 0
  s_and_b32 s39, s39, 3
  s_mul_i32 s39, s39, 0x4000
  s_mul_i32 s32, s24, 0x10000
  s_add_u32 s32, s32, s39
  s_add_u32 s32, s32, 0x5d00000
  s_add_u32 s39, s29, 3
  s_and_b32 s39, s39, 3
  s_mul_i32 s39, s39, 0x4000
  s_mul_i32 s42, s24, 0x10000
  s_add_u32 s42, s42, s39
  s_add_u32 s42, s42, 0x5d00000
  s_add_u32 s39, s29, 3
  s_and_b32 s39, s39, 3
  s_mul_i32 s39, s39, 0x10000
  s_mul_i32 s43, s24, 0x40000
  s_add_u32 s43, s43, s39
  s_add_u32 s43, s43, 0x5e00000
  s_add_u32 s39, s29, 3
  s_and_b32 s39, s39, 3
  s_mul_i32 s39, s39, 0x4000
  s_mul_i32 s44, s24, 0x10000
  s_add_u32 s44, s44, s39
  s_add_u32 s44, s44, 0x5d40000
  s_add_u32 s39, s29, 2
  s_and_b32 s39, s39, 3
  s_lshl_b32 s39, s39, 18
  s_add_u32 s45, s36, s39
  s_barrier
  s_cmp_ge_u32 s29, 32
  s_cbranch_scc1 L_noro_124
  s_lshl_b32 s39, s29, 17
  s_add_u32 s39, s39, s64
  buffer_store_dwordx4 v[36:39], v44, s[4:7], s39 offen sc1
L_noro_124:
  buffer_store_dwordx4 v[36:39], v43, s[4:7], s45 offen sc1
  buffer_store_dwordx4 v[36:39], v40, s[4:7], s42 offen
  buffer_store_dwordx4 v[36:39], v41, s[4:7], s43 offen
  buffer_store_dwordx4 v[36:39], v42, s[4:7], s43 offen
  buffer_store_dwordx4 v[36:39], v40, s[4:7], s44 offen
  s_barrier
  s_barrier
  s_cmp_eq_u32 s29, 63
  s_cbranch_scc1 L_rec_done
  s_barrier
  v_mov_b32 v28, 0
  v_mov_b32 v29, 0
  v_mov_b32 v30, 0
  v_mov_b32 v31, 0
  v_mov_b32 v32, 0
  v_mov_b32 v33, 0
  v_mov_b32 v34, 0
  v_mov_b32 v35, 0
  buffer_load_dwordx4 v[12:15], v5, s[4:7], s32 offen offset:0 sc1
  buffer_load_dwordx4 v[16:19], v5, s[4:7], s32 offen offset:1024 sc1
  buffer_load_dwordx4 v[20:23], v5, s[4:7], s32 offen offset:2048 sc1
  buffer_load_dwordx4 v[24:27], v5, s[4:7], s32 offen offset:3072 sc1
L_await_125:
  s_waitcnt vmcnt(0)
  v_max3_u32 v9, v15, v19, v23
  v_max_u32 v9, v9, v27
  v_cmp_eq_u32 vcc, -1, v9
  s_cbranch_vccnz L_aretry_126
  v_smfmac_f32_16x16x64_bf16 v[28:31], v[12:15], a[0:7], v4
  v_smfmac_f32_16x16x64_bf16 v[32:35], v[12:15], a[8:15], v4
  v_smfmac_f32_16x16x64_bf16 v[28:31], v[16:19], a[16:23], v4
  v_smfmac_f32_16x16x64_bf16 v[32:35], v[16:19], a[24:31], v4
  v_smfmac_f32_16x16x64_bf16 v[28:31], v[20:23], a[32:39], v4
  v_smfmac_f32_16x16x64_bf16 v[32:35], v[20:23], a[40:47], v4
  v_smfmac_f32_16x16x64_bf16 v[28:31], v[24:27], a[48:55], v4
  v_smfmac_f32_16x16x64_bf16 v[32:35], v[24:27], a[56:63], v4
  s_nop 7
  v_permlane32_swap_b32 v28, v32
  v_permlane32_swap_b32 v29, v33
  v_permlane32_swap_b32 v30, v34
  v_permlane32_swap_b32 v31, v35
  v_pk_add_f32 v[28:29], v[28:29], v[32:33]
  v_pk_add_f32 v[30:31], v[30:31], v[34:35]
  ds_write2_b32 v7, v28, v29 offset0:0 offset1:36
  ds_write2_b32 v7, v30, v31 offset0:72 offset1:108
  s_waitcnt lgkmcnt(0)
  s_barrier
  s_add_u32 s29, s29, 1
  s_barrier
  s_branch L_w7loop_123
L_aretry_126:
  buffer_load_dwordx4 v[12:15], v5, s[4:7], s32 offen offset:0 sc1
  buffer_load_dwordx4 v[16:19], v5, s[4:7], s32 offen offset:1024 sc1
  buffer_load_dwordx4 v[20:23], v5, s[4:7], s32 offen offset:2048 sc1
  buffer_load_dwordx4 v[24:27], v5, s[4:7], s32 offen offset:3072 sc1
  s_add_u32 s31, s31, 1
  s_cmp_lt_u32 s31, 1048576
  s_cbranch_scc1 L_await_125
  s_branch L_abort
L_rec_done_y2_y:
  s_barrier
  s_barrier
L_rec_done:
  s_cmp_lt_u32 s28, 4
  s_cbranch_scc1 L_rofin_127
  v_lshrrev_b32 v6, 5, v1
  v_lshlrev_b32 v60, 10, v6
  v_bfe_u32 v6, v1, 3, 2
  v_lshl_add_u32 v60, v6, 8, v60
  v_and_b32 v6, 7, v1
  v_lshl_add_u32 v60, v6, 4, v60
  s_lshl_b32 s39, s24, 2
  s_add_u32 s39, s39, s28
  s_sub_u32 s39, s39, 4
  s_lshl_b32 s39, s39, 13
  s_add_u32 s39, s39, 0x4e00000
  v_add_u32 v60, s39, v60
  v_add_u32 v61, 4096, v60
  v_add_u32 v12, 19968, v7
  v_add_u32 v13, 24576, v7
  v_add_u32 v14, 29184, v7
  v_add_u32 v15, 33792, v7
  v_add_u32 v16, 38400, v7
  v_add_u32 v17, 43008, v7
  v_add_u32 v18, 47616, v7
  v_add_u32 v19, 52224, v7
  v_min_u32 v24, 7, v1
  v_lshlrev_b32 v24, 9, v24
  s_lshl_b32 s38, s24, 7
  s_add_u32 s38, s38, 0x5c15e00
  s_add_u32 s40, s38, 0
  v_mov_b32 v8, 0
  s_mov_b32 s41, 0x8
L_poll_129:
  buffer_load_dword v6, v8, s[4:7], s40 offen sc1
  s_waitcnt vmcnt(0)
  v_cmp_le_u32 vcc, s41, v6
  s_cbranch_vccnz L_pollok_130
  s_sleep 1
  s_add_u32 s31, s31, 1
  s_cmp_lt_u32 s31, 1048576
  s_cbranch_scc1 L_poll_129
  s_branch L_abort
L_pollok_130:
  s_mov_b32 s32, 0
  s_mov_b32 s33, 131072
  buffer_load_dwordx4 v[64:67], v60, s[4:7], s32 offen offset:0 sc1
  buffer_load_dwordx4 v[68:71], v60, s[4:7], s32 offen offset:2048 sc1
  buffer_load_dwordx4 v[72:75], v61, s[4:7], s32 offen offset:0 sc1
  buffer_load_dwordx4 v[76:79], v61, s[4:7], s32 offen offset:2048 sc1
  buffer_load_dwordx4 v[80:83], v60, s[4:7], s32 offen offset:128 sc1
  buffer_load_dwordx4 v[84:87], v60, s[4:7], s32 offen offset:2176 sc1
  buffer_load_dwordx4 v[88:91], v61, s[4:7], s32 offen offset:128 sc1
  buffer_load_dwordx4 v[92:95], v61, s[4:7], s32 offen offset:2176 sc1
  buffer_load_dwordx4 v[96:99], v60, s[4:7], s33 offen offset:0 sc1
  buffer_load_dwordx4 v[100:103], v60, s[4:7], s33 offen offset:2048 sc1
  buffer_load_dwordx4 v[104:107], v61, s[4:7], s33 offen offset:0 sc1
  buffer_load_dwordx4 v[108:111], v61, s[4:7], s33 offen offset:2048 sc1
  buffer_load_dwordx4 v[112:115], v60, s[4:7], s33 offen offset:128 sc1
  buffer_load_dwordx4 v[116:119], v60, s[4:7], s33 offen offset:2176 sc1
  buffer_load_dwordx4 v[120:123], v61, s[4:7], s33 offen offset:128 sc1
  buffer_load_dwordx4 v[124:127], v61, s[4:7], s33 offen offset:2176 sc1
  buffer_load_dword v25, v24, s[4:7], s38 offen sc1
  v_mov_b32 v28, 0
  v_mov_b32 v29, 0
  v_mov_b32 v30, 0
  v_mov_b32 v31, 0
  v_mov_b32 v32, 0
  v_mov_b32 v33, 0
  v_mov_b32 v34, 0
  v_mov_b32 v35, 0
  v_mov_b32 v36, 0
  v_mov_b32 v37, 0
  v_mov_b32 v38, 0
  v_mov_b32 v39, 0
  v_mov_b32 v40, 0
  v_mov_b32 v41, 0
  v_mov_b32 v42, 0
  v_mov_b32 v43, 0
  v_mov_b32 v44, 0
  v_mov_b32 v45, 0
  v_mov_b32 v46, 0
  v_mov_b32 v47, 0
  v_mov_b32 v48, 0
  v_mov_b32 v49, 0
  v_mov_b32 v50, 0
  v_mov_b32 v51, 0
  v_mov_b32 v52, 0
  v_mov_b32 v53, 0
  v_mov_b32 v54, 0
  v_mov_b32 v55, 0
  v_mov_b32 v56, 0
  v_mov_b32 v57, 0
  v_mov_b32 v58, 0
  v_mov_b32 v59, 0
  s_waitcnt vmcnt(0)
  s_mov_b32 s34, 0
  v_readlane_b32 s39, v25, 1
  s_nop 3
  s_cmp_lt_u32 s39, 8
  s_cbranch_scc1 L_rolate_131
  s_mov_b32 s32, 262144
  s_mov_b32 s33, 393216
  buffer_load_dwordx4 v[128:131], v60, s[4:7], s32 offen offset:0 sc1
  buffer_load_dwordx4 v[132:135], v60, s[4:7], s32 offen offset:2048 sc1
  buffer_load_dwordx4 v[136:139], v61, s[4:7], s32 offen offset:0 sc1
  buffer_load_dwordx4 v[140:143], v61, s[4:7], s32 offen offset:2048 sc1
  buffer_load_dwordx4 v[144:147], v60, s[4:7], s32 offen offset:128 sc1
  buffer_load_dwordx4 v[148:151], v60, s[4:7], s32 offen offset:2176 sc1
  buffer_load_dwordx4 v[152:155], v61, s[4:7], s32 offen offset:128 sc1
  buffer_load_dwordx4 v[156:159], v61, s[4:7], s32 offen offset:2176 sc1
  buffer_load_dwordx4 v[160:163], v60, s[4:7], s33 offen offset:0 sc1
  buffer_load_dwordx4 v[164:167], v60, s[4:7], s33 offen offset:2048 sc1
  buffer_load_dwordx4 v[168:171], v61, s[4:7], s33 offen offset:0 sc1
  buffer_load_dwordx4 v[172:175], v61, s[4:7], s33 offen offset:2048 sc1
  buffer_load_dwordx4 v[176:179], v60, s[4:7], s33 offen offset:128 sc1
  buffer_load_dwordx4 v[180:183], v60, s[4:7], s33 offen offset:2176 sc1
  buffer_load_dwordx4 v[184:187], v61, s[4:7], s33 offen offset:128 sc1
  buffer_load_dwordx4 v[188:191], v61, s[4:7], s33 offen offset:2176 sc1
  s_mov_b32 s34, 1
L_rolate_131:
  v_smfmac_f32_16x16x64_bf16 v[28:31], v[64:67], a[0:7], v4
  v_smfmac_f32_16x16x64_bf16 v[32:35], v[64:67], a[8:15], v4
  v_smfmac_f32_16x16x64_bf16 v[28:31], v[68:71], a[16:23], v4
  v_smfmac_f32_16x16x64_bf16 v[32:35], v[68:71], a[24:31], v4
  v_smfmac_f32_16x16x64_bf16 v[28:31], v[72:75], a[32:39], v4
  v_smfmac_f32_16x16x64_bf16 v[32:35], v[72:75], a[40:47], v4
  v_smfmac_f32_16x16x64_bf16 v[28:31], v[76:79], a[48:55], v4
  v_smfmac_f32_16x16x64_bf16 v[32:35], v[76:79], a[56:63], v4
  v_smfmac_f32_16x16x64_bf16 v[36:39], v[80:83], a[0:7], v4
  v_smfmac_f32_16x16x64_bf16 v[40:43], v[80:83], a[8:15], v4
  v_smfmac_f32_16x16x64_bf16 v[36:39], v[84:87], a[16:23], v4
  v_smfmac_f32_16x16x64_bf16 v[40:43], v[84:87], a[24:31], v4
  v_smfmac_f32_16x16x64_bf16 v[36:39], v[88:91], a[32:39], v4
  v_smfmac_f32_16x16x64_bf16 v[40:43], v[88:91], a[40:47], v4
  v_smfmac_f32_16x16x64_bf16 v[36:39], v[92:95], a[48:55], v4
  v_smfmac_f32_16x16x64_bf16 v[40:43], v[92:95], a[56:63], v4
  v_smfmac_f32_16x16x64_bf16 v[44:47], v[96:99], a[0:7], v4
  v_smfmac_f32_16x16x64_bf16 v[48:51], v[96:99], a[8:15], v4
  v_smfmac_f32_16x16x64_bf16 v[44:47], v[100:103], a[16:23], v4
  v_smfmac_f32_16x16x64_bf16 v[48:51], v[100:103], a[24:31], v4
  v_smfmac_f32_16x16x64_bf16 v[44:47], v[104:107], a[32:39], v4
  v_smfmac_f32_16x16x64_bf16 v[48:51], v[104:107], a[40:47], v4
  v_smfmac_f32_16x16x64_bf16 v[44:47], v[108:111], a[48:55], v4
  v_smfmac_f32_16x16x64_bf16 v[48:51], v[108:111], a[56:63], v4
  v_smfmac_f32_16x16x64_bf16 v[52:55], v[112:115], a[0:7], v4
  v_smfmac_f32_16x16x64_bf16 v[56:59], v[112:115], a[8:15], v4
  v_smfmac_f32_16x16x64_bf16 v[52:55], v[116:119], a[16:23], v4
  v_smfmac_f32_16x16x64_bf16 v[56:59], v[116:119], a[24:31], v4
  v_smfmac_f32_16x16x64_bf16 v[52:55], v[120:123], a[32:39], v4
  v_smfmac_f32_16x16x64_bf16 v[56:59], v[120:123], a[40:47], v4
  v_smfmac_f32_16x16x64_bf16 v[52:55], v[124:127], a[48:55], v4
  v_smfmac_f32_16x16x64_bf16 v[56:59], v[124:127], a[56:63], v4
  v_permlane32_swap_b32 v28, v32
  v_permlane32_swap_b32 v29, v33
  v_permlane32_swap_b32 v30, v34
  v_permlane32_swap_b32 v31, v35
  v_pk_add_f32 v[28:29], v[28:29], v[32:33]
  v_pk_add_f32 v[30:31], v[30:31], v[34:35]
  ds_write2_b32 v12, v28, v29 offset0:0 offset1:36
  ds_write2_b32 v12, v30, v31 offset0:72 offset1:108
  v_permlane32_swap_b32 v36, v40
  v_permlane32_swap_b32 v37, v41
  v_permlane32_swap_b32 v38, v42
  v_permlane32_swap_b32 v39, v43
  v_pk_add_f32 v[36:37], v[36:37], v[40:41]
  v_pk_add_f32 v[38:39], v[38:39], v[42:43]
  ds_write2_b32 v13, v36, v37 offset0:0 offset1:36
  ds_write2_b32 v13, v38, v39 offset0:72 offset1:108
  v_permlane32_swap_b32 v44, v48
  v_permlane32_swap_b32 v45, v49
  v_permlane32_swap_b32 v46, v50
  v_permlane32_swap_b32 v47, v51
  v_pk_add_f32 v[44:45], v[44:45], v[48:49]
  v_pk_add_f32 v[46:47], v[46:47], v[50:51]
  ds_write2_b32 v14, v44, v45 offset0:0 offset1:36
  ds_write2_b32 v14, v46, v47 offset0:72 offset1:108
  s_nop 7
  v_permlane32_swap_b32 v52, v56
  v_permlane32_swap_b32 v53, v57
  v_permlane32_swap_b32 v54, v58
  v_permlane32_swap_b32 v55, v59
  v_pk_add_f32 v[52:53], v[52:53], v[56:57]
  v_pk_add_f32 v[54:55], v[54:55], v[58:59]
  ds_write2_b32 v15, v52, v53 offset0:0 offset1:36
  ds_write2_b32 v15, v54, v55 offset0:72 offset1:108
  s_waitcnt lgkmcnt(0)
  s_barrier
  s_cmp_lg_u32 s34, 0
  s_cbranch_scc1 L_rocont_132
  s_add_u32 s40, s38, 512
  v_mov_b32 v8, 0
  s_mov_b32 s41, 0x8
L_poll_133:
  buffer_load_dword v6, v8, s[4:7], s40 offen sc1
  s_waitcnt vmcnt(0)
  v_cmp_le_u32 vcc, s41, v6
  s_cbranch_vccnz L_pollok_134
  s_sleep 1
  s_add_u32 s31, s31, 1
  s_cmp_lt_u32 s31, 1048576
  s_cbranch_scc1 L_poll_133
  s_branch L_abort
L_pollok_134:
  s_mov_b32 s32, 262144
  s_mov_b32 s33, 393216
  buffer_load_dwordx4 v[128:131], v60, s[4:7], s32 offen offset:0 sc1
  buffer_load_dwordx4 v[132:135], v60, s[4:7], s32 offen offset:2048 sc1
  buffer_load_dwordx4 v[136:139], v61, s[4:7], s32 offen offset:0 sc1
  buffer_load_dwordx4 v[140:143], v61, s[4:7], s32 offen offset:2048 sc1
  buffer_load_dwordx4 v[144:147], v60, s[4:7], s32 offen offset:128 sc1
  buffer_load_dwordx4 v[148:151], v60, s[4:7], s32 offen offset:2176 sc1
  buffer_load_dwordx4 v[152:155], v61, s[4:7], s32 offen offset:128 sc1
  buffer_load_dwordx4 v[156:159], v61, s[4:7], s32 offen offset:2176 sc1
  buffer_load_dwordx4 v[160:163], v60, s[4:7], s33 offen offset:0 sc1
  buffer_load_dwordx4 v[164:167], v60, s[4:7], s33 offen offset:2048 sc1
  buffer_load_dwordx4 v[168:171], v61, s[4:7], s33 offen offset:0 sc1
  buffer_load_dwordx4 v[172:175], v61, s[4:7], s33 offen offset:2048 sc1
  buffer_load_dwordx4 v[176:179], v60, s[4:7], s33 offen offset:128 sc1
  buffer_load_dwordx4 v[180:183], v60, s[4:7], s33 offen offset:2176 sc1
  buffer_load_dwordx4 v[184:187], v61, s[4:7], s33 offen offset:128 sc1
  buffer_load_dwordx4 v[188:191], v61, s[4:7], s33 offen offset:2176 sc1
L_rocont_132:
  buffer_load_dword v25, v24, s[4:7], s38 offen sc1
  v_mov_b32 v28, 0
  v_mov_b32 v29, 0
  v_mov_b32 v30, 0
  v_mov_b32 v31, 0
  v_mov_b32 v32, 0
  v_mov_b32 v33, 0
  v_mov_b32 v34, 0
  v_mov_b32 v35, 0
  v_mov_b32 v36, 0
  v_mov_b32 v37, 0
  v_mov_b32 v38, 0
  v_mov_b32 v39, 0
  v_mov_b32 v40, 0
  v_mov_b32 v41, 0
  v_mov_b32 v42, 0
  v_mov_b32 v43, 0
  v_mov_b32 v44, 0
  v_mov_b32 v45, 0
  v_mov_b32 v46, 0
  v_mov_b32 v47, 0
  v_mov_b32 v48, 0
  v_mov_b32 v49, 0
  v_mov_b32 v50, 0
  v_mov_b32 v51, 0
  v_mov_b32 v52, 0
  v_mov_b32 v53, 0
  v_mov_b32 v54, 0
  v_mov_b32 v55, 0
  v_mov_b32 v56, 0
  v_mov_b32 v57, 0
  v_mov_b32 v58, 0
  v_mov_b32 v59, 0
  s_waitcnt vmcnt(0)
  s_mov_b32 s34, 0
  v_readlane_b32 s39, v25, 2
  s_nop 3
  s_cmp_lt_u32 s39, 8
  s_cbranch_scc1 L_rolate_135
  s_mov_b32 s32, 524288
  s_mov_b32 s33, 655360
  buffer_load_dwordx4 v[64:67], v60, s[4:7], s32 offen offset:0 sc1
  buffer_load_dwordx4 v[68:71], v60, s[4:7], s32 offen offset:2048 sc1
  buffer_load_dwordx4 v[72:75], v61, s[4:7], s32 offen offset:0 sc1
  buffer_load_dwordx4 v[76:79], v61, s[4:7], s32 offen offset:2048 sc1
  buffer_load_dwordx4 v[80:83], v60, s[4:7], s32 offen offset:128 sc1
  buffer_load_dwordx4 v[84:87], v60, s[4:7], s32 offen offset:2176 sc1
  buffer_load_dwordx4 v[88:91], v61, s[4:7], s32 offen offset:128 sc1
  buffer_load_dwordx4 v[92:95], v61, s[4:7], s32 offen offset:2176 sc1
  buffer_load_dwordx4 v[96:99], v60, s[4:7], s33 offen offset:0 sc1
  buffer_load_dwordx4 v[100:103], v60, s[4:7], s33 offen offset:2048 sc1
  buffer_load_dwordx4 v[104:107], v61, s[4:7], s33 offen offset:0 sc1
  buffer_load_dwordx4 v[108:111], v61, s[4:7], s33 offen offset:2048 sc1
  buffer_load_dwordx4 v[112:115], v60, s[4:7], s33 offen offset:128 sc1
  buffer_load_dwordx4 v[116:119], v60, s[4:7], s33 offen offset:2176 sc1
  buffer_load_dwordx4 v[120:123], v61, s[4:7], s33 offen offset:128 sc1
  buffer_load_dwordx4 v[124:127], v61, s[4:7], s33 offen offset:2176 sc1
  s_mov_b32 s34, 1
L_rolate_135:
  v_smfmac_f32_16x16x64_bf16 v[28:31], v[128:131], a[0:7], v4
  v_smfmac_f32_16x16x64_bf16 v[32:35], v[128:131], a[8:15], v4
  v_smfmac_f32_16x16x64_bf16 v[28:31], v[132:135], a[16:23], v4
  v_smfmac_f32_16x16x64_bf16 v[32:35], v[132:135], a[24:31], v4
  v_smfmac_f32_16x16x64_bf16 v[28:31], v[136:139], a[32:39], v4
  v_smfmac_f32_16x16x64_bf16 v[32:35], v[136:139], a[40:47], v4
  v_smfmac_f32_16x16x64_bf16 v[28:31], v[140:143], a[48:55], v4
  v_smfmac_f32_16x16x64_bf16 v[32:35], v[140:143], a[56:63], v4
  v_smfmac_f32_16x16x64_bf16 v[36:39], v[144:147], a[0:7], v4
  v_smfmac_f32_16x16x64_bf16 v[40:43], v[144:147], a[8:15], v4
  v_smfmac_f32_16x16x64_bf16 v[36:39], v[148:151], a[16:23], v4
  v_smfmac_f32_16x16x64_bf16 v[40:43], v[148:151], a[24:31], v4
  v_smfmac_f32_16x16x64_bf16 v[36:39], v[152:155], a[32:39], v4
  v_smfmac_f32_16x16x64_bf16 v[40:43], v[152:155], a[40:47], v4
  v_smfmac_f32_16x16x64_bf16 v[36:39], v[156:159], a[48:55], v4
  v_smfmac_f32_16x16x64_bf16 v[40:43], v[156:159], a[56:63], v4
  v_smfmac_f32_16x16x64_bf16 v[44:47], v[160:163], a[0:7], v4
  v_smfmac_f32_16x16x64_bf16 v[48:51], v[160:163], a[8:15], v4
  v_smfmac_f32_16x16x64_bf16 v[44:47], v[164:167], a[16:23], v4
  v_smfmac_f32_16x16x64_bf16 v[48:51], v[164:167], a[24:31], v4
  v_smfmac_f32_16x16x64_bf16 v[44:47], v[168:171], a[32:39], v4
  v_smfmac_f32_16x16x64_bf16 v[48:51], v[168:171], a[40:47], v4
  v_smfmac_f32_16x16x64_bf16 v[44:47], v[172:175], a[48:55], v4
  v_smfmac_f32_16x16x64_bf16 v[48:51], v[172:175], a[56:63], v4
  v_smfmac_f32_16x16x64_bf16 v[52:55], v[176:179], a[0:7], v4
  v_smfmac_f32_16x16x64_bf16 v[56:59], v[176:179], a[8:15], v4
  v_smfmac_f32_16x16x64_bf16 v[52:55], v[180:183], a[16:23], v4
  v_smfmac_f32_16x16x64_bf16 v[56:59], v[180:183], a[24:31], v4
  v_smfmac_f32_16x16x64_bf16 v[52:55], v[184:187], a[32:39], v4
  v_smfmac_f32_16x16x64_bf16 v[56:59], v[184:187], a[40:47], v4
  v_smfmac_f32_16x16x64_bf16 v[52:55], v[188:191], a[48:55], v4
  v_smfmac_f32_16x16x64_bf16 v[56:59], v[188:191], a[56:63], v4
  v_permlane32_swap_b32 v28, v32
  v_permlane32_swap_b32 v29, v33
  v_permlane32_swap_b32 v30, v34
  v_permlane32_swap_b32 v31, v35
  v_pk_add_f32 v[28:29], v[28:29], v[32:33]
  v_pk_add_f32 v[30:31], v[30:31], v[34:35]
  ds_write2_b32 v16, v28, v29 offset0:0 offset1:36
  ds_write2_b32 v16, v30, v31 offset0:72 offset1:108
  v_permlane32_swap_b32 v36, v40
  v_permlane32_swap_b32 v37, v41
  v_permlane32_swap_b32 v38, v42
  v_permlane32_swap_b32 v39, v43
  v_pk_add_f32 v[36:37], v[36:37], v[40:41]
  v_pk_add_f32 v[38:39], v[38:39], v[42:43]
  ds_write2_b32 v17, v36, v37 offset0:0 offset1:36
  ds_write2_b32 v17, v38, v39 offset0:72 offset1:108
  v_permlane32_swap_b32 v44, v48
  v_permlane32_swap_b32 v45, v49
  v_permlane32_swap_b32 v46, v50
  v_permlane32_swap_b32 v47, v51
  v_pk_add_f32 v[44:45], v[44:45], v[48:49]
  v_pk_add_f32 v[46:47], v[46:47], v[50:51]
  ds_write2_b32 v18, v44, v45 offset0:0 offset1:36
  ds_write2_b32 v18, v46, v47 offset0:72 offset1:108
  s_nop 7
  v_permlane32_swap_b32 v52, v56
  v_permlane32_swap_b32 v53, v57
  v_permlane32_swap_b32 v54, v58
  v_permlane32_swap_b32 v55, v59
  v_pk_add_f32 v[52:53], v[52:53], v[56:57]
  v_pk_add_f32 v[54:55], v[54:55], v[58:59]
  ds_write2_b32 v19, v52, v53 offset0:0 offset1:36
  ds_write2_b32 v19, v54, v55 offset0:72 offset1:108
  s_waitcnt lgkmcnt(0)
  s_barrier
  s_cmp_lg_u32 s34, 0
  s_cbranch_scc1 L_rocont_136
  s_add_u32 s40, s38, 1024
  v_mov_b32 v8, 0
  s_mov_b32 s41, 0x8
L_poll_137:
  buffer_load_dword v6, v8, s[4:7], s40 offen sc1
  s_waitcnt vmcnt(0)
  v_cmp_le_u32 vcc, s41, v6
  s_cbranch_vccnz L_pollok_138
  s_sleep 1
  s_add_u32 s31, s31, 1
  s_cmp_lt_u32 s31, 1048576
  s_cbranch_scc1 L_poll_137
  s_branch L_abort
L_pollok_138:
  s_mov_b32 s32, 524288
  s_mov_b32 s33, 655360
  buffer_load_dwordx4 v[64:67], v60, s[4:7], s32 offen offset:0 sc1
  buffer_load_dwordx4 v[68:71], v60, s[4:7], s32 offen offset:2048 sc1
  buffer_load_dwordx4 v[72:75], v61, s[4:7], s32 offen offset:0 sc1
  buffer_load_dwordx4 v[76:79], v61, s[4:7], s32 offen offset:2048 sc1
  buffer_load_dwordx4 v[80:83], v60, s[4:7], s32 offen offset:128 sc1
  buffer_load_dwordx4 v[84:87], v60, s[4:7], s32 offen offset:2176 sc1
  buffer_load_dwordx4 v[88:91], v61, s[4:7], s32 offen offset:128 sc1
  buffer_load_dwordx4 v[92:95], v61, s[4:7], s32 offen offset:2176 sc1
  buffer_load_dwordx4 v[96:99], v60, s[4:7], s33 offen offset:0 sc1
  buffer_load_dwordx4 v[100:103], v60, s[4:7], s33 offen offset:2048 sc1
  buffer_load_dwordx4 v[104:107], v61, s[4:7], s33 offen offset:0 sc1
  buffer_load_dwordx4 v[108:111], v61, s[4:7], s33 offen offset:2048 sc1
  buffer_load_dwordx4 v[112:115], v60, s[4:7], s33 offen offset:128 sc1
  buffer_load_dwordx4 v[116:119], v60, s[4:7], s33 offen offset:2176 sc1
  buffer_load_dwordx4 v[120:123], v61, s[4:7], s33 offen offset:128 sc1
  buffer_load_dwordx4 v[124:127], v61, s[4:7], s33 offen offset:2176 sc1
L_rocont_136:
  buffer_load_dword v25, v24, s[4:7], s38 offen sc1
  v_mov_b32 v28, 0
  v_mov_b32 v29, 0
  v_mov_b32 v30, 0
  v_mov_b32 v31, 0
  v_mov_b32 v32, 0
  v_mov_b32 v33, 0
  v_mov_b32 v34, 0
  v_mov_b32 v35, 0
  v_mov_b32 v36, 0
  v_mov_b32 v37, 0
  v_mov_b32 v38, 0
  v_mov_b32 v39, 0
  v_mov_b32 v40, 0
  v_mov_b32 v41, 0
  v_mov_b32 v42, 0
  v_mov_b32 v43, 0
  v_mov_b32 v44, 0
  v_mov_b32 v45, 0
  v_mov_b32 v46, 0
  v_mov_b32 v47, 0
  v_mov_b32 v48, 0
  v_mov_b32 v49, 0
  v_mov_b32 v50, 0
  v_mov_b32 v51, 0
  v_mov_b32 v52, 0
  v_mov_b32 v53, 0
  v_mov_b32 v54, 0
  v_mov_b32 v55, 0
  v_mov_b32 v56, 0
  v_mov_b32 v57, 0
  v_mov_b32 v58, 0
  v_mov_b32 v59, 0
  s_waitcnt vmcnt(0)
  s_mov_b32 s34, 0
  v_readlane_b32 s39, v25, 3
  s_nop 3
  s_cmp_lt_u32 s39, 8
  s_cbranch_scc1 L_rolate_139
  s_mov_b32 s32, 786432
  s_mov_b32 s33, 917504
  buffer_load_dwordx4 v[128:131], v60, s[4:7], s32 offen offset:0 sc1
  buffer_load_dwordx4 v[132:135], v60, s[4:7], s32 offen offset:2048 sc1
  buffer_load_dwordx4 v[136:139], v61, s[4:7], s32 offen offset:0 sc1
  buffer_load_dwordx4 v[140:143], v61, s[4:7], s32 offen offset:2048 sc1
  buffer_load_dwordx4 v[144:147], v60, s[4:7], s32 offen offset:128 sc1
  buffer_load_dwordx4 v[148:151], v60, s[4:7], s32 offen offset:2176 sc1
  buffer_load_dwordx4 v[152:155], v61, s[4:7], s32 offen offset:128 sc1
  buffer_load_dwordx4 v[156:159], v61, s[4:7], s32 offen offset:2176 sc1
  buffer_load_dwordx4 v[160:163], v60, s[4:7], s33 offen offset:0 sc1
  buffer_load_dwordx4 v[164:167], v60, s[4:7], s33 offen offset:2048 sc1
  buffer_load_dwordx4 v[168:171], v61, s[4:7], s33 offen offset:0 sc1
  buffer_load_dwordx4 v[172:175], v61, s[4:7], s33 offen offset:2048 sc1
  buffer_load_dwordx4 v[176:179], v60, s[4:7], s33 offen offset:128 sc1
  buffer_load_dwordx4 v[180:183], v60, s[4:7], s33 offen offset:2176 sc1
  buffer_load_dwordx4 v[184:187], v61, s[4:7], s33 offen offset:128 sc1
  buffer_load_dwordx4 v[188:191], v61, s[4:7], s33 offen offset:2176 sc1
  s_mov_b32 s34, 1
L_rolate_139:
  v_smfmac_f32_16x16x64_bf16 v[28:31], v[64:67], a[0:7], v4
  v_smfmac_f32_16x16x64_bf16 v[32:35], v[64:67], a[8:15], v4
  v_smfmac_f32_16x16x64_bf16 v[28:31], v[68:71], a[16:23], v4
  v_smfmac_f32_16x16x64_bf16 v[32:35], v[68:71], a[24:31], v4
  v_smfmac_f32_16x16x64_bf16 v[28:31], v[72:75], a[32:39], v4
  v_smfmac_f32_16x16x64_bf16 v[32:35], v[72:75], a[40:47], v4
  v_smfmac_f32_16x16x64_bf16 v[28:31], v[76:79], a[48:55], v4
  v_smfmac_f32_16x16x64_bf16 v[32:35], v[76:79], a[56:63], v4
  v_smfmac_f32_16x16x64_bf16 v[36:39], v[80:83], a[0:7], v4
  v_smfmac_f32_16x16x64_bf16 v[40:43], v[80:83], a[8:15], v4
  v_smfmac_f32_16x16x64_bf16 v[36:39], v[84:87], a[16:23], v4
  v_smfmac_f32_16x16x64_bf16 v[40:43], v[84:87], a[24:31], v4
  v_smfmac_f32_16x16x64_bf16 v[36:39], v[88:91], a[32:39], v4
  v_smfmac_f32_16x16x64_bf16 v[40:43], v[88:91], a[40:47], v4
  v_smfmac_f32_16x16x64_bf16 v[36:39], v[92:95], a[48:55], v4
  v_smfmac_f32_16x16x64_bf16 v[40:43], v[92:95], a[56:63], v4
  v_smfmac_f32_16x16x64_bf16 v[44:47], v[96:99], a[0:7], v4
  v_smfmac_f32_16x16x64_bf16 v[48:51], v[96:99], a[8:15], v4
  v_smfmac_f32_16x16x64_bf16 v[44:47], v[100:103], a[16:23], v4
  v_smfmac_f32_16x16x64_bf16 v[48:51], v[100:103], a[24:31], v4
  v_smfmac_f32_16x16x64_bf16 v[44:47], v[104:107], a[32:39], v4
  v_smfmac_f32_16x16x64_bf16 v[48:51], v[104:107], a[40:47], v4
  v_smfmac_f32_16x16x64_bf16 v[44:47], v[108:111], a[48:55], v4
  v_smfmac_f32_16x16x64_bf16 v[48:51], v[108:111], a[56:63], v4
  v_smfmac_f32_16x16x64_bf16 v[52:55], v[112:115], a[0:7], v4
  v_smfmac_f32_16x16x64_bf16 v[56:59], v[112:115], a[8:15], v4
  v_smfmac_f32_16x16x64_bf16 v[52:55], v[116:119], a[16:23], v4
  v_smfmac_f32_16x16x64_bf16 v[56:59], v[116:119], a[24:31], v4
  v_smfmac_f32_16x16x64_bf16 v[52:55], v[120:123], a[32:39], v4
  v_smfmac_f32_16x16x64_bf16 v[56:59], v[120:123], a[40:47], v4
  v_smfmac_f32_16x16x64_bf16 v[52:55], v[124:127], a[48:55], v4
  v_smfmac_f32_16x16x64_bf16 v[56:59], v[124:127], a[56:63], v4
  v_permlane32_swap_b32 v28, v32
  v_permlane32_swap_b32 v29, v33
  v_permlane32_swap_b32 v30, v34
  v_permlane32_swap_b32 v31, v35
  v_pk_add_f32 v[28:29], v[28:29], v[32:33]
  v_pk_add_f32 v[30:31], v[30:31], v[34:35]
  ds_write2_b32 v12, v28, v29 offset0:0 offset1:36
  ds_write2_b32 v12, v30, v31 offset0:72 offset1:108
  v_permlane32_swap_b32 v36, v40
  v_permlane32_swap_b32 v37, v41
  v_permlane32_swap_b32 v38, v42
  v_permlane32_swap_b32 v39, v43
  v_pk_add_f32 v[36:37], v[36:37], v[40:41]
  v_pk_add_f32 v[38:39], v[38:39], v[42:43]
  ds_write2_b32 v13, v36, v37 offset0:0 offset1:36
  ds_write2_b32 v13, v38, v39 offset0:72 offset1:108
  v_permlane32_swap_b32 v44, v48
  v_permlane32_swap_b32 v45, v49
  v_permlane32_swap_b32 v46, v50
  v_permlane32_swap_b32 v47, v51
  v_pk_add_f32 v[44:45], v[44:45], v[48:49]
  v_pk_add_f32 v[46:47], v[46:47], v[50:51]
  ds_write2_b32 v14, v44, v45 offset0:0 offset1:36
  ds_write2_b32 v14, v46, v47 offset0:72 offset1:108
  s_nop 7
  v_permlane32_swap_b32 v52, v56
  v_permlane32_swap_b32 v53, v57
  v_permlane32_swap_b32 v54, v58
  v_permlane32_swap_b32 v55, v59
  v_pk_add_f32 v[52:53], v[52:53], v[56:57]
  v_pk_add_f32 v[54:55], v[54:55], v[58:59]
  ds_write2_b32 v15, v52, v53 offset0:0 offset1:36
  ds_write2_b32 v15, v54, v55 offset0:72 offset1:108
  s_waitcnt lgkmcnt(0)
  s_barrier
  s_cmp_lg_u32 s34, 0
  s_cbranch_scc1 L_rocont_140
  s_add_u32 s40, s38, 1536
  v_mov_b32 v8, 0
  s_mov_b32 s41, 0x8
L_poll_141:
  buffer_load_dword v6, v8, s[4:7], s40 offen sc1
  s_waitcnt vmcnt(0)
  v_cmp_le_u32 vcc, s41, v6
  s_cbranch_vccnz L_pollok_142
  s_sleep 1
  s_add_u32 s31, s31, 1
  s_cmp_lt_u32 s31, 1048576
  s_cbranch_scc1 L_poll_141
  s_branch L_abort
L_pollok_142:
  s_mov_b32 s32, 786432
  s_mov_b32 s33, 917504
  buffer_load_dwordx4 v[128:131], v60, s[4:7], s32 offen offset:0 sc1
  buffer_load_dwordx4 v[132:135], v60, s[4:7], s32 offen offset:2048 sc1
  buffer_load_dwordx4 v[136:139], v61, s[4:7], s32 offen offset:0 sc1
  buffer_load_dwordx4 v[140:143], v61, s[4:7], s32 offen offset:2048 sc1
  buffer_load_dwordx4 v[144:147], v60, s[4:7], s32 offen offset:128 sc1
  buffer_load_dwordx4 v[148:151], v60, s[4:7], s32 offen offset:2176 sc1
  buffer_load_dwordx4 v[152:155], v61, s[4:7], s32 offen offset:128 sc1
  buffer_load_dwordx4 v[156:159], v61, s[4:7], s32 offen offset:2176 sc1
  buffer_load_dwordx4 v[160:163], v60, s[4:7], s33 offen offset:0 sc1
  buffer_load_dwordx4 v[164:167], v60, s[4:7], s33 offen offset:2048 sc1
  buffer_load_dwordx4 v[168:171], v61, s[4:7], s33 offen offset:0 sc1
  buffer_load_dwordx4 v[172:175], v61, s[4:7], s33 offen offset:2048 sc1
  buffer_load_dwordx4 v[176:179], v60, s[4:7], s33 offen offset:128 sc1
  buffer_load_dwordx4 v[180:183], v60, s[4:7], s33 offen offset:2176 sc1
  buffer_load_dwordx4 v[184:187], v61, s[4:7], s33 offen offset:128 sc1
  buffer_load_dwordx4 v[188:191], v61, s[4:7], s33 offen offset:2176 sc1
L_rocont_140:
  buffer_load_dword v25, v24, s[4:7], s38 offen sc1
  v_mov_b32 v28, 0
  v_mov_b32 v29, 0
  v_mov_b32 v30, 0
  v_mov_b32 v31, 0
  v_mov_b32 v32, 0
  v_mov_b32 v33, 0
  v_mov_b32 v34, 0
  v_mov_b32 v35, 0
  v_mov_b32 v36, 0
  v_mov_b32 v37, 0
  v_mov_b32 v38, 0
  v_mov_b32 v39, 0
  v_mov_b32 v40, 0
  v_mov_b32 v41, 0
  v_mov_b32 v42, 0
  v_mov_b32 v43, 0
  v_mov_b32 v44, 0
  v_mov_b32 v45, 0
  v_mov_b32 v46, 0
  v_mov_b32 v47, 0
  v_mov_b32 v48, 0
  v_mov_b32 v49, 0
  v_mov_b32 v50, 0
  v_mov_b32 v51, 0
  v_mov_b32 v52, 0
  v_mov_b32 v53, 0
  v_mov_b32 v54, 0
  v_mov_b32 v55, 0
  v_mov_b32 v56, 0
  v_mov_b32 v57, 0
  v_mov_b32 v58, 0
  v_mov_b32 v59, 0
  s_waitcnt vmcnt(0)
  s_mov_b32 s34, 0
  v_readlane_b32 s39, v25, 4
  s_nop 3
  s_cmp_lt_u32 s39, 8
  s_cbranch_scc1 L_rolate_143
  s_mov_b32 s32, 1048576
  s_mov_b32 s33, 1179648
  buffer_load_dwordx4 v[64:67], v60, s[4:7], s32 offen offset:0 sc1
  buffer_load_dwordx4 v[68:71], v60, s[4:7], s32 offen offset:2048 sc1
  buffer_load_dwordx4 v[72:75], v61, s[4:7], s32 offen offset:0 sc1
  buffer_load_dwordx4 v[76:79], v61, s[4:7], s32 offen offset:2048 sc1
  buffer_load_dwordx4 v[80:83], v60, s[4:7], s32 offen offset:128 sc1
  buffer_load_dwordx4 v[84:87], v60, s[4:7], s32 offen offset:2176 sc1
  buffer_load_dwordx4 v[88:91], v61, s[4:7], s32 offen offset:128 sc1
  buffer_load_dwordx4 v[92:95], v61, s[4:7], s32 offen offset:2176 sc1
  buffer_load_dwordx4 v[96:99], v60, s[4:7], s33 offen offset:0 sc1
  buffer_load_dwordx4 v[100:103], v60, s[4:7], s33 offen offset:2048 sc1
  buffer_load_dwordx4 v[104:107], v61, s[4:7], s33 offen offset:0 sc1
  buffer_load_dwordx4 v[108:111], v61, s[4:7], s33 offen offset:2048 sc1
  buffer_load_dwordx4 v[112:115], v60, s[4:7], s33 offen offset:128 sc1
  buffer_load_dwordx4 v[116:119], v60, s[4:7], s33 offen offset:2176 sc1
  buffer_load_dwordx4 v[120:123], v61, s[4:7], s33 offen offset:128 sc1
  buffer_load_dwordx4 v[124:127], v61, s[4:7], s33 offen offset:2176 sc1
  s_mov_b32 s34, 1
L_rolate_143:
  v_smfmac_f32_16x16x64_bf16 v[28:31], v[128:131], a[0:7], v4
  v_smfmac_f32_16x16x64_bf16 v[32:35], v[128:131], a[8:15], v4
  v_smfmac_f32_16x16x64_bf16 v[28:31], v[132:135], a[16:23], v4
  v_smfmac_f32_16x16x64_bf16 v[32:35], v[132:135], a[24:31], v4
  v_smfmac_f32_16x16x64_bf16 v[28:31], v[136:139], a[32:39], v4
  v_smfmac_f32_16x16x64_bf16 v[32:35], v[136:139], a[40:47], v4
  v_smfmac_f32_16x16x64_bf16 v[28:31], v[140:143], a[48:55], v4
  v_smfmac_f32_16x16x64_bf16 v[32:35], v[140:143], a[56:63], v4
  v_smfmac_f32_16x16x64_bf16 v[36:39], v[144:147], a[0:7], v4
  v_smfmac_f32_16x16x64_bf16 v[40:43], v[144:147], a[8:15], v4
  v_smfmac_f32_16x16x64_bf16 v[36:39], v[148:151], a[16:23], v4
  v_smfmac_f32_16x16x64_bf16 v[40:43], v[148:151], a[24:31], v4
  v_smfmac_f32_16x16x64_bf16 v[36:39], v[152:155], a[32:39], v4
  v_smfmac_f32_16x16x64_bf16 v[40:43], v[152:155], a[40:47], v4
  v_smfmac_f32_16x16x64_bf16 v[36:39], v[156:159], a[48:55], v4
  v_smfmac_f32_16x16x64_bf16 v[40:43], v[156:159], a[56:63], v4
  v_smfmac_f32_16x16x64_bf16 v[44:47], v[160:163], a[0:7], v4
  v_smfmac_f32_16x16x64_bf16 v[48:51], v[160:163], a[8:15], v4
  v_smfmac_f32_16x16x64_bf16 v[44:47], v[164:167], a[16:23], v4
  v_smfmac_f32_16x16x64_bf16 v[48:51], v[164:167], a[24:31], v4
  v_smfmac_f32_16x16x64_bf16 v[44:47], v[168:171], a[32:39], v4
  v_smfmac_f32_16x16x64_bf16 v[48:51], v[168:171], a[40:47], v4
  v_smfmac_f32_16x16x64_bf16 v[44:47], v[172:175], a[48:55], v4
  v_smfmac_f32_16x16x64_bf16 v[48:51], v[172:175], a[56:63], v4
  v_smfmac_f32_16x16x64_bf16 v[52:55], v[176:179], a[0:7], v4
  v_smfmac_f32_16x16x64_bf16 v[56:59], v[176:179], a[8:15], v4
  v_smfmac_f32_16x16x64_bf16 v[52:55], v[180:183], a[16:23], v4
  v_smfmac_f32_16x16x64_bf16 v[56:59], v[180:183], a[24:31], v4
  v_smfmac_f32_16x16x64_bf16 v[52:55], v[184:187], a[32:39], v4
  v_smfmac_f32_16x16x64_bf16 v[56:59], v[184:187], a[40:47], v4
  v_smfmac_f32_16x16x64_bf16 v[52:55], v[188:191], a[48:55], v4
  v_smfmac_f32_16x16x64_bf16 v[56:59], v[188:191], a[56:63], v4
  v_permlane32_swap_b32 v28, v32
  v_permlane32_swap_b32 v29, v33
  v_permlane32_swap_b32 v30, v34
  v_permlane32_swap_b32 v31, v35
  v_pk_add_f32 v[28:29], v[28:29], v[32:33]
  v_pk_add_f32 v[30:31], v[30:31], v[34:35]
  ds_write2_b32 v16, v28, v29 offset0:0 offset1:36
  ds_write2_b32 v16, v30, v31 offset0:72 offset1:108
  v_permlane32_swap_b32 v36, v40
  v_permlane32_swap_b32 v37, v41
  v_permlane32_swap_b32 v38, v42
  v_permlane32_swap_b32 v39, v43
  v_pk_add_f32 v[36:37], v[36:37], v[40:41]
  v_pk_add_f32 v[38:39], v[38:39], v[42:43]
  ds_write2_b32 v17, v36, v37 offset0:0 offset1:36
  ds_write2_b32 v17, v38, v39 offset0:72 offset1:108
  v_permlane32_swap_b32 v44, v48
  v_permlane32_swap_b32 v45, v49
  v_permlane32_swap_b32 v46, v50
  v_permlane32_swap_b32 v47, v51
  v_pk_add_f32 v[44:45], v[44:45], v[48:49]
  v_pk_add_f32 v[46:47], v[46:47], v[50:51]
  ds_write2_b32 v18, v44, v45 offset0:0 offset1:36
  ds_write2_b32 v18, v46, v47 offset0:72 offset1:108
  s_nop 7
  v_permlane32_swap_b32 v52, v56
  v_permlane32_swap_b32 v53, v57
  v_permlane32_swap_b32 v54, v58
  v_permlane32_swap_b32 v55, v59
  v_pk_add_f32 v[52:53], v[52:53], v[56:57]
  v_pk_add_f32 v[54:55], v[54:55], v[58:59]
  ds_write2_b32 v19, v52, v53 offset0:0 offset1:36
  ds_write2_b32 v19, v54, v55 offset0:72 offset1:108
  s_waitcnt lgkmcnt(0)
  s_barrier
  s_cmp_lg_u32 s34, 0
  s_cbranch_scc1 L_rocont_144
  s_add_u32 s40, s38, 2048
  v_mov_b32 v8, 0
  s_mov_b32 s41, 0x8
L_poll_145:
  buffer_load_dword v6, v8, s[4:7], s40 offen sc1
  s_waitcnt vmcnt(0)
  v_cmp_le_u32 vcc, s41, v6
  s_cbranch_vccnz L_pollok_146
  s_sleep 1
  s_add_u32 s31, s31, 1
  s_cmp_lt_u32 s31, 1048576
  s_cbranch_scc1 L_poll_145
  s_branch L_abort
L_pollok_146:
  s_mov_b32 s32, 1048576
  s_mov_b32 s33, 1179648
  buffer_load_dwordx4 v[64:67], v60, s[4:7], s32 offen offset:0 sc1
  buffer_load_dwordx4 v[68:71], v60, s[4:7], s32 offen offset:2048 sc1
  buffer_load_dwordx4 v[72:75], v61, s[4:7], s32 offen offset:0 sc1
  buffer_load_dwordx4 v[76:79], v61, s[4:7], s32 offen offset:2048 sc1
  buffer_load_dwordx4 v[80:83], v60, s[4:7], s32 offen offset:128 sc1
  buffer_load_dwordx4 v[84:87], v60, s[4:7], s32 offen offset:2176 sc1
  buffer_load_dwordx4 v[88:91], v61, s[4:7], s32 offen offset:128 sc1
  buffer_load_dwordx4 v[92:95], v61, s[4:7], s32 offen offset:2176 sc1
  buffer_load_dwordx4 v[96:99], v60, s[4:7], s33 offen offset:0 sc1
  buffer_load_dwordx4 v[100:103], v60, s[4:7], s33 offen offset:2048 sc1
  buffer_load_dwordx4 v[104:107], v61, s[4:7], s33 offen offset:0 sc1
  buffer_load_dwordx4 v[108:111], v61, s[4:7], s33 offen offset:2048 sc1
  buffer_load_dwordx4 v[112:115], v60, s[4:7], s33 offen offset:128 sc1
  buffer_load_dwordx4 v[116:119], v60, s[4:7], s33 offen offset:2176 sc1
  buffer_load_dwordx4 v[120:123], v61, s[4:7], s33 offen offset:128 sc1
  buffer_load_dwordx4 v[124:127], v61, s[4:7], s33 offen offset:2176 sc1
L_rocont_144:
  buffer_load_dword v25, v24, s[4:7], s38 offen sc1
  v_mov_b32 v28, 0
  v_mov_b32 v29, 0
  v_mov_b32 v30, 0
  v_mov_b32 v31, 0
  v_mov_b32 v32, 0
  v_mov_b32 v33, 0
  v_mov_b32 v34, 0
  v_mov_b32 v35, 0
  v_mov_b32 v36, 0
  v_mov_b32 v37, 0
  v_mov_b32 v38, 0
  v_mov_b32 v39, 0
  v_mov_b32 v40, 0
  v_mov_b32 v41, 0
  v_mov_b32 v42, 0
  v_mov_b32 v43, 0
  v_mov_b32 v44, 0
  v_mov_b32 v45, 0
  v_mov_b32 v46, 0
  v_mov_b32 v47, 0
  v_mov_b32 v48, 0
  v_mov_b32 v49, 0
  v_mov_b32 v50, 0
  v_mov_b32 v51, 0
  v_mov_b32 v52, 0
  v_mov_b32 v53, 0
  v_mov_b32 v54, 0
  v_mov_b32 v55, 0
  v_mov_b32 v56, 0
  v_mov_b32 v57, 0
  v_mov_b32 v58, 0
  v_mov_b32 v59, 0
  s_waitcnt vmcnt(0)
  s_mov_b32 s34, 0
  v_readlane_b32 s39, v25, 5
  s_nop 3
  s_cmp_lt_u32 s39, 8
  s_cbranch_scc1 L_rolate_147
  s_mov_b32 s32, 1310720
  s_mov_b32 s33, 1441792
  buffer_load_dwordx4 v[128:131], v60, s[4:7], s32 offen offset:0 sc1
  buffer_load_dwordx4 v[132:135], v60, s[4:7], s32 offen offset:2048 sc1
  buffer_load_dwordx4 v[136:139], v61, s[4:7], s32 offen offset:0 sc1
  buffer_load_dwordx4 v[140:143], v61, s[4:7], s32 offen offset:2048 sc1
  buffer_load_dwordx4 v[144:147], v60, s[4:7], s32 offen offset:128 sc1
  buffer_load_dwordx4 v[148:151], v60, s[4:7], s32 offen offset:2176 sc1
  buffer_load_dwordx4 v[152:155], v61, s[4:7], s32 offen offset:128 sc1
  buffer_load_dwordx4 v[156:159], v61, s[4:7], s32 offen offset:2176 sc1
  buffer_load_dwordx4 v[160:163], v60, s[4:7], s33 offen offset:0 sc1
  buffer_load_dwordx4 v[164:167], v60, s[4:7], s33 offen offset:2048 sc1
  buffer_load_dwordx4 v[168:171], v61, s[4:7], s33 offen offset:0 sc1
  buffer_load_dwordx4 v[172:175], v61, s[4:7], s33 offen offset:2048 sc1
  buffer_load_dwordx4 v[176:179], v60, s[4:7], s33 offen offset:128 sc1
  buffer_load_dwordx4 v[180:183], v60, s[4:7], s33 offen offset:2176 sc1
  buffer_load_dwordx4 v[184:187], v61, s[4:7], s33 offen offset:128 sc1
  buffer_load_dwordx4 v[188:191], v61, s[4:7], s33 offen offset:2176 sc1
  s_mov_b32 s34, 1
L_rolate_147:
  v_smfmac_f32_16x16x64_bf16 v[28:31], v[64:67], a[0:7], v4
  v_smfmac_f32_16x16x64_bf16 v[32:35], v[64:67], a[8:15], v4
  v_smfmac_f32_16x16x64_bf16 v[28:31], v[68:71], a[16:23], v4
  v_smfmac_f32_16x16x64_bf16 v[32:35], v[68:71], a[24:31], v4
  v_smfmac_f32_16x16x64_bf16 v[28:31], v[72:75], a[32:39], v4
  v_smfmac_f32_16x16x64_bf16 v[32:35], v[72:75], a[40:47], v4
  v_smfmac_f32_16x16x64_bf16 v[28:31], v[76:79], a[48:55], v4
  v_smfmac_f32_16x16x64_bf16 v[32:35], v[76:79], a[56:63], v4
  v_smfmac_f32_16x16x64_bf16 v[36:39], v[80:83], a[0:7], v4
  v_smfmac_f32_16x16x64_bf16 v[40:43], v[80:83], a[8:15], v4
  v_smfmac_f32_16x16x64_bf16 v[36:39], v[84:87], a[16:23], v4
  v_smfmac_f32_16x16x64_bf16 v[40:43], v[84:87], a[24:31], v4
  v_smfmac_f32_16x16x64_bf16 v[36:39], v[88:91], a[32:39], v4
  v_smfmac_f32_16x16x64_bf16 v[40:43], v[88:91], a[40:47], v4
  v_smfmac_f32_16x16x64_bf16 v[36:39], v[92:95], a[48:55], v4
  v_smfmac_f32_16x16x64_bf16 v[40:43], v[92:95], a[56:63], v4
  v_smfmac_f32_16x16x64_bf16 v[44:47], v[96:99], a[0:7], v4
  v_smfmac_f32_16x16x64_bf16 v[48:51], v[96:99], a[8:15], v4
  v_smfmac_f32_16x16x64_bf16 v[44:47], v[100:103], a[16:23], v4
  v_smfmac_f32_16x16x64_bf16 v[48:51], v[100:103], a[24:31], v4
  v_smfmac_f32_16x16x64_bf16 v[44:47], v[104:107], a[32:39], v4
  v_smfmac_f32_16x16x64_bf16 v[48:51], v[104:107], a[40:47], v4
  v_smfmac_f32_16x16x64_bf16 v[44:47], v[108:111], a[48:55], v4
  v_smfmac_f32_16x16x64_bf16 v[48:51], v[108:111], a[56:63], v4
  v_smfmac_f32_16x16x64_bf16 v[52:55], v[112:115], a[0:7], v4
  v_smfmac_f32_16x16x64_bf16 v[56:59], v[112:115], a[8:15], v4
  v_smfmac_f32_16x16x64_bf16 v[52:55], v[116:119], a[16:23], v4
  v_smfmac_f32_16x16x64_bf16 v[56:59], v[116:119], a[24:31], v4
  v_smfmac_f32_16x16x64_bf16 v[52:55], v[120:123], a[32:39], v4
  v_smfmac_f32_16x16x64_bf16 v[56:59], v[120:123], a[40:47], v4
  v_smfmac_f32_16x16x64_bf16 v[52:55], v[124:127], a[48:55], v4
  v_smfmac_f32_16x16x64_bf16 v[56:59], v[124:127], a[56:63], v4
  v_permlane32_swap_b32 v28, v32
  v_permlane32_swap_b32 v29, v33
  v_permlane32_swap_b32 v30, v34
  v_permlane32_swap_b32 v31, v35
  v_pk_add_f32 v[28:29], v[28:29], v[32:33]
  v_pk_add_f32 v[30:31], v[30:31], v[34:35]
  ds_write2_b32 v12, v28, v29 offset0:0 offset1:36
  ds_write2_b32 v12, v30, v31 offset0:72 offset1:108
  v_permlane32_swap_b32 v36, v40
  v_permlane32_swap_b32 v37, v41
  v_permlane32_swap_b32 v38, v42
  v_permlane32_swap_b32 v39, v43
  v_pk_add_f32 v[36:37], v[36:37], v[40:41]
  v_pk_add_f32 v[38:39], v[38:39], v[42:43]
  ds_write2_b32 v13, v36, v37 offset0:0 offset1:36
  ds_write2_b32 v13, v38, v39 offset0:72 offset1:108
  v_permlane32_swap_b32 v44, v48
  v_permlane32_swap_b32 v45, v49
  v_permlane32_swap_b32 v46, v50
  v_permlane32_swap_b32 v47, v51
  v_pk_add_f32 v[44:45], v[44:45], v[48:49]
  v_pk_add_f32 v[46:47], v[46:47], v[50:51]
  ds_write2_b32 v14, v44, v45 offset0:0 offset1:36
  ds_write2_b32 v14, v46, v47 offset0:72 offset1:108
  s_nop 7
  v_permlane32_swap_b32 v52, v56
  v_permlane32_swap_b32 v53, v57
  v_permlane32_swap_b32 v54, v58
  v_permlane32_swap_b32 v55, v59
  v_pk_add_f32 v[52:53], v[52:53], v[56:57]
  v_pk_add_f32 v[54:55], v[54:55], v[58:59]
  ds_write2_b32 v15, v52, v53 offset0:0 offset1:36
  ds_write2_b32 v15, v54, v55 offset0:72 offset1:108
  s_waitcnt lgkmcnt(0)
  s_barrier
  s_cmp_lg_u32 s34, 0
  s_cbranch_scc1 L_rocont_148
  s_add_u32 s40, s38, 2560
  v_mov_b32 v8, 0
  s_mov_b32 s41, 0x8
L_poll_149:
  buffer_load_dword v6, v8, s[4:7], s40 offen sc1
  s_waitcnt vmcnt(0)
  v_cmp_le_u32 vcc, s41, v6
  s_cbranch_vccnz L_pollok_150
  s_sleep 1
  s_add_u32 s31, s31, 1
  s_cmp_lt_u32 s31, 1048576
  s_cbranch_scc1 L_poll_149
  s_branch L_abort
L_pollok_150:
  s_mov_b32 s32, 1310720
  s_mov_b32 s33, 1441792
  buffer_load_dwordx4 v[128:131], v60, s[4:7], s32 offen offset:0 sc1
  buffer_load_dwordx4 v[132:135], v60, s[4:7], s32 offen offset:2048 sc1
  buffer_load_dwordx4 v[136:139], v61, s[4:7], s32 offen offset:0 sc1
  buffer_load_dwordx4 v[140:143], v61, s[4:7], s32 offen offset:2048 sc1
  buffer_load_dwordx4 v[144:147], v60, s[4:7], s32 offen offset:128 sc1
  buffer_load_dwordx4 v[148:151], v60, s[4:7], s32 offen offset:2176 sc1
  buffer_load_dwordx4 v[152:155], v61, s[4:7], s32 offen offset:128 sc1
  buffer_load_dwordx4 v[156:159], v61, s[4:7], s32 offen offset:2176 sc1
  buffer_load_dwordx4 v[160:163], v60, s[4:7], s33 offen offset:0 sc1
  buffer_load_dwordx4 v[164:167], v60, s[4:7], s33 offen offset:2048 sc1
  buffer_load_dwordx4 v[168:171], v61, s[4:7], s33 offen offset:0 sc1
  buffer_load_dwordx4 v[172:175], v61, s[4:7], s33 offen offset:2048 sc1
  buffer_load_dwordx4 v[176:179], v60, s[4:7], s33 offen offset:128 sc1
  buffer_load_dwordx4 v[180:183], v60, s[4:7], s33 offen offset:2176 sc1
  buffer_load_dwordx4 v[184:187], v61, s[4:7], s33 offen offset:128 sc1
  buffer_load_dwordx4 v[188:191], v61, s[4:7], s33 offen offset:2176 sc1
L_rocont_148:
  buffer_load_dword v25, v24, s[4:7], s38 offen sc1
  v_mov_b32 v28, 0
  v_mov_b32 v29, 0
  v_mov_b32 v30, 0
  v_mov_b32 v31, 0
  v_mov_b32 v32, 0
  v_mov_b32 v33, 0
  v_mov_b32 v34, 0
  v_mov_b32 v35, 0
  v_mov_b32 v36, 0
  v_mov_b32 v37, 0
  v_mov_b32 v38, 0
  v_mov_b32 v39, 0
  v_mov_b32 v40, 0
  v_mov_b32 v41, 0
  v_mov_b32 v42, 0
  v_mov_b32 v43, 0
  v_mov_b32 v44, 0
  v_mov_b32 v45, 0
  v_mov_b32 v46, 0
  v_mov_b32 v47, 0
  v_mov_b32 v48, 0
  v_mov_b32 v49, 0
  v_mov_b32 v50, 0
  v_mov_b32 v51, 0
  v_mov_b32 v52, 0
  v_mov_b32 v53, 0
  v_mov_b32 v54, 0
  v_mov_b32 v55, 0
  v_mov_b32 v56, 0
  v_mov_b32 v57, 0
  v_mov_b32 v58, 0
  v_mov_b32 v59, 0
  s_waitcnt vmcnt(0)
  s_mov_b32 s34, 0
  v_readlane_b32 s39, v25, 6
  s_nop 3
  s_cmp_lt_u32 s39, 8
  s_cbranch_scc1 L_rolate_151
  s_mov_b32 s32, 1572864
  s_mov_b32 s33, 1703936
  buffer_load_dwordx4 v[64:67], v60, s[4:7], s32 offen offset:0 sc1
  buffer_load_dwordx4 v[68:71], v60, s[4:7], s32 offen offset:2048 sc1
  buffer_load_dwordx4 v[72:75], v61, s[4:7], s32 offen offset:0 sc1
  buffer_load_dwordx4 v[76:79], v61, s[4:7], s32 offen offset:2048 sc1
  buffer_load_dwordx4 v[80:83], v60, s[4:7], s32 offen offset:128 sc1
  buffer_load_dwordx4 v[84:87], v60, s[4:7], s32 offen offset:2176 sc1
  buffer_load_dwordx4 v[88:91], v61, s[4:7], s32 offen offset:128 sc1
  buffer_load_dwordx4 v[92:95], v61, s[4:7], s32 offen offset:2176 sc1
  buffer_load_dwordx4 v[96:99], v60, s[4:7], s33 offen offset:0 sc1
  buffer_load_dwordx4 v[100:103], v60, s[4:7], s33 offen offset:2048 sc1
  buffer_load_dwordx4 v[104:107], v61, s[4:7], s33 offen offset:0 sc1
  buffer_load_dwordx4 v[108:111], v61, s[4:7], s33 offen offset:2048 sc1
  buffer_load_dwordx4 v[112:115], v60, s[4:7], s33 offen offset:128 sc1
  buffer_load_dwordx4 v[116:119], v60, s[4:7], s33 offen offset:2176 sc1
  buffer_load_dwordx4 v[120:123], v61, s[4:7], s33 offen offset:128 sc1
  buffer_load_dwordx4 v[124:127], v61, s[4:7], s33 offen offset:2176 sc1
  s_mov_b32 s34, 1
L_rolate_151:
  v_smfmac_f32_16x16x64_bf16 v[28:31], v[128:131], a[0:7], v4
  v_smfmac_f32_16x16x64_bf16 v[32:35], v[128:131], a[8:15], v4
  v_smfmac_f32_16x16x64_bf16 v[28:31], v[132:135], a[16:23], v4
  v_smfmac_f32_16x16x64_bf16 v[32:35], v[132:135], a[24:31], v4
  v_smfmac_f32_16x16x64_bf16 v[28:31], v[136:139], a[32:39], v4
  v_smfmac_f32_16x16x64_bf16 v[32:35], v[136:139], a[40:47], v4
  v_smfmac_f32_16x16x64_bf16 v[28:31], v[140:143], a[48:55], v4
  v_smfmac_f32_16x16x64_bf16 v[32:35], v[140:143], a[56:63], v4
  v_smfmac_f32_16x16x64_bf16 v[36:39], v[144:147], a[0:7], v4
  v_smfmac_f32_16x16x64_bf16 v[40:43], v[144:147], a[8:15], v4
  v_smfmac_f32_16x16x64_bf16 v[36:39], v[148:151], a[16:23], v4
  v_smfmac_f32_16x16x64_bf16 v[40:43], v[148:151], a[24:31], v4
  v_smfmac_f32_16x16x64_bf16 v[36:39], v[152:155], a[32:39], v4
  v_smfmac_f32_16x16x64_bf16 v[40:43], v[152:155], a[40:47], v4
  v_smfmac_f32_16x16x64_bf16 v[36:39], v[156:159], a[48:55], v4
  v_smfmac_f32_16x16x64_bf16 v[40:43], v[156:159], a[56:63], v4
  v_smfmac_f32_16x16x64_bf16 v[44:47], v[160:163], a[0:7], v4
  v_smfmac_f32_16x16x64_bf16 v[48:51], v[160:163], a[8:15], v4
  v_smfmac_f32_16x16x64_bf16 v[44:47], v[164:167], a[16:23], v4
  v_smfmac_f32_16x16x64_bf16 v[48:51], v[164:167], a[24:31], v4
  v_smfmac_f32_16x16x64_bf16 v[44:47], v[168:171], a[32:39], v4
  v_smfmac_f32_16x16x64_bf16 v[48:51], v[168:171], a[40:47], v4
  v_smfmac_f32_16x16x64_bf16 v[44:47], v[172:175], a[48:55], v4
  v_smfmac_f32_16x16x64_bf16 v[48:51], v[172:175], a[56:63], v4
  v_smfmac_f32_16x16x64_bf16 v[52:55], v[176:179], a[0:7], v4
  v_smfmac_f32_16x16x64_bf16 v[56:59], v[176:179], a[8:15], v4
  v_smfmac_f32_16x16x64_bf16 v[52:55], v[180:183], a[16:23], v4
  v_smfmac_f32_16x16x64_bf16 v[56:59], v[180:183], a[24:31], v4
  v_smfmac_f32_16x16x64_bf16 v[52:55], v[184:187], a[32:39], v4
  v_smfmac_f32_16x16x64_bf16 v[56:59], v[184:187], a[40:47], v4
  v_smfmac_f32_16x16x64_bf16 v[52:55], v[188:191], a[48:55], v4
  v_smfmac_f32_16x16x64_bf16 v[56:59], v[188:191], a[56:63], v4
  v_permlane32_swap_b32 v28, v32
  v_permlane32_swap_b32 v29, v33
  v_permlane32_swap_b32 v30, v34
  v_permlane32_swap_b32 v31, v35
  v_pk_add_f32 v[28:29], v[28:29], v[32:33]
  v_pk_add_f32 v[30:31], v[30:31], v[34:35]
  ds_write2_b32 v16, v28, v29 offset0:0 offset1:36
  ds_write2_b32 v16, v30, v31 offset0:72 offset1:108
  v_permlane32_swap_b32 v36, v40
  v_permlane32_swap_b32 v37, v41
  v_permlane32_swap_b32 v38, v42
  v_permlane32_swap_b32 v39, v43
  v_pk_add_f32 v[36:37], v[36:37], v[40:41]
  v_pk_add_f32 v[38:39], v[38:39], v[42:43]
  ds_write2_b32 v17, v36, v37 offset0:0 offset1:36
  ds_write2_b32 v17, v38, v39 offset0:72 offset1:108
  v_permlane32_swap_b32 v44, v48
  v_permlane32_swap_b32 v45, v49
  v_permlane32_swap_b32 v46, v50
  v_permlane32_swap_b32 v47, v51
  v_pk_add_f32 v[44:45], v[44:45], v[48:49]
  v_pk_add_f32 v[46:47], v[46:47], v[50:51]
  ds_write2_b32 v18, v44, v45 offset0:0 offset1:36
  ds_write2_b32 v18, v46, v47 offset0:72 offset1:108
  s_nop 7
  v_permlane32_swap_b32 v52, v56
  v_permlane32_swap_b32 v53, v57
  v_permlane32_swap_b32 v54, v58
  v_permlane32_swap_b32 v55, v59
  v_pk_add_f32 v[52:53], v[52:53], v[56:57]
  v_pk_add_f32 v[54:55], v[54:55], v[58:59]
  ds_write2_b32 v19, v52, v53 offset0:0 offset1:36
  ds_write2_b32 v19, v54, v55 offset0:72 offset1:108
  s_waitcnt lgkmcnt(0)
  s_barrier
  s_cmp_lg_u32 s34, 0
  s_cbranch_scc1 L_rocont_152
  s_add_u32 s40, s38, 3072
  v_mov_b32 v8, 0
  s_mov_b32 s41, 0x8
L_poll_153:
  buffer_load_dword v6, v8, s[4:7], s40 offen sc1
  s_waitcnt vmcnt(0)
  v_cmp_le_u32 vcc, s41, v6
  s_cbranch_vccnz L_pollok_154
  s_sleep 1
  s_add_u32 s31, s31, 1
  s_cmp_lt_u32 s31, 1048576
  s_cbranch_scc1 L_poll_153
  s_branch L_abort
L_pollok_154:
  s_mov_b32 s32, 1572864
  s_mov_b32 s33, 1703936
  buffer_load_dwordx4 v[64:67], v60, s[4:7], s32 offen offset:0 sc1
  buffer_load_dwordx4 v[68:71], v60, s[4:7], s32 offen offset:2048 sc1
  buffer_load_dwordx4 v[72:75], v61, s[4:7], s32 offen offset:0 sc1
  buffer_load_dwordx4 v[76:79], v61, s[4:7], s32 offen offset:2048 sc1
  buffer_load_dwordx4 v[80:83], v60, s[4:7], s32 offen offset:128 sc1
  buffer_load_dwordx4 v[84:87], v60, s[4:7], s32 offen offset:2176 sc1
  buffer_load_dwordx4 v[88:91], v61, s[4:7], s32 offen offset:128 sc1
  buffer_load_dwordx4 v[92:95], v61, s[4:7], s32 offen offset:2176 sc1
  buffer_load_dwordx4 v[96:99], v60, s[4:7], s33 offen offset:0 sc1
  buffer_load_dwordx4 v[100:103], v60, s[4:7], s33 offen offset:2048 sc1
  buffer_load_dwordx4 v[104:107], v61, s[4:7], s33 offen offset:0 sc1
  buffer_load_dwordx4 v[108:111], v61, s[4:7], s33 offen offset:2048 sc1
  buffer_load_dwordx4 v[112:115], v60, s[4:7], s33 offen offset:128 sc1
  buffer_load_dwordx4 v[116:119], v60, s[4:7], s33 offen offset:2176 sc1
  buffer_load_dwordx4 v[120:123], v61, s[4:7], s33 offen offset:128 sc1
  buffer_load_dwordx4 v[124:127], v61, s[4:7], s33 offen offset:2176 sc1
L_rocont_152:
  buffer_load_dword v25, v24, s[4:7], s38 offen sc1
  v_mov_b32 v28, 0
  v_mov_b32 v29, 0
  v_mov_b32 v30, 0
  v_mov_b32 v31, 0
  v_mov_b32 v32, 0
  v_mov_b32 v33, 0
  v_mov_b32 v34, 0
  v_mov_b32 v35, 0
  v_mov_b32 v36, 0
  v_mov_b32 v37, 0
  v_mov_b32 v38, 0
  v_mov_b32 v39, 0
  v_mov_b32 v40, 0
  v_mov_b32 v41, 0
  v_mov_b32 v42, 0
  v_mov_b32 v43, 0
  v_mov_b32 v44, 0
  v_mov_b32 v45, 0
  v_mov_b32 v46, 0
  v_mov_b32 v47, 0
  v_mov_b32 v48, 0
  v_mov_b32 v49, 0
  v_mov_b32 v50, 0
  v_mov_b32 v51, 0
  v_mov_b32 v52, 0
  v_mov_b32 v53, 0
  v_mov_b32 v54, 0
  v_mov_b32 v55, 0
  v_mov_b32 v56, 0
  v_mov_b32 v57, 0
  v_mov_b32 v58, 0
  v_mov_b32 v59, 0
  s_waitcnt vmcnt(0)
  s_mov_b32 s34, 0
  v_readlane_b32 s39, v25, 7
  s_nop 3
  s_cmp_lt_u32 s39, 8
  s_cbranch_scc1 L_rolate_155
  s_mov_b32 s32, 1835008
  s_mov_b32 s33, 1966080
  buffer_load_dwordx4 v[128:131], v60, s[4:7], s32 offen offset:0 sc1
  buffer_load_dwordx4 v[132:135], v60, s[4:7], s32 offen offset:2048 sc1
  buffer_load_dwordx4 v[136:139], v61, s[4:7], s32 offen offset:0 sc1
  buffer_load_dwordx4 v[140:143], v61, s[4:7], s32 offen offset:2048 sc1
  buffer_load_dwordx4 v[144:147], v60, s[4:7], s32 offen offset:128 sc1
  buffer_load_dwordx4 v[148:151], v60, s[4:7], s32 offen offset:2176 sc1
  buffer_load_dwordx4 v[152:155], v61, s[4:7], s32 offen offset:128 sc1
  buffer_load_dwordx4 v[156:159], v61, s[4:7], s32 offen offset:2176 sc1
  buffer_load_dwordx4 v[160:163], v60, s[4:7], s33 offen offset:0 sc1
  buffer_load_dwordx4 v[164:167], v60, s[4:7], s33 offen offset:2048 sc1
  buffer_load_dwordx4 v[168:171], v61, s[4:7], s33 offen offset:0 sc1
  buffer_load_dwordx4 v[172:175], v61, s[4:7], s33 offen offset:2048 sc1
  buffer_load_dwordx4 v[176:179], v60, s[4:7], s33 offen offset:128 sc1
  buffer_load_dwordx4 v[180:183], v60, s[4:7], s33 offen offset:2176 sc1
  buffer_load_dwordx4 v[184:187], v61, s[4:7], s33 offen offset:128 sc1
  buffer_load_dwordx4 v[188:191], v61, s[4:7], s33 offen offset:2176 sc1
  s_mov_b32 s34, 1
L_rolate_155:
  v_smfmac_f32_16x16x64_bf16 v[28:31], v[64:67], a[0:7], v4
  v_smfmac_f32_16x16x64_bf16 v[32:35], v[64:67], a[8:15], v4
  v_smfmac_f32_16x16x64_bf16 v[28:31], v[68:71], a[16:23], v4
  v_smfmac_f32_16x16x64_bf16 v[32:35], v[68:71], a[24:31], v4
  v_smfmac_f32_16x16x64_bf16 v[28:31], v[72:75], a[32:39], v4
  v_smfmac_f32_16x16x64_bf16 v[32:35], v[72:75], a[40:47], v4
  v_smfmac_f32_16x16x64_bf16 v[28:31], v[76:79], a[48:55], v4
  v_smfmac_f32_16x16x64_bf16 v[32:35], v[76:79], a[56:63], v4
  v_smfmac_f32_16x16x64_bf16 v[36:39], v[80:83], a[0:7], v4
  v_smfmac_f32_16x16x64_bf16 v[40:43], v[80:83], a[8:15], v4
  v_smfmac_f32_16x16x64_bf16 v[36:39], v[84:87], a[16:23], v4
  v_smfmac_f32_16x16x64_bf16 v[40:43], v[84:87], a[24:31], v4
  v_smfmac_f32_16x16x64_bf16 v[36:39], v[88:91], a[32:39], v4
  v_smfmac_f32_16x16x64_bf16 v[40:43], v[88:91], a[40:47], v4
  v_smfmac_f32_16x16x64_bf16 v[36:39], v[92:95], a[48:55], v4
  v_smfmac_f32_16x16x64_bf16 v[40:43], v[92:95], a[56:63], v4
  v_smfmac_f32_16x16x64_bf16 v[44:47], v[96:99], a[0:7], v4
  v_smfmac_f32_16x16x64_bf16 v[48:51], v[96:99], a[8:15], v4
  v_smfmac_f32_16x16x64_bf16 v[44:47], v[100:103], a[16:23], v4
  v_smfmac_f32_16x16x64_bf16 v[48:51], v[100:103], a[24:31], v4
  v_smfmac_f32_16x16x64_bf16 v[44:47], v[104:107], a[32:39], v4
  v_smfmac_f32_16x16x64_bf16 v[48:51], v[104:107], a[40:47], v4
  v_smfmac_f32_16x16x64_bf16 v[44:47], v[108:111], a[48:55], v4
  v_smfmac_f32_16x16x64_bf16 v[48:51], v[108:111], a[56:63], v4
  v_smfmac_f32_16x16x64_bf16 v[52:55], v[112:115], a[0:7], v4
  v_smfmac_f32_16x16x64_bf16 v[56:59], v[112:115], a[8:15], v4
  v_smfmac_f32_16x16x64_bf16 v[52:55], v[116:119], a[16:23], v4
  v_smfmac_f32_16x16x64_bf16 v[56:59], v[116:119], a[24:31], v4
  v_smfmac_f32_16x16x64_bf16 v[52:55], v[120:123], a[32:39], v4
  v_smfmac_f32_16x16x64_bf16 v[56:59], v[120:123], a[40:47], v4
  v_smfmac_f32_16x16x64_bf16 v[52:55], v[124:127], a[48:55], v4
  v_smfmac_f32_16x16x64_bf16 v[56:59], v[124:127], a[56:63], v4
  v_permlane32_swap_b32 v28, v32
  v_permlane32_swap_b32 v29, v33
  v_permlane32_swap_b32 v30, v34
  v_permlane32_swap_b32 v31, v35
  v_pk_add_f32 v[28:29], v[28:29], v[32:33]
  v_pk_add_f32 v[30:31], v[30:31], v[34:35]
  ds_write2_b32 v12, v28, v29 offset0:0 offset1:36
  ds_write2_b32 v12, v30, v31 offset0:72 offset1:108
  v_permlane32_swap_b32 v36, v40
  v_permlane32_swap_b32 v37, v41
  v_permlane32_swap_b32 v38, v42
  v_permlane32_swap_b32 v39, v43
  v_pk_add_f32 v[36:37], v[36:37], v[40:41]
  v_pk_add_f32 v[38:39], v[38:39], v[42:43]
  ds_write2_b32 v13, v36, v37 offset0:0 offset1:36
  ds_write2_b32 v13, v38, v39 offset0:72 offset1:108
  v_permlane32_swap_b32 v44, v48
  v_permlane32_swap_b32 v45, v49
  v_permlane32_swap_b32 v46, v50
  v_permlane32_swap_b32 v47, v51
  v_pk_add_f32 v[44:45], v[44:45], v[48:49]
  v_pk_add_f32 v[46:47], v[46:47], v[50:51]
  ds_write2_b32 v14, v44, v45 offset0:0 offset1:36
  ds_write2_b32 v14, v46, v47 offset0:72 offset1:108
  s_nop 7
  v_permlane32_swap_b32 v52, v56
  v_permlane32_swap_b32 v53, v57
  v_permlane32_swap_b32 v54, v58
  v_permlane32_swap_b32 v55, v59
  v_pk_add_f32 v[52:53], v[52:53], v[56:57]
  v_pk_add_f32 v[54:55], v[54:55], v[58:59]
  ds_write2_b32 v15, v52, v53 offset0:0 offset1:36
  ds_write2_b32 v15, v54, v55 offset0:72 offset1:108
  s_waitcnt lgkmcnt(0)
  s_barrier
  s_cmp_lg_u32 s34, 0
  s_cbranch_scc1 L_rocont_156
  s_add_u32 s40, s38, 3584
  v_mov_b32 v8, 0
  s_mov_b32 s41, 0x8
L_poll_157:
  buffer_load_dword v6, v8, s[4:7], s40 offen sc1
  s_waitcnt vmcnt(0)
  v_cmp_le_u32 vcc, s41, v6
  s_cbranch_vccnz L_pollok_158
  s_sleep 1
  s_add_u32 s31, s31, 1
  s_cmp_lt_u32 s31, 1048576
  s_cbranch_scc1 L_poll_157
  s_branch L_abort
L_pollok_158:
  s_mov_b32 s32, 1835008
  s_mov_b32 s33, 1966080
  buffer_load_dwordx4 v[128:131], v60, s[4:7], s32 offen offset:0 sc1
  buffer_load_dwordx4 v[132:135], v60, s[4:7], s32 offen offset:2048 sc1
  buffer_load_dwordx4 v[136:139], v61, s[4:7], s32 offen offset:0 sc1
  buffer_load_dwordx4 v[140:143], v61, s[4:7], s32 offen offset:2048 sc1
  buffer_load_dwordx4 v[144:147], v60, s[4:7], s32 offen offset:128 sc1
  buffer_load_dwordx4 v[148:151], v60, s[4:7], s32 offen offset:2176 sc1
  buffer_load_dwordx4 v[152:155], v61, s[4:7], s32 offen offset:128 sc1
  buffer_load_dwordx4 v[156:159], v61, s[4:7], s32 offen offset:2176 sc1
  buffer_load_dwordx4 v[160:163], v60, s[4:7], s33 offen offset:0 sc1
  buffer_load_dwordx4 v[164:167], v60, s[4:7], s33 offen offset:2048 sc1
  buffer_load_dwordx4 v[168:171], v61, s[4:7], s33 offen offset:0 sc1
  buffer_load_dwordx4 v[172:175], v61, s[4:7], s33 offen offset:2048 sc1
  buffer_load_dwordx4 v[176:179], v60, s[4:7], s33 offen offset:128 sc1
  buffer_load_dwordx4 v[180:183], v60, s[4:7], s33 offen offset:2176 sc1
  buffer_load_dwordx4 v[184:187], v61, s[4:7], s33 offen offset:128 sc1
  buffer_load_dwordx4 v[188:191], v61, s[4:7], s33 offen offset:2176 sc1
L_rocont_156:
  v_mov_b32 v28, 0
  v_mov_b32 v29, 0
  v_mov_b32 v30, 0
  v_mov_b32 v31, 0
  v_mov_b32 v32, 0
  v_mov_b32 v33, 0
  v_mov_b32 v34, 0
  v_mov_b32 v35, 0
  v_mov_b32 v36, 0
  v_mov_b32 v37, 0
  v_mov_b32 v38, 0
  v_mov_b32 v39, 0
  v_mov_b32 v40, 0
  v_mov_b32 v41, 0
  v_mov_b32 v42, 0
  v_mov_b32 v43, 0
  v_mov_b32 v44, 0
  v_mov_b32 v45, 0
  v_mov_b32 v46, 0
  v_mov_b32 v47, 0
  v_mov_b32 v48, 0
  v_mov_b32 v49, 0
  v_mov_b32 v50, 0
  v_mov_b32 v51, 0
  v_mov_b32 v52, 0
  v_mov_b32 v53, 0
  v_mov_b32 v54, 0
  v_mov_b32 v55, 0
  v_mov_b32 v56, 0
  v_mov_b32 v57, 0
  v_mov_b32 v58, 0
  v_mov_b32 v59, 0
  s_waitcnt vmcnt(0)
  s_mov_b32 s34, 0
  v_smfmac_f32_16x16x64_bf16 v[28:31], v[128:131], a[0:7], v4
  v_smfmac_f32_16x16x64_bf16 v[32:35], v[128:131], a[8:15], v4
  v_smfmac_f32_16x16x64_bf16 v[28:31], v[132:135], a[16:23], v4
  v_smfmac_f32_16x16x64_bf16 v[32:35], v[132:135], a[24:31], v4
  v_smfmac_f32_16x16x64_bf16 v[28:31], v[136:139], a[32:39], v4
  v_smfmac_f32_16x16x64_bf16 v[32:35], v[136:139], a[40:47], v4
  v_smfmac_f32_16x16x64_bf16 v[28:31], v[140:143], a[48:55], v4
  v_smfmac_f32_16x16x64_bf16 v[32:35], v[140:143], a[56:63], v4
  v_smfmac_f32_16x16x64_bf16 v[36:39], v[144:147], a[0:7], v4
  v_smfmac_f32_16x16x64_bf16 v[40:43], v[144:147], a[8:15], v4
  v_smfmac_f32_16x16x64_bf16 v[36:39], v[148:151], a[16:23], v4
  v_smfmac_f32_16x16x64_bf16 v[40:43], v[148:151], a[24:31], v4
  v_smfmac_f32_16x16x64_bf16 v[36:39], v[152:155], a[32:39], v4
  v_smfmac_f32_16x16x64_bf16 v[40:43], v[152:155], a[40:47], v4
  v_smfmac_f32_16x16x64_bf16 v[36:39], v[156:159], a[48:55], v4
  v_smfmac_f32_16x16x64_bf16 v[40:43], v[156:159], a[56:63], v4
  v_smfmac_f32_16x16x64_bf16 v[44:47], v[160:163], a[0:7], v4
  v_smfmac_f32_16x16x64_bf16 v[48:51], v[160:163], a[8:15], v4
  v_smfmac_f32_16x16x64_bf16 v[44:47], v[164:167], a[16:23], v4
  v_smfmac_f32_16x16x64_bf16 v[48:51], v[164:167], a[24:31], v4
  v_smfmac_f32_16x16x64_bf16 v[44:47], v[168:171], a[32:39], v4
  v_smfmac_f32_16x16x64_bf16 v[48:51], v[168:171], a[40:47], v4
  v_smfmac_f32_16x16x64_bf16 v[44:47], v[172:175], a[48:55], v4
  v_smfmac_f32_16x16x64_bf16 v[48:51], v[172:175], a[56:63], v4
  v_smfmac_f32_16x16x64_bf16 v[52:55], v[176:179], a[0:7], v4
  v_smfmac_f32_16x16x64_bf16 v[56:59], v[176:179], a[8:15], v4
  v_smfmac_f32_16x16x64_bf16 v[52:55], v[180:183], a[16:23], v4
  v_smfmac_f32_16x16x64_bf16 v[56:59], v[180:183], a[24:31], v4
  v_smfmac_f32_16x16x64_bf16 v[52:55], v[184:187], a[32:39], v4
  v_smfmac_f32_16x16x64_bf16 v[56:59], v[184:187], a[40:47], v4
  v_smfmac_f32_16x16x64_bf16 v[52:55], v[188:191], a[48:55], v4
  v_smfmac_f32_16x16x64_bf16 v[56:59], v[188:191], a[56:63], v4
  v_permlane32_swap_b32 v28, v32
  v_permlane32_swap_b32 v29, v33
  v_permlane32_swap_b32 v30, v34
  v_permlane32_swap_b32 v31, v35
  v_pk_add_f32 v[28:29], v[28:29], v[32:33]
  v_pk_add_f32 v[30:31], v[30:31], v[34:35]
  ds_write2_b32 v16, v28, v29 offset0:0 offset1:36
  ds_write2_b32 v16, v30, v31 offset0:72 offset1:108
  v_permlane32_swap_b32 v36, v40
  v_permlane32_swap_b32 v37, v41
  v_permlane32_swap_b32 v38, v42
  v_permlane32_swap_b32 v39, v43
  v_pk_add_f32 v[36:37], v[36:37], v[40:41]
  v_pk_add_f32 v[38:39], v[38:39], v[42:43]
  ds_write2_b32 v17, v36, v37 offset0:0 offset1:36
  ds_write2_b32 v17, v38, v39 offset0:72 offset1:108
  v_permlane32_swap_b32 v44, v48
  v_permlane32_swap_b32 v45, v49
  v_permlane32_swap_b32 v46, v50
  v_permlane32_swap_b32 v47, v51
  v_pk_add_f32 v[44:45], v[44:45], v[48:49]
  v_pk_add_f32 v[46:47], v[46:47], v[50:51]
  ds_write2_b32 v18, v44, v45 offset0:0 offset1:36
  ds_write2_b32 v18, v46, v47 offset0:72 offset1:108
  s_nop 7
  v_permlane32_swap_b32 v52, v56
  v_permlane32_swap_b32 v53, v57
  v_permlane32_swap_b32 v54, v58
  v_permlane32_swap_b32 v55, v59
  v_pk_add_f32 v[52:53], v[52:53], v[56:57]
  v_pk_add_f32 v[54:55], v[54:55], v[58:59]
  ds_write2_b32 v19, v52, v53 offset0:0 offset1:36
  ds_write2_b32 v19, v54, v55 offset0:72 offset1:108
  s_waitcnt lgkmcnt(0)
  s_barrier
  s_branch L_roout_128
L_rofin_127:
  s_mov_b32 s29, 0
  v_and_b32 v6, 7, v1
  v_mul_u32_u24 v12, 144, v6
  v_lshrrev_b32 v8, 3, v1
  v_lshl_add_u32 v12, v8, 4, v12
  s_mul_i32 s39, s28, 4608
  s_add_u32 s39, s39, 32768
  v_add_u32 v12, s39, v12
  s_xor_b32 s39, s24, 0
  s_lshl_b32 s39, s39, 15
  s_lshl_b32 s40, s28, 17
  s_add_u32 s39, s39, s40
  s_lshl_b32 s40, s25, 10
  s_add_u32 s39, s39, s40
  s_add_u32 s39, s39, 0x6400000
  v_lshl_add_u32 v13, v1, 4, s39
  s_xor_b32 s39, s24, 1
  s_lshl_b32 s39, s39, 15
  s_lshl_b32 s40, s28, 17
  s_add_u32 s39, s39, s40
  s_lshl_b32 s40, s25, 10
  s_add_u32 s39, s39, s40
  s_add_u32 s39, s39, 0x6400000
  v_lshl_add_u32 v14, v1, 4, s39
  s_xor_b32 s39, s24, 2
  s_lshl_b32 s39, s39, 15
  s_lshl_b32 s40, s28, 17
  s_add_u32 s39, s39, s40
  s_lshl_b32 s40, s25, 10
  s_add_u32 s39, s39, s40
  s_add_u32 s39, s39, 0x6400000
  v_lshl_add_u32 v15, v1, 4, s39
  s_xor_b32 s39, s24, 3
  s_lshl_b32 s39, s39, 15
  s_lshl_b32 s40, s28, 17
  s_add_u32 s39, s39, s40
  s_lshl_b32 s40, s25, 10
  s_add_u32 s39, s39, s40
  s_add_u32 s39, s39, 0x6400000
  v_lshl_add_u32 v19, v1, 4, s39
  s_cmp_eq_u32 s28, s24
  s_cbranch_scc1 L_romine_161
  s_barrier
  ds_read_b128 v[20:23], v12 offset:0
  ds_read_b128 v[24:27], v12 offset:1152
  ds_read_b128 v[28:31], v12 offset:2304
  ds_read_b128 v[32:35], v12 offset:3456
  s_waitcnt lgkmcnt(0)
  v_pk_add_f32 v[20:21], v[20:21], v[24:25]
  v_pk_add_f32 v[22:23], v[22:23], v[26:27]
  v_pk_add_f32 v[20:21], v[20:21], v[28:29]
  v_pk_add_f32 v[22:23], v[22:23], v[30:31]
  v_pk_add_f32 v[20:21], v[20:21], v[32:33]
  v_pk_add_f32 v[22:23], v[22:23], v[34:35]
  s_mov_b32 s32, 0
  buffer_store_dwordx4 v[20:23], v13, s[4:7], s32 offen sc1
  s_barrier
  ds_read_b128 v[20:23], v12 offset:18432
  ds_read_b128 v[24:27], v12 offset:19584
  ds_read_b128 v[28:31], v12 offset:20736
  ds_read_b128 v[32:35], v12 offset:21888
  s_waitcnt lgkmcnt(0)
  v_pk_add_f32 v[20:21], v[20:21], v[24:25]
  v_pk_add_f32 v[22:23], v[22:23], v[26:27]
  v_pk_add_f32 v[20:21], v[20:21], v[28:29]
  v_pk_add_f32 v[22:23], v[22:23], v[30:31]
  v_pk_add_f32 v[20:21], v[20:21], v[32:33]
  v_pk_add_f32 v[22:23], v[22:23], v[34:35]
  s_mov_b32 s32, 524288
  buffer_store_dwordx4 v[20:23], v13, s[4:7], s32 offen sc1
  s_barrier
  ds_read_b128 v[20:23], v12 offset:0
  ds_read_b128 v[24:27], v12 offset:1152
  ds_read_b128 v[28:31], v12 offset:2304
  ds_read_b128 v[32:35], v12 offset:3456
  s_waitcnt lgkmcnt(0)
  v_pk_add_f32 v[20:21], v[20:21], v[24:25]
  v_pk_add_f32 v[22:23], v[22:23], v[26:27]
  v_pk_add_f32 v[20:21], v[20:21], v[28:29]
  v_pk_add_f32 v[22:23], v[22:23], v[30:31]
  v_pk_add_f32 v[20:21], v[20:21], v[32:33]
  v_pk_add_f32 v[22:23], v[22:23], v[34:35]
  s_mov_b32 s32, 1048576
  buffer_store_dwordx4 v[20:23], v13, s[4:7], s32 offen sc1
  s_barrier
  ds_read_b128 v[20:23], v12 offset:18432
  ds_read_b128 v[24:27], v12 offset:19584
  ds_read_b128 v[28:31], v12 offset:20736
  ds_read_b128 v[32:35], v12 offset:21888
  s_waitcnt lgkmcnt(0)
  v_pk_add_f32 v[20:21], v[20:21], v[24:25]
  v_pk_add_f32 v[22:23], v[22:23], v[26:27]
  v_pk_add_f32 v[20:21], v[20:21], v[28:29]
  v_pk_add_f32 v[22:23], v[22:23], v[30:31]
  v_pk_add_f32 v[20:21], v[20:21], v[32:33]
  v_pk_add_f32 v[22:23], v[22:23], v[34:35]
  s_mov_b32 s32, 1572864
  buffer_store_dwordx4 v[20:23], v13, s[4:7], s32 offen sc1
  s_barrier
  ds_read_b128 v[20:23], v12 offset:0
  ds_read_b128 v[24:27], v12 offset:1152
  ds_read_b128 v[28:31], v12 offset:2304
  ds_read_b128 v[32:35], v12 offset:3456
  s_waitcnt lgkmcnt(0)
  v_pk_add_f32 v[20:21], v[20:21], v[24:25]
  v_pk_add_f32 v[22:23], v[22:23], v[26:27]
  v_pk_add_f32 v[20:21], v[20:21], v[28:29]
  v_pk_add_f32 v[22:23], v[22:23], v[30:31]
  v_pk_add_f32 v[20:21], v[20:21], v[32:33]
  v_pk_add_f32 v[22:23], v[22:23], v[34:35]
  s_mov_b32 s32, 2097152
  buffer_store_dwordx4 v[20:23], v13, s[4:7], s32 offen sc1
  s_barrier
  ds_read_b128 v[20:23], v12 offset:18432
  ds_read_b128 v[24:27], v12 offset:19584
  ds_read_b128 v[28:31], v12 offset:20736
  ds_read_b128 v[32:35], v12 offset:21888
  s_waitcnt lgkmcnt(0)
  v_pk_add_f32 v[20:21], v[20:21], v[24:25]
  v_pk_add_f32 v[22:23], v[22:23], v[26:27]
  v_pk_add_f32 v[20:21], v[20:21], v[28:29]
  v_pk_add_f32 v[22:23], v[22:23], v[30:31]
  v_pk_add_f32 v[20:21], v[20:21], v[32:33]
  v_pk_add_f32 v[22:23], v[22:23], v[34:35]
  s_mov_b32 s32, 2621440
  buffer_store_dwordx4 v[20:23], v13, s[4:7], s32 offen sc1
  s_barrier
  ds_read_b128 v[20:23], v12 offset:0
  ds_read_b128 v[24:27], v12 offset:1152
  ds_read_b128 v[28:31], v12 offset:2304
  ds_read_b128 v[32:35], v12 offset:3456
  s_waitcnt lgkmcnt(0)
  v_pk_add_f32 v[20:21], v[20:21], v[24:25]
  v_pk_add_f32 v[22:23], v[22:23], v[26:27]
  v_pk_add_f32 v[20:21], v[20:21], v[28:29]
  v_pk_add_f32 v[22:23], v[22:23], v[30:31]
  v_pk_add_f32 v[20:21], v[20:21], v[32:33]
  v_pk_add_f32 v[22:23], v[22:23], v[34:35]
  s_mov_b32 s32, 3145728
  buffer_store_dwordx4 v[20:23], v13, s[4:7], s32 offen sc1
  s_barrier
  ds_read_b128 v[20:23], v12 offset:18432
  ds_read_b128 v[24:27], v12 offset:19584
  ds_read_b128 v[28:31], v12 offset:20736
  ds_read_b128 v[32:35], v12 offset:21888
  s_waitcnt lgkmcnt(0)
  v_pk_add_f32 v[20:21], v[20:21], v[24:25]
  v_pk_add_f32 v[22:23], v[22:23], v[26:27]
  v_pk_add_f32 v[20:21], v[20:21], v[28:29]
  v_pk_add_f32 v[22:23], v[22:23], v[30:31]
  v_pk_add_f32 v[20:21], v[20:21], v[32:33]
  v_pk_add_f32 v[22:23], v[22:23], v[34:35]
  s_mov_b32 s32, 3670016
  buffer_store_dwordx4 v[20:23], v13, s[4:7], s32 offen sc1
  s_branch L_roout_128
L_romine_161:
  s_load_dwordx2 s[52:53], s[0:1], 88
  s_waitcnt lgkmcnt(0)
  s_mov_b32 s12, s52
  s_mov_b32 s13, s53
  s_mov_b32 s14, 0x400000
  s_mov_b32 s15, 0x20000
  s_lshl_b32 s39, s24, 3
  s_add_u32 s39, s39, 1792
  v_add_u32 v9, s39, v6
  v_lshlrev_b32 v17, 2, v9
  v_add_u32 v17, 0x5c00000, v17
  v_lshlrev_b32 v18, 11, v9
  v_lshl_add_u32 v18, v8, 3, v18
  s_lshl_b32 s39, s25, 6
  v_add_u32 v18, s39, v18
  v_lshrrev_b32 v10, 4, v9
  v_lshlrev_b32 v16, 15, v10
  v_and_b32 v10, 15, v9
  v_lshl_add_u32 v16, v10, 4, v16
  v_and_b32 v10, 3, v8
  v_lshl_add_u32 v16, v10, 8, v16
  v_lshrrev_b32 v10, 2, v8
  v_lshl_add_u32 v16, v10, 3, v16
  s_lshl_b32 s39, s25, 10
  s_add_u32 s39, s39, 0x5000000
  v_add_u32 v16, s39, v16
  s_mov_b32 s40, 0x5c15380
  v_mov_b32 v8, 0
  s_mov_b32 s41, 0x40
L_poll_163:
  buffer_load_dword v6, v8, s[4:7], s40 offen sc1
  s_waitcnt vmcnt(0)
  v_cmp_le_u32 vcc, s41, v6
  s_cbranch_vccnz L_pollok_164
  s_sleep 4
  s_add_u32 s31, s31, 1
  s_cmp_lt_u32 s31, 1048576
  s_cbranch_scc1 L_poll_163
  s_branch L_abort
L_pollok_164:
  s_mov_b32 s33, 0
  s_mov_b32 s34, 0
  buffer_load_dwordx2 v[64:65], v16, s[4:7], s33 offen sc1
  buffer_load_dword v66, v17, s[4:7], s34 offen sc1
  s_mov_b32 s33, 65536
  s_mov_b32 s34, 128
  buffer_load_dwordx2 v[68:69], v16, s[4:7], s33 offen sc1
  buffer_load_dword v70, v17, s[4:7], s34 offen sc1
  s_mov_b32 s33, 131072
  s_mov_b32 s34, 256
  buffer_load_dwordx2 v[72:73], v16, s[4:7], s33 offen sc1
  buffer_load_dword v74, v17, s[4:7], s34 offen sc1
  s_mov_b32 s33, 196608
  s_mov_b32 s34, 384
  buffer_load_dwordx2 v[76:77], v16, s[4:7], s33 offen sc1
  buffer_load_dword v78, v17, s[4:7], s34 offen sc1
  s_mov_b32 s33, 262144
  s_mov_b32 s34, 512
  buffer_load_dwordx2 v[80:81], v16, s[4:7], s33 offen sc1
  buffer_load_dword v82, v17, s[4:7], s34 offen sc1
  s_mov_b32 s33, 327680
  s_mov_b32 s34, 640
  buffer_load_dwordx2 v[84:85], v16, s[4:7], s33 offen sc1
  buffer_load_dword v86, v17, s[4:7], s34 offen sc1
  s_mov_b32 s33, 393216
  s_mov_b32 s34, 768
  buffer_load_dwordx2 v[88:89], v16, s[4:7], s33 offen sc1
  buffer_load_dword v90, v17, s[4:7], s34 offen sc1
  s_mov_b32 s33, 458752
  s_mov_b32 s34, 896
  buffer_load_dwordx2 v[92:93], v16, s[4:7], s33 offen sc1
  buffer_load_dword v94, v17, s[4:7], s34 offen sc1
  s_barrier
  ds_read_b128 v[20:23], v12 offset:0
  ds_read_b128 v[24:27], v12 offset:1152
  ds_read_b128 v[28:31], v12 offset:2304
  ds_read_b128 v[32:35], v12 offset:3456
  s_waitcnt lgkmcnt(0)
  v_pk_add_f32 v[20:21], v[20:21], v[24:25]
  v_pk_add_f32 v[22:23], v[22:23], v[26:27]
  v_pk_add_f32 v[20:21], v[20:21], v[28:29]
  v_pk_add_f32 v[22:23], v[22:23], v[30:31]
  v_pk_add_f32 v[128:129], v[20:21], v[32:33]
  v_pk_add_f32 v[130:131], v[22:23], v[34:35]
  s_barrier
  ds_read_b128 v[20:23], v12 offset:18432
  ds_read_b128 v[24:27], v12 offset:19584
  ds_read_b128 v[28:31], v12 offset:20736
  ds_read_b128 v[32:35], v12 offset:21888
  s_waitcnt lgkmcnt(0)
  v_pk_add_f32 v[20:21], v[20:21], v[24:25]
  v_pk_add_f32 v[22:23], v[22:23], v[26:27]
  v_pk_add_f32 v[20:21], v[20:21], v[28:29]
  v_pk_add_f32 v[22:23], v[22:23], v[30:31]
  v_pk_add_f32 v[132:133], v[20:21], v[32:33]
  v_pk_add_f32 v[134:135], v[22:23], v[34:35]
  s_mov_b32 s32, 0
  s_mov_b32 s33, 0
  buffer_load_dwordx4 v[36:39], v14, s[4:7], s32 offen sc1
  buffer_load_dwordx4 v[40:43], v15, s[4:7], s32 offen sc1
  buffer_load_dwordx4 v[44:47], v19, s[4:7], s32 offen sc1
L_rowait_165:
  s_waitcnt vmcnt(0)
  v_max3_u32 v9, v39, v43, v47
  v_cmp_eq_u32 vcc, -1, v9
  s_cbranch_vccnz L_roretry_166
  v_pk_add_f32 v[128:129], v[128:129], v[36:37]
  v_pk_add_f32 v[130:131], v[130:131], v[38:39]
  v_pk_add_f32 v[128:129], v[128:129], v[40:41]
  v_pk_add_f32 v[130:131], v[130:131], v[42:43]
  v_pk_add_f32 v[128:129], v[128:129], v[44:45]
  v_pk_add_f32 v[130:131], v[130:131], v[46:47]
  v_sub_f32 v52, 1.0, v66
  v_pk_mul_f32 v[128:129], v[128:129], v[66:67] op_sel_hi:[1,0]
  v_lshlrev_b32 v36, 16, v64
  v_and_b32 v37, 0xffff0000, v64
  v_pk_fma_f32 v[128:129], v[36:37], v[52:53], v[128:129] op_sel_hi:[1,0,1]
  v_cvt_pk_bf16_f32 v56, v128, v129
  v_pk_mul_f32 v[130:131], v[130:131], v[66:67] op_sel_hi:[1,0]
  v_lshlrev_b32 v38, 16, v65
  v_and_b32 v39, 0xffff0000, v65
  v_pk_fma_f32 v[130:131], v[38:39], v[52:53], v[130:131] op_sel_hi:[1,0,1]
  v_cvt_pk_bf16_f32 v57, v130, v131
  buffer_store_dwordx2 v[56:57], v18, s[12:15], s33 offen
  s_barrier
  ds_read_b128 v[20:23], v12 offset:0
  ds_read_b128 v[24:27], v12 offset:1152
  ds_read_b128 v[28:31], v12 offset:2304
  ds_read_b128 v[32:35], v12 offset:3456
  s_waitcnt lgkmcnt(0)
  v_pk_add_f32 v[20:21], v[20:21], v[24:25]
  v_pk_add_f32 v[22:23], v[22:23], v[26:27]
  v_pk_add_f32 v[20:21], v[20:21], v[28:29]
  v_pk_add_f32 v[22:23], v[22:23], v[30:31]
  v_pk_add_f32 v[136:137], v[20:21], v[32:33]
  v_pk_add_f32 v[138:139], v[22:23], v[34:35]
  s_mov_b32 s32, 524288
  s_mov_b32 s33, 65536
  buffer_load_dwordx4 v[36:39], v14, s[4:7], s32 offen sc1
  buffer_load_dwordx4 v[40:43], v15, s[4:7], s32 offen sc1
  buffer_load_dwordx4 v[44:47], v19, s[4:7], s32 offen sc1
L_rowait_167:
  s_waitcnt vmcnt(0)
  v_max3_u32 v9, v39, v43, v47
  v_cmp_eq_u32 vcc, -1, v9
  s_cbranch_vccnz L_roretry_168
  v_pk_add_f32 v[132:133], v[132:133], v[36:37]
  v_pk_add_f32 v[134:135], v[134:135], v[38:39]
  v_pk_add_f32 v[132:133], v[132:133], v[40:41]
  v_pk_add_f32 v[134:135], v[134:135], v[42:43]
  v_pk_add_f32 v[132:133], v[132:133], v[44:45]
  v_pk_add_f32 v[134:135], v[134:135], v[46:47]
  v_sub_f32 v52, 1.0, v70
  v_pk_mul_f32 v[132:133], v[132:133], v[70:71] op_sel_hi:[1,0]
  v_lshlrev_b32 v36, 16, v68
  v_and_b32 v37, 0xffff0000, v68
  v_pk_fma_f32 v[132:133], v[36:37], v[52:53], v[132:133] op_sel_hi:[1,0,1]
  v_cvt_pk_bf16_f32 v56, v132, v133
  v_pk_mul_f32 v[134:135], v[134:135], v[70:71] op_sel_hi:[1,0]
  v_lshlrev_b32 v38, 16, v69
  v_and_b32 v39, 0xffff0000, v69
  v_pk_fma_f32 v[134:135], v[38:39], v[52:53], v[134:135] op_sel_hi:[1,0,1]
  v_cvt_pk_bf16_f32 v57, v134, v135
  buffer_store_dwordx2 v[56:57], v18, s[12:15], s33 offen
  s_barrier
  ds_read_b128 v[20:23], v12 offset:18432
  ds_read_b128 v[24:27], v12 offset:19584
  ds_read_b128 v[28:31], v12 offset:20736
  ds_read_b128 v[32:35], v12 offset:21888
  s_waitcnt lgkmcnt(0)
  v_pk_add_f32 v[20:21], v[20:21], v[24:25]
  v_pk_add_f32 v[22:23], v[22:23], v[26:27]
  v_pk_add_f32 v[20:21], v[20:21], v[28:29]
  v_pk_add_f32 v[22:23], v[22:23], v[30:31]
  v_pk_add_f32 v[140:141], v[20:21], v[32:33]
  v_pk_add_f32 v[142:143], v[22:23], v[34:35]
  s_mov_b32 s32, 1048576
  s_mov_b32 s33, 131072
  buffer_load_dwordx4 v[36:39], v14, s[4:7], s32 offen sc1
  buffer_load_dwordx4 v[40:43], v15, s[4:7], s32 offen sc1
  buffer_load_dwordx4 v[44:47], v19, s[4:7], s32 offen sc1
L_rowait_169:
  s_waitcnt vmcnt(0)
  v_max3_u32 v9, v39, v43, v47
  v_cmp_eq_u32 vcc, -1, v9
  s_cbranch_vccnz L_roretry_170
  v_pk_add_f32 v[136:137], v[136:137], v[36:37]
  v_pk_add_f32 v[138:139], v[138:139], v[38:39]
  v_pk_add_f32 v[136:137], v[136:137], v[40:41]
  v_pk_add_f32 v[138:139], v[138:139], v[42:43]
  v_pk_add_f32 v[136:137], v[136:137], v[44:45]
  v_pk_add_f32 v[138:139], v[138:139], v[46:47]
  v_sub_f32 v52, 1.0, v74
  v_pk_mul_f32 v[136:137], v[136:137], v[74:75] op_sel_hi:[1,0]
  v_lshlrev_b32 v36, 16, v72
  v_and_b32 v37, 0xffff0000, v72
  v_pk_fma_f32 v[136:137], v[36:37], v[52:53], v[136:137] op_sel_hi:[1,0,1]
  v_cvt_pk_bf16_f32 v56, v136, v137
  v_pk_mul_f32 v[138:139], v[138:139], v[74:75] op_sel_hi:[1,0]
  v_lshlrev_b32 v38, 16, v73
  v_and_b32 v39, 0xffff0000, v73
  v_pk_fma_f32 v[138:139], v[38:39], v[52:53], v[138:139] op_sel_hi:[1,0,1]
  v_cvt_pk_bf16_f32 v57, v138, v139
  buffer_store_dwordx2 v[56:57], v18, s[12:15], s33 offen
  s_barrier
  ds_read_b128 v[20:23], v12 offset:0
  ds_read_b128 v[24:27], v12 offset:1152
  ds_read_b128 v[28:31], v12 offset:2304
  ds_read_b128 v[32:35], v12 offset:3456
  s_waitcnt lgkmcnt(0)
  v_pk_add_f32 v[20:21], v[20:21], v[24:25]
  v_pk_add_f32 v[22:23], v[22:23], v[26:27]
  v_pk_add_f32 v[20:21], v[20:21], v[28:29]
  v_pk_add_f32 v[22:23], v[22:23], v[30:31]
  v_pk_add_f32 v[144:145], v[20:21], v[32:33]
  v_pk_add_f32 v[146:147], v[22:23], v[34:35]
  s_mov_b32 s32, 1572864
  s_mov_b32 s33, 196608
  buffer_load_dwordx4 v[36:39], v14, s[4:7], s32 offen sc1
  buffer_load_dwordx4 v[40:43], v15, s[4:7], s32 offen sc1
  buffer_load_dwordx4 v[44:47], v19, s[4:7], s32 offen sc1
L_rowait_171:
  s_waitcnt vmcnt(0)
  v_max3_u32 v9, v39, v43, v47
  v_cmp_eq_u32 vcc, -1, v9
  s_cbranch_vccnz L_roretry_172
  v_pk_add_f32 v[140:141], v[140:141], v[36:37]
  v_pk_add_f32 v[142:143], v[142:143], v[38:39]
  v_pk_add_f32 v[140:141], v[140:141], v[40:41]
  v_pk_add_f32 v[142:143], v[142:143], v[42:43]
  v_pk_add_f32 v[140:141], v[140:141], v[44:45]
  v_pk_add_f32 v[142:143], v[142:143], v[46:47]
  v_sub_f32 v52, 1.0, v78
  v_pk_mul_f32 v[140:141], v[140:141], v[78:79] op_sel_hi:[1,0]
  v_lshlrev_b32 v36, 16, v76
  v_and_b32 v37, 0xffff0000, v76
  v_pk_fma_f32 v[140:141], v[36:37], v[52:53], v[140:141] op_sel_hi:[1,0,1]
  v_cvt_pk_bf16_f32 v56, v140, v141
  v_pk_mul_f32 v[142:143], v[142:143], v[78:79] op_sel_hi:[1,0]
  v_lshlrev_b32 v38, 16, v77
  v_and_b32 v39, 0xffff0000, v77
  v_pk_fma_f32 v[142:143], v[38:39], v[52:53], v[142:143] op_sel_hi:[1,0,1]
  v_cvt_pk_bf16_f32 v57, v142, v143
  buffer_store_dwordx2 v[56:57], v18, s[12:15], s33 offen
  s_barrier
  ds_read_b128 v[20:23], v12 offset:18432
  ds_read_b128 v[24:27], v12 offset:19584
  ds_read_b128 v[28:31], v12 offset:20736
  ds_read_b128 v[32:35], v12 offset:21888
  s_waitcnt lgkmcnt(0)
  v_pk_add_f32 v[20:21], v[20:21], v[24:25]
  v_pk_add_f32 v[22:23], v[22:23], v[26:27]
  v_pk_add_f32 v[20:21], v[20:21], v[28:29]
  v_pk_add_f32 v[22:23], v[22:23], v[30:31]
  v_pk_add_f32 v[148:149], v[20:21], v[32:33]
  v_pk_add_f32 v[150:151], v[22:23], v[34:35]
  s_mov_b32 s32, 2097152
  s_mov_b32 s33, 262144
  buffer_load_dwordx4 v[36:39], v14, s[4:7], s32 offen sc1
  buffer_load_dwordx4 v[40:43], v15, s[4:7], s32 offen sc1
  buffer_load_dwordx4 v[44:47], v19, s[4:7], s32 offen sc1
L_rowait_173:
  s_waitcnt vmcnt(0)
  v_max3_u32 v9, v39, v43, v47
  v_cmp_eq_u32 vcc, -1, v9
  s_cbranch_vccnz L_roretry_174
  v_pk_add_f32 v[144:145], v[144:145], v[36:37]
  v_pk_add_f32 v[146:147], v[146:147], v[38:39]
  v_pk_add_f32 v[144:145], v[144:145], v[40:41]
  v_pk_add_f32 v[146:147], v[146:147], v[42:43]
  v_pk_add_f32 v[144:145], v[144:145], v[44:45]
  v_pk_add_f32 v[146:147], v[146:147], v[46:47]
  v_sub_f32 v52, 1.0, v82
  v_pk_mul_f32 v[144:145], v[144:145], v[82:83] op_sel_hi:[1,0]
  v_lshlrev_b32 v36, 16, v80
  v_and_b32 v37, 0xffff0000, v80
  v_pk_fma_f32 v[144:145], v[36:37], v[52:53], v[144:145] op_sel_hi:[1,0,1]
  v_cvt_pk_bf16_f32 v56, v144, v145
  v_pk_mul_f32 v[146:147], v[146:147], v[82:83] op_sel_hi:[1,0]
  v_lshlrev_b32 v38, 16, v81
  v_and_b32 v39, 0xffff0000, v81
  v_pk_fma_f32 v[146:147], v[38:39], v[52:53], v[146:147] op_sel_hi:[1,0,1]
  v_cvt_pk_bf16_f32 v57, v146, v147
  buffer_store_dwordx2 v[56:57], v18, s[12:15], s33 offen
  s_barrier
  ds_read_b128 v[20:23], v12 offset:0
  ds_read_b128 v[24:27], v12 offset:1152
  ds_read_b128 v[28:31], v12 offset:2304
  ds_read_b128 v[32:35], v12 offset:3456
  s_waitcnt lgkmcnt(0)
  v_pk_add_f32 v[20:21], v[20:21], v[24:25]
  v_pk_add_f32 v[22:23], v[22:23], v[26:27]
  v_pk_add_f32 v[20:21], v[20:21], v[28:29]
  v_pk_add_f32 v[22:23], v[22:23], v[30:31]
  v_pk_add_f32 v[152:153], v[20:21], v[32:33]
  v_pk_add_f32 v[154:155], v[22:23], v[34:35]
  s_mov_b32 s32, 2621440
  s_mov_b32 s33, 327680
  buffer_load_dwordx4 v[36:39], v14, s[4:7], s32 offen sc1
  buffer_load_dwordx4 v[40:43], v15, s[4:7], s32 offen sc1
  buffer_load_dwordx4 v[44:47], v19, s[4:7], s32 offen sc1
L_rowait_175:
  s_waitcnt vmcnt(0)
  v_max3_u32 v9, v39, v43, v47
  v_cmp_eq_u32 vcc, -1, v9
  s_cbranch_vccnz L_roretry_176
  v_pk_add_f32 v[148:149], v[148:149], v[36:37]
  v_pk_add_f32 v[150:151], v[150:151], v[38:39]
  v_pk_add_f32 v[148:149], v[148:149], v[40:41]
  v_pk_add_f32 v[150:151], v[150:151], v[42:43]
  v_pk_add_f32 v[148:149], v[148:149], v[44:45]
  v_pk_add_f32 v[150:151], v[150:151], v[46:47]
  v_sub_f32 v52, 1.0, v86
  v_pk_mul_f32 v[148:149], v[148:149], v[86:87] op_sel_hi:[1,0]
  v_lshlrev_b32 v36, 16, v84
  v_and_b32 v37, 0xffff0000, v84
  v_pk_fma_f32 v[148:149], v[36:37], v[52:53], v[148:149] op_sel_hi:[1,0,1]
  v_cvt_pk_bf16_f32 v56, v148, v149
  v_pk_mul_f32 v[150:151], v[150:151], v[86:87] op_sel_hi:[1,0]
  v_lshlrev_b32 v38, 16, v85
  v_and_b32 v39, 0xffff0000, v85
  v_pk_fma_f32 v[150:151], v[38:39], v[52:53], v[150:151] op_sel_hi:[1,0,1]
  v_cvt_pk_bf16_f32 v57, v150, v151
  buffer_store_dwordx2 v[56:57], v18, s[12:15], s33 offen
  s_barrier
  ds_read_b128 v[20:23], v12 offset:18432
  ds_read_b128 v[24:27], v12 offset:19584
  ds_read_b128 v[28:31], v12 offset:20736
  ds_read_b128 v[32:35], v12 offset:21888
  s_waitcnt lgkmcnt(0)
  v_pk_add_f32 v[20:21], v[20:21], v[24:25]
  v_pk_add_f32 v[22:23], v[22:23], v[26:27]
  v_pk_add_f32 v[20:21], v[20:21], v[28:29]
  v_pk_add_f32 v[22:23], v[22:23], v[30:31]
  v_pk_add_f32 v[156:157], v[20:21], v[32:33]
  v_pk_add_f32 v[158:159], v[22:23], v[34:35]
  s_mov_b32 s32, 3145728
  s_mov_b32 s33, 393216
  buffer_load_dwordx4 v[36:39], v14, s[4:7], s32 offen sc1
  buffer_load_dwordx4 v[40:43], v15, s[4:7], s32 offen sc1
  buffer_load_dwordx4 v[44:47], v19, s[4:7], s32 offen sc1
L_rowait_177:
  s_waitcnt vmcnt(0)
  v_max3_u32 v9, v39, v43, v47
  v_cmp_eq_u32 vcc, -1, v9
  s_cbranch_vccnz L_roretry_178
  v_pk_add_f32 v[152:153], v[152:153], v[36:37]
  v_pk_add_f32 v[154:155], v[154:155], v[38:39]
  v_pk_add_f32 v[152:153], v[152:153], v[40:41]
  v_pk_add_f32 v[154:155], v[154:155], v[42:43]
  v_pk_add_f32 v[152:153], v[152:153], v[44:45]
  v_pk_add_f32 v[154:155], v[154:155], v[46:47]
  v_sub_f32 v52, 1.0, v90
  v_pk_mul_f32 v[152:153], v[152:153], v[90:91] op_sel_hi:[1,0]
  v_lshlrev_b32 v36, 16, v88
  v_and_b32 v37, 0xffff0000, v88
  v_pk_fma_f32 v[152:153], v[36:37], v[52:53], v[152:153] op_sel_hi:[1,0,1]
  v_cvt_pk_bf16_f32 v56, v152, v153
  v_pk_mul_f32 v[154:155], v[154:155], v[90:91] op_sel_hi:[1,0]
  v_lshlrev_b32 v38, 16, v89
  v_and_b32 v39, 0xffff0000, v89
  v_pk_fma_f32 v[154:155], v[38:39], v[52:53], v[154:155] op_sel_hi:[1,0,1]
  v_cvt_pk_bf16_f32 v57, v154, v155
  buffer_store_dwordx2 v[56:57], v18, s[12:15], s33 offen
  s_mov_b32 s32, 3670016
  s_mov_b32 s33, 458752
  buffer_load_dwordx4 v[36:39], v14, s[4:7], s32 offen sc1
  buffer_load_dwordx4 v[40:43], v15, s[4:7], s32 offen sc1
  buffer_load_dwordx4 v[44:47], v19, s[4:7], s32 offen sc1
L_rowait_179:
  s_waitcnt vmcnt(0)
  v_max3_u32 v9, v39, v43, v47
  v_cmp_eq_u32 vcc, -1, v9
  s_cbranch_vccnz L_roretry_180
  v_pk_add_f32 v[156:157], v[156:157], v[36:37]
  v_pk_add_f32 v[158:159], v[158:159], v[38:39]
  v_pk_add_f32 v[156:157], v[156:157], v[40:41]
  v_pk_add_f32 v[158:159], v[158:159], v[42:43]
  v_pk_add_f32 v[156:157], v[156:157], v[44:45]
  v_pk_add_f32 v[158:159], v[158:159], v[46:47]
  v_sub_f32 v52, 1.0, v94
  v_pk_mul_f32 v[156:157], v[156:157], v[94:95] op_sel_hi:[1,0]
  v_lshlrev_b32 v36, 16, v92
  v_and_b32 v37, 0xffff0000, v92
  v_pk_fma_f32 v[156:157], v[36:37], v[52:53], v[156:157] op_sel_hi:[1,0,1]
  v_cvt_pk_bf16_f32 v56, v156, v157
  v_pk_mul_f32 v[158:159], v[158:159], v[94:95] op_sel_hi:[1,0]
  v_lshlrev_b32 v38, 16, v93
  v_and_b32 v39, 0xffff0000, v93
  v_pk_fma_f32 v[158:159], v[38:39], v[52:53], v[158:159] op_sel_hi:[1,0,1]
  v_cvt_pk_bf16_f32 v57, v158, v159
  buffer_store_dwordx2 v[56:57], v18, s[12:15], s33 offen
  s_branch L_roout_128
L_roretry_166:
  buffer_load_dwordx4 v[36:39], v14, s[4:7], s32 offen sc1
  buffer_load_dwordx4 v[40:43], v15, s[4:7], s32 offen sc1
  buffer_load_dwordx4 v[44:47], v19, s[4:7], s32 offen sc1
  s_add_u32 s31, s31, 1
  s_cmp_lt_u32 s31, 1048576
  s_cbranch_scc1 L_rowait_165
  s_branch L_abort
L_roretry_168:
  buffer_load_dwordx4 v[36:39], v14, s[4:7], s32 offen sc1
  buffer_load_dwordx4 v[40:43], v15, s[4:7], s32 offen sc1
  buffer_load_dwordx4 v[44:47], v19, s[4:7], s32 offen sc1
  s_add_u32 s31, s31, 1
  s_cmp_lt_u32 s31, 1048576
  s_cbranch_scc1 L_rowait_167
  s_branch L_abort
L_roretry_170:
  buffer_load_dwordx4 v[36:39], v14, s[4:7], s32 offen sc1
  buffer_load_dwordx4 v[40:43], v15, s[4:7], s32 offen sc1
  buffer_load_dwordx4 v[44:47], v19, s[4:7], s32 offen sc1
  s_add_u32 s31, s31, 1
  s_cmp_lt_u32 s31, 1048576
  s_cbranch_scc1 L_rowait_169
  s_branch L_abort
L_roretry_172:
  buffer_load_dwordx4 v[36:39], v14, s[4:7], s32 offen sc1
  buffer_load_dwordx4 v[40:43], v15, s[4:7], s32 offen sc1
  buffer_load_dwordx4 v[44:47], v19, s[4:7], s32 offen sc1
  s_add_u32 s31, s31, 1
  s_cmp_lt_u32 s31, 1048576
  s_cbranch_scc1 L_rowait_171
  s_branch L_abort
L_roretry_174:
  buffer_load_dwordx4 v[36:39], v14, s[4:7], s32 offen sc1
  buffer_load_dwordx4 v[40:43], v15, s[4:7], s32 offen sc1
  buffer_load_dwordx4 v[44:47], v19, s[4:7], s32 offen sc1
  s_add_u32 s31, s31, 1
  s_cmp_lt_u32 s31, 1048576
  s_cbranch_scc1 L_rowait_173
  s_branch L_abort
L_roretry_176:
  buffer_load_dwordx4 v[36:39], v14, s[4:7], s32 offen sc1
  buffer_load_dwordx4 v[40:43], v15, s[4:7], s32 offen sc1
  buffer_load_dwordx4 v[44:47], v19, s[4:7], s32 offen sc1
  s_add_u32 s31, s31, 1
  s_cmp_lt_u32 s31, 1048576
  s_cbranch_scc1 L_rowait_175
  s_branch L_abort
L_roretry_178:
  buffer_load_dwordx4 v[36:39], v14, s[4:7], s32 offen sc1
  buffer_load_dwordx4 v[40:43], v15, s[4:7], s32 offen sc1
  buffer_load_dwordx4 v[44:47], v19, s[4:7], s32 offen sc1
  s_add_u32 s31, s31, 1
  s_cmp_lt_u32 s31, 1048576
  s_cbranch_scc1 L_rowait_177
  s_branch L_abort
L_roretry_180:
  buffer_load_dwordx4 v[36:39], v14, s[4:7], s32 offen sc1
  buffer_load_dwordx4 v[40:43], v15, s[4:7], s32 offen sc1
  buffer_load_dwordx4 v[44:47], v19, s[4:7], s32 offen sc1
  s_add_u32 s31, s31, 1
  s_cmp_lt_u32 s31, 1048576
  s_cbranch_scc1 L_rowait_179
  s_branch L_abort
L_roout_128:
  s_waitcnt vmcnt(0) lgkmcnt(0)
  s_barrier
  s_setprio 0
  s_add_u32 s24, s24, 4
  s_mov_b32 s87, 1
  s_mov_b32 s59, 0
  s_mov_b32 s58, 1
  s_branch L_exec_t
L_extra:
  s_cmp_lg_u32 s28, 0
  s_cbranch_scc1 L_ex_181
  v_lshlrev_b32 v4, 2, v1
  s_mov_b32 s42, 0
L_rm_182:
  buffer_load_dword v5, v4, s[20:23], 0 offen sc1
  s_waitcnt vmcnt(0)
  v_readlane_b32 s87, v5, 10
  v_readlane_b32 s43, v5, 8
  v_cmp_eq_u32 vcc, 32, v5
  s_nop 2
  s_cmp_lg_u32 s87, 0
  s_cbranch_scc1 L_rmdone_184
  s_cmp_lt_u32 s43, 256
  s_cbranch_scc1 L_rmnc_185
  s_and_b32 vcc_lo, vcc_lo, 0x30003
  s_and_b32 vcc_hi, vcc_hi, 0x30003
  s_and_b32 vcc_lo, vcc_lo, vcc_hi
  s_cmp_eq_u32 vcc_lo, 0x30003
  s_cselect_b32 s43, 1, 2
  s_branch L_rmcas_183
L_rmnc_185:
  s_sleep 2
  s_add_u32 s42, s42, 1
  s_cmp_lt_u32 s42, 2048
  s_cbranch_scc1 L_rm_182
  s_mov_b32 s43, 2
L_rmcas_183:
  v_mov_b32 v6, s43
  v_mov_b32 v7, 0
  v_mov_b32 v4, 40
  v_mov_b32 v5, 0x80000000
  v_cmp_eq_u32 vcc, 0, v1
  s_nop 1
  v_cndmask_b32 v4, v5, v4, vcc
  buffer_atomic_cmpswap v[6:7], v4, s[20:23], 0 offen sc0
  s_waitcnt vmcnt(0)
  v_readfirstlane_b32 s87, v6
  s_nop 3
  s_cmp_eq_u32 s87, 0
  s_cselect_b32 s87, s43, s87
L_rmdone_184:
  v_mov_b32 v4, s87
  v_mov_b32 v2, 17408
  ds_write_b32 v2, v4
  s_waitcnt lgkmcnt(0)
L_ex_181:
  s_barrier
  v_mov_b32 v2, 17408
  ds_read_b32 v4, v2
  s_waitcnt lgkmcnt(0)
  v_readfirstlane_b32 s87, v4
  s_nop 3
  s_cmp_lg_u32 s87, 2
  s_cbranch_scc1 L_end
L_slow:
  s_waitcnt vmcnt(0) lgkmcnt(0)
  s_barrier
  v_and_b32 v1, 63, v0
  s_cmp_lg_u32 s28, 0
  s_cbranch_scc1 L_slow_186
  v_mov_b32 v2, 44
  v_mov_b32 v3, 0x80000000
  v_cmp_eq_u32 vcc, 0, v1
  v_mov_b32 v4, 1
  s_nop 0
  v_cndmask_b32 v2, v3, v2, vcc
  buffer_atomic_add v4, v2, s[20:23], 0 offen sc0
  s_waitcnt vmcnt(0)
  v_readfirstlane_b32 s42, v4
  s_nop 1
  v_mov_b32 v4, s42
  v_mov_b32 v2, 17408
  ds_write_b32 v2, v4
  s_waitcnt lgkmcnt(0)
L_slow_186:
  s_barrier
  v_mov_b32 v2, 17408
  ds_read_b32 v4, v2
  s_waitcnt lgkmcnt(0)
  v_readfirstlane_b32 s42, v4
  s_nop 3
  s_barrier
  s_cmp_lt_u32 s42, 128
  s_cbranch_scc1 L_rec_slow
  v_mov_b32 v2, 48
  s_mov_b32 s83, 0
  s_movk_i32 s43, 128
L_in2_187:
  buffer_load_dword v3, v2, s[20:23], 0 offen sc1
  s_waitcnt vmcnt(0)
  v_cmp_le_u32 vcc, s43, v3
  s_cbranch_vccnz L_in2ok_188
  s_sleep 8
  s_add_u32 s83, s83, 1
  s_cmp_lt_u32 s83, 1048576
  s_cbranch_scc1 L_in2_187
  s_branch L_abort
L_in2ok_188:
  s_and_b32 s25, s42, 127
  s_mov_b32 s24, 0
  s_mov_b32 s87, 2
  s_mov_b32 s59, 0x4000000
  s_mov_b32 s58, 1
  s_branch L_exec_t
L_rec_slow:
  s_lshr_b32 s24, s42, 5
  s_and_b32 s25, s42, 31
  s_load_dwordx4 s[44:47], s[0:1], 8
  s_load_dwordx4 s[48:51], s[0:1], 24
  s_load_dwordx2 s[54:55], s[0:1], 40
  s_waitcnt lgkmcnt(0)
  s_mov_b32 s52, s44
  s_mov_b32 s53, s45
  s_lshl_b32 s26, s24, 3
  s_lshr_b32 s39, s25, 2
  s_add_u32 s26, s26, s39
  s_and_b32 s27, s25, 3
  s_mov_b32 s29, 0
  s_mov_b32 s31, 0
  s_add_u32 s39, s4, 0xa1fffff
  s_and_b32 s39, s39, 0xffe00000
  s_sub_u32 s36, s39, s4
  v_and_b32 v1, 63, v0
  v_and_b32 v2, 15, v1
  v_lshrrev_b32 v3, 4, v1
  s_cmp_lt_u32 s28, 4
  s_cbranch_scc1 L_ws1_193
  s_cmp_eq_u32 s28, 7
  s_cbranch_scc1 L_w7_192
  s_mov_b32 s8, s54
  s_mov_b32 s9, s55
  s_mov_b32 s10, 0x800000
  s_mov_b32 s11, 0x20000
  s_lshl_b32 s39, s24, 21
  s_sub_u32 s41, s28, 4
  s_mul_i32 s40, s41, 16384
  s_add_u32 s40, s40, 92160
  s_lshl_b32 s41, s41, 19
  s_add_u32 s39, s39, s41
  s_lshl_b32 s41, s25, 6
  s_add_u32 s39, s39, s41
  v_lshrrev_b32 v4, 2, v1
  v_mul_u32_u24 v4, 2048, v4
  v_and_b32 v6, 3, v1
  v_lshl_add_u32 v4, v6, 4, v4
  v_add_u32 v4, s39, v4
  v_lshrrev_b32 v6, 1, v3
  v_and_b32 v7, 1, v3
  v_lshlrev_b32 v6, 3, v6
  v_lshl_add_u32 v6, v7, 4, v6
  v_lshrrev_b32 v7, 2, v2
  v_add_u32 v6, v6, v7
  v_and_b32 v7, 3, v2
  v_lshlrev_b32 v7, 3, v7
  v_lshl_add_u32 v5, v6, 6, v7
  v_add_u32 v5, s40, v5
  s_add_u32 m0, s40, 0
  s_mov_b32 s39, 0x0
  buffer_load_dwordx4 v4, s[8:11], s39 offen lds
  s_add_u32 m0, s40, 1024
  s_mov_b32 s39, 0x8000
  buffer_load_dwordx4 v4, s[8:11], s39 offen lds
  s_add_u32 m0, s40, 2048
  s_mov_b32 s39, 0x10000
  buffer_load_dwordx4 v4, s[8:11], s39 offen lds
  s_add_u32 m0, s40, 3072
  s_mov_b32 s39, 0x18000
  buffer_load_dwordx4 v4, s[8:11], s39 offen lds
  s_add_u32 m0, s40, 4096
  s_mov_b32 s39, 0x20000
  buffer_load_dwordx4 v4, s[8:11], s39 offen lds
  s_add_u32 m0, s40, 5120
  s_mov_b32 s39, 0x28000
  buffer_load_dwordx4 v4, s[8:11], s39 offen lds
  s_add_u32 m0, s40, 6144
  s_mov_b32 s39, 0x30000
  buffer_load_dwordx4 v4, s[8:11], s39 offen lds
  s_add_u32 m0, s40, 7168
  s_mov_b32 s39, 0x38000
  buffer_load_dwordx4 v4, s[8:11], s39 offen lds
  s_add_u32 m0, s40, 8192
  s_mov_b32 s39, 0x40000
  buffer_load_dwordx4 v4, s[8:11], s39 offen lds
  s_add_u32 m0, s40, 9216
  s_mov_b32 s39, 0x48000
  buffer_load_dwordx4 v4, s[8:11], s39 offen lds
  s_add_u32 m0, s40, 10240
  s_mov_b32 s39, 0x50000
  buffer_load_dwordx4 v4, s[8:11], s39 offen lds
  s_add_u32 m0, s40, 11264
  s_mov_b32 s39, 0x58000
  buffer_load_dwordx4 v4, s[8:11], s39 offen lds
  s_add_u32 m0, s40, 12288
  s_mov_b32 s39, 0x60000
  buffer_load_dwordx4 v4, s[8:11], s39 offen lds
  s_add_u32 m0, s40, 13312
  s_mov_b32 s39, 0x68000
  buffer_load_dwordx4 v4, s[8:11], s39 offen lds
  s_add_u32 m0, s40, 14336
  s_mov_b32 s39, 0x70000
  buffer_load_dwordx4 v4, s[8:11], s39 offen lds
  s_add_u32 m0, s40, 15360
  s_mov_b32 s39, 0x78000
  buffer_load_dwordx4 v4, s[8:11], s39 offen lds
  s_waitcnt vmcnt(12)
  ds_read_b64_tr_b16 v[12:13], v5 offset:0
  ds_read_b64_tr_b16 v[14:15], v5 offset:256
  ds_read_b64_tr_b16 v[16:17], v5 offset:2048
  ds_read_b64_tr_b16 v[18:19], v5 offset:2304
  ds_read_b64_tr_b16 v[20:21], v5 offset:32
  ds_read_b64_tr_b16 v[22:23], v5 offset:288
  ds_read_b64_tr_b16 v[24:25], v5 offset:2080
  ds_read_b64_tr_b16 v[26:27], v5 offset:2336
  s_waitcnt lgkmcnt(0)
  v_accvgpr_write_b32 a0, v12
  v_accvgpr_write_b32 a2, v13
  v_accvgpr_write_b32 a1, v14
  v_accvgpr_write_b32 a3, v15
  v_accvgpr_write_b32 a4, v16
  v_accvgpr_write_b32 a6, v17
  v_accvgpr_write_b32 a5, v18
  v_accvgpr_write_b32 a7, v19
  v_accvgpr_write_b32 a8, v20
  v_accvgpr_write_b32 a10, v21
  v_accvgpr_write_b32 a9, v22
  v_accvgpr_write_b32 a11, v23
  v_accvgpr_write_b32 a12, v24
  v_accvgpr_write_b32 a14, v25
  v_accvgpr_write_b32 a13, v26
  v_accvgpr_write_b32 a15, v27
  s_waitcnt vmcnt(8)
  ds_read_b64_tr_b16 v[12:13], v5 offset:4096
  ds_read_b64_tr_b16 v[14:15], v5 offset:4352
  ds_read_b64_tr_b16 v[16:17], v5 offset:6144
  ds_read_b64_tr_b16 v[18:19], v5 offset:6400
  ds_read_b64_tr_b16 v[20:21], v5 offset:4128
  ds_read_b64_tr_b16 v[22:23], v5 offset:4384
  ds_read_b64_tr_b16 v[24:25], v5 offset:6176
  ds_read_b64_tr_b16 v[26:27], v5 offset:6432
  s_waitcnt lgkmcnt(0)
  v_accvgpr_write_b32 a16, v12
  v_accvgpr_write_b32 a18, v13
  v_accvgpr_write_b32 a17, v14
  v_accvgpr_write_b32 a19, v15
  v_accvgpr_write_b32 a20, v16
  v_accvgpr_write_b32 a22, v17
  v_accvgpr_write_b32 a21, v18
  v_accvgpr_write_b32 a23, v19
  v_accvgpr_write_b32 a24, v20
  v_accvgpr_write_b32 a26, v21
  v_accvgpr_write_b32 a25, v22
  v_accvgpr_write_b32 a27, v23
  v_accvgpr_write_b32 a28, v24
  v_accvgpr_write_b32 a30, v25
  v_accvgpr_write_b32 a29, v26
  v_accvgpr_write_b32 a31, v27
  s_waitcnt vmcnt(4)
  ds_read_b64_tr_b16 v[12:13], v5 offset:8192
  ds_read_b64_tr_b16 v[14:15], v5 offset:8448
  ds_read_b64_tr_b16 v[16:17], v5 offset:10240
  ds_read_b64_tr_b16 v[18:19], v5 offset:10496
  ds_read_b64_tr_b16 v[20:21], v5 offset:8224
  ds_read_b64_tr_b16 v[22:23], v5 offset:8480
  ds_read_b64_tr_b16 v[24:25], v5 offset:10272
  ds_read_b64_tr_b16 v[26:27], v5 offset:10528
  s_waitcnt lgkmcnt(0)
  v_accvgpr_write_b32 a32, v12
  v_accvgpr_write_b32 a34, v13
  v_accvgpr_write_b32 a33, v14
  v_accvgpr_write_b32 a35, v15
  v_accvgpr_write_b32 a36, v16
  v_accvgpr_write_b32 a38, v17
  v_accvgpr_write_b32 a37, v18
  v_accvgpr_write_b32 a39, v19
  v_accvgpr_write_b32 a40, v20
  v_accvgpr_write_b32 a42, v21
  v_accvgpr_write_b32 a41, v22
  v_accvgpr_write_b32 a43, v23
  v_accvgpr_write_b32 a44, v24
  v_accvgpr_write_b32 a46, v25
  v_accvgpr_write_b32 a45, v26
  v_accvgpr_write_b32 a47, v27
  s_waitcnt vmcnt(0)
  ds_read_b64_tr_b16 v[12:13], v5 offset:12288
  ds_read_b64_tr_b16 v[14:15], v5 offset:12544
  ds_read_b64_tr_b16 v[16:17], v5 offset:14336
  ds_read_b64_tr_b16 v[18:19], v5 offset:14592
  ds_read_b64_tr_b16 v[20:21], v5 offset:12320
  ds_read_b64_tr_b16 v[22:23], v5 offset:12576
  ds_read_b64_tr_b16 v[24:25], v5 offset:14368
  ds_read_b64_tr_b16 v[26:27], v5 offset:14624
  s_waitcnt lgkmcnt(0)
  v_accvgpr_write_b32 a48, v12
  v_accvgpr_write_b32 a50, v13
  v_accvgpr_write_b32 a49, v14
  v_accvgpr_write_b32 a51, v15
  v_accvgpr_write_b32 a52, v16
  v_accvgpr_write_b32 a54, v17
  v_accvgpr_write_b32 a53, v18
  v_accvgpr_write_b32 a55, v19
  v_accvgpr_write_b32 a56, v20
  v_accvgpr_write_b32 a58, v21
  v_accvgpr_write_b32 a57, v22
  v_accvgpr_write_b32 a59, v23
  v_accvgpr_write_b32 a60, v24
  v_accvgpr_write_b32 a62, v25
  v_accvgpr_write_b32 a61, v26
  v_accvgpr_write_b32 a63, v27
  s_setprio 0
  v_and_b32 v4, 8, v1
  v_cmp_eq_u32 vcc, 0, v4
  v_mov_b32 v4, 0xeeee
  v_mov_b32 v6, 0x4444
  v_cndmask_b32 v4, v4, v6, vcc
  s_sub_u32 s40, s28, 4
  s_lshl_b32 s39, s40, 12
  v_lshl_add_u32 v5, v1, 4, s39
  v_and_b32 v6, 1, v3
  v_mul_u32_u24 v7, 576, v6
  v_lshrrev_b32 v6, 5, v1
  v_lshl_add_u32 v6, v6, 4, v2
  v_lshl_add_u32 v7, v6, 2, v7
  s_mul_i32 s39, s40, 1152
  s_add_u32 s39, s39, 12800
  v_add_u32 v7, s39, v7
  s_cmp_eq_u32 s28, 4
  s_cbranch_scc1 L_w4_189
  s_cmp_eq_u32 s28, 5
  s_cbranch_scc1 L_w5_190
  s_branch L_w6_191
L_ws1_193:
  s_mov_b32 s8, s46
  s_mov_b32 s9, s47
  s_mov_b32 s10, 0x800000
  s_mov_b32 s11, 0x20000
  s_mov_b32 s12, s48
  s_mov_b32 s13, s49
  s_mov_b32 s14, 0x800000
  s_mov_b32 s15, 0x20000
  s_mov_b32 s16, s50
  s_mov_b32 s17, s51
  s_mov_b32 s18, 0x800000
  s_mov_b32 s19, 0x20000
  s_lshl_b32 s39, s26, 8
  s_lshl_b32 s41, s27, 6
  s_add_u32 s39, s39, s41
  s_lshl_b32 s41, s28, 19
  s_add_u32 s39, s39, s41
  s_mul_i32 s40, s28, 16384
  s_add_u32 s40, s40, 26624
  v_lshrrev_b32 v4, 2, v1
  v_mul_u32_u24 v4, 8192, v4
  v_and_b32 v6, 3, v1
  v_lshl_add_u32 v4, v6, 4, v4
  v_add_u32 v4, s39, v4
  v_lshrrev_b32 v6, 1, v3
  v_and_b32 v7, 1, v3
  v_lshlrev_b32 v6, 4, v6
  v_lshl_add_u32 v6, v7, 2, v6
  v_lshrrev_b32 v7, 2, v2
  v_add_u32 v6, v6, v7
  v_and_b32 v7, 3, v2
  v_lshlrev_b32 v7, 3, v7
  v_lshl_add_u32 v5, v6, 6, v7
  v_add_u32 v5, s40, v5
  s_add_u32 m0, s40, 0
  s_mov_b32 s39, 0x0
  buffer_load_dwordx4 v4, s[8:11], s39 offen lds
  s_add_u32 m0, s40, 1024
  s_mov_b32 s39, 0x20000
  buffer_load_dwordx4 v4, s[8:11], s39 offen lds
  s_add_u32 m0, s40, 2048
  s_mov_b32 s39, 0x40000
  buffer_load_dwordx4 v4, s[8:11], s39 offen lds
  s_add_u32 m0, s40, 3072
  s_mov_b32 s39, 0x60000
  buffer_load_dwordx4 v4, s[8:11], s39 offen lds
  s_add_u32 m0, s40, 4096
  s_mov_b32 s39, 0x200000
  buffer_load_dwordx4 v4, s[8:11], s39 offen lds
  s_add_u32 m0, s40, 5120
  s_mov_b32 s39, 0x220000
  buffer_load_dwordx4 v4, s[8:11], s39 offen lds
  s_add_u32 m0, s40, 6144
  s_mov_b32 s39, 0x240000
  buffer_load_dwordx4 v4, s[8:11], s39 offen lds
  s_add_u32 m0, s40, 7168
  s_mov_b32 s39, 0x260000
  buffer_load_dwordx4 v4, s[8:11], s39 offen lds
  s_add_u32 m0, s40, 8192
  s_mov_b32 s39, 0x400000
  buffer_load_dwordx4 v4, s[8:11], s39 offen lds
  s_add_u32 m0, s40, 9216
  s_mov_b32 s39, 0x420000
  buffer_load_dwordx4 v4, s[8:11], s39 offen lds
  s_add_u32 m0, s40, 10240
  s_mov_b32 s39, 0x440000
  buffer_load_dwordx4 v4, s[8:11], s39 offen lds
  s_add_u32 m0, s40, 11264
  s_mov_b32 s39, 0x460000
  buffer_load_dwordx4 v4, s[8:11], s39 offen lds
  s_add_u32 m0, s40, 12288
  s_mov_b32 s39, 0x600000
  buffer_load_dwordx4 v4, s[8:11], s39 offen lds
  s_add_u32 m0, s40, 13312
  s_mov_b32 s39, 0x620000
  buffer_load_dwordx4 v4, s[8:11], s39 offen lds
  s_add_u32 m0, s40, 14336
  s_mov_b32 s39, 0x640000
  buffer_load_dwordx4 v4, s[8:11], s39 offen lds
  s_add_u32 m0, s40, 15360
  s_mov_b32 s39, 0x660000
  buffer_load_dwordx4 v4, s[8:11], s39 offen lds
  s_waitcnt vmcnt(12)
  ds_read_b64_tr_b16 v[12:13], v5 offset:0
  ds_read_b64_tr_b16 v[14:15], v5 offset:512
  ds_read_b64_tr_b16 v[16:17], v5 offset:2048
  ds_read_b64_tr_b16 v[18:19], v5 offset:2560
  ds_read_b64_tr_b16 v[20:21], v5 offset:32
  ds_read_b64_tr_b16 v[22:23], v5 offset:544
  ds_read_b64_tr_b16 v[24:25], v5 offset:2080
  ds_read_b64_tr_b16 v[26:27], v5 offset:2592
  s_waitcnt lgkmcnt(0)
  s_add_u32 m0, s40, 0
  s_mov_b32 s39, 0x0
  buffer_load_dwordx4 v4, s[12:15], s39 offen lds
  s_add_u32 m0, s40, 1024
  s_mov_b32 s39, 0x20000
  buffer_load_dwordx4 v4, s[12:15], s39 offen lds
  s_add_u32 m0, s40, 2048
  s_mov_b32 s39, 0x40000
  buffer_load_dwordx4 v4, s[12:15], s39 offen lds
  s_add_u32 m0, s40, 3072
  s_mov_b32 s39, 0x60000
  buffer_load_dwordx4 v4, s[12:15], s39 offen lds
  v_accvgpr_write_b32 a0, v12
  v_accvgpr_write_b32 a2, v13
  v_accvgpr_write_b32 a1, v14
  v_accvgpr_write_b32 a3, v15
  v_accvgpr_write_b32 a4, v16
  v_accvgpr_write_b32 a6, v17
  v_accvgpr_write_b32 a5, v18
  v_accvgpr_write_b32 a7, v19
  v_accvgpr_write_b32 a8, v20
  v_accvgpr_write_b32 a10, v21
  v_accvgpr_write_b32 a9, v22
  v_accvgpr_write_b32 a11, v23
  v_accvgpr_write_b32 a12, v24
  v_accvgpr_write_b32 a14, v25
  v_accvgpr_write_b32 a13, v26
  v_accvgpr_write_b32 a15, v27
  s_waitcnt vmcnt(12)
  ds_read_b64_tr_b16 v[12:13], v5 offset:4096
  ds_read_b64_tr_b16 v[14:15], v5 offset:4608
  ds_read_b64_tr_b16 v[16:17], v5 offset:6144
  ds_read_b64_tr_b16 v[18:19], v5 offset:6656
  ds_read_b64_tr_b16 v[20:21], v5 offset:4128
  ds_read_b64_tr_b16 v[22:23], v5 offset:4640
  ds_read_b64_tr_b16 v[24:25], v5 offset:6176
  ds_read_b64_tr_b16 v[26:27], v5 offset:6688
  s_waitcnt lgkmcnt(0)
  s_add_u32 m0, s40, 4096
  s_mov_b32 s39, 0x0
  buffer_load_dwordx4 v4, s[16:19], s39 offen lds
  s_add_u32 m0, s40, 5120
  s_mov_b32 s39, 0x20000
  buffer_load_dwordx4 v4, s[16:19], s39 offen lds
  s_add_u32 m0, s40, 6144
  s_mov_b32 s39, 0x40000
  buffer_load_dwordx4 v4, s[16:19], s39 offen lds
  s_add_u32 m0, s40, 7168
  s_mov_b32 s39, 0x60000
  buffer_load_dwordx4 v4, s[16:19], s39 offen lds
  v_accvgpr_write_b32 a48, v12
  v_accvgpr_write_b32 a50, v13
  v_accvgpr_write_b32 a49, v14
  v_accvgpr_write_b32 a51, v15
  v_accvgpr_write_b32 a52, v16
  v_accvgpr_write_b32 a54, v17
  v_accvgpr_write_b32 a53, v18
  v_accvgpr_write_b32 a55, v19
  v_accvgpr_write_b32 a56, v20
  v_accvgpr_write_b32 a58, v21
  v_accvgpr_write_b32 a57, v22
  v_accvgpr_write_b32 a59, v23
  v_accvgpr_write_b32 a60, v24
  v_accvgpr_write_b32 a62, v25
  v_accvgpr_write_b32 a61, v26
  v_accvgpr_write_b32 a63, v27
  s_waitcnt vmcnt(12)
  ds_read_b64_tr_b16 v[12:13], v5 offset:8192
  ds_read_b64_tr_b16 v[14:15], v5 offset:8704
  ds_read_b64_tr_b16 v[16:17], v5 offset:10240
  ds_read_b64_tr_b16 v[18:19], v5 offset:10752
  ds_read_b64_tr_b16 v[20:21], v5 offset:8224
  ds_read_b64_tr_b16 v[22:23], v5 offset:8736
  ds_read_b64_tr_b16 v[24:25], v5 offset:10272
  ds_read_b64_tr_b16 v[26:27], v5 offset:10784
  s_waitcnt lgkmcnt(0)
  s_add_u32 m0, s40, 8192
  s_mov_b32 s39, 0x200000
  buffer_load_dwordx4 v4, s[12:15], s39 offen lds
  s_add_u32 m0, s40, 9216
  s_mov_b32 s39, 0x220000
  buffer_load_dwordx4 v4, s[12:15], s39 offen lds
  s_add_u32 m0, s40, 10240
  s_mov_b32 s39, 0x240000
  buffer_load_dwordx4 v4, s[12:15], s39 offen lds
  s_add_u32 m0, s40, 11264
  s_mov_b32 s39, 0x260000
  buffer_load_dwordx4 v4, s[12:15], s39 offen lds
  v_mov_b32 v96, v12
  v_mov_b32 v98, v13
  v_mov_b32 v97, v14
  v_mov_b32 v99, v15
  v_mov_b32 v100, v16
  v_mov_b32 v102, v17
  v_mov_b32 v101, v18
  v_mov_b32 v103, v19
  v_mov_b32 v104, v20
  v_mov_b32 v106, v21
  v_mov_b32 v105, v22
  v_mov_b32 v107, v23
  v_mov_b32 v108, v24
  v_mov_b32 v110, v25
  v_mov_b32 v109, v26
  v_mov_b32 v111, v27
  s_waitcnt vmcnt(12)
  ds_read_b64_tr_b16 v[12:13], v5 offset:12288
  ds_read_b64_tr_b16 v[14:15], v5 offset:12800
  ds_read_b64_tr_b16 v[16:17], v5 offset:14336
  ds_read_b64_tr_b16 v[18:19], v5 offset:14848
  ds_read_b64_tr_b16 v[20:21], v5 offset:12320
  ds_read_b64_tr_b16 v[22:23], v5 offset:12832
  ds_read_b64_tr_b16 v[24:25], v5 offset:14368
  ds_read_b64_tr_b16 v[26:27], v5 offset:14880
  s_waitcnt lgkmcnt(0)
  s_add_u32 m0, s40, 12288
  s_mov_b32 s39, 0x200000
  buffer_load_dwordx4 v4, s[16:19], s39 offen lds
  s_add_u32 m0, s40, 13312
  s_mov_b32 s39, 0x220000
  buffer_load_dwordx4 v4, s[16:19], s39 offen lds
  s_add_u32 m0, s40, 14336
  s_mov_b32 s39, 0x240000
  buffer_load_dwordx4 v4, s[16:19], s39 offen lds
  s_add_u32 m0, s40, 15360
  s_mov_b32 s39, 0x260000
  buffer_load_dwordx4 v4, s[16:19], s39 offen lds
  v_mov_b32 v144, v12
  v_mov_b32 v146, v13
  v_mov_b32 v145, v14
  v_mov_b32 v147, v15
  v_mov_b32 v148, v16
  v_mov_b32 v150, v17
  v_mov_b32 v149, v18
  v_mov_b32 v151, v19
  v_mov_b32 v152, v20
  v_mov_b32 v154, v21
  v_mov_b32 v153, v22
  v_mov_b32 v155, v23
  v_mov_b32 v156, v24
  v_mov_b32 v158, v25
  v_mov_b32 v157, v26
  v_mov_b32 v159, v27
  s_waitcnt vmcnt(12)
  ds_read_b64_tr_b16 v[12:13], v5 offset:0
  ds_read_b64_tr_b16 v[14:15], v5 offset:512
  ds_read_b64_tr_b16 v[16:17], v5 offset:2048
  ds_read_b64_tr_b16 v[18:19], v5 offset:2560
  ds_read_b64_tr_b16 v[20:21], v5 offset:32
  ds_read_b64_tr_b16 v[22:23], v5 offset:544
  ds_read_b64_tr_b16 v[24:25], v5 offset:2080
  ds_read_b64_tr_b16 v[26:27], v5 offset:2592
  s_waitcnt lgkmcnt(0)
  s_add_u32 m0, s40, 0
  s_mov_b32 s39, 0x400000
  buffer_load_dwordx4 v4, s[12:15], s39 offen lds
  s_add_u32 m0, s40, 1024
  s_mov_b32 s39, 0x420000
  buffer_load_dwordx4 v4, s[12:15], s39 offen lds
  s_add_u32 m0, s40, 2048
  s_mov_b32 s39, 0x440000
  buffer_load_dwordx4 v4, s[12:15], s39 offen lds
  s_add_u32 m0, s40, 3072
  s_mov_b32 s39, 0x460000
  buffer_load_dwordx4 v4, s[12:15], s39 offen lds
  v_accvgpr_write_b32 a16, v12
  v_accvgpr_write_b32 a18, v13
  v_accvgpr_write_b32 a17, v14
  v_accvgpr_write_b32 a19, v15
  v_accvgpr_write_b32 a20, v16
  v_accvgpr_write_b32 a22, v17
  v_accvgpr_write_b32 a21, v18
  v_accvgpr_write_b32 a23, v19
  v_accvgpr_write_b32 a24, v20
  v_accvgpr_write_b32 a26, v21
  v_accvgpr_write_b32 a25, v22
  v_accvgpr_write_b32 a27, v23
  v_accvgpr_write_b32 a28, v24
  v_accvgpr_write_b32 a30, v25
  v_accvgpr_write_b32 a29, v26
  v_accvgpr_write_b32 a31, v27
  s_waitcnt vmcnt(12)
  ds_read_b64_tr_b16 v[12:13], v5 offset:4096
  ds_read_b64_tr_b16 v[14:15], v5 offset:4608
  ds_read_b64_tr_b16 v[16:17], v5 offset:6144
  ds_read_b64_tr_b16 v[18:19], v5 offset:6656
  ds_read_b64_tr_b16 v[20:21], v5 offset:4128
  ds_read_b64_tr_b16 v[22:23], v5 offset:4640
  ds_read_b64_tr_b16 v[24:25], v5 offset:6176
  ds_read_b64_tr_b16 v[26:27], v5 offset:6688
  s_waitcnt lgkmcnt(0)
  s_add_u32 m0, s40, 4096
  s_mov_b32 s39, 0x400000
  buffer_load_dwordx4 v4, s[16:19], s39 offen lds
  s_add_u32 m0, s40, 5120
  s_mov_b32 s39, 0x420000
  buffer_load_dwordx4 v4, s[16:19], s39 offen lds
  s_add_u32 m0, s40, 6144
  s_mov_b32 s39, 0x440000
  buffer_load_dwordx4 v4, s[16:19], s39 offen lds
  s_add_u32 m0, s40, 7168
  s_mov_b32 s39, 0x460000
  buffer_load_dwordx4 v4, s[16:19], s39 offen lds
  v_accvgpr_write_b32 a32, v12
  v_accvgpr_write_b32 a34, v13
  v_accvgpr_write_b32 a33, v14
  v_accvgpr_write_b32 a35, v15
  v_accvgpr_write_b32 a36, v16
  v_accvgpr_write_b32 a38, v17
  v_accvgpr_write_b32 a37, v18
  v_accvgpr_write_b32 a39, v19
  v_accvgpr_write_b32 a40, v20
  v_accvgpr_write_b32 a42, v21
  v_accvgpr_write_b32 a41, v22
  v_accvgpr_write_b32 a43, v23
  v_accvgpr_write_b32 a44, v24
  v_accvgpr_write_b32 a46, v25
  v_accvgpr_write_b32 a45, v26
  v_accvgpr_write_b32 a47, v27
  s_waitcnt vmcnt(12)
  ds_read_b64_tr_b16 v[12:13], v5 offset:8192
  ds_read_b64_tr_b16 v[14:15], v5 offset:8704
  ds_read_b64_tr_b16 v[16:17], v5 offset:10240
  ds_read_b64_tr_b16 v[18:19], v5 offset:10752
  ds_read_b64_tr_b16 v[20:21], v5 offset:8224
  ds_read_b64_tr_b16 v[22:23], v5 offset:8736
  ds_read_b64_tr_b16 v[24:25], v5 offset:10272
  ds_read_b64_tr_b16 v[26:27], v5 offset:10784
  s_waitcnt lgkmcnt(0)
  s_add_u32 m0, s40, 8192
  s_mov_b32 s39, 0x600000
  buffer_load_dwordx4 v4, s[12:15], s39 offen lds
  s_add_u32 m0, s40, 9216
  s_mov_b32 s39, 0x620000
  buffer_load_dwordx4 v4, s[12:15], s39 offen lds
  s_add_u32 m0, s40, 10240
  s_mov_b32 s39, 0x640000
  buffer_load_dwordx4 v4, s[12:15], s39 offen lds
  s_add_u32 m0, s40, 11264
  s_mov_b32 s39, 0x660000
  buffer_load_dwordx4 v4, s[12:15], s39 offen lds
  v_mov_b32 v64, v12
  v_mov_b32 v66, v13
  v_mov_b32 v65, v14
  v_mov_b32 v67, v15
  v_mov_b32 v68, v16
  v_mov_b32 v70, v17
  v_mov_b32 v69, v18
  v_mov_b32 v71, v19
  v_mov_b32 v72, v20
  v_mov_b32 v74, v21
  v_mov_b32 v73, v22
  v_mov_b32 v75, v23
  v_mov_b32 v76, v24
  v_mov_b32 v78, v25
  v_mov_b32 v77, v26
  v_mov_b32 v79, v27
  s_waitcnt vmcnt(12)
  ds_read_b64_tr_b16 v[12:13], v5 offset:12288
  ds_read_b64_tr_b16 v[14:15], v5 offset:12800
  ds_read_b64_tr_b16 v[16:17], v5 offset:14336
  ds_read_b64_tr_b16 v[18:19], v5 offset:14848
  ds_read_b64_tr_b16 v[20:21], v5 offset:12320
  ds_read_b64_tr_b16 v[22:23], v5 offset:12832
  ds_read_b64_tr_b16 v[24:25], v5 offset:14368
  ds_read_b64_tr_b16 v[26:27], v5 offset:14880
  s_waitcnt lgkmcnt(0)
  s_add_u32 m0, s40, 12288
  s_mov_b32 s39, 0x600000
  buffer_load_dwordx4 v4, s[16:19], s39 offen lds
  s_add_u32 m0, s40, 13312
  s_mov_b32 s39, 0x620000
  buffer_load_dwordx4 v4, s[16:19], s39 offen lds
  s_add_u32 m0, s40, 14336
  s_mov_b32 s39, 0x640000
  buffer_load_dwordx4 v4, s[16:19], s39 offen lds
  s_add_u32 m0, s40, 15360
  s_mov_b32 s39, 0x660000
  buffer_load_dwordx4 v4, s[16:19], s39 offen lds
  v_mov_b32 v80, v12
  v_mov_b32 v82, v13
  v_mov_b32 v81, v14
  v_mov_b32 v83, v15
  v_mov_b32 v84, v16
  v_mov_b32 v86, v17
  v_mov_b32 v85, v18
  v_mov_b32 v87, v19
  v_mov_b32 v88, v20
  v_mov_b32 v90, v21
  v_mov_b32 v89, v22
  v_mov_b32 v91, v23
  v_mov_b32 v92, v24
  v_mov_b32 v94, v25
  v_mov_b32 v93, v26
  v_mov_b32 v95, v27
  s_waitcnt vmcnt(12)
  ds_read_b64_tr_b16 v[12:13], v5 offset:0
  ds_read_b64_tr_b16 v[14:15], v5 offset:512
  ds_read_b64_tr_b16 v[16:17], v5 offset:2048
  ds_read_b64_tr_b16 v[18:19], v5 offset:2560
  ds_read_b64_tr_b16 v[20:21], v5 offset:32
  ds_read_b64_tr_b16 v[22:23], v5 offset:544
  ds_read_b64_tr_b16 v[24:25], v5 offset:2080
  ds_read_b64_tr_b16 v[26:27], v5 offset:2592
  s_waitcnt lgkmcnt(0)
  v_mov_b32 v112, v12
  v_mov_b32 v114, v13
  v_mov_b32 v113, v14
  v_mov_b32 v115, v15
  v_mov_b32 v116, v16
  v_mov_b32 v118, v17
  v_mov_b32 v117, v18
  v_mov_b32 v119, v19
  v_mov_b32 v120, v20
  v_mov_b32 v122, v21
  v_mov_b32 v121, v22
  v_mov_b32 v123, v23
  v_mov_b32 v124, v24
  v_mov_b32 v126, v25
  v_mov_b32 v125, v26
  v_mov_b32 v127, v27
  s_waitcnt vmcnt(8)
  ds_read_b64_tr_b16 v[12:13], v5 offset:4096
  ds_read_b64_tr_b16 v[14:15], v5 offset:4608
  ds_read_b64_tr_b16 v[16:17], v5 offset:6144
  ds_read_b64_tr_b16 v[18:19], v5 offset:6656
  ds_read_b64_tr_b16 v[20:21], v5 offset:4128
  ds_read_b64_tr_b16 v[22:23], v5 offset:4640
  ds_read_b64_tr_b16 v[24:25], v5 offset:6176
  ds_read_b64_tr_b16 v[26:27], v5 offset:6688
  s_waitcnt lgkmcnt(0)
  v_mov_b32 v128, v12
  v_mov_b32 v130, v13
  v_mov_b32 v129, v14
  v_mov_b32 v131, v15
  v_mov_b32 v132, v16
  v_mov_b32 v134, v17
  v_mov_b32 v133, v18
  v_mov_b32 v135, v19
  v_mov_b32 v136, v20
  v_mov_b32 v138, v21
  v_mov_b32 v137, v22
  v_mov_b32 v139, v23
  v_mov_b32 v140, v24
  v_mov_b32 v142, v25
  v_mov_b32 v141, v26
  v_mov_b32 v143, v27
  s_waitcnt vmcnt(4)
  ds_read_b64_tr_b16 v[12:13], v5 offset:8192
  ds_read_b64_tr_b16 v[14:15], v5 offset:8704
  ds_read_b64_tr_b16 v[16:17], v5 offset:10240
  ds_read_b64_tr_b16 v[18:19], v5 offset:10752
  ds_read_b64_tr_b16 v[20:21], v5 offset:8224
  ds_read_b64_tr_b16 v[22:23], v5 offset:8736
  ds_read_b64_tr_b16 v[24:25], v5 offset:10272
  ds_read_b64_tr_b16 v[26:27], v5 offset:10784
  s_waitcnt lgkmcnt(0)
  v_mov_b32 v160, v12
  v_mov_b32 v162, v13
  v_mov_b32 v161, v14
  v_mov_b32 v163, v15
  v_mov_b32 v164, v16
  v_mov_b32 v166, v17
  v_mov_b32 v165, v18
  v_mov_b32 v167, v19
  v_mov_b32 v168, v20
  v_mov_b32 v170, v21
  v_mov_b32 v169, v22
  v_mov_b32 v171, v23
  v_mov_b32 v172, v24
  v_mov_b32 v174, v25
  v_mov_b32 v173, v26
  v_mov_b32 v175, v27
  s_waitcnt vmcnt(0)
  ds_read_b64_tr_b16 v[12:13], v5 offset:12288
  ds_read_b64_tr_b16 v[14:15], v5 offset:12800
  ds_read_b64_tr_b16 v[16:17], v5 offset:14336
  ds_read_b64_tr_b16 v[18:19], v5 offset:14848
  ds_read_b64_tr_b16 v[20:21], v5 offset:12320
  ds_read_b64_tr_b16 v[22:23], v5 offset:12832
  ds_read_b64_tr_b16 v[24:25], v5 offset:14368
  ds_read_b64_tr_b16 v[26:27], v5 offset:14880
  s_waitcnt lgkmcnt(0)
  v_mov_b32 v176, v12
  v_mov_b32 v178, v13
  v_mov_b32 v177, v14
  v_mov_b32 v179, v15
  v_mov_b32 v180, v16
  v_mov_b32 v182, v17
  v_mov_b32 v181, v18
  v_mov_b32 v183, v19
  v_mov_b32 v184, v20
  v_mov_b32 v186, v21
  v_mov_b32 v185, v22
  v_mov_b32 v187, v23
  v_mov_b32 v188, v24
  v_mov_b32 v190, v25
  v_mov_b32 v189, v26
  v_mov_b32 v191, v27
  v_and_b32 v4, 8, v1
  v_cmp_eq_u32 vcc, 0, v4
  v_mov_b32 v4, 0xeeee
  v_mov_b32 v6, 0x4444
  v_cndmask_b32 v4, v4, v6, vcc
  s_mov_b32 s8, s52
  s_mov_b32 s9, s53
  s_mov_b32 s10, 0x4000
  s_mov_b32 s11, 0x20000
  v_and_b32 v6, 7, v1
  v_lshlrev_b32 v6, 11, v6
  v_lshrrev_b32 v9, 3, v1
  v_lshl_add_u32 v6, v9, 4, v6
  s_lshl_b32 s39, s28, 7
  v_add_u32 v6, s39, v6
  buffer_load_dwordx4 v[12:15], v6, s[8:11], 0 offen offset:0
  buffer_load_dwordx4 v[16:19], v6, s[8:11], 0 offen offset:512
  buffer_load_dwordx4 v[20:23], v6, s[8:11], 0 offen offset:1024
  buffer_load_dwordx4 v[24:27], v6, s[8:11], 0 offen offset:1536
  s_lshl_b32 s39, s28, 10
  v_lshl_add_u32 v5, v1, 4, s39
  v_and_b32 v6, 1, v3
  v_mul_u32_u24 v7, 1088, v6
  v_lshrrev_b32 v6, 5, v1
  v_lshl_add_u32 v6, v6, 4, v2
  v_lshl_add_u32 v7, v6, 2, v7
  s_mul_i32 s39, s28, 2176
  v_add_u32 v7, s39, v7
  s_lshl_b32 s39, s28, 10
  s_add_u32 s39, s39, 8704
  v_lshl_add_u32 v2, v1, 4, s39
  v_mov_b32 v28, 0
  v_mov_b32 v29, 0
  v_mov_b32 v30, 0
  v_mov_b32 v31, 0
  v_mov_b32 v32, 0
  v_mov_b32 v33, 0
  v_mov_b32 v34, 0
  v_mov_b32 v35, 0
  v_mov_b32 v36, 0
  v_mov_b32 v37, 0
  v_mov_b32 v38, 0
  v_mov_b32 v39, 0
  v_mov_b32 v40, 0
  v_mov_b32 v41, 0
  v_mov_b32 v42, 0
  v_mov_b32 v43, 0
  v_mov_b32 v44, 0
  v_mov_b32 v45, 0
  v_mov_b32 v46, 0
  v_mov_b32 v47, 0
  v_mov_b32 v48, 0
  v_mov_b32 v49, 0
  v_mov_b32 v50, 0
  v_mov_b32 v51, 0
  s_barrier
  s_barrier
  s_waitcnt vmcnt(0)
  v_smfmac_f32_16x16x64_bf16 v[28:31], v[12:15], a[0:7], v4
  v_smfmac_f32_16x16x64_bf16 v[32:35], v[12:15], a[8:15], v4
  s_barrier
  v_smfmac_f32_16x16x64_bf16 v[28:31], v[16:19], a[48:55], v4
  v_smfmac_f32_16x16x64_bf16 v[32:35], v[16:19], a[56:63], v4
  v_smfmac_f32_16x16x64_bf16 v[28:31], v[20:23], v[96:103], v4
  v_smfmac_f32_16x16x64_bf16 v[32:35], v[20:23], v[104:111], v4
  v_smfmac_f32_16x16x64_bf16 v[28:31], v[24:27], v[144:151], v4
  v_smfmac_f32_16x16x64_bf16 v[32:35], v[24:27], v[152:159], v4
  v_smfmac_f32_16x16x64_bf16 v[36:39], v[12:15], a[16:23], v4
  v_smfmac_f32_16x16x64_bf16 v[40:43], v[12:15], a[24:31], v4
  v_smfmac_f32_16x16x64_bf16 v[36:39], v[16:19], v[64:71], v4
  v_smfmac_f32_16x16x64_bf16 v[40:43], v[16:19], v[72:79], v4
  v_permlane32_swap_b32 v28, v32
  v_permlane32_swap_b32 v29, v33
  v_smfmac_f32_16x16x64_bf16 v[36:39], v[20:23], v[112:119], v4
  v_permlane32_swap_b32 v30, v34
  v_permlane32_swap_b32 v31, v35
  v_smfmac_f32_16x16x64_bf16 v[40:43], v[20:23], v[120:127], v4
  v_pk_add_f32 v[28:29], v[28:29], v[32:33]
  v_pk_add_f32 v[30:31], v[30:31], v[34:35]
  v_smfmac_f32_16x16x64_bf16 v[36:39], v[24:27], v[160:167], v4
  ds_write2_b32 v7, v28, v29 offset0:0 offset1:68
  ds_write2_b32 v7, v30, v31 offset0:136 offset1:204
  v_smfmac_f32_16x16x64_bf16 v[40:43], v[24:27], v[168:175], v4
  v_smfmac_f32_16x16x64_bf16 v[44:47], v[12:15], a[32:39], v4
  v_smfmac_f32_16x16x64_bf16 v[48:51], v[12:15], a[40:47], v4
  v_smfmac_f32_16x16x64_bf16 v[44:47], v[16:19], v[80:87], v4
  v_permlane32_swap_b32 v36, v40
  v_permlane32_swap_b32 v37, v41
  v_permlane32_swap_b32 v38, v42
  v_permlane32_swap_b32 v39, v43
  v_pk_add_f32 v[36:37], v[36:37], v[40:41]
  v_pk_add_f32 v[38:39], v[38:39], v[42:43]
  ds_write2_b32 v7, v36, v37 offset0:32 offset1:100
  ds_write2_b32 v7, v38, v39 offset0:168 offset1:236
  s_waitcnt lgkmcnt(0)
  s_barrier
  v_smfmac_f32_16x16x64_bf16 v[48:51], v[16:19], v[88:95], v4
  v_smfmac_f32_16x16x64_bf16 v[44:47], v[20:23], v[128:135], v4
  v_smfmac_f32_16x16x64_bf16 v[48:51], v[20:23], v[136:143], v4
  v_smfmac_f32_16x16x64_bf16 v[44:47], v[24:27], v[176:183], v4
  v_smfmac_f32_16x16x64_bf16 v[48:51], v[24:27], v[184:191], v4
  s_branch L_s1rest_195
L_s1loop_194:
  s_barrier
  v_mov_b32 v28, 0
  v_mov_b32 v29, 0
  v_mov_b32 v30, 0
  v_mov_b32 v31, 0
  v_mov_b32 v32, 0
  v_mov_b32 v33, 0
  v_mov_b32 v34, 0
  v_mov_b32 v35, 0
  v_mov_b32 v36, 0
  v_mov_b32 v37, 0
  v_mov_b32 v38, 0
  v_mov_b32 v39, 0
  v_mov_b32 v40, 0
  v_mov_b32 v41, 0
  v_mov_b32 v42, 0
  v_mov_b32 v43, 0
  v_mov_b32 v44, 0
  v_mov_b32 v45, 0
  v_mov_b32 v46, 0
  v_mov_b32 v47, 0
  v_mov_b32 v48, 0
  v_mov_b32 v49, 0
  v_mov_b32 v50, 0
  v_mov_b32 v51, 0
  buffer_load_dwordx4 v[12:15], v5, s[4:7], s64 offen sc1
  buffer_load_dwordx4 v[16:19], v5, s[4:7], s65 offen sc1
  buffer_load_dwordx4 v[20:23], v5, s[4:7], s66 offen sc1
  buffer_load_dwordx4 v[24:27], v5, s[4:7], s67 offen sc1
L_b2wait_196:
  s_waitcnt vmcnt(0)
  v_max3_u32 v3, v15, v19, v23
  v_max_u32 v3, v3, v27
  v_cmp_eq_u32 vcc, -1, v3
  s_cbranch_vccnz L_b2retry_197
  v_smfmac_f32_16x16x64_bf16 v[28:31], v[12:15], a[0:7], v4
  v_smfmac_f32_16x16x64_bf16 v[32:35], v[12:15], a[8:15], v4
  s_barrier
  v_smfmac_f32_16x16x64_bf16 v[28:31], v[16:19], a[48:55], v4
  v_smfmac_f32_16x16x64_bf16 v[32:35], v[16:19], a[56:63], v4
  v_smfmac_f32_16x16x64_bf16 v[28:31], v[20:23], v[96:103], v4
  v_smfmac_f32_16x16x64_bf16 v[32:35], v[20:23], v[104:111], v4
  v_smfmac_f32_16x16x64_bf16 v[28:31], v[24:27], v[144:151], v4
  v_smfmac_f32_16x16x64_bf16 v[32:35], v[24:27], v[152:159], v4
  v_smfmac_f32_16x16x64_bf16 v[36:39], v[12:15], a[16:23], v4
  v_smfmac_f32_16x16x64_bf16 v[40:43], v[12:15], a[24:31], v4
  v_smfmac_f32_16x16x64_bf16 v[36:39], v[16:19], v[64:71], v4
  v_smfmac_f32_16x16x64_bf16 v[40:43], v[16:19], v[72:79], v4
  v_permlane32_swap_b32 v28, v32
  v_permlane32_swap_b32 v29, v33
  v_smfmac_f32_16x16x64_bf16 v[36:39], v[20:23], v[112:119], v4
  v_permlane32_swap_b32 v30, v34
  v_permlane32_swap_b32 v31, v35
  v_smfmac_f32_16x16x64_bf16 v[40:43], v[20:23], v[120:127], v4
  v_pk_add_f32 v[28:29], v[28:29], v[32:33]
  v_pk_add_f32 v[30:31], v[30:31], v[34:35]
  v_smfmac_f32_16x16x64_bf16 v[36:39], v[24:27], v[160:167], v4
  ds_write2_b32 v7, v28, v29 offset0:0 offset1:68
  ds_write2_b32 v7, v30, v31 offset0:136 offset1:204
  v_smfmac_f32_16x16x64_bf16 v[40:43], v[24:27], v[168:175], v4
  v_smfmac_f32_16x16x64_bf16 v[44:47], v[12:15], a[32:39], v4
  v_smfmac_f32_16x16x64_bf16 v[48:51], v[12:15], a[40:47], v4
  v_smfmac_f32_16x16x64_bf16 v[44:47], v[16:19], v[80:87], v4
  v_permlane32_swap_b32 v36, v40
  v_permlane32_swap_b32 v37, v41
  v_permlane32_swap_b32 v38, v42
  v_permlane32_swap_b32 v39, v43
  v_pk_add_f32 v[36:37], v[36:37], v[40:41]
  v_pk_add_f32 v[38:39], v[38:39], v[42:43]
  ds_write2_b32 v7, v36, v37 offset0:32 offset1:100
  ds_write2_b32 v7, v38, v39 offset0:168 offset1:236
  s_waitcnt lgkmcnt(0)
  s_barrier
  v_smfmac_f32_16x16x64_bf16 v[48:51], v[16:19], v[88:95], v4
  v_smfmac_f32_16x16x64_bf16 v[44:47], v[20:23], v[128:135], v4
  v_smfmac_f32_16x16x64_bf16 v[48:51], v[20:23], v[136:143], v4
  v_smfmac_f32_16x16x64_bf16 v[44:47], v[24:27], v[176:183], v4
  v_smfmac_f32_16x16x64_bf16 v[48:51], v[24:27], v[184:191], v4
L_s1rest_195:
  s_nop 7
  v_permlane32_swap_b32 v44, v48
  v_permlane32_swap_b32 v45, v49
  v_permlane32_swap_b32 v46, v50
  v_permlane32_swap_b32 v47, v51
  v_pk_add_f32 v[44:45], v[44:45], v[48:49]
  v_pk_add_f32 v[46:47], v[46:47], v[50:51]
  ds_write_b128 v2, v[44:47]
  s_waitcnt lgkmcnt(0)
  s_barrier
  s_cmp_eq_u32 s29, 63
  s_cbranch_scc1 L_rec_done_s
  s_add_u32 s29, s29, 1
  s_add_u32 s39, s29, 0
  s_and_b32 s39, s39, 3
  s_mul_i32 s39, s39, 0x4000
  s_mul_i32 s64, s24, 0x10000
  s_add_u32 s64, s64, s39
  s_add_u32 s64, s64, 0x9d40000
  s_add_u32 s65, s64, 4096
  s_add_u32 s66, s64, 8192
  s_add_u32 s67, s64, 12288
  s_barrier
  s_barrier
  s_branch L_s1loop_194
L_b2retry_197:
  buffer_load_dwordx4 v[12:15], v5, s[4:7], s64 offen sc1
  buffer_load_dwordx4 v[16:19], v5, s[4:7], s65 offen sc1
  buffer_load_dwordx4 v[20:23], v5, s[4:7], s66 offen sc1
  buffer_load_dwordx4 v[24:27], v5, s[4:7], s67 offen sc1
  s_add_u32 s31, s31, 1
  s_cmp_lt_u32 s31, 1048576
  s_cbranch_scc1 L_b2wait_196
  s_branch L_abort
L_w4_189:
  v_and_b32 v6, 7, v2
  v_mul_u32_u24 v36, 272, v6
  v_lshrrev_b32 v6, 3, v2
  v_lshl_add_u32 v36, v6, 7, v36
  v_lshl_add_u32 v36, v3, 4, v36
  s_lshl_b32 s39, s25, 11
  v_lshl_add_u32 v37, v1, 4, s39
  s_xor_b32 s40, s25, 1
  s_lshl_b32 s40, s40, 11
  v_lshl_add_u32 v39, v1, 4, s40
  s_xor_b32 s40, s25, 2
  s_lshl_b32 s40, s40, 11
  v_lshl_add_u32 v40, v1, 4, s40
  s_xor_b32 s40, s25, 3
  s_lshl_b32 s40, s40, 11
  v_lshl_add_u32 v41, v1, 4, s40
  v_and_b32 v6, 1, v3
  v_lshlrev_b32 v6, 3, v6
  v_add_u32 v6, v6, v2
  s_add_u32 s40, s39, 1024
  v_lshl_add_u32 v38, v6, 4, s40
  v_and_b32 v6, 0x28, v1
  v_cmp_eq_u32 vcc, 0x20, v6
  v_mov_b32 v6, 0x80000000
  s_nop 0
  v_cndmask_b32 v38, v6, v38, vcc
  v_lshlrev_b32 v6, 4, v2
  v_lshl_add_u32 v6, v3, 2, v6
  v_add_u32 v42, 1024, v6
  v_add_u32 v43, 8704, v6
  v_lshlrev_b32 v6, 7, v3
  v_lshl_add_u32 v6, v2, 4, v6
  s_lshl_b32 s39, s25, 9
  v_add_u32 v44, s39, v6
  v_cmp_gt_u32 vcc, 8, v2
  v_mov_b32 v6, 0x80000000
  s_nop 0
  v_cndmask_b32 v44, v6, v44, vcc
  v_lshlrev_b32 v45, 4, v1
  v_mov_b32 v132, 0x3f803f80
  v_mov_b32 v133, 0x3f803f80
  v_mov_b32 v134, 0x3f803f80
  v_mov_b32 v135, 0x3f803f80
  v_mov_b32 v129, 0
  v_mov_b32 v131, 0
  v_mov_b32 v141, 0
  s_mov_b32 s46, 0x3e0293ee
  v_mov_b32 v46, 0x439cd7d4
  s_xor_b32 s48, s25, 0
  s_lshl_b32 s48, s48, 11
  s_xor_b32 s49, s25, 1
  s_lshl_b32 s49, s49, 11
  s_xor_b32 s50, s25, 2
  s_lshl_b32 s50, s50, 11
  s_xor_b32 s51, s25, 3
  s_lshl_b32 s51, s51, 11
  s_barrier
  s_barrier
L_w4loop_198:
  s_and_b32 s39, s29, 1
  s_lshl_b32 s39, s39, 12
  v_add_u32 v6, s39, v45
  ds_read_b128 v[48:51], v6 offset:18432
  ds_read_b128 v[52:55], v6 offset:19456
  ds_read_b128 v[56:59], v6 offset:20480
  ds_read_b128 v[60:63], v6 offset:21504
  s_add_u32 s39, s29, 0
  s_and_b32 s39, s39, 3
  s_mul_i32 s39, s39, 0x10000
  s_mul_i32 s34, s24, 0x40000
  s_add_u32 s34, s34, s39
  s_add_u32 s34, s34, 0x9e00000
  s_add_u32 s39, s29, 0
  s_and_b32 s39, s39, 3
  s_mul_i32 s39, s39, 0x4000
  s_mul_i32 s32, s24, 0x10000
  s_add_u32 s32, s32, s39
  s_add_u32 s32, s32, 0x9d00000
  s_add_u32 s64, s48, s34
  s_add_u32 s65, s49, s34
  s_add_u32 s66, s50, s34
  s_add_u32 s67, s51, s34
  s_waitcnt lgkmcnt(0)
  s_barrier
  s_cmp_eq_u32 s29, 63
  s_cbranch_scc1 L_rec_done_y2_s_y
  s_barrier
  ds_read_b128 v[64:67], v36 offset:0
  ds_read_b128 v[68:71], v36 offset:64
  ds_read_b128 v[72:75], v36 offset:2176
  ds_read_b128 v[76:79], v36 offset:2240
  ds_read_b128 v[80:83], v36 offset:4352
  ds_read_b128 v[84:87], v36 offset:4416
  ds_read_b128 v[88:91], v36 offset:6528
  ds_read_b128 v[92:95], v36 offset:6592
  s_waitcnt lgkmcnt(4)
  v_pk_add_f32 v[64:65], v[64:65], v[72:73]
  v_pk_add_f32 v[66:67], v[66:67], v[74:75]
  v_pk_add_f32 v[68:69], v[68:69], v[76:77]
  v_pk_add_f32 v[70:71], v[70:71], v[78:79]
  s_waitcnt lgkmcnt(2)
  v_pk_add_f32 v[64:65], v[64:65], v[80:81]
  v_pk_add_f32 v[66:67], v[66:67], v[82:83]
  v_pk_add_f32 v[68:69], v[68:69], v[84:85]
  v_pk_add_f32 v[70:71], v[70:71], v[86:87]
  s_waitcnt lgkmcnt(0)
  v_pk_add_f32 v[64:65], v[64:65], v[88:89]
  v_pk_add_f32 v[66:67], v[66:67], v[90:91]
  v_pk_add_f32 v[68:69], v[68:69], v[92:93]
  v_pk_add_f32 v[70:71], v[70:71], v[94:95]
  v_cvt_pk_bf16_f32 v96, v64, v65
  v_cvt_pk_bf16_f32 v97, v66, v67
  v_cvt_pk_bf16_f32 v98, v68, v69
  v_cvt_pk_bf16_f32 v99, v70, v71
  s_nop 1
  v_mfma_f32_16x16x32_bf16 v[104:107], v[52:55], v[96:99], 0
  v_mfma_f32_16x16x32_bf16 v[100:103], v[48:51], v[96:99], 0
  v_mfma_f32_16x16x32_bf16 v[108:111], v[96:99], v[96:99], 0
  s_nop 6
  v_mov_b32_dpp v100, v104 row_shr:8 row_mask:0xf bank_mask:0xc
  v_mov_b32_dpp v101, v105 row_shr:8 row_mask:0xf bank_mask:0xc
  v_mov_b32_dpp v102, v106 row_shr:8 row_mask:0xf bank_mask:0xc
  v_mov_b32_dpp v103, v107 row_shr:8 row_mask:0xf bank_mask:0xc
  buffer_store_dwordx4 v[100:103], v37, s[4:7], s34 offen sc1
  buffer_store_dwordx4 v[108:111], v38, s[4:7], s34 offen sc1
  s_barrier
  buffer_load_dwordx4 v[112:115], v39, s[4:7], s34 offen sc1
  buffer_load_dwordx4 v[116:119], v40, s[4:7], s34 offen sc1
  buffer_load_dwordx4 v[120:123], v41, s[4:7], s34 offen sc1
  buffer_load_dword v124, v42, s[4:7], s64 offen sc1
  buffer_load_dword v125, v42, s[4:7], s65 offen sc1
  buffer_load_dword v126, v42, s[4:7], s66 offen sc1
  buffer_load_dword v127, v42, s[4:7], s67 offen sc1
  ds_read2st64_b32 v[64:65], v43 offset0:0 offset1:1
  ds_read2st64_b32 v[66:67], v43 offset0:2 offset1:3
  ds_read2st64_b32 v[68:69], v43 offset0:4 offset1:5
  ds_read2st64_b32 v[70:71], v43 offset0:6 offset1:7
  ds_read2st64_b32 v[72:73], v43 offset0:8 offset1:9
  ds_read2st64_b32 v[74:75], v43 offset0:10 offset1:11
  ds_read2st64_b32 v[76:77], v43 offset0:12 offset1:13
  ds_read2st64_b32 v[78:79], v43 offset0:14 offset1:15
  s_waitcnt lgkmcnt(0)
  v_pk_add_f32 v[64:65], v[64:65], v[68:69]
  v_pk_add_f32 v[66:67], v[66:67], v[70:71]
  v_pk_add_f32 v[72:73], v[72:73], v[76:77]
  v_pk_add_f32 v[74:75], v[74:75], v[78:79]
  v_pk_add_f32 v[64:65], v[64:65], v[72:73]
  v_pk_add_f32 v[66:67], v[66:67], v[74:75]
  v_cvt_pk_bf16_f32 v128, v64, v65
  v_cvt_pk_bf16_f32 v130, v66, v67
  buffer_load_dwordx4 v[160:163], v39, s[4:7], s34 offen sc1
  buffer_load_dwordx4 v[164:167], v40, s[4:7], s34 offen sc1
  buffer_load_dwordx4 v[168:171], v41, s[4:7], s34 offen sc1
  buffer_load_dword v172, v42, s[4:7], s64 offen sc1
  buffer_load_dword v173, v42, s[4:7], s65 offen sc1
  buffer_load_dword v174, v42, s[4:7], s66 offen sc1
  buffer_load_dword v175, v42, s[4:7], s67 offen sc1
L_cwa_199:
  s_waitcnt vmcnt(7)
  v_max3_u32 v9, v115, v119, v123
  v_max3_u32 v9, v9, v124, v125
  v_max3_u32 v9, v9, v126, v127
  v_cmp_eq_u32 vcc, -1, v9
  s_cbranch_vccnz L_cra_200
  v_pk_add_f32 v[116:117], v[116:117], v[120:121]
  v_pk_add_f32 v[118:119], v[118:119], v[122:123]
  v_pk_add_f32 v[100:101], v[100:101], v[112:113]
  v_pk_add_f32 v[102:103], v[102:103], v[114:115]
  v_pk_add_f32 v[124:125], v[124:125], v[126:127]
  v_pk_add_f32 v[100:101], v[100:101], v[116:117]
  v_pk_add_f32 v[102:103], v[102:103], v[118:119]
  v_add_f32 v159, v124, v125
L_cdone_201:
  v_max3_f32 v156, abs(v100), abs(v101), abs(v102)
  v_max3_f32 v156, v156, abs(v103), abs(v159)
  v_cmp_nlt_f32 vcc, v156, v46
  s_cbranch_vccnz L_smax_202
  v_mul_f32 v159, s46, v159
  v_mul_f32 v100, s46, v100
  v_mul_f32 v101, s46, v101
  v_mul_f32 v102, s46, v102
  v_mul_f32 v103, s46, v103
L_smaxb_203:
  v_exp_f32 v159, v159
  v_exp_f32 v100, v100
  v_exp_f32 v101, v101
  v_exp_f32 v102, v102
  v_exp_f32 v103, v103
  v_mov_b32_dpp v157, v159 row_shl:8 row_mask:0xf bank_mask:0xf
  v_cvt_pk_bf16_f32 v136, v100, v101
  v_cvt_pk_bf16_f32 v137, v102, v103
  v_cvt_pk_bf16_f32 v140, v159, v157
  v_mov_b32_dpp v138, v136 row_shl:8 row_mask:0xf bank_mask:0xf
  v_mov_b32_dpp v139, v137 row_shl:8 row_mask:0xf bank_mask:0xf
  v_mfma_f32_16x16x16_bf16 v[152:155], v[132:133], v[140:141], 0
  v_mfma_f32_16x16x16_bf16 v[144:147], v[128:129], v[140:141], 0
  v_mfma_f32_16x16x16_bf16 v[148:151], v[130:131], v[140:141], 0
  v_mfma_f32_16x16x32_bf16 v[152:155], v[132:135], v[136:139], v[152:155]
  v_mfma_f32_16x16x32_bf16 v[144:147], v[56:59], v[136:139], v[144:147]
  v_mfma_f32_16x16x32_bf16 v[148:151], v[60:63], v[136:139], v[148:151]
  s_nop 5
  v_rcp_f32 v156, v152
  s_nop 0
  v_pk_mul_f32 v[144:145], v[144:145], v[156:157] op_sel_hi:[1,0]
  v_pk_mul_f32 v[146:147], v[146:147], v[156:157] op_sel_hi:[1,0]
  v_pk_mul_f32 v[148:149], v[148:149], v[156:157] op_sel_hi:[1,0]
  v_pk_mul_f32 v[150:151], v[150:151], v[156:157] op_sel_hi:[1,0]
  v_cvt_pk_bf16_f32 v96, v144, v145
  v_cvt_pk_bf16_f32 v97, v146, v147
  v_cvt_pk_bf16_f32 v98, v148, v149
  v_cvt_pk_bf16_f32 v99, v150, v151
  buffer_store_dwordx4 v[96:99], v44, s[4:7], s32 offen sc1
  s_barrier
  v_mov_b32 v28, 0
  v_mov_b32 v29, 0
  v_mov_b32 v30, 0
  v_mov_b32 v31, 0
  v_mov_b32 v32, 0
  v_mov_b32 v33, 0
  v_mov_b32 v34, 0
  v_mov_b32 v35, 0
  buffer_load_dwordx4 v[12:15], v5, s[4:7], s32 offen offset:0 sc1
  buffer_load_dwordx4 v[16:19], v5, s[4:7], s32 offen offset:1024 sc1
  buffer_load_dwordx4 v[20:23], v5, s[4:7], s32 offen offset:2048 sc1
  buffer_load_dwordx4 v[24:27], v5, s[4:7], s32 offen offset:3072 sc1
L_await_204:
  s_waitcnt vmcnt(0)
  v_max3_u32 v9, v15, v19, v23
  v_max_u32 v9, v9, v27
  v_cmp_eq_u32 vcc, -1, v9
  s_cbranch_vccnz L_aretry_205
  v_smfmac_f32_16x16x64_bf16 v[28:31], v[12:15], a[0:7], v4
  v_smfmac_f32_16x16x64_bf16 v[32:35], v[12:15], a[8:15], v4
  v_smfmac_f32_16x16x64_bf16 v[28:31], v[16:19], a[16:23], v4
  v_smfmac_f32_16x16x64_bf16 v[32:35], v[16:19], a[24:31], v4
  v_smfmac_f32_16x16x64_bf16 v[28:31], v[20:23], a[32:39], v4
  v_smfmac_f32_16x16x64_bf16 v[32:35], v[20:23], a[40:47], v4
  v_smfmac_f32_16x16x64_bf16 v[28:31], v[24:27], a[48:55], v4
  v_smfmac_f32_16x16x64_bf16 v[32:35], v[24:27], a[56:63], v4
  s_nop 7
  v_permlane32_swap_b32 v28, v32
  v_permlane32_swap_b32 v29, v33
  v_permlane32_swap_b32 v30, v34
  v_permlane32_swap_b32 v31, v35
  v_pk_add_f32 v[28:29], v[28:29], v[32:33]
  v_pk_add_f32 v[30:31], v[30:31], v[34:35]
  ds_write2_b32 v7, v28, v29 offset0:0 offset1:36
  ds_write2_b32 v7, v30, v31 offset0:72 offset1:108
  s_waitcnt lgkmcnt(0)
  s_barrier
  s_add_u32 s29, s29, 1
  s_barrier
  s_branch L_w4loop_198
L_cra_200:
  buffer_load_dwordx4 v[112:115], v39, s[4:7], s34 offen sc1
  buffer_load_dwordx4 v[116:119], v40, s[4:7], s34 offen sc1
  buffer_load_dwordx4 v[120:123], v41, s[4:7], s34 offen sc1
  buffer_load_dword v124, v42, s[4:7], s64 offen sc1
  buffer_load_dword v125, v42, s[4:7], s65 offen sc1
  buffer_load_dword v126, v42, s[4:7], s66 offen sc1
  buffer_load_dword v127, v42, s[4:7], s67 offen sc1
  s_waitcnt vmcnt(7)
  v_max3_u32 v9, v163, v167, v171
  v_max3_u32 v9, v9, v172, v173
  v_max3_u32 v9, v9, v174, v175
  v_cmp_eq_u32 vcc, -1, v9
  s_cbranch_vccz L_cub_206
  buffer_load_dwordx4 v[160:163], v39, s[4:7], s34 offen sc1
  buffer_load_dwordx4 v[164:167], v40, s[4:7], s34 offen sc1
  buffer_load_dwordx4 v[168:171], v41, s[4:7], s34 offen sc1
  buffer_load_dword v172, v42, s[4:7], s64 offen sc1
  buffer_load_dword v173, v42, s[4:7], s65 offen sc1
  buffer_load_dword v174, v42, s[4:7], s66 offen sc1
  buffer_load_dword v175, v42, s[4:7], s67 offen sc1
  s_add_u32 s31, s31, 1
  s_cmp_lt_u32 s31, 1048576
  s_cbranch_scc1 L_cwa_199
  s_branch L_abort
L_cub_206:
  v_pk_add_f32 v[164:165], v[164:165], v[168:169]
  v_pk_add_f32 v[166:167], v[166:167], v[170:171]
  v_pk_add_f32 v[100:101], v[100:101], v[160:161]
  v_pk_add_f32 v[102:103], v[102:103], v[162:163]
  v_pk_add_f32 v[172:173], v[172:173], v[174:175]
  v_pk_add_f32 v[100:101], v[100:101], v[164:165]
  v_pk_add_f32 v[102:103], v[102:103], v[166:167]
  v_add_f32 v159, v172, v173
  s_branch L_cdone_201
L_smax_202:
  v_max3_f32 v156, v100, v101, v102
  v_max3_f32 v156, v156, v103, v159
  s_nop 1
  v_max_f32_dpp v157, v156, v156 row_ror:8 row_mask:0xf bank_mask:0xf
  v_max_f32_dpp v156, v156, v156 row_ror:8 row_mask:0xf bank_mask:0xf
  s_nop 1
  v_permlane16_swap_b32 v156, v157
  v_max_f32 v158, v156, v157
  v_max_f32 v157, v156, v157
  s_nop 1
  v_permlane32_swap_b32 v158, v157
  v_max_f32 v156, v158, v157
  v_mul_f32 v156, s46, v156
  v_fma_f32 v159, v159, s46, -v156
  v_fma_f32 v100, v100, s46, -v156
  v_fma_f32 v101, v101, s46, -v156
  v_fma_f32 v102, v102, s46, -v156
  v_fma_f32 v103, v103, s46, -v156
  s_branch L_smaxb_203
L_aretry_205:
  buffer_load_dwordx4 v[12:15], v5, s[4:7], s32 offen offset:0 sc1
  buffer_load_dwordx4 v[16:19], v5, s[4:7], s32 offen offset:1024 sc1
  buffer_load_dwordx4 v[20:23], v5, s[4:7], s32 offen offset:2048 sc1
  buffer_load_dwordx4 v[24:27], v5, s[4:7], s32 offen offset:3072 sc1
  s_add_u32 s31, s31, 1
  s_cmp_lt_u32 s31, 1048576
  s_cbranch_scc1 L_await_204
  s_branch L_abort
L_w5_190:
  s_lshl_b32 s40, s26, 12
  s_lshl_b32 s39, s27, 10
  s_add_u32 s40, s40, s39
  v_lshl_add_u32 v36, v1, 4, s40
  v_add_u32 v37, 131072, v36
  s_lshl_b32 s40, s40, 1
  s_add_u32 s40, s40, 0x1000000
  v_lshl_add_u32 v38, v1, 4, s40
  v_add_u32 v39, 1024, v38
  v_mov_b32 v45, 0
  v_mov_b32 v46, 0
  s_movk_i32 s42, 128
  v_and_b32 v6, 7, v1
  v_mul_u32_u24 v40, 272, v6
  v_add_u32 v40, 128, v40
  v_bfe_u32 v6, v1, 3, 2
  v_lshl_add_u32 v40, v6, 4, v40
  s_lshl_b32 s40, s26, 11
  s_lshl_b32 s39, s27, 9
  s_add_u32 s40, s40, s39
  s_add_u32 s39, s40, 0x5400000
  v_lshl_add_u32 v42, v1, 4, s39
  v_cmp_gt_u32 vcc, 32, v1
  v_mov_b32 v6, 0x80000000
  s_nop 0
  v_cndmask_b32 v42, v6, v42, vcc
  v_lshlrev_b32 v41, 4, v1
  v_add_u32 v41, 8704, v41
  s_add_u32 s39, s40, 0x5800000
  v_lshl_add_u32 v43, v1, 3, s39
  s_lshl_b32 s39, s24, 5
  s_add_u32 s39, s39, s25
  s_lshl_b32 s39, s39, 7
  s_add_u32 s39, s39, 0x9c10000
  v_mov_b32 v44, s39
  v_cmp_eq_u32 vcc, 0, v1
  v_mov_b32 v6, 0x80000000
  s_nop 0
  v_cndmask_b32 v44, v6, v44, vcc
  s_lshl_b32 s39, s24, 5
  s_add_u32 s39, s39, s25
  s_cmp_eq_u32 s39, 1
  s_mov_b32 s39, 0x80000000
  s_cselect_b32 s39, 0x9c17f00, s39
  v_mov_b32 v47, s39
  v_cmp_eq_u32 vcc, 0, v1
  v_mov_b32 v6, 0x80000000
  s_nop 0
  v_cndmask_b32 v47, v6, v47, vcc
  s_mov_b32 s40, 48
  v_mov_b32 v8, 0
  s_mov_b32 s41, 0x80
L_poll_208:
  buffer_load_dword v6, v8, s[20:23], s40 offen sc1
  s_waitcnt vmcnt(0)
  v_cmp_le_u32 vcc, s41, v6
  s_cbranch_vccnz L_pollok_209
  s_sleep 4
  s_add_u32 s31, s31, 1
  s_cmp_lt_u32 s31, 1048576
  s_cbranch_scc1 L_poll_208
  s_branch L_abort
L_pollok_209:
  s_mov_b32 s40, 0x9c14400
  v_mov_b32 v8, 0
  s_mov_b32 s41, 0x80
L_poll_210:
  buffer_load_dword v6, v8, s[4:7], s40 offen sc1
  s_waitcnt vmcnt(0)
  v_cmp_le_u32 vcc, s41, v6
  s_cbranch_vccnz L_pollok_211
  s_sleep 4
  s_add_u32 s31, s31, 1
  s_cmp_lt_u32 s31, 1048576
  s_cbranch_scc1 L_poll_210
  s_branch L_abort
L_pollok_211:
  s_add_u32 s39, s29, 0
  s_min_u32 s37, s39, 63
  s_lshl_b32 s37, s37, 18
  s_and_b32 s39, s39, 1
  s_lshl_b32 s39, s39, 12
  s_add_u32 m0, s39, 18432
  s_nop 0
  buffer_load_dwordx4 v36, s[4:7], s37 offen sc1 lds
  s_add_u32 m0, s39, 19456
  s_nop 0
  buffer_load_dwordx4 v37, s[4:7], s37 offen sc1 lds
  s_add_u32 m0, s39, 20480
  s_nop 0
  buffer_load_dwordx4 v38, s[4:7], s37 offen sc1 lds
  s_add_u32 m0, s39, 21504
  s_nop 0
  buffer_load_dwordx4 v39, s[4:7], s37 offen sc1 lds
  s_add_u32 s39, s29, 1
  s_min_u32 s37, s39, 63
  s_lshl_b32 s37, s37, 18
  s_and_b32 s39, s39, 1
  s_lshl_b32 s39, s39, 12
  s_add_u32 m0, s39, 18432
  s_nop 0
  buffer_load_dwordx4 v36, s[4:7], s37 offen sc1 lds
  s_add_u32 m0, s39, 19456
  s_nop 0
  buffer_load_dwordx4 v37, s[4:7], s37 offen sc1 lds
  s_add_u32 m0, s39, 20480
  s_nop 0
  buffer_load_dwordx4 v38, s[4:7], s37 offen sc1 lds
  s_add_u32 m0, s39, 21504
  s_nop 0
  buffer_load_dwordx4 v39, s[4:7], s37 offen sc1 lds
L_nokv_207:
  s_waitcnt vmcnt(0)
  s_barrier
  s_barrier
  s_barrier
  s_branch L_w5first_214
L_w5loop_212:
  s_barrier
  s_sub_u32 s39, s29, 1
  v_mov_b32 v6, s39
  buffer_store_dword v6, v47, s[4:7], 0 offen sc1
  buffer_store_dwordx4 v[96:99], v42, s[4:7], s38 offen sc1
  buffer_store_dwordx2 v[100:101], v43, s[4:7], s38 offen sc1
  s_add_u32 s40, s29, 1
  s_and_b32 s39, s40, 0x47
  s_cmp_lg_u32 s39, 0
  s_cbranch_scc1 L_kvok_215
  v_cmp_le_u32 vcc, s42, v45
  s_cbranch_vccnz L_kvok_215
  s_lshl_b32 s40, s40, 4
  s_add_u32 s40, s40, 0x9c14400
  v_mov_b32 v8, 0
  s_mov_b32 s41, 0x80
L_poll_217:
  buffer_load_dword v6, v8, s[4:7], s40 offen sc1
  s_waitcnt vmcnt(0)
  v_cmp_le_u32 vcc, s41, v6
  s_cbranch_vccnz L_pollok_218
  s_sleep 4
  s_add_u32 s31, s31, 1
  s_cmp_lt_u32 s31, 1048576
  s_cbranch_scc1 L_poll_217
  s_branch L_abort
L_pollok_218:
L_kvok_215:
  s_add_u32 s40, s29, 2
  s_and_b32 s39, s40, 0x47
  s_cmp_lg_u32 s39, 0
  s_cbranch_scc1 L_kvnf_216
  s_lshl_b32 s40, s40, 4
  s_add_u32 s40, s40, 0x9c14400
  buffer_load_dword v45, v46, s[4:7], s40 offen sc1
L_kvnf_216:
  s_add_u32 s39, s29, 1
  s_min_u32 s37, s39, 63
  s_lshl_b32 s37, s37, 18
  s_and_b32 s39, s39, 1
  s_lshl_b32 s39, s39, 12
  s_add_u32 m0, s39, 18432
  s_nop 0
  buffer_load_dwordx4 v36, s[4:7], s37 offen sc1 lds
  s_add_u32 m0, s39, 19456
  s_nop 0
  buffer_load_dwordx4 v37, s[4:7], s37 offen sc1 lds
  s_add_u32 m0, s39, 20480
  s_nop 0
  buffer_load_dwordx4 v38, s[4:7], s37 offen sc1 lds
  s_add_u32 m0, s39, 21504
  s_nop 0
  buffer_load_dwordx4 v39, s[4:7], s37 offen sc1 lds
L_w5first_214:
  s_add_u32 s39, s29, 0
  s_and_b32 s39, s39, 3
  s_mul_i32 s39, s39, 0x4000
  s_mul_i32 s32, s24, 0x10000
  s_add_u32 s32, s32, s39
  s_add_u32 s32, s32, 0x9d00000
  s_barrier
  s_barrier
  ds_read_b128 v[48:51], v40 offset:0
  ds_read_b128 v[52:55], v40 offset:64
  ds_read_b128 v[56:59], v40 offset:2176
  ds_read_b128 v[60:63], v40 offset:2240
  ds_read_b128 v[64:67], v40 offset:4352
  ds_read_b128 v[68:71], v40 offset:4416
  ds_read_b128 v[72:75], v40 offset:6528
  ds_read_b128 v[76:79], v40 offset:6592
  ds_read_b128 v[80:83], v41 offset:0
  ds_read_b128 v[84:87], v41 offset:1024
  ds_read_b128 v[88:91], v41 offset:2048
  ds_read_b128 v[92:95], v41 offset:3072
  s_lshl_b32 s38, s29, 16
  s_waitcnt lgkmcnt(0)
  v_pk_add_f32 v[48:49], v[48:49], v[56:57]
  v_pk_add_f32 v[50:51], v[50:51], v[58:59]
  v_pk_add_f32 v[52:53], v[52:53], v[60:61]
  v_pk_add_f32 v[54:55], v[54:55], v[62:63]
  v_pk_add_f32 v[48:49], v[48:49], v[64:65]
  v_pk_add_f32 v[50:51], v[50:51], v[66:67]
  v_pk_add_f32 v[52:53], v[52:53], v[68:69]
  v_pk_add_f32 v[54:55], v[54:55], v[70:71]
  v_pk_add_f32 v[48:49], v[48:49], v[72:73]
  v_pk_add_f32 v[50:51], v[50:51], v[74:75]
  v_pk_add_f32 v[52:53], v[52:53], v[76:77]
  v_pk_add_f32 v[54:55], v[54:55], v[78:79]
  v_cvt_pk_bf16_f32 v96, v48, v49
  v_cvt_pk_bf16_f32 v97, v50, v51
  v_cvt_pk_bf16_f32 v98, v52, v53
  v_cvt_pk_bf16_f32 v99, v54, v55
  v_pk_add_f32 v[80:81], v[80:81], v[84:85]
  v_pk_add_f32 v[82:83], v[82:83], v[86:87]
  v_pk_add_f32 v[80:81], v[80:81], v[88:89]
  v_pk_add_f32 v[82:83], v[82:83], v[90:91]
  v_pk_add_f32 v[80:81], v[80:81], v[92:93]
  v_pk_add_f32 v[82:83], v[82:83], v[94:95]
  v_cvt_pk_bf16_f32 v100, v80, v81
  v_cvt_pk_bf16_f32 v101, v82, v83
  s_cmp_eq_u32 s29, 63
  s_cbranch_scc1 L_w5last_213
  s_barrier
  v_mov_b32 v28, 0
  v_mov_b32 v29, 0
  v_mov_b32 v30, 0
  v_mov_b32 v31, 0
  v_mov_b32 v32, 0
  v_mov_b32 v33, 0
  v_mov_b32 v34, 0
  v_mov_b32 v35, 0
  buffer_load_dwordx4 v[12:15], v5, s[4:7], s32 offen offset:0 sc1
  buffer_load_dwordx4 v[16:19], v5, s[4:7], s32 offen offset:1024 sc1
  buffer_load_dwordx4 v[20:23], v5, s[4:7], s32 offen offset:2048 sc1
  buffer_load_dwordx4 v[24:27], v5, s[4:7], s32 offen offset:3072 sc1
L_await_219:
  s_waitcnt vmcnt(0)
  v_max3_u32 v9, v15, v19, v23
  v_max_u32 v9, v9, v27
  v_cmp_eq_u32 vcc, -1, v9
  s_cbranch_vccnz L_aretry_220
  v_smfmac_f32_16x16x64_bf16 v[28:31], v[12:15], a[0:7], v4
  v_smfmac_f32_16x16x64_bf16 v[32:35], v[12:15], a[8:15], v4
  v_smfmac_f32_16x16x64_bf16 v[28:31], v[16:19], a[16:23], v4
  v_smfmac_f32_16x16x64_bf16 v[32:35], v[16:19], a[24:31], v4
  v_smfmac_f32_16x16x64_bf16 v[28:31], v[20:23], a[32:39], v4
  v_smfmac_f32_16x16x64_bf16 v[32:35], v[20:23], a[40:47], v4
  v_smfmac_f32_16x16x64_bf16 v[28:31], v[24:27], a[48:55], v4
  v_smfmac_f32_16x16x64_bf16 v[32:35], v[24:27], a[56:63], v4
  s_nop 7
  v_permlane32_swap_b32 v28, v32
  v_permlane32_swap_b32 v29, v33
  v_permlane32_swap_b32 v30, v34
  v_permlane32_swap_b32 v31, v35
  v_pk_add_f32 v[28:29], v[28:29], v[32:33]
  v_pk_add_f32 v[30:31], v[30:31], v[34:35]
  ds_write2_b32 v7, v28, v29 offset0:0 offset1:36
  ds_write2_b32 v7, v30, v31 offset0:72 offset1:108
  s_waitcnt lgkmcnt(0)
  s_barrier
  s_add_u32 s29, s29, 1
  s_barrier
  s_branch L_w5loop_212
L_w5last_213:
  buffer_store_dwordx4 v[96:99], v42, s[4:7], s38 offen sc1
  buffer_store_dwordx2 v[100:101], v43, s[4:7], s38 offen sc1
  s_waitcnt vmcnt(0)
  v_mov_b32 v6, 64
  buffer_store_dword v6, v44, s[4:7], 0 offen sc1
  s_branch L_rec_done_s
L_aretry_220:
  buffer_load_dwordx4 v[12:15], v5, s[4:7], s32 offen offset:0 sc1
  buffer_load_dwordx4 v[16:19], v5, s[4:7], s32 offen offset:1024 sc1
  buffer_load_dwordx4 v[20:23], v5, s[4:7], s32 offen offset:2048 sc1
  buffer_load_dwordx4 v[24:27], v5, s[4:7], s32 offen offset:3072 sc1
  s_add_u32 s31, s31, 1
  s_cmp_lt_u32 s31, 1048576
  s_cbranch_scc1 L_await_219
  s_branch L_abort
L_w6_191:
  v_and_b32 v6, 7, v1
  v_mul_u32_u24 v36, 144, v6
  v_lshrrev_b32 v8, 3, v1
  v_lshl_add_u32 v36, v8, 4, v36
  s_lshr_b32 s40, s25, 3
  s_lshl_b32 s40, s40, 14
  s_and_b32 s39, s25, 7
  s_lshl_b32 s39, s39, 10
  s_add_u32 s40, s40, s39
  s_xor_b32 s39, s24, 0
  s_lshl_b32 s39, s39, 16
  s_add_u32 s39, s39, s40
  v_lshl_add_u32 v37, v1, 4, s39
  s_xor_b32 s39, s24, 1
  s_lshl_b32 s39, s39, 16
  s_add_u32 s39, s39, s40
  v_lshl_add_u32 v38, v1, 4, s39
  s_xor_b32 s39, s24, 2
  s_lshl_b32 s39, s39, 16
  s_add_u32 s39, s39, s40
  v_lshl_add_u32 v39, v1, 4, s39
  s_xor_b32 s39, s24, 3
  s_lshl_b32 s39, s39, 16
  s_add_u32 s39, s39, s40
  v_lshl_add_u32 v40, v1, 4, s39
  v_lshlrev_b32 v41, 4, v6
  v_lshrrev_b32 v9, 1, v8
  v_lshl_add_u32 v41, v9, 7, v41
  v_and_b32 v9, 1, v8
  v_lshl_add_u32 v41, v9, 3, v41
  s_lshl_b32 s39, s25, 9
  v_add_u32 v41, s39, v41
  s_barrier
  s_barrier
  v_mov_b32 v6, 17416
  ds_read_b32 v6, v6
  s_waitcnt lgkmcnt(0)
  v_readfirstlane_b32 s39, v6
  s_nop 3
  s_add_u32 s36, s36, s39
L_w6loop_221:
  s_add_u32 s39, s29, 0
  s_and_b32 s39, s39, 3
  s_mul_i32 s39, s39, 0x4000
  s_mul_i32 s32, s24, 0x10000
  s_add_u32 s32, s32, s39
  s_add_u32 s32, s32, 0x9d00000
  s_add_u32 s39, s29, 1
  s_and_b32 s39, s39, 3
  s_mul_i32 s39, s39, 0x4000
  s_mul_i32 s33, s24, 0x10000
  s_add_u32 s33, s33, s39
  s_add_u32 s33, s33, 0x9d40000
  s_add_u32 s39, s29, 0
  s_and_b32 s39, s39, 3
  s_lshl_b32 s39, s39, 18
  s_add_u32 s35, s36, s39
  s_barrier
  s_barrier
  s_barrier
  s_cmp_eq_u32 s29, 63
  s_cbranch_scc1 L_rec_done_s
  s_barrier
  v_mov_b32 v28, 0
  v_mov_b32 v29, 0
  v_mov_b32 v30, 0
  v_mov_b32 v31, 0
  v_mov_b32 v32, 0
  v_mov_b32 v33, 0
  v_mov_b32 v34, 0
  v_mov_b32 v35, 0
  buffer_load_dwordx4 v[12:15], v5, s[4:7], s32 offen offset:0 sc1
  buffer_load_dwordx4 v[16:19], v5, s[4:7], s32 offen offset:1024 sc1
  buffer_load_dwordx4 v[20:23], v5, s[4:7], s32 offen offset:2048 sc1
  buffer_load_dwordx4 v[24:27], v5, s[4:7], s32 offen offset:3072 sc1
L_await_222:
  s_waitcnt vmcnt(0)
  v_max3_u32 v9, v15, v19, v23
  v_max_u32 v9, v9, v27
  v_cmp_eq_u32 vcc, -1, v9
  s_cbranch_vccnz L_aretry_223
  v_smfmac_f32_16x16x64_bf16 v[28:31], v[12:15], a[0:7], v4
  v_smfmac_f32_16x16x64_bf16 v[32:35], v[12:15], a[8:15], v4
  v_smfmac_f32_16x16x64_bf16 v[28:31], v[16:19], a[16:23], v4
  v_smfmac_f32_16x16x64_bf16 v[32:35], v[16:19], a[24:31], v4
  v_smfmac_f32_16x16x64_bf16 v[28:31], v[20:23], a[32:39], v4
  v_smfmac_f32_16x16x64_bf16 v[32:35], v[20:23], a[40:47], v4
  v_smfmac_f32_16x16x64_bf16 v[28:31], v[24:27], a[48:55], v4
  v_smfmac_f32_16x16x64_bf16 v[32:35], v[24:27], a[56:63], v4
  s_nop 7
  v_permlane32_swap_b32 v28, v32
  v_permlane32_swap_b32 v29, v33
  v_permlane32_swap_b32 v30, v34
  v_permlane32_swap_b32 v31, v35
  v_pk_add_f32 v[28:29], v[28:29], v[32:33]
  v_pk_add_f32 v[30:31], v[30:31], v[34:35]
  ds_write2_b32 v7, v28, v29 offset0:0 offset1:36
  ds_write2_b32 v7, v30, v31 offset0:72 offset1:108
  s_waitcnt lgkmcnt(0)
  s_barrier
  ds_read_b128 v[48:51], v36 offset:12800
  ds_read_b128 v[52:55], v36 offset:13952
  ds_read_b128 v[56:59], v36 offset:15104
  ds_read_b128 v[60:63], v36 offset:16256
  s_waitcnt lgkmcnt(2)
  v_pk_add_f32 v[48:49], v[48:49], v[52:53]
  v_pk_add_f32 v[50:51], v[50:51], v[54:55]
  s_waitcnt lgkmcnt(0)
  v_pk_add_f32 v[56:57], v[56:57], v[60:61]
  v_pk_add_f32 v[58:59], v[58:59], v[62:63]
  v_pk_add_f32 v[48:49], v[48:49], v[56:57]
  v_pk_add_f32 v[50:51], v[50:51], v[58:59]
  buffer_store_dwordx4 v[48:51], v37, s[4:7], s35 offen sc1
  s_waitcnt vmcnt(0)
  buffer_load_dwordx4 v[64:67], v38, s[4:7], s35 offen sc1
  buffer_load_dwordx4 v[68:71], v39, s[4:7], s35 offen sc1
  buffer_load_dwordx4 v[72:75], v40, s[4:7], s35 offen sc1
L_b1wait_224:
  s_waitcnt vmcnt(0)
  v_max3_u32 v9, v67, v71, v75
  v_cmp_eq_u32 vcc, -1, v9
  s_cbranch_vccnz L_b1retry_225
  v_pk_add_f32 v[68:69], v[68:69], v[72:73]
  v_pk_add_f32 v[70:71], v[70:71], v[74:75]
  v_pk_add_f32 v[48:49], v[48:49], v[64:65]
  v_pk_add_f32 v[50:51], v[50:51], v[66:67]
  v_pk_add_f32 v[48:49], v[48:49], v[68:69]
  v_pk_add_f32 v[50:51], v[50:51], v[70:71]
  v_cvt_pk_bf16_f32 v76, v48, v49
  v_cvt_pk_bf16_f32 v77, v50, v51
  buffer_store_dwordx2 v[76:77], v41, s[4:7], s33 offen sc1
  s_add_u32 s29, s29, 1
  s_barrier
  s_branch L_w6loop_221
L_aretry_223:
  buffer_load_dwordx4 v[12:15], v5, s[4:7], s32 offen offset:0 sc1
  buffer_load_dwordx4 v[16:19], v5, s[4:7], s32 offen offset:1024 sc1
  buffer_load_dwordx4 v[20:23], v5, s[4:7], s32 offen offset:2048 sc1
  buffer_load_dwordx4 v[24:27], v5, s[4:7], s32 offen offset:3072 sc1
  s_add_u32 s31, s31, 1
  s_cmp_lt_u32 s31, 1048576
  s_cbranch_scc1 L_await_222
  s_branch L_abort
L_b1retry_225:
  buffer_load_dwordx4 v[64:67], v38, s[4:7], s35 offen sc1
  buffer_load_dwordx4 v[68:71], v39, s[4:7], s35 offen sc1
  buffer_load_dwordx4 v[72:75], v40, s[4:7], s35 offen sc1
  s_add_u32 s31, s31, 1
  s_cmp_lt_u32 s31, 1048576
  s_cbranch_scc1 L_b1wait_224
  s_branch L_abort
L_w7_192:
  v_mov_b32 v36, -1
  v_mov_b32 v37, -1
  v_mov_b32 v38, -1
  v_mov_b32 v39, -1
  s_lshl_b32 s39, s25, 9
  v_lshl_add_u32 v40, v1, 4, s39
  v_cmp_gt_u32 vcc, 32, v1
  v_mov_b32 v6, 0x80000000
  s_nop 0
  v_cndmask_b32 v40, v6, v40, vcc
  s_lshl_b32 s39, s25, 11
  v_lshl_add_u32 v41, v1, 4, s39
  v_add_u32 v42, 1024, v41
  s_lshr_b32 s40, s25, 3
  s_lshl_b32 s40, s40, 14
  s_and_b32 s39, s25, 7
  s_lshl_b32 s39, s39, 10
  s_add_u32 s40, s40, s39
  s_xor_b32 s39, s24, 0
  s_lshl_b32 s39, s39, 16
  s_add_u32 s39, s39, s40
  v_lshl_add_u32 v43, v1, 4, s39
  v_mov_b32 v9, 0
  s_lshl_b32 s39, s24, 5
  s_add_u32 s39, s39, s25
  s_lshl_b32 s39, s39, 7
  s_add_u32 s39, s39, 0x9c10000
  v_mov_b32 v44, s39
  v_cmp_eq_u32 vcc, 0, v1
  v_mov_b32 v6, 0x80000000
  s_nop 0
  v_cndmask_b32 v44, v6, v44, vcc
  buffer_store_dword v9, v44, s[4:7], 0 offen sc1
  s_lshl_b32 s39, s24, 5
  s_add_u32 s39, s39, s25
  s_lshl_b32 s39, s39, 7
  s_add_u32 s39, s39, 0x9c14000
  v_mov_b32 v44, s39
  v_cmp_eq_u32 vcc, 0, v1
  v_mov_b32 v6, 0x80000000
  s_nop 0
  v_cndmask_b32 v44, v6, v44, vcc
  buffer_store_dword v9, v44, s[4:7], 0 offen sc1
  s_mov_b32 s29, 0
  s_add_u32 s39, s29, 0
  s_and_b32 s39, s39, 3
  s_mul_i32 s39, s39, 0x4000
  s_mul_i32 s32, s24, 0x10000
  s_add_u32 s32, s32, s39
  s_add_u32 s32, s32, 0x9d00000
  buffer_store_dwordx4 v[36:39], v40, s[4:7], s32 offen sc1
  s_add_u32 s39, s29, 0
  s_and_b32 s39, s39, 3
  s_mul_i32 s39, s39, 0x4000
  s_mul_i32 s32, s24, 0x10000
  s_add_u32 s32, s32, s39
  s_add_u32 s32, s32, 0x9d40000
  buffer_store_dwordx4 v[36:39], v40, s[4:7], s32 offen sc1
  s_add_u32 s39, s29, 0
  s_and_b32 s39, s39, 3
  s_mul_i32 s39, s39, 0x10000
  s_mul_i32 s32, s24, 0x40000
  s_add_u32 s32, s32, s39
  s_add_u32 s32, s32, 0x9e00000
  buffer_store_dwordx4 v[36:39], v41, s[4:7], s32 offen sc1
  buffer_store_dwordx4 v[36:39], v42, s[4:7], s32 offen sc1
  s_add_u32 s39, s29, 0
  s_and_b32 s39, s39, 3
  s_lshl_b32 s39, s39, 18
  s_add_u32 s32, s36, s39
  buffer_store_dwordx4 v[36:39], v43, s[4:7], s32 offen sc1
  s_mov_b32 s29, 1
  s_add_u32 s39, s29, 0
  s_and_b32 s39, s39, 3
  s_mul_i32 s39, s39, 0x4000
  s_mul_i32 s32, s24, 0x10000
  s_add_u32 s32, s32, s39
  s_add_u32 s32, s32, 0x9d00000
  buffer_store_dwordx4 v[36:39], v40, s[4:7], s32 offen sc1
  s_add_u32 s39, s29, 0
  s_and_b32 s39, s39, 3
  s_mul_i32 s39, s39, 0x4000
  s_mul_i32 s32, s24, 0x10000
  s_add_u32 s32, s32, s39
  s_add_u32 s32, s32, 0x9d40000
  buffer_store_dwordx4 v[36:39], v40, s[4:7], s32 offen sc1
  s_add_u32 s39, s29, 0
  s_and_b32 s39, s39, 3
  s_mul_i32 s39, s39, 0x10000
  s_mul_i32 s32, s24, 0x40000
  s_add_u32 s32, s32, s39
  s_add_u32 s32, s32, 0x9e00000
  buffer_store_dwordx4 v[36:39], v41, s[4:7], s32 offen sc1
  buffer_store_dwordx4 v[36:39], v42, s[4:7], s32 offen sc1
  s_add_u32 s39, s29, 0
  s_and_b32 s39, s39, 3
  s_lshl_b32 s39, s39, 18
  s_add_u32 s32, s36, s39
  buffer_store_dwordx4 v[36:39], v43, s[4:7], s32 offen sc1
  s_mov_b32 s29, 2
  s_add_u32 s39, s29, 0
  s_and_b32 s39, s39, 3
  s_mul_i32 s39, s39, 0x4000
  s_mul_i32 s32, s24, 0x10000
  s_add_u32 s32, s32, s39
  s_add_u32 s32, s32, 0x9d00000
  buffer_store_dwordx4 v[36:39], v40, s[4:7], s32 offen sc1
  s_add_u32 s39, s29, 0
  s_and_b32 s39, s39, 3
  s_mul_i32 s39, s39, 0x4000
  s_mul_i32 s32, s24, 0x10000
  s_add_u32 s32, s32, s39
  s_add_u32 s32, s32, 0x9d40000
  buffer_store_dwordx4 v[36:39], v40, s[4:7], s32 offen sc1
  s_add_u32 s39, s29, 0
  s_and_b32 s39, s39, 3
  s_mul_i32 s39, s39, 0x10000
  s_mul_i32 s32, s24, 0x40000
  s_add_u32 s32, s32, s39
  s_add_u32 s32, s32, 0x9e00000
  buffer_store_dwordx4 v[36:39], v41, s[4:7], s32 offen sc1
  buffer_store_dwordx4 v[36:39], v42, s[4:7], s32 offen sc1
  s_add_u32 s39, s29, 0
  s_and_b32 s39, s39, 3
  s_lshl_b32 s39, s39, 18
  s_add_u32 s32, s36, s39
  buffer_store_dwordx4 v[36:39], v43, s[4:7], s32 offen sc1
  s_mov_b32 s29, 3
  s_add_u32 s39, s29, 0
  s_and_b32 s39, s39, 3
  s_mul_i32 s39, s39, 0x4000
  s_mul_i32 s32, s24, 0x10000
  s_add_u32 s32, s32, s39
  s_add_u32 s32, s32, 0x9d00000
  buffer_store_dwordx4 v[36:39], v40, s[4:7], s32 offen sc1
  s_add_u32 s39, s29, 0
  s_and_b32 s39, s39, 3
  s_mul_i32 s39, s39, 0x4000
  s_mul_i32 s32, s24, 0x10000
  s_add_u32 s32, s32, s39
  s_add_u32 s32, s32, 0x9d40000
  buffer_store_dwordx4 v[36:39], v40, s[4:7], s32 offen sc1
  s_add_u32 s39, s29, 0
  s_and_b32 s39, s39, 3
  s_mul_i32 s39, s39, 0x10000
  s_mul_i32 s32, s24, 0x40000
  s_add_u32 s32, s32, s39
  s_add_u32 s32, s32, 0x9e00000
  buffer_store_dwordx4 v[36:39], v41, s[4:7], s32 offen sc1
  buffer_store_dwordx4 v[36:39], v42, s[4:7], s32 offen sc1
  s_add_u32 s39, s29, 0
  s_and_b32 s39, s39, 3
  s_lshl_b32 s39, s39, 18
  s_add_u32 s32, s36, s39
  buffer_store_dwordx4 v[36:39], v43, s[4:7], s32 offen sc1
  s_mov_b32 s29, 0
  s_waitcnt vmcnt(0)
  v_mov_b32 v9, 1
  v_mov_b32 v8, 48
  v_cmp_eq_u32 vcc, 0, v1
  v_mov_b32 v6, 0x80000000
  s_nop 0
  v_cndmask_b32 v8, v6, v8, vcc
  buffer_atomic_add v9, v8, s[20:23], 0 offen
  s_mov_b32 s8, s54
  s_mov_b32 s9, s55
  s_mov_b32 s10, 0x800000
  s_mov_b32 s11, 0x20000
  s_lshl_b32 s39, s24, 21
  s_sub_u32 s41, s28, 4
  s_mul_i32 s40, s41, 16384
  s_add_u32 s40, s40, 92160
  s_lshl_b32 s41, s41, 19
  s_add_u32 s39, s39, s41
  s_lshl_b32 s41, s25, 6
  s_add_u32 s39, s39, s41
  v_lshrrev_b32 v4, 2, v1
  v_mul_u32_u24 v4, 2048, v4
  v_and_b32 v6, 3, v1
  v_lshl_add_u32 v4, v6, 4, v4
  v_add_u32 v4, s39, v4
  v_lshrrev_b32 v6, 1, v3
  v_and_b32 v7, 1, v3
  v_lshlrev_b32 v6, 3, v6
  v_lshl_add_u32 v6, v7, 4, v6
  v_lshrrev_b32 v7, 2, v2
  v_add_u32 v6, v6, v7
  v_and_b32 v7, 3, v2
  v_lshlrev_b32 v7, 3, v7
  v_lshl_add_u32 v5, v6, 6, v7
  v_add_u32 v5, s40, v5
  s_add_u32 m0, s40, 0
  s_mov_b32 s39, 0x0
  buffer_load_dwordx4 v4, s[8:11], s39 offen lds
  s_add_u32 m0, s40, 1024
  s_mov_b32 s39, 0x8000
  buffer_load_dwordx4 v4, s[8:11], s39 offen lds
  s_add_u32 m0, s40, 2048
  s_mov_b32 s39, 0x10000
  buffer_load_dwordx4 v4, s[8:11], s39 offen lds
  s_add_u32 m0, s40, 3072
  s_mov_b32 s39, 0x18000
  buffer_load_dwordx4 v4, s[8:11], s39 offen lds
  s_add_u32 m0, s40, 4096
  s_mov_b32 s39, 0x20000
  buffer_load_dwordx4 v4, s[8:11], s39 offen lds
  s_add_u32 m0, s40, 5120
  s_mov_b32 s39, 0x28000
  buffer_load_dwordx4 v4, s[8:11], s39 offen lds
  s_add_u32 m0, s40, 6144
  s_mov_b32 s39, 0x30000
  buffer_load_dwordx4 v4, s[8:11], s39 offen lds
  s_add_u32 m0, s40, 7168
  s_mov_b32 s39, 0x38000
  buffer_load_dwordx4 v4, s[8:11], s39 offen lds
  s_add_u32 m0, s40, 8192
  s_mov_b32 s39, 0x40000
  buffer_load_dwordx4 v4, s[8:11], s39 offen lds
  s_add_u32 m0, s40, 9216
  s_mov_b32 s39, 0x48000
  buffer_load_dwordx4 v4, s[8:11], s39 offen lds
  s_add_u32 m0, s40, 10240
  s_mov_b32 s39, 0x50000
  buffer_load_dwordx4 v4, s[8:11], s39 offen lds
  s_add_u32 m0, s40, 11264
  s_mov_b32 s39, 0x58000
  buffer_load_dwordx4 v4, s[8:11], s39 offen lds
  s_add_u32 m0, s40, 12288
  s_mov_b32 s39, 0x60000
  buffer_load_dwordx4 v4, s[8:11], s39 offen lds
  s_add_u32 m0, s40, 13312
  s_mov_b32 s39, 0x68000
  buffer_load_dwordx4 v4, s[8:11], s39 offen lds
  s_add_u32 m0, s40, 14336
  s_mov_b32 s39, 0x70000
  buffer_load_dwordx4 v4, s[8:11], s39 offen lds
  s_add_u32 m0, s40, 15360
  s_mov_b32 s39, 0x78000
  buffer_load_dwordx4 v4, s[8:11], s39 offen lds
  s_waitcnt vmcnt(12)
  ds_read_b64_tr_b16 v[12:13], v5 offset:0
  ds_read_b64_tr_b16 v[14:15], v5 offset:256
  ds_read_b64_tr_b16 v[16:17], v5 offset:2048
  ds_read_b64_tr_b16 v[18:19], v5 offset:2304
  ds_read_b64_tr_b16 v[20:21], v5 offset:32
  ds_read_b64_tr_b16 v[22:23], v5 offset:288
  ds_read_b64_tr_b16 v[24:25], v5 offset:2080
  ds_read_b64_tr_b16 v[26:27], v5 offset:2336
  s_waitcnt lgkmcnt(0)
  v_accvgpr_write_b32 a0, v12
  v_accvgpr_write_b32 a2, v13
  v_accvgpr_write_b32 a1, v14
  v_accvgpr_write_b32 a3, v15
  v_accvgpr_write_b32 a4, v16
  v_accvgpr_write_b32 a6, v17
  v_accvgpr_write_b32 a5, v18
  v_accvgpr_write_b32 a7, v19
  v_accvgpr_write_b32 a8, v20
  v_accvgpr_write_b32 a10, v21
  v_accvgpr_write_b32 a9, v22
  v_accvgpr_write_b32 a11, v23
  v_accvgpr_write_b32 a12, v24
  v_accvgpr_write_b32 a14, v25
  v_accvgpr_write_b32 a13, v26
  v_accvgpr_write_b32 a15, v27
  s_waitcnt vmcnt(8)
  ds_read_b64_tr_b16 v[12:13], v5 offset:4096
  ds_read_b64_tr_b16 v[14:15], v5 offset:4352
  ds_read_b64_tr_b16 v[16:17], v5 offset:6144
  ds_read_b64_tr_b16 v[18:19], v5 offset:6400
  ds_read_b64_tr_b16 v[20:21], v5 offset:4128
  ds_read_b64_tr_b16 v[22:23], v5 offset:4384
  ds_read_b64_tr_b16 v[24:25], v5 offset:6176
  ds_read_b64_tr_b16 v[26:27], v5 offset:6432
  s_waitcnt lgkmcnt(0)
  v_accvgpr_write_b32 a16, v12
  v_accvgpr_write_b32 a18, v13
  v_accvgpr_write_b32 a17, v14
  v_accvgpr_write_b32 a19, v15
  v_accvgpr_write_b32 a20, v16
  v_accvgpr_write_b32 a22, v17
  v_accvgpr_write_b32 a21, v18
  v_accvgpr_write_b32 a23, v19
  v_accvgpr_write_b32 a24, v20
  v_accvgpr_write_b32 a26, v21
  v_accvgpr_write_b32 a25, v22
  v_accvgpr_write_b32 a27, v23
  v_accvgpr_write_b32 a28, v24
  v_accvgpr_write_b32 a30, v25
  v_accvgpr_write_b32 a29, v26
  v_accvgpr_write_b32 a31, v27
  s_waitcnt vmcnt(4)
  ds_read_b64_tr_b16 v[12:13], v5 offset:8192
  ds_read_b64_tr_b16 v[14:15], v5 offset:8448
  ds_read_b64_tr_b16 v[16:17], v5 offset:10240
  ds_read_b64_tr_b16 v[18:19], v5 offset:10496
  ds_read_b64_tr_b16 v[20:21], v5 offset:8224
  ds_read_b64_tr_b16 v[22:23], v5 offset:8480
  ds_read_b64_tr_b16 v[24:25], v5 offset:10272
  ds_read_b64_tr_b16 v[26:27], v5 offset:10528
  s_waitcnt lgkmcnt(0)
  v_accvgpr_write_b32 a32, v12
  v_accvgpr_write_b32 a34, v13
  v_accvgpr_write_b32 a33, v14
  v_accvgpr_write_b32 a35, v15
  v_accvgpr_write_b32 a36, v16
  v_accvgpr_write_b32 a38, v17
  v_accvgpr_write_b32 a37, v18
  v_accvgpr_write_b32 a39, v19
  v_accvgpr_write_b32 a40, v20
  v_accvgpr_write_b32 a42, v21
  v_accvgpr_write_b32 a41, v22
  v_accvgpr_write_b32 a43, v23
  v_accvgpr_write_b32 a44, v24
  v_accvgpr_write_b32 a46, v25
  v_accvgpr_write_b32 a45, v26
  v_accvgpr_write_b32 a47, v27
  s_waitcnt vmcnt(0)
  ds_read_b64_tr_b16 v[12:13], v5 offset:12288
  ds_read_b64_tr_b16 v[14:15], v5 offset:12544
  ds_read_b64_tr_b16 v[16:17], v5 offset:14336
  ds_read_b64_tr_b16 v[18:19], v5 offset:14592
  ds_read_b64_tr_b16 v[20:21], v5 offset:12320
  ds_read_b64_tr_b16 v[22:23], v5 offset:12576
  ds_read_b64_tr_b16 v[24:25], v5 offset:14368
  ds_read_b64_tr_b16 v[26:27], v5 offset:14624
  s_waitcnt lgkmcnt(0)
  v_accvgpr_write_b32 a48, v12
  v_accvgpr_write_b32 a50, v13
  v_accvgpr_write_b32 a49, v14
  v_accvgpr_write_b32 a51, v15
  v_accvgpr_write_b32 a52, v16
  v_accvgpr_write_b32 a54, v17
  v_accvgpr_write_b32 a53, v18
  v_accvgpr_write_b32 a55, v19
  v_accvgpr_write_b32 a56, v20
  v_accvgpr_write_b32 a58, v21
  v_accvgpr_write_b32 a57, v22
  v_accvgpr_write_b32 a59, v23
  v_accvgpr_write_b32 a60, v24
  v_accvgpr_write_b32 a62, v25
  v_accvgpr_write_b32 a61, v26
  v_accvgpr_write_b32 a63, v27
  s_setprio 0
  v_and_b32 v4, 8, v1
  v_cmp_eq_u32 vcc, 0, v4
  v_mov_b32 v4, 0xeeee
  v_mov_b32 v6, 0x4444
  v_cndmask_b32 v4, v4, v6, vcc
  s_sub_u32 s40, s28, 4
  s_lshl_b32 s39, s40, 12
  v_lshl_add_u32 v5, v1, 4, s39
  v_and_b32 v6, 1, v3
  v_mul_u32_u24 v7, 576, v6
  v_lshrrev_b32 v6, 5, v1
  v_lshl_add_u32 v6, v6, 4, v2
  v_lshl_add_u32 v7, v6, 2, v7
  s_mul_i32 s39, s40, 1152
  s_add_u32 s39, s39, 12800
  v_add_u32 v7, s39, v7
  s_barrier
  s_mov_b32 s40, 48
  v_mov_b32 v8, 0
  s_mov_b32 s41, 0x80
L_poll_226:
  buffer_load_dword v6, v8, s[20:23], s40 offen sc1
  s_waitcnt vmcnt(0)
  v_cmp_le_u32 vcc, s41, v6
  s_cbranch_vccnz L_pollok_227
  s_sleep 1
  s_add_u32 s31, s31, 1
  s_cmp_lt_u32 s31, 1048576
  s_cbranch_scc1 L_poll_226
  s_branch L_abort
L_pollok_227:
  v_mov_b32 v6, 0
  v_mov_b32 v8, 17416
  ds_write_b32 v8, v6
  s_waitcnt lgkmcnt(0)
  s_barrier
  v_lshlrev_b32 v44, 4, v1
  s_lshl_b32 s64, s24, 15
  s_lshl_b32 s39, s25, 10
  s_add_u32 s64, s64, s39
  s_add_u32 s64, s64, 0xa400000
L_w7loop_228:
  s_add_u32 s39, s29, 0
  s_and_b32 s39, s39, 3
  s_mul_i32 s39, s39, 0x4000
  s_mul_i32 s32, s24, 0x10000
  s_add_u32 s32, s32, s39
  s_add_u32 s32, s32, 0x9d00000
  s_add_u32 s39, s29, 3
  s_and_b32 s39, s39, 3
  s_mul_i32 s39, s39, 0x4000
  s_mul_i32 s42, s24, 0x10000
  s_add_u32 s42, s42, s39
  s_add_u32 s42, s42, 0x9d00000
  s_add_u32 s39, s29, 3
  s_and_b32 s39, s39, 3
  s_mul_i32 s39, s39, 0x10000
  s_mul_i32 s43, s24, 0x40000
  s_add_u32 s43, s43, s39
  s_add_u32 s43, s43, 0x9e00000
  s_add_u32 s39, s29, 3
  s_and_b32 s39, s39, 3
  s_mul_i32 s39, s39, 0x4000
  s_mul_i32 s44, s24, 0x10000
  s_add_u32 s44, s44, s39
  s_add_u32 s44, s44, 0x9d40000
  s_add_u32 s39, s29, 2
  s_and_b32 s39, s39, 3
  s_lshl_b32 s39, s39, 18
  s_add_u32 s45, s36, s39
  s_barrier
  s_cmp_ge_u32 s29, 32
  s_cbranch_scc1 L_noro_229
  s_lshl_b32 s39, s29, 17
  s_add_u32 s39, s39, s64
  buffer_store_dwordx4 v[36:39], v44, s[4:7], s39 offen sc1
L_noro_229:
  buffer_store_dwordx4 v[36:39], v43, s[4:7], s45 offen sc1
  buffer_store_dwordx4 v[36:39], v40, s[4:7], s42 offen sc1
  buffer_store_dwordx4 v[36:39], v41, s[4:7], s43 offen sc1
  buffer_store_dwordx4 v[36:39], v42, s[4:7], s43 offen sc1
  buffer_store_dwordx4 v[36:39], v40, s[4:7], s44 offen sc1
  s_barrier
  s_barrier
  s_cmp_eq_u32 s29, 63
  s_cbranch_scc1 L_rec_done_s
  s_barrier
  v_mov_b32 v28, 0
  v_mov_b32 v29, 0
  v_mov_b32 v30, 0
  v_mov_b32 v31, 0
  v_mov_b32 v32, 0
  v_mov_b32 v33, 0
  v_mov_b32 v34, 0
  v_mov_b32 v35, 0
  buffer_load_dwordx4 v[12:15], v5, s[4:7], s32 offen offset:0 sc1
  buffer_load_dwordx4 v[16:19], v5, s[4:7], s32 offen offset:1024 sc1
  buffer_load_dwordx4 v[20:23], v5, s[4:7], s32 offen offset:2048 sc1
  buffer_load_dwordx4 v[24:27], v5, s[4:7], s32 offen offset:3072 sc1
L_await_230:
  s_waitcnt vmcnt(0)
  v_max3_u32 v9, v15, v19, v23
  v_max_u32 v9, v9, v27
  v_cmp_eq_u32 vcc, -1, v9
  s_cbranch_vccnz L_aretry_231
  v_smfmac_f32_16x16x64_bf16 v[28:31], v[12:15], a[0:7], v4
  v_smfmac_f32_16x16x64_bf16 v[32:35], v[12:15], a[8:15], v4
  v_smfmac_f32_16x16x64_bf16 v[28:31], v[16:19], a[16:23], v4
  v_smfmac_f32_16x16x64_bf16 v[32:35], v[16:19], a[24:31], v4
  v_smfmac_f32_16x16x64_bf16 v[28:31], v[20:23], a[32:39], v4
  v_smfmac_f32_16x16x64_bf16 v[32:35], v[20:23], a[40:47], v4
  v_smfmac_f32_16x16x64_bf16 v[28:31], v[24:27], a[48:55], v4
  v_smfmac_f32_16x16x64_bf16 v[32:35], v[24:27], a[56:63], v4
  s_nop 7
  v_permlane32_swap_b32 v28, v32
  v_permlane32_swap_b32 v29, v33
  v_permlane32_swap_b32 v30, v34
  v_permlane32_swap_b32 v31, v35
  v_pk_add_f32 v[28:29], v[28:29], v[32:33]
  v_pk_add_f32 v[30:31], v[30:31], v[34:35]
  ds_write2_b32 v7, v28, v29 offset0:0 offset1:36
  ds_write2_b32 v7, v30, v31 offset0:72 offset1:108
  s_waitcnt lgkmcnt(0)
  s_barrier
  s_add_u32 s29, s29, 1
  s_barrier
  s_branch L_w7loop_228
L_aretry_231:
  buffer_load_dwordx4 v[12:15], v5, s[4:7], s32 offen offset:0 sc1
  buffer_load_dwordx4 v[16:19], v5, s[4:7], s32 offen offset:1024 sc1
  buffer_load_dwordx4 v[20:23], v5, s[4:7], s32 offen offset:2048 sc1
  buffer_load_dwordx4 v[24:27], v5, s[4:7], s32 offen offset:3072 sc1
  s_add_u32 s31, s31, 1
  s_cmp_lt_u32 s31, 1048576
  s_cbranch_scc1 L_await_230
  s_branch L_abort
L_rec_done_y2_s_y:
  s_barrier
  s_barrier
L_rec_done_s:
  s_cmp_lt_u32 s28, 4
  s_cbranch_scc1 L_rofin_232
  v_lshrrev_b32 v6, 5, v1
  v_lshlrev_b32 v60, 10, v6
  v_bfe_u32 v6, v1, 3, 2
  v_lshl_add_u32 v60, v6, 8, v60
  v_and_b32 v6, 7, v1
  v_lshl_add_u32 v60, v6, 4, v60
  s_lshl_b32 s39, s24, 2
  s_add_u32 s39, s39, s28
  s_sub_u32 s39, s39, 4
  s_lshl_b32 s39, s39, 13
  s_add_u32 s39, s39, 0x4e00000
  v_add_u32 v60, s39, v60
  v_add_u32 v61, 4096, v60
  v_add_u32 v12, 19968, v7
  v_add_u32 v13, 24576, v7
  v_add_u32 v14, 29184, v7
  v_add_u32 v15, 33792, v7
  v_add_u32 v16, 38400, v7
  v_add_u32 v17, 43008, v7
  v_add_u32 v18, 47616, v7
  v_add_u32 v19, 52224, v7
  v_min_u32 v24, 7, v1
  v_lshlrev_b32 v24, 9, v24
  s_lshl_b32 s38, s24, 7
  s_add_u32 s38, s38, 0x9c15e00
  s_add_u32 s40, s38, 0
  v_mov_b32 v8, 0
  s_mov_b32 s41, 0x8
L_poll_234:
  buffer_load_dword v6, v8, s[4:7], s40 offen sc1
  s_waitcnt vmcnt(0)
  v_cmp_le_u32 vcc, s41, v6
  s_cbranch_vccnz L_pollok_235
  s_sleep 1
  s_add_u32 s31, s31, 1
  s_cmp_lt_u32 s31, 1048576
  s_cbranch_scc1 L_poll_234
  s_branch L_abort
L_pollok_235:
  s_mov_b32 s32, 0
  s_mov_b32 s33, 131072
  buffer_load_dwordx4 v[64:67], v60, s[4:7], s32 offen offset:0 sc1
  buffer_load_dwordx4 v[68:71], v60, s[4:7], s32 offen offset:2048 sc1
  buffer_load_dwordx4 v[72:75], v61, s[4:7], s32 offen offset:0 sc1
  buffer_load_dwordx4 v[76:79], v61, s[4:7], s32 offen offset:2048 sc1
  buffer_load_dwordx4 v[80:83], v60, s[4:7], s32 offen offset:128 sc1
  buffer_load_dwordx4 v[84:87], v60, s[4:7], s32 offen offset:2176 sc1
  buffer_load_dwordx4 v[88:91], v61, s[4:7], s32 offen offset:128 sc1
  buffer_load_dwordx4 v[92:95], v61, s[4:7], s32 offen offset:2176 sc1
  buffer_load_dwordx4 v[96:99], v60, s[4:7], s33 offen offset:0 sc1
  buffer_load_dwordx4 v[100:103], v60, s[4:7], s33 offen offset:2048 sc1
  buffer_load_dwordx4 v[104:107], v61, s[4:7], s33 offen offset:0 sc1
  buffer_load_dwordx4 v[108:111], v61, s[4:7], s33 offen offset:2048 sc1
  buffer_load_dwordx4 v[112:115], v60, s[4:7], s33 offen offset:128 sc1
  buffer_load_dwordx4 v[116:119], v60, s[4:7], s33 offen offset:2176 sc1
  buffer_load_dwordx4 v[120:123], v61, s[4:7], s33 offen offset:128 sc1
  buffer_load_dwordx4 v[124:127], v61, s[4:7], s33 offen offset:2176 sc1
  buffer_load_dword v25, v24, s[4:7], s38 offen sc1
  v_mov_b32 v28, 0
  v_mov_b32 v29, 0
  v_mov_b32 v30, 0
  v_mov_b32 v31, 0
  v_mov_b32 v32, 0
  v_mov_b32 v33, 0
  v_mov_b32 v34, 0
  v_mov_b32 v35, 0
  v_mov_b32 v36, 0
  v_mov_b32 v37, 0
  v_mov_b32 v38, 0
  v_mov_b32 v39, 0
  v_mov_b32 v40, 0
  v_mov_b32 v41, 0
  v_mov_b32 v42, 0
  v_mov_b32 v43, 0
  v_mov_b32 v44, 0
  v_mov_b32 v45, 0
  v_mov_b32 v46, 0
  v_mov_b32 v47, 0
  v_mov_b32 v48, 0
  v_mov_b32 v49, 0
  v_mov_b32 v50, 0
  v_mov_b32 v51, 0
  v_mov_b32 v52, 0
  v_mov_b32 v53, 0
  v_mov_b32 v54, 0
  v_mov_b32 v55, 0
  v_mov_b32 v56, 0
  v_mov_b32 v57, 0
  v_mov_b32 v58, 0
  v_mov_b32 v59, 0
  s_waitcnt vmcnt(0)
  s_mov_b32 s34, 0
  v_readlane_b32 s39, v25, 1
  s_nop 3
  s_cmp_lt_u32 s39, 8
  s_cbranch_scc1 L_rolate_236
  s_mov_b32 s32, 262144
  s_mov_b32 s33, 393216
  buffer_load_dwordx4 v[128:131], v60, s[4:7], s32 offen offset:0 sc1
  buffer_load_dwordx4 v[132:135], v60, s[4:7], s32 offen offset:2048 sc1
  buffer_load_dwordx4 v[136:139], v61, s[4:7], s32 offen offset:0 sc1
  buffer_load_dwordx4 v[140:143], v61, s[4:7], s32 offen offset:2048 sc1
  buffer_load_dwordx4 v[144:147], v60, s[4:7], s32 offen offset:128 sc1
  buffer_load_dwordx4 v[148:151], v60, s[4:7], s32 offen offset:2176 sc1
  buffer_load_dwordx4 v[152:155], v61, s[4:7], s32 offen offset:128 sc1
  buffer_load_dwordx4 v[156:159], v61, s[4:7], s32 offen offset:2176 sc1
  buffer_load_dwordx4 v[160:163], v60, s[4:7], s33 offen offset:0 sc1
  buffer_load_dwordx4 v[164:167], v60, s[4:7], s33 offen offset:2048 sc1
  buffer_load_dwordx4 v[168:171], v61, s[4:7], s33 offen offset:0 sc1
  buffer_load_dwordx4 v[172:175], v61, s[4:7], s33 offen offset:2048 sc1
  buffer_load_dwordx4 v[176:179], v60, s[4:7], s33 offen offset:128 sc1
  buffer_load_dwordx4 v[180:183], v60, s[4:7], s33 offen offset:2176 sc1
  buffer_load_dwordx4 v[184:187], v61, s[4:7], s33 offen offset:128 sc1
  buffer_load_dwordx4 v[188:191], v61, s[4:7], s33 offen offset:2176 sc1
  s_mov_b32 s34, 1
L_rolate_236:
  v_smfmac_f32_16x16x64_bf16 v[28:31], v[64:67], a[0:7], v4
  v_smfmac_f32_16x16x64_bf16 v[32:35], v[64:67], a[8:15], v4
  v_smfmac_f32_16x16x64_bf16 v[28:31], v[68:71], a[16:23], v4
  v_smfmac_f32_16x16x64_bf16 v[32:35], v[68:71], a[24:31], v4
  v_smfmac_f32_16x16x64_bf16 v[28:31], v[72:75], a[32:39], v4
  v_smfmac_f32_16x16x64_bf16 v[32:35], v[72:75], a[40:47], v4
  v_smfmac_f32_16x16x64_bf16 v[28:31], v[76:79], a[48:55], v4
  v_smfmac_f32_16x16x64_bf16 v[32:35], v[76:79], a[56:63], v4
  v_smfmac_f32_16x16x64_bf16 v[36:39], v[80:83], a[0:7], v4
  v_smfmac_f32_16x16x64_bf16 v[40:43], v[80:83], a[8:15], v4
  v_smfmac_f32_16x16x64_bf16 v[36:39], v[84:87], a[16:23], v4
  v_smfmac_f32_16x16x64_bf16 v[40:43], v[84:87], a[24:31], v4
  v_smfmac_f32_16x16x64_bf16 v[36:39], v[88:91], a[32:39], v4
  v_smfmac_f32_16x16x64_bf16 v[40:43], v[88:91], a[40:47], v4
  v_smfmac_f32_16x16x64_bf16 v[36:39], v[92:95], a[48:55], v4
  v_smfmac_f32_16x16x64_bf16 v[40:43], v[92:95], a[56:63], v4
  v_smfmac_f32_16x16x64_bf16 v[44:47], v[96:99], a[0:7], v4
  v_smfmac_f32_16x16x64_bf16 v[48:51], v[96:99], a[8:15], v4
  v_smfmac_f32_16x16x64_bf16 v[44:47], v[100:103], a[16:23], v4
  v_smfmac_f32_16x16x64_bf16 v[48:51], v[100:103], a[24:31], v4
  v_smfmac_f32_16x16x64_bf16 v[44:47], v[104:107], a[32:39], v4
  v_smfmac_f32_16x16x64_bf16 v[48:51], v[104:107], a[40:47], v4
  v_smfmac_f32_16x16x64_bf16 v[44:47], v[108:111], a[48:55], v4
  v_smfmac_f32_16x16x64_bf16 v[48:51], v[108:111], a[56:63], v4
  v_smfmac_f32_16x16x64_bf16 v[52:55], v[112:115], a[0:7], v4
  v_smfmac_f32_16x16x64_bf16 v[56:59], v[112:115], a[8:15], v4
  v_smfmac_f32_16x16x64_bf16 v[52:55], v[116:119], a[16:23], v4
  v_smfmac_f32_16x16x64_bf16 v[56:59], v[116:119], a[24:31], v4
  v_smfmac_f32_16x16x64_bf16 v[52:55], v[120:123], a[32:39], v4
  v_smfmac_f32_16x16x64_bf16 v[56:59], v[120:123], a[40:47], v4
  v_smfmac_f32_16x16x64_bf16 v[52:55], v[124:127], a[48:55], v4
  v_smfmac_f32_16x16x64_bf16 v[56:59], v[124:127], a[56:63], v4
  v_permlane32_swap_b32 v28, v32
  v_permlane32_swap_b32 v29, v33
  v_permlane32_swap_b32 v30, v34
  v_permlane32_swap_b32 v31, v35
  v_pk_add_f32 v[28:29], v[28:29], v[32:33]
  v_pk_add_f32 v[30:31], v[30:31], v[34:35]
  ds_write2_b32 v12, v28, v29 offset0:0 offset1:36
  ds_write2_b32 v12, v30, v31 offset0:72 offset1:108
  v_permlane32_swap_b32 v36, v40
  v_permlane32_swap_b32 v37, v41
  v_permlane32_swap_b32 v38, v42
  v_permlane32_swap_b32 v39, v43
  v_pk_add_f32 v[36:37], v[36:37], v[40:41]
  v_pk_add_f32 v[38:39], v[38:39], v[42:43]
  ds_write2_b32 v13, v36, v37 offset0:0 offset1:36
  ds_write2_b32 v13, v38, v39 offset0:72 offset1:108
  v_permlane32_swap_b32 v44, v48
  v_permlane32_swap_b32 v45, v49
  v_permlane32_swap_b32 v46, v50
  v_permlane32_swap_b32 v47, v51
  v_pk_add_f32 v[44:45], v[44:45], v[48:49]
  v_pk_add_f32 v[46:47], v[46:47], v[50:51]
  ds_write2_b32 v14, v44, v45 offset0:0 offset1:36
  ds_write2_b32 v14, v46, v47 offset0:72 offset1:108
  s_nop 7
  v_permlane32_swap_b32 v52, v56
  v_permlane32_swap_b32 v53, v57
  v_permlane32_swap_b32 v54, v58
  v_permlane32_swap_b32 v55, v59
  v_pk_add_f32 v[52:53], v[52:53], v[56:57]
  v_pk_add_f32 v[54:55], v[54:55], v[58:59]
  ds_write2_b32 v15, v52, v53 offset0:0 offset1:36
  ds_write2_b32 v15, v54, v55 offset0:72 offset1:108
  s_waitcnt lgkmcnt(0)
  s_barrier
  s_cmp_lg_u32 s34, 0
  s_cbranch_scc1 L_rocont_237
  s_add_u32 s40, s38, 512
  v_mov_b32 v8, 0
  s_mov_b32 s41, 0x8
L_poll_238:
  buffer_load_dword v6, v8, s[4:7], s40 offen sc1
  s_waitcnt vmcnt(0)
  v_cmp_le_u32 vcc, s41, v6
  s_cbranch_vccnz L_pollok_239
  s_sleep 1
  s_add_u32 s31, s31, 1
  s_cmp_lt_u32 s31, 1048576
  s_cbranch_scc1 L_poll_238
  s_branch L_abort
L_pollok_239:
  s_mov_b32 s32, 262144
  s_mov_b32 s33, 393216
  buffer_load_dwordx4 v[128:131], v60, s[4:7], s32 offen offset:0 sc1
  buffer_load_dwordx4 v[132:135], v60, s[4:7], s32 offen offset:2048 sc1
  buffer_load_dwordx4 v[136:139], v61, s[4:7], s32 offen offset:0 sc1
  buffer_load_dwordx4 v[140:143], v61, s[4:7], s32 offen offset:2048 sc1
  buffer_load_dwordx4 v[144:147], v60, s[4:7], s32 offen offset:128 sc1
  buffer_load_dwordx4 v[148:151], v60, s[4:7], s32 offen offset:2176 sc1
  buffer_load_dwordx4 v[152:155], v61, s[4:7], s32 offen offset:128 sc1
  buffer_load_dwordx4 v[156:159], v61, s[4:7], s32 offen offset:2176 sc1
  buffer_load_dwordx4 v[160:163], v60, s[4:7], s33 offen offset:0 sc1
  buffer_load_dwordx4 v[164:167], v60, s[4:7], s33 offen offset:2048 sc1
  buffer_load_dwordx4 v[168:171], v61, s[4:7], s33 offen offset:0 sc1
  buffer_load_dwordx4 v[172:175], v61, s[4:7], s33 offen offset:2048 sc1
  buffer_load_dwordx4 v[176:179], v60, s[4:7], s33 offen offset:128 sc1
  buffer_load_dwordx4 v[180:183], v60, s[4:7], s33 offen offset:2176 sc1
  buffer_load_dwordx4 v[184:187], v61, s[4:7], s33 offen offset:128 sc1
  buffer_load_dwordx4 v[188:191], v61, s[4:7], s33 offen offset:2176 sc1
L_rocont_237:
  buffer_load_dword v25, v24, s[4:7], s38 offen sc1
  v_mov_b32 v28, 0
  v_mov_b32 v29, 0
  v_mov_b32 v30, 0
  v_mov_b32 v31, 0
  v_mov_b32 v32, 0
  v_mov_b32 v33, 0
  v_mov_b32 v34, 0
  v_mov_b32 v35, 0
  v_mov_b32 v36, 0
  v_mov_b32 v37, 0
  v_mov_b32 v38, 0
  v_mov_b32 v39, 0
  v_mov_b32 v40, 0
  v_mov_b32 v41, 0
  v_mov_b32 v42, 0
  v_mov_b32 v43, 0
  v_mov_b32 v44, 0
  v_mov_b32 v45, 0
  v_mov_b32 v46, 0
  v_mov_b32 v47, 0
  v_mov_b32 v48, 0
  v_mov_b32 v49, 0
  v_mov_b32 v50, 0
  v_mov_b32 v51, 0
  v_mov_b32 v52, 0
  v_mov_b32 v53, 0
  v_mov_b32 v54, 0
  v_mov_b32 v55, 0
  v_mov_b32 v56, 0
  v_mov_b32 v57, 0
  v_mov_b32 v58, 0
  v_mov_b32 v59, 0
  s_waitcnt vmcnt(0)
  s_mov_b32 s34, 0
  v_readlane_b32 s39, v25, 2
  s_nop 3
  s_cmp_lt_u32 s39, 8
  s_cbranch_scc1 L_rolate_240
  s_mov_b32 s32, 524288
  s_mov_b32 s33, 655360
  buffer_load_dwordx4 v[64:67], v60, s[4:7], s32 offen offset:0 sc1
  buffer_load_dwordx4 v[68:71], v60, s[4:7], s32 offen offset:2048 sc1
  buffer_load_dwordx4 v[72:75], v61, s[4:7], s32 offen offset:0 sc1
  buffer_load_dwordx4 v[76:79], v61, s[4:7], s32 offen offset:2048 sc1
  buffer_load_dwordx4 v[80:83], v60, s[4:7], s32 offen offset:128 sc1
  buffer_load_dwordx4 v[84:87], v60, s[4:7], s32 offen offset:2176 sc1
  buffer_load_dwordx4 v[88:91], v61, s[4:7], s32 offen offset:128 sc1
  buffer_load_dwordx4 v[92:95], v61, s[4:7], s32 offen offset:2176 sc1
  buffer_load_dwordx4 v[96:99], v60, s[4:7], s33 offen offset:0 sc1
  buffer_load_dwordx4 v[100:103], v60, s[4:7], s33 offen offset:2048 sc1
  buffer_load_dwordx4 v[104:107], v61, s[4:7], s33 offen offset:0 sc1
  buffer_load_dwordx4 v[108:111], v61, s[4:7], s33 offen offset:2048 sc1
  buffer_load_dwordx4 v[112:115], v60, s[4:7], s33 offen offset:128 sc1
  buffer_load_dwordx4 v[116:119], v60, s[4:7], s33 offen offset:2176 sc1
  buffer_load_dwordx4 v[120:123], v61, s[4:7], s33 offen offset:128 sc1
  buffer_load_dwordx4 v[124:127], v61, s[4:7], s33 offen offset:2176 sc1
  s_mov_b32 s34, 1
L_rolate_240:
  v_smfmac_f32_16x16x64_bf16 v[28:31], v[128:131], a[0:7], v4
  v_smfmac_f32_16x16x64_bf16 v[32:35], v[128:131], a[8:15], v4
  v_smfmac_f32_16x16x64_bf16 v[28:31], v[132:135], a[16:23], v4
  v_smfmac_f32_16x16x64_bf16 v[32:35], v[132:135], a[24:31], v4
  v_smfmac_f32_16x16x64_bf16 v[28:31], v[136:139], a[32:39], v4
  v_smfmac_f32_16x16x64_bf16 v[32:35], v[136:139], a[40:47], v4
  v_smfmac_f32_16x16x64_bf16 v[28:31], v[140:143], a[48:55], v4
  v_smfmac_f32_16x16x64_bf16 v[32:35], v[140:143], a[56:63], v4
  v_smfmac_f32_16x16x64_bf16 v[36:39], v[144:147], a[0:7], v4
  v_smfmac_f32_16x16x64_bf16 v[40:43], v[144:147], a[8:15], v4
  v_smfmac_f32_16x16x64_bf16 v[36:39], v[148:151], a[16:23], v4
  v_smfmac_f32_16x16x64_bf16 v[40:43], v[148:151], a[24:31], v4
  v_smfmac_f32_16x16x64_bf16 v[36:39], v[152:155], a[32:39], v4
  v_smfmac_f32_16x16x64_bf16 v[40:43], v[152:155], a[40:47], v4
  v_smfmac_f32_16x16x64_bf16 v[36:39], v[156:159], a[48:55], v4
  v_smfmac_f32_16x16x64_bf16 v[40:43], v[156:159], a[56:63], v4
  v_smfmac_f32_16x16x64_bf16 v[44:47], v[160:163], a[0:7], v4
  v_smfmac_f32_16x16x64_bf16 v[48:51], v[160:163], a[8:15], v4
  v_smfmac_f32_16x16x64_bf16 v[44:47], v[164:167], a[16:23], v4
  v_smfmac_f32_16x16x64_bf16 v[48:51], v[164:167], a[24:31], v4
  v_smfmac_f32_16x16x64_bf16 v[44:47], v[168:171], a[32:39], v4
  v_smfmac_f32_16x16x64_bf16 v[48:51], v[168:171], a[40:47], v4
  v_smfmac_f32_16x16x64_bf16 v[44:47], v[172:175], a[48:55], v4
  v_smfmac_f32_16x16x64_bf16 v[48:51], v[172:175], a[56:63], v4
  v_smfmac_f32_16x16x64_bf16 v[52:55], v[176:179], a[0:7], v4
  v_smfmac_f32_16x16x64_bf16 v[56:59], v[176:179], a[8:15], v4
  v_smfmac_f32_16x16x64_bf16 v[52:55], v[180:183], a[16:23], v4
  v_smfmac_f32_16x16x64_bf16 v[56:59], v[180:183], a[24:31], v4
  v_smfmac_f32_16x16x64_bf16 v[52:55], v[184:187], a[32:39], v4
  v_smfmac_f32_16x16x64_bf16 v[56:59], v[184:187], a[40:47], v4
  v_smfmac_f32_16x16x64_bf16 v[52:55], v[188:191], a[48:55], v4
  v_smfmac_f32_16x16x64_bf16 v[56:59], v[188:191], a[56:63], v4
  v_permlane32_swap_b32 v28, v32
  v_permlane32_swap_b32 v29, v33
  v_permlane32_swap_b32 v30, v34
  v_permlane32_swap_b32 v31, v35
  v_pk_add_f32 v[28:29], v[28:29], v[32:33]
  v_pk_add_f32 v[30:31], v[30:31], v[34:35]
  ds_write2_b32 v16, v28, v29 offset0:0 offset1:36
  ds_write2_b32 v16, v30, v31 offset0:72 offset1:108
  v_permlane32_swap_b32 v36, v40
  v_permlane32_swap_b32 v37, v41
  v_permlane32_swap_b32 v38, v42
  v_permlane32_swap_b32 v39, v43
  v_pk_add_f32 v[36:37], v[36:37], v[40:41]
  v_pk_add_f32 v[38:39], v[38:39], v[42:43]
  ds_write2_b32 v17, v36, v37 offset0:0 offset1:36
  ds_write2_b32 v17, v38, v39 offset0:72 offset1:108
  v_permlane32_swap_b32 v44, v48
  v_permlane32_swap_b32 v45, v49
  v_permlane32_swap_b32 v46, v50
  v_permlane32_swap_b32 v47, v51
  v_pk_add_f32 v[44:45], v[44:45], v[48:49]
  v_pk_add_f32 v[46:47], v[46:47], v[50:51]
  ds_write2_b32 v18, v44, v45 offset0:0 offset1:36
  ds_write2_b32 v18, v46, v47 offset0:72 offset1:108
  s_nop 7
  v_permlane32_swap_b32 v52, v56
  v_permlane32_swap_b32 v53, v57
  v_permlane32_swap_b32 v54, v58
  v_permlane32_swap_b32 v55, v59
  v_pk_add_f32 v[52:53], v[52:53], v[56:57]
  v_pk_add_f32 v[54:55], v[54:55], v[58:59]
  ds_write2_b32 v19, v52, v53 offset0:0 offset1:36
  ds_write2_b32 v19, v54, v55 offset0:72 offset1:108
  s_waitcnt lgkmcnt(0)
  s_barrier
  s_cmp_lg_u32 s34, 0
  s_cbranch_scc1 L_rocont_241
  s_add_u32 s40, s38, 1024
  v_mov_b32 v8, 0
  s_mov_b32 s41, 0x8
L_poll_242:
  buffer_load_dword v6, v8, s[4:7], s40 offen sc1
  s_waitcnt vmcnt(0)
  v_cmp_le_u32 vcc, s41, v6
  s_cbranch_vccnz L_pollok_243
  s_sleep 1
  s_add_u32 s31, s31, 1
  s_cmp_lt_u32 s31, 1048576
  s_cbranch_scc1 L_poll_242
  s_branch L_abort
L_pollok_243:
  s_mov_b32 s32, 524288
  s_mov_b32 s33, 655360
  buffer_load_dwordx4 v[64:67], v60, s[4:7], s32 offen offset:0 sc1
  buffer_load_dwordx4 v[68:71], v60, s[4:7], s32 offen offset:2048 sc1
  buffer_load_dwordx4 v[72:75], v61, s[4:7], s32 offen offset:0 sc1
  buffer_load_dwordx4 v[76:79], v61, s[4:7], s32 offen offset:2048 sc1
  buffer_load_dwordx4 v[80:83], v60, s[4:7], s32 offen offset:128 sc1
  buffer_load_dwordx4 v[84:87], v60, s[4:7], s32 offen offset:2176 sc1
  buffer_load_dwordx4 v[88:91], v61, s[4:7], s32 offen offset:128 sc1
  buffer_load_dwordx4 v[92:95], v61, s[4:7], s32 offen offset:2176 sc1
  buffer_load_dwordx4 v[96:99], v60, s[4:7], s33 offen offset:0 sc1
  buffer_load_dwordx4 v[100:103], v60, s[4:7], s33 offen offset:2048 sc1
  buffer_load_dwordx4 v[104:107], v61, s[4:7], s33 offen offset:0 sc1
  buffer_load_dwordx4 v[108:111], v61, s[4:7], s33 offen offset:2048 sc1
  buffer_load_dwordx4 v[112:115], v60, s[4:7], s33 offen offset:128 sc1
  buffer_load_dwordx4 v[116:119], v60, s[4:7], s33 offen offset:2176 sc1
  buffer_load_dwordx4 v[120:123], v61, s[4:7], s33 offen offset:128 sc1
  buffer_load_dwordx4 v[124:127], v61, s[4:7], s33 offen offset:2176 sc1
L_rocont_241:
  buffer_load_dword v25, v24, s[4:7], s38 offen sc1
  v_mov_b32 v28, 0
  v_mov_b32 v29, 0
  v_mov_b32 v30, 0
  v_mov_b32 v31, 0
  v_mov_b32 v32, 0
  v_mov_b32 v33, 0
  v_mov_b32 v34, 0
  v_mov_b32 v35, 0
  v_mov_b32 v36, 0
  v_mov_b32 v37, 0
  v_mov_b32 v38, 0
  v_mov_b32 v39, 0
  v_mov_b32 v40, 0
  v_mov_b32 v41, 0
  v_mov_b32 v42, 0
  v_mov_b32 v43, 0
  v_mov_b32 v44, 0
  v_mov_b32 v45, 0
  v_mov_b32 v46, 0
  v_mov_b32 v47, 0
  v_mov_b32 v48, 0
  v_mov_b32 v49, 0
  v_mov_b32 v50, 0
  v_mov_b32 v51, 0
  v_mov_b32 v52, 0
  v_mov_b32 v53, 0
  v_mov_b32 v54, 0
  v_mov_b32 v55, 0
  v_mov_b32 v56, 0
  v_mov_b32 v57, 0
  v_mov_b32 v58, 0
  v_mov_b32 v59, 0
  s_waitcnt vmcnt(0)
  s_mov_b32 s34, 0
  v_readlane_b32 s39, v25, 3
  s_nop 3
  s_cmp_lt_u32 s39, 8
  s_cbranch_scc1 L_rolate_244
  s_mov_b32 s32, 786432
  s_mov_b32 s33, 917504
  buffer_load_dwordx4 v[128:131], v60, s[4:7], s32 offen offset:0 sc1
  buffer_load_dwordx4 v[132:135], v60, s[4:7], s32 offen offset:2048 sc1
  buffer_load_dwordx4 v[136:139], v61, s[4:7], s32 offen offset:0 sc1
  buffer_load_dwordx4 v[140:143], v61, s[4:7], s32 offen offset:2048 sc1
  buffer_load_dwordx4 v[144:147], v60, s[4:7], s32 offen offset:128 sc1
  buffer_load_dwordx4 v[148:151], v60, s[4:7], s32 offen offset:2176 sc1
  buffer_load_dwordx4 v[152:155], v61, s[4:7], s32 offen offset:128 sc1
  buffer_load_dwordx4 v[156:159], v61, s[4:7], s32 offen offset:2176 sc1
  buffer_load_dwordx4 v[160:163], v60, s[4:7], s33 offen offset:0 sc1
  buffer_load_dwordx4 v[164:167], v60, s[4:7], s33 offen offset:2048 sc1
  buffer_load_dwordx4 v[168:171], v61, s[4:7], s33 offen offset:0 sc1
  buffer_load_dwordx4 v[172:175], v61, s[4:7], s33 offen offset:2048 sc1
  buffer_load_dwordx4 v[176:179], v60, s[4:7], s33 offen offset:128 sc1
  buffer_load_dwordx4 v[180:183], v60, s[4:7], s33 offen offset:2176 sc1
  buffer_load_dwordx4 v[184:187], v61, s[4:7], s33 offen offset:128 sc1
  buffer_load_dwordx4 v[188:191], v61, s[4:7], s33 offen offset:2176 sc1
  s_mov_b32 s34, 1
L_rolate_244:
  v_smfmac_f32_16x16x64_bf16 v[28:31], v[64:67], a[0:7], v4
  v_smfmac_f32_16x16x64_bf16 v[32:35], v[64:67], a[8:15], v4
  v_smfmac_f32_16x16x64_bf16 v[28:31], v[68:71], a[16:23], v4
  v_smfmac_f32_16x16x64_bf16 v[32:35], v[68:71], a[24:31], v4
  v_smfmac_f32_16x16x64_bf16 v[28:31], v[72:75], a[32:39], v4
  v_smfmac_f32_16x16x64_bf16 v[32:35], v[72:75], a[40:47], v4
  v_smfmac_f32_16x16x64_bf16 v[28:31], v[76:79], a[48:55], v4
  v_smfmac_f32_16x16x64_bf16 v[32:35], v[76:79], a[56:63], v4
  v_smfmac_f32_16x16x64_bf16 v[36:39], v[80:83], a[0:7], v4
  v_smfmac_f32_16x16x64_bf16 v[40:43], v[80:83], a[8:15], v4
  v_smfmac_f32_16x16x64_bf16 v[36:39], v[84:87], a[16:23], v4
  v_smfmac_f32_16x16x64_bf16 v[40:43], v[84:87], a[24:31], v4
  v_smfmac_f32_16x16x64_bf16 v[36:39], v[88:91], a[32:39], v4
  v_smfmac_f32_16x16x64_bf16 v[40:43], v[88:91], a[40:47], v4
  v_smfmac_f32_16x16x64_bf16 v[36:39], v[92:95], a[48:55], v4
  v_smfmac_f32_16x16x64_bf16 v[40:43], v[92:95], a[56:63], v4
  v_smfmac_f32_16x16x64_bf16 v[44:47], v[96:99], a[0:7], v4
  v_smfmac_f32_16x16x64_bf16 v[48:51], v[96:99], a[8:15], v4
  v_smfmac_f32_16x16x64_bf16 v[44:47], v[100:103], a[16:23], v4
  v_smfmac_f32_16x16x64_bf16 v[48:51], v[100:103], a[24:31], v4
  v_smfmac_f32_16x16x64_bf16 v[44:47], v[104:107], a[32:39], v4
  v_smfmac_f32_16x16x64_bf16 v[48:51], v[104:107], a[40:47], v4
  v_smfmac_f32_16x16x64_bf16 v[44:47], v[108:111], a[48:55], v4
  v_smfmac_f32_16x16x64_bf16 v[48:51], v[108:111], a[56:63], v4
  v_smfmac_f32_16x16x64_bf16 v[52:55], v[112:115], a[0:7], v4
  v_smfmac_f32_16x16x64_bf16 v[56:59], v[112:115], a[8:15], v4
  v_smfmac_f32_16x16x64_bf16 v[52:55], v[116:119], a[16:23], v4
  v_smfmac_f32_16x16x64_bf16 v[56:59], v[116:119], a[24:31], v4
  v_smfmac_f32_16x16x64_bf16 v[52:55], v[120:123], a[32:39], v4
  v_smfmac_f32_16x16x64_bf16 v[56:59], v[120:123], a[40:47], v4
  v_smfmac_f32_16x16x64_bf16 v[52:55], v[124:127], a[48:55], v4
  v_smfmac_f32_16x16x64_bf16 v[56:59], v[124:127], a[56:63], v4
  v_permlane32_swap_b32 v28, v32
  v_permlane32_swap_b32 v29, v33
  v_permlane32_swap_b32 v30, v34
  v_permlane32_swap_b32 v31, v35
  v_pk_add_f32 v[28:29], v[28:29], v[32:33]
  v_pk_add_f32 v[30:31], v[30:31], v[34:35]
  ds_write2_b32 v12, v28, v29 offset0:0 offset1:36
  ds_write2_b32 v12, v30, v31 offset0:72 offset1:108
  v_permlane32_swap_b32 v36, v40
  v_permlane32_swap_b32 v37, v41
  v_permlane32_swap_b32 v38, v42
  v_permlane32_swap_b32 v39, v43
  v_pk_add_f32 v[36:37], v[36:37], v[40:41]
  v_pk_add_f32 v[38:39], v[38:39], v[42:43]
  ds_write2_b32 v13, v36, v37 offset0:0 offset1:36
  ds_write2_b32 v13, v38, v39 offset0:72 offset1:108
  v_permlane32_swap_b32 v44, v48
  v_permlane32_swap_b32 v45, v49
  v_permlane32_swap_b32 v46, v50
  v_permlane32_swap_b32 v47, v51
  v_pk_add_f32 v[44:45], v[44:45], v[48:49]
  v_pk_add_f32 v[46:47], v[46:47], v[50:51]
  ds_write2_b32 v14, v44, v45 offset0:0 offset1:36
  ds_write2_b32 v14, v46, v47 offset0:72 offset1:108
  s_nop 7
  v_permlane32_swap_b32 v52, v56
  v_permlane32_swap_b32 v53, v57
  v_permlane32_swap_b32 v54, v58
  v_permlane32_swap_b32 v55, v59
  v_pk_add_f32 v[52:53], v[52:53], v[56:57]
  v_pk_add_f32 v[54:55], v[54:55], v[58:59]
  ds_write2_b32 v15, v52, v53 offset0:0 offset1:36
  ds_write2_b32 v15, v54, v55 offset0:72 offset1:108
  s_waitcnt lgkmcnt(0)
  s_barrier
  s_cmp_lg_u32 s34, 0
  s_cbranch_scc1 L_rocont_245
  s_add_u32 s40, s38, 1536
  v_mov_b32 v8, 0
  s_mov_b32 s41, 0x8
L_poll_246:
  buffer_load_dword v6, v8, s[4:7], s40 offen sc1
  s_waitcnt vmcnt(0)
  v_cmp_le_u32 vcc, s41, v6
  s_cbranch_vccnz L_pollok_247
  s_sleep 1
  s_add_u32 s31, s31, 1
  s_cmp_lt_u32 s31, 1048576
  s_cbranch_scc1 L_poll_246
  s_branch L_abort
L_pollok_247:
  s_mov_b32 s32, 786432
  s_mov_b32 s33, 917504
  buffer_load_dwordx4 v[128:131], v60, s[4:7], s32 offen offset:0 sc1
  buffer_load_dwordx4 v[132:135], v60, s[4:7], s32 offen offset:2048 sc1
  buffer_load_dwordx4 v[136:139], v61, s[4:7], s32 offen offset:0 sc1
  buffer_load_dwordx4 v[140:143], v61, s[4:7], s32 offen offset:2048 sc1
  buffer_load_dwordx4 v[144:147], v60, s[4:7], s32 offen offset:128 sc1
  buffer_load_dwordx4 v[148:151], v60, s[4:7], s32 offen offset:2176 sc1
  buffer_load_dwordx4 v[152:155], v61, s[4:7], s32 offen offset:128 sc1
  buffer_load_dwordx4 v[156:159], v61, s[4:7], s32 offen offset:2176 sc1
  buffer_load_dwordx4 v[160:163], v60, s[4:7], s33 offen offset:0 sc1
  buffer_load_dwordx4 v[164:167], v60, s[4:7], s33 offen offset:2048 sc1
  buffer_load_dwordx4 v[168:171], v61, s[4:7], s33 offen offset:0 sc1
  buffer_load_dwordx4 v[172:175], v61, s[4:7], s33 offen offset:2048 sc1
  buffer_load_dwordx4 v[176:179], v60, s[4:7], s33 offen offset:128 sc1
  buffer_load_dwordx4 v[180:183], v60, s[4:7], s33 offen offset:2176 sc1
  buffer_load_dwordx4 v[184:187], v61, s[4:7], s33 offen offset:128 sc1
  buffer_load_dwordx4 v[188:191], v61, s[4:7], s33 offen offset:2176 sc1
L_rocont_245:
  buffer_load_dword v25, v24, s[4:7], s38 offen sc1
  v_mov_b32 v28, 0
  v_mov_b32 v29, 0
  v_mov_b32 v30, 0
  v_mov_b32 v31, 0
  v_mov_b32 v32, 0
  v_mov_b32 v33, 0
  v_mov_b32 v34, 0
  v_mov_b32 v35, 0
  v_mov_b32 v36, 0
  v_mov_b32 v37, 0
  v_mov_b32 v38, 0
  v_mov_b32 v39, 0
  v_mov_b32 v40, 0
  v_mov_b32 v41, 0
  v_mov_b32 v42, 0
  v_mov_b32 v43, 0
  v_mov_b32 v44, 0
  v_mov_b32 v45, 0
  v_mov_b32 v46, 0
  v_mov_b32 v47, 0
  v_mov_b32 v48, 0
  v_mov_b32 v49, 0
  v_mov_b32 v50, 0
  v_mov_b32 v51, 0
  v_mov_b32 v52, 0
  v_mov_b32 v53, 0
  v_mov_b32 v54, 0
  v_mov_b32 v55, 0
  v_mov_b32 v56, 0
  v_mov_b32 v57, 0
  v_mov_b32 v58, 0
  v_mov_b32 v59, 0
  s_waitcnt vmcnt(0)
  s_mov_b32 s34, 0
  v_readlane_b32 s39, v25, 4
  s_nop 3
  s_cmp_lt_u32 s39, 8
  s_cbranch_scc1 L_rolate_248
  s_mov_b32 s32, 1048576
  s_mov_b32 s33, 1179648
  buffer_load_dwordx4 v[64:67], v60, s[4:7], s32 offen offset:0 sc1
  buffer_load_dwordx4 v[68:71], v60, s[4:7], s32 offen offset:2048 sc1
  buffer_load_dwordx4 v[72:75], v61, s[4:7], s32 offen offset:0 sc1
  buffer_load_dwordx4 v[76:79], v61, s[4:7], s32 offen offset:2048 sc1
  buffer_load_dwordx4 v[80:83], v60, s[4:7], s32 offen offset:128 sc1
  buffer_load_dwordx4 v[84:87], v60, s[4:7], s32 offen offset:2176 sc1
  buffer_load_dwordx4 v[88:91], v61, s[4:7], s32 offen offset:128 sc1
  buffer_load_dwordx4 v[92:95], v61, s[4:7], s32 offen offset:2176 sc1
  buffer_load_dwordx4 v[96:99], v60, s[4:7], s33 offen offset:0 sc1
  buffer_load_dwordx4 v[100:103], v60, s[4:7], s33 offen offset:2048 sc1
  buffer_load_dwordx4 v[104:107], v61, s[4:7], s33 offen offset:0 sc1
  buffer_load_dwordx4 v[108:111], v61, s[4:7], s33 offen offset:2048 sc1
  buffer_load_dwordx4 v[112:115], v60, s[4:7], s33 offen offset:128 sc1
  buffer_load_dwordx4 v[116:119], v60, s[4:7], s33 offen offset:2176 sc1
  buffer_load_dwordx4 v[120:123], v61, s[4:7], s33 offen offset:128 sc1
  buffer_load_dwordx4 v[124:127], v61, s[4:7], s33 offen offset:2176 sc1
  s_mov_b32 s34, 1
L_rolate_248:
  v_smfmac_f32_16x16x64_bf16 v[28:31], v[128:131], a[0:7], v4
  v_smfmac_f32_16x16x64_bf16 v[32:35], v[128:131], a[8:15], v4
  v_smfmac_f32_16x16x64_bf16 v[28:31], v[132:135], a[16:23], v4
  v_smfmac_f32_16x16x64_bf16 v[32:35], v[132:135], a[24:31], v4
  v_smfmac_f32_16x16x64_bf16 v[28:31], v[136:139], a[32:39], v4
  v_smfmac_f32_16x16x64_bf16 v[32:35], v[136:139], a[40:47], v4
  v_smfmac_f32_16x16x64_bf16 v[28:31], v[140:143], a[48:55], v4
  v_smfmac_f32_16x16x64_bf16 v[32:35], v[140:143], a[56:63], v4
  v_smfmac_f32_16x16x64_bf16 v[36:39], v[144:147], a[0:7], v4
  v_smfmac_f32_16x16x64_bf16 v[40:43], v[144:147], a[8:15], v4
  v_smfmac_f32_16x16x64_bf16 v[36:39], v[148:151], a[16:23], v4
  v_smfmac_f32_16x16x64_bf16 v[40:43], v[148:151], a[24:31], v4
  v_smfmac_f32_16x16x64_bf16 v[36:39], v[152:155], a[32:39], v4
  v_smfmac_f32_16x16x64_bf16 v[40:43], v[152:155], a[40:47], v4
  v_smfmac_f32_16x16x64_bf16 v[36:39], v[156:159], a[48:55], v4
  v_smfmac_f32_16x16x64_bf16 v[40:43], v[156:159], a[56:63], v4
  v_smfmac_f32_16x16x64_bf16 v[44:47], v[160:163], a[0:7], v4
  v_smfmac_f32_16x16x64_bf16 v[48:51], v[160:163], a[8:15], v4
  v_smfmac_f32_16x16x64_bf16 v[44:47], v[164:167], a[16:23], v4
  v_smfmac_f32_16x16x64_bf16 v[48:51], v[164:167], a[24:31], v4
  v_smfmac_f32_16x16x64_bf16 v[44:47], v[168:171], a[32:39], v4
  v_smfmac_f32_16x16x64_bf16 v[48:51], v[168:171], a[40:47], v4
  v_smfmac_f32_16x16x64_bf16 v[44:47], v[172:175], a[48:55], v4
  v_smfmac_f32_16x16x64_bf16 v[48:51], v[172:175], a[56:63], v4
  v_smfmac_f32_16x16x64_bf16 v[52:55], v[176:179], a[0:7], v4
  v_smfmac_f32_16x16x64_bf16 v[56:59], v[176:179], a[8:15], v4
  v_smfmac_f32_16x16x64_bf16 v[52:55], v[180:183], a[16:23], v4
  v_smfmac_f32_16x16x64_bf16 v[56:59], v[180:183], a[24:31], v4
  v_smfmac_f32_16x16x64_bf16 v[52:55], v[184:187], a[32:39], v4
  v_smfmac_f32_16x16x64_bf16 v[56:59], v[184:187], a[40:47], v4
  v_smfmac_f32_16x16x64_bf16 v[52:55], v[188:191], a[48:55], v4
  v_smfmac_f32_16x16x64_bf16 v[56:59], v[188:191], a[56:63], v4
  v_permlane32_swap_b32 v28, v32
  v_permlane32_swap_b32 v29, v33
  v_permlane32_swap_b32 v30, v34
  v_permlane32_swap_b32 v31, v35
  v_pk_add_f32 v[28:29], v[28:29], v[32:33]
  v_pk_add_f32 v[30:31], v[30:31], v[34:35]
  ds_write2_b32 v16, v28, v29 offset0:0 offset1:36
  ds_write2_b32 v16, v30, v31 offset0:72 offset1:108
  v_permlane32_swap_b32 v36, v40
  v_permlane32_swap_b32 v37, v41
  v_permlane32_swap_b32 v38, v42
  v_permlane32_swap_b32 v39, v43
  v_pk_add_f32 v[36:37], v[36:37], v[40:41]
  v_pk_add_f32 v[38:39], v[38:39], v[42:43]
  ds_write2_b32 v17, v36, v37 offset0:0 offset1:36
  ds_write2_b32 v17, v38, v39 offset0:72 offset1:108
  v_permlane32_swap_b32 v44, v48
  v_permlane32_swap_b32 v45, v49
  v_permlane32_swap_b32 v46, v50
  v_permlane32_swap_b32 v47, v51
  v_pk_add_f32 v[44:45], v[44:45], v[48:49]
  v_pk_add_f32 v[46:47], v[46:47], v[50:51]
  ds_write2_b32 v18, v44, v45 offset0:0 offset1:36
  ds_write2_b32 v18, v46, v47 offset0:72 offset1:108
  s_nop 7
  v_permlane32_swap_b32 v52, v56
  v_permlane32_swap_b32 v53, v57
  v_permlane32_swap_b32 v54, v58
  v_permlane32_swap_b32 v55, v59
  v_pk_add_f32 v[52:53], v[52:53], v[56:57]
  v_pk_add_f32 v[54:55], v[54:55], v[58:59]
  ds_write2_b32 v19, v52, v53 offset0:0 offset1:36
  ds_write2_b32 v19, v54, v55 offset0:72 offset1:108
  s_waitcnt lgkmcnt(0)
  s_barrier
  s_cmp_lg_u32 s34, 0
  s_cbranch_scc1 L_rocont_249
  s_add_u32 s40, s38, 2048
  v_mov_b32 v8, 0
  s_mov_b32 s41, 0x8
L_poll_250:
  buffer_load_dword v6, v8, s[4:7], s40 offen sc1
  s_waitcnt vmcnt(0)
  v_cmp_le_u32 vcc, s41, v6
  s_cbranch_vccnz L_pollok_251
  s_sleep 1
  s_add_u32 s31, s31, 1
  s_cmp_lt_u32 s31, 1048576
  s_cbranch_scc1 L_poll_250
  s_branch L_abort
L_pollok_251:
  s_mov_b32 s32, 1048576
  s_mov_b32 s33, 1179648
  buffer_load_dwordx4 v[64:67], v60, s[4:7], s32 offen offset:0 sc1
  buffer_load_dwordx4 v[68:71], v60, s[4:7], s32 offen offset:2048 sc1
  buffer_load_dwordx4 v[72:75], v61, s[4:7], s32 offen offset:0 sc1
  buffer_load_dwordx4 v[76:79], v61, s[4:7], s32 offen offset:2048 sc1
  buffer_load_dwordx4 v[80:83], v60, s[4:7], s32 offen offset:128 sc1
  buffer_load_dwordx4 v[84:87], v60, s[4:7], s32 offen offset:2176 sc1
  buffer_load_dwordx4 v[88:91], v61, s[4:7], s32 offen offset:128 sc1
  buffer_load_dwordx4 v[92:95], v61, s[4:7], s32 offen offset:2176 sc1
  buffer_load_dwordx4 v[96:99], v60, s[4:7], s33 offen offset:0 sc1
  buffer_load_dwordx4 v[100:103], v60, s[4:7], s33 offen offset:2048 sc1
  buffer_load_dwordx4 v[104:107], v61, s[4:7], s33 offen offset:0 sc1
  buffer_load_dwordx4 v[108:111], v61, s[4:7], s33 offen offset:2048 sc1
  buffer_load_dwordx4 v[112:115], v60, s[4:7], s33 offen offset:128 sc1
  buffer_load_dwordx4 v[116:119], v60, s[4:7], s33 offen offset:2176 sc1
  buffer_load_dwordx4 v[120:123], v61, s[4:7], s33 offen offset:128 sc1
  buffer_load_dwordx4 v[124:127], v61, s[4:7], s33 offen offset:2176 sc1
L_rocont_249:
  buffer_load_dword v25, v24, s[4:7], s38 offen sc1
  v_mov_b32 v28, 0
  v_mov_b32 v29, 0
  v_mov_b32 v30, 0
  v_mov_b32 v31, 0
  v_mov_b32 v32, 0
  v_mov_b32 v33, 0
  v_mov_b32 v34, 0
  v_mov_b32 v35, 0
  v_mov_b32 v36, 0
  v_mov_b32 v37, 0
  v_mov_b32 v38, 0
  v_mov_b32 v39, 0
  v_mov_b32 v40, 0
  v_mov_b32 v41, 0
  v_mov_b32 v42, 0
  v_mov_b32 v43, 0
  v_mov_b32 v44, 0
  v_mov_b32 v45, 0
  v_mov_b32 v46, 0
  v_mov_b32 v47, 0
  v_mov_b32 v48, 0
  v_mov_b32 v49, 0
  v_mov_b32 v50, 0
  v_mov_b32 v51, 0
  v_mov_b32 v52, 0
  v_mov_b32 v53, 0
  v_mov_b32 v54, 0
  v_mov_b32 v55, 0
  v_mov_b32 v56, 0
  v_mov_b32 v57, 0
  v_mov_b32 v58, 0
  v_mov_b32 v59, 0
  s_waitcnt vmcnt(0)
  s_mov_b32 s34, 0
  v_readlane_b32 s39, v25, 5
  s_nop 3
  s_cmp_lt_u32 s39, 8
  s_cbranch_scc1 L_rolate_252
  s_mov_b32 s32, 1310720
  s_mov_b32 s33, 1441792
  buffer_load_dwordx4 v[128:131], v60, s[4:7], s32 offen offset:0 sc1
  buffer_load_dwordx4 v[132:135], v60, s[4:7], s32 offen offset:2048 sc1
  buffer_load_dwordx4 v[136:139], v61, s[4:7], s32 offen offset:0 sc1
  buffer_load_dwordx4 v[140:143], v61, s[4:7], s32 offen offset:2048 sc1
  buffer_load_dwordx4 v[144:147], v60, s[4:7], s32 offen offset:128 sc1
  buffer_load_dwordx4 v[148:151], v60, s[4:7], s32 offen offset:2176 sc1
  buffer_load_dwordx4 v[152:155], v61, s[4:7], s32 offen offset:128 sc1
  buffer_load_dwordx4 v[156:159], v61, s[4:7], s32 offen offset:2176 sc1
  buffer_load_dwordx4 v[160:163], v60, s[4:7], s33 offen offset:0 sc1
  buffer_load_dwordx4 v[164:167], v60, s[4:7], s33 offen offset:2048 sc1
  buffer_load_dwordx4 v[168:171], v61, s[4:7], s33 offen offset:0 sc1
  buffer_load_dwordx4 v[172:175], v61, s[4:7], s33 offen offset:2048 sc1
  buffer_load_dwordx4 v[176:179], v60, s[4:7], s33 offen offset:128 sc1
  buffer_load_dwordx4 v[180:183], v60, s[4:7], s33 offen offset:2176 sc1
  buffer_load_dwordx4 v[184:187], v61, s[4:7], s33 offen offset:128 sc1
  buffer_load_dwordx4 v[188:191], v61, s[4:7], s33 offen offset:2176 sc1
  s_mov_b32 s34, 1
L_rolate_252:
  v_smfmac_f32_16x16x64_bf16 v[28:31], v[64:67], a[0:7], v4
  v_smfmac_f32_16x16x64_bf16 v[32:35], v[64:67], a[8:15], v4
  v_smfmac_f32_16x16x64_bf16 v[28:31], v[68:71], a[16:23], v4
  v_smfmac_f32_16x16x64_bf16 v[32:35], v[68:71], a[24:31], v4
  v_smfmac_f32_16x16x64_bf16 v[28:31], v[72:75], a[32:39], v4
  v_smfmac_f32_16x16x64_bf16 v[32:35], v[72:75], a[40:47], v4
  v_smfmac_f32_16x16x64_bf16 v[28:31], v[76:79], a[48:55], v4
  v_smfmac_f32_16x16x64_bf16 v[32:35], v[76:79], a[56:63], v4
  v_smfmac_f32_16x16x64_bf16 v[36:39], v[80:83], a[0:7], v4
  v_smfmac_f32_16x16x64_bf16 v[40:43], v[80:83], a[8:15], v4
  v_smfmac_f32_16x16x64_bf16 v[36:39], v[84:87], a[16:23], v4
  v_smfmac_f32_16x16x64_bf16 v[40:43], v[84:87], a[24:31], v4
  v_smfmac_f32_16x16x64_bf16 v[36:39], v[88:91], a[32:39], v4
  v_smfmac_f32_16x16x64_bf16 v[40:43], v[88:91], a[40:47], v4
  v_smfmac_f32_16x16x64_bf16 v[36:39], v[92:95], a[48:55], v4
  v_smfmac_f32_16x16x64_bf16 v[40:43], v[92:95], a[56:63], v4
  v_smfmac_f32_16x16x64_bf16 v[44:47], v[96:99], a[0:7], v4
  v_smfmac_f32_16x16x64_bf16 v[48:51], v[96:99], a[8:15], v4
  v_smfmac_f32_16x16x64_bf16 v[44:47], v[100:103], a[16:23], v4
  v_smfmac_f32_16x16x64_bf16 v[48:51], v[100:103], a[24:31], v4
  v_smfmac_f32_16x16x64_bf16 v[44:47], v[104:107], a[32:39], v4
  v_smfmac_f32_16x16x64_bf16 v[48:51], v[104:107], a[40:47], v4
  v_smfmac_f32_16x16x64_bf16 v[44:47], v[108:111], a[48:55], v4
  v_smfmac_f32_16x16x64_bf16 v[48:51], v[108:111], a[56:63], v4
  v_smfmac_f32_16x16x64_bf16 v[52:55], v[112:115], a[0:7], v4
  v_smfmac_f32_16x16x64_bf16 v[56:59], v[112:115], a[8:15], v4
  v_smfmac_f32_16x16x64_bf16 v[52:55], v[116:119], a[16:23], v4
  v_smfmac_f32_16x16x64_bf16 v[56:59], v[116:119], a[24:31], v4
  v_smfmac_f32_16x16x64_bf16 v[52:55], v[120:123], a[32:39], v4
  v_smfmac_f32_16x16x64_bf16 v[56:59], v[120:123], a[40:47], v4
  v_smfmac_f32_16x16x64_bf16 v[52:55], v[124:127], a[48:55], v4
  v_smfmac_f32_16x16x64_bf16 v[56:59], v[124:127], a[56:63], v4
  v_permlane32_swap_b32 v28, v32
  v_permlane32_swap_b32 v29, v33
  v_permlane32_swap_b32 v30, v34
  v_permlane32_swap_b32 v31, v35
  v_pk_add_f32 v[28:29], v[28:29], v[32:33]
  v_pk_add_f32 v[30:31], v[30:31], v[34:35]
  ds_write2_b32 v12, v28, v29 offset0:0 offset1:36
  ds_write2_b32 v12, v30, v31 offset0:72 offset1:108
  v_permlane32_swap_b32 v36, v40
  v_permlane32_swap_b32 v37, v41
  v_permlane32_swap_b32 v38, v42
  v_permlane32_swap_b32 v39, v43
  v_pk_add_f32 v[36:37], v[36:37], v[40:41]
  v_pk_add_f32 v[38:39], v[38:39], v[42:43]
  ds_write2_b32 v13, v36, v37 offset0:0 offset1:36
  ds_write2_b32 v13, v38, v39 offset0:72 offset1:108
  v_permlane32_swap_b32 v44, v48
  v_permlane32_swap_b32 v45, v49
  v_permlane32_swap_b32 v46, v50
  v_permlane32_swap_b32 v47, v51
  v_pk_add_f32 v[44:45], v[44:45], v[48:49]
  v_pk_add_f32 v[46:47], v[46:47], v[50:51]
  ds_write2_b32 v14, v44, v45 offset0:0 offset1:36
  ds_write2_b32 v14, v46, v47 offset0:72 offset1:108
  s_nop 7
  v_permlane32_swap_b32 v52, v56
  v_permlane32_swap_b32 v53, v57
  v_permlane32_swap_b32 v54, v58
  v_permlane32_swap_b32 v55, v59
  v_pk_add_f32 v[52:53], v[52:53], v[56:57]
  v_pk_add_f32 v[54:55], v[54:55], v[58:59]
  ds_write2_b32 v15, v52, v53 offset0:0 offset1:36
  ds_write2_b32 v15, v54, v55 offset0:72 offset1:108
  s_waitcnt lgkmcnt(0)
  s_barrier
  s_cmp_lg_u32 s34, 0
  s_cbranch_scc1 L_rocont_253
  s_add_u32 s40, s38, 2560
  v_mov_b32 v8, 0
  s_mov_b32 s41, 0x8
L_poll_254:
  buffer_load_dword v6, v8, s[4:7], s40 offen sc1
  s_waitcnt vmcnt(0)
  v_cmp_le_u32 vcc, s41, v6
  s_cbranch_vccnz L_pollok_255
  s_sleep 1
  s_add_u32 s31, s31, 1
  s_cmp_lt_u32 s31, 1048576
  s_cbranch_scc1 L_poll_254
  s_branch L_abort
L_pollok_255:
  s_mov_b32 s32, 1310720
  s_mov_b32 s33, 1441792
  buffer_load_dwordx4 v[128:131], v60, s[4:7], s32 offen offset:0 sc1
  buffer_load_dwordx4 v[132:135], v60, s[4:7], s32 offen offset:2048 sc1
  buffer_load_dwordx4 v[136:139], v61, s[4:7], s32 offen offset:0 sc1
  buffer_load_dwordx4 v[140:143], v61, s[4:7], s32 offen offset:2048 sc1
  buffer_load_dwordx4 v[144:147], v60, s[4:7], s32 offen offset:128 sc1
  buffer_load_dwordx4 v[148:151], v60, s[4:7], s32 offen offset:2176 sc1
  buffer_load_dwordx4 v[152:155], v61, s[4:7], s32 offen offset:128 sc1
  buffer_load_dwordx4 v[156:159], v61, s[4:7], s32 offen offset:2176 sc1
  buffer_load_dwordx4 v[160:163], v60, s[4:7], s33 offen offset:0 sc1
  buffer_load_dwordx4 v[164:167], v60, s[4:7], s33 offen offset:2048 sc1
  buffer_load_dwordx4 v[168:171], v61, s[4:7], s33 offen offset:0 sc1
  buffer_load_dwordx4 v[172:175], v61, s[4:7], s33 offen offset:2048 sc1
  buffer_load_dwordx4 v[176:179], v60, s[4:7], s33 offen offset:128 sc1
  buffer_load_dwordx4 v[180:183], v60, s[4:7], s33 offen offset:2176 sc1
  buffer_load_dwordx4 v[184:187], v61, s[4:7], s33 offen offset:128 sc1
  buffer_load_dwordx4 v[188:191], v61, s[4:7], s33 offen offset:2176 sc1
L_rocont_253:
  buffer_load_dword v25, v24, s[4:7], s38 offen sc1
  v_mov_b32 v28, 0
  v_mov_b32 v29, 0
  v_mov_b32 v30, 0
  v_mov_b32 v31, 0
  v_mov_b32 v32, 0
  v_mov_b32 v33, 0
  v_mov_b32 v34, 0
  v_mov_b32 v35, 0
  v_mov_b32 v36, 0
  v_mov_b32 v37, 0
  v_mov_b32 v38, 0
  v_mov_b32 v39, 0
  v_mov_b32 v40, 0
  v_mov_b32 v41, 0
  v_mov_b32 v42, 0
  v_mov_b32 v43, 0
  v_mov_b32 v44, 0
  v_mov_b32 v45, 0
  v_mov_b32 v46, 0
  v_mov_b32 v47, 0
  v_mov_b32 v48, 0
  v_mov_b32 v49, 0
  v_mov_b32 v50, 0
  v_mov_b32 v51, 0
  v_mov_b32 v52, 0
  v_mov_b32 v53, 0
  v_mov_b32 v54, 0
  v_mov_b32 v55, 0
  v_mov_b32 v56, 0
  v_mov_b32 v57, 0
  v_mov_b32 v58, 0
  v_mov_b32 v59, 0
  s_waitcnt vmcnt(0)
  s_mov_b32 s34, 0
  v_readlane_b32 s39, v25, 6
  s_nop 3
  s_cmp_lt_u32 s39, 8
  s_cbranch_scc1 L_rolate_256
  s_mov_b32 s32, 1572864
  s_mov_b32 s33, 1703936
  buffer_load_dwordx4 v[64:67], v60, s[4:7], s32 offen offset:0 sc1
  buffer_load_dwordx4 v[68:71], v60, s[4:7], s32 offen offset:2048 sc1
  buffer_load_dwordx4 v[72:75], v61, s[4:7], s32 offen offset:0 sc1
  buffer_load_dwordx4 v[76:79], v61, s[4:7], s32 offen offset:2048 sc1
  buffer_load_dwordx4 v[80:83], v60, s[4:7], s32 offen offset:128 sc1
  buffer_load_dwordx4 v[84:87], v60, s[4:7], s32 offen offset:2176 sc1
  buffer_load_dwordx4 v[88:91], v61, s[4:7], s32 offen offset:128 sc1
  buffer_load_dwordx4 v[92:95], v61, s[4:7], s32 offen offset:2176 sc1
  buffer_load_dwordx4 v[96:99], v60, s[4:7], s33 offen offset:0 sc1
  buffer_load_dwordx4 v[100:103], v60, s[4:7], s33 offen offset:2048 sc1
  buffer_load_dwordx4 v[104:107], v61, s[4:7], s33 offen offset:0 sc1
  buffer_load_dwordx4 v[108:111], v61, s[4:7], s33 offen offset:2048 sc1
  buffer_load_dwordx4 v[112:115], v60, s[4:7], s33 offen offset:128 sc1
  buffer_load_dwordx4 v[116:119], v60, s[4:7], s33 offen offset:2176 sc1
  buffer_load_dwordx4 v[120:123], v61, s[4:7], s33 offen offset:128 sc1
  buffer_load_dwordx4 v[124:127], v61, s[4:7], s33 offen offset:2176 sc1
  s_mov_b32 s34, 1
L_rolate_256:
  v_smfmac_f32_16x16x64_bf16 v[28:31], v[128:131], a[0:7], v4
  v_smfmac_f32_16x16x64_bf16 v[32:35], v[128:131], a[8:15], v4
  v_smfmac_f32_16x16x64_bf16 v[28:31], v[132:135], a[16:23], v4
  v_smfmac_f32_16x16x64_bf16 v[32:35], v[132:135], a[24:31], v4
  v_smfmac_f32_16x16x64_bf16 v[28:31], v[136:139], a[32:39], v4
  v_smfmac_f32_16x16x64_bf16 v[32:35], v[136:139], a[40:47], v4
  v_smfmac_f32_16x16x64_bf16 v[28:31], v[140:143], a[48:55], v4
  v_smfmac_f32_16x16x64_bf16 v[32:35], v[140:143], a[56:63], v4
  v_smfmac_f32_16x16x64_bf16 v[36:39], v[144:147], a[0:7], v4
  v_smfmac_f32_16x16x64_bf16 v[40:43], v[144:147], a[8:15], v4
  v_smfmac_f32_16x16x64_bf16 v[36:39], v[148:151], a[16:23], v4
  v_smfmac_f32_16x16x64_bf16 v[40:43], v[148:151], a[24:31], v4
  v_smfmac_f32_16x16x64_bf16 v[36:39], v[152:155], a[32:39], v4
  v_smfmac_f32_16x16x64_bf16 v[40:43], v[152:155], a[40:47], v4
  v_smfmac_f32_16x16x64_bf16 v[36:39], v[156:159], a[48:55], v4
  v_smfmac_f32_16x16x64_bf16 v[40:43], v[156:159], a[56:63], v4
  v_smfmac_f32_16x16x64_bf16 v[44:47], v[160:163], a[0:7], v4
  v_smfmac_f32_16x16x64_bf16 v[48:51], v[160:163], a[8:15], v4
  v_smfmac_f32_16x16x64_bf16 v[44:47], v[164:167], a[16:23], v4
  v_smfmac_f32_16x16x64_bf16 v[48:51], v[164:167], a[24:31], v4
  v_smfmac_f32_16x16x64_bf16 v[44:47], v[168:171], a[32:39], v4
  v_smfmac_f32_16x16x64_bf16 v[48:51], v[168:171], a[40:47], v4
  v_smfmac_f32_16x16x64_bf16 v[44:47], v[172:175], a[48:55], v4
  v_smfmac_f32_16x16x64_bf16 v[48:51], v[172:175], a[56:63], v4
  v_smfmac_f32_16x16x64_bf16 v[52:55], v[176:179], a[0:7], v4
  v_smfmac_f32_16x16x64_bf16 v[56:59], v[176:179], a[8:15], v4
  v_smfmac_f32_16x16x64_bf16 v[52:55], v[180:183], a[16:23], v4
  v_smfmac_f32_16x16x64_bf16 v[56:59], v[180:183], a[24:31], v4
  v_smfmac_f32_16x16x64_bf16 v[52:55], v[184:187], a[32:39], v4
  v_smfmac_f32_16x16x64_bf16 v[56:59], v[184:187], a[40:47], v4
  v_smfmac_f32_16x16x64_bf16 v[52:55], v[188:191], a[48:55], v4
  v_smfmac_f32_16x16x64_bf16 v[56:59], v[188:191], a[56:63], v4
  v_permlane32_swap_b32 v28, v32
  v_permlane32_swap_b32 v29, v33
  v_permlane32_swap_b32 v30, v34
  v_permlane32_swap_b32 v31, v35
  v_pk_add_f32 v[28:29], v[28:29], v[32:33]
  v_pk_add_f32 v[30:31], v[30:31], v[34:35]
  ds_write2_b32 v16, v28, v29 offset0:0 offset1:36
  ds_write2_b32 v16, v30, v31 offset0:72 offset1:108
  v_permlane32_swap_b32 v36, v40
  v_permlane32_swap_b32 v37, v41
  v_permlane32_swap_b32 v38, v42
  v_permlane32_swap_b32 v39, v43
  v_pk_add_f32 v[36:37], v[36:37], v[40:41]
  v_pk_add_f32 v[38:39], v[38:39], v[42:43]
  ds_write2_b32 v17, v36, v37 offset0:0 offset1:36
  ds_write2_b32 v17, v38, v39 offset0:72 offset1:108
  v_permlane32_swap_b32 v44, v48
  v_permlane32_swap_b32 v45, v49
  v_permlane32_swap_b32 v46, v50
  v_permlane32_swap_b32 v47, v51
  v_pk_add_f32 v[44:45], v[44:45], v[48:49]
  v_pk_add_f32 v[46:47], v[46:47], v[50:51]
  ds_write2_b32 v18, v44, v45 offset0:0 offset1:36
  ds_write2_b32 v18, v46, v47 offset0:72 offset1:108
  s_nop 7
  v_permlane32_swap_b32 v52, v56
  v_permlane32_swap_b32 v53, v57
  v_permlane32_swap_b32 v54, v58
  v_permlane32_swap_b32 v55, v59
  v_pk_add_f32 v[52:53], v[52:53], v[56:57]
  v_pk_add_f32 v[54:55], v[54:55], v[58:59]
  ds_write2_b32 v19, v52, v53 offset0:0 offset1:36
  ds_write2_b32 v19, v54, v55 offset0:72 offset1:108
  s_waitcnt lgkmcnt(0)
  s_barrier
  s_cmp_lg_u32 s34, 0
  s_cbranch_scc1 L_rocont_257
  s_add_u32 s40, s38, 3072
  v_mov_b32 v8, 0
  s_mov_b32 s41, 0x8
L_poll_258:
  buffer_load_dword v6, v8, s[4:7], s40 offen sc1
  s_waitcnt vmcnt(0)
  v_cmp_le_u32 vcc, s41, v6
  s_cbranch_vccnz L_pollok_259
  s_sleep 1
  s_add_u32 s31, s31, 1
  s_cmp_lt_u32 s31, 1048576
  s_cbranch_scc1 L_poll_258
  s_branch L_abort
L_pollok_259:
  s_mov_b32 s32, 1572864
  s_mov_b32 s33, 1703936
  buffer_load_dwordx4 v[64:67], v60, s[4:7], s32 offen offset:0 sc1
  buffer_load_dwordx4 v[68:71], v60, s[4:7], s32 offen offset:2048 sc1
  buffer_load_dwordx4 v[72:75], v61, s[4:7], s32 offen offset:0 sc1
  buffer_load_dwordx4 v[76:79], v61, s[4:7], s32 offen offset:2048 sc1
  buffer_load_dwordx4 v[80:83], v60, s[4:7], s32 offen offset:128 sc1
  buffer_load_dwordx4 v[84:87], v60, s[4:7], s32 offen offset:2176 sc1
  buffer_load_dwordx4 v[88:91], v61, s[4:7], s32 offen offset:128 sc1
  buffer_load_dwordx4 v[92:95], v61, s[4:7], s32 offen offset:2176 sc1
  buffer_load_dwordx4 v[96:99], v60, s[4:7], s33 offen offset:0 sc1
  buffer_load_dwordx4 v[100:103], v60, s[4:7], s33 offen offset:2048 sc1
  buffer_load_dwordx4 v[104:107], v61, s[4:7], s33 offen offset:0 sc1
  buffer_load_dwordx4 v[108:111], v61, s[4:7], s33 offen offset:2048 sc1
  buffer_load_dwordx4 v[112:115], v60, s[4:7], s33 offen offset:128 sc1
  buffer_load_dwordx4 v[116:119], v60, s[4:7], s33 offen offset:2176 sc1
  buffer_load_dwordx4 v[120:123], v61, s[4:7], s33 offen offset:128 sc1
  buffer_load_dwordx4 v[124:127], v61, s[4:7], s33 offen offset:2176 sc1
L_rocont_257:
  buffer_load_dword v25, v24, s[4:7], s38 offen sc1
  v_mov_b32 v28, 0
  v_mov_b32 v29, 0
  v_mov_b32 v30, 0
  v_mov_b32 v31, 0
  v_mov_b32 v32, 0
  v_mov_b32 v33, 0
  v_mov_b32 v34, 0
  v_mov_b32 v35, 0
  v_mov_b32 v36, 0
  v_mov_b32 v37, 0
  v_mov_b32 v38, 0
  v_mov_b32 v39, 0
  v_mov_b32 v40, 0
  v_mov_b32 v41, 0
  v_mov_b32 v42, 0
  v_mov_b32 v43, 0
  v_mov_b32 v44, 0
  v_mov_b32 v45, 0
  v_mov_b32 v46, 0
  v_mov_b32 v47, 0
  v_mov_b32 v48, 0
  v_mov_b32 v49, 0
  v_mov_b32 v50, 0
  v_mov_b32 v51, 0
  v_mov_b32 v52, 0
  v_mov_b32 v53, 0
  v_mov_b32 v54, 0
  v_mov_b32 v55, 0
  v_mov_b32 v56, 0
  v_mov_b32 v57, 0
  v_mov_b32 v58, 0
  v_mov_b32 v59, 0
  s_waitcnt vmcnt(0)
  s_mov_b32 s34, 0
  v_readlane_b32 s39, v25, 7
  s_nop 3
  s_cmp_lt_u32 s39, 8
  s_cbranch_scc1 L_rolate_260
  s_mov_b32 s32, 1835008
  s_mov_b32 s33, 1966080
  buffer_load_dwordx4 v[128:131], v60, s[4:7], s32 offen offset:0 sc1
  buffer_load_dwordx4 v[132:135], v60, s[4:7], s32 offen offset:2048 sc1
  buffer_load_dwordx4 v[136:139], v61, s[4:7], s32 offen offset:0 sc1
  buffer_load_dwordx4 v[140:143], v61, s[4:7], s32 offen offset:2048 sc1
  buffer_load_dwordx4 v[144:147], v60, s[4:7], s32 offen offset:128 sc1
  buffer_load_dwordx4 v[148:151], v60, s[4:7], s32 offen offset:2176 sc1
  buffer_load_dwordx4 v[152:155], v61, s[4:7], s32 offen offset:128 sc1
  buffer_load_dwordx4 v[156:159], v61, s[4:7], s32 offen offset:2176 sc1
  buffer_load_dwordx4 v[160:163], v60, s[4:7], s33 offen offset:0 sc1
  buffer_load_dwordx4 v[164:167], v60, s[4:7], s33 offen offset:2048 sc1
  buffer_load_dwordx4 v[168:171], v61, s[4:7], s33 offen offset:0 sc1
  buffer_load_dwordx4 v[172:175], v61, s[4:7], s33 offen offset:2048 sc1
  buffer_load_dwordx4 v[176:179], v60, s[4:7], s33 offen offset:128 sc1
  buffer_load_dwordx4 v[180:183], v60, s[4:7], s33 offen offset:2176 sc1
  buffer_load_dwordx4 v[184:187], v61, s[4:7], s33 offen offset:128 sc1
  buffer_load_dwordx4 v[188:191], v61, s[4:7], s33 offen offset:2176 sc1
  s_mov_b32 s34, 1
L_rolate_260:
  v_smfmac_f32_16x16x64_bf16 v[28:31], v[64:67], a[0:7], v4
  v_smfmac_f32_16x16x64_bf16 v[32:35], v[64:67], a[8:15], v4
  v_smfmac_f32_16x16x64_bf16 v[28:31], v[68:71], a[16:23], v4
  v_smfmac_f32_16x16x64_bf16 v[32:35], v[68:71], a[24:31], v4
  v_smfmac_f32_16x16x64_bf16 v[28:31], v[72:75], a[32:39], v4
  v_smfmac_f32_16x16x64_bf16 v[32:35], v[72:75], a[40:47], v4
  v_smfmac_f32_16x16x64_bf16 v[28:31], v[76:79], a[48:55], v4
  v_smfmac_f32_16x16x64_bf16 v[32:35], v[76:79], a[56:63], v4
  v_smfmac_f32_16x16x64_bf16 v[36:39], v[80:83], a[0:7], v4
  v_smfmac_f32_16x16x64_bf16 v[40:43], v[80:83], a[8:15], v4
  v_smfmac_f32_16x16x64_bf16 v[36:39], v[84:87], a[16:23], v4
  v_smfmac_f32_16x16x64_bf16 v[40:43], v[84:87], a[24:31], v4
  v_smfmac_f32_16x16x64_bf16 v[36:39], v[88:91], a[32:39], v4
  v_smfmac_f32_16x16x64_bf16 v[40:43], v[88:91], a[40:47], v4
  v_smfmac_f32_16x16x64_bf16 v[36:39], v[92:95], a[48:55], v4
  v_smfmac_f32_16x16x64_bf16 v[40:43], v[92:95], a[56:63], v4
  v_smfmac_f32_16x16x64_bf16 v[44:47], v[96:99], a[0:7], v4
  v_smfmac_f32_16x16x64_bf16 v[48:51], v[96:99], a[8:15], v4
  v_smfmac_f32_16x16x64_bf16 v[44:47], v[100:103], a[16:23], v4
  v_smfmac_f32_16x16x64_bf16 v[48:51], v[100:103], a[24:31], v4
  v_smfmac_f32_16x16x64_bf16 v[44:47], v[104:107], a[32:39], v4
  v_smfmac_f32_16x16x64_bf16 v[48:51], v[104:107], a[40:47], v4
  v_smfmac_f32_16x16x64_bf16 v[44:47], v[108:111], a[48:55], v4
  v_smfmac_f32_16x16x64_bf16 v[48:51], v[108:111], a[56:63], v4
  v_smfmac_f32_16x16x64_bf16 v[52:55], v[112:115], a[0:7], v4
  v_smfmac_f32_16x16x64_bf16 v[56:59], v[112:115], a[8:15], v4
  v_smfmac_f32_16x16x64_bf16 v[52:55], v[116:119], a[16:23], v4
  v_smfmac_f32_16x16x64_bf16 v[56:59], v[116:119], a[24:31], v4
  v_smfmac_f32_16x16x64_bf16 v[52:55], v[120:123], a[32:39], v4
  v_smfmac_f32_16x16x64_bf16 v[56:59], v[120:123], a[40:47], v4
  v_smfmac_f32_16x16x64_bf16 v[52:55], v[124:127], a[48:55], v4
  v_smfmac_f32_16x16x64_bf16 v[56:59], v[124:127], a[56:63], v4
  v_permlane32_swap_b32 v28, v32
  v_permlane32_swap_b32 v29, v33
  v_permlane32_swap_b32 v30, v34
  v_permlane32_swap_b32 v31, v35
  v_pk_add_f32 v[28:29], v[28:29], v[32:33]
  v_pk_add_f32 v[30:31], v[30:31], v[34:35]
  ds_write2_b32 v12, v28, v29 offset0:0 offset1:36
  ds_write2_b32 v12, v30, v31 offset0:72 offset1:108
  v_permlane32_swap_b32 v36, v40
  v_permlane32_swap_b32 v37, v41
  v_permlane32_swap_b32 v38, v42
  v_permlane32_swap_b32 v39, v43
  v_pk_add_f32 v[36:37], v[36:37], v[40:41]
  v_pk_add_f32 v[38:39], v[38:39], v[42:43]
  ds_write2_b32 v13, v36, v37 offset0:0 offset1:36
  ds_write2_b32 v13, v38, v39 offset0:72 offset1:108
  v_permlane32_swap_b32 v44, v48
  v_permlane32_swap_b32 v45, v49
  v_permlane32_swap_b32 v46, v50
  v_permlane32_swap_b32 v47, v51
  v_pk_add_f32 v[44:45], v[44:45], v[48:49]
  v_pk_add_f32 v[46:47], v[46:47], v[50:51]
  ds_write2_b32 v14, v44, v45 offset0:0 offset1:36
  ds_write2_b32 v14, v46, v47 offset0:72 offset1:108
  s_nop 7
  v_permlane32_swap_b32 v52, v56
  v_permlane32_swap_b32 v53, v57
  v_permlane32_swap_b32 v54, v58
  v_permlane32_swap_b32 v55, v59
  v_pk_add_f32 v[52:53], v[52:53], v[56:57]
  v_pk_add_f32 v[54:55], v[54:55], v[58:59]
  ds_write2_b32 v15, v52, v53 offset0:0 offset1:36
  ds_write2_b32 v15, v54, v55 offset0:72 offset1:108
  s_waitcnt lgkmcnt(0)
  s_barrier
  s_cmp_lg_u32 s34, 0
  s_cbranch_scc1 L_rocont_261
  s_add_u32 s40, s38, 3584
  v_mov_b32 v8, 0
  s_mov_b32 s41, 0x8
L_poll_262:
  buffer_load_dword v6, v8, s[4:7], s40 offen sc1
  s_waitcnt vmcnt(0)
  v_cmp_le_u32 vcc, s41, v6
  s_cbranch_vccnz L_pollok_263
  s_sleep 1
  s_add_u32 s31, s31, 1
  s_cmp_lt_u32 s31, 1048576
  s_cbranch_scc1 L_poll_262
  s_branch L_abort
L_pollok_263:
  s_mov_b32 s32, 1835008
  s_mov_b32 s33, 1966080
  buffer_load_dwordx4 v[128:131], v60, s[4:7], s32 offen offset:0 sc1
  buffer_load_dwordx4 v[132:135], v60, s[4:7], s32 offen offset:2048 sc1
  buffer_load_dwordx4 v[136:139], v61, s[4:7], s32 offen offset:0 sc1
  buffer_load_dwordx4 v[140:143], v61, s[4:7], s32 offen offset:2048 sc1
  buffer_load_dwordx4 v[144:147], v60, s[4:7], s32 offen offset:128 sc1
  buffer_load_dwordx4 v[148:151], v60, s[4:7], s32 offen offset:2176 sc1
  buffer_load_dwordx4 v[152:155], v61, s[4:7], s32 offen offset:128 sc1
  buffer_load_dwordx4 v[156:159], v61, s[4:7], s32 offen offset:2176 sc1
  buffer_load_dwordx4 v[160:163], v60, s[4:7], s33 offen offset:0 sc1
  buffer_load_dwordx4 v[164:167], v60, s[4:7], s33 offen offset:2048 sc1
  buffer_load_dwordx4 v[168:171], v61, s[4:7], s33 offen offset:0 sc1
  buffer_load_dwordx4 v[172:175], v61, s[4:7], s33 offen offset:2048 sc1
  buffer_load_dwordx4 v[176:179], v60, s[4:7], s33 offen offset:128 sc1
  buffer_load_dwordx4 v[180:183], v60, s[4:7], s33 offen offset:2176 sc1
  buffer_load_dwordx4 v[184:187], v61, s[4:7], s33 offen offset:128 sc1
  buffer_load_dwordx4 v[188:191], v61, s[4:7], s33 offen offset:2176 sc1
L_rocont_261:
  v_mov_b32 v28, 0
  v_mov_b32 v29, 0
  v_mov_b32 v30, 0
  v_mov_b32 v31, 0
  v_mov_b32 v32, 0
  v_mov_b32 v33, 0
  v_mov_b32 v34, 0
  v_mov_b32 v35, 0
  v_mov_b32 v36, 0
  v_mov_b32 v37, 0
  v_mov_b32 v38, 0
  v_mov_b32 v39, 0
  v_mov_b32 v40, 0
  v_mov_b32 v41, 0
  v_mov_b32 v42, 0
  v_mov_b32 v43, 0
  v_mov_b32 v44, 0
  v_mov_b32 v45, 0
  v_mov_b32 v46, 0
  v_mov_b32 v47, 0
  v_mov_b32 v48, 0
  v_mov_b32 v49, 0
  v_mov_b32 v50, 0
  v_mov_b32 v51, 0
  v_mov_b32 v52, 0
  v_mov_b32 v53, 0
  v_mov_b32 v54, 0
  v_mov_b32 v55, 0
  v_mov_b32 v56, 0
  v_mov_b32 v57, 0
  v_mov_b32 v58, 0
  v_mov_b32 v59, 0
  s_waitcnt vmcnt(0)
  s_mov_b32 s34, 0
  v_smfmac_f32_16x16x64_bf16 v[28:31], v[128:131], a[0:7], v4
  v_smfmac_f32_16x16x64_bf16 v[32:35], v[128:131], a[8:15], v4
  v_smfmac_f32_16x16x64_bf16 v[28:31], v[132:135], a[16:23], v4
  v_smfmac_f32_16x16x64_bf16 v[32:35], v[132:135], a[24:31], v4
  v_smfmac_f32_16x16x64_bf16 v[28:31], v[136:139], a[32:39], v4
  v_smfmac_f32_16x16x64_bf16 v[32:35], v[136:139], a[40:47], v4
  v_smfmac_f32_16x16x64_bf16 v[28:31], v[140:143], a[48:55], v4
  v_smfmac_f32_16x16x64_bf16 v[32:35], v[140:143], a[56:63], v4
  v_smfmac_f32_16x16x64_bf16 v[36:39], v[144:147], a[0:7], v4
  v_smfmac_f32_16x16x64_bf16 v[40:43], v[144:147], a[8:15], v4
  v_smfmac_f32_16x16x64_bf16 v[36:39], v[148:151], a[16:23], v4
  v_smfmac_f32_16x16x64_bf16 v[40:43], v[148:151], a[24:31], v4
  v_smfmac_f32_16x16x64_bf16 v[36:39], v[152:155], a[32:39], v4
  v_smfmac_f32_16x16x64_bf16 v[40:43], v[152:155], a[40:47], v4
  v_smfmac_f32_16x16x64_bf16 v[36:39], v[156:159], a[48:55], v4
  v_smfmac_f32_16x16x64_bf16 v[40:43], v[156:159], a[56:63], v4
  v_smfmac_f32_16x16x64_bf16 v[44:47], v[160:163], a[0:7], v4
  v_smfmac_f32_16x16x64_bf16 v[48:51], v[160:163], a[8:15], v4
  v_smfmac_f32_16x16x64_bf16 v[44:47], v[164:167], a[16:23], v4
  v_smfmac_f32_16x16x64_bf16 v[48:51], v[164:167], a[24:31], v4
  v_smfmac_f32_16x16x64_bf16 v[44:47], v[168:171], a[32:39], v4
  v_smfmac_f32_16x16x64_bf16 v[48:51], v[168:171], a[40:47], v4
  v_smfmac_f32_16x16x64_bf16 v[44:47], v[172:175], a[48:55], v4
  v_smfmac_f32_16x16x64_bf16 v[48:51], v[172:175], a[56:63], v4
  v_smfmac_f32_16x16x64_bf16 v[52:55], v[176:179], a[0:7], v4
  v_smfmac_f32_16x16x64_bf16 v[56:59], v[176:179], a[8:15], v4
  v_smfmac_f32_16x16x64_bf16 v[52:55], v[180:183], a[16:23], v4
  v_smfmac_f32_16x16x64_bf16 v[56:59], v[180:183], a[24:31], v4
  v_smfmac_f32_16x16x64_bf16 v[52:55], v[184:187], a[32:39], v4
  v_smfmac_f32_16x16x64_bf16 v[56:59], v[184:187], a[40:47], v4
  v_smfmac_f32_16x16x64_bf16 v[52:55], v[188:191], a[48:55], v4
  v_smfmac_f32_16x16x64_bf16 v[56:59], v[188:191], a[56:63], v4
  v_permlane32_swap_b32 v28, v32
  v_permlane32_swap_b32 v29, v33
  v_permlane32_swap_b32 v30, v34
  v_permlane32_swap_b32 v31, v35
  v_pk_add_f32 v[28:29], v[28:29], v[32:33]
  v_pk_add_f32 v[30:31], v[30:31], v[34:35]
  ds_write2_b32 v16, v28, v29 offset0:0 offset1:36
  ds_write2_b32 v16, v30, v31 offset0:72 offset1:108
  v_permlane32_swap_b32 v36, v40
  v_permlane32_swap_b32 v37, v41
  v_permlane32_swap_b32 v38, v42
  v_permlane32_swap_b32 v39, v43
  v_pk_add_f32 v[36:37], v[36:37], v[40:41]
  v_pk_add_f32 v[38:39], v[38:39], v[42:43]
  ds_write2_b32 v17, v36, v37 offset0:0 offset1:36
  ds_write2_b32 v17, v38, v39 offset0:72 offset1:108
  v_permlane32_swap_b32 v44, v48
  v_permlane32_swap_b32 v45, v49
  v_permlane32_swap_b32 v46, v50
  v_permlane32_swap_b32 v47, v51
  v_pk_add_f32 v[44:45], v[44:45], v[48:49]
  v_pk_add_f32 v[46:47], v[46:47], v[50:51]
  ds_write2_b32 v18, v44, v45 offset0:0 offset1:36
  ds_write2_b32 v18, v46, v47 offset0:72 offset1:108
  s_nop 7
  v_permlane32_swap_b32 v52, v56
  v_permlane32_swap_b32 v53, v57
  v_permlane32_swap_b32 v54, v58
  v_permlane32_swap_b32 v55, v59
  v_pk_add_f32 v[52:53], v[52:53], v[56:57]
  v_pk_add_f32 v[54:55], v[54:55], v[58:59]
  ds_write2_b32 v19, v52, v53 offset0:0 offset1:36
  ds_write2_b32 v19, v54, v55 offset0:72 offset1:108
  s_waitcnt lgkmcnt(0)
  s_barrier
  s_branch L_roout_233
L_rofin_232:
  s_mov_b32 s29, 0
  v_and_b32 v6, 7, v1
  v_mul_u32_u24 v12, 144, v6
  v_lshrrev_b32 v8, 3, v1
  v_lshl_add_u32 v12, v8, 4, v12
  s_mul_i32 s39, s28, 4608
  s_add_u32 s39, s39, 32768
  v_add_u32 v12, s39, v12
  s_xor_b32 s39, s24, 0
  s_lshl_b32 s39, s39, 15
  s_lshl_b32 s40, s28, 17
  s_add_u32 s39, s39, s40
  s_lshl_b32 s40, s25, 10
  s_add_u32 s39, s39, s40
  s_add_u32 s39, s39, 0xa400000
  v_lshl_add_u32 v13, v1, 4, s39
  s_xor_b32 s39, s24, 1
  s_lshl_b32 s39, s39, 15
  s_lshl_b32 s40, s28, 17
  s_add_u32 s39, s39, s40
  s_lshl_b32 s40, s25, 10
  s_add_u32 s39, s39, s40
  s_add_u32 s39, s39, 0xa400000
  v_lshl_add_u32 v14, v1, 4, s39
  s_xor_b32 s39, s24, 2
  s_lshl_b32 s39, s39, 15
  s_lshl_b32 s40, s28, 17
  s_add_u32 s39, s39, s40
  s_lshl_b32 s40, s25, 10
  s_add_u32 s39, s39, s40
  s_add_u32 s39, s39, 0xa400000
  v_lshl_add_u32 v15, v1, 4, s39
  s_xor_b32 s39, s24, 3
  s_lshl_b32 s39, s39, 15
  s_lshl_b32 s40, s28, 17
  s_add_u32 s39, s39, s40
  s_lshl_b32 s40, s25, 10
  s_add_u32 s39, s39, s40
  s_add_u32 s39, s39, 0xa400000
  v_lshl_add_u32 v19, v1, 4, s39
  s_cmp_eq_u32 s28, s24
  s_cbranch_scc1 L_romine_266
  s_barrier
  ds_read_b128 v[20:23], v12 offset:0
  ds_read_b128 v[24:27], v12 offset:1152
  ds_read_b128 v[28:31], v12 offset:2304
  ds_read_b128 v[32:35], v12 offset:3456
  s_waitcnt lgkmcnt(0)
  v_pk_add_f32 v[20:21], v[20:21], v[24:25]
  v_pk_add_f32 v[22:23], v[22:23], v[26:27]
  v_pk_add_f32 v[20:21], v[20:21], v[28:29]
  v_pk_add_f32 v[22:23], v[22:23], v[30:31]
  v_pk_add_f32 v[20:21], v[20:21], v[32:33]
  v_pk_add_f32 v[22:23], v[22:23], v[34:35]
  s_mov_b32 s32, 0
  buffer_store_dwordx4 v[20:23], v13, s[4:7], s32 offen sc1
  s_barrier
  ds_read_b128 v[20:23], v12 offset:18432
  ds_read_b128 v[24:27], v12 offset:19584
  ds_read_b128 v[28:31], v12 offset:20736
  ds_read_b128 v[32:35], v12 offset:21888
  s_waitcnt lgkmcnt(0)
  v_pk_add_f32 v[20:21], v[20:21], v[24:25]
  v_pk_add_f32 v[22:23], v[22:23], v[26:27]
  v_pk_add_f32 v[20:21], v[20:21], v[28:29]
  v_pk_add_f32 v[22:23], v[22:23], v[30:31]
  v_pk_add_f32 v[20:21], v[20:21], v[32:33]
  v_pk_add_f32 v[22:23], v[22:23], v[34:35]
  s_mov_b32 s32, 524288
  buffer_store_dwordx4 v[20:23], v13, s[4:7], s32 offen sc1
  s_barrier
  ds_read_b128 v[20:23], v12 offset:0
  ds_read_b128 v[24:27], v12 offset:1152
  ds_read_b128 v[28:31], v12 offset:2304
  ds_read_b128 v[32:35], v12 offset:3456
  s_waitcnt lgkmcnt(0)
  v_pk_add_f32 v[20:21], v[20:21], v[24:25]
  v_pk_add_f32 v[22:23], v[22:23], v[26:27]
  v_pk_add_f32 v[20:21], v[20:21], v[28:29]
  v_pk_add_f32 v[22:23], v[22:23], v[30:31]
  v_pk_add_f32 v[20:21], v[20:21], v[32:33]
  v_pk_add_f32 v[22:23], v[22:23], v[34:35]
  s_mov_b32 s32, 1048576
  buffer_store_dwordx4 v[20:23], v13, s[4:7], s32 offen sc1
  s_barrier
  ds_read_b128 v[20:23], v12 offset:18432
  ds_read_b128 v[24:27], v12 offset:19584
  ds_read_b128 v[28:31], v12 offset:20736
  ds_read_b128 v[32:35], v12 offset:21888
  s_waitcnt lgkmcnt(0)
  v_pk_add_f32 v[20:21], v[20:21], v[24:25]
  v_pk_add_f32 v[22:23], v[22:23], v[26:27]
  v_pk_add_f32 v[20:21], v[20:21], v[28:29]
  v_pk_add_f32 v[22:23], v[22:23], v[30:31]
  v_pk_add_f32 v[20:21], v[20:21], v[32:33]
  v_pk_add_f32 v[22:23], v[22:23], v[34:35]
  s_mov_b32 s32, 1572864
  buffer_store_dwordx4 v[20:23], v13, s[4:7], s32 offen sc1
  s_barrier
  ds_read_b128 v[20:23], v12 offset:0
  ds_read_b128 v[24:27], v12 offset:1152
  ds_read_b128 v[28:31], v12 offset:2304
  ds_read_b128 v[32:35], v12 offset:3456
  s_waitcnt lgkmcnt(0)
  v_pk_add_f32 v[20:21], v[20:21], v[24:25]
  v_pk_add_f32 v[22:23], v[22:23], v[26:27]
  v_pk_add_f32 v[20:21], v[20:21], v[28:29]
  v_pk_add_f32 v[22:23], v[22:23], v[30:31]
  v_pk_add_f32 v[20:21], v[20:21], v[32:33]
  v_pk_add_f32 v[22:23], v[22:23], v[34:35]
  s_mov_b32 s32, 2097152
  buffer_store_dwordx4 v[20:23], v13, s[4:7], s32 offen sc1
  s_barrier
  ds_read_b128 v[20:23], v12 offset:18432
  ds_read_b128 v[24:27], v12 offset:19584
  ds_read_b128 v[28:31], v12 offset:20736
  ds_read_b128 v[32:35], v12 offset:21888
  s_waitcnt lgkmcnt(0)
  v_pk_add_f32 v[20:21], v[20:21], v[24:25]
  v_pk_add_f32 v[22:23], v[22:23], v[26:27]
  v_pk_add_f32 v[20:21], v[20:21], v[28:29]
  v_pk_add_f32 v[22:23], v[22:23], v[30:31]
  v_pk_add_f32 v[20:21], v[20:21], v[32:33]
  v_pk_add_f32 v[22:23], v[22:23], v[34:35]
  s_mov_b32 s32, 2621440
  buffer_store_dwordx4 v[20:23], v13, s[4:7], s32 offen sc1
  s_barrier
  ds_read_b128 v[20:23], v12 offset:0
  ds_read_b128 v[24:27], v12 offset:1152
  ds_read_b128 v[28:31], v12 offset:2304
  ds_read_b128 v[32:35], v12 offset:3456
  s_waitcnt lgkmcnt(0)
  v_pk_add_f32 v[20:21], v[20:21], v[24:25]
  v_pk_add_f32 v[22:23], v[22:23], v[26:27]
  v_pk_add_f32 v[20:21], v[20:21], v[28:29]
  v_pk_add_f32 v[22:23], v[22:23], v[30:31]
  v_pk_add_f32 v[20:21], v[20:21], v[32:33]
  v_pk_add_f32 v[22:23], v[22:23], v[34:35]
  s_mov_b32 s32, 3145728
  buffer_store_dwordx4 v[20:23], v13, s[4:7], s32 offen sc1
  s_barrier
  ds_read_b128 v[20:23], v12 offset:18432
  ds_read_b128 v[24:27], v12 offset:19584
  ds_read_b128 v[28:31], v12 offset:20736
  ds_read_b128 v[32:35], v12 offset:21888
  s_waitcnt lgkmcnt(0)
  v_pk_add_f32 v[20:21], v[20:21], v[24:25]
  v_pk_add_f32 v[22:23], v[22:23], v[26:27]
  v_pk_add_f32 v[20:21], v[20:21], v[28:29]
  v_pk_add_f32 v[22:23], v[22:23], v[30:31]
  v_pk_add_f32 v[20:21], v[20:21], v[32:33]
  v_pk_add_f32 v[22:23], v[22:23], v[34:35]
  s_mov_b32 s32, 3670016
  buffer_store_dwordx4 v[20:23], v13, s[4:7], s32 offen sc1
  s_branch L_roout_233
L_romine_266:
  s_load_dwordx2 s[52:53], s[0:1], 88
  s_waitcnt lgkmcnt(0)
  s_mov_b32 s12, s52
  s_mov_b32 s13, s53
  s_mov_b32 s14, 0x400000
  s_mov_b32 s15, 0x20000
  s_lshl_b32 s39, s24, 3
  s_add_u32 s39, s39, 1792
  v_add_u32 v9, s39, v6
  v_lshlrev_b32 v17, 2, v9
  v_add_u32 v17, 0x5c00000, v17
  v_lshlrev_b32 v18, 11, v9
  v_lshl_add_u32 v18, v8, 3, v18
  s_lshl_b32 s39, s25, 6
  v_add_u32 v18, s39, v18
  v_lshrrev_b32 v10, 4, v9
  v_lshlrev_b32 v16, 15, v10
  v_and_b32 v10, 15, v9
  v_lshl_add_u32 v16, v10, 4, v16
  v_and_b32 v10, 3, v8
  v_lshl_add_u32 v16, v10, 8, v16
  v_lshrrev_b32 v10, 2, v8
  v_lshl_add_u32 v16, v10, 3, v16
  s_lshl_b32 s39, s25, 10
  s_add_u32 s39, s39, 0x5000000
  v_add_u32 v16, s39, v16
  s_mov_b32 s40, 0x9c15380
  v_mov_b32 v8, 0
  s_mov_b32 s41, 0x40
L_poll_268:
  buffer_load_dword v6, v8, s[4:7], s40 offen sc1
  s_waitcnt vmcnt(0)
  v_cmp_le_u32 vcc, s41, v6
  s_cbranch_vccnz L_pollok_269
  s_sleep 4
  s_add_u32 s31, s31, 1
  s_cmp_lt_u32 s31, 1048576
  s_cbranch_scc1 L_poll_268
  s_branch L_abort
L_pollok_269:
  s_mov_b32 s33, 0
  s_mov_b32 s34, 0
  buffer_load_dwordx2 v[64:65], v16, s[4:7], s33 offen sc1
  buffer_load_dword v66, v17, s[4:7], s34 offen sc1
  s_mov_b32 s33, 65536
  s_mov_b32 s34, 128
  buffer_load_dwordx2 v[68:69], v16, s[4:7], s33 offen sc1
  buffer_load_dword v70, v17, s[4:7], s34 offen sc1
  s_mov_b32 s33, 131072
  s_mov_b32 s34, 256
  buffer_load_dwordx2 v[72:73], v16, s[4:7], s33 offen sc1
  buffer_load_dword v74, v17, s[4:7], s34 offen sc1
  s_mov_b32 s33, 196608
  s_mov_b32 s34, 384
  buffer_load_dwordx2 v[76:77], v16, s[4:7], s33 offen sc1
  buffer_load_dword v78, v17, s[4:7], s34 offen sc1
  s_mov_b32 s33, 262144
  s_mov_b32 s34, 512
  buffer_load_dwordx2 v[80:81], v16, s[4:7], s33 offen sc1
  buffer_load_dword v82, v17, s[4:7], s34 offen sc1
  s_mov_b32 s33, 327680
  s_mov_b32 s34, 640
  buffer_load_dwordx2 v[84:85], v16, s[4:7], s33 offen sc1
  buffer_load_dword v86, v17, s[4:7], s34 offen sc1
  s_mov_b32 s33, 393216
  s_mov_b32 s34, 768
  buffer_load_dwordx2 v[88:89], v16, s[4:7], s33 offen sc1
  buffer_load_dword v90, v17, s[4:7], s34 offen sc1
  s_mov_b32 s33, 458752
  s_mov_b32 s34, 896
  buffer_load_dwordx2 v[92:93], v16, s[4:7], s33 offen sc1
  buffer_load_dword v94, v17, s[4:7], s34 offen sc1
  s_barrier
  ds_read_b128 v[20:23], v12 offset:0
  ds_read_b128 v[24:27], v12 offset:1152
  ds_read_b128 v[28:31], v12 offset:2304
  ds_read_b128 v[32:35], v12 offset:3456
  s_waitcnt lgkmcnt(0)
  v_pk_add_f32 v[20:21], v[20:21], v[24:25]
  v_pk_add_f32 v[22:23], v[22:23], v[26:27]
  v_pk_add_f32 v[20:21], v[20:21], v[28:29]
  v_pk_add_f32 v[22:23], v[22:23], v[30:31]
  v_pk_add_f32 v[128:129], v[20:21], v[32:33]
  v_pk_add_f32 v[130:131], v[22:23], v[34:35]
  s_barrier
  ds_read_b128 v[20:23], v12 offset:18432
  ds_read_b128 v[24:27], v12 offset:19584
  ds_read_b128 v[28:31], v12 offset:20736
  ds_read_b128 v[32:35], v12 offset:21888
  s_waitcnt lgkmcnt(0)
  v_pk_add_f32 v[20:21], v[20:21], v[24:25]
  v_pk_add_f32 v[22:23], v[22:23], v[26:27]
  v_pk_add_f32 v[20:21], v[20:21], v[28:29]
  v_pk_add_f32 v[22:23], v[22:23], v[30:31]
  v_pk_add_f32 v[132:133], v[20:21], v[32:33]
  v_pk_add_f32 v[134:135], v[22:23], v[34:35]
  s_mov_b32 s32, 0
  s_mov_b32 s33, 0
  buffer_load_dwordx4 v[36:39], v14, s[4:7], s32 offen sc1
  buffer_load_dwordx4 v[40:43], v15, s[4:7], s32 offen sc1
  buffer_load_dwordx4 v[44:47], v19, s[4:7], s32 offen sc1
L_rowait_270:
  s_waitcnt vmcnt(0)
  v_max3_u32 v9, v39, v43, v47
  v_cmp_eq_u32 vcc, -1, v9
  s_cbranch_vccnz L_roretry_271
  v_pk_add_f32 v[128:129], v[128:129], v[36:37]
  v_pk_add_f32 v[130:131], v[130:131], v[38:39]
  v_pk_add_f32 v[128:129], v[128:129], v[40:41]
  v_pk_add_f32 v[130:131], v[130:131], v[42:43]
  v_pk_add_f32 v[128:129], v[128:129], v[44:45]
  v_pk_add_f32 v[130:131], v[130:131], v[46:47]
  v_sub_f32 v52, 1.0, v66
  v_pk_mul_f32 v[128:129], v[128:129], v[66:67] op_sel_hi:[1,0]
  v_lshlrev_b32 v36, 16, v64
  v_and_b32 v37, 0xffff0000, v64
  v_pk_fma_f32 v[128:129], v[36:37], v[52:53], v[128:129] op_sel_hi:[1,0,1]
  v_cvt_pk_bf16_f32 v56, v128, v129
  v_pk_mul_f32 v[130:131], v[130:131], v[66:67] op_sel_hi:[1,0]
  v_lshlrev_b32 v38, 16, v65
  v_and_b32 v39, 0xffff0000, v65
  v_pk_fma_f32 v[130:131], v[38:39], v[52:53], v[130:131] op_sel_hi:[1,0,1]
  v_cvt_pk_bf16_f32 v57, v130, v131
  buffer_store_dwordx2 v[56:57], v18, s[12:15], s33 offen
  s_barrier
  ds_read_b128 v[20:23], v12 offset:0
  ds_read_b128 v[24:27], v12 offset:1152
  ds_read_b128 v[28:31], v12 offset:2304
  ds_read_b128 v[32:35], v12 offset:3456
  s_waitcnt lgkmcnt(0)
  v_pk_add_f32 v[20:21], v[20:21], v[24:25]
  v_pk_add_f32 v[22:23], v[22:23], v[26:27]
  v_pk_add_f32 v[20:21], v[20:21], v[28:29]
  v_pk_add_f32 v[22:23], v[22:23], v[30:31]
  v_pk_add_f32 v[136:137], v[20:21], v[32:33]
  v_pk_add_f32 v[138:139], v[22:23], v[34:35]
  s_mov_b32 s32, 524288
  s_mov_b32 s33, 65536
  buffer_load_dwordx4 v[36:39], v14, s[4:7], s32 offen sc1
  buffer_load_dwordx4 v[40:43], v15, s[4:7], s32 offen sc1
  buffer_load_dwordx4 v[44:47], v19, s[4:7], s32 offen sc1
L_rowait_272:
  s_waitcnt vmcnt(0)
  v_max3_u32 v9, v39, v43, v47
  v_cmp_eq_u32 vcc, -1, v9
  s_cbranch_vccnz L_roretry_273
  v_pk_add_f32 v[132:133], v[132:133], v[36:37]
  v_pk_add_f32 v[134:135], v[134:135], v[38:39]
  v_pk_add_f32 v[132:133], v[132:133], v[40:41]
  v_pk_add_f32 v[134:135], v[134:135], v[42:43]
  v_pk_add_f32 v[132:133], v[132:133], v[44:45]
  v_pk_add_f32 v[134:135], v[134:135], v[46:47]
  v_sub_f32 v52, 1.0, v70
  v_pk_mul_f32 v[132:133], v[132:133], v[70:71] op_sel_hi:[1,0]
  v_lshlrev_b32 v36, 16, v68
  v_and_b32 v37, 0xffff0000, v68
  v_pk_fma_f32 v[132:133], v[36:37], v[52:53], v[132:133] op_sel_hi:[1,0,1]
  v_cvt_pk_bf16_f32 v56, v132, v133
  v_pk_mul_f32 v[134:135], v[134:135], v[70:71] op_sel_hi:[1,0]
  v_lshlrev_b32 v38, 16, v69
  v_and_b32 v39, 0xffff0000, v69
  v_pk_fma_f32 v[134:135], v[38:39], v[52:53], v[134:135] op_sel_hi:[1,0,1]
  v_cvt_pk_bf16_f32 v57, v134, v135
  buffer_store_dwordx2 v[56:57], v18, s[12:15], s33 offen
  s_barrier
  ds_read_b128 v[20:23], v12 offset:18432
  ds_read_b128 v[24:27], v12 offset:19584
  ds_read_b128 v[28:31], v12 offset:20736
  ds_read_b128 v[32:35], v12 offset:21888
  s_waitcnt lgkmcnt(0)
  v_pk_add_f32 v[20:21], v[20:21], v[24:25]
  v_pk_add_f32 v[22:23], v[22:23], v[26:27]
  v_pk_add_f32 v[20:21], v[20:21], v[28:29]
  v_pk_add_f32 v[22:23], v[22:23], v[30:31]
  v_pk_add_f32 v[140:141], v[20:21], v[32:33]
  v_pk_add_f32 v[142:143], v[22:23], v[34:35]
  s_mov_b32 s32, 1048576
  s_mov_b32 s33, 131072
  buffer_load_dwordx4 v[36:39], v14, s[4:7], s32 offen sc1
  buffer_load_dwordx4 v[40:43], v15, s[4:7], s32 offen sc1
  buffer_load_dwordx4 v[44:47], v19, s[4:7], s32 offen sc1
L_rowait_274:
  s_waitcnt vmcnt(0)
  v_max3_u32 v9, v39, v43, v47
  v_cmp_eq_u32 vcc, -1, v9
  s_cbranch_vccnz L_roretry_275
  v_pk_add_f32 v[136:137], v[136:137], v[36:37]
  v_pk_add_f32 v[138:139], v[138:139], v[38:39]
  v_pk_add_f32 v[136:137], v[136:137], v[40:41]
  v_pk_add_f32 v[138:139], v[138:139], v[42:43]
  v_pk_add_f32 v[136:137], v[136:137], v[44:45]
  v_pk_add_f32 v[138:139], v[138:139], v[46:47]
  v_sub_f32 v52, 1.0, v74
  v_pk_mul_f32 v[136:137], v[136:137], v[74:75] op_sel_hi:[1,0]
  v_lshlrev_b32 v36, 16, v72
  v_and_b32 v37, 0xffff0000, v72
  v_pk_fma_f32 v[136:137], v[36:37], v[52:53], v[136:137] op_sel_hi:[1,0,1]
  v_cvt_pk_bf16_f32 v56, v136, v137
  v_pk_mul_f32 v[138:139], v[138:139], v[74:75] op_sel_hi:[1,0]
  v_lshlrev_b32 v38, 16, v73
  v_and_b32 v39, 0xffff0000, v73
  v_pk_fma_f32 v[138:139], v[38:39], v[52:53], v[138:139] op_sel_hi:[1,0,1]
  v_cvt_pk_bf16_f32 v57, v138, v139
  buffer_store_dwordx2 v[56:57], v18, s[12:15], s33 offen
  s_barrier
  ds_read_b128 v[20:23], v12 offset:0
  ds_read_b128 v[24:27], v12 offset:1152
  ds_read_b128 v[28:31], v12 offset:2304
  ds_read_b128 v[32:35], v12 offset:3456
  s_waitcnt lgkmcnt(0)
  v_pk_add_f32 v[20:21], v[20:21], v[24:25]
  v_pk_add_f32 v[22:23], v[22:23], v[26:27]
  v_pk_add_f32 v[20:21], v[20:21], v[28:29]
  v_pk_add_f32 v[22:23], v[22:23], v[30:31]
  v_pk_add_f32 v[144:145], v[20:21], v[32:33]
  v_pk_add_f32 v[146:147], v[22:23], v[34:35]
  s_mov_b32 s32, 1572864
  s_mov_b32 s33, 196608
  buffer_load_dwordx4 v[36:39], v14, s[4:7], s32 offen sc1
  buffer_load_dwordx4 v[40:43], v15, s[4:7], s32 offen sc1
  buffer_load_dwordx4 v[44:47], v19, s[4:7], s32 offen sc1
L_rowait_276:
  s_waitcnt vmcnt(0)
  v_max3_u32 v9, v39, v43, v47
  v_cmp_eq_u32 vcc, -1, v9
  s_cbranch_vccnz L_roretry_277
  v_pk_add_f32 v[140:141], v[140:141], v[36:37]
  v_pk_add_f32 v[142:143], v[142:143], v[38:39]
  v_pk_add_f32 v[140:141], v[140:141], v[40:41]
  v_pk_add_f32 v[142:143], v[142:143], v[42:43]
  v_pk_add_f32 v[140:141], v[140:141], v[44:45]
  v_pk_add_f32 v[142:143], v[142:143], v[46:47]
  v_sub_f32 v52, 1.0, v78
  v_pk_mul_f32 v[140:141], v[140:141], v[78:79] op_sel_hi:[1,0]
  v_lshlrev_b32 v36, 16, v76
  v_and_b32 v37, 0xffff0000, v76
  v_pk_fma_f32 v[140:141], v[36:37], v[52:53], v[140:141] op_sel_hi:[1,0,1]
  v_cvt_pk_bf16_f32 v56, v140, v141
  v_pk_mul_f32 v[142:143], v[142:143], v[78:79] op_sel_hi:[1,0]
  v_lshlrev_b32 v38, 16, v77
  v_and_b32 v39, 0xffff0000, v77
  v_pk_fma_f32 v[142:143], v[38:39], v[52:53], v[142:143] op_sel_hi:[1,0,1]
  v_cvt_pk_bf16_f32 v57, v142, v143
  buffer_store_dwordx2 v[56:57], v18, s[12:15], s33 offen
  s_barrier
  ds_read_b128 v[20:23], v12 offset:18432
  ds_read_b128 v[24:27], v12 offset:19584
  ds_read_b128 v[28:31], v12 offset:20736
  ds_read_b128 v[32:35], v12 offset:21888
  s_waitcnt lgkmcnt(0)
  v_pk_add_f32 v[20:21], v[20:21], v[24:25]
  v_pk_add_f32 v[22:23], v[22:23], v[26:27]
  v_pk_add_f32 v[20:21], v[20:21], v[28:29]
  v_pk_add_f32 v[22:23], v[22:23], v[30:31]
  v_pk_add_f32 v[148:149], v[20:21], v[32:33]
  v_pk_add_f32 v[150:151], v[22:23], v[34:35]
  s_mov_b32 s32, 2097152
  s_mov_b32 s33, 262144
  buffer_load_dwordx4 v[36:39], v14, s[4:7], s32 offen sc1
  buffer_load_dwordx4 v[40:43], v15, s[4:7], s32 offen sc1
  buffer_load_dwordx4 v[44:47], v19, s[4:7], s32 offen sc1
L_rowait_278:
  s_waitcnt vmcnt(0)
  v_max3_u32 v9, v39, v43, v47
  v_cmp_eq_u32 vcc, -1, v9
  s_cbranch_vccnz L_roretry_279
  v_pk_add_f32 v[144:145], v[144:145], v[36:37]
  v_pk_add_f32 v[146:147], v[146:147], v[38:39]
  v_pk_add_f32 v[144:145], v[144:145], v[40:41]
  v_pk_add_f32 v[146:147], v[146:147], v[42:43]
  v_pk_add_f32 v[144:145], v[144:145], v[44:45]
  v_pk_add_f32 v[146:147], v[146:147], v[46:47]
  v_sub_f32 v52, 1.0, v82
  v_pk_mul_f32 v[144:145], v[144:145], v[82:83] op_sel_hi:[1,0]
  v_lshlrev_b32 v36, 16, v80
  v_and_b32 v37, 0xffff0000, v80
  v_pk_fma_f32 v[144:145], v[36:37], v[52:53], v[144:145] op_sel_hi:[1,0,1]
  v_cvt_pk_bf16_f32 v56, v144, v145
  v_pk_mul_f32 v[146:147], v[146:147], v[82:83] op_sel_hi:[1,0]
  v_lshlrev_b32 v38, 16, v81
  v_and_b32 v39, 0xffff0000, v81
  v_pk_fma_f32 v[146:147], v[38:39], v[52:53], v[146:147] op_sel_hi:[1,0,1]
  v_cvt_pk_bf16_f32 v57, v146, v147
  buffer_store_dwordx2 v[56:57], v18, s[12:15], s33 offen
  s_barrier
  ds_read_b128 v[20:23], v12 offset:0
  ds_read_b128 v[24:27], v12 offset:1152
  ds_read_b128 v[28:31], v12 offset:2304
  ds_read_b128 v[32:35], v12 offset:3456
  s_waitcnt lgkmcnt(0)
  v_pk_add_f32 v[20:21], v[20:21], v[24:25]
  v_pk_add_f32 v[22:23], v[22:23], v[26:27]
  v_pk_add_f32 v[20:21], v[20:21], v[28:29]
  v_pk_add_f32 v[22:23], v[22:23], v[30:31]
  v_pk_add_f32 v[152:153], v[20:21], v[32:33]
  v_pk_add_f32 v[154:155], v[22:23], v[34:35]
  s_mov_b32 s32, 2621440
  s_mov_b32 s33, 327680
  buffer_load_dwordx4 v[36:39], v14, s[4:7], s32 offen sc1
  buffer_load_dwordx4 v[40:43], v15, s[4:7], s32 offen sc1
  buffer_load_dwordx4 v[44:47], v19, s[4:7], s32 offen sc1
L_rowait_280:
  s_waitcnt vmcnt(0)
  v_max3_u32 v9, v39, v43, v47
  v_cmp_eq_u32 vcc, -1, v9
  s_cbranch_vccnz L_roretry_281
  v_pk_add_f32 v[148:149], v[148:149], v[36:37]
  v_pk_add_f32 v[150:151], v[150:151], v[38:39]
  v_pk_add_f32 v[148:149], v[148:149], v[40:41]
  v_pk_add_f32 v[150:151], v[150:151], v[42:43]
  v_pk_add_f32 v[148:149], v[148:149], v[44:45]
  v_pk_add_f32 v[150:151], v[150:151], v[46:47]
  v_sub_f32 v52, 1.0, v86
  v_pk_mul_f32 v[148:149], v[148:149], v[86:87] op_sel_hi:[1,0]
  v_lshlrev_b32 v36, 16, v84
  v_and_b32 v37, 0xffff0000, v84
  v_pk_fma_f32 v[148:149], v[36:37], v[52:53], v[148:149] op_sel_hi:[1,0,1]
  v_cvt_pk_bf16_f32 v56, v148, v149
  v_pk_mul_f32 v[150:151], v[150:151], v[86:87] op_sel_hi:[1,0]
  v_lshlrev_b32 v38, 16, v85
  v_and_b32 v39, 0xffff0000, v85
  v_pk_fma_f32 v[150:151], v[38:39], v[52:53], v[150:151] op_sel_hi:[1,0,1]
  v_cvt_pk_bf16_f32 v57, v150, v151
  buffer_store_dwordx2 v[56:57], v18, s[12:15], s33 offen
  s_barrier
  ds_read_b128 v[20:23], v12 offset:18432
  ds_read_b128 v[24:27], v12 offset:19584
  ds_read_b128 v[28:31], v12 offset:20736
  ds_read_b128 v[32:35], v12 offset:21888
  s_waitcnt lgkmcnt(0)
  v_pk_add_f32 v[20:21], v[20:21], v[24:25]
  v_pk_add_f32 v[22:23], v[22:23], v[26:27]
  v_pk_add_f32 v[20:21], v[20:21], v[28:29]
  v_pk_add_f32 v[22:23], v[22:23], v[30:31]
  v_pk_add_f32 v[156:157], v[20:21], v[32:33]
  v_pk_add_f32 v[158:159], v[22:23], v[34:35]
  s_mov_b32 s32, 3145728
  s_mov_b32 s33, 393216
  buffer_load_dwordx4 v[36:39], v14, s[4:7], s32 offen sc1
  buffer_load_dwordx4 v[40:43], v15, s[4:7], s32 offen sc1
  buffer_load_dwordx4 v[44:47], v19, s[4:7], s32 offen sc1
L_rowait_282:
  s_waitcnt vmcnt(0)
  v_max3_u32 v9, v39, v43, v47
  v_cmp_eq_u32 vcc, -1, v9
  s_cbranch_vccnz L_roretry_283
  v_pk_add_f32 v[152:153], v[152:153], v[36:37]
  v_pk_add_f32 v[154:155], v[154:155], v[38:39]
  v_pk_add_f32 v[152:153], v[152:153], v[40:41]
  v_pk_add_f32 v[154:155], v[154:155], v[42:43]
  v_pk_add_f32 v[152:153], v[152:153], v[44:45]
  v_pk_add_f32 v[154:155], v[154:155], v[46:47]
  v_sub_f32 v52, 1.0, v90
  v_pk_mul_f32 v[152:153], v[152:153], v[90:91] op_sel_hi:[1,0]
  v_lshlrev_b32 v36, 16, v88
  v_and_b32 v37, 0xffff0000, v88
  v_pk_fma_f32 v[152:153], v[36:37], v[52:53], v[152:153] op_sel_hi:[1,0,1]
  v_cvt_pk_bf16_f32 v56, v152, v153
  v_pk_mul_f32 v[154:155], v[154:155], v[90:91] op_sel_hi:[1,0]
  v_lshlrev_b32 v38, 16, v89
  v_and_b32 v39, 0xffff0000, v89
  v_pk_fma_f32 v[154:155], v[38:39], v[52:53], v[154:155] op_sel_hi:[1,0,1]
  v_cvt_pk_bf16_f32 v57, v154, v155
  buffer_store_dwordx2 v[56:57], v18, s[12:15], s33 offen
  s_mov_b32 s32, 3670016
  s_mov_b32 s33, 458752
  buffer_load_dwordx4 v[36:39], v14, s[4:7], s32 offen sc1
  buffer_load_dwordx4 v[40:43], v15, s[4:7], s32 offen sc1
  buffer_load_dwordx4 v[44:47], v19, s[4:7], s32 offen sc1
L_rowait_284:
  s_waitcnt vmcnt(0)
  v_max3_u32 v9, v39, v43, v47
  v_cmp_eq_u32 vcc, -1, v9
  s_cbranch_vccnz L_roretry_285
  v_pk_add_f32 v[156:157], v[156:157], v[36:37]
  v_pk_add_f32 v[158:159], v[158:159], v[38:39]
  v_pk_add_f32 v[156:157], v[156:157], v[40:41]
  v_pk_add_f32 v[158:159], v[158:159], v[42:43]
  v_pk_add_f32 v[156:157], v[156:157], v[44:45]
  v_pk_add_f32 v[158:159], v[158:159], v[46:47]
  v_sub_f32 v52, 1.0, v94
  v_pk_mul_f32 v[156:157], v[156:157], v[94:95] op_sel_hi:[1,0]
  v_lshlrev_b32 v36, 16, v92
  v_and_b32 v37, 0xffff0000, v92
  v_pk_fma_f32 v[156:157], v[36:37], v[52:53], v[156:157] op_sel_hi:[1,0,1]
  v_cvt_pk_bf16_f32 v56, v156, v157
  v_pk_mul_f32 v[158:159], v[158:159], v[94:95] op_sel_hi:[1,0]
  v_lshlrev_b32 v38, 16, v93
  v_and_b32 v39, 0xffff0000, v93
  v_pk_fma_f32 v[158:159], v[38:39], v[52:53], v[158:159] op_sel_hi:[1,0,1]
  v_cvt_pk_bf16_f32 v57, v158, v159
  buffer_store_dwordx2 v[56:57], v18, s[12:15], s33 offen
  s_branch L_roout_233
L_roretry_271:
  buffer_load_dwordx4 v[36:39], v14, s[4:7], s32 offen sc1
  buffer_load_dwordx4 v[40:43], v15, s[4:7], s32 offen sc1
  buffer_load_dwordx4 v[44:47], v19, s[4:7], s32 offen sc1
  s_add_u32 s31, s31, 1
  s_cmp_lt_u32 s31, 1048576
  s_cbranch_scc1 L_rowait_270
  s_branch L_abort
L_roretry_273:
  buffer_load_dwordx4 v[36:39], v14, s[4:7], s32 offen sc1
  buffer_load_dwordx4 v[40:43], v15, s[4:7], s32 offen sc1
  buffer_load_dwordx4 v[44:47], v19, s[4:7], s32 offen sc1
  s_add_u32 s31, s31, 1
  s_cmp_lt_u32 s31, 1048576
  s_cbranch_scc1 L_rowait_272
  s_branch L_abort
L_roretry_275:
  buffer_load_dwordx4 v[36:39], v14, s[4:7], s32 offen sc1
  buffer_load_dwordx4 v[40:43], v15, s[4:7], s32 offen sc1
  buffer_load_dwordx4 v[44:47], v19, s[4:7], s32 offen sc1
  s_add_u32 s31, s31, 1
  s_cmp_lt_u32 s31, 1048576
  s_cbranch_scc1 L_rowait_274
  s_branch L_abort
L_roretry_277:
  buffer_load_dwordx4 v[36:39], v14, s[4:7], s32 offen sc1
  buffer_load_dwordx4 v[40:43], v15, s[4:7], s32 offen sc1
  buffer_load_dwordx4 v[44:47], v19, s[4:7], s32 offen sc1
  s_add_u32 s31, s31, 1
  s_cmp_lt_u32 s31, 1048576
  s_cbranch_scc1 L_rowait_276
  s_branch L_abort
L_roretry_279:
  buffer_load_dwordx4 v[36:39], v14, s[4:7], s32 offen sc1
  buffer_load_dwordx4 v[40:43], v15, s[4:7], s32 offen sc1
  buffer_load_dwordx4 v[44:47], v19, s[4:7], s32 offen sc1
  s_add_u32 s31, s31, 1
  s_cmp_lt_u32 s31, 1048576
  s_cbranch_scc1 L_rowait_278
  s_branch L_abort
L_roretry_281:
  buffer_load_dwordx4 v[36:39], v14, s[4:7], s32 offen sc1
  buffer_load_dwordx4 v[40:43], v15, s[4:7], s32 offen sc1
  buffer_load_dwordx4 v[44:47], v19, s[4:7], s32 offen sc1
  s_add_u32 s31, s31, 1
  s_cmp_lt_u32 s31, 1048576
  s_cbranch_scc1 L_rowait_280
  s_branch L_abort
L_roretry_283:
  buffer_load_dwordx4 v[36:39], v14, s[4:7], s32 offen sc1
  buffer_load_dwordx4 v[40:43], v15, s[4:7], s32 offen sc1
  buffer_load_dwordx4 v[44:47], v19, s[4:7], s32 offen sc1
  s_add_u32 s31, s31, 1
  s_cmp_lt_u32 s31, 1048576
  s_cbranch_scc1 L_rowait_282
  s_branch L_abort
L_roretry_285:
  buffer_load_dwordx4 v[36:39], v14, s[4:7], s32 offen sc1
  buffer_load_dwordx4 v[40:43], v15, s[4:7], s32 offen sc1
  buffer_load_dwordx4 v[44:47], v19, s[4:7], s32 offen sc1
  s_add_u32 s31, s31, 1
  s_cmp_lt_u32 s31, 1048576
  s_cbranch_scc1 L_rowait_284
  s_branch L_abort
L_roout_233:
  s_waitcnt vmcnt(0) lgkmcnt(0)
  s_barrier
  s_setprio 0
  s_add_u32 s24, s24, 4
  s_mov_b32 s87, 2
  s_mov_b32 s59, 0x4000000
  s_mov_b32 s58, 1
  s_branch L_exec_t
  s_branch L_end
  s_endpgm
.p2align 6
.type L_table,@object
L_table:
.long 1152,1440,1760,2080,2400,2688,3008,3328
.long 3648,3968,4256,4544,4832,5120,5408,5696
.long 5920,6112,6304,6528,6752,6976,7200,7456
.long 7712,8000,8288,8576,8864,9120,9344,9600
.long 9856,10144,10464,10784,11104,11392,11712,12032
.long 12352,12672,12960,13248,13536,13824,14112,14400
.long 14624,14816,15008,15232,15456,15680,15904,16160
.long 16416,16704,16992,17280,17568,17824,18048,18304
.long 18560,18848,19168,19488,19808,20128,20448,20736
.long 21024,21312,21600,21888,22176,22496,22816,23104
.long 23328,23520,23712,23936,24160,24384,24608,24864
.long 25120,25408,25696,25984,26272,26528,26752,27008
.long 27264,27552,27872,28192,28512,28832,29152,29440
.long 29728,30016,30304,30592,30880,31200,31520,31808
.long 32032,32224,32416,32640,32864,33088,33312,33568
.long 33824,34112,34400,34688,34976,35232,35456,35712
.long 35968,36000,36032,36064,36096,36128,36160,36192
.long 36224,36256,36288,36320,36352,36384,36416,36448
.long 36480,36512,36544,36576,36608,36640,36672,36704
.long 36736,36768,36800,36832,36864,36896,36928,36960
.long 36992,37024,37056,37088,37120,37152,37184,37216
.long 37248,37280,37312,37344,37376,37408,37440,37472
.long 37504,37536,37568,37600,37632,37664,37696,37728
.long 37760,37792,37824,37856,37888,37920,37952,37984
.long 38016,38048,38080,38112,38144,38176,38208,38240
.long 38272,38304,38336,38368,38400,38432,38464,38496
.long 38528,38560,38592,38624,38656,38688,38720,38752
.long 38784,38816,38848,38880,38912,38944,38976,39008
.long 39040,39072,39104,39136,39168,39200,39232,39264
.long 39296,39328,39360,39392,39424,39456,39488,39520
.long 39552,39584,39616,39648,39680,39712,39744,39776
.long 39808,39840,39872,39904,39936,39968,40000,40032
.long 40096,14,40544,14,40992,14,41440,14,41888,1112,77472,24,78240,24,79008,24,79776,24,0,0,0,0,0,0,0,0,0,0,0,0,0,0
.long 16,0,0,0,0,0,0,2049
.long 8,0,0,0,0,0,0,1
.long 16,256,0,0,0,0,0,2305
.long 9,512,0,0,128,0,0,2562
.long 1,768,256,1,0,0,0,2820
.long 3,0,256,0,0,0,0,4097
.long 7,0,0,4,268435472,0,0,10272
.long 7,24,0,4,318767120,0,0,11040
.long 0,1,0,0,0,0,0,0
.long 16,128,0,0,0,0,0,2049
.long 8,16,0,0,0,0,0,1
.long 16,384,0,0,0,0,0,2305
.long 9,512,128,0,128,0,0,2562
.long 1,1024,256,1,0,0,0,3076
.long 3,256,256,0,0,0,0,4353
.long 7,4,0,4,268435472,0,0,10272
.long 7,28,0,4,318767120,0,0,11040
.long 14,768,0,0,721420544,0,587202624,0
.long 0,0,0,0,0,0,0,0
.long 16,0,128,0,0,0,0,2049
.long 8,32,0,0,0,0,0,1
.long 16,256,128,0,0,0,0,2305
.long 9,512,256,0,128,0,0,2562
.long 1,768,512,1,0,0,0,2820
.long 3,0,512,0,0,0,0,4097
.long 7,8,0,4,285212688,0,0,10528
.long 1,1792,1024,0,0,0,0,3844
.long 14,256,128,0,687866112,0,553648192,0
.long 0,0,0,0,0,0,0,0
.long 16,128,128,0,0,0,0,2049
.long 8,48,0,0,0,0,0,1
.long 16,384,128,0,0,0,0,2305
.long 9,512,384,0,128,0,0,2562
.long 1,1024,512,1,0,0,0,3076
.long 3,256,512,0,0,0,0,4353
.long 7,12,0,4,285212688,0,0,10528
.long 1,1792,1280,1,0,0,0,3844
.long 3,1792,768,0,0,0,0,5889
.long 0,0,0,0,0,0,0,0
.long 16,0,256,0,0,0,0,2049
.long 8,64,0,0,0,0,0,1
.long 16,256,256,0,0,0,0,2305
.long 9,512,512,0,128,0,0,2562
.long 1,768,768,1,0,0,0,2820
.long 3,0,768,1,0,0,0,4097
.long 1,1536,512,1,0,0,0,3588
.long 1,1792,1536,0,0,0,0,3844
.long 0,0,0,0,0,0,0,0
.long 16,128,256,0,0,0,0,2049
.long 8,80,0,0,0,0,0,1
.long 16,384,256,0,0,0,0,2305
.long 9,512,640,0,128,0,0,2562
.long 1,1024,768,1,0,0,0,3076
.long 3,256,768,1,0,0,0,4353
.long 1,1536,768,1,0,0,0,3588
.long 1,1792,1792,0,0,0,0,3844
.long 11,1024,0,0,738197760,0,603979840,0
.long 0,0,0,0,0,0,0,0
.long 16,0,384,0,0,0,0,2049
.long 8,96,0,0,0,0,0,1
.long 16,256,384,0,0,0,0,2305
.long 9,512,768,0,128,0,0,2562
.long 1,768,1024,1,0,0,0,2820
.long 1,1280,0,1,0,0,0,3332
.long 1,1536,1024,1,0,0,0,3588
.long 3,1536,256,0,0,0,0,5633
.long 11,1024,128,0,738197760,0,603979840,0
.long 0,0,0,0,0,0,0,0
.long 16,128,384,0,0,0,0,2049
.long 8,112,0,0,0,0,0,1
.long 16,384,384,0,0,0,0,2305
.long 9,512,896,0,128,0,0,2562
.long 1,1024,1024,1,0,0,0,3076
.long 1,1280,256,1,0,0,0,3332
.long 1,1536,1280,1,0,0,0,3588
.long 3,1792,256,0,0,0,0,5889
.long 11,1152,0,0,738197760,0,603979840,0
.long 0,0,0,0,0,0,0,0
.long 16,0,512,0,0,0,0,2049
.long 8,128,0,0,0,0,0,1
.long 16,256,512,0,0,0,0,2305
.long 9,512,1024,0,128,0,0,2562
.long 1,768,1280,1,0,0,0,2820
.long 1,1280,512,1,0,0,0,3332
.long 1,1536,1536,1,0,0,0,3588
.long 3,1536,512,0,0,0,0,5633
.long 11,1152,128,0,738197760,0,603979840,0
.long 0,0,0,0,0,0,0,0
.long 16,128,512,0,0,0,0,2049
.long 8,144,0,0,0,0,0,1
.long 16,384,512,0,0,0,0,2305
.long 9,512,1152,0,128,0,0,2562
.long 1,1024,1280,1,0,0,0,3076
.long 1,1280,768,1,0,0,0,3332
.long 1,1536,1792,1,0,0,0,3588
.long 3,1792,512,0,0,0,0,5889
.long 0,0,0,0,0,0,0,0
.long 16,0,640,0,0,0,0,2049
.long 8,160,0,0,0,0,0,1
.long 16,256,640,0,0,0,0,2305
.long 9,512,1280,0,128,0,0,2562
.long 1,768,1536,1,0,0,0,2820
.long 1,1280,1024,1,0,0,0,3332
.long 3,1024,0,0,0,0,0,5121
.long 14,0,0,0,671088896,0,536870976,0
.long 0,0,0,0,0,0,0,0
.long 16,128,640,0,0,0,0,2049
.long 8,176,0,0,0,0,0,1
.long 16,384,640,0,0,0,0,2305
.long 9,512,1408,0,128,0,0,2562
.long 1,1024,1536,1,0,0,0,3076
.long 1,1280,1280,1,0,0,0,3332
.long 3,1280,0,0,0,0,0,5377
.long 14,0,128,0,671088896,0,536870976,0
.long 0,0,0,0,0,0,0,0
.long 16,0,768,0,0,0,0,2049
.long 8,192,0,0,0,0,0,1
.long 16,256,768,0,0,0,0,2305
.long 9,512,1536,0,128,0,0,2562
.long 1,768,1792,1,0,0,0,2820
.long 1,1280,1536,1,0,0,0,3332
.long 3,1024,256,1,0,0,0,5121
.long 3,1536,0,0,0,0,0,5633
.long 0,0,0,0,0,0,0,0
.long 16,128,768,0,0,0,0,2049
.long 8,208,0,0,0,0,0,1
.long 16,384,768,0,0,0,0,2305
.long 9,512,1664,0,128,0,0,2562
.long 1,1024,1792,1,0,0,0,3076
.long 1,1280,1792,1,0,0,0,3332
.long 3,1280,256,1,0,0,0,5377
.long 3,1792,0,0,0,0,0,5889
.long 0,0,0,0,0,0,0,0
.long 16,0,896,0,0,0,0,2049
.long 8,224,0,0,0,0,0,1
.long 16,256,896,0,0,0,0,2305
.long 9,512,1792,0,128,0,0,2562
.long 4,512,0,1,0,0,0,6657
.long 3,512,0,1,0,0,0,4609
.long 3,1024,512,1,0,0,0,5121
.long 3,1536,768,0,0,0,0,5633
.long 0,0,0,0,0,0,0,0
.long 16,128,896,0,0,0,0,2049
.long 8,240,0,0,0,0,0,1
.long 16,384,896,0,0,0,0,2305
.long 9,512,1920,0,128,0,0,2562
.long 4,768,0,0,0,0,0,6913
.long 5,256,0,0,419430414,128,0,8464
.long 0,0,0,0,0,0,0,0
.long 16,0,1024,0,0,0,0,2049
.long 8,256,0,0,0,0,0,1
.long 16,256,1024,0,0,0,0,2305
.long 4,0,0,0,128,0,0,6145
.long 5,0,0,0,402653198,128,0,8208
.long 0,0,0,0,0,0,0,0
.long 16,128,1024,0,0,0,0,2049
.long 8,272,0,0,0,0,0,1
.long 16,384,1024,0,0,0,0,2305
.long 4,256,0,0,128,0,0,6401
.long 5,0,256,0,402653198,128,0,8208
.long 0,0,0,0,0,0,0,0
.long 16,0,1152,0,0,0,0,2049
.long 8,288,0,0,0,0,0,1
.long 16,256,1152,0,0,0,0,2305
.long 4,0,256,1,128,0,0,6145
.long 4,512,512,0,0,0,0,6657
.long 5,512,0,0,436207630,128,0,8720
.long 0,0,0,0,0,0,0,0
.long 16,128,1152,0,0,0,0,2049
.long 8,304,0,0,0,0,0,1
.long 16,384,1152,0,0,0,0,2305
.long 4,256,256,1,128,0,0,6401
.long 4,768,512,0,0,0,0,6913
.long 5,512,256,0,436207630,128,0,8720
.long 0,0,0,0,0,0,0,0
.long 16,0,1280,0,0,0,0,2049
.long 8,320,0,0,0,0,0,1
.long 16,256,1280,0,0,0,0,2305
.long 4,0,512,1,128,0,0,6145
.long 4,512,768,0,0,0,0,6657
.long 5,768,0,0,452984846,128,0,8976
.long 0,0,0,0,0,0,0,0
.long 16,128,1280,0,0,0,0,2049
.long 8,336,0,0,0,0,0,1
.long 16,384,1280,0,0,0,0,2305
.long 4,256,512,1,128,0,0,6401
.long 4,768,768,0,0,0,0,6913
.long 5,768,256,0,452984846,128,0,8976
.long 0,0,0,0,0,0,0,0
.long 16,0,1408,0,0,0,0,2049
.long 8,352,0,0,0,0,0,1
.long 16,256,1408,0,0,0,0,2305
.long 4,0,768,1,128,0,0,6145
.long 4,512,1024,1,0,0,0,6657
.long 3,512,512,0,0,0,0,4609
.long 7,16,0,4,301989904,0,0,10784
.long 0,1,0,0,0,0,0,0
.long 16,128,1408,0,0,0,0,2049
.long 8,368,0,0,0,0,0,1
.long 16,384,1408,0,0,0,0,2305
.long 4,256,768,1,128,0,0,6401
.long 4,768,1024,1,0,0,0,6913
.long 3,768,512,0,0,0,0,4865
.long 7,20,0,4,301989904,0,0,10784
.long 0,1,0,0,0,0,0,0
.long 16,0,1536,0,0,0,0,2049
.long 8,384,0,0,0,0,0,1
.long 16,256,1536,0,0,0,0,2305
.long 4,0,1024,1,128,0,0,6145
.long 4,512,1280,1,0,0,0,6657
.long 3,512,768,1,0,0,0,4609
.long 1,1792,0,0,0,0,0,3844
.long 14,768,128,0,721420544,0,587202624,0
.long 0,0,0,0,0,0,0,0
.long 16,128,1536,0,0,0,0,2049
.long 8,400,0,0,0,0,0,1
.long 16,384,1536,0,0,0,0,2305
.long 4,256,1024,1,128,0,0,6401
.long 4,768,1280,1,0,0,0,6913
.long 3,768,768,1,0,0,0,4865
.long 1,1792,256,0,0,0,0,3844
.long 14,512,0,0,704643328,0,570425408,0
.long 0,0,0,0,0,0,0,0
.long 16,0,1664,0,0,0,0,2049
.long 8,416,0,0,0,0,0,1
.long 16,256,1664,0,0,0,0,2305
.long 4,0,1280,1,128,0,0,6145
.long 4,512,1536,1,0,0,0,6657
.long 1,1536,0,1,0,0,0,3588
.long 1,1792,512,0,0,0,0,3844
.long 14,512,128,0,704643328,0,570425408,0
.long 0,0,0,0,0,0,0,0
.long 16,128,1664,0,0,0,0,2049
.long 8,432,0,0,0,0,0,1
.long 16,384,1664,0,0,0,0,2305
.long 4,256,1280,1,128,0,0,6401
.long 4,768,1536,1,0,0,0,6913
.long 1,1536,256,1,0,0,0,3588
.long 1,1792,768,0,0,0,0,3844
.long 14,256,0,0,687866112,0,553648192,0
.long 0,0,0,0,0,0,0,0
.long 16,0,1792,0,0,0,0,2049
.long 8,448,0,0,0,0,0,1
.long 16,256,1792,0,0,0,0,2305
.long 4,0,1536,1,128,0,0,6145
.long 3,0,0,1,0,0,0,4097
.long 3,768,0,1,0,0,0,4865
.long 3,1280,512,0,0,0,0,5377
.long 0,1,0,0,0,0,0,0
.long 16,128,1792,0,0,0,0,2049
.long 8,464,0,0,0,0,0,1
.long 16,384,1792,0,0,0,0,2305
.long 4,256,1536,1,128,0,0,6401
.long 3,256,0,0,0,0,0,4353
.long 5,256,256,0,419430414,128,0,8464
.long 0,0,0,0,0,0,0,0
.long 16,0,1920,0,0,0,0,2049
.long 8,480,0,0,0,0,0,1
.long 16,256,1920,0,0,0,0,2305
.long 1,768,0,1,128,0,0,2820
.long 4,512,256,1,0,0,0,6657
.long 3,512,256,1,0,0,0,4609
.long 3,1024,768,0,0,0,0,5121
.long 0,1,0,0,0,0,0,0
.long 16,128,1920,0,0,0,0,2049
.long 8,496,0,0,0,0,0,1
.long 16,384,1920,0,0,0,0,2305
.long 1,1024,0,1,128,0,0,3076
.long 4,768,256,1,0,0,0,6913
.long 3,768,256,1,0,0,0,4865
.long 3,1280,768,0,0,0,0,5377
.long 0,1,0,0,0,0,0,0
.long 16,0,2048,0,0,0,0,2049
.long 8,512,0,0,0,0,0,1
.long 16,256,2048,0,0,0,0,2305
.long 9,512,2048,0,128,0,0,2562
.long 1,768,2304,1,0,0,0,2820
.long 3,0,1280,0,0,0,0,4097
.long 7,1,0,4,268435472,0,0,10272
.long 7,25,0,4,318767120,0,0,11040
.long 0,1,0,0,0,0,0,0
.long 16,128,2048,0,0,0,0,2049
.long 8,528,0,0,0,0,0,1
.long 16,384,2048,0,0,0,0,2305
.long 9,512,2176,0,128,0,0,2562
.long 1,1024,2304,1,0,0,0,3076
.long 3,256,1280,0,0,0,0,4353
.long 7,5,0,4,268435472,0,0,10272
.long 7,29,0,4,318767120,0,0,11040
.long 14,768,256,0,721420544,0,587202624,0
.long 0,0,0,0,0,0,0,0
.long 16,0,2176,0,0,0,0,2049
.long 8,544,0,0,0,0,0,1
.long 16,256,2176,0,0,0,0,2305
.long 9,512,2304,0,128,0,0,2562
.long 1,768,2560,1,0,0,0,2820
.long 3,0,1536,0,0,0,0,4097
.long 7,9,0,4,285212688,0,0,10528
.long 1,1792,3072,0,0,0,0,3844
.long 14,256,384,0,687866112,0,553648192,0
.long 0,0,0,0,0,0,0,0
.long 16,128,2176,0,0,0,0,2049
.long 8,560,0,0,0,0,0,1
.long 16,384,2176,0,0,0,0,2305
.long 9,512,2432,0,128,0,0,2562
.long 1,1024,2560,1,0,0,0,3076
.long 3,256,1536,0,0,0,0,4353
.long 7,13,0,4,285212688,0,0,10528
.long 1,1792,3328,1,0,0,0,3844
.long 3,1792,1792,0,0,0,0,5889
.long 0,0,0,0,0,0,0,0
.long 16,0,2304,0,0,0,0,2049
.long 8,576,0,0,0,0,0,1
.long 16,256,2304,0,0,0,0,2305
.long 9,512,2560,0,128,0,0,2562
.long 1,768,2816,1,0,0,0,2820
.long 3,0,1792,1,0,0,0,4097
.long 1,1536,2560,1,0,0,0,3588
.long 1,1792,3584,0,0,0,0,3844
.long 0,0,0,0,0,0,0,0
.long 16,128,2304,0,0,0,0,2049
.long 8,592,0,0,0,0,0,1
.long 16,384,2304,0,0,0,0,2305
.long 9,512,2688,0,128,0,0,2562
.long 1,1024,2816,1,0,0,0,3076
.long 3,256,1792,1,0,0,0,4353
.long 1,1536,2816,1,0,0,0,3588
.long 1,1792,3840,0,0,0,0,3844
.long 11,1024,256,0,738197760,0,603979840,0
.long 0,0,0,0,0,0,0,0
.long 16,0,2432,0,0,0,0,2049
.long 8,608,0,0,0,0,0,1
.long 16,256,2432,0,0,0,0,2305
.long 9,512,2816,0,128,0,0,2562
.long 1,768,3072,1,0,0,0,2820
.long 1,1280,2048,1,0,0,0,3332
.long 1,1536,3072,1,0,0,0,3588
.long 3,1536,1280,0,0,0,0,5633
.long 11,1024,384,0,738197760,0,603979840,0
.long 0,0,0,0,0,0,0,0
.long 16,128,2432,0,0,0,0,2049
.long 8,624,0,0,0,0,0,1
.long 16,384,2432,0,0,0,0,2305
.long 9,512,2944,0,128,0,0,2562
.long 1,1024,3072,1,0,0,0,3076
.long 1,1280,2304,1,0,0,0,3332
.long 1,1536,3328,1,0,0,0,3588
.long 3,1792,1280,0,0,0,0,5889
.long 11,1152,256,0,738197760,0,603979840,0
.long 0,0,0,0,0,0,0,0
.long 16,0,2560,0,0,0,0,2049
.long 8,640,0,0,0,0,0,1
.long 16,256,2560,0,0,0,0,2305
.long 9,512,3072,0,128,0,0,2562
.long 1,768,3328,1,0,0,0,2820
.long 1,1280,2560,1,0,0,0,3332
.long 1,1536,3584,1,0,0,0,3588
.long 3,1536,1536,0,0,0,0,5633
.long 11,1152,384,0,738197760,0,603979840,0
.long 0,0,0,0,0,0,0,0
.long 16,128,2560,0,0,0,0,2049
.long 8,656,0,0,0,0,0,1
.long 16,384,2560,0,0,0,0,2305
.long 9,512,3200,0,128,0,0,2562
.long 1,1024,3328,1,0,0,0,3076
.long 1,1280,2816,1,0,0,0,3332
.long 1,1536,3840,1,0,0,0,3588
.long 3,1792,1536,0,0,0,0,5889
.long 0,0,0,0,0,0,0,0
.long 16,0,2688,0,0,0,0,2049
.long 8,672,0,0,0,0,0,1
.long 16,256,2688,0,0,0,0,2305
.long 9,512,3328,0,128,0,0,2562
.long 1,768,3584,1,0,0,0,2820
.long 1,1280,3072,1,0,0,0,3332
.long 3,1024,1024,0,0,0,0,5121
.long 14,0,256,0,671088896,0,536870976,0
.long 0,0,0,0,0,0,0,0
.long 16,128,2688,0,0,0,0,2049
.long 8,688,0,0,0,0,0,1
.long 16,384,2688,0,0,0,0,2305
.long 9,512,3456,0,128,0,0,2562
.long 1,1024,3584,1,0,0,0,3076
.long 1,1280,3328,1,0,0,0,3332
.long 3,1280,1024,0,0,0,0,5377
.long 14,0,384,0,671088896,0,536870976,0
.long 0,0,0,0,0,0,0,0
.long 16,0,2816,0,0,0,0,2049
.long 8,704,0,0,0,0,0,1
.long 16,256,2816,0,0,0,0,2305
.long 9,512,3584,0,128,0,0,2562
.long 1,768,3840,1,0,0,0,2820
.long 1,1280,3584,1,0,0,0,3332
.long 3,1024,1280,1,0,0,0,5121
.long 3,1536,1024,0,0,0,0,5633
.long 0,0,0,0,0,0,0,0
.long 16,128,2816,0,0,0,0,2049
.long 8,720,0,0,0,0,0,1
.long 16,384,2816,0,0,0,0,2305
.long 9,512,3712,0,128,0,0,2562
.long 1,1024,3840,1,0,0,0,3076
.long 1,1280,3840,1,0,0,0,3332
.long 3,1280,1280,1,0,0,0,5377
.long 3,1792,1024,0,0,0,0,5889
.long 0,0,0,0,0,0,0,0
.long 16,0,2944,0,0,0,0,2049
.long 8,736,0,0,0,0,0,1
.long 16,256,2944,0,0,0,0,2305
.long 9,512,3840,0,128,0,0,2562
.long 4,1536,0,1,0,0,0,7681
.long 3,512,1024,1,0,0,0,4609
.long 3,1024,1536,1,0,0,0,5121
.long 3,1536,1792,0,0,0,0,5633
.long 0,0,0,0,0,0,0,0
.long 16,128,2944,0,0,0,0,2049
.long 8,752,0,0,0,0,0,1
.long 16,384,2944,0,0,0,0,2305
.long 9,512,3968,0,128,0,0,2562
.long 4,1792,0,0,0,0,0,7937
.long 5,1280,0,0,486539278,128,0,9488
.long 0,0,0,0,0,0,0,0
.long 16,0,3072,0,0,0,0,2049
.long 8,768,0,0,0,0,0,1
.long 16,256,3072,0,0,0,0,2305
.long 4,1024,0,0,128,0,0,7169
.long 5,1024,0,0,469762062,128,0,9232
.long 0,0,0,0,0,0,0,0
.long 16,128,3072,0,0,0,0,2049
.long 8,784,0,0,0,0,0,1
.long 16,384,3072,0,0,0,0,2305
.long 4,1280,0,0,128,0,0,7425
.long 5,1024,256,0,469762062,128,0,9232
.long 0,0,0,0,0,0,0,0
.long 16,0,3200,0,0,0,0,2049
.long 8,800,0,0,0,0,0,1
.long 16,256,3200,0,0,0,0,2305
.long 4,1024,256,1,128,0,0,7169
.long 4,1536,512,0,0,0,0,7681
.long 5,1536,0,0,503316494,128,0,9744
.long 0,0,0,0,0,0,0,0
.long 16,128,3200,0,0,0,0,2049
.long 8,816,0,0,0,0,0,1
.long 16,384,3200,0,0,0,0,2305
.long 4,1280,256,1,128,0,0,7425
.long 4,1792,512,0,0,0,0,7937
.long 5,1536,256,0,503316494,128,0,9744
.long 0,0,0,0,0,0,0,0
.long 16,0,3328,0,0,0,0,2049
.long 8,832,0,0,0,0,0,1
.long 16,256,3328,0,0,0,0,2305
.long 4,1024,512,1,128,0,0,7169
.long 4,1536,768,0,0,0,0,7681
.long 5,1792,0,0,520093710,128,0,10000
.long 0,0,0,0,0,0,0,0
.long 16,128,3328,0,0,0,0,2049
.long 8,848,0,0,0,0,0,1
.long 16,384,3328,0,0,0,0,2305
.long 4,1280,512,1,128,0,0,7425
.long 4,1792,768,0,0,0,0,7937
.long 5,1792,256,0,520093710,128,0,10000
.long 0,0,0,0,0,0,0,0
.long 16,0,3456,0,0,0,0,2049
.long 8,864,0,0,0,0,0,1
.long 16,256,3456,0,0,0,0,2305
.long 4,1024,768,1,128,0,0,7169
.long 4,1536,1024,1,0,0,0,7681
.long 3,512,1536,0,0,0,0,4609
.long 7,17,0,4,301989904,0,0,10784
.long 0,1,0,0,0,0,0,0
.long 16,128,3456,0,0,0,0,2049
.long 8,880,0,0,0,0,0,1
.long 16,384,3456,0,0,0,0,2305
.long 4,1280,768,1,128,0,0,7425
.long 4,1792,1024,1,0,0,0,7937
.long 3,768,1536,0,0,0,0,4865
.long 7,21,0,4,301989904,0,0,10784
.long 0,1,0,0,0,0,0,0
.long 16,0,3584,0,0,0,0,2049
.long 8,896,0,0,0,0,0,1
.long 16,256,3584,0,0,0,0,2305
.long 4,1024,1024,1,128,0,0,7169
.long 4,1536,1280,1,0,0,0,7681
.long 3,512,1792,1,0,0,0,4609
.long 1,1792,2048,0,0,0,0,3844
.long 14,768,384,0,721420544,0,587202624,0
.long 0,0,0,0,0,0,0,0
.long 16,128,3584,0,0,0,0,2049
.long 8,912,0,0,0,0,0,1
.long 16,384,3584,0,0,0,0,2305
.long 4,1280,1024,1,128,0,0,7425
.long 4,1792,1280,1,0,0,0,7937
.long 3,768,1792,1,0,0,0,4865
.long 1,1792,2304,0,0,0,0,3844
.long 14,512,256,0,704643328,0,570425408,0
.long 0,0,0,0,0,0,0,0
.long 16,0,3712,0,0,0,0,2049
.long 8,928,0,0,0,0,0,1
.long 16,256,3712,0,0,0,0,2305
.long 4,1024,1280,1,128,0,0,7169
.long 4,1536,1536,1,0,0,0,7681
.long 1,1536,2048,1,0,0,0,3588
.long 1,1792,2560,0,0,0,0,3844
.long 14,512,384,0,704643328,0,570425408,0
.long 0,0,0,0,0,0,0,0
.long 16,128,3712,0,0,0,0,2049
.long 8,944,0,0,0,0,0,1
.long 16,384,3712,0,0,0,0,2305
.long 4,1280,1280,1,128,0,0,7425
.long 4,1792,1536,1,0,0,0,7937
.long 1,1536,2304,1,0,0,0,3588
.long 1,1792,2816,0,0,0,0,3844
.long 14,256,256,0,687866112,0,553648192,0
.long 0,0,0,0,0,0,0,0
.long 16,0,3840,0,0,0,0,2049
.long 8,960,0,0,0,0,0,1
.long 16,256,3840,0,0,0,0,2305
.long 4,1024,1536,1,128,0,0,7169
.long 3,0,1024,1,0,0,0,4097
.long 3,768,1024,1,0,0,0,4865
.long 3,1280,1536,0,0,0,0,5377
.long 0,1,0,0,0,0,0,0
.long 16,128,3840,0,0,0,0,2049
.long 8,976,0,0,0,0,0,1
.long 16,384,3840,0,0,0,0,2305
.long 4,1280,1536,1,128,0,0,7425
.long 3,256,1024,0,0,0,0,4353
.long 5,1280,256,0,486539278,128,0,9488
.long 0,0,0,0,0,0,0,0
.long 16,0,3968,0,0,0,0,2049
.long 8,992,0,0,0,0,0,1
.long 16,256,3968,0,0,0,0,2305
.long 1,768,2048,1,128,0,0,2820
.long 4,1536,256,1,0,0,0,7681
.long 3,512,1280,1,0,0,0,4609
.long 3,1024,1792,0,0,0,0,5121
.long 0,1,0,0,0,0,0,0
.long 16,128,3968,0,0,0,0,2049
.long 8,1008,0,0,0,0,0,1
.long 16,384,3968,0,0,0,0,2305
.long 1,1024,2048,1,128,0,0,3076
.long 4,1792,256,1,0,0,0,7937
.long 3,768,1280,1,0,0,0,4865
.long 3,1280,1792,0,0,0,0,5377
.long 0,1,0,0,0,0,0,0
.long 17,0,0,0,0,0,0,2049
.long 8,1024,0,0,0,0,0,1
.long 17,256,0,0,0,0,0,2305
.long 10,512,0,0,128,0,0,2562
.long 2,768,256,1,0,0,0,2820
.long 3,0,2304,0,0,0,0,4097
.long 7,2,0,4,268435472,0,0,10272
.long 7,26,0,4,318767120,0,0,11040
.long 0,1,0,0,0,0,0,0
.long 17,128,0,0,0,0,0,2049
.long 8,1040,0,0,0,0,0,1
.long 17,384,0,0,0,0,0,2305
.long 10,512,128,0,128,0,0,2562
.long 2,1024,256,1,0,0,0,3076
.long 3,256,2304,0,0,0,0,4353
.long 7,6,0,4,268435472,0,0,10272
.long 7,30,0,4,318767120,0,0,11040
.long 14,768,512,0,721420544,0,587202624,0
.long 0,0,0,0,0,0,0,0
.long 17,0,128,0,0,0,0,2049
.long 8,1056,0,0,0,0,0,1
.long 17,256,128,0,0,0,0,2305
.long 10,512,256,0,128,0,0,2562
.long 2,768,512,1,0,0,0,2820
.long 3,0,2560,0,0,0,0,4097
.long 7,10,0,4,285212688,0,0,10528
.long 2,1792,1024,0,0,0,0,3844
.long 14,256,640,0,687866112,0,553648192,0
.long 0,0,0,0,0,0,0,0
.long 17,128,128,0,0,0,0,2049
.long 8,1072,0,0,0,0,0,1
.long 17,384,128,0,0,0,0,2305
.long 10,512,384,0,128,0,0,2562
.long 2,1024,512,1,0,0,0,3076
.long 3,256,2560,0,0,0,0,4353
.long 7,14,0,4,285212688,0,0,10528
.long 2,1792,1280,1,0,0,0,3844
.long 3,1792,2816,0,0,0,0,5889
.long 0,0,0,0,0,0,0,0
.long 17,0,256,0,0,0,0,2049
.long 8,1088,0,0,0,0,0,1
.long 17,256,256,0,0,0,0,2305
.long 10,512,512,0,128,0,0,2562
.long 2,768,768,1,0,0,0,2820
.long 3,0,2816,1,0,0,0,4097
.long 2,1536,512,1,0,0,0,3588
.long 2,1792,1536,0,0,0,0,3844
.long 11,1152,512,0,738197760,0,603979840,0
.long 0,0,0,0,0,0,0,0
.long 17,128,256,0,0,0,0,2049
.long 8,1104,0,0,0,0,0,1
.long 17,384,256,0,0,0,0,2305
.long 10,512,640,0,128,0,0,2562
.long 2,1024,768,1,0,0,0,3076
.long 3,256,2816,1,0,0,0,4353
.long 2,1536,768,1,0,0,0,3588
.long 2,1792,1792,0,0,0,0,3844
.long 11,1152,640,0,738197760,0,603979840,0
.long 0,0,0,0,0,0,0,0
.long 17,0,384,0,0,0,0,2049
.long 8,1120,0,0,0,0,0,1
.long 17,256,384,0,0,0,0,2305
.long 10,512,768,0,128,0,0,2562
.long 2,768,1024,1,0,0,0,2820
.long 2,1280,0,1,0,0,0,3332
.long 2,1536,1024,1,0,0,0,3588
.long 3,1536,2304,0,0,0,0,5633
.long 0,0,0,0,0,0,0,0
.long 17,128,384,0,0,0,0,2049
.long 8,1136,0,0,0,0,0,1
.long 17,384,384,0,0,0,0,2305
.long 10,512,896,0,128,0,0,2562
.long 2,1024,1024,1,0,0,0,3076
.long 2,1280,256,1,0,0,0,3332
.long 2,1536,1280,1,0,0,0,3588
.long 3,1792,2304,0,0,0,0,5889
.long 0,0,0,0,0,0,0,0
.long 17,0,512,0,0,0,0,2049
.long 8,1152,0,0,0,0,0,1
.long 17,256,512,0,0,0,0,2305
.long 10,512,1024,0,128,0,0,2562
.long 2,768,1280,1,0,0,0,2820
.long 2,1280,512,1,0,0,0,3332
.long 2,1536,1536,1,0,0,0,3588
.long 3,1536,2560,0,0,0,0,5633
.long 0,0,0,0,0,0,0,0
.long 17,128,512,0,0,0,0,2049
.long 8,1168,0,0,0,0,0,1
.long 17,384,512,0,0,0,0,2305
.long 10,512,1152,0,128,0,0,2562
.long 2,1024,1280,1,0,0,0,3076
.long 2,1280,768,1,0,0,0,3332
.long 2,1536,1792,1,0,0,0,3588
.long 3,1792,2560,0,0,0,0,5889
.long 0,0,0,0,0,0,0,0
.long 17,0,640,0,0,0,0,2049
.long 8,1184,0,0,0,0,0,1
.long 17,256,640,0,0,0,0,2305
.long 10,512,1280,0,128,0,0,2562
.long 2,768,1536,1,0,0,0,2820
.long 2,1280,1024,1,0,0,0,3332
.long 3,1024,2048,0,0,0,0,5121
.long 14,0,512,0,671088896,0,536870976,0
.long 0,0,0,0,0,0,0,0
.long 17,128,640,0,0,0,0,2049
.long 8,1200,0,0,0,0,0,1
.long 17,384,640,0,0,0,0,2305
.long 10,512,1408,0,128,0,0,2562
.long 2,1024,1536,1,0,0,0,3076
.long 2,1280,1280,1,0,0,0,3332
.long 3,1280,2048,0,0,0,0,5377
.long 14,0,640,0,671088896,0,536870976,0
.long 0,0,0,0,0,0,0,0
.long 17,0,768,0,0,0,0,2049
.long 8,1216,0,0,0,0,0,1
.long 17,256,768,0,0,0,0,2305
.long 10,512,1536,0,128,0,0,2562
.long 2,768,1792,1,0,0,0,2820
.long 2,1280,1536,1,0,0,0,3332
.long 3,1024,2304,1,0,0,0,5121
.long 3,1536,2048,0,0,0,0,5633
.long 11,1024,512,0,738197760,0,603979840,0
.long 0,0,0,0,0,0,0,0
.long 17,128,768,0,0,0,0,2049
.long 8,1232,0,0,0,0,0,1
.long 17,384,768,0,0,0,0,2305
.long 10,512,1664,0,128,0,0,2562
.long 2,1024,1792,1,0,0,0,3076
.long 2,1280,1792,1,0,0,0,3332
.long 3,1280,2304,1,0,0,0,5377
.long 3,1792,2048,0,0,0,0,5889
.long 11,1024,640,0,738197760,0,603979840,0
.long 0,0,0,0,0,0,0,0
.long 17,0,896,0,0,0,0,2049
.long 8,1248,0,0,0,0,0,1
.long 17,256,896,0,0,0,0,2305
.long 10,512,1792,0,128,0,0,2562
.long 4,512,1792,1,0,0,0,6657
.long 3,512,2048,1,0,0,0,4609
.long 3,1024,2560,1,0,0,0,5121
.long 3,1536,2816,0,0,0,0,5633
.long 0,0,0,0,0,0,0,0
.long 17,128,896,0,0,0,0,2049
.long 8,1264,0,0,0,0,0,1
.long 17,384,896,0,0,0,0,2305
.long 10,512,1920,0,128,0,0,2562
.long 4,768,1792,0,0,0,0,6913
.long 5,256,512,0,419430414,128,0,8464
.long 0,0,0,0,0,0,0,0
.long 17,0,1024,0,0,0,0,2049
.long 8,1280,0,0,0,0,0,1
.long 17,256,1024,0,0,0,0,2305
.long 4,0,1792,0,128,0,0,6145
.long 5,0,512,0,402653198,128,0,8208
.long 0,0,0,0,0,0,0,0
.long 17,128,1024,0,0,0,0,2049
.long 8,1296,0,0,0,0,0,1
.long 17,384,1024,0,0,0,0,2305
.long 4,256,1792,0,128,0,0,6401
.long 5,0,768,0,402653198,128,0,8208
.long 0,0,0,0,0,0,0,0
.long 17,0,1152,0,0,0,0,2049
.long 8,1312,0,0,0,0,0,1
.long 17,256,1152,0,0,0,0,2305
.long 4,0,2048,1,128,0,0,6145
.long 4,512,2304,0,0,0,0,6657
.long 5,512,512,0,436207630,128,0,8720
.long 0,0,0,0,0,0,0,0
.long 17,128,1152,0,0,0,0,2049
.long 8,1328,0,0,0,0,0,1
.long 17,384,1152,0,0,0,0,2305
.long 4,256,2048,1,128,0,0,6401
.long 4,768,2304,0,0,0,0,6913
.long 5,512,768,0,436207630,128,0,8720
.long 0,0,0,0,0,0,0,0
.long 17,0,1280,0,0,0,0,2049
.long 8,1344,0,0,0,0,0,1
.long 17,256,1280,0,0,0,0,2305
.long 4,0,2304,1,128,0,0,6145
.long 4,512,2560,0,0,0,0,6657
.long 5,768,512,0,452984846,128,0,8976
.long 0,0,0,0,0,0,0,0
.long 17,128,1280,0,0,0,0,2049
.long 8,1360,0,0,0,0,0,1
.long 17,384,1280,0,0,0,0,2305
.long 4,256,2304,1,128,0,0,6401
.long 4,768,2560,0,0,0,0,6913
.long 5,768,768,0,452984846,128,0,8976
.long 0,0,0,0,0,0,0,0
.long 17,0,1408,0,0,0,0,2049
.long 8,1376,0,0,0,0,0,1
.long 17,256,1408,0,0,0,0,2305
.long 4,0,2560,1,128,0,0,6145
.long 4,512,2816,1,0,0,0,6657
.long 3,512,2560,0,0,0,0,4609
.long 7,18,0,4,301989904,0,0,10784
.long 0,1,0,0,0,0,0,0
.long 17,128,1408,0,0,0,0,2049
.long 8,1392,0,0,0,0,0,1
.long 17,384,1408,0,0,0,0,2305
.long 4,256,2560,1,128,0,0,6401
.long 4,768,2816,1,0,0,0,6913
.long 3,768,2560,0,0,0,0,4865
.long 7,22,0,4,301989904,0,0,10784
.long 0,1,0,0,0,0,0,0
.long 17,0,1536,0,0,0,0,2049
.long 8,1408,0,0,0,0,0,1
.long 17,256,1536,0,0,0,0,2305
.long 4,0,2816,1,128,0,0,6145
.long 4,512,3072,1,0,0,0,6657
.long 3,512,2816,1,0,0,0,4609
.long 2,1792,0,0,0,0,0,3844
.long 14,768,640,0,721420544,0,587202624,0
.long 0,0,0,0,0,0,0,0
.long 17,128,1536,0,0,0,0,2049
.long 8,1424,0,0,0,0,0,1
.long 17,384,1536,0,0,0,0,2305
.long 4,256,2816,1,128,0,0,6401
.long 4,768,3072,1,0,0,0,6913
.long 3,768,2816,1,0,0,0,4865
.long 2,1792,256,0,0,0,0,3844
.long 14,512,512,0,704643328,0,570425408,0
.long 0,0,0,0,0,0,0,0
.long 17,0,1664,0,0,0,0,2049
.long 8,1440,0,0,0,0,0,1
.long 17,256,1664,0,0,0,0,2305
.long 4,0,3072,1,128,0,0,6145
.long 4,512,3328,1,0,0,0,6657
.long 2,1536,0,1,0,0,0,3588
.long 2,1792,512,0,0,0,0,3844
.long 14,512,640,0,704643328,0,570425408,0
.long 0,0,0,0,0,0,0,0
.long 17,128,1664,0,0,0,0,2049
.long 8,1456,0,0,0,0,0,1
.long 17,384,1664,0,0,0,0,2305
.long 4,256,3072,1,128,0,0,6401
.long 4,768,3328,1,0,0,0,6913
.long 2,1536,256,1,0,0,0,3588
.long 2,1792,768,0,0,0,0,3844
.long 14,256,512,0,687866112,0,553648192,0
.long 0,0,0,0,0,0,0,0
.long 17,0,1792,0,0,0,0,2049
.long 8,1472,0,0,0,0,0,1
.long 17,256,1792,0,0,0,0,2305
.long 4,0,3328,1,128,0,0,6145
.long 3,0,2048,1,0,0,0,4097
.long 3,768,2048,1,0,0,0,4865
.long 3,1280,2560,0,0,0,0,5377
.long 0,1,0,0,0,0,0,0
.long 17,128,1792,0,0,0,0,2049
.long 8,1488,0,0,0,0,0,1
.long 17,384,1792,0,0,0,0,2305
.long 4,256,3328,1,128,0,0,6401
.long 3,256,2048,0,0,0,0,4353
.long 5,256,768,0,419430414,128,0,8464
.long 0,0,0,0,0,0,0,0
.long 17,0,1920,0,0,0,0,2049
.long 8,1504,0,0,0,0,0,1
.long 17,256,1920,0,0,0,0,2305
.long 2,768,0,1,128,0,0,2820
.long 4,512,2048,1,0,0,0,6657
.long 3,512,2304,1,0,0,0,4609
.long 3,1024,2816,0,0,0,0,5121
.long 0,1,0,0,0,0,0,0
.long 17,128,1920,0,0,0,0,2049
.long 8,1520,0,0,0,0,0,1
.long 17,384,1920,0,0,0,0,2305
.long 2,1024,0,1,128,0,0,3076
.long 4,768,2048,1,0,0,0,6913
.long 3,768,2304,1,0,0,0,4865
.long 3,1280,2816,0,0,0,0,5377
.long 0,1,0,0,0,0,0,0
.long 17,0,2048,0,0,0,0,2049
.long 8,1536,0,0,0,0,0,1
.long 17,256,2048,0,0,0,0,2305
.long 10,512,2048,0,128,0,0,2562
.long 2,768,2304,1,0,0,0,2820
.long 3,0,3328,0,0,0,0,4097
.long 7,3,0,4,268435472,0,0,10272
.long 7,27,0,4,318767120,0,0,11040
.long 0,1,0,0,0,0,0,0
.long 17,128,2048,0,0,0,0,2049
.long 8,1552,0,0,0,0,0,1
.long 17,384,2048,0,0,0,0,2305
.long 10,512,2176,0,128,0,0,2562
.long 2,1024,2304,1,0,0,0,3076
.long 3,256,3328,0,0,0,0,4353
.long 7,7,0,4,268435472,0,0,10272
.long 7,31,0,4,318767120,0,0,11040
.long 14,768,768,0,721420544,0,587202624,0
.long 0,0,0,0,0,0,0,0
.long 17,0,2176,0,0,0,0,2049
.long 8,1568,0,0,0,0,0,1
.long 17,256,2176,0,0,0,0,2305
.long 10,512,2304,0,128,0,0,2562
.long 2,768,2560,1,0,0,0,2820
.long 3,0,3584,0,0,0,0,4097
.long 7,11,0,4,285212688,0,0,10528
.long 2,1792,3072,0,0,0,0,3844
.long 14,256,896,0,687866112,0,553648192,0
.long 0,0,0,0,0,0,0,0
.long 17,128,2176,0,0,0,0,2049
.long 8,1584,0,0,0,0,0,1
.long 17,384,2176,0,0,0,0,2305
.long 10,512,2432,0,128,0,0,2562
.long 2,1024,2560,1,0,0,0,3076
.long 3,256,3584,0,0,0,0,4353
.long 7,15,0,4,285212688,0,0,10528
.long 2,1792,3328,1,0,0,0,3844
.long 3,1792,3840,0,0,0,0,5889
.long 0,0,0,0,0,0,0,0
.long 17,0,2304,0,0,0,0,2049
.long 8,1600,0,0,0,0,0,1
.long 17,256,2304,0,0,0,0,2305
.long 10,512,2560,0,128,0,0,2562
.long 2,768,2816,1,0,0,0,2820
.long 3,0,3840,1,0,0,0,4097
.long 2,1536,2560,1,0,0,0,3588
.long 2,1792,3584,0,0,0,0,3844
.long 11,1152,768,0,738197760,0,603979840,0
.long 0,0,0,0,0,0,0,0
.long 17,128,2304,0,0,0,0,2049
.long 8,1616,0,0,0,0,0,1
.long 17,384,2304,0,0,0,0,2305
.long 10,512,2688,0,128,0,0,2562
.long 2,1024,2816,1,0,0,0,3076
.long 3,256,3840,1,0,0,0,4353
.long 2,1536,2816,1,0,0,0,3588
.long 2,1792,3840,0,0,0,0,3844
.long 11,1152,896,0,738197760,0,603979840,0
.long 0,0,0,0,0,0,0,0
.long 17,0,2432,0,0,0,0,2049
.long 8,1632,0,0,0,0,0,1
.long 17,256,2432,0,0,0,0,2305
.long 10,512,2816,0,128,0,0,2562
.long 2,768,3072,1,0,0,0,2820
.long 2,1280,2048,1,0,0,0,3332
.long 2,1536,3072,1,0,0,0,3588
.long 3,1536,3328,0,0,0,0,5633
.long 0,0,0,0,0,0,0,0
.long 17,128,2432,0,0,0,0,2049
.long 8,1648,0,0,0,0,0,1
.long 17,384,2432,0,0,0,0,2305
.long 10,512,2944,0,128,0,0,2562
.long 2,1024,3072,1,0,0,0,3076
.long 2,1280,2304,1,0,0,0,3332
.long 2,1536,3328,1,0,0,0,3588
.long 3,1792,3328,0,0,0,0,5889
.long 0,0,0,0,0,0,0,0
.long 17,0,2560,0,0,0,0,2049
.long 8,1664,0,0,0,0,0,1
.long 17,256,2560,0,0,0,0,2305
.long 10,512,3072,0,128,0,0,2562
.long 2,768,3328,1,0,0,0,2820
.long 2,1280,2560,1,0,0,0,3332
.long 2,1536,3584,1,0,0,0,3588
.long 3,1536,3584,0,0,0,0,5633
.long 0,0,0,0,0,0,0,0
.long 17,128,2560,0,0,0,0,2049
.long 8,1680,0,0,0,0,0,1
.long 17,384,2560,0,0,0,0,2305
.long 10,512,3200,0,128,0,0,2562
.long 2,1024,3328,1,0,0,0,3076
.long 2,1280,2816,1,0,0,0,3332
.long 2,1536,3840,1,0,0,0,3588
.long 3,1792,3584,0,0,0,0,5889
.long 0,0,0,0,0,0,0,0
.long 17,0,2688,0,0,0,0,2049
.long 8,1696,0,0,0,0,0,1
.long 17,256,2688,0,0,0,0,2305
.long 10,512,3328,0,128,0,0,2562
.long 2,768,3584,1,0,0,0,2820
.long 2,1280,3072,1,0,0,0,3332
.long 3,1024,3072,0,0,0,0,5121
.long 14,0,768,0,671088896,0,536870976,0
.long 0,0,0,0,0,0,0,0
.long 17,128,2688,0,0,0,0,2049
.long 8,1712,0,0,0,0,0,1
.long 17,384,2688,0,0,0,0,2305
.long 10,512,3456,0,128,0,0,2562
.long 2,1024,3584,1,0,0,0,3076
.long 2,1280,3328,1,0,0,0,3332
.long 3,1280,3072,0,0,0,0,5377
.long 14,0,896,0,671088896,0,536870976,0
.long 0,0,0,0,0,0,0,0
.long 17,0,2816,0,0,0,0,2049
.long 8,1728,0,0,0,0,0,1
.long 17,256,2816,0,0,0,0,2305
.long 10,512,3584,0,128,0,0,2562
.long 2,768,3840,1,0,0,0,2820
.long 2,1280,3584,1,0,0,0,3332
.long 3,1024,3328,1,0,0,0,5121
.long 3,1536,3072,0,0,0,0,5633
.long 11,1024,768,0,738197760,0,603979840,0
.long 0,0,0,0,0,0,0,0
.long 17,128,2816,0,0,0,0,2049
.long 8,1744,0,0,0,0,0,1
.long 17,384,2816,0,0,0,0,2305
.long 10,512,3712,0,128,0,0,2562
.long 2,1024,3840,1,0,0,0,3076
.long 2,1280,3840,1,0,0,0,3332
.long 3,1280,3328,1,0,0,0,5377
.long 3,1792,3072,0,0,0,0,5889
.long 11,1024,896,0,738197760,0,603979840,0
.long 0,0,0,0,0,0,0,0
.long 17,0,2944,0,0,0,0,2049
.long 8,1760,0,0,0,0,0,1
.long 17,256,2944,0,0,0,0,2305
.long 10,512,3840,0,128,0,0,2562
.long 4,1536,1792,1,0,0,0,7681
.long 3,512,3072,1,0,0,0,4609
.long 3,1024,3584,1,0,0,0,5121
.long 3,1536,3840,0,0,0,0,5633
.long 0,0,0,0,0,0,0,0
.long 17,128,2944,0,0,0,0,2049
.long 8,1776,0,0,0,0,0,1
.long 17,384,2944,0,0,0,0,2305
.long 10,512,3968,0,128,0,0,2562
.long 4,1792,1792,0,0,0,0,7937
.long 5,1280,512,0,486539278,128,0,9488
.long 0,0,0,0,0,0,0,0
.long 17,0,3072,0,0,0,0,2049
.long 8,1792,0,0,0,0,0,1
.long 17,256,3072,0,0,0,0,2305
.long 4,1024,1792,0,128,0,0,7169
.long 5,1024,512,0,469762062,128,0,9232
.long 0,0,0,0,0,0,0,0
.long 17,128,3072,0,0,0,0,2049
.long 8,1808,0,0,0,0,0,1
.long 17,384,3072,0,0,0,0,2305
.long 4,1280,1792,0,128,0,0,7425
.long 5,1024,768,0,469762062,128,0,9232
.long 0,0,0,0,0,0,0,0
.long 17,0,3200,0,0,0,0,2049
.long 8,1824,0,0,0,0,0,1
.long 17,256,3200,0,0,0,0,2305
.long 4,1024,2048,1,128,0,0,7169
.long 4,1536,2304,0,0,0,0,7681
.long 5,1536,512,0,503316494,128,0,9744
.long 0,0,0,0,0,0,0,0
.long 17,128,3200,0,0,0,0,2049
.long 8,1840,0,0,0,0,0,1
.long 17,384,3200,0,0,0,0,2305
.long 4,1280,2048,1,128,0,0,7425
.long 4,1792,2304,0,0,0,0,7937
.long 5,1536,768,0,503316494,128,0,9744
.long 0,0,0,0,0,0,0,0
.long 17,0,3328,0,0,0,0,2049
.long 8,1856,0,0,0,0,0,1
.long 17,256,3328,0,0,0,0,2305
.long 4,1024,2304,1,128,0,0,7169
.long 4,1536,2560,0,0,0,0,7681
.long 5,1792,512,0,520093710,128,0,10000
.long 0,0,0,0,0,0,0,0
.long 17,128,3328,0,0,0,0,2049
.long 8,1872,0,0,0,0,0,1
.long 17,384,3328,0,0,0,0,2305
.long 4,1280,2304,1,128,0,0,7425
.long 4,1792,2560,0,0,0,0,7937
.long 5,1792,768,0,520093710,128,0,10000
.long 0,0,0,0,0,0,0,0
.long 17,0,3456,0,0,0,0,2049
.long 8,1888,0,0,0,0,0,1
.long 17,256,3456,0,0,0,0,2305
.long 4,1024,2560,1,128,0,0,7169
.long 4,1536,2816,1,0,0,0,7681
.long 3,512,3584,0,0,0,0,4609
.long 7,19,0,4,301989904,0,0,10784
.long 0,1,0,0,0,0,0,0
.long 17,128,3456,0,0,0,0,2049
.long 8,1904,0,0,0,0,0,1
.long 17,384,3456,0,0,0,0,2305
.long 4,1280,2560,1,128,0,0,7425
.long 4,1792,2816,1,0,0,0,7937
.long 3,768,3584,0,0,0,0,4865
.long 7,23,0,4,301989904,0,0,10784
.long 0,1,0,0,0,0,0,0
.long 17,0,3584,0,0,0,0,2049
.long 8,1920,0,0,0,0,0,1
.long 17,256,3584,0,0,0,0,2305
.long 4,1024,2816,1,128,0,0,7169
.long 4,1536,3072,1,0,0,0,7681
.long 3,512,3840,1,0,0,0,4609
.long 2,1792,2048,0,0,0,0,3844
.long 14,768,896,0,721420544,0,587202624,0
.long 0,0,0,0,0,0,0,0
.long 17,128,3584,0,0,0,0,2049
.long 8,1936,0,0,0,0,0,1
.long 17,384,3584,0,0,0,0,2305
.long 4,1280,2816,1,128,0,0,7425
.long 4,1792,3072,1,0,0,0,7937
.long 3,768,3840,1,0,0,0,4865
.long 2,1792,2304,0,0,0,0,3844
.long 14,512,768,0,704643328,0,570425408,0
.long 0,0,0,0,0,0,0,0
.long 17,0,3712,0,0,0,0,2049
.long 8,1952,0,0,0,0,0,1
.long 17,256,3712,0,0,0,0,2305
.long 4,1024,3072,1,128,0,0,7169
.long 4,1536,3328,1,0,0,0,7681
.long 2,1536,2048,1,0,0,0,3588
.long 2,1792,2560,0,0,0,0,3844
.long 14,512,896,0,704643328,0,570425408,0
.long 0,0,0,0,0,0,0,0
.long 17,128,3712,0,0,0,0,2049
.long 8,1968,0,0,0,0,0,1
.long 17,384,3712,0,0,0,0,2305
.long 4,1280,3072,1,128,0,0,7425
.long 4,1792,3328,1,0,0,0,7937
.long 2,1536,2304,1,0,0,0,3588
.long 2,1792,2816,0,0,0,0,3844
.long 14,256,768,0,687866112,0,553648192,0
.long 0,0,0,0,0,0,0,0
.long 17,0,3840,0,0,0,0,2049
.long 8,1984,0,0,0,0,0,1
.long 17,256,3840,0,0,0,0,2305
.long 4,1024,3328,1,128,0,0,7169
.long 3,0,3072,1,0,0,0,4097
.long 3,768,3072,1,0,0,0,4865
.long 3,1280,3584,0,0,0,0,5377
.long 0,1,0,0,0,0,0,0
.long 17,128,3840,0,0,0,0,2049
.long 8,2000,0,0,0,0,0,1
.long 17,384,3840,0,0,0,0,2305
.long 4,1280,3328,1,128,0,0,7425
.long 3,256,3072,0,0,0,0,4353
.long 5,1280,768,0,486539278,128,0,9488
.long 0,0,0,0,0,0,0,0
.long 17,0,3968,0,0,0,0,2049
.long 8,2016,0,0,0,0,0,1
.long 17,256,3968,0,0,0,0,2305
.long 2,768,2048,1,128,0,0,2820
.long 4,1536,2048,1,0,0,0,7681
.long 3,512,3328,1,0,0,0,4609
.long 3,1024,3840,0,0,0,0,5121
.long 0,1,0,0,0,0,0,0
.long 17,128,3968,0,0,0,0,2049
.long 8,2032,0,0,0,0,0,1
.long 17,384,3968,0,0,0,0,2305
.long 2,1024,2048,1,128,0,0,3076
.long 4,1792,2048,1,0,0,0,7937
.long 3,768,3328,1,0,0,0,4865
.long 3,1280,3840,0,0,0,0,5377
.long 0,1,0,0,0,0,0,0
.long 0,0,0,0,0,0,0,0
.long 0,0,0,0,0,0,0,0
.long 0,0,0,0,0,0,0,0
.long 0,0,0,0,0,0,0,0
.long 0,0,0,0,0,0,0,0
.long 0,0,0,0,0,0,0,0
.long 0,0,0,0,0,0,0,0
.long 0,0,0,0,0,0,0,0
.long 0,0,0,0,0,0,0,0
.long 0,0,0,0,0,0,0,0
.long 0,0,0,0,0,0,0,0
.long 0,0,0,0,0,0,0,0
.long 0,0,0,0,0,0,0,0
.long 0,0,0,0,0,0,0,0
.long 0,0,0,0,0,0,0,0
.long 0,0,0,0,0,0,0,0
.long 0,0,0,0,0,0,0,0
.long 0,0,0,0,0,0,0,0
.long 0,0,0,0,0,0,0,0
.long 0,0,0,0,0,0,0,0
.long 0,0,0,0,0,0,0,0
.long 0,0,0,0,0,0,0,0
.long 0,0,0,0,0,0,0,0
.long 0,0,0,0,0,0,0,0
.long 0,0,0,0,0,0,0,0
.long 0,0,0,0,0,0,0,0
.long 0,0,0,0,0,0,0,0
.long 0,0,0,0,0,0,0,0
.long 0,0,0,0,0,0,0,0
.long 0,0,0,0,0,0,0,0
.long 0,0,0,0,0,0,0,0
.long 0,0,0,0,0,0,0,0
.long 0,0,0,0,0,0,0,0
.long 0,0,0,0,0,0,0,0
.long 0,0,0,0,0,0,0,0
.long 0,0,0,0,0,0,0,0
.long 0,0,0,0,0,0,0,0
.long 0,0,0,0,0,0,0,0
.long 0,0,0,0,0,0,0,0
.long 0,0,0,0,0,0,0,0
.long 0,0,0,0,0,0,0,0
.long 0,0,0,0,0,0,0,0
.long 0,0,0,0,0,0,0,0
.long 0,0,0,0,0,0,0,0
.long 0,0,0,0,0,0,0,0
.long 0,0,0,0,0,0,0,0
.long 0,0,0,0,0,0,0,0
.long 0,0,0,0,0,0,0,0
.long 0,0,0,0,0,0,0,0
.long 0,0,0,0,0,0,0,0
.long 0,0,0,0,0,0,0,0
.long 0,0,0,0,0,0,0,0
.long 0,0,0,0,0,0,0,0
.long 0,0,0,0,0,0,0,0
.long 0,0,0,0,0,0,0,0
.long 0,0,0,0,0,0,0,0
.long 0,0,0,0,0,0,0,0
.long 0,0,0,0,0,0,0,0
.long 0,0,0,0,0,0,0,0
.long 0,0,0,0,0,0,0,0
.long 0,0,0,0,0,0,0,0
.long 0,0,0,0,0,0,0,0
.long 0,0,0,0,0,0,0,0
.long 0,0,0,0,0,0,0,0
.long 0,0,0,0,0,0,0,0
.long 0,0,0,0,0,0,0,0
.long 0,0,0,0,0,0,0,0
.long 0,0,0,0,0,0,0,0
.long 0,0,0,0,0,0,0,0
.long 0,0,0,0,0,0,0,0
.long 0,0,0,0,0,0,0,0
.long 0,0,0,0,0,0,0,0
.long 0,0,0,0,0,0,0,0
.long 0,0,0,0,0,0,0,0
.long 0,0,0,0,0,0,0,0
.long 0,0,0,0,0,0,0,0
.long 0,0,0,0,0,0,0,0
.long 0,0,0,0,0,0,0,0
.long 0,0,0,0,0,0,0,0
.long 0,0,0,0,0,0,0,0
.long 0,0,0,0,0,0,0,0
.long 0,0,0,0,0,0,0,0
.long 0,0,0,0,0,0,0,0
.long 0,0,0,0,0,0,0,0
.long 0,0,0,0,0,0,0,0
.long 0,0,0,0,0,0,0,0
.long 0,0,0,0,0,0,0,0
.long 0,0,0,0,0,0,0,0
.long 0,0,0,0,0,0,0,0
.long 0,0,0,0,0,0,0,0
.long 0,0,0,0,0,0,0,0
.long 0,0,0,0,0,0,0,0
.long 0,0,0,0,0,0,0,0
.long 0,0,0,0,0,0,0,0
.long 0,0,0,0,0,0,0,0
.long 0,0,0,0,0,0,0,0
.long 0,0,0,0,0,0,0,0
.long 0,0,0,0,0,0,0,0
.long 0,0,0,0,0,0,0,0
.long 0,0,0,0,0,0,0,0
.long 0,0,0,0,0,0,0,0
.long 0,0,0,0,0,0,0,0
.long 0,0,0,0,0,0,0,0
.long 0,0,0,0,0,0,0,0
.long 0,0,0,0,0,0,0,0
.long 0,0,0,0,0,0,0,0
.long 0,0,0,0,0,0,0,0
.long 0,0,0,0,0,0,0,0
.long 0,0,0,0,0,0,0,0
.long 0,0,0,0,0,0,0,0
.long 0,0,0,0,0,0,0,0
.long 0,0,0,0,0,0,0,0
.long 0,0,0,0,0,0,0,0
.long 0,0,0,0,0,0,0,0
.long 0,0,0,0,0,0,0,0
.long 0,0,0,0,0,0,0,0
.long 0,0,0,0,0,0,0,0
.long 0,0,0,0,0,0,0,0
.long 0,0,0,0,0,0,0,0
.long 0,0,0,0,0,0,0,0
.long 0,0,0,0,0,0,0,0
.long 0,0,0,0,0,0,0,0
.long 0,0,0,0,0,0,0,0
.long 0,0,0,0,0,0,0,0
.long 0,0,0,0,0,0,0,0
.long 0,0,0,0,0,0,0,0
.long 0,0,0,0,0,0,0,0
.long 0,0,0,0,0,0,0,0
.long 0,0,0,0,0,0,0,0
.long 11,1280,0,0,754974784,771752000,620757056,0
.long 11,1280,128,0,754974784,771752000,620757056,0
.long 11,1408,0,0,788529216,805306432,620757056,0
.long 11,1408,128,0,788529216,805306432,620757056,0
.long 11,1536,0,0,822083648,838860864,637534272,0
.long 11,1536,128,0,822083648,838860864,637534272,0
.long 12,1664,0,0,855638080,0,637534272,0
.long 12,1664,64,0,855638080,0,637534272,0
.long 12,1664,128,0,855638080,0,637534272,0
.long 12,1664,192,0,855638080,0,637534272,0
.long 12,1728,0,0,872415296,0,637534272,0
.long 12,1728,64,0,872415296,0,637534272,0
.long 12,1728,128,0,872415296,0,637534272,0
.long 12,1728,192,0,872415296,0,637534272,0
.long 11,1280,256,0,754974784,771752000,620757056,0
.long 11,1280,384,0,754974784,771752000,620757056,0
.long 11,1408,256,0,788529216,805306432,620757056,0
.long 11,1408,384,0,788529216,805306432,620757056,0
.long 11,1536,256,0,822083648,838860864,637534272,0
.long 11,1536,384,0,822083648,838860864,637534272,0
.long 12,1664,256,0,855638080,0,637534272,0
.long 12,1664,320,0,855638080,0,637534272,0
.long 12,1664,384,0,855638080,0,637534272,0
.long 12,1664,448,0,855638080,0,637534272,0
.long 12,1728,256,0,872415296,0,637534272,0
.long 12,1728,320,0,872415296,0,637534272,0
.long 12,1728,384,0,872415296,0,637534272,0
.long 12,1728,448,0,872415296,0,637534272,0
.long 11,1280,512,0,754974784,771752000,620757056,0
.long 11,1280,640,0,754974784,771752000,620757056,0
.long 11,1408,512,0,788529216,805306432,620757056,0
.long 11,1408,640,0,788529216,805306432,620757056,0
.long 11,1536,512,0,822083648,838860864,637534272,0
.long 11,1536,640,0,822083648,838860864,637534272,0
.long 12,1664,512,0,855638080,0,637534272,0
.long 12,1664,576,0,855638080,0,637534272,0
.long 12,1664,640,0,855638080,0,637534272,0
.long 12,1664,704,0,855638080,0,637534272,0
.long 12,1728,512,0,872415296,0,637534272,0
.long 12,1728,576,0,872415296,0,637534272,0
.long 12,1728,640,0,872415296,0,637534272,0
.long 12,1728,704,0,872415296,0,637534272,0
.long 11,1280,768,0,754974784,771752000,620757056,0
.long 11,1280,896,0,754974784,771752000,620757056,0
.long 11,1408,768,0,788529216,805306432,620757056,0
.long 11,1408,896,0,788529216,805306432,620757056,0
.long 11,1536,768,0,822083648,838860864,637534272,0
.long 11,1536,896,0,822083648,838860864,637534272,0
.long 12,1664,768,0,855638080,0,637534272,0
.long 12,1664,832,0,855638080,0,637534272,0
.long 12,1664,896,0,855638080,0,637534272,0
.long 12,1664,960,0,855638080,0,637534272,0
.long 12,1728,768,0,872415296,0,637534272,0
.long 12,1728,832,0,872415296,0,637534272,0
.long 12,1728,896,0,872415296,0,637534272,0
.long 12,1728,960,0,872415296,0,637534272,0
.long 8,0,0,0,0,0,0,1
.long 8,16,0,0,0,0,0,1
.long 8,32,0,0,0,0,0,1
.long 8,48,0,0,0,0,0,1
.long 8,64,0,0,0,0,0,1
.long 8,80,0,0,0,0,0,1
.long 8,96,0,0,0,0,0,1
.long 8,112,0,0,0,0,0,1
.long 8,128,0,0,0,0,0,1
.long 8,144,0,0,0,0,0,1
.long 8,160,0,0,0,0,0,1
.long 8,176,0,0,0,0,0,1
.long 8,192,0,0,0,0,0,1
.long 8,208,0,0,0,0,0,1
.long 8,224,0,0,0,0,0,1
.long 8,240,0,0,0,0,0,1
.long 8,256,0,0,0,0,0,1
.long 8,272,0,0,0,0,0,1
.long 8,288,0,0,0,0,0,1
.long 8,304,0,0,0,0,0,1
.long 8,320,0,0,0,0,0,1
.long 8,336,0,0,0,0,0,1
.long 8,352,0,0,0,0,0,1
.long 8,368,0,0,0,0,0,1
.long 8,384,0,0,0,0,0,1
.long 8,400,0,0,0,0,0,1
.long 8,416,0,0,0,0,0,1
.long 8,432,0,0,0,0,0,1
.long 8,448,0,0,0,0,0,1
.long 8,464,0,0,0,0,0,1
.long 8,480,0,0,0,0,0,1
.long 8,496,0,0,0,0,0,1
.long 8,512,0,0,0,0,0,1
.long 8,528,0,0,0,0,0,1
.long 8,544,0,0,0,0,0,1
.long 8,560,0,0,0,0,0,1
.long 8,576,0,0,0,0,0,1
.long 8,592,0,0,0,0,0,1
.long 8,608,0,0,0,0,0,1
.long 8,624,0,0,0,0,0,1
.long 8,640,0,0,0,0,0,1
.long 8,656,0,0,0,0,0,1
.long 8,672,0,0,0,0,0,1
.long 8,688,0,0,0,0,0,1
.long 8,704,0,0,0,0,0,1
.long 8,720,0,0,0,0,0,1
.long 8,736,0,0,0,0,0,1
.long 8,752,0,0,0,0,0,1
.long 8,768,0,0,0,0,0,1
.long 8,784,0,0,0,0,0,1
.long 8,800,0,0,0,0,0,1
.long 8,816,0,0,0,0,0,1
.long 8,832,0,0,0,0,0,1
.long 8,848,0,0,0,0,0,1
.long 8,864,0,0,0,0,0,1
.long 8,880,0,0,0,0,0,1
.long 8,896,0,0,0,0,0,1
.long 8,912,0,0,0,0,0,1
.long 8,928,0,0,0,0,0,1
.long 8,944,0,0,0,0,0,1
.long 8,960,0,0,0,0,0,1
.long 8,976,0,0,0,0,0,1
.long 8,992,0,0,0,0,0,1
.long 8,1008,0,0,0,0,0,1
.long 8,1024,0,0,0,0,0,1
.long 8,1040,0,0,0,0,0,1
.long 8,1056,0,0,0,0,0,1
.long 8,1072,0,0,0,0,0,1
.long 8,1088,0,0,0,0,0,1
.long 8,1104,0,0,0,0,0,1
.long 8,1120,0,0,0,0,0,1
.long 8,1136,0,0,0,0,0,1
.long 8,1152,0,0,0,0,0,1
.long 8,1168,0,0,0,0,0,1
.long 8,1184,0,0,0,0,0,1
.long 8,1200,0,0,0,0,0,1
.long 8,1216,0,0,0,0,0,1
.long 8,1232,0,0,0,0,0,1
.long 8,1248,0,0,0,0,0,1
.long 8,1264,0,0,0,0,0,1
.long 8,1280,0,0,0,0,0,1
.long 8,1296,0,0,0,0,0,1
.long 8,1312,0,0,0,0,0,1
.long 8,1328,0,0,0,0,0,1
.long 8,1344,0,0,0,0,0,1
.long 8,1360,0,0,0,0,0,1
.long 8,1376,0,0,0,0,0,1
.long 8,1392,0,0,0,0,0,1
.long 8,1408,0,0,0,0,0,1
.long 8,1424,0,0,0,0,0,1
.long 8,1440,0,0,0,0,0,1
.long 8,1456,0,0,0,0,0,1
.long 8,1472,0,0,0,0,0,1
.long 8,1488,0,0,0,0,0,1
.long 8,1504,0,0,0,0,0,1
.long 8,1520,0,0,0,0,0,1
.long 8,1536,0,0,0,0,0,1
.long 8,1552,0,0,0,0,0,1
.long 8,1568,0,0,0,0,0,1
.long 8,1584,0,0,0,0,0,1
.long 8,1600,0,0,0,0,0,1
.long 8,1616,0,0,0,0,0,1
.long 8,1632,0,0,0,0,0,1
.long 8,1648,0,0,0,0,0,1
.long 8,1664,0,0,0,0,0,1
.long 8,1680,0,0,0,0,0,1
.long 8,1696,0,0,0,0,0,1
.long 8,1712,0,0,0,0,0,1
.long 8,1728,0,0,0,0,0,1
.long 8,1744,0,0,0,0,0,1
.long 8,1760,0,0,0,0,0,1
.long 8,1776,0,0,0,0,0,1
.long 8,1792,0,0,0,0,0,1
.long 8,1808,0,0,0,0,0,1
.long 8,1824,0,0,0,0,0,1
.long 8,1840,0,0,0,0,0,1
.long 8,1856,0,0,0,0,0,1
.long 8,1872,0,0,0,0,0,1
.long 8,1888,0,0,0,0,0,1
.long 8,1904,0,0,0,0,0,1
.long 8,1920,0,0,0,0,0,1
.long 8,1936,0,0,0,0,0,1
.long 8,1952,0,0,0,0,0,1
.long 8,1968,0,0,0,0,0,1
.long 8,1984,0,0,0,0,0,1
.long 8,2000,0,0,0,0,0,1
.long 8,2016,0,0,0,0,0,1
.long 8,2032,0,0,0,0,0,1
.long 16,0,0,0,0,0,0,2049
.long 17,0,0,0,0,0,0,2049
.long 16,0,128,0,0,0,0,2049
.long 17,0,128,0,0,0,0,2049
.long 16,0,256,0,0,0,0,2049
.long 17,0,256,0,0,0,0,2049
.long 16,0,384,0,0,0,0,2049
.long 17,0,384,0,0,0,0,2049
.long 16,0,512,0,0,0,0,2049
.long 17,0,512,0,0,0,0,2049
.long 16,0,640,0,0,0,0,2049
.long 17,0,640,0,0,0,0,2049
.long 16,0,768,0,0,0,0,2049
.long 17,0,768,0,0,0,0,2049
.long 16,0,896,0,0,0,0,2049
.long 17,0,896,0,0,0,0,2049
.long 16,0,1024,0,0,0,0,2049
.long 17,0,1024,0,0,0,0,2049
.long 16,0,1152,0,0,0,0,2049
.long 17,0,1152,0,0,0,0,2049
.long 16,0,1280,0,0,0,0,2049
.long 17,0,1280,0,0,0,0,2049
.long 16,0,1408,0,0,0,0,2049
.long 17,0,1408,0,0,0,0,2049
.long 16,0,1536,0,0,0,0,2049
.long 17,0,1536,0,0,0,0,2049
.long 16,0,1664,0,0,0,0,2049
.long 17,0,1664,0,0,0,0,2049
.long 16,0,1792,0,0,0,0,2049
.long 17,0,1792,0,0,0,0,2049
.long 16,0,1920,0,0,0,0,2049
.long 17,0,1920,0,0,0,0,2049
.long 16,0,2048,0,0,0,0,2049
.long 17,0,2048,0,0,0,0,2049
.long 16,0,2176,0,0,0,0,2049
.long 17,0,2176,0,0,0,0,2049
.long 16,0,2304,0,0,0,0,2049
.long 17,0,2304,0,0,0,0,2049
.long 16,0,2432,0,0,0,0,2049
.long 17,0,2432,0,0,0,0,2049
.long 16,0,2560,0,0,0,0,2049
.long 17,0,2560,0,0,0,0,2049
.long 16,0,2688,0,0,0,0,2049
.long 17,0,2688,0,0,0,0,2049
.long 16,0,2816,0,0,0,0,2049
.long 17,0,2816,0,0,0,0,2049
.long 16,0,2944,0,0,0,0,2049
.long 17,0,2944,0,0,0,0,2049
.long 16,0,3072,0,0,0,0,2049
.long 17,0,3072,0,0,0,0,2049
.long 16,0,3200,0,0,0,0,2049
.long 17,0,3200,0,0,0,0,2049
.long 16,0,3328,0,0,0,0,2049
.long 17,0,3328,0,0,0,0,2049
.long 16,0,3456,0,0,0,0,2049
.long 17,0,3456,0,0,0,0,2049
.long 16,0,3584,0,0,0,0,2049
.long 17,0,3584,0,0,0,0,2049
.long 16,0,3712,0,0,0,0,2049
.long 17,0,3712,0,0,0,0,2049
.long 16,0,3840,0,0,0,0,2049
.long 17,0,3840,0,0,0,0,2049
.long 16,0,3968,0,0,0,0,2049
.long 17,0,3968,0,0,0,0,2049
.long 16,128,0,0,0,0,0,2049
.long 17,128,0,0,0,0,0,2049
.long 16,128,128,0,0,0,0,2049
.long 17,128,128,0,0,0,0,2049
.long 16,128,256,0,0,0,0,2049
.long 17,128,256,0,0,0,0,2049
.long 16,128,384,0,0,0,0,2049
.long 17,128,384,0,0,0,0,2049
.long 16,128,512,0,0,0,0,2049
.long 17,128,512,0,0,0,0,2049
.long 16,128,640,0,0,0,0,2049
.long 17,128,640,0,0,0,0,2049
.long 16,128,768,0,0,0,0,2049
.long 17,128,768,0,0,0,0,2049
.long 16,128,896,0,0,0,0,2049
.long 17,128,896,0,0,0,0,2049
.long 16,128,1024,0,0,0,0,2049
.long 17,128,1024,0,0,0,0,2049
.long 16,128,1152,0,0,0,0,2049
.long 17,128,1152,0,0,0,0,2049
.long 16,128,1280,0,0,0,0,2049
.long 17,128,1280,0,0,0,0,2049
.long 16,128,1408,0,0,0,0,2049
.long 17,128,1408,0,0,0,0,2049
.long 16,128,1536,0,0,0,0,2049
.long 17,128,1536,0,0,0,0,2049
.long 16,128,1664,0,0,0,0,2049
.long 17,128,1664,0,0,0,0,2049
.long 16,128,1792,0,0,0,0,2049
.long 17,128,1792,0,0,0,0,2049
.long 16,128,1920,0,0,0,0,2049
.long 17,128,1920,0,0,0,0,2049
.long 16,128,2048,0,0,0,0,2049
.long 17,128,2048,0,0,0,0,2049
.long 16,128,2176,0,0,0,0,2049
.long 17,128,2176,0,0,0,0,2049
.long 16,128,2304,0,0,0,0,2049
.long 17,128,2304,0,0,0,0,2049
.long 16,128,2432,0,0,0,0,2049
.long 17,128,2432,0,0,0,0,2049
.long 16,128,2560,0,0,0,0,2049
.long 17,128,2560,0,0,0,0,2049
.long 16,128,2688,0,0,0,0,2049
.long 17,128,2688,0,0,0,0,2049
.long 16,128,2816,0,0,0,0,2049
.long 17,128,2816,0,0,0,0,2049
.long 16,128,2944,0,0,0,0,2049
.long 17,128,2944,0,0,0,0,2049
.long 16,128,3072,0,0,0,0,2049
.long 17,128,3072,0,0,0,0,2049
.long 16,128,3200,0,0,0,0,2049
.long 17,128,3200,0,0,0,0,2049
.long 16,128,3328,0,0,0,0,2049
.long 17,128,3328,0,0,0,0,2049
.long 16,128,3456,0,0,0,0,2049
.long 17,128,3456,0,0,0,0,2049
.long 16,128,3584,0,0,0,0,2049
.long 17,128,3584,0,0,0,0,2049
.long 16,128,3712,0,0,0,0,2049
.long 17,128,3712,0,0,0,0,2049
.long 16,128,3840,0,0,0,0,2049
.long 17,128,3840,0,0,0,0,2049
.long 16,128,3968,0,0,0,0,2049
.long 17,128,3968,0,0,0,0,2049
.long 16,256,0,0,0,0,0,2305
.long 17,256,0,0,0,0,0,2305
.long 16,256,128,0,0,0,0,2305
.long 17,256,128,0,0,0,0,2305
.long 16,256,256,0,0,0,0,2305
.long 17,256,256,0,0,0,0,2305
.long 16,256,384,0,0,0,0,2305
.long 17,256,384,0,0,0,0,2305
.long 16,256,512,0,0,0,0,2305
.long 17,256,512,0,0,0,0,2305
.long 16,256,640,0,0,0,0,2305
.long 17,256,640,0,0,0,0,2305
.long 16,256,768,0,0,0,0,2305
.long 17,256,768,0,0,0,0,2305
.long 16,256,896,0,0,0,0,2305
.long 17,256,896,0,0,0,0,2305
.long 16,256,1024,0,0,0,0,2305
.long 17,256,1024,0,0,0,0,2305
.long 16,256,1152,0,0,0,0,2305
.long 17,256,1152,0,0,0,0,2305
.long 16,256,1280,0,0,0,0,2305
.long 17,256,1280,0,0,0,0,2305
.long 16,256,1408,0,0,0,0,2305
.long 17,256,1408,0,0,0,0,2305
.long 16,256,1536,0,0,0,0,2305
.long 17,256,1536,0,0,0,0,2305
.long 16,256,1664,0,0,0,0,2305
.long 17,256,1664,0,0,0,0,2305
.long 16,256,1792,0,0,0,0,2305
.long 17,256,1792,0,0,0,0,2305
.long 16,256,1920,0,0,0,0,2305
.long 17,256,1920,0,0,0,0,2305
.long 16,256,2048,0,0,0,0,2305
.long 17,256,2048,0,0,0,0,2305
.long 16,256,2176,0,0,0,0,2305
.long 17,256,2176,0,0,0,0,2305
.long 16,256,2304,0,0,0,0,2305
.long 17,256,2304,0,0,0,0,2305
.long 16,256,2432,0,0,0,0,2305
.long 17,256,2432,0,0,0,0,2305
.long 16,256,2560,0,0,0,0,2305
.long 17,256,2560,0,0,0,0,2305
.long 16,256,2688,0,0,0,0,2305
.long 17,256,2688,0,0,0,0,2305
.long 16,256,2816,0,0,0,0,2305
.long 17,256,2816,0,0,0,0,2305
.long 16,256,2944,0,0,0,0,2305
.long 17,256,2944,0,0,0,0,2305
.long 16,256,3072,0,0,0,0,2305
.long 17,256,3072,0,0,0,0,2305
.long 16,256,3200,0,0,0,0,2305
.long 17,256,3200,0,0,0,0,2305
.long 16,256,3328,0,0,0,0,2305
.long 17,256,3328,0,0,0,0,2305
.long 16,256,3456,0,0,0,0,2305
.long 17,256,3456,0,0,0,0,2305
.long 16,256,3584,0,0,0,0,2305
.long 17,256,3584,0,0,0,0,2305
.long 16,256,3712,0,0,0,0,2305
.long 17,256,3712,0,0,0,0,2305
.long 16,256,3840,0,0,0,0,2305
.long 17,256,3840,0,0,0,0,2305
.long 16,256,3968,0,0,0,0,2305
.long 17,256,3968,0,0,0,0,2305
.long 16,384,0,0,0,0,0,2305
.long 17,384,0,0,0,0,0,2305
.long 16,384,128,0,0,0,0,2305
.long 17,384,128,0,0,0,0,2305
.long 16,384,256,0,0,0,0,2305
.long 17,384,256,0,0,0,0,2305
.long 16,384,384,0,0,0,0,2305
.long 17,384,384,0,0,0,0,2305
.long 16,384,512,0,0,0,0,2305
.long 17,384,512,0,0,0,0,2305
.long 16,384,640,0,0,0,0,2305
.long 17,384,640,0,0,0,0,2305
.long 16,384,768,0,0,0,0,2305
.long 17,384,768,0,0,0,0,2305
.long 16,384,896,0,0,0,0,2305
.long 17,384,896,0,0,0,0,2305
.long 16,384,1024,0,0,0,0,2305
.long 17,384,1024,0,0,0,0,2305
.long 16,384,1152,0,0,0,0,2305
.long 17,384,1152,0,0,0,0,2305
.long 16,384,1280,0,0,0,0,2305
.long 17,384,1280,0,0,0,0,2305
.long 16,384,1408,0,0,0,0,2305
.long 17,384,1408,0,0,0,0,2305
.long 16,384,1536,0,0,0,0,2305
.long 17,384,1536,0,0,0,0,2305
.long 16,384,1664,0,0,0,0,2305
.long 17,384,1664,0,0,0,0,2305
.long 16,384,1792,0,0,0,0,2305
.long 17,384,1792,0,0,0,0,2305
.long 16,384,1920,0,0,0,0,2305
.long 17,384,1920,0,0,0,0,2305
.long 16,384,2048,0,0,0,0,2305
.long 17,384,2048,0,0,0,0,2305
.long 16,384,2176,0,0,0,0,2305
.long 17,384,2176,0,0,0,0,2305
.long 16,384,2304,0,0,0,0,2305
.long 17,384,2304,0,0,0,0,2305
.long 16,384,2432,0,0,0,0,2305
.long 17,384,2432,0,0,0,0,2305
.long 16,384,2560,0,0,0,0,2305
.long 17,384,2560,0,0,0,0,2305
.long 16,384,2688,0,0,0,0,2305
.long 17,384,2688,0,0,0,0,2305
.long 16,384,2816,0,0,0,0,2305
.long 17,384,2816,0,0,0,0,2305
.long 16,384,2944,0,0,0,0,2305
.long 17,384,2944,0,0,0,0,2305
.long 16,384,3072,0,0,0,0,2305
.long 17,384,3072,0,0,0,0,2305
.long 16,384,3200,0,0,0,0,2305
.long 17,384,3200,0,0,0,0,2305
.long 16,384,3328,0,0,0,0,2305
.long 17,384,3328,0,0,0,0,2305
.long 16,384,3456,0,0,0,0,2305
.long 17,384,3456,0,0,0,0,2305
.long 16,384,3584,0,0,0,0,2305
.long 17,384,3584,0,0,0,0,2305
.long 16,384,3712,0,0,0,0,2305
.long 17,384,3712,0,0,0,0,2305
.long 16,384,3840,0,0,0,0,2305
.long 17,384,3840,0,0,0,0,2305
.long 16,384,3968,0,0,0,0,2305
.long 17,384,3968,0,0,0,0,2305
.long 9,512,0,0,128,0,0,2562
.long 10,512,0,0,128,0,0,2562
.long 9,512,128,0,128,0,0,2562
.long 10,512,128,0,128,0,0,2562
.long 9,512,256,0,128,0,0,2562
.long 10,512,256,0,128,0,0,2562
.long 9,512,384,0,128,0,0,2562
.long 10,512,384,0,128,0,0,2562
.long 9,512,512,0,128,0,0,2562
.long 10,512,512,0,128,0,0,2562
.long 9,512,640,0,128,0,0,2562
.long 10,512,640,0,128,0,0,2562
.long 9,512,768,0,128,0,0,2562
.long 10,512,768,0,128,0,0,2562
.long 9,512,896,0,128,0,0,2562
.long 10,512,896,0,128,0,0,2562
.long 9,512,1024,0,128,0,0,2562
.long 10,512,1024,0,128,0,0,2562
.long 9,512,1152,0,128,0,0,2562
.long 10,512,1152,0,128,0,0,2562
.long 9,512,1280,0,128,0,0,2562
.long 10,512,1280,0,128,0,0,2562
.long 9,512,1408,0,128,0,0,2562
.long 10,512,1408,0,128,0,0,2562
.long 9,512,1536,0,128,0,0,2562
.long 10,512,1536,0,128,0,0,2562
.long 9,512,1664,0,128,0,0,2562
.long 10,512,1664,0,128,0,0,2562
.long 9,512,1792,0,128,0,0,2562
.long 10,512,1792,0,128,0,0,2562
.long 9,512,1920,0,128,0,0,2562
.long 10,512,1920,0,128,0,0,2562
.long 9,512,2048,0,128,0,0,2562
.long 10,512,2048,0,128,0,0,2562
.long 9,512,2176,0,128,0,0,2562
.long 10,512,2176,0,128,0,0,2562
.long 9,512,2304,0,128,0,0,2562
.long 10,512,2304,0,128,0,0,2562
.long 9,512,2432,0,128,0,0,2562
.long 10,512,2432,0,128,0,0,2562
.long 9,512,2560,0,128,0,0,2562
.long 10,512,2560,0,128,0,0,2562
.long 9,512,2688,0,128,0,0,2562
.long 10,512,2688,0,128,0,0,2562
.long 9,512,2816,0,128,0,0,2562
.long 10,512,2816,0,128,0,0,2562
.long 9,512,2944,0,128,0,0,2562
.long 10,512,2944,0,128,0,0,2562
.long 9,512,3072,0,128,0,0,2562
.long 10,512,3072,0,128,0,0,2562
.long 9,512,3200,0,128,0,0,2562
.long 10,512,3200,0,128,0,0,2562
.long 9,512,3328,0,128,0,0,2562
.long 10,512,3328,0,128,0,0,2562
.long 9,512,3456,0,128,0,0,2562
.long 10,512,3456,0,128,0,0,2562
.long 9,512,3584,0,128,0,0,2562
.long 10,512,3584,0,128,0,0,2562
.long 9,512,3712,0,128,0,0,2562
.long 10,512,3712,0,128,0,0,2562
.long 9,512,3840,0,128,0,0,2562
.long 10,512,3840,0,128,0,0,2562
.long 9,512,3968,0,128,0,0,2562
.long 10,512,3968,0,128,0,0,2562
.long 1,768,0,0,128,0,0,2820
.long 2,768,0,0,128,0,0,2820
.long 1,768,256,0,128,0,0,2820
.long 2,768,256,0,128,0,0,2820
.long 1,768,512,0,128,0,0,2820
.long 2,768,512,0,128,0,0,2820
.long 1,768,768,0,128,0,0,2820
.long 2,768,768,0,128,0,0,2820
.long 1,768,1024,0,128,0,0,2820
.long 2,768,1024,0,128,0,0,2820
.long 1,768,1280,0,128,0,0,2820
.long 2,768,1280,0,128,0,0,2820
.long 1,768,1536,0,128,0,0,2820
.long 2,768,1536,0,128,0,0,2820
.long 1,768,1792,0,128,0,0,2820
.long 2,768,1792,0,128,0,0,2820
.long 1,768,2048,0,128,0,0,2820
.long 2,768,2048,0,128,0,0,2820
.long 1,768,2304,0,128,0,0,2820
.long 2,768,2304,0,128,0,0,2820
.long 1,768,2560,0,128,0,0,2820
.long 2,768,2560,0,128,0,0,2820
.long 1,768,2816,0,128,0,0,2820
.long 2,768,2816,0,128,0,0,2820
.long 1,768,3072,0,128,0,0,2820
.long 2,768,3072,0,128,0,0,2820
.long 1,768,3328,0,128,0,0,2820
.long 2,768,3328,0,128,0,0,2820
.long 1,768,3584,0,128,0,0,2820
.long 2,768,3584,0,128,0,0,2820
.long 1,768,3840,0,128,0,0,2820
.long 2,768,3840,0,128,0,0,2820
.long 1,1024,0,0,128,0,0,3076
.long 2,1024,0,0,128,0,0,3076
.long 1,1024,256,0,128,0,0,3076
.long 2,1024,256,0,128,0,0,3076
.long 1,1024,512,0,128,0,0,3076
.long 2,1024,512,0,128,0,0,3076
.long 1,1024,768,0,128,0,0,3076
.long 2,1024,768,0,128,0,0,3076
.long 1,1024,1024,0,128,0,0,3076
.long 2,1024,1024,0,128,0,0,3076
.long 1,1024,1280,0,128,0,0,3076
.long 2,1024,1280,0,128,0,0,3076
.long 1,1024,1536,0,128,0,0,3076
.long 2,1024,1536,0,128,0,0,3076
.long 1,1024,1792,0,128,0,0,3076
.long 2,1024,1792,0,128,0,0,3076
.long 1,1024,2048,0,128,0,0,3076
.long 2,1024,2048,0,128,0,0,3076
.long 1,1024,2304,0,128,0,0,3076
.long 2,1024,2304,0,128,0,0,3076
.long 1,1024,2560,0,128,0,0,3076
.long 2,1024,2560,0,128,0,0,3076
.long 1,1024,2816,0,128,0,0,3076
.long 2,1024,2816,0,128,0,0,3076
.long 1,1024,3072,0,128,0,0,3076
.long 2,1024,3072,0,128,0,0,3076
.long 1,1024,3328,0,128,0,0,3076
.long 2,1024,3328,0,128,0,0,3076
.long 1,1024,3584,0,128,0,0,3076
.long 2,1024,3584,0,128,0,0,3076
.long 1,1024,3840,0,128,0,0,3076
.long 2,1024,3840,0,128,0,0,3076
.long 1,1280,0,0,128,0,0,3332
.long 2,1280,0,0,128,0,0,3332
.long 1,1280,256,0,128,0,0,3332
.long 2,1280,256,0,128,0,0,3332
.long 1,1280,512,0,128,0,0,3332
.long 2,1280,512,0,128,0,0,3332
.long 1,1280,768,0,128,0,0,3332
.long 2,1280,768,0,128,0,0,3332
.long 1,1280,1024,0,128,0,0,3332
.long 2,1280,1024,0,128,0,0,3332
.long 1,1280,1280,0,128,0,0,3332
.long 2,1280,1280,0,128,0,0,3332
.long 1,1280,1536,0,128,0,0,3332
.long 2,1280,1536,0,128,0,0,3332
.long 1,1280,1792,0,128,0,0,3332
.long 2,1280,1792,0,128,0,0,3332
.long 1,1280,2048,0,128,0,0,3332
.long 2,1280,2048,0,128,0,0,3332
.long 1,1280,2304,0,128,0,0,3332
.long 2,1280,2304,0,128,0,0,3332
.long 1,1280,2560,0,128,0,0,3332
.long 2,1280,2560,0,128,0,0,3332
.long 1,1280,2816,0,128,0,0,3332
.long 2,1280,2816,0,128,0,0,3332
.long 1,1280,3072,0,128,0,0,3332
.long 2,1280,3072,0,128,0,0,3332
.long 1,1280,3328,0,128,0,0,3332
.long 2,1280,3328,0,128,0,0,3332
.long 1,1280,3584,0,128,0,0,3332
.long 2,1280,3584,0,128,0,0,3332
.long 1,1280,3840,0,128,0,0,3332
.long 2,1280,3840,0,128,0,0,3332
.long 1,1536,0,0,128,0,0,3588
.long 2,1536,0,0,128,0,0,3588
.long 1,1536,256,0,128,0,0,3588
.long 2,1536,256,0,128,0,0,3588
.long 1,1536,512,0,128,0,0,3588
.long 2,1536,512,0,128,0,0,3588
.long 1,1536,768,0,128,0,0,3588
.long 2,1536,768,0,128,0,0,3588
.long 1,1536,1024,0,128,0,0,3588
.long 2,1536,1024,0,128,0,0,3588
.long 1,1536,1280,0,128,0,0,3588
.long 2,1536,1280,0,128,0,0,3588
.long 1,1536,1536,0,128,0,0,3588
.long 2,1536,1536,0,128,0,0,3588
.long 1,1536,1792,0,128,0,0,3588
.long 2,1536,1792,0,128,0,0,3588
.long 1,1536,2048,0,128,0,0,3588
.long 2,1536,2048,0,128,0,0,3588
.long 1,1536,2304,0,128,0,0,3588
.long 2,1536,2304,0,128,0,0,3588
.long 1,1536,2560,0,128,0,0,3588
.long 2,1536,2560,0,128,0,0,3588
.long 1,1536,2816,0,128,0,0,3588
.long 2,1536,2816,0,128,0,0,3588
.long 1,1536,3072,0,128,0,0,3588
.long 2,1536,3072,0,128,0,0,3588
.long 1,1536,3328,0,128,0,0,3588
.long 2,1536,3328,0,128,0,0,3588
.long 1,1536,3584,0,128,0,0,3588
.long 2,1536,3584,0,128,0,0,3588
.long 1,1536,3840,0,128,0,0,3588
.long 2,1536,3840,0,128,0,0,3588
.long 1,1792,0,0,128,0,0,3844
.long 2,1792,0,0,128,0,0,3844
.long 1,1792,256,0,128,0,0,3844
.long 2,1792,256,0,128,0,0,3844
.long 1,1792,512,0,128,0,0,3844
.long 2,1792,512,0,128,0,0,3844
.long 1,1792,768,0,128,0,0,3844
.long 2,1792,768,0,128,0,0,3844
.long 1,1792,1024,0,128,0,0,3844
.long 2,1792,1024,0,128,0,0,3844
.long 1,1792,1280,0,128,0,0,3844
.long 2,1792,1280,0,128,0,0,3844
.long 1,1792,1536,0,128,0,0,3844
.long 2,1792,1536,0,128,0,0,3844
.long 1,1792,1792,0,128,0,0,3844
.long 2,1792,1792,0,128,0,0,3844
.long 1,1792,2048,0,128,0,0,3844
.long 2,1792,2048,0,128,0,0,3844
.long 1,1792,2304,0,128,0,0,3844
.long 2,1792,2304,0,128,0,0,3844
.long 1,1792,2560,0,128,0,0,3844
.long 2,1792,2560,0,128,0,0,3844
.long 1,1792,2816,0,128,0,0,3844
.long 2,1792,2816,0,128,0,0,3844
.long 1,1792,3072,0,128,0,0,3844
.long 2,1792,3072,0,128,0,0,3844
.long 1,1792,3328,0,128,0,0,3844
.long 2,1792,3328,0,128,0,0,3844
.long 1,1792,3584,0,128,0,0,3844
.long 2,1792,3584,0,128,0,0,3844
.long 1,1792,3840,0,128,0,0,3844
.long 2,1792,3840,0,128,0,0,3844
.long 3,0,0,0,128,0,0,4097
.long 3,0,256,0,128,0,0,4097
.long 3,0,512,0,128,0,0,4097
.long 3,0,768,0,128,0,0,4097
.long 3,0,1024,0,128,0,0,4097
.long 3,0,1280,0,128,0,0,4097
.long 3,0,1536,0,128,0,0,4097
.long 3,0,1792,0,128,0,0,4097
.long 3,0,2048,0,128,0,0,4097
.long 3,0,2304,0,128,0,0,4097
.long 3,0,2560,0,128,0,0,4097
.long 3,0,2816,0,128,0,0,4097
.long 3,0,3072,0,128,0,0,4097
.long 3,0,3328,0,128,0,0,4097
.long 3,0,3584,0,128,0,0,4097
.long 3,0,3840,0,128,0,0,4097
.long 3,256,0,0,128,0,0,4353
.long 3,256,256,0,128,0,0,4353
.long 3,256,512,0,128,0,0,4353
.long 3,256,768,0,128,0,0,4353
.long 3,256,1024,0,128,0,0,4353
.long 3,256,1280,0,128,0,0,4353
.long 3,256,1536,0,128,0,0,4353
.long 3,256,1792,0,128,0,0,4353
.long 3,256,2048,0,128,0,0,4353
.long 3,256,2304,0,128,0,0,4353
.long 3,256,2560,0,128,0,0,4353
.long 3,256,2816,0,128,0,0,4353
.long 3,256,3072,0,128,0,0,4353
.long 3,256,3328,0,128,0,0,4353
.long 3,256,3584,0,128,0,0,4353
.long 3,256,3840,0,128,0,0,4353
.long 3,512,0,0,128,0,0,4609
.long 3,512,256,0,128,0,0,4609
.long 3,512,512,0,128,0,0,4609
.long 3,512,768,0,128,0,0,4609
.long 3,512,1024,0,128,0,0,4609
.long 3,512,1280,0,128,0,0,4609
.long 3,512,1536,0,128,0,0,4609
.long 3,512,1792,0,128,0,0,4609
.long 3,512,2048,0,128,0,0,4609
.long 3,512,2304,0,128,0,0,4609
.long 3,512,2560,0,128,0,0,4609
.long 3,512,2816,0,128,0,0,4609
.long 3,512,3072,0,128,0,0,4609
.long 3,512,3328,0,128,0,0,4609
.long 3,512,3584,0,128,0,0,4609
.long 3,512,3840,0,128,0,0,4609
.long 3,768,0,0,128,0,0,4865
.long 3,768,256,0,128,0,0,4865
.long 3,768,512,0,128,0,0,4865
.long 3,768,768,0,128,0,0,4865
.long 3,768,1024,0,128,0,0,4865
.long 3,768,1280,0,128,0,0,4865
.long 3,768,1536,0,128,0,0,4865
.long 3,768,1792,0,128,0,0,4865
.long 3,768,2048,0,128,0,0,4865
.long 3,768,2304,0,128,0,0,4865
.long 3,768,2560,0,128,0,0,4865
.long 3,768,2816,0,128,0,0,4865
.long 3,768,3072,0,128,0,0,4865
.long 3,768,3328,0,128,0,0,4865
.long 3,768,3584,0,128,0,0,4865
.long 3,768,3840,0,128,0,0,4865
.long 3,1024,0,0,128,0,0,5121
.long 3,1024,256,0,128,0,0,5121
.long 3,1024,512,0,128,0,0,5121
.long 3,1024,768,0,128,0,0,5121
.long 3,1024,1024,0,128,0,0,5121
.long 3,1024,1280,0,128,0,0,5121
.long 3,1024,1536,0,128,0,0,5121
.long 3,1024,1792,0,128,0,0,5121
.long 3,1024,2048,0,128,0,0,5121
.long 3,1024,2304,0,128,0,0,5121
.long 3,1024,2560,0,128,0,0,5121
.long 3,1024,2816,0,128,0,0,5121
.long 3,1024,3072,0,128,0,0,5121
.long 3,1024,3328,0,128,0,0,5121
.long 3,1024,3584,0,128,0,0,5121
.long 3,1024,3840,0,128,0,0,5121
.long 3,1280,0,0,128,0,0,5377
.long 3,1280,256,0,128,0,0,5377
.long 3,1280,512,0,128,0,0,5377
.long 3,1280,768,0,128,0,0,5377
.long 3,1280,1024,0,128,0,0,5377
.long 3,1280,1280,0,128,0,0,5377
.long 3,1280,1536,0,128,0,0,5377
.long 3,1280,1792,0,128,0,0,5377
.long 3,1280,2048,0,128,0,0,5377
.long 3,1280,2304,0,128,0,0,5377
.long 3,1280,2560,0,128,0,0,5377
.long 3,1280,2816,0,128,0,0,5377
.long 3,1280,3072,0,128,0,0,5377
.long 3,1280,3328,0,128,0,0,5377
.long 3,1280,3584,0,128,0,0,5377
.long 3,1280,3840,0,128,0,0,5377
.long 3,1536,0,0,128,0,0,5633
.long 3,1536,256,0,128,0,0,5633
.long 3,1536,512,0,128,0,0,5633
.long 3,1536,768,0,128,0,0,5633
.long 3,1536,1024,0,128,0,0,5633
.long 3,1536,1280,0,128,0,0,5633
.long 3,1536,1536,0,128,0,0,5633
.long 3,1536,1792,0,128,0,0,5633
.long 3,1536,2048,0,128,0,0,5633
.long 3,1536,2304,0,128,0,0,5633
.long 3,1536,2560,0,128,0,0,5633
.long 3,1536,2816,0,128,0,0,5633
.long 3,1536,3072,0,128,0,0,5633
.long 3,1536,3328,0,128,0,0,5633
.long 3,1536,3584,0,128,0,0,5633
.long 3,1536,3840,0,128,0,0,5633
.long 3,1792,0,0,128,0,0,5889
.long 3,1792,256,0,128,0,0,5889
.long 3,1792,512,0,128,0,0,5889
.long 3,1792,768,0,128,0,0,5889
.long 3,1792,1024,0,128,0,0,5889
.long 3,1792,1280,0,128,0,0,5889
.long 3,1792,1536,0,128,0,0,5889
.long 3,1792,1792,0,128,0,0,5889
.long 3,1792,2048,0,128,0,0,5889
.long 3,1792,2304,0,128,0,0,5889
.long 3,1792,2560,0,128,0,0,5889
.long 3,1792,2816,0,128,0,0,5889
.long 3,1792,3072,0,128,0,0,5889
.long 3,1792,3328,0,128,0,0,5889
.long 3,1792,3584,0,128,0,0,5889
.long 3,1792,3840,0,128,0,0,5889
.long 4,0,0,0,128,0,0,6145
.long 4,0,256,0,128,0,0,6145
.long 4,0,512,0,128,0,0,6145
.long 4,0,768,0,128,0,0,6145
.long 4,0,1024,0,128,0,0,6145
.long 4,0,1280,0,128,0,0,6145
.long 4,0,1536,0,128,0,0,6145
.long 4,0,1792,0,128,0,0,6145
.long 4,0,2048,0,128,0,0,6145
.long 4,0,2304,0,128,0,0,6145
.long 4,0,2560,0,128,0,0,6145
.long 4,0,2816,0,128,0,0,6145
.long 4,0,3072,0,128,0,0,6145
.long 4,0,3328,0,128,0,0,6145
.long 4,256,0,0,128,0,0,6401
.long 4,256,256,0,128,0,0,6401
.long 4,256,512,0,128,0,0,6401
.long 4,256,768,0,128,0,0,6401
.long 4,256,1024,0,128,0,0,6401
.long 4,256,1280,0,128,0,0,6401
.long 4,256,1536,0,128,0,0,6401
.long 4,256,1792,0,128,0,0,6401
.long 4,256,2048,0,128,0,0,6401
.long 4,256,2304,0,128,0,0,6401
.long 4,256,2560,0,128,0,0,6401
.long 4,256,2816,0,128,0,0,6401
.long 4,256,3072,0,128,0,0,6401
.long 4,256,3328,0,128,0,0,6401
.long 4,512,0,0,128,0,0,6657
.long 4,512,256,0,128,0,0,6657
.long 4,512,512,0,128,0,0,6657
.long 4,512,768,0,128,0,0,6657
.long 4,512,1024,0,128,0,0,6657
.long 4,512,1280,0,128,0,0,6657
.long 4,512,1536,0,128,0,0,6657
.long 4,512,1792,0,128,0,0,6657
.long 4,512,2048,0,128,0,0,6657
.long 4,512,2304,0,128,0,0,6657
.long 4,512,2560,0,128,0,0,6657
.long 4,512,2816,0,128,0,0,6657
.long 4,512,3072,0,128,0,0,6657
.long 4,512,3328,0,128,0,0,6657
.long 4,768,0,0,128,0,0,6913
.long 4,768,256,0,128,0,0,6913
.long 4,768,512,0,128,0,0,6913
.long 4,768,768,0,128,0,0,6913
.long 4,768,1024,0,128,0,0,6913
.long 4,768,1280,0,128,0,0,6913
.long 4,768,1536,0,128,0,0,6913
.long 4,768,1792,0,128,0,0,6913
.long 4,768,2048,0,128,0,0,6913
.long 4,768,2304,0,128,0,0,6913
.long 4,768,2560,0,128,0,0,6913
.long 4,768,2816,0,128,0,0,6913
.long 4,768,3072,0,128,0,0,6913
.long 4,768,3328,0,128,0,0,6913
.long 4,1024,0,0,128,0,0,7169
.long 4,1024,256,0,128,0,0,7169
.long 4,1024,512,0,128,0,0,7169
.long 4,1024,768,0,128,0,0,7169
.long 4,1024,1024,0,128,0,0,7169
.long 4,1024,1280,0,128,0,0,7169
.long 4,1024,1536,0,128,0,0,7169
.long 4,1024,1792,0,128,0,0,7169
.long 4,1024,2048,0,128,0,0,7169
.long 4,1024,2304,0,128,0,0,7169
.long 4,1024,2560,0,128,0,0,7169
.long 4,1024,2816,0,128,0,0,7169
.long 4,1024,3072,0,128,0,0,7169
.long 4,1024,3328,0,128,0,0,7169
.long 4,1280,0,0,128,0,0,7425
.long 4,1280,256,0,128,0,0,7425
.long 4,1280,512,0,128,0,0,7425
.long 4,1280,768,0,128,0,0,7425
.long 4,1280,1024,0,128,0,0,7425
.long 4,1280,1280,0,128,0,0,7425
.long 4,1280,1536,0,128,0,0,7425
.long 4,1280,1792,0,128,0,0,7425
.long 4,1280,2048,0,128,0,0,7425
.long 4,1280,2304,0,128,0,0,7425
.long 4,1280,2560,0,128,0,0,7425
.long 4,1280,2816,0,128,0,0,7425
.long 4,1280,3072,0,128,0,0,7425
.long 4,1280,3328,0,128,0,0,7425
.long 4,1536,0,0,128,0,0,7681
.long 4,1536,256,0,128,0,0,7681
.long 4,1536,512,0,128,0,0,7681
.long 4,1536,768,0,128,0,0,7681
.long 4,1536,1024,0,128,0,0,7681
.long 4,1536,1280,0,128,0,0,7681
.long 4,1536,1536,0,128,0,0,7681
.long 4,1536,1792,0,128,0,0,7681
.long 4,1536,2048,0,128,0,0,7681
.long 4,1536,2304,0,128,0,0,7681
.long 4,1536,2560,0,128,0,0,7681
.long 4,1536,2816,0,128,0,0,7681
.long 4,1536,3072,0,128,0,0,7681
.long 4,1536,3328,0,128,0,0,7681
.long 4,1792,0,0,128,0,0,7937
.long 4,1792,256,0,128,0,0,7937
.long 4,1792,512,0,128,0,0,7937
.long 4,1792,768,0,128,0,0,7937
.long 4,1792,1024,0,128,0,0,7937
.long 4,1792,1280,0,128,0,0,7937
.long 4,1792,1536,0,128,0,0,7937
.long 4,1792,1792,0,128,0,0,7937
.long 4,1792,2048,0,128,0,0,7937
.long 4,1792,2304,0,128,0,0,7937
.long 4,1792,2560,0,128,0,0,7937
.long 4,1792,2816,0,128,0,0,7937
.long 4,1792,3072,0,128,0,0,7937
.long 4,1792,3328,0,128,0,0,7937
.long 5,0,0,0,402653198,128,0,8208
.long 5,0,256,0,402653198,128,0,8208
.long 5,0,512,0,402653198,128,0,8208
.long 5,0,768,0,402653198,128,0,8208
.long 5,256,0,0,419430414,128,0,8464
.long 5,256,256,0,419430414,128,0,8464
.long 5,256,512,0,419430414,128,0,8464
.long 5,256,768,0,419430414,128,0,8464
.long 5,512,0,0,436207630,128,0,8720
.long 5,512,256,0,436207630,128,0,8720
.long 5,512,512,0,436207630,128,0,8720
.long 5,512,768,0,436207630,128,0,8720
.long 5,768,0,0,452984846,128,0,8976
.long 5,768,256,0,452984846,128,0,8976
.long 5,768,512,0,452984846,128,0,8976
.long 5,768,768,0,452984846,128,0,8976
.long 5,1024,0,0,469762062,128,0,9232
.long 5,1024,256,0,469762062,128,0,9232
.long 5,1024,512,0,469762062,128,0,9232
.long 5,1024,768,0,469762062,128,0,9232
.long 5,1280,0,0,486539278,128,0,9488
.long 5,1280,256,0,486539278,128,0,9488
.long 5,1280,512,0,486539278,128,0,9488
.long 5,1280,768,0,486539278,128,0,9488
.long 5,1536,0,0,503316494,128,0,9744
.long 5,1536,256,0,503316494,128,0,9744
.long 5,1536,512,0,503316494,128,0,9744
.long 5,1536,768,0,503316494,128,0,9744
.long 5,1792,0,0,520093710,128,0,10000
.long 5,1792,256,0,520093710,128,0,10000
.long 5,1792,512,0,520093710,128,0,10000
.long 5,1792,768,0,520093710,128,0,10000
.long 7,0,0,4,268435472,0,0,10272
.long 7,1,0,4,268435472,0,0,10272
.long 7,2,0,4,268435472,0,0,10272
.long 7,3,0,4,268435472,0,0,10272
.long 7,4,0,4,268435472,0,0,10272
.long 7,5,0,4,268435472,0,0,10272
.long 7,6,0,4,268435472,0,0,10272
.long 7,7,0,4,268435472,0,0,10272
.long 14,0,0,0,671088896,0,536870976,0
.long 14,0,128,0,671088896,0,536870976,0
.long 14,0,256,0,671088896,0,536870976,0
.long 14,0,384,0,671088896,0,536870976,0
.long 14,0,512,0,671088896,0,536870976,0
.long 14,0,640,0,671088896,0,536870976,0
.long 14,0,768,0,671088896,0,536870976,0
.long 14,0,896,0,671088896,0,536870976,0
.long 7,8,0,4,285212688,0,0,10528
.long 7,9,0,4,285212688,0,0,10528
.long 7,10,0,4,285212688,0,0,10528
.long 7,11,0,4,285212688,0,0,10528
.long 7,12,0,4,285212688,0,0,10528
.long 7,13,0,4,285212688,0,0,10528
.long 7,14,0,4,285212688,0,0,10528
.long 7,15,0,4,285212688,0,0,10528
.long 14,256,0,0,687866112,0,553648192,0
.long 14,256,128,0,687866112,0,553648192,0
.long 14,256,256,0,687866112,0,553648192,0
.long 14,256,384,0,687866112,0,553648192,0
.long 14,256,512,0,687866112,0,553648192,0
.long 14,256,640,0,687866112,0,553648192,0
.long 14,256,768,0,687866112,0,553648192,0
.long 14,256,896,0,687866112,0,553648192,0
.long 7,16,0,4,301989904,0,0,10784
.long 7,17,0,4,301989904,0,0,10784
.long 7,18,0,4,301989904,0,0,10784
.long 7,19,0,4,301989904,0,0,10784
.long 7,20,0,4,301989904,0,0,10784
.long 7,21,0,4,301989904,0,0,10784
.long 7,22,0,4,301989904,0,0,10784
.long 7,23,0,4,301989904,0,0,10784
.long 14,512,0,0,704643328,0,570425408,0
.long 14,512,128,0,704643328,0,570425408,0
.long 14,512,256,0,704643328,0,570425408,0
.long 14,512,384,0,704643328,0,570425408,0
.long 14,512,512,0,704643328,0,570425408,0
.long 14,512,640,0,704643328,0,570425408,0
.long 14,512,768,0,704643328,0,570425408,0
.long 14,512,896,0,704643328,0,570425408,0
.long 7,24,0,4,318767120,0,0,11040
.long 7,25,0,4,318767120,0,0,11040
.long 7,26,0,4,318767120,0,0,11040
.long 7,27,0,4,318767120,0,0,11040
.long 7,28,0,4,318767120,0,0,11040
.long 7,29,0,4,318767120,0,0,11040
.long 7,30,0,4,318767120,0,0,11040
.long 7,31,0,4,318767120,0,0,11040
.long 14,768,0,0,721420544,0,587202624,0
.long 14,768,128,0,721420544,0,587202624,0
.long 14,768,256,0,721420544,0,587202624,0
.long 14,768,384,0,721420544,0,587202624,0
.long 14,768,512,0,721420544,0,587202624,0
.long 14,768,640,0,721420544,0,587202624,0
.long 14,768,768,0,721420544,0,587202624,0
.long 14,768,896,0,721420544,0,587202624,0
.long 7,32,0,2,335544336,0,0,11280
.long 7,32,16,2,335544336,0,0,11280
.long 7,33,0,2,335544336,0,0,11280
.long 7,33,16,2,335544336,0,0,11280
.long 7,34,0,2,335544336,0,0,11280
.long 7,34,16,2,335544336,0,0,11280
.long 7,35,0,2,335544336,0,0,11280
.long 7,35,16,2,335544336,0,0,11280
.long 11,1024,0,0,738197760,0,603979840,0
.long 11,1024,128,0,738197760,0,603979840,0
.long 11,1024,256,0,738197760,0,603979840,0
.long 11,1024,384,0,738197760,0,603979840,0
.long 11,1024,512,0,738197760,0,603979840,0
.long 11,1024,640,0,738197760,0,603979840,0
.long 11,1024,768,0,738197760,0,603979840,0
.long 11,1024,896,0,738197760,0,603979840,0
.long 7,36,0,2,335544336,0,0,11280
.long 7,36,16,2,335544336,0,0,11280
.long 7,37,0,2,335544336,0,0,11280
.long 7,37,16,2,335544336,0,0,11280
.long 7,38,0,2,335544336,0,0,11280
.long 7,38,16,2,335544336,0,0,11280
.long 7,39,0,2,335544336,0,0,11280
.long 7,39,16,2,335544336,0,0,11280
.long 11,1152,0,0,738197760,0,603979840,0
.long 11,1152,128,0,738197760,0,603979840,0
.long 11,1152,256,0,738197760,0,603979840,0
.long 11,1152,384,0,738197760,0,603979840,0
.long 11,1152,512,0,738197760,0,603979840,0
.long 11,1152,640,0,738197760,0,603979840,0
.long 11,1152,768,0,738197760,0,603979840,0
.long 11,1152,896,0,738197760,0,603979840,0
.long 7,40,0,2,352321552,0,0,11536
.long 7,40,16,2,352321552,0,0,11536
.long 7,41,0,2,352321552,0,0,11536
.long 7,41,16,2,352321552,0,0,11536
.long 7,42,0,2,352321552,0,0,11792
.long 7,42,16,2,352321552,0,0,11792
.long 7,43,0,2,352321552,0,0,11792
.long 7,43,16,2,352321552,0,0,11792
.long 11,1280,0,0,754974784,771752000,620757056,0
.long 11,1280,128,0,754974784,771752000,620757056,0
.long 11,1280,256,0,754974784,771752000,620757056,0
.long 11,1280,384,0,754974784,771752000,620757056,0
.long 11,1280,512,0,754974784,771752000,620757056,0
.long 11,1280,640,0,754974784,771752000,620757056,0
.long 11,1280,768,0,754974784,771752000,620757056,0
.long 11,1280,896,0,754974784,771752000,620757056,0
.long 7,44,0,2,352321552,0,0,12048
.long 7,44,16,2,352321552,0,0,12048
.long 7,45,0,2,352321552,0,0,12048
.long 7,45,16,2,352321552,0,0,12048
.long 7,46,0,2,352321552,0,0,12304
.long 7,46,16,2,352321552,0,0,12304
.long 7,47,0,2,352321552,0,0,12304
.long 7,47,16,2,352321552,0,0,12304
.long 11,1408,0,0,788529216,805306432,620757056,0
.long 11,1408,128,0,788529216,805306432,620757056,0
.long 11,1408,256,0,788529216,805306432,620757056,0
.long 11,1408,384,0,788529216,805306432,620757056,0
.long 11,1408,512,0,788529216,805306432,620757056,0
.long 11,1408,640,0,788529216,805306432,620757056,0
.long 11,1408,768,0,788529216,805306432,620757056,0
.long 11,1408,896,0,788529216,805306432,620757056,0
.long 7,48,0,1,369098768,0,0,12552
.long 7,48,8,1,369098768,0,0,12552
.long 7,48,16,1,369098768,0,0,12552
.long 7,48,24,1,369098768,0,0,12552
.long 7,49,0,1,369098768,0,0,12552
.long 7,49,8,1,369098768,0,0,12552
.long 7,49,16,1,369098768,0,0,12552
.long 7,49,24,1,369098768,0,0,12552
.long 7,50,0,1,369098768,0,0,12808
.long 7,50,8,1,369098768,0,0,12808
.long 7,50,16,1,369098768,0,0,12808
.long 7,50,24,1,369098768,0,0,12808
.long 7,51,0,1,369098768,0,0,12808
.long 7,51,8,1,369098768,0,0,12808
.long 7,51,16,1,369098768,0,0,12808
.long 7,51,24,1,369098768,0,0,12808
.long 11,1536,0,0,822083648,838860864,637534272,0
.long 11,1536,128,0,822083648,838860864,637534272,0
.long 11,1536,256,0,822083648,838860864,637534272,0
.long 11,1536,384,0,822083648,838860864,637534272,0
.long 11,1536,512,0,822083648,838860864,637534272,0
.long 11,1536,640,0,822083648,838860864,637534272,0
.long 11,1536,768,0,822083648,838860864,637534272,0
.long 11,1536,896,0,822083648,838860864,637534272,0
.long 7,52,0,1,369098768,0,0,13064
.long 7,52,8,1,369098768,0,0,13064
.long 7,52,16,1,369098768,0,0,13064
.long 7,52,24,1,369098768,0,0,13064
.long 7,53,0,1,369098768,0,0,13064
.long 7,53,8,1,369098768,0,0,13064
.long 7,53,16,1,369098768,0,0,13064
.long 7,53,24,1,369098768,0,0,13064
.long 12,1664,0,0,855638080,0,637534272,0
.long 12,1664,64,0,855638080,0,637534272,0
.long 12,1664,128,0,855638080,0,637534272,0
.long 12,1664,192,0,855638080,0,637534272,0
.long 12,1664,256,0,855638080,0,637534272,0
.long 12,1664,320,0,855638080,0,637534272,0
.long 12,1664,384,0,855638080,0,637534272,0
.long 12,1664,448,0,855638080,0,637534272,0
.long 12,1664,512,0,855638080,0,637534272,0
.long 12,1664,576,0,855638080,0,637534272,0
.long 12,1664,640,0,855638080,0,637534272,0
.long 12,1664,704,0,855638080,0,637534272,0
.long 12,1664,768,0,855638080,0,637534272,0
.long 12,1664,832,0,855638080,0,637534272,0
.long 12,1664,896,0,855638080,0,637534272,0
.long 12,1664,960,0,855638080,0,637534272,0
.long 7,54,0,1,369098768,0,0,13320
.long 7,54,8,1,369098768,0,0,13320
.long 7,54,16,1,369098768,0,0,13320
.long 7,54,24,1,369098768,0,0,13320
.long 7,55,0,1,369098768,0,0,13320
.long 7,55,8,1,369098768,0,0,13320
.long 7,55,16,1,369098768,0,0,13320
.long 7,55,24,1,369098768,0,0,13320
.long 12,1728,0,0,872415296,0,637534272,0
.long 12,1728,64,0,872415296,0,637534272,0
.long 12,1728,128,0,872415296,0,637534272,0
.long 12,1728,192,0,872415296,0,637534272,0
.long 12,1728,256,0,872415296,0,637534272,0
.long 12,1728,320,0,872415296,0,637534272,0
.long 12,1728,384,0,872415296,0,637534272,0
.long 12,1728,448,0,872415296,0,637534272,0
.long 12,1728,512,0,872415296,0,637534272,0
.long 12,1728,576,0,872415296,0,637534272,0
.long 12,1728,640,0,872415296,0,637534272,0
.long 12,1728,704,0,872415296,0,637534272,0
.long 12,1728,768,0,872415296,0,637534272,0
.long 12,1728,832,0,872415296,0,637534272,0
.long 12,1728,896,0,872415296,0,637534272,0
.long 12,1728,960,0,872415296,0,637534272,0
.long 7,56,0,1,385875984,0,0,15368
.long 7,56,8,1,385875984,0,0,15624
.long 7,56,16,1,385875984,0,0,15880
.long 7,56,24,1,385875984,0,0,16136
.long 7,57,0,1,385875984,0,0,16392
.long 7,57,8,1,385875984,0,0,16648
.long 7,57,16,1,385875984,0,0,16904
.long 7,57,24,1,385875984,0,0,17160
.long 7,58,0,1,385875984,0,0,17416
.long 7,58,8,1,385875984,0,0,17672
.long 7,58,16,1,385875984,0,0,17928
.long 7,58,24,1,385875984,0,0,18184
.long 7,59,0,1,385875984,0,0,18440
.long 7,59,8,1,385875984,0,0,18696
.long 7,59,16,1,385875984,0,0,18952
.long 7,59,24,1,385875984,0,0,19208
.long 7,60,0,1,385875984,0,0,19464
.long 7,60,8,1,385875984,0,0,19720
.long 7,60,16,1,385875984,0,0,19976
.long 7,60,24,1,385875984,0,0,20232
.long 7,61,0,1,385875984,0,0,20488
.long 7,61,8,1,385875984,0,0,20744
.long 7,61,16,1,385875984,0,0,21000
.long 7,61,24,1,385875984,0,0,21256
.long 7,62,0,1,385875984,0,0,21512
.long 7,62,8,1,385875984,0,0,21768
.long 7,62,16,1,385875984,0,0,22024
.long 7,62,24,1,385875984,0,0,22280
.long 7,63,0,1,385875984,0,0,22536
.long 7,63,8,1,385875984,0,0,22792
.long 7,63,16,1,385875984,0,0,23048
.long 7,63,24,1,385875984,0,0,23304
.long 7,32,0,2,335544336,0,0,11280
.long 7,34,0,2,335544336,0,0,11280
.long 7,36,0,2,335544336,0,0,11280
.long 7,38,0,2,335544336,0,0,11280
.long 7,40,0,2,352321552,0,0,11536
.long 7,42,0,2,352321552,0,0,11792
.long 7,44,0,2,352321552,0,0,12048
.long 7,46,0,2,352321552,0,0,12304
.long 7,48,0,1,369098768,0,0,12552
.long 7,49,0,1,369098768,0,0,12552
.long 7,50,0,1,369098768,0,0,12808
.long 7,51,0,1,369098768,0,0,12808
.long 7,52,0,1,369098768,0,0,13064
.long 7,53,0,1,369098768,0,0,13064
.long 7,54,0,1,369098768,0,0,13320
.long 7,55,0,1,369098768,0,0,13320
.long 7,56,0,1,385875984,0,0,15368
.long 7,57,0,1,385875984,0,0,16392
.long 7,58,0,1,385875984,0,0,17416
.long 7,59,0,1,385875984,0,0,18440
.long 7,60,0,1,385875984,0,0,19464
.long 7,61,0,1,385875984,0,0,20488
.long 7,62,0,1,385875984,0,0,21512
.long 7,63,0,1,385875984,0,0,22536
.long 7,32,16,2,335544336,0,0,11280
.long 7,34,16,2,335544336,0,0,11280
.long 7,36,16,2,335544336,0,0,11280
.long 7,38,16,2,335544336,0,0,11280
.long 7,40,16,2,352321552,0,0,11536
.long 7,42,16,2,352321552,0,0,11792
.long 7,44,16,2,352321552,0,0,12048
.long 7,46,16,2,352321552,0,0,12304
.long 7,48,8,1,369098768,0,0,12552
.long 7,49,8,1,369098768,0,0,12552
.long 7,50,8,1,369098768,0,0,12808
.long 7,51,8,1,369098768,0,0,12808
.long 7,52,8,1,369098768,0,0,13064
.long 7,53,8,1,369098768,0,0,13064
.long 7,54,8,1,369098768,0,0,13320
.long 7,55,8,1,369098768,0,0,13320
.long 7,56,8,1,385875984,0,0,15624
.long 7,57,8,1,385875984,0,0,16648
.long 7,58,8,1,385875984,0,0,17672
.long 7,59,8,1,385875984,0,0,18696
.long 7,60,8,1,385875984,0,0,19720
.long 7,61,8,1,385875984,0,0,20744
.long 7,62,8,1,385875984,0,0,21768
.long 7,63,8,1,385875984,0,0,22792
.long 7,33,0,2,335544336,0,0,11280
.long 7,35,0,2,335544336,0,0,11280
.long 7,37,0,2,335544336,0,0,11280
.long 7,39,0,2,335544336,0,0,11280
.long 7,41,0,2,352321552,0,0,11536
.long 7,43,0,2,352321552,0,0,11792
.long 7,45,0,2,352321552,0,0,12048
.long 7,47,0,2,352321552,0,0,12304
.long 7,48,16,1,369098768,0,0,12552
.long 7,49,16,1,369098768,0,0,12552
.long 7,50,16,1,369098768,0,0,12808
.long 7,51,16,1,369098768,0,0,12808
.long 7,52,16,1,369098768,0,0,13064
.long 7,53,16,1,369098768,0,0,13064
.long 7,54,16,1,369098768,0,0,13320
.long 7,55,16,1,369098768,0,0,13320
.long 7,56,16,1,385875984,0,0,15880
.long 7,57,16,1,385875984,0,0,16904
.long 7,58,16,1,385875984,0,0,17928
.long 7,59,16,1,385875984,0,0,18952
.long 7,60,16,1,385875984,0,0,19976
.long 7,61,16,1,385875984,0,0,21000
.long 7,62,16,1,385875984,0,0,22024
.long 7,63,16,1,385875984,0,0,23048
.long 7,33,16,2,335544336,0,0,11280
.long 7,35,16,2,335544336,0,0,11280
.long 7,37,16,2,335544336,0,0,11280
.long 7,39,16,2,335544336,0,0,11280
.long 7,41,16,2,352321552,0,0,11536
.long 7,43,16,2,352321552,0,0,11792
.long 7,45,16,2,352321552,0,0,12048
.long 7,47,16,2,352321552,0,0,12304
.long 7,48,24,1,369098768,0,0,12552
.long 7,49,24,1,369098768,0,0,12552
.long 7,50,24,1,369098768,0,0,12808
.long 7,51,24,1,369098768,0,0,12808
.long 7,52,24,1,369098768,0,0,13064
.long 7,53,24,1,369098768,0,0,13064
.long 7,54,24,1,369098768,0,0,13320
.long 7,55,24,1,369098768,0,0,13320
.long 7,56,24,1,385875984,0,0,16136
.long 7,57,24,1,385875984,0,0,17160
.long 7,58,24,1,385875984,0,0,18184
.long 7,59,24,1,385875984,0,0,19208
.long 7,60,24,1,385875984,0,0,20232
.long 7,61,24,1,385875984,0,0,21256
.long 7,62,24,1,385875984,0,0,22280
.long 7,63,24,1,385875984,0,0,23304
.size L_table, .-L_table
.section .rodata,"a"
.p2align 6
.amdhsa_kernel gated_mix__memory_aug_recurrent_mem_tr__dense_activation_silu__prompt_kernel
  .amdhsa_next_free_vgpr 256
  .amdhsa_next_free_sgpr 102
  .amdhsa_accum_offset 192
  .amdhsa_group_segment_fixed_size 0
  .amdhsa_kernarg_size 112
  .amdhsa_user_sgpr_count 2
  .amdhsa_user_sgpr_kernarg_segment_ptr 1
  .amdhsa_system_sgpr_workgroup_id_x 1
  .amdhsa_float_denorm_mode_32 3
.end_amdhsa_kernel
```
